```python
import torch

def _softmax(x, axis=-1):
    return torch.softmax(x, dim=axis)
def _gelu(x):
    return torch.nn.functional.gelu(x, approximate="tanh")
def _silu(x):
    return torch.nn.functional.silu(x)
def _sigmoid(x):
    return torch.sigmoid(x)
def _layernorm(x, axis=-1, eps=1e-5):
    m = x.mean(dim=axis, keepdim=True)
    v = x.var(dim=axis, keepdim=True, unbiased=False)
    return (x - m) / torch.sqrt(v + eps)
def _scatter_add(tgt, idx, src, axis=0):
    return tgt.clone().index_add_(axis, idx, src)
def _segment_sum(src, seg, n):
    out = torch.zeros((n,) + src.shape[1:], dtype=src.dtype)
    return out.index_add_(0, seg, src)
def _pad(x, pw):
    flat = tuple(v for pair in reversed(pw) for v in pair)
    return torch.nn.functional.pad(x, flat)

kernel_name = 'gated_mix__ssm_conv_s5__glu_gated_reglu__prompt'

def setup_inputs():

    _w = (lambda a: (lambda t: t.to(torch.bfloat16) if t.is_floating_point() else t)(torch.as_tensor(a)))
    def _A_setup():
        B, S, D = 1, 2048, 576
        P = D
        Lambda_re = -0.5 * (lambda _x: torch.exp(torch.as_tensor(_x)))((lambda *s: torch.randn(*s, dtype=torch.bfloat16) * 0.2)(P))
        Lambda_im = (lambda *s: torch.randn(*s, dtype=torch.bfloat16) * 0.4)(P) * 1.0
        B_re = (lambda *s: torch.randn(*s, dtype=torch.bfloat16) * 0.2)(P, D) * (D ** -0.5)
        B_im = (lambda *s: torch.randn(*s, dtype=torch.bfloat16) * 0.2)(P, D) * (D ** -0.5)
        C_re = (lambda *s: torch.randn(*s, dtype=torch.bfloat16) * 0.2)(D, P) * (P ** -0.5)
        C_im = (lambda *s: torch.randn(*s, dtype=torch.bfloat16) * 0.2)(D, P) * (P ** -0.5)
        log_dt = (lambda *s: torch.randn(*s, dtype=torch.bfloat16) * 0.2)(P) * 0.3 - 2.0
        Dskip = (lambda *s: torch.randn(*s, dtype=torch.bfloat16) * 0.05)(D)
        return {
            "x": _w((lambda *s: torch.randn(*s, dtype=torch.bfloat16) * 0.05)(B, S, D)),
            "Lambda_re": _w(Lambda_re),
            "Lambda_im": _w(Lambda_im),
            "B_re": _w(B_re),
            "B_im": _w(B_im),
            "C_re": _w(C_re),
            "C_im": _w(C_im),
            "log_dt": _w(log_dt),
            "Dskip": _w(Dskip),
        }
    _A_in = _A_setup()

    def _B_setup():
        B, S, D, F = 1, 2048, 576, 4608
        return {
            "x": _w((lambda *s: torch.randn(*s, dtype=torch.bfloat16) * 0.05)(B, S, D)),
            "W_gate": _w((lambda *s: torch.randn(*s, dtype=torch.bfloat16) * 0.8)(D, F) * (2.0 / D) ** 0.5),
            "W_up": _w((lambda *s: torch.randn(*s, dtype=torch.bfloat16) * 0.8)(D, F) * (2.0 / D) ** 0.5),
            "W_down": _w((lambda *s: torch.randn(*s, dtype=torch.bfloat16) * 0.8)(F, D) * (1.0 / F) ** 0.5),
        }
    _B_in = _B_setup()

    return {
        "A_x": _A_in["x"],
        "A_Lambda_re": _A_in["Lambda_re"],
        "A_Lambda_im": _A_in["Lambda_im"],
        "A_B_re": _A_in["B_re"],
        "A_B_im": _A_in["B_im"],
        "A_C_re": _A_in["C_re"],
        "A_C_im": _A_in["C_im"],
        "A_log_dt": _A_in["log_dt"],
        "A_Dskip": _A_in["Dskip"],
        "B_x": _B_in["x"],
        "B_W_gate": _B_in["W_gate"],
        "B_W_up": _B_in["W_up"],
        "B_W_down": _B_in["W_down"],
        "gate_w": _w((lambda *s: torch.randn(*s, dtype=torch.bfloat16) * 0.05)(576) * 16.0),
    }

def reference(A_x, A_Lambda_re, A_Lambda_im, A_B_re, A_B_im, A_C_re, A_C_im, A_log_dt, A_Dskip, B_x, B_W_gate, B_W_up, B_W_down, gate_w):
    def _A_ref(x, Lambda_re, Lambda_im, B_re, B_im, C_re, C_im, log_dt, Dskip):
        Bsz, L, H = x.shape
        Lam = Lambda_re + 1j * Lambda_im
        Bmat = B_re + 1j * B_im
        Cmat = C_re + 1j * C_im
        dt = torch.exp(log_dt)
        Lam_bar = torch.exp(dt * Lam)
        B_bar = ((Lam_bar - 1.0) / Lam)[:, None] * Bmat
        Bu = torch.einsum("bld,pd->blp", x + 0j, B_bar)
        h = torch.zeros_like(Bu[:, 0, :])
        hs = []
        for t in range(L):
            h = Lam_bar[None, :] * h + Bu[:, t, :]
            hs.append(h)
        hseq = torch.stack(hs, 1)
        y = 2.0 * torch.einsum("blp,dp->bld", hseq, Cmat).real + x * Dskip[None, None, :]
        return y

    def _B_ref(x, W_gate, W_up, W_down):
        gate = torch.einsum("bsd,df->bsf", x, W_gate)
        up = torch.einsum("bsd,df->bsf", x, W_up)
        gate = gate * (lambda x, dt: x.to(dt))(gate > 0, gate.dtype)
        h = gate * up
        return torch.einsum("bsf,fd->bsd", h, W_down)

    x = A_x
    g = _sigmoid((x * gate_w).sum(-1, keepdims=True))
    a = _A_ref(x, A_Lambda_re, A_Lambda_im, A_B_re, A_B_im, A_C_re, A_C_im, A_log_dt, A_Dskip)
    b = _B_ref(x, B_W_gate, B_W_up, B_W_down)
    return g * a + (1 - g) * b
```

```asm
; @launch grid=(256,1,1) block=(256,1,1) lds=163584
.amdgcn_target "amdgcn-amd-amdhsa--gfx950"
.text
.globl gated_mix__ssm_conv_s5__glu_gated_reglu__prompt_kernel
.p2align 8
.type gated_mix__ssm_conv_s5__glu_gated_reglu__prompt_kernel,@function
gated_mix__ssm_conv_s5__glu_gated_reglu__prompt_kernel:
  s_cmp_ge_u32 s2, 256
  s_cbranch_scc0 L_go
  s_endpgm
L_go:
  s_load_dwordx16 s[64:79], s[0:1], 0
  s_load_dwordx16 s[80:95], s[0:1], 64
  s_load_dwordx2 s[96:97], s[0:1], 128
  v_and_b32 v225, 63, v0
  v_lshrrev_b32 v1, 6, v0
  s_and_b32 s49, s2, 7
  s_lshr_b32 s50, s2, 3
  v_readfirstlane_b32 s40, v1
  s_lshl_b32 s42, s49, 1
  s_and_b32 s53, s50, 1
  s_add_u32 s42, s42, s53
  s_lshr_b32 s41, s50, 1
  s_cmp_eq_u32 s53, 1
  s_cbranch_scc0 L_var0
  s_branch L_var1
L_var0:
  s_mul_i32 s43, s42, 9
  s_lshr_b32 s43, s43, 1
  s_lshl_b32 s43, s43, 3
  s_mul_i32 s46, s40, 6144
  s_mul_i32 s47, s40, 3072
  v_lshrrev_b32 v203, 4, v225
  v_and_b32 v10, 7, v225
  v_xor_b32 v203, v203, v10
  v_lshlrev_b32 v203, 4, v203
  v_lshrrev_b32 v10, 3, v225
  v_mul_u32_u24 v10, 1152, v10
  v_xor_b32 v204, 64, v203
  v_add_u32 v203, v203, v10
  v_add_u32 v204, v204, v10
  v_add_u32 v204, 8192, v204
  v_add_u32 v205, 16384, v203
  v_add_u32 v206, 16384, v204
  v_add_u32 v207, 36864, v203
  v_add_u32 v208, 36864, v204
  s_and_b32 s55, s40, 1
  s_mul_i32 s44, s43, 1152
  s_lshl_b32 s49, s55, 7
  s_add_u32 s44, s44, s49
  s_lshl_b32 s49, s41, 7
  s_lshl_b32 s50, s40, 5
  s_add_u32 s49, s49, s50
  s_mul_i32 s98, s49, 1152
  s_lshl_b32 s99, s40, 12
  s_add_u32 s99, s99, 49152
  s_waitcnt lgkmcnt(0)
  s_mov_b32 s4, s64
  s_mov_b32 s5, s65
  s_mov_b32 s6, 2359296
  s_mov_b32 s7, 0x20000
  s_cmp_lt_u32 s40, 2
  s_cselect_b32 s16, s70, s72
  s_cselect_b32 s17, s71, s73
  s_mov_b32 s18, 663552
  s_mov_b32 s19, 0x20000
  s_add_u32 m0, s46, 0
  s_nop 0
  buffer_load_dwordx4 v203, s[16:19], s44 offen lds
  v_and_b32 v14, 15, v225
  v_lshrrev_b32 v15, 1, v14
  v_lshlrev_b32 v14, 7, v14
  v_lshrrev_b32 v196, 4, v225
  v_add_u32 v196, 0, v196
  v_xor_b32 v196, v196, v15
  v_lshlrev_b32 v196, 4, v196
  v_add_u32 v196, v196, v14
  v_add_u32 v198, 49152, v196
  v_add_u32 v200, 98304, v196
  v_lshrrev_b32 v197, 4, v225
  v_add_u32 v197, 4, v197
  buffer_load_dwordx4 v204, s[16:19], s44 offen offset:1024 lds
  v_xor_b32 v197, v197, v15
  v_lshlrev_b32 v197, 4, v197
  v_add_u32 v197, v197, v14
  v_add_u32 v199, 49152, v197
  v_add_u32 v201, 98304, v197
  v_add_u32 v252, s99, v196
  v_add_u32 v253, s99, v197
  v_add_u32 v66, 49152, v252
  v_add_u32 v67, 49152, v253
  v_lshrrev_b32 v3, 4, v225
  v_lshlrev_b32 v202, 4, v3
  v_add_u32 v202, s47, v202
  buffer_load_dwordx4 v205, s[16:19], s44 offen offset:2048 lds
  v_add_u32 v202, 147456, v202
  v_lshrrev_b32 v209, 5, v225
  v_lshlrev_b32 v209, 1, v209
  v_and_b32 v14, 3, v225
  v_xor_b32 v209, v209, v14
  v_lshlrev_b32 v209, 4, v209
  v_lshrrev_b32 v14, 2, v225
  v_mul_u32_u24 v14, 9216, v14
  v_add_u32 v209, v209, v14
  v_add_u32 v210, 146432, v209
  v_add_u32 v211, 292864, v209
  v_add_u32 v212, 439296, v209
  buffer_load_dwordx4 v206, s[16:19], s44 offen offset:3072 lds
  v_add_u32 v213, 589824, v209
  v_add_u32 v214, 736256, v209
  v_lshrrev_b32 v14, 4, v225
  v_lshlrev_b32 v14, 3, v14
  v_bfe_u32 v15, v225, 2, 2
  v_add_u32 v14, v14, v15
  v_lshlrev_b32 v14, 6, v14
  v_and_b32 v15, 3, v225
  v_lshlrev_b32 v15, 3, v15
  v_add_u32 v14, v14, v15
  v_bfe_u32 v15, v225, 4, 1
  v_xor_b32 v184, 0, v15
  s_add_u32 s45, s98, 0
  s_add_u32 m0, s99, 0
  s_nop 0
  buffer_load_dwordx4 v203, s[4:7], s45 offen lds
  v_lshlrev_b32 v184, 5, v184
  v_add_u32 v184, v184, v14
  v_add_u32 v186, 49152, v184
  v_add_u32 v188, 98304, v184
  v_xor_b32 v185, 1, v15
  v_lshlrev_b32 v185, 5, v185
  v_add_u32 v185, v185, v14
  v_add_u32 v187, 49152, v185
  v_add_u32 v189, 98304, v185
  s_mul_i32 s49, s42, 576
  s_mul_i32 s50, s55, 442368
  s_add_u32 s64, s49, s50
  buffer_load_dwordx4 v204, s[4:7], s45 offen offset:1024 lds
  s_add_u32 s64, s64, 0
  s_mul_i32 s50, s55, 884736
  s_add_u32 s65, s49, s50
  s_add_u32 s65, s65, 512
  s_cmp_lt_u32 s40, 2
  s_cselect_b32 s20, s74, s76
  s_cselect_b32 s21, s75, s77
  s_mov_b32 s22, 663552
  s_mov_b32 s23, 0x20000
  s_mov_b32 s12, s88
  s_mov_b32 s13, s89
  s_mov_b32 s14, 5308416
  buffer_load_dwordx4 v205, s[4:7], s45 offen offset:2048 lds
  s_mov_b32 s15, 0x20000
  s_mov_b32 s24, s96
  s_mov_b32 s25, s97
  s_mov_b32 s26, 46276608
  s_mov_b32 s27, 0x20000
  s_mul_i32 s49, s42, 6144
  s_add_u32 s49, s49, 46137344
  s_add_u32 s28, s96, s49
  s_addc_u32 s29, s97, 0
  s_mov_b32 s30, 6144
  s_mov_b32 s31, 0x20000
  s_mov_b32 s32, s94
  buffer_load_dwordx4 v206, s[4:7], s45 offen offset:3072 lds
  s_mov_b32 s33, s95
  s_mov_b32 s34, 256
  s_mov_b32 s35, 0x20000
  s_add_u32 s45, s98, 128
  s_add_u32 m0, s99, 16384
  s_nop 0
  buffer_load_dwordx4 v203, s[4:7], s45 offen lds
  buffer_load_dwordx4 v204, s[4:7], s45 offen offset:1024 lds
  buffer_load_dwordx4 v205, s[4:7], s45 offen offset:2048 lds
  buffer_load_dwordx4 v206, s[4:7], s45 offen offset:3072 lds
  v_lshlrev_b32 v226, 4, v225
  v_min_u32 v8, 47, v225
  v_lshlrev_b32 v227, 3, v8
  v_add_u32 v9, s43, v8
  v_lshlrev_b32 v9, 1, v9
  s_mov_b32 s36, s66
  s_mov_b32 s37, s67
  s_mov_b32 s38, 1152
  s_mov_b32 s39, 0x20000
  buffer_load_ushort v228, v9, s[36:39], 0 offen
  s_mov_b32 s56, s68
  s_mov_b32 s57, s69
  s_mov_b32 s58, 1152
  s_mov_b32 s59, 0x20000
  buffer_load_ushort v229, v9, s[56:59], 0 offen
  s_mov_b32 s60, s78
  s_mov_b32 s61, s79
  s_mov_b32 s62, 1152
  s_mov_b32 s63, 0x20000
  buffer_load_ushort v230, v9, s[60:63], 0 offen
  s_mov_b32 s36, s90
  s_mov_b32 s37, s91
  s_mov_b32 s38, 1152
  s_mov_b32 s39, 0x20000
  s_add_u32 m0, s47, 147456
  s_nop 0
  buffer_load_dwordx4 v226, s[36:39], 0 offen lds
  buffer_load_dwordx4 v226, s[36:39], 0 offen offset:1024 lds
  s_add_u32 s45, s98, 256
  s_add_u32 m0, s99, 32768
  s_nop 0
  buffer_load_dwordx4 v203, s[4:7], s45 offen lds
  buffer_load_dwordx4 v204, s[4:7], s45 offen offset:1024 lds
  buffer_load_dwordx4 v205, s[4:7], s45 offen offset:2048 lds
  buffer_load_dwordx4 v206, s[4:7], s45 offen offset:3072 lds
  s_add_u32 s45, s98, 384
  s_add_u32 m0, s99, 49152
  s_nop 0
  buffer_load_dwordx4 v203, s[4:7], s45 offen lds
  buffer_load_dwordx4 v204, s[4:7], s45 offen offset:1024 lds
  buffer_load_dwordx4 v205, s[4:7], s45 offen offset:2048 lds
  buffer_load_dwordx4 v206, s[4:7], s45 offen offset:3072 lds
  s_add_u32 s44, s44, 256
  s_add_u32 m0, s46, 24576
  s_nop 0
  buffer_load_dwordx4 v203, s[16:19], s44 offen lds
  buffer_load_dwordx4 v204, s[16:19], s44 offen offset:1024 lds
  buffer_load_dwordx4 v205, s[16:19], s44 offen offset:2048 lds
  buffer_load_dwordx4 v206, s[16:19], s44 offen offset:3072 lds
  s_add_u32 s45, s98, 512
  s_add_u32 m0, s99, 65536
  s_nop 0
  buffer_load_dwordx4 v203, s[4:7], s45 offen lds
  buffer_load_dwordx4 v204, s[4:7], s45 offen offset:1024 lds
  buffer_load_dwordx4 v205, s[4:7], s45 offen offset:2048 lds
  buffer_load_dwordx4 v206, s[4:7], s45 offen offset:3072 lds
  s_add_u32 s45, s98, 640
  s_add_u32 m0, s99, 81920
  s_nop 0
  buffer_load_dwordx4 v203, s[4:7], s45 offen lds
  buffer_load_dwordx4 v204, s[4:7], s45 offen offset:1024 lds
  buffer_load_dwordx4 v205, s[4:7], s45 offen offset:2048 lds
  buffer_load_dwordx4 v206, s[4:7], s45 offen offset:3072 lds
  s_cmp_lt_u32 s40, 2
  s_cselect_b32 s8, s84, s86
  s_cselect_b32 s9, s85, s87
  s_mov_b32 s10, 5308416
  s_mov_b32 s11, 0x20000
  s_getpc_b64 s[100:101]
L_pc0:
  s_lshl_b32 s49, s41, 2
  s_add_u32 s49, s49, s40
  s_mul_i32 s49, s49, 1152
  v_lshlrev_b32 v12, 7, v225
  v_add_u32 v12, s49, v12
  v_min_u32 v12, CODE_SPAN0, v12
  v_cmp_gt_u32 vcc, 9, v225
  s_nop 3
  s_and_saveexec_b64 s[62:63], vcc
  global_load_dword a247, v12, s[100:101]
  s_mov_b64 exec, s[62:63]
  s_lshl_b32 s70, s41, 1
  s_add_u32 s70, s70, s55
  s_mul_i32 s100, s70, 1792
  s_mul_i32 s49, s43, 1152
  s_add_u32 s100, s100, s49
  v_lshlrev_b32 v12, 7, v225
  v_mov_b32 v13, 0x7ffffff0
  v_cmp_gt_u32 vcc, 14, v225
  s_nop 1
  v_cndmask_b32 v12, v13, v12, vcc
  buffer_load_dword a248, v12, s[16:19], s100 offen sc1
  v_mul_u32_u24 v12, 57, v225
  v_lshrrev_b32 v12, 10, v12
  v_mul_u32_u24 v13, 18, v12
  v_sub_u32 v13, v225, v13
  v_mul_u32_u24 v13, 9216, v13
  v_mul_i32_i24 v12, -512, v12
  v_add_u32 v12, 512, v12
  v_add_u32 v12, v12, v13
  v_mov_b32 v13, 0x7ffffff0
  v_cmp_gt_u32 vcc, 36, v225
  s_nop 1
  v_cndmask_b32 v12, v13, v12, vcc
  s_mul_i32 s100, s70, 165888
  s_mul_i32 s49, s42, 576
  s_add_u32 s100, s100, s49
  buffer_load_dword a251, v12, s[8:11], s100 offen sc1
  s_waitcnt vmcnt(32)
  ds_read_b128 a[0:3], v252 offset:0
  ds_read_b128 a[4:7], v252 offset:2048
  ds_read_b128 a[8:11], v253 offset:0
  ds_read_b128 a[12:15], v253 offset:2048
  s_waitcnt vmcnt(28)
  ds_read_b128 a[16:19], v252 offset:16384
  ds_read_b128 a[20:23], v252 offset:18432
  ds_read_b128 a[24:27], v253 offset:16384
  ds_read_b128 a[28:31], v253 offset:18432
  s_waitcnt vmcnt(23) lgkmcnt(0)
  s_barrier
  ds_read_b128 a[144:147], v196
  ds_read_b128 a[148:151], v196 offset:12288
  ds_read_b128 a[152:155], v196 offset:2048
  ds_read_b128 a[156:159], v196 offset:14336
  ds_read_b128 a[160:163], v202
  ds_read_b128 a[164:167], v197
  s_waitcnt lgkmcnt(3)
  v_mfma_f32_16x16x32_bf16 v[128:131], a[0:3], a[144:147], 0
  ds_read_b128 a[168:171], v197 offset:12288
  s_waitcnt vmcnt(19)
  v_mfma_f32_16x16x32_bf16 v[132:135], a[4:7], a[144:147], 0
  ds_read_b128 a[32:35], v252 offset:32768
  ds_read_b128 a[36:39], v252 offset:34816
  v_mfma_f32_16x16x32_bf16 v[136:139], a[0:3], a[148:151], 0
  ds_read_b128 a[172:175], v197 offset:2048
  ds_read_b128 a[40:43], v253 offset:32768
  ds_read_b128 a[44:47], v253 offset:34816
  v_mfma_f32_16x16x32_bf16 v[140:143], a[4:7], a[148:151], 0
  s_waitcnt vmcnt(15)
  ds_read_b128 a[48:51], v66 offset:0
  v_mfma_f32_16x16x32_bf16 v[144:147], a[0:3], a[152:155], 0
  ds_read_b128 a[144:147], v197 offset:14336
  ds_read_b128 a[52:55], v66 offset:2048
  ds_read_b128 a[56:59], v67 offset:0
  v_mfma_f32_16x16x32_bf16 v[148:151], a[4:7], a[152:155], 0
  ds_read_b128 a[60:63], v67 offset:2048
  s_waitcnt lgkmcnt(10)
  v_mfma_f32_16x16x32_bf16 v[152:155], a[0:3], a[156:159], 0
  ds_read_b128 a[148:151], v202 offset:64
  s_add_u32 s44, s44, 256
  s_add_u32 m0, s46, 49152
  v_mfma_f32_16x16x32_bf16 v[156:159], a[4:7], a[156:159], 0
  buffer_load_dwordx4 v203, s[16:19], s44 offen lds
  s_lshl_b32 s49, s42, 4
  s_add_u32 s49, s49, s41
  s_lshl_b32 s50, s49, 7
  s_add_u32 s50, s50, 46243840
  s_cmp_eq_u32 s40, 0
  s_cselect_b32 s51, 1, 0
  v_mfma_f32_16x16x32_bf16 v[176:179], a[0:3], a[160:163], 0
  ds_read_b128 a[152:155], v196 offset:6144
  v_cmp_gt_u32 vcc, s51, v225
  v_mov_b32 v248, 0x7ffffff0
  v_mfma_f32_16x16x32_bf16 v[180:183], a[4:7], a[160:163], 0
  v_mov_b32 v249, s50
  v_mov_b32 v250, s49
  v_mfma_f32_16x16x32_bf16 v[128:131], a[8:11], a[164:167], v[128:131]
  ds_read_b128 a[156:159], v196 offset:18432
  v_mov_b32 v251, 0
  v_cndmask_b32 v249, v248, v249, vcc
  v_mfma_f32_16x16x32_bf16 v[132:135], a[12:15], a[164:167], v[132:135]
  v_cndmask_b32 v254, v248, v250, vcc
  v_mfma_f32_16x16x32_bf16 v[136:139], a[8:11], a[168:171], v[136:139]
  ds_read_b128 a[160:163], v196 offset:8192
  buffer_load_dwordx4 v204, s[16:19], s44 offen offset:1024 lds
  v_mfma_f32_16x16x32_bf16 v[140:143], a[12:15], a[168:171], v[140:143]
  s_waitcnt lgkmcnt(2)
  v_mfma_f32_16x16x32_bf16 v[144:147], a[8:11], a[172:175], v[144:147]
  ds_read_b128 a[164:167], v196 offset:20480
  v_mfma_f32_16x16x32_bf16 v[148:151], a[12:15], a[172:175], v[148:151]
  v_mfma_f32_16x16x32_bf16 v[152:155], a[8:11], a[144:147], v[152:155]
  ds_read_b128 a[168:171], v202 offset:128
  v_mfma_f32_16x16x32_bf16 v[156:159], a[12:15], a[144:147], v[156:159]
  buffer_load_dwordx4 v205, s[16:19], s44 offen offset:2048 lds
  v_mfma_f32_16x16x32_bf16 v[176:179], a[8:11], a[148:151], v[176:179]
  ds_read_b128 a[172:175], v197 offset:6144
  v_mfma_f32_16x16x32_bf16 v[180:183], a[12:15], a[148:151], v[180:183]
  v_mfma_f32_16x16x32_bf16 v[128:131], a[16:19], a[152:155], v[128:131]
  ds_read_b128 a[144:147], v197 offset:18432
  v_mfma_f32_16x16x32_bf16 v[132:135], a[20:23], a[152:155], v[132:135]
  s_waitcnt lgkmcnt(2)
  v_mfma_f32_16x16x32_bf16 v[136:139], a[16:19], a[156:159], v[136:139]
  ds_read_b128 a[148:151], v197 offset:8192
  buffer_load_dwordx4 v206, s[16:19], s44 offen offset:3072 lds
  v_mfma_f32_16x16x32_bf16 v[140:143], a[20:23], a[156:159], v[140:143]
  s_add_u32 s45, s98, 768
  s_add_u32 m0, s99, 49152
  v_mfma_f32_16x16x32_bf16 v[144:147], a[16:19], a[160:163], v[144:147]
  ds_read_b128 a[152:155], v197 offset:20480
  v_mfma_f32_16x16x32_bf16 v[148:151], a[20:23], a[160:163], v[148:151]
  v_mfma_f32_16x16x32_bf16 v[152:155], a[16:19], a[164:167], v[152:155]
  ds_read_b128 a[156:159], v202 offset:192
  s_waitcnt vmcnt(15)
  v_mfma_f32_16x16x32_bf16 v[156:159], a[20:23], a[164:167], v[156:159]
  buffer_load_dwordx4 v203, s[4:7], s45 offen lds
  s_barrier
  v_mfma_f32_16x16x32_bf16 v[176:179], a[16:19], a[168:171], v[176:179]
  ds_read_b128 a[160:163], v196 offset:24576
  v_mfma_f32_16x16x32_bf16 v[180:183], a[20:23], a[168:171], v[180:183]
  buffer_load_dwordx4 v204, s[4:7], s45 offen offset:1024 lds
  buffer_load_dwordx4 v205, s[4:7], s45 offen offset:2048 lds
  buffer_load_dwordx4 v206, s[4:7], s45 offen offset:3072 lds
  s_waitcnt lgkmcnt(2)
  v_mfma_f32_16x16x32_bf16 v[128:131], a[24:27], a[172:175], v[128:131]
  ds_read_b128 a[164:167], v196 offset:36864
  s_add_u32 s44, s44, 256
  s_add_u32 m0, s46, 73728
  v_mfma_f32_16x16x32_bf16 v[132:135], a[28:31], a[172:175], v[132:135]
  v_mfma_f32_16x16x32_bf16 v[136:139], a[24:27], a[144:147], v[136:139]
  ds_read_b128 a[168:171], v196 offset:26624
  v_mfma_f32_16x16x32_bf16 v[140:143], a[28:31], a[144:147], v[140:143]
  v_mfma_f32_16x16x32_bf16 v[144:147], a[24:27], a[148:151], v[144:147]
  ds_read_b128 a[172:175], v196 offset:38912
  v_mfma_f32_16x16x32_bf16 v[148:151], a[28:31], a[148:151], v[148:151]
  buffer_load_dwordx4 v203, s[16:19], s44 offen lds
  v_mfma_f32_16x16x32_bf16 v[152:155], a[24:27], a[152:155], v[152:155]
  ds_read_b128 a[144:147], v202 offset:256
  v_mfma_f32_16x16x32_bf16 v[156:159], a[28:31], a[152:155], v[156:159]
  s_waitcnt lgkmcnt(2)
  v_mfma_f32_16x16x32_bf16 v[176:179], a[24:27], a[156:159], v[176:179]
  ds_read_b128 a[148:151], v197 offset:24576
  v_mfma_f32_16x16x32_bf16 v[180:183], a[28:31], a[156:159], v[180:183]
  v_mfma_f32_16x16x32_bf16 v[128:131], a[32:35], a[160:163], v[128:131]
  ds_read_b128 a[152:155], v197 offset:36864
  buffer_load_dwordx4 v204, s[16:19], s44 offen offset:1024 lds
  v_mfma_f32_16x16x32_bf16 v[132:135], a[36:39], a[160:163], v[132:135]
  v_mfma_f32_16x16x32_bf16 v[136:139], a[32:35], a[164:167], v[136:139]
  ds_read_b128 a[156:159], v197 offset:26624
  v_mfma_f32_16x16x32_bf16 v[140:143], a[36:39], a[164:167], v[140:143]
  buffer_load_dwordx4 v205, s[16:19], s44 offen offset:2048 lds
  buffer_load_dwordx4 v206, s[16:19], s44 offen offset:3072 lds
  v_mfma_f32_16x16x32_bf16 v[144:147], a[32:35], a[168:171], v[144:147]
  ds_read_b128 a[160:163], v197 offset:38912
  s_waitcnt vmcnt(19)
  v_mfma_f32_16x16x32_bf16 v[148:151], a[36:39], a[168:171], v[148:151]
  ds_read_b128 a[64:67], v66 offset:16384
  ds_read_b128 a[68:71], v66 offset:18432
  s_waitcnt lgkmcnt(4)
  v_mfma_f32_16x16x32_bf16 v[152:155], a[32:35], a[172:175], v[152:155]
  ds_read_b128 a[164:167], v202 offset:320
  ds_read_b128 a[72:75], v67 offset:16384
  ds_read_b128 a[76:79], v67 offset:18432
  v_mfma_f32_16x16x32_bf16 v[156:159], a[36:39], a[172:175], v[156:159]
  v_mfma_f32_16x16x32_bf16 v[176:179], a[32:35], a[144:147], v[176:179]
  ds_read_b128 a[168:171], v196 offset:30720
  v_mfma_f32_16x16x32_bf16 v[180:183], a[36:39], a[144:147], v[180:183]
  buffer_store_dword v251, v249, s[24:27], 0 offen sc1
  s_lshr_b32 s49, s42, 1
  v_mfma_f32_16x16x32_bf16 v[128:131], a[40:43], a[148:151], v[128:131]
  ds_read_b128 a[172:175], v196 offset:43008
  s_mul_i32 s49, s49, 663552
  s_mul_i32 s50, s55, 55296
  v_mfma_f32_16x16x32_bf16 v[132:135], a[44:47], a[148:151], v[132:135]
  s_lshr_b32 s51, s40, 1
  s_lshl_b32 s51, s51, 7
  s_add_u32 s66, s49, s50
  v_mfma_f32_16x16x32_bf16 v[136:139], a[40:43], a[152:155], v[136:139]
  ds_read_b128 a[144:147], v196 offset:32768
  s_add_u32 s66, s66, s51
  v_mfma_f32_16x16x32_bf16 v[140:143], a[44:47], a[152:155], v[140:143]
  s_add_u32 s49, s49, 0
  s_mul_i32 s50, s40, 55296
  s_waitcnt lgkmcnt(2)
  v_mfma_f32_16x16x32_bf16 v[144:147], a[40:43], a[156:159], v[144:147]
  ds_read_b128 a[148:151], v196 offset:45056
  v_mfma_f32_16x16x32_bf16 v[148:151], a[44:47], a[156:159], v[148:151]
  s_add_u32 s45, s98, 896
  s_add_u32 m0, s99, 65536
  s_nop 0
  buffer_load_dwordx4 v203, s[4:7], s45 offen lds
  v_mfma_f32_16x16x32_bf16 v[152:155], a[40:43], a[160:163], v[152:155]
  ds_read_b128 a[152:155], v202 offset:384
  s_add_u32 s67, s49, s50
  s_mul_i32 s50, s40, 27648
  v_mfma_f32_16x16x32_bf16 v[156:159], a[44:47], a[160:163], v[156:159]
  s_add_u32 s68, s49, s50
  s_add_u32 s68, s68, 221184
  v_mfma_f32_16x16x32_bf16 v[176:179], a[40:43], a[164:167], v[176:179]
  ds_read_b128 a[156:159], v197 offset:30720
  s_add_u32 s71, s43, 32
  s_mul_i32 s50, s55, 73728
  v_mfma_f32_16x16x32_bf16 v[180:183], a[44:47], a[164:167], v[180:183]
  s_lshl_b32 s51, s43, 1
  s_add_u32 s52, s50, s51
  v_mfma_f32_16x16x32_bf16 v[128:131], a[48:51], a[168:171], v[128:131]
  ds_read_b128 a[160:163], v197 offset:43008
  buffer_load_dwordx4 v204, s[4:7], s45 offen offset:1024 lds
  s_lshl_b32 s49, s71, 1
  v_mfma_f32_16x16x32_bf16 v[132:135], a[52:55], a[168:171], v[132:135]
  s_add_u32 s72, s50, s49
  s_mul_i32 s50, s55, 36864
  buffer_load_dwordx4 v205, s[4:7], s45 offen offset:2048 lds
  buffer_load_dwordx4 v206, s[4:7], s45 offen offset:3072 lds
  s_waitcnt lgkmcnt(2)
  v_mfma_f32_16x16x32_bf16 v[136:139], a[48:51], a[172:175], v[136:139]
  ds_read_b128 a[164:167], v197 offset:32768
  s_waitcnt vmcnt(20)
  ds_read_b128 a[80:83], v66 offset:32768
  v_mfma_f32_16x16x32_bf16 v[140:143], a[52:55], a[172:175], v[140:143]
  ds_read_b128 a[84:87], v66 offset:34816
  ds_read_b128 a[88:91], v67 offset:32768
  v_mfma_f32_16x16x32_bf16 v[144:147], a[48:51], a[144:147], v[144:147]
  ds_read_b128 a[168:171], v197 offset:45056
  ds_read_b128 a[92:95], v67 offset:34816
  s_add_u32 s69, s50, s51
  v_mfma_f32_16x16x32_bf16 v[148:151], a[52:55], a[144:147], v[148:151]
  s_lshr_b32 s48, s42, 1
  s_lshl_b32 s48, s48, 4
  v_mfma_f32_16x16x32_bf16 v[152:155], a[48:51], a[148:151], v[152:155]
  ds_read_b128 a[172:175], v202 offset:448
  s_add_u32 s48, s48, s41
  s_waitcnt vmcnt(13)
  v_mfma_f32_16x16x32_bf16 v[156:159], a[52:55], a[148:151], v[156:159]
  s_lshl_b32 s48, s48, 2
  s_add_u32 s48, s48, s40
  s_barrier
  v_mfma_f32_16x16x32_bf16 v[176:179], a[48:51], a[152:155], v[176:179]
  ds_read_b128 a[144:147], v198
  s_lshl_b32 s48, s48, 15
  v_mfma_f32_16x16x32_bf16 v[180:183], a[52:55], a[152:155], v[180:183]
  s_add_u32 s48, s48, 0
  s_lshl_b32 s54, s42, 4
  s_waitcnt lgkmcnt(3)
  v_mfma_f32_16x16x32_bf16 v[128:131], a[56:59], a[156:159], v[128:131]
  ds_read_b128 a[148:151], v198 offset:12288
  s_add_u32 s54, s54, s41
  s_lshl_b32 s54, s54, 2
  s_add_u32 s54, s54, s40
  v_mfma_f32_16x16x32_bf16 v[132:135], a[60:63], a[156:159], v[132:135]
  s_lshl_b32 s54, s54, 12
  s_add_u32 s54, s54, 16777216
  s_lshl_b32 s61, s41, 4
  s_add_u32 s62, s61, s42
  s_lshl_b32 s62, s62, 2
  s_add_u32 s62, s62, s40
  s_mul_i32 s61, s62, 24576
  s_waitcnt lgkmcnt(3)
  s_add_u32 s45, s98, 1024
  s_add_u32 m0, s99, 81920
  s_nop 0
  buffer_load_dwordx4 v203, s[4:7], s45 offen lds
  buffer_load_dwordx4 v204, s[4:7], s45 offen offset:1024 lds
  buffer_load_dwordx4 v205, s[4:7], s45 offen offset:2048 lds
  buffer_load_dwordx4 v206, s[4:7], s45 offen offset:3072 lds
  v_mfma_f32_16x16x32_bf16 v[136:139], a[56:59], a[160:163], v[136:139]
  ds_read_b128 a[152:155], v198 offset:2048
  s_add_u32 s44, s44, 256
  s_add_u32 m0, s46, 0
  v_mfma_f32_16x16x32_bf16 v[140:143], a[60:63], a[160:163], v[140:143]
  s_add_u32 s61, s61, 20971520
  s_add_u32 s62, s61, 98304
  v_mfma_f32_16x16x32_bf16 v[144:147], a[56:59], a[164:167], v[144:147]
  ds_read_b128 a[156:159], v198 offset:14336
  s_bfm_b64 s[56:57], s41, 0
  s_not_b64 s[56:57], s[56:57]
  v_mfma_f32_16x16x32_bf16 v[148:151], a[60:63], a[164:167], v[148:151]
  s_cmp_ge_u32 s40, 1
  s_cselect_b32 s58, 1.0, 0
  v_mfma_f32_16x16x32_bf16 v[152:155], a[56:59], a[168:171], v[152:155]
  ds_read_b128 a[160:163], v202 offset:512
  s_cmp_ge_u32 s40, 2
  s_cselect_b32 s59, 1.0, 0
  v_mfma_f32_16x16x32_bf16 v[156:159], a[60:63], a[168:171], v[156:159]
  buffer_load_dwordx4 v203, s[16:19], s44 offen lds
  s_waitcnt lgkmcnt(2)
  v_mfma_f32_16x16x32_bf16 v[176:179], a[56:59], a[172:175], v[176:179]
  ds_read_b128 a[164:167], v199
  s_cmp_ge_u32 s40, 3
  s_cselect_b32 s60, 1.0, 0
  v_mfma_f32_16x16x32_bf16 v[180:183], a[60:63], a[172:175], v[180:183]
  v_mul_u32_u24 v248, 57, v225
  v_mfma_f32_16x16x32_bf16 v[128:131], a[64:67], a[144:147], v[128:131]
  ds_read_b128 a[168:171], v199 offset:12288
  v_lshrrev_b32 v248, 10, v248
  v_mfma_f32_16x16x32_bf16 v[132:135], a[68:71], a[144:147], v[132:135]
  v_mul_u32_u24 v249, 18, v248
  v_mfma_f32_16x16x32_bf16 v[136:139], a[64:67], a[148:151], v[136:139]
  ds_read_b128 a[172:175], v199 offset:2048
  buffer_load_dwordx4 v204, s[16:19], s44 offen offset:1024 lds
  v_mfma_f32_16x16x32_bf16 v[140:143], a[68:71], a[148:151], v[140:143]
  v_sub_u32 v249, v225, v249
  v_mfma_f32_16x16x32_bf16 v[144:147], a[64:67], a[152:155], v[144:147]
  ds_read_b128 a[144:147], v199 offset:14336
  v_mul_u32_u24 v249, 9216, v249
  v_mfma_f32_16x16x32_bf16 v[148:151], a[68:71], a[152:155], v[148:151]
  v_lshlrev_b32 v248, 7, v248
  s_waitcnt lgkmcnt(2)
  v_mfma_f32_16x16x32_bf16 v[152:155], a[64:67], a[156:159], v[152:155]
  ds_read_b128 a[148:151], v202 offset:576
  v_add_u32 v248, 128, v248
  v_mfma_f32_16x16x32_bf16 v[156:159], a[68:71], a[156:159], v[156:159]
  buffer_load_dwordx4 v205, s[16:19], s44 offen offset:2048 lds
  v_add_u32 v249, v249, v248
  v_mov_b32 v250, 0x7ffffff0
  buffer_load_dwordx4 v206, s[16:19], s44 offen offset:3072 lds
  v_mfma_f32_16x16x32_bf16 v[176:179], a[64:67], a[160:163], v[176:179]
  ds_read_b128 a[152:155], v198 offset:6144
  v_cmp_gt_u32 vcc, 54, v225
  v_mfma_f32_16x16x32_bf16 v[180:183], a[68:71], a[160:163], v[180:183]
  s_nop 0
  v_cndmask_b32 v249, v250, v249, vcc
  v_mfma_f32_16x16x32_bf16 v[128:131], a[72:75], a[164:167], v[128:131]
  ds_read_b128 a[156:159], v198 offset:18432
  v_accvgpr_write_b32 a253, v249
  v_lshlrev_b32 v248, 7, v225
  v_mfma_f32_16x16x32_bf16 v[132:135], a[76:79], a[164:167], v[132:135]
  v_cmp_gt_u32 vcc, 41, v225
  v_mfma_f32_16x16x32_bf16 v[136:139], a[72:75], a[168:171], v[136:139]
  ds_read_b128 a[160:163], v198 offset:8192
  v_cndmask_b32 v248, v250, v248, vcc
  v_mfma_f32_16x16x32_bf16 v[140:143], a[76:79], a[168:171], v[140:143]
  v_accvgpr_write_b32 a254, v248
  s_waitcnt lgkmcnt(2)
  v_mfma_f32_16x16x32_bf16 v[144:147], a[72:75], a[172:175], v[144:147]
  ds_read_b128 a[164:167], v198 offset:20480
  v_lshrrev_b32 v248, 1, v225
  v_mfma_f32_16x16x32_bf16 v[148:151], a[76:79], a[172:175], v[148:151]
  v_mul_u32_u24 v248, 1152, v248
  v_and_b32 v249, 1, v225
  v_mfma_f32_16x16x32_bf16 v[152:155], a[72:75], a[144:147], v[152:155]
  ds_read_b128 a[168:171], v202 offset:640
  v_mul_u32_u24 v249, 92, v249
  v_mfma_f32_16x16x32_bf16 v[156:159], a[76:79], a[144:147], v[156:159]
  v_add_u32 v248, v248, v249
  v_cmp_gt_u32 vcc, 36, v225
  v_mfma_f32_16x16x32_bf16 v[176:179], a[72:75], a[148:151], v[176:179]
  ds_read_b128 a[172:175], v199 offset:6144
  v_cndmask_b32 v248, v250, v248, vcc
  v_mfma_f32_16x16x32_bf16 v[180:183], a[76:79], a[148:151], v[180:183]
  v_accvgpr_write_b32 a255, v248
  v_lshlrev_b32 v231, 16, v228
  v_lshlrev_b32 v232, 16, v229
  v_lshlrev_b32 v233, 16, v230
  s_waitcnt vmcnt(17)
  ds_read_b128 a[96:99], v66 offset:0
  ds_read_b128 a[100:103], v66 offset:2048
  ds_read_b128 a[104:107], v67 offset:0
  ds_read_b128 a[108:111], v67 offset:2048
  v_mfma_f32_16x16x32_bf16 v[128:131], a[80:83], a[152:155], v[128:131]
  ds_read_b128 a[144:147], v199 offset:18432
  v_mul_f32 v233, 0x3fb8aa3b, v233
  v_mfma_f32_16x16x32_bf16 v[132:135], a[84:87], a[152:155], v[132:135]
  v_exp_f32 v233, v233
  s_waitcnt lgkmcnt(6)
  v_mfma_f32_16x16x32_bf16 v[136:139], a[80:83], a[156:159], v[136:139]
  ds_read_b128 a[148:151], v199 offset:8192
  v_lshrrev_b32 v250, 3, v227
  v_mfma_f32_16x16x32_bf16 v[140:143], a[84:87], a[156:159], v[140:143]
  v_cvt_pk_bf16_f32 v233, v233, v233
  v_mfma_f32_16x16x32_bf16 v[144:147], a[80:83], a[160:163], v[144:147]
  ds_read_b128 a[152:155], v199 offset:20480
  v_lshlrev_b32 v233, 16, v233
  v_mfma_f32_16x16x32_bf16 v[148:151], a[84:87], a[160:163], v[148:151]
  v_mul_f32 v234, v233, v231
  v_mul_f32 v235, v233, v232
  v_mul_f32 v234, 0x3fb8aa3b, v234
  v_mul_f32 v235, 0x3e22f983, v235
  v_mul_f32 v248, 1.0, v234
  s_waitcnt vmcnt(8)
  ds_read_b128 a[112:115], v66 offset:16384
  ds_read_b128 a[116:119], v66 offset:18432
  ds_read_b128 a[120:123], v67 offset:16384
  ds_read_b128 a[124:127], v67 offset:18432
  v_mfma_f32_16x16x32_bf16 v[152:155], a[80:83], a[164:167], v[152:155]
  ds_read_b128 a[156:159], v202 offset:704
  v_mfma_f32_16x16x32_bf16 v[156:159], a[84:87], a[164:167], v[156:159]
  v_mul_f32 v249, 1.0, v235
  v_exp_f32 v248, v248
  s_barrier
  v_mfma_f32_16x16x32_bf16 v[176:179], a[80:83], a[168:171], v[176:179]
  ds_read_b128 a[160:163], v198 offset:24576
  s_mov_b32 s44, s65
  v_mfma_f32_16x16x32_bf16 v[180:183], a[84:87], a[168:171], v[180:183]
  s_add_u32 m0, s46, 24576
  s_nop 0
  buffer_load_dwordx4 v209, s[8:11], s44 offen lds
  s_waitcnt lgkmcnt(6)
  v_mfma_f32_16x16x32_bf16 v[128:131], a[88:91], a[172:175], v[128:131]
  ds_read_b128 a[164:167], v198 offset:36864
  v_fract_f32 v249, v249
  v_mfma_f32_16x16x32_bf16 v[132:135], a[92:95], a[172:175], v[132:135]
  v_cos_f32 v236, v249
  v_mfma_f32_16x16x32_bf16 v[136:139], a[88:91], a[144:147], v[136:139]
  ds_read_b128 a[168:171], v198 offset:26624
  v_sin_f32 v237, v249
  v_mfma_f32_16x16x32_bf16 v[140:143], a[92:95], a[144:147], v[140:143]
  v_mul_f32 v236, v248, v236
  v_mul_f32 v237, v248, v237
  v_mfma_f32_16x16x32_bf16 v[144:147], a[88:91], a[148:151], v[144:147]
  ds_read_b128 a[172:175], v198 offset:38912
  buffer_load_dwordx4 v210, s[8:11], s44 offen offset:1024 lds
  v_mul_f32 v248, 2.0, v234
  v_mfma_f32_16x16x32_bf16 v[148:151], a[92:95], a[148:151], v[148:151]
  v_mul_f32 v249, 2.0, v235
  v_exp_f32 v248, v248
  v_mfma_f32_16x16x32_bf16 v[152:155], a[88:91], a[152:155], v[152:155]
  ds_read_b128 a[144:147], v202 offset:768
  v_fract_f32 v249, v249
  v_mfma_f32_16x16x32_bf16 v[156:159], a[92:95], a[152:155], v[156:159]
  v_cos_f32 v238, v249
  v_sin_f32 v239, v249
  v_mov_b32 v64, 1
  buffer_store_byte v64, v254, s[32:35], 0 offen sc1
  s_waitcnt lgkmcnt(2)
  v_mfma_f32_16x16x32_bf16 v[176:179], a[88:91], a[156:159], v[176:179]
  ds_read_b128 a[148:151], v199 offset:24576
  v_mul_f32 v238, v248, v238
  v_mfma_f32_16x16x32_bf16 v[180:183], a[92:95], a[156:159], v[180:183]
  v_mul_f32 v239, v248, v239
  s_mov_b32 s49, 0x40400000
  v_mul_f32 v248, s49, v234
  v_mfma_f32_16x16x32_bf16 v[128:131], a[96:99], a[160:163], v[128:131]
  ds_read_b128 a[152:155], v199 offset:36864
  v_bfe_u32 v203, v225, 4, 1
  v_mul_f32 v249, s49, v235
  v_mfma_f32_16x16x32_bf16 v[132:135], a[100:103], a[160:163], v[132:135]
  v_lshlrev_b32 v203, 1, v203
  v_and_b32 v254, 7, v225
  v_mfma_f32_16x16x32_bf16 v[136:139], a[96:99], a[164:167], v[136:139]
  ds_read_b128 a[156:159], v199 offset:26624
  v_xor_b32 v203, v203, v254
  v_exp_f32 v248, v248
  v_mfma_f32_16x16x32_bf16 v[140:143], a[100:103], a[164:167], v[140:143]
  buffer_load_dwordx4 v211, s[8:11], s44 offen offset:2048 lds
  v_lshlrev_b32 v203, 4, v203
  v_lshrrev_b32 v254, 3, v225
  v_fract_f32 v249, v249
  v_mul_u32_u24 v254, 9216, v254
  buffer_load_dwordx4 v212, s[8:11], s44 offen offset:3072 lds
  s_add_u32 m0, s46, 28672
  s_nop 0
  buffer_load_dwordx4 v213, s[8:11], s44 offen lds
  buffer_load_dwordx4 v214, s[8:11], s44 offen offset:1024 lds
  v_mfma_f32_16x16x32_bf16 v[144:147], a[96:99], a[168:171], v[144:147]
  ds_read_b128 a[160:163], v199 offset:38912
  v_xor_b32 v204, 64, v203
  v_add_u32 v203, v203, v254
  v_mfma_f32_16x16x32_bf16 v[148:151], a[100:103], a[168:171], v[148:151]
  v_add_u32 v204, v204, v254
  s_waitcnt lgkmcnt(2)
  v_mfma_f32_16x16x32_bf16 v[152:155], a[96:99], a[172:175], v[152:155]
  ds_read_b128 a[164:167], v202 offset:832
  v_add_u32 v204, 72704, v204
  v_add_u32 v205, 145408, v203
  v_mfma_f32_16x16x32_bf16 v[156:159], a[100:103], a[172:175], v[156:159]
  v_add_u32 v206, 145408, v204
  v_add_u32 v207, 294912, v203
  v_mfma_f32_16x16x32_bf16 v[176:179], a[96:99], a[144:147], v[176:179]
  ds_read_b128 a[168:171], v198 offset:30720
  v_add_u32 v208, 294912, v204
  v_cos_f32 v240, v249
  v_mfma_f32_16x16x32_bf16 v[180:183], a[100:103], a[144:147], v[180:183]
  v_sin_f32 v241, v249
  v_mfma_f32_16x16x32_bf16 v[128:131], a[104:107], a[148:151], v[128:131]
  ds_read_b128 a[172:175], v198 offset:43008
  v_mul_f32 v240, v248, v240
  v_mul_f32 v241, v248, v241
  v_mfma_f32_16x16x32_bf16 v[132:135], a[108:111], a[148:151], v[132:135]
  v_mul_f32 v248, 4.0, v234
  v_mul_f32 v249, 4.0, v235
  v_mfma_f32_16x16x32_bf16 v[136:139], a[104:107], a[152:155], v[136:139]
  ds_read_b128 a[144:147], v198 offset:32768
  v_exp_f32 v248, v248
  v_mfma_f32_16x16x32_bf16 v[140:143], a[108:111], a[152:155], v[140:143]
  v_fract_f32 v249, v249
  s_waitcnt lgkmcnt(2)
  v_mfma_f32_16x16x32_bf16 v[144:147], a[104:107], a[156:159], v[144:147]
  ds_read_b128 a[148:151], v198 offset:45056
  v_cos_f32 v242, v249
  v_mfma_f32_16x16x32_bf16 v[148:151], a[108:111], a[156:159], v[148:151]
  v_sin_f32 v243, v249
  v_mfma_f32_16x16x32_bf16 v[152:155], a[104:107], a[160:163], v[152:155]
  ds_read_b128 a[152:155], v202 offset:896
  v_mul_f32 v242, v248, v242
  v_mul_f32 v243, v248, v243
  v_mfma_f32_16x16x32_bf16 v[156:159], a[108:111], a[160:163], v[156:159]
  v_mov_b32 v217, v242
  v_mov_b32 v218, v243
  v_mfma_f32_16x16x32_bf16 v[176:179], a[104:107], a[164:167], v[176:179]
  ds_read_b128 a[156:159], v199 offset:30720
  s_mov_b32 s49, 0x42000000
  v_mul_f32 v248, s49, v234
  v_mfma_f32_16x16x32_bf16 v[180:183], a[108:111], a[164:167], v[180:183]
  v_mul_f32 v249, s49, v235
  v_exp_f32 v248, v248
  v_mfma_f32_16x16x32_bf16 v[128:131], a[112:115], a[168:171], v[128:131]
  ds_read_b128 a[160:163], v199 offset:43008
  v_fract_f32 v249, v249
  v_mfma_f32_16x16x32_bf16 v[132:135], a[116:119], a[168:171], v[132:135]
  v_cos_f32 v219, v249
  s_waitcnt lgkmcnt(2)
  v_mfma_f32_16x16x32_bf16 v[136:139], a[112:115], a[172:175], v[136:139]
  ds_read_b128 a[164:167], v199 offset:32768
  v_sin_f32 v220, v249
  v_mfma_f32_16x16x32_bf16 v[140:143], a[116:119], a[172:175], v[140:143]
  v_mul_f32 v219, v248, v219
  v_mul_f32 v220, v248, v220
  s_mov_b32 s49, 0x43000000
  v_mfma_f32_16x16x32_bf16 v[144:147], a[112:115], a[144:147], v[144:147]
  ds_read_b128 a[168:171], v199 offset:45056
  v_mul_f32 v248, s49, v234
  v_mul_f32 v249, s49, v235
  v_mfma_f32_16x16x32_bf16 v[148:151], a[116:119], a[144:147], v[148:151]
  v_exp_f32 v248, v248
  v_fract_f32 v249, v249
  s_waitcnt vmcnt(11)
  ds_read_b128 a[128:131], v66 offset:32768
  ds_read_b128 a[132:135], v66 offset:34816
  ds_read_b128 a[136:139], v67 offset:32768
  ds_read_b128 a[140:143], v67 offset:34816
  v_mfma_f32_16x16x32_bf16 v[152:155], a[112:115], a[148:151], v[152:155]
  ds_read_b128 a[172:175], v202 offset:960
  s_waitcnt vmcnt(7) lgkmcnt(1)
  v_mfma_f32_16x16x32_bf16 v[156:159], a[116:119], a[148:151], v[156:159]
  v_cos_f32 v221, v249
  s_barrier
  v_mfma_f32_16x16x32_bf16 v[176:179], a[112:115], a[152:155], v[176:179]
  ds_read_b128 a[144:147], v196
  s_add_u32 s44, s44, 1769472
  s_add_u32 m0, s46, 49152
  v_mfma_f32_16x16x32_bf16 v[180:183], a[116:119], a[152:155], v[180:183]
  buffer_load_dwordx4 v209, s[8:11], s44 offen lds
  v_sin_f32 v222, v249
  v_mfma_f32_16x16x32_bf16 v[128:131], a[120:123], a[156:159], v[128:131]
  ds_read_b128 a[148:151], v196 offset:12288
  v_mul_f32 v221, v248, v221
  v_mul_f32 v222, v248, v222
  v_mfma_f32_16x16x32_bf16 v[132:135], a[124:127], a[156:159], v[132:135]
  s_lshl_b32 s49, s40, 5
  v_cvt_f32_u32 v251, s49
  v_lshrrev_b32 v252, 4, v225
  v_mul_f32 v248, v251, v234
  v_mul_f32 v249, v251, v235
  v_exp_f32 v248, v248
  buffer_load_dwordx4 v210, s[8:11], s44 offen offset:1024 lds
  buffer_load_dwordx4 v211, s[8:11], s44 offen offset:2048 lds
  buffer_load_dwordx4 v212, s[8:11], s44 offen offset:3072 lds
  s_add_u32 m0, s46, 53248
  s_nop 0
  buffer_load_dwordx4 v213, s[8:11], s44 offen lds
  buffer_load_dwordx4 v214, s[8:11], s44 offen offset:1024 lds
  v_mfma_f32_16x16x32_bf16 v[136:139], a[120:123], a[160:163], v[136:139]
  ds_read_b128 a[152:155], v196 offset:2048
  v_fract_f32 v249, v249
  s_add_u32 s44, s44, 1769472
  v_mfma_f32_16x16x32_bf16 v[140:143], a[124:127], a[160:163], v[140:143]
  v_cos_f32 v223, v249
  v_mfma_f32_16x16x32_bf16 v[144:147], a[120:123], a[164:167], v[144:147]
  ds_read_b128 a[156:159], v196 offset:14336
  v_sin_f32 v224, v249
  v_mfma_f32_16x16x32_bf16 v[148:151], a[124:127], a[164:167], v[148:151]
  v_mul_f32 v223, v248, v223
  v_mul_f32 v224, v248, v224
  v_mfma_f32_16x16x32_bf16 v[152:155], a[120:123], a[168:171], v[152:155]
  ds_read_b128 a[160:163], v202 offset:1024
  v_add_f32 v248, -1.0, v236
  v_mul_f32 v249, v231, v231
  v_mfma_f32_16x16x32_bf16 v[156:159], a[124:127], a[168:171], v[156:159]
  v_fmac_f32 v249, v232, v232
  s_waitcnt lgkmcnt(2)
  v_mfma_f32_16x16x32_bf16 v[176:179], a[120:123], a[172:175], v[176:179]
  ds_read_b128 a[164:167], v197
  v_rcp_f32 v249, v249
  v_mfma_f32_16x16x32_bf16 v[180:183], a[124:127], a[172:175], v[180:183]
  v_mul_f32 v228, v248, v231
  s_add_u32 m0, s46, 98304
  v_mfma_f32_16x16x32_bf16 v[128:131], a[128:131], a[144:147], v[128:131]
  ds_read_b128 a[168:171], v197 offset:12288
  v_fmac_f32 v228, v237, v232
  v_mul_f32 v229, v237, v231
  v_mfma_f32_16x16x32_bf16 v[132:135], a[132:135], a[144:147], v[132:135]
  v_fma_f32 v229, -v248, v232, v229
  v_mul_f32 v228, v228, v249
  v_mfma_f32_16x16x32_bf16 v[136:139], a[128:131], a[148:151], v[136:139]
  ds_read_b128 a[172:175], v197 offset:2048
  v_mul_f32 v229, v229, v249
  v_cmp_gt_u32 vcc, 32, v250
  v_mfma_f32_16x16x32_bf16 v[140:143], a[132:135], a[148:151], v[140:143]
  v_mul_u32_u24 v250, 48, v250
  buffer_load_dwordx4 v209, s[8:11], s44 offen lds
  v_mfma_f32_16x16x32_bf16 v[144:147], a[128:131], a[152:155], v[144:147]
  ds_read_b128 a[144:147], v197 offset:14336
  v_add_u32 v250, 161280, v250
  v_cndmask_b32 v228, 0, v228, vcc
  v_mfma_f32_16x16x32_bf16 v[148:151], a[132:135], a[152:155], v[148:151]
  v_cndmask_b32 v229, 0, v229, vcc
  s_waitcnt lgkmcnt(2)
  v_mfma_f32_16x16x32_bf16 v[152:155], a[128:131], a[156:159], v[152:155]
  ds_read_b128 a[148:151], v202 offset:1088
  v_mov_b32 v230, 0
  s_waitcnt vmcnt(7)
  v_mfma_f32_16x16x32_bf16 v[156:159], a[132:135], a[156:159], v[156:159]
  v_mov_b32 v231, 0
  s_barrier
  v_mfma_f32_16x16x32_bf16 v[176:179], a[128:131], a[160:163], v[176:179]
  ds_read_b64_tr_b16 a[152:153], v184 offset:24576
  ds_write_b128 v250, v[236:239]
  ds_write_b128 v250, v[240:243] offset:16
  v_mfma_f32_16x16x32_bf16 v[180:183], a[132:135], a[160:163], v[180:183]
  ds_read_b64_tr_b16 a[154:155], v184 offset:24832
  ds_write_b128 v250, v[228:231] offset:32
  v_mfma_f32_16x16x32_bf16 v[128:131], a[136:139], a[164:167], v[128:131]
  ds_read_b64_tr_b16 a[156:157], v185 offset:24576
  buffer_load_dwordx4 v210, s[8:11], s44 offen offset:1024 lds
  v_mul_u32_u24 v252, 8, v252
  v_mfma_f32_16x16x32_bf16 v[132:135], a[140:143], a[164:167], v[132:135]
  ds_read_b64_tr_b16 a[158:159], v185 offset:24832
  v_bfe_u32 v253, v225, 2, 2
  v_mfma_f32_16x16x32_bf16 v[136:139], a[136:139], a[168:171], v[136:139]
  ds_read_b64_tr_b16 a[160:161], v184 offset:36864
  v_add_u32 v252, v252, v253
  v_mfma_f32_16x16x32_bf16 v[140:143], a[140:143], a[168:171], v[140:143]
  ds_read_b64_tr_b16 a[162:163], v184 offset:37120
  s_waitcnt lgkmcnt(5)
  v_mfma_f32_16x16x32_bf16 v[144:147], a[136:139], a[172:175], v[144:147]
  ds_read_b64_tr_b16 a[164:165], v185 offset:36864
  v_lshlrev_b32 v252, 7, v252
  v_and_b32 v253, 3, v225
  v_mfma_f32_16x16x32_bf16 v[148:151], a[140:143], a[172:175], v[148:151]
  ds_read_b64_tr_b16 a[166:167], v185 offset:37120
  v_lshlrev_b32 v253, 3, v253
  v_mfma_f32_16x16x32_bf16 v[152:155], a[136:139], a[144:147], v[152:155]
  ds_read_b64_tr_b16 a[168:169], v184 offset:26624
  v_add_u32 v252, v252, v253
  v_bfe_u32 v253, v225, 3, 2
  v_mfma_f32_16x16x32_bf16 v[156:159], a[140:143], a[144:147], v[156:159]
  ds_read_b64_tr_b16 a[170:171], v184 offset:26880
  buffer_load_dwordx4 v211, s[8:11], s44 offen offset:2048 lds
  v_mfma_f32_16x16x32_bf16 v[176:179], a[136:139], a[148:151], v[176:179]
  ds_read_b64_tr_b16 a[172:173], v185 offset:26624
  v_xor_b32 v190, 0, v253
  v_mfma_f32_16x16x32_bf16 v[180:183], a[140:143], a[148:151], v[180:183]
  ds_read_b64_tr_b16 a[174:175], v185 offset:26880
  v_lshlrev_b32 v190, 5, v190
  v_mfma_f32_16x16x32_bf16 v[0:3], a[152:155], a[0:3], 0
  ds_read_b64_tr_b16 a[144:145], v184 offset:38912
  v_add_u32 v190, v190, v252
  v_mfma_f32_16x16x32_bf16 v[4:7], a[152:155], a[4:7], 0
  ds_read_b64_tr_b16 a[146:147], v184 offset:39168
  v_xor_b32 v191, 1, v253
  s_waitcnt lgkmcnt(4)
  v_mfma_f32_16x16x32_bf16 v[8:11], a[156:159], a[0:3], 0
  ds_read_b64_tr_b16 a[148:149], v185 offset:38912
  v_lshlrev_b32 v191, 5, v191
  v_mfma_f32_16x16x32_bf16 v[12:15], a[156:159], a[4:7], 0
  ds_read_b64_tr_b16 a[150:151], v185 offset:39168
  v_add_u32 v191, v191, v252
  v_xor_b32 v192, 2, v253
  v_mfma_f32_16x16x32_bf16 v[32:35], a[160:163], a[0:3], 0
  ds_read_b64_tr_b16 a[152:153], v184 offset:28672
  buffer_load_dwordx4 v212, s[8:11], s44 offen offset:3072 lds
  s_add_u32 m0, s46, 102400
  v_mfma_f32_16x16x32_bf16 v[36:39], a[160:163], a[4:7], 0
  ds_read_b64_tr_b16 a[154:155], v184 offset:28928
  v_lshlrev_b32 v192, 5, v192
  v_mfma_f32_16x16x32_bf16 v[40:43], a[164:167], a[0:3], 0
  ds_read_b64_tr_b16 a[156:157], v185 offset:28672
  v_add_u32 v192, v192, v252
  v_mfma_f32_16x16x32_bf16 v[44:47], a[164:167], a[4:7], 0
  ds_read_b64_tr_b16 a[158:159], v185 offset:28928
  v_xor_b32 v193, 3, v253
  v_lshrrev_b32 v228, 4, v225
  v_mfma_f32_16x16x32_bf16 v[0:3], a[168:171], a[8:11], v[0:3]
  ds_read_b64_tr_b16 a[160:161], v184 offset:40960
  v_lshlrev_b32 v193, 5, v193
  v_lshlrev_b32 v228, 4, v228
  buffer_load_dwordx4 v213, s[8:11], s44 offen lds
  buffer_load_dwordx4 v214, s[8:11], s44 offen offset:1024 lds
  v_mfma_f32_16x16x32_bf16 v[4:7], a[168:171], a[12:15], v[4:7]
  ds_read_b64_tr_b16 a[162:163], v184 offset:41216
  s_waitcnt lgkmcnt(4)
  v_mfma_f32_16x16x32_bf16 v[8:11], a[172:175], a[8:11], v[8:11]
  ds_read_b64_tr_b16 a[164:165], v185 offset:40960
  s_add_u32 s44, s64, 0
  s_add_u32 m0, s46, 122880
  v_mfma_f32_16x16x32_bf16 v[12:15], a[172:175], a[12:15], v[12:15]
  ds_read_b64_tr_b16 a[166:167], v185 offset:41216
  v_add_u32 v193, v193, v252
  v_mfma_f32_16x16x32_bf16 v[32:35], a[144:147], a[8:11], v[32:35]
  ds_read_b64_tr_b16 a[168:169], v184 offset:30720
  v_xor_b32 v194, 0, v253
  v_add_u32 v228, s47, v228
  v_mfma_f32_16x16x32_bf16 v[36:39], a[144:147], a[12:15], v[36:39]
  ds_read_b64_tr_b16 a[170:171], v184 offset:30976
  v_lshlrev_b32 v194, 5, v194
  v_mfma_f32_16x16x32_bf16 v[40:43], a[148:151], a[8:11], v[40:43]
  ds_read_b64_tr_b16 a[172:173], v185 offset:30720
  v_add_u32 v194, v194, v252
  v_add_u32 v228, 147456, v228
  v_mfma_f32_16x16x32_bf16 v[44:47], a[148:151], a[12:15], v[44:47]
  ds_read_b64_tr_b16 a[174:175], v185 offset:30976
  v_add_u32 v194, 49152, v194
  v_mfma_f32_16x16x32_bf16 v[0:3], a[152:155], a[16:19], v[0:3]
  ds_read_b64_tr_b16 a[144:145], v184 offset:43008
  buffer_load_dwordx4 v203, s[8:11], s44 offen lds
  v_xor_b32 v195, 1, v253
  v_mfma_f32_16x16x32_bf16 v[4:7], a[152:155], a[20:23], v[4:7]
  ds_read_b64_tr_b16 a[146:147], v184 offset:43264
  s_waitcnt lgkmcnt(4)
  v_mfma_f32_16x16x32_bf16 v[8:11], a[156:159], a[16:19], v[8:11]
  ds_read_b64_tr_b16 a[148:149], v185 offset:43008
  v_lshlrev_b32 v195, 5, v195
  ds_write_b128 v228, v[176:179] offset:0
  v_mfma_f32_16x16x32_bf16 v[12:15], a[156:159], a[20:23], v[12:15]
  ds_read_b64_tr_b16 a[150:151], v185 offset:43264
  v_add_u32 v195, v195, v252
  v_mfma_f32_16x16x32_bf16 v[32:35], a[160:163], a[16:19], v[32:35]
  ds_read_b64_tr_b16 a[152:153], v184 offset:32768
  v_add_u32 v195, 49152, v195
  v_xor_b32 v196, 2, v253
  v_mfma_f32_16x16x32_bf16 v[36:39], a[160:163], a[20:23], v[36:39]
  ds_read_b64_tr_b16 a[154:155], v184 offset:33024
  v_lshlrev_b32 v196, 5, v196
  v_mfma_f32_16x16x32_bf16 v[40:43], a[164:167], a[16:19], v[40:43]
  ds_read_b64_tr_b16 a[156:157], v185 offset:32768
  v_add_u32 v196, v196, v252
  ds_write_b128 v228, v[180:183] offset:64
  v_mfma_f32_16x16x32_bf16 v[44:47], a[164:167], a[20:23], v[44:47]
  ds_read_b64_tr_b16 a[158:159], v185 offset:33024
  buffer_load_dwordx4 v204, s[8:11], s44 offen offset:1024 lds
  v_mfma_f32_16x16x32_bf16 v[0:3], a[168:171], a[24:27], v[0:3]
  ds_read_b64_tr_b16 a[160:161], v184 offset:45056
  v_add_u32 v196, 49152, v196
  v_xor_b32 v197, 3, v253
  v_mfma_f32_16x16x32_bf16 v[4:7], a[168:171], a[28:31], v[4:7]
  ds_read_b64_tr_b16 a[162:163], v184 offset:45312
  s_waitcnt lgkmcnt(5)
  v_mfma_f32_16x16x32_bf16 v[8:11], a[172:175], a[24:27], v[8:11]
  ds_read_b64_tr_b16 a[164:165], v185 offset:45056
  v_lshlrev_b32 v197, 5, v197
  v_and_b32 v229, 31, v225
  v_mfma_f32_16x16x32_bf16 v[12:15], a[172:175], a[28:31], v[12:15]
  ds_read_b64_tr_b16 a[166:167], v185 offset:45312
  v_add_u32 v197, v197, v252
  v_mfma_f32_16x16x32_bf16 v[32:35], a[144:147], a[24:27], v[32:35]
  ds_read_b64_tr_b16 a[168:169], v184 offset:34816
  v_add_u32 v197, 49152, v197
  v_xor_b32 v198, 0, v253
  v_mfma_f32_16x16x32_bf16 v[36:39], a[144:147], a[28:31], v[36:39]
  ds_read_b64_tr_b16 a[170:171], v184 offset:35072
  v_lshlrev_b32 v198, 5, v198
  v_mfma_f32_16x16x32_bf16 v[40:43], a[148:151], a[24:27], v[40:43]
  ds_read_b64_tr_b16 a[172:173], v185 offset:34816
  buffer_load_dwordx4 v205, s[8:11], s44 offen offset:2048 lds
  v_accvgpr_read_b32 v254, a253
  v_mfma_f32_16x16x32_bf16 v[44:47], a[148:151], a[28:31], v[44:47]
  ds_read_b64_tr_b16 a[174:175], v185 offset:35072
  s_mul_i32 s73, s70, 165888
  v_mfma_f32_16x16x32_bf16 v[0:3], a[152:155], a[32:35], v[0:3]
  ds_read_b64_tr_b16 a[144:145], v184 offset:47104
  s_mul_i32 s76, s42, 576
  s_add_u32 s73, s73, s76
  v_mfma_f32_16x16x32_bf16 v[4:7], a[152:155], a[36:39], v[4:7]
  ds_read_b64_tr_b16 a[146:147], v184 offset:47360
  s_waitcnt lgkmcnt(4)
  v_mfma_f32_16x16x32_bf16 v[8:11], a[156:159], a[32:35], v[8:11]
  ds_read_b64_tr_b16 a[148:149], v185 offset:47104
  v_add_u32 v198, v198, v252
  s_waitcnt vmcnt(9)
  v_mfma_f32_16x16x32_bf16 v[12:15], a[156:159], a[36:39], v[12:15]
  ds_read_b64_tr_b16 a[150:151], v185 offset:47360
  s_barrier
  v_mfma_f32_16x16x32_bf16 v[32:35], a[160:163], a[32:35], v[32:35]
  ds_read_b64_tr_b16 a[152:153], v186
  buffer_load_dword a252, v254, s[8:11], s73 offen sc1
  v_add_u32 v198, 98304, v198
  v_mfma_f32_16x16x32_bf16 v[36:39], a[160:163], a[36:39], v[36:39]
  ds_read_b64_tr_b16 a[154:155], v186 offset:256
  v_xor_b32 v199, 1, v253
  v_mfma_f32_16x16x32_bf16 v[40:43], a[164:167], a[32:35], v[40:43]
  ds_read_b64_tr_b16 a[156:157], v187
  v_lshlrev_b32 v199, 5, v199
  v_lshlrev_b32 v229, 2, v229
  v_mfma_f32_16x16x32_bf16 v[44:47], a[164:167], a[36:39], v[44:47]
  ds_read_b64_tr_b16 a[158:159], v187 offset:256
  v_add_u32 v199, v199, v252
  v_mfma_f32_16x16x32_bf16 v[0:3], a[168:171], a[40:43], v[0:3]
  ds_read_b64_tr_b16 a[160:161], v186 offset:12288
  v_add_u32 v199, 98304, v199
  v_xor_b32 v200, 2, v253
  v_mfma_f32_16x16x32_bf16 v[4:7], a[168:171], a[44:47], v[4:7]
  ds_read_b64_tr_b16 a[162:163], v186 offset:12544
  s_waitcnt lgkmcnt(4)
  v_mfma_f32_16x16x32_bf16 v[8:11], a[172:175], a[40:43], v[8:11]
  ds_read_b64_tr_b16 a[164:165], v187 offset:12288
  buffer_load_dwordx4 v206, s[8:11], s44 offen offset:3072 lds
  s_add_u32 m0, s46, 126976
  v_mfma_f32_16x16x32_bf16 v[12:15], a[172:175], a[44:47], v[12:15]
  ds_read_b64_tr_b16 a[166:167], v187 offset:12544
  v_lshlrev_b32 v200, 5, v200
  v_mfma_f32_16x16x32_bf16 v[32:35], a[144:147], a[40:43], v[32:35]
  ds_read_b64_tr_b16 a[168:169], v186 offset:2048
  v_add_u32 v200, v200, v252
  v_mfma_f32_16x16x32_bf16 v[36:39], a[144:147], a[44:47], v[36:39]
  ds_read_b64_tr_b16 a[170:171], v186 offset:2304
  v_add_u32 v200, 98304, v200
  v_xor_b32 v201, 3, v253
  v_mfma_f32_16x16x32_bf16 v[40:43], a[148:151], a[40:43], v[40:43]
  ds_read_b64_tr_b16 a[172:173], v187 offset:2048
  v_lshlrev_b32 v201, 5, v201
  v_mfma_f32_16x16x32_bf16 v[44:47], a[148:151], a[44:47], v[44:47]
  ds_read_b64_tr_b16 a[174:175], v187 offset:2304
  v_add_u32 v201, v201, v252
  v_add_u32 v229, s47, v229
  v_mfma_f32_16x16x32_bf16 v[0:3], a[152:155], a[48:51], v[0:3]
  ds_read_b64_tr_b16 a[144:145], v186 offset:14336
  v_add_u32 v201, 98304, v201
  v_mfma_f32_16x16x32_bf16 v[4:7], a[152:155], a[52:55], v[4:7]
  ds_read_b64_tr_b16 a[146:147], v186 offset:14592
  buffer_load_dwordx4 v207, s[8:11], s44 offen lds
  s_waitcnt lgkmcnt(4)
  v_mfma_f32_16x16x32_bf16 v[8:11], a[156:159], a[48:51], v[8:11]
  ds_read_b64_tr_b16 a[148:149], v187 offset:14336
  v_add_u32 v229, 147456, v229
  v_mfma_f32_16x16x32_bf16 v[12:15], a[156:159], a[52:55], v[12:15]
  ds_read_b64_tr_b16 a[150:151], v187 offset:14592
  ds_read_b32 v230, v229
  v_and_b32 v247, 15, v225
  v_mfma_f32_16x16x32_bf16 v[32:35], a[160:163], a[48:51], v[32:35]
  ds_read_b64_tr_b16 a[152:153], v186 offset:4096
  v_mul_u32_u24 v247, 48, v247
  v_mfma_f32_16x16x32_bf16 v[36:39], a[160:163], a[52:55], v[36:39]
  ds_read_b64_tr_b16 a[154:155], v186 offset:4352
  v_add_u32 v247, 161280, v247
  ds_read_b64 v[236:237], v247 offset:0
  v_mfma_f32_16x16x32_bf16 v[40:43], a[164:167], a[48:51], v[40:43]
  ds_read_b64_tr_b16 a[156:157], v187 offset:4096
  ds_read_b64 v[238:239], v247 offset:768
  v_mfma_f32_16x16x32_bf16 v[44:47], a[164:167], a[52:55], v[44:47]
  ds_read_b64_tr_b16 a[158:159], v187 offset:4352
  v_lshrrev_b32 v209, 4, v225
  v_mfma_f32_16x16x32_bf16 v[0:3], a[168:171], a[56:59], v[0:3]
  ds_read_b64_tr_b16 a[160:161], v186 offset:16384
  buffer_load_dwordx4 v208, s[8:11], s44 offen offset:1024 lds
  v_mfma_f32_16x16x32_bf16 v[4:7], a[168:171], a[60:63], v[4:7]
  ds_read_b64_tr_b16 a[162:163], v186 offset:16640
  s_add_u32 s44, s44, 884736
  s_waitcnt lgkmcnt(6)
  v_mfma_f32_16x16x32_bf16 v[8:11], a[172:175], a[56:59], v[8:11]
  ds_read_b64_tr_b16 a[164:165], v187 offset:16384
  s_add_u32 m0, s46, 73728
  v_mfma_f32_16x16x32_bf16 v[12:15], a[172:175], a[60:63], v[12:15]
  ds_read_b64_tr_b16 a[166:167], v187 offset:16640
  v_cvt_pk_bf16_f32 v230, v230, v230
  v_lshlrev_b32 v209, 1, v209
  v_mfma_f32_16x16x32_bf16 v[32:35], a[144:147], a[56:59], v[32:35]
  ds_read_b64_tr_b16 a[168:169], v186 offset:6144
  v_lshlrev_b32 v230, 16, v230
  v_mfma_f32_16x16x32_bf16 v[36:39], a[144:147], a[60:63], v[36:39]
  ds_read_b64_tr_b16 a[170:171], v186 offset:6400
  v_mul_f32 v230, 0xbfb8aa3b, v230
  v_and_b32 v252, 7, v225
  v_mfma_f32_16x16x32_bf16 v[40:43], a[148:151], a[56:59], v[40:43]
  ds_read_b64_tr_b16 a[172:173], v187 offset:6144
  v_exp_f32 v230, v230
  v_mfma_f32_16x16x32_bf16 v[44:47], a[148:151], a[60:63], v[44:47]
  ds_read_b64_tr_b16 a[174:175], v187 offset:6400
  buffer_load_dwordx4 v203, s[8:11], s44 offen lds
  v_lshrrev_b32 v244, 4, v225
  v_mfma_f32_16x16x32_bf16 v[0:3], a[152:155], a[64:67], v[0:3]
  ds_read_b64_tr_b16 a[144:145], v186 offset:18432
  v_add_f32 v230, 1.0, v230
  v_mfma_f32_16x16x32_bf16 v[4:7], a[152:155], a[68:71], v[4:7]
  ds_read_b64_tr_b16 a[146:147], v186 offset:18688
  v_rcp_f32 v230, v230
  s_waitcnt lgkmcnt(4)
  v_mfma_f32_16x16x32_bf16 v[8:11], a[156:159], a[64:67], v[8:11]
  ds_read_b64_tr_b16 a[148:149], v187 offset:18432
  v_mul_u32_u24 v244, 384, v244
  v_mfma_f32_16x16x32_bf16 v[12:15], a[156:159], a[68:71], v[12:15]
  ds_read_b64_tr_b16 a[150:151], v187 offset:18688
  v_cvt_pk_bf16_f32 v230, v230, v230
  v_xor_b32 v209, v209, v252
  v_mfma_f32_16x16x32_bf16 v[32:35], a[160:163], a[64:67], v[32:35]
  ds_read_b64_tr_b16 a[152:153], v186 offset:8192
  v_lshlrev_b32 v230, 16, v230
  v_lshlrev_b32 v209, 4, v209
  v_mfma_f32_16x16x32_bf16 v[36:39], a[160:163], a[68:71], v[36:39]
  ds_read_b64_tr_b16 a[154:155], v186 offset:8448
  v_sub_f32 v231, 1.0, v230
  v_mfma_f32_16x16x32_bf16 v[40:43], a[164:167], a[64:67], v[40:43]
  ds_read_b64_tr_b16 a[156:157], v187 offset:8192
  buffer_load_dwordx4 v204, s[8:11], s44 offen offset:1024 lds
  v_cvt_pk_bf16_f32 v231, v231, v231
  v_mfma_f32_16x16x32_bf16 v[44:47], a[164:167], a[68:71], v[44:47]
  ds_read_b64_tr_b16 a[158:159], v187 offset:8448
  v_lshlrev_b32 v231, 16, v231
  v_mfma_f32_16x16x32_bf16 v[0:3], a[168:171], a[72:75], v[0:3]
  ds_read_b64_tr_b16 a[160:161], v186 offset:20480
  v_add_f32 v232, v230, v230
  ds_write_b32 v229, v231 offset:128
  v_mfma_f32_16x16x32_bf16 v[4:7], a[168:171], a[76:79], v[4:7]
  ds_read_b64_tr_b16 a[162:163], v186 offset:20736
  s_waitcnt lgkmcnt(5)
  v_mfma_f32_16x16x32_bf16 v[8:11], a[172:175], a[72:75], v[8:11]
  ds_read_b64_tr_b16 a[164:165], v187 offset:20480
  ds_write_b32 v229, v232 offset:256
  ds_write_b32 v229, v230 offset:384
  v_mfma_f32_16x16x32_bf16 v[12:15], a[172:175], a[76:79], v[12:15]
  ds_read_b64_tr_b16 a[166:167], v187 offset:20736
  s_lshl_b32 s49, s41, 7
  s_lshl_b32 s50, s40, 5
  s_add_u32 s49, s49, s50
  s_lshl_b32 s49, s49, 2
  s_add_u32 s49, s49, 46235648
  s_cmp_eq_u32 s42, 0
  s_cselect_b32 s50, 32, 0
  v_mfma_f32_16x16x32_bf16 v[32:35], a[144:147], a[72:75], v[32:35]
  ds_read_b64_tr_b16 a[168:169], v186 offset:10240
  v_lshlrev_b32 v233, 2, v225
  v_cmp_gt_u32 vcc, s50, v225
  v_mfma_f32_16x16x32_bf16 v[36:39], a[144:147], a[76:79], v[36:39]
  ds_read_b64_tr_b16 a[170:171], v186 offset:10496
  buffer_load_dwordx4 v205, s[8:11], s44 offen offset:2048 lds
  v_mfma_f32_16x16x32_bf16 v[40:43], a[148:151], a[72:75], v[40:43]
  ds_read_b64_tr_b16 a[172:173], v187 offset:10240
  v_mov_b32 v234, 0x7ffffff0
  v_lshrrev_b32 v252, 3, v225
  v_mfma_f32_16x16x32_bf16 v[44:47], a[148:151], a[76:79], v[44:47]
  ds_read_b64_tr_b16 a[174:175], v187 offset:10496
  v_cndmask_b32 v233, v234, v233, vcc
  v_mfma_f32_16x16x32_bf16 v[0:3], a[152:155], a[80:83], v[0:3]
  ds_read_b64_tr_b16 a[144:145], v186 offset:22528
  v_mul_u32_u24 v252, 1152, v252
  v_mfma_f32_16x16x32_bf16 v[4:7], a[152:155], a[84:87], v[4:7]
  ds_read_b64_tr_b16 a[146:147], v186 offset:22784
  s_waitcnt lgkmcnt(4)
  v_mfma_f32_16x16x32_bf16 v[8:11], a[156:159], a[80:83], v[8:11]
  ds_read_b64_tr_b16 a[148:149], v187 offset:22528
  buffer_store_dword v230, v233, s[24:27], s49 offen sc1
  s_waitcnt vmcnt(11)
  v_mfma_f32_16x16x32_bf16 v[12:15], a[156:159], a[84:87], v[12:15]
  ds_read_b64_tr_b16 a[150:151], v187 offset:22784
  s_barrier
  v_mfma_f32_16x16x32_bf16 v[32:35], a[160:163], a[80:83], v[32:35]
  ds_read_b64_tr_b16 a[152:153], v188
  v_and_b32 v235, 15, v225
  v_add_u32 v209, v209, v252
  v_mfma_f32_16x16x32_bf16 v[36:39], a[160:163], a[84:87], v[36:39]
  ds_read_b64_tr_b16 a[154:155], v188 offset:256
  v_lshlrev_b32 v235, 2, v235
  v_mfma_f32_16x16x32_bf16 v[40:43], a[164:167], a[80:83], v[40:43]
  ds_read_b64_tr_b16 a[156:157], v189
  v_add_u32 v235, s47, v235
  v_add_u32 v210, 8192, v209
  v_mfma_f32_16x16x32_bf16 v[44:47], a[164:167], a[84:87], v[44:47]
  ds_read_b64_tr_b16 a[158:159], v189 offset:256
  buffer_load_dwordx4 v206, s[8:11], s44 offen offset:3072 lds
  v_mfma_f32_16x16x32_bf16 v[0:3], a[168:171], a[88:91], v[0:3]
  ds_read_b64_tr_b16 a[160:161], v188 offset:12288
  s_add_u32 m0, s46, 77824
  v_add_u32 v235, 147456, v235
  v_mfma_f32_16x16x32_bf16 v[4:7], a[168:171], a[92:95], v[4:7]
  ds_read_b64_tr_b16 a[162:163], v188 offset:12544
  s_waitcnt lgkmcnt(4)
  v_mfma_f32_16x16x32_bf16 v[8:11], a[172:175], a[88:91], v[8:11]
  ds_read_b64_tr_b16 a[164:165], v189 offset:12288
  ds_read_b32 v215, v235 offset:128
  ds_read_b32 v216, v235 offset:192
  v_mfma_f32_16x16x32_bf16 v[12:15], a[172:175], a[92:95], v[12:15]
  ds_read_b64_tr_b16 a[166:167], v189 offset:12544
  ds_read_b128 v[176:179], v228 offset:256
  v_mfma_f32_16x16x32_bf16 v[32:35], a[144:147], a[88:91], v[32:35]
  ds_read_b64_tr_b16 a[168:169], v188 offset:2048
  ds_read_b128 v[180:183], v228 offset:320
  ds_read_b32 v233, v235 offset:384
  v_mfma_f32_16x16x32_bf16 v[36:39], a[144:147], a[92:95], v[36:39]
  ds_read_b64_tr_b16 a[170:171], v188 offset:2304
  ds_read_b32 v234, v235 offset:448
  v_mfma_f32_16x16x32_bf16 v[40:43], a[148:151], a[88:91], v[40:43]
  ds_read_b64_tr_b16 a[172:173], v189 offset:2048
  buffer_load_dwordx4 v207, s[8:11], s44 offen lds
  v_and_b32 v245, 15, v225
  v_mfma_f32_16x16x32_bf16 v[44:47], a[148:151], a[92:95], v[44:47]
  s_waitcnt lgkmcnt(14)
  ds_read_b64_tr_b16 a[174:175], v189 offset:2304
  v_lshlrev_b32 v245, 3, v245
  v_mfma_f32_16x16x32_bf16 v[0:3], a[152:155], a[96:99], v[0:3]
  s_waitcnt lgkmcnt(14)
  ds_read_b64_tr_b16 a[144:145], v188 offset:14336
  v_add_u32 v244, v244, v245
  v_add_u32 v211, 16384, v209
  v_mfma_f32_16x16x32_bf16 v[4:7], a[152:155], a[100:103], v[4:7]
  s_waitcnt lgkmcnt(14)
  ds_read_b64_tr_b16 a[146:147], v188 offset:14592
  v_add_u32 v244, s47, v244
  s_waitcnt lgkmcnt(5)
  v_mfma_f32_16x16x32_bf16 v[8:11], a[156:159], a[96:99], v[8:11]
  ds_read_b64_tr_b16 a[148:149], v189 offset:14336
  v_add_u32 v244, 147456, v244
  v_mfma_f32_16x16x32_bf16 v[12:15], a[156:159], a[100:103], v[12:15]
  ds_read_b64_tr_b16 a[150:151], v189 offset:14592
  v_add_u32 v245, 1536, v244
  v_add_u32 v212, 24576, v209
  v_mfma_f32_16x16x32_bf16 v[32:35], a[160:163], a[96:99], v[32:35]
  ds_read_b64_tr_b16 a[152:153], v188 offset:4096
  v_mfma_f32_16x16x32_bf16 v[36:39], a[160:163], a[100:103], v[36:39]
  ds_read_b64_tr_b16 a[154:155], v188 offset:4352
  buffer_load_dwordx4 v208, s[8:11], s44 offen offset:1024 lds
  s_add_u32 s44, s44, 884736
  v_mfma_f32_16x16x32_bf16 v[40:43], a[164:167], a[96:99], v[40:43]
  ds_read_b64_tr_b16 a[156:157], v189 offset:4096
  s_add_u32 m0, s46, 0
  v_mfma_f32_16x16x32_bf16 v[44:47], a[164:167], a[100:103], v[44:47]
  ds_read_b64_tr_b16 a[158:159], v189 offset:4352
  v_accvgpr_write_b32 a249, v233
  s_waitcnt lgkmcnt(10)
  v_accvgpr_write_b32 a250, v234
  v_mfma_f32_16x16x32_bf16 v[0:3], a[168:171], a[104:107], v[0:3]
  ds_read_b64_tr_b16 a[160:161], v188 offset:16384
  v_fmac_f32 v129, v236, v128
  v_mfma_f32_16x16x32_bf16 v[4:7], a[168:171], a[108:111], v[4:7]
  ds_read_b64_tr_b16 a[162:163], v188 offset:16640
  v_fmac_f32 v137, v236, v136
  s_waitcnt lgkmcnt(4)
  v_mfma_f32_16x16x32_bf16 v[8:11], a[172:175], a[104:107], v[8:11]
  ds_read_b64_tr_b16 a[164:165], v189 offset:16384
  v_fmac_f32 v133, v236, v132
  v_mfma_f32_16x16x32_bf16 v[12:15], a[172:175], a[108:111], v[12:15]
  ds_read_b64_tr_b16 a[166:167], v189 offset:16640
  v_fmac_f32 v141, v236, v140
  v_fma_f32 v129, -v237, v136, v129
  v_mfma_f32_16x16x32_bf16 v[32:35], a[144:147], a[104:107], v[32:35]
  ds_read_b64_tr_b16 a[168:169], v188 offset:6144
  buffer_load_dwordx4 v203, s[8:11], s44 offen lds
  v_fmac_f32 v137, v237, v128
  v_mfma_f32_16x16x32_bf16 v[36:39], a[144:147], a[108:111], v[36:39]
  ds_read_b64_tr_b16 a[170:171], v188 offset:6400
  v_fma_f32 v133, -v237, v140, v133
  v_mfma_f32_16x16x32_bf16 v[40:43], a[148:151], a[104:107], v[40:43]
  ds_read_b64_tr_b16 a[172:173], v189 offset:6144
  v_fmac_f32 v141, v237, v132
  v_fmac_f32 v145, v238, v144
  v_mfma_f32_16x16x32_bf16 v[44:47], a[148:151], a[108:111], v[44:47]
  ds_read_b64_tr_b16 a[174:175], v189 offset:6400
  v_fmac_f32 v153, v238, v152
  v_mfma_f32_16x16x32_bf16 v[0:3], a[152:155], a[112:115], v[0:3]
  ds_read_b64_tr_b16 a[144:145], v188 offset:18432
  v_fmac_f32 v149, v238, v148
  v_fmac_f32 v157, v238, v156
  v_mfma_f32_16x16x32_bf16 v[4:7], a[152:155], a[116:119], v[4:7]
  ds_read_b64_tr_b16 a[146:147], v188 offset:18688
  s_waitcnt lgkmcnt(4)
  v_mfma_f32_16x16x32_bf16 v[8:11], a[156:159], a[112:115], v[8:11]
  ds_read_b64_tr_b16 a[148:149], v189 offset:18432
  v_fma_f32 v145, -v239, v152, v145
  v_fmac_f32 v153, v239, v144
  v_mfma_f32_16x16x32_bf16 v[12:15], a[156:159], a[116:119], v[12:15]
  ds_read_b64_tr_b16 a[150:151], v189 offset:18688
  buffer_load_dwordx4 v204, s[8:11], s44 offen offset:1024 lds
  v_mfma_f32_16x16x32_bf16 v[32:35], a[160:163], a[112:115], v[32:35]
  ds_read_b64_tr_b16 a[152:153], v188 offset:8192
  v_fma_f32 v149, -v239, v156, v149
  v_fmac_f32 v157, v239, v148
  v_mfma_f32_16x16x32_bf16 v[36:39], a[160:163], a[116:119], v[36:39]
  ds_read_b64_tr_b16 a[154:155], v188 offset:8448
  v_fmac_f32 v130, v236, v129
  v_fmac_f32 v138, v236, v137
  v_mfma_f32_16x16x32_bf16 v[40:43], a[164:167], a[112:115], v[40:43]
  ds_read_b64_tr_b16 a[156:157], v189 offset:8192
  v_fmac_f32 v134, v236, v133
  v_mfma_f32_16x16x32_bf16 v[44:47], a[164:167], a[116:119], v[44:47]
  ds_read_b64_tr_b16 a[158:159], v189 offset:8448
  v_fmac_f32 v142, v236, v141
  v_fma_f32 v130, -v237, v137, v130
  v_mfma_f32_16x16x32_bf16 v[0:3], a[168:171], a[120:123], v[0:3]
  ds_read_b64_tr_b16 a[160:161], v188 offset:20480
  v_fmac_f32 v138, v237, v129
  v_mfma_f32_16x16x32_bf16 v[4:7], a[168:171], a[124:127], v[4:7]
  ds_read_b64_tr_b16 a[162:163], v188 offset:20736
  v_fma_f32 v134, -v237, v141, v134
  s_waitcnt lgkmcnt(4)
  v_mfma_f32_16x16x32_bf16 v[8:11], a[172:175], a[120:123], v[8:11]
  ds_read_b64_tr_b16 a[164:165], v189 offset:20480
  buffer_load_dwordx4 v205, s[8:11], s44 offen offset:2048 lds
  v_mfma_f32_16x16x32_bf16 v[12:15], a[172:175], a[124:127], v[12:15]
  ds_read_b64_tr_b16 a[166:167], v189 offset:20736
  v_fmac_f32 v142, v237, v133
  v_fmac_f32 v146, v238, v145
  v_mfma_f32_16x16x32_bf16 v[32:35], a[144:147], a[120:123], v[32:35]
  ds_read_b64_tr_b16 a[168:169], v188 offset:10240
  v_fmac_f32 v154, v238, v153
  v_mfma_f32_16x16x32_bf16 v[36:39], a[144:147], a[124:127], v[36:39]
  ds_read_b64_tr_b16 a[170:171], v188 offset:10496
  v_fmac_f32 v150, v238, v149
  v_fmac_f32 v158, v238, v157
  v_mfma_f32_16x16x32_bf16 v[40:43], a[148:151], a[120:123], v[40:43]
  ds_read_b64_tr_b16 a[172:173], v189 offset:10240
  v_fma_f32 v146, -v239, v153, v146
  v_mfma_f32_16x16x32_bf16 v[44:47], a[148:151], a[124:127], v[44:47]
  ds_read_b64_tr_b16 a[174:175], v189 offset:10496
  v_fmac_f32 v154, v239, v145
  v_fma_f32 v150, -v239, v157, v150
  v_mfma_f32_16x16x32_bf16 v[0:3], a[152:155], a[128:131], v[0:3]
  ds_read_b64_tr_b16 a[144:145], v188 offset:22528
  v_fmac_f32 v158, v239, v149
  v_fmac_f32 v131, v236, v130
  v_mfma_f32_16x16x32_bf16 v[4:7], a[152:155], a[132:135], v[4:7]
  ds_read_b64_tr_b16 a[146:147], v188 offset:22784
  s_waitcnt lgkmcnt(4)
  v_mfma_f32_16x16x32_bf16 v[8:11], a[156:159], a[128:131], v[8:11]
  ds_read_b64_tr_b16 a[148:149], v189 offset:22528
  buffer_load_dwordx4 v206, s[8:11], s44 offen offset:3072 lds
  s_waitcnt vmcnt(11)
  v_mfma_f32_16x16x32_bf16 v[12:15], a[156:159], a[132:135], v[12:15]
  ds_read_b64_tr_b16 a[150:151], v189 offset:22784
  s_barrier
  v_mfma_f32_16x16x32_bf16 v[32:35], a[160:163], a[128:131], v[32:35]
  ds_read_b64_tr_b16 a[152:153], v198 offset:24576
  s_add_u32 m0, s46, 4096
  v_fmac_f32 v139, v236, v138
  v_mfma_f32_16x16x32_bf16 v[36:39], a[160:163], a[132:135], v[36:39]
  ds_read_b64_tr_b16 a[154:155], v198 offset:25088
  v_fmac_f32 v135, v236, v134
  v_mfma_f32_16x16x32_bf16 v[40:43], a[164:167], a[128:131], v[40:43]
  ds_read_b64_tr_b16 a[156:157], v199 offset:24576
  v_fmac_f32 v143, v236, v142
  v_fma_f32 v131, -v237, v138, v131
  v_mfma_f32_16x16x32_bf16 v[44:47], a[164:167], a[132:135], v[44:47]
  ds_read_b64_tr_b16 a[158:159], v199 offset:25088
  v_fmac_f32 v139, v237, v130
  v_mfma_f32_16x16x32_bf16 v[0:3], a[168:171], a[136:139], v[0:3]
  ds_read_b64_tr_b16 a[160:161], v200 offset:24576
  v_fma_f32 v135, -v237, v142, v135
  v_fmac_f32 v143, v237, v134
  v_mfma_f32_16x16x32_bf16 v[4:7], a[168:171], a[140:143], v[4:7]
  ds_read_b64_tr_b16 a[162:163], v200 offset:25088
  buffer_load_dwordx4 v207, s[8:11], s44 offen lds
  s_waitcnt lgkmcnt(4)
  v_mfma_f32_16x16x32_bf16 v[8:11], a[172:175], a[136:139], v[8:11]
  ds_read_b64_tr_b16 a[164:165], v201 offset:24576
  v_fmac_f32 v147, v238, v146
  v_mfma_f32_16x16x32_bf16 v[12:15], a[172:175], a[140:143], v[12:15]
  ds_read_b64_tr_b16 a[166:167], v201 offset:25088
  v_fmac_f32 v155, v238, v154
  v_fmac_f32 v151, v238, v150
  v_mfma_f32_16x16x32_bf16 v[32:35], a[144:147], a[136:139], v[32:35]
  ds_read_b64_tr_b16 a[168:169], v198 offset:36864
  v_fmac_f32 v159, v238, v158
  v_mfma_f32_16x16x32_bf16 v[36:39], a[144:147], a[140:143], v[36:39]
  ds_read_b64_tr_b16 a[170:171], v198 offset:37376
  v_fma_f32 v147, -v239, v154, v147
  v_fmac_f32 v155, v239, v146
  v_mfma_f32_16x16x32_bf16 v[40:43], a[148:151], a[136:139], v[40:43]
  ds_read_b64_tr_b16 a[172:173], v199 offset:36864
  v_fma_f32 v151, -v239, v158, v151
  v_mfma_f32_16x16x32_bf16 v[44:47], a[148:151], a[140:143], v[44:47]
  ds_read_b64_tr_b16 a[174:175], v199 offset:37376
  v_fmac_f32 v159, v239, v150
  ds_write2_b32 v244, v131, v139 offset0:0 offset1:1
  v_mfma_f32_16x16x32_bf16 v[64:67], a[152:155], a[0:3], 0
  ds_read_b64_tr_b16 a[144:145], v200 offset:36864
  buffer_load_dwordx4 v208, s[8:11], s44 offen offset:1024 lds
  v_mfma_f32_16x16x32_bf16 v[68:71], a[152:155], a[4:7], 0
  ds_read_b64_tr_b16 a[146:147], v200 offset:37376
  ds_write2_b32 v245, v135, v143 offset0:0 offset1:1
  s_waitcnt lgkmcnt(6)
  v_mfma_f32_16x16x32_bf16 v[72:75], a[156:159], a[0:3], 0
  ds_read_b64_tr_b16 a[148:149], v201 offset:36864
  ds_write2_b32 v244, v147, v155 offset0:32 offset1:33
  v_mfma_f32_16x16x32_bf16 v[76:79], a[156:159], a[4:7], 0
  ds_read_b64_tr_b16 a[150:151], v201 offset:37376
  ds_write2_b32 v245, v151, v159 offset0:32 offset1:33
  v_add_u32 v246, s47, v227
  v_mfma_f32_16x16x32_bf16 v[80:83], a[160:163], a[0:3], 0
  ds_read_b64_tr_b16 a[152:153], v198 offset:28672
  v_add_u32 v246, 147456, v246
  ds_read_b64 v[228:229], v246 offset:0
  v_mfma_f32_16x16x32_bf16 v[84:87], a[160:163], a[4:7], 0
  ds_read_b64_tr_b16 a[154:155], v198 offset:29184
  ds_read_b64 v[230:231], v246 offset:384
  v_mfma_f32_16x16x32_bf16 v[88:91], a[164:167], a[0:3], 0
  ds_read_b64_tr_b16 a[156:157], v199 offset:28672
  s_waitcnt lgkmcnt(14)
  ds_read_b64 v[232:233], v246 offset:768
  s_waitcnt lgkmcnt(14)
  ds_read_b64 v[234:235], v246 offset:1152
  v_mfma_f32_16x16x32_bf16 v[92:95], a[164:167], a[4:7], 0
  s_waitcnt lgkmcnt(14)
  ds_read_b64_tr_b16 a[158:159], v199 offset:29184
  s_waitcnt lgkmcnt(14)
  ds_read_b64 v[236:237], v246 offset:1536
  v_mfma_f32_16x16x32_bf16 v[96:99], a[168:171], a[0:3], 0
  s_waitcnt lgkmcnt(14)
  ds_read_b64_tr_b16 a[160:161], v200 offset:28672
  s_waitcnt lgkmcnt(14)
  ds_read_b64 v[238:239], v246 offset:1920
  s_waitcnt lgkmcnt(14)
  ds_read_b64 v[240:241], v246 offset:2304
  v_mfma_f32_16x16x32_bf16 v[100:103], a[168:171], a[4:7], 0
  s_waitcnt lgkmcnt(14)
  ds_read_b64_tr_b16 a[162:163], v200 offset:29184
  s_waitcnt lgkmcnt(10)
  v_mfma_f32_16x16x32_bf16 v[104:107], a[172:175], a[0:3], 0
  ds_read_b64_tr_b16 a[164:165], v201 offset:28672
  ds_read_b64 v[242:243], v246 offset:2688
  s_mul_i32 s49, s40, 384
  s_add_u32 s49, s49, 159744
  v_mfma_f32_16x16x32_bf16 v[108:111], a[172:175], a[4:7], 0
  ds_read_b64_tr_b16 a[166:167], v201 offset:29184
  v_add_u32 v248, s49, v227
  v_mfma_f32_16x16x32_bf16 v[112:115], a[144:147], a[0:3], 0
  ds_read_b64_tr_b16 a[168:169], v198 offset:40960
  s_lshl_b32 s74, s42, 4
  s_add_u32 s74, s74, s41
  s_lshl_b32 s74, s74, 7
  s_add_u32 s74, s74, 46243840
  s_cmp_eq_u32 s40, 0
  s_cselect_b32 s75, 1, 0
  v_mfma_f32_16x16x32_bf16 v[116:119], a[144:147], a[4:7], 0
  ds_read_b64_tr_b16 a[170:171], v198 offset:41472
  s_waitcnt lgkmcnt(14)
  v_fmac_f32 v230, v217, v228
  v_mfma_f32_16x16x32_bf16 v[120:123], a[148:151], a[0:3], 0
  ds_read_b64_tr_b16 a[172:173], v199 offset:40960
  v_fmac_f32 v231, v217, v229
  v_fma_f32 v230, -v218, v229, v230
  v_mfma_f32_16x16x32_bf16 v[124:127], a[148:151], a[4:7], 0
  s_waitcnt lgkmcnt(14)
  ds_read_b64_tr_b16 a[174:175], v199 offset:41472
  v_fmac_f32 v231, v218, v228
  v_mfma_f32_16x16x32_bf16 v[64:67], a[152:155], a[8:11], v[64:67]
  s_waitcnt lgkmcnt(14)
  ds_read_b64_tr_b16 a[144:145], v200 offset:40960
  v_fmac_f32 v232, v217, v230
  v_fmac_f32 v233, v217, v231
  v_mfma_f32_16x16x32_bf16 v[68:71], a[152:155], a[12:15], v[68:71]
  s_waitcnt lgkmcnt(14)
  ds_read_b64_tr_b16 a[146:147], v200 offset:41472
  v_fma_f32 v232, -v218, v231, v232
  s_waitcnt lgkmcnt(4)
  v_mfma_f32_16x16x32_bf16 v[72:75], a[156:159], a[8:11], v[72:75]
  ds_read_b64_tr_b16 a[148:149], v201 offset:40960
  v_fmac_f32 v233, v218, v230
  v_mfma_f32_16x16x32_bf16 v[76:79], a[156:159], a[12:15], v[76:79]
  ds_read_b64_tr_b16 a[150:151], v201 offset:41472
  v_fmac_f32 v234, v217, v232
  v_fmac_f32 v235, v217, v233
  v_mfma_f32_16x16x32_bf16 v[80:83], a[160:163], a[8:11], v[80:83]
  ds_read_b64_tr_b16 a[152:153], v198 offset:32768
  v_fma_f32 v234, -v218, v233, v234
  v_mfma_f32_16x16x32_bf16 v[84:87], a[160:163], a[12:15], v[84:87]
  ds_read_b64_tr_b16 a[154:155], v198 offset:33280
  v_fmac_f32 v235, v218, v232
  v_fmac_f32 v236, v217, v234
  v_mfma_f32_16x16x32_bf16 v[88:91], a[164:167], a[8:11], v[88:91]
  ds_read_b64_tr_b16 a[156:157], v199 offset:32768
  v_fmac_f32 v237, v217, v235
  v_mfma_f32_16x16x32_bf16 v[92:95], a[164:167], a[12:15], v[92:95]
  ds_read_b64_tr_b16 a[158:159], v199 offset:33280
  v_fma_f32 v236, -v218, v235, v236
  v_fmac_f32 v237, v218, v234
  v_mfma_f32_16x16x32_bf16 v[96:99], a[168:171], a[8:11], v[96:99]
  ds_read_b64_tr_b16 a[160:161], v200 offset:32768
  v_fmac_f32 v238, v217, v236
  v_mfma_f32_16x16x32_bf16 v[100:103], a[168:171], a[12:15], v[100:103]
  ds_read_b64_tr_b16 a[162:163], v200 offset:33280
  v_fmac_f32 v239, v217, v237
  s_waitcnt lgkmcnt(4)
  v_mfma_f32_16x16x32_bf16 v[104:107], a[172:175], a[8:11], v[104:107]
  ds_read_b64_tr_b16 a[164:165], v201 offset:32768
  v_fma_f32 v238, -v218, v237, v238
  v_mfma_f32_16x16x32_bf16 v[108:111], a[172:175], a[12:15], v[108:111]
  ds_read_b64_tr_b16 a[166:167], v201 offset:33280
  v_fmac_f32 v239, v218, v236
  v_fmac_f32 v240, v217, v238
  v_mfma_f32_16x16x32_bf16 v[112:115], a[144:147], a[8:11], v[112:115]
  ds_read_b64_tr_b16 a[168:169], v198 offset:45056
  v_fmac_f32 v241, v217, v239
  v_mfma_f32_16x16x32_bf16 v[116:119], a[144:147], a[12:15], v[116:119]
  ds_read_b64_tr_b16 a[170:171], v198 offset:45568
  v_fma_f32 v240, -v218, v239, v240
  v_fmac_f32 v241, v218, v238
  v_mfma_f32_16x16x32_bf16 v[120:123], a[148:151], a[8:11], v[120:123]
  ds_read_b64_tr_b16 a[172:173], v199 offset:45056
  v_fmac_f32 v242, v217, v240
  v_mfma_f32_16x16x32_bf16 v[124:127], a[148:151], a[12:15], v[124:127]
  ds_read_b64_tr_b16 a[174:175], v199 offset:45568
  v_fmac_f32 v243, v217, v241
  v_fma_f32 v242, -v218, v241, v242
  v_mfma_f32_16x16x32_bf16 v[64:67], a[152:155], a[16:19], v[64:67]
  ds_read_b64_tr_b16 a[144:145], v200 offset:45056
  v_fmac_f32 v243, v218, v240
  ds_write_b64 v248, v[242:243]
  v_mfma_f32_16x16x32_bf16 v[68:71], a[152:155], a[20:23], v[68:71]
  ds_read_b64_tr_b16 a[146:147], v200 offset:45568
  s_waitcnt lgkmcnt(5)
  v_mfma_f32_16x16x32_bf16 v[72:75], a[156:159], a[16:19], v[72:75]
  ds_read_b64_tr_b16 a[148:149], v201 offset:45056
  s_waitcnt vmcnt(6) lgkmcnt(2)
  v_mfma_f32_16x16x32_bf16 v[76:79], a[156:159], a[20:23], v[76:79]
  ds_read_b64_tr_b16 a[150:151], v201 offset:45568
  s_barrier
  v_mfma_f32_16x16x32_bf16 v[80:83], a[160:163], a[16:19], v[80:83]
  ds_read_b64_tr_b16 a[152:153], v194 offset:24576
  v_mov_b32 v187, s74
  v_mfma_f32_16x16x32_bf16 v[84:87], a[160:163], a[20:23], v[84:87]
  ds_read_b64_tr_b16 a[154:155], v194 offset:25088
  v_cmp_gt_u32 vcc, s75, v225
  v_mov_b32 v189, 0x7ffffff0
  v_mfma_f32_16x16x32_bf16 v[88:91], a[164:167], a[16:19], v[88:91]
  ds_read_b64_tr_b16 a[156:157], v195 offset:24576
  v_cndmask_b32 v187, v189, v187, vcc
  v_mfma_f32_16x16x32_bf16 v[92:95], a[164:167], a[20:23], v[92:95]
  ds_read_b64_tr_b16 a[158:159], v195 offset:25088
  s_sub_u32 s74, s74, 46243840
  s_xor_b32 s74, s74, 2048
  s_add_u32 s74, s74, 46243840
  v_mfma_f32_16x16x32_bf16 v[96:99], a[168:171], a[16:19], v[96:99]
  ds_read_b64_tr_b16 a[160:161], v196 offset:24576
  v_mov_b32 v188, s74
  v_mfma_f32_16x16x32_bf16 v[100:103], a[168:171], a[20:23], v[100:103]
  ds_read_b64_tr_b16 a[162:163], v196 offset:25088
  s_waitcnt lgkmcnt(4)
  v_mfma_f32_16x16x32_bf16 v[104:107], a[172:175], a[16:19], v[104:107]
  ds_read_b64_tr_b16 a[164:165], v197 offset:24576
  s_add_u32 s44, s44, 884736
  s_add_u32 m0, s46, 24576
  v_mfma_f32_16x16x32_bf16 v[108:111], a[172:175], a[20:23], v[108:111]
  ds_read_b64_tr_b16 a[166:167], v197 offset:25088
  buffer_load_dwordx4 v203, s[8:11], s44 offen lds
  v_mfma_f32_16x16x32_bf16 v[112:115], a[144:147], a[16:19], v[112:115]
  ds_read_b64_tr_b16 a[168:169], v194 offset:36864
  v_add_u32 v248, 159744, v227
  v_mfma_f32_16x16x32_bf16 v[116:119], a[144:147], a[20:23], v[116:119]
  ds_read_b64_tr_b16 a[170:171], v194 offset:37376
  ds_read_b64 v[228:229], v248 offset:0
  v_mfma_f32_16x16x32_bf16 v[120:123], a[148:151], a[16:19], v[120:123]
  ds_read_b64_tr_b16 a[172:173], v195 offset:36864
  ds_read_b64 v[230:231], v248 offset:384
  v_mfma_f32_16x16x32_bf16 v[124:127], a[148:151], a[20:23], v[124:127]
  ds_read_b64_tr_b16 a[174:175], v195 offset:37376
  ds_read_b64 v[232:233], v248 offset:768
  ds_read_b64 v[234:235], v248 offset:1152
  v_mfma_f32_16x16x32_bf16 v[64:67], a[152:155], a[24:27], v[64:67]
  ds_read_b64_tr_b16 a[144:145], v196 offset:36864
  s_mul_i32 s49, s41, 384
  s_cmp_eq_u32 s40, 0
  s_cselect_b32 s50, 48, 0
  v_mfma_f32_16x16x32_bf16 v[68:71], a[152:155], a[28:31], v[68:71]
  s_waitcnt lgkmcnt(14)
  ds_read_b64_tr_b16 a[146:147], v196 offset:37376
  s_waitcnt lgkmcnt(8)
  v_mfma_f32_16x16x32_bf16 v[72:75], a[156:159], a[24:27], v[72:75]
  ds_read_b64_tr_b16 a[148:149], v197 offset:36864
  buffer_load_dwordx4 v204, s[8:11], s44 offen offset:1024 lds
  v_mfma_f32_16x16x32_bf16 v[76:79], a[156:159], a[28:31], v[76:79]
  ds_read_b64_tr_b16 a[150:151], v197 offset:37376
  v_add_u32 v249, s49, v227
  v_mfma_f32_16x16x32_bf16 v[80:83], a[160:163], a[24:27], v[80:83]
  ds_read_b64_tr_b16 a[152:153], v194 offset:28672
  v_cmp_gt_u32 vcc, s50, v225
  v_mov_b32 v250, 0x7ffffff0
  v_mfma_f32_16x16x32_bf16 v[84:87], a[160:163], a[28:31], v[84:87]
  ds_read_b64_tr_b16 a[154:155], v194 offset:29184
  v_max_f32 v0, 0, v0
  v_mfma_f32_16x16x32_bf16 v[88:91], a[164:167], a[24:27], v[88:91]
  ds_read_b64_tr_b16 a[156:157], v195 offset:28672
  s_waitcnt lgkmcnt(10)
  v_fmac_f32 v230, v219, v228
  v_mfma_f32_16x16x32_bf16 v[92:95], a[164:167], a[28:31], v[92:95]
  ds_read_b64_tr_b16 a[158:159], v195 offset:29184
  v_fmac_f32 v231, v219, v229
  v_fma_f32 v230, -v220, v229, v230
  v_fmac_f32 v231, v220, v228
  v_mfma_f32_16x16x32_bf16 v[96:99], a[168:171], a[24:27], v[96:99]
  ds_read_b64_tr_b16 a[160:161], v196 offset:28672
  s_waitcnt lgkmcnt(10)
  v_fmac_f32 v232, v219, v230
  v_fmac_f32 v233, v219, v231
  v_fma_f32 v232, -v220, v231, v232
  v_fmac_f32 v233, v220, v230
  s_waitcnt lgkmcnt(9)
  v_fmac_f32 v234, v219, v232
  buffer_load_dwordx4 v205, s[8:11], s44 offen offset:2048 lds
  buffer_load_dwordx4 v206, s[8:11], s44 offen offset:3072 lds
  s_add_u32 m0, s46, 28672
  s_nop 0
  buffer_load_dwordx4 v207, s[8:11], s44 offen lds
  buffer_load_dwordx4 v208, s[8:11], s44 offen offset:1024 lds
  v_mfma_f32_16x16x32_bf16 v[100:103], a[168:171], a[28:31], v[100:103]
  ds_read_b64_tr_b16 a[162:163], v196 offset:29184
  s_waitcnt lgkmcnt(4)
  v_mfma_f32_16x16x32_bf16 v[104:107], a[172:175], a[24:27], v[104:107]
  ds_read_b64_tr_b16 a[164:165], v197 offset:28672
  s_add_u32 s44, s44, 884736
  v_mfma_f32_16x16x32_bf16 v[108:111], a[172:175], a[28:31], v[108:111]
  ds_read_b64_tr_b16 a[166:167], v197 offset:29184
  s_add_u32 m0, s46, 49152
  v_fmac_f32 v235, v219, v233
  v_mfma_f32_16x16x32_bf16 v[112:115], a[144:147], a[24:27], v[112:115]
  ds_read_b64_tr_b16 a[168:169], v194 offset:40960
  v_fma_f32 v234, -v220, v233, v234
  v_mfma_f32_16x16x32_bf16 v[116:119], a[144:147], a[28:31], v[116:119]
  ds_read_b64_tr_b16 a[170:171], v194 offset:41472
  v_fmac_f32 v235, v220, v232
  v_mfma_f32_16x16x32_bf16 v[120:123], a[148:151], a[24:27], v[120:123]
  ds_read_b64_tr_b16 a[172:173], v195 offset:40960
  v_cndmask_b32 v249, v250, v249, vcc
  v_mfma_f32_16x16x32_bf16 v[124:127], a[148:151], a[28:31], v[124:127]
  ds_read_b64_tr_b16 a[174:175], v195 offset:41472
  buffer_store_dwordx2 v[234:235], v249, s[28:31], 0 offen sc1
  v_mfma_f32_16x16x32_bf16 v[64:67], a[152:155], a[32:35], v[64:67]
  ds_read_b64_tr_b16 a[144:145], v196 offset:40960
  v_mul_f32 v32, v215, v32
  v_mfma_f32_16x16x32_bf16 v[68:71], a[152:155], a[36:39], v[68:71]
  ds_read_b64_tr_b16 a[146:147], v196 offset:41472
  v_max_f32 v1, 0, v1
  s_waitcnt lgkmcnt(4)
  v_mfma_f32_16x16x32_bf16 v[72:75], a[156:159], a[32:35], v[72:75]
  ds_read_b64_tr_b16 a[148:149], v197 offset:40960
  v_mul_f32 v33, v215, v33
  v_mfma_f32_16x16x32_bf16 v[76:79], a[156:159], a[36:39], v[76:79]
  ds_read_b64_tr_b16 a[150:151], v197 offset:41472
  v_max_f32 v2, 0, v2
  v_mfma_f32_16x16x32_bf16 v[80:83], a[160:163], a[32:35], v[80:83]
  ds_read_b64_tr_b16 a[152:153], v194 offset:32768
  buffer_load_dwordx4 v203, s[8:11], s44 offen lds
  v_mfma_f32_16x16x32_bf16 v[84:87], a[160:163], a[36:39], v[84:87]
  ds_read_b64_tr_b16 a[154:155], v194 offset:33280
  v_mul_f32 v34, v215, v34
  v_mfma_f32_16x16x32_bf16 v[88:91], a[164:167], a[32:35], v[88:91]
  ds_read_b64_tr_b16 a[156:157], v195 offset:32768
  v_max_f32 v3, 0, v3
  v_mul_f32 v35, v215, v35
  v_mfma_f32_16x16x32_bf16 v[92:95], a[164:167], a[36:39], v[92:95]
  ds_read_b64_tr_b16 a[158:159], v195 offset:33280
  v_mul_f32 v0, v0, v32
  v_mfma_f32_16x16x32_bf16 v[96:99], a[168:171], a[32:35], v[96:99]
  ds_read_b64_tr_b16 a[160:161], v196 offset:32768
  v_mul_f32 v1, v1, v33
  v_mfma_f32_16x16x32_bf16 v[100:103], a[168:171], a[36:39], v[100:103]
  ds_read_b64_tr_b16 a[162:163], v196 offset:33280
  s_waitcnt lgkmcnt(4)
  v_mfma_f32_16x16x32_bf16 v[104:107], a[172:175], a[32:35], v[104:107]
  ds_read_b64_tr_b16 a[164:165], v197 offset:32768
  v_mul_f32 v2, v2, v34
  v_mfma_f32_16x16x32_bf16 v[108:111], a[172:175], a[36:39], v[108:111]
  ds_read_b64_tr_b16 a[166:167], v197 offset:33280
  buffer_load_dwordx4 v204, s[8:11], s44 offen offset:1024 lds
  v_mul_f32 v3, v3, v35
  v_mfma_f32_16x16x32_bf16 v[112:115], a[144:147], a[32:35], v[112:115]
  ds_read_b64_tr_b16 a[168:169], v194 offset:45056
  v_max_f32 v8, 0, v8
  v_mfma_f32_16x16x32_bf16 v[116:119], a[144:147], a[36:39], v[116:119]
  ds_read_b64_tr_b16 a[170:171], v194 offset:45568
  v_mul_f32 v40, v215, v40
  v_mfma_f32_16x16x32_bf16 v[120:123], a[148:151], a[32:35], v[120:123]
  ds_read_b64_tr_b16 a[172:173], v195 offset:45056
  v_max_f32 v9, 0, v9
  v_mfma_f32_16x16x32_bf16 v[124:127], a[148:151], a[36:39], v[124:127]
  ds_read_b64_tr_b16 a[174:175], v195 offset:45568
  v_mul_f32 v41, v215, v41
  v_mfma_f32_16x16x32_bf16 v[64:67], a[152:155], a[40:43], v[64:67]
  ds_read_b64_tr_b16 a[144:145], v196 offset:45056
  v_max_f32 v10, 0, v10
  v_mfma_f32_16x16x32_bf16 v[68:71], a[152:155], a[44:47], v[68:71]
  ds_read_b64_tr_b16 a[146:147], v196 offset:45568
  v_mul_f32 v42, v215, v42
  s_waitcnt lgkmcnt(4)
  v_mfma_f32_16x16x32_bf16 v[72:75], a[156:159], a[40:43], v[72:75]
  ds_read_b64_tr_b16 a[148:149], v197 offset:45056
  s_waitcnt vmcnt(9)
  v_mfma_f32_16x16x32_bf16 v[76:79], a[156:159], a[44:47], v[76:79]
  ds_read_b64_tr_b16 a[150:151], v197 offset:45568
  s_barrier
  v_mfma_f32_16x16x32_bf16 v[80:83], a[160:163], a[40:43], v[80:83]
  ds_read_b64_tr_b16 a[152:153], v190
  buffer_load_dwordx4 v205, s[8:11], s44 offen offset:2048 lds
  v_mfma_f32_16x16x32_bf16 v[84:87], a[160:163], a[44:47], v[84:87]
  ds_read_b64_tr_b16 a[154:155], v190 offset:512
  v_max_f32 v11, 0, v11
  v_mfma_f32_16x16x32_bf16 v[88:91], a[164:167], a[40:43], v[88:91]
  ds_read_b64_tr_b16 a[156:157], v191
  v_mul_f32 v43, v215, v43
  v_mul_f32 v8, v8, v40
  v_mfma_f32_16x16x32_bf16 v[92:95], a[164:167], a[44:47], v[92:95]
  ds_read_b64_tr_b16 a[158:159], v191 offset:512
  v_mul_f32 v9, v9, v41
  v_mfma_f32_16x16x32_bf16 v[96:99], a[168:171], a[40:43], v[96:99]
  ds_read_b64_tr_b16 a[160:161], v192
  v_mul_f32 v10, v10, v42
  v_mfma_f32_16x16x32_bf16 v[100:103], a[168:171], a[44:47], v[100:103]
  ds_read_b64_tr_b16 a[162:163], v192 offset:512
  s_waitcnt lgkmcnt(4)
  v_mfma_f32_16x16x32_bf16 v[104:107], a[172:175], a[40:43], v[104:107]
  ds_read_b64_tr_b16 a[164:165], v193
  v_mul_f32 v11, v11, v43
  v_mfma_f32_16x16x32_bf16 v[108:111], a[172:175], a[44:47], v[108:111]
  ds_read_b64_tr_b16 a[166:167], v193 offset:512
  buffer_load_dwordx4 v206, s[8:11], s44 offen offset:3072 lds
  s_add_u32 m0, s46, 53248
  v_mfma_f32_16x16x32_bf16 v[112:115], a[144:147], a[40:43], v[112:115]
  ds_read_b64_tr_b16 a[168:169], v190 offset:12288
  v_cvt_pk_bf16_f32 v32, v0, v1
  v_mfma_f32_16x16x32_bf16 v[116:119], a[144:147], a[44:47], v[116:119]
  ds_read_b64_tr_b16 a[170:171], v190 offset:12800
  v_cvt_pk_bf16_f32 v33, v2, v3
  v_mfma_f32_16x16x32_bf16 v[120:123], a[148:151], a[40:43], v[120:123]
  ds_read_b64_tr_b16 a[172:173], v191 offset:12288
  v_cvt_pk_bf16_f32 v34, v8, v9
  v_mfma_f32_16x16x32_bf16 v[124:127], a[148:151], a[44:47], v[124:127]
  ds_read_b64_tr_b16 a[174:175], v191 offset:12800
  v_cvt_pk_bf16_f32 v35, v10, v11
  v_mfma_f32_16x16x32_bf16 v[64:67], a[152:155], a[48:51], v[64:67]
  ds_read_b64_tr_b16 a[144:145], v192 offset:12288
  v_accvgpr_write_b32 a240, v32
  v_mfma_f32_16x16x32_bf16 v[68:71], a[152:155], a[52:55], v[68:71]
  ds_read_b64_tr_b16 a[146:147], v192 offset:12800
  v_accvgpr_write_b32 a241, v33
  s_waitcnt lgkmcnt(4)
  v_mfma_f32_16x16x32_bf16 v[72:75], a[156:159], a[48:51], v[72:75]
  ds_read_b64_tr_b16 a[148:149], v193 offset:12288
  buffer_load_dwordx4 v207, s[8:11], s44 offen lds
  v_mfma_f32_16x16x32_bf16 v[76:79], a[156:159], a[52:55], v[76:79]
  ds_read_b64_tr_b16 a[150:151], v193 offset:12800
  v_accvgpr_write_b32 a242, v34
  v_mfma_f32_16x16x32_bf16 v[80:83], a[160:163], a[48:51], v[80:83]
  ds_read_b64_tr_b16 a[152:153], v190 offset:4096
  v_accvgpr_write_b32 a243, v35
  v_mfma_f32_16x16x32_bf16 v[84:87], a[160:163], a[52:55], v[84:87]
  ds_read_b64_tr_b16 a[154:155], v190 offset:4608
  v_add_u32 v213, 36864, v209
  v_mfma_f32_16x16x32_bf16 v[88:91], a[164:167], a[48:51], v[88:91]
  ds_read_b64_tr_b16 a[156:157], v191 offset:4096
  v_add_u32 v214, 45056, v209
  v_and_b32 v252, 15, v225
  v_mfma_f32_16x16x32_bf16 v[92:95], a[164:167], a[52:55], v[92:95]
  ds_read_b64_tr_b16 a[158:159], v191 offset:4608
  s_add_u32 s63, s61, 16384
  buffer_store_dwordx4 v[32:35], v226, s[24:27], s63 offen sc1
  v_mfma_f32_16x16x32_bf16 v[96:99], a[168:171], a[48:51], v[96:99]
  ds_read_b64_tr_b16 a[160:161], v192 offset:4096
  v_max_f32 v4, 0, v4
  buffer_load_dwordx4 v208, s[8:11], s44 offen offset:1024 lds
  v_mfma_f32_16x16x32_bf16 v[100:103], a[168:171], a[52:55], v[100:103]
  ds_read_b64_tr_b16 a[162:163], v192 offset:4608
  s_waitcnt lgkmcnt(4)
  v_mfma_f32_16x16x32_bf16 v[104:107], a[172:175], a[48:51], v[104:107]
  ds_read_b64_tr_b16 a[164:165], v193 offset:4096
  s_add_u32 s44, s44, 884736
  v_mfma_f32_16x16x32_bf16 v[108:111], a[172:175], a[52:55], v[108:111]
  ds_read_b64_tr_b16 a[166:167], v193 offset:4608
  s_add_u32 m0, s46, 98304
  v_mul_f32 v36, v216, v36
  v_mfma_f32_16x16x32_bf16 v[112:115], a[144:147], a[48:51], v[112:115]
  ds_read_b64_tr_b16 a[168:169], v190 offset:16384
  v_max_f32 v5, 0, v5
  v_mfma_f32_16x16x32_bf16 v[116:119], a[144:147], a[52:55], v[116:119]
  ds_read_b64_tr_b16 a[170:171], v190 offset:16896
  v_mul_f32 v37, v216, v37
  v_mfma_f32_16x16x32_bf16 v[120:123], a[148:151], a[48:51], v[120:123]
  ds_read_b64_tr_b16 a[172:173], v191 offset:16384
  v_max_f32 v6, 0, v6
  v_mfma_f32_16x16x32_bf16 v[124:127], a[148:151], a[52:55], v[124:127]
  ds_read_b64_tr_b16 a[174:175], v191 offset:16896
  v_mul_f32 v38, v216, v38
  v_mfma_f32_16x16x32_bf16 v[64:67], a[152:155], a[56:59], v[64:67]
  ds_read_b64_tr_b16 a[144:145], v192 offset:16384
  buffer_load_dwordx4 v203, s[8:11], s44 offen lds
  v_mfma_f32_16x16x32_bf16 v[68:71], a[152:155], a[60:63], v[68:71]
  ds_read_b64_tr_b16 a[146:147], v192 offset:16896
  v_max_f32 v7, 0, v7
  s_waitcnt lgkmcnt(4)
  v_mfma_f32_16x16x32_bf16 v[72:75], a[156:159], a[56:59], v[72:75]
  ds_read_b64_tr_b16 a[148:149], v193 offset:16384
  v_mul_f32 v39, v216, v39
  v_mfma_f32_16x16x32_bf16 v[76:79], a[156:159], a[60:63], v[76:79]
  ds_read_b64_tr_b16 a[150:151], v193 offset:16896
  v_mul_f32 v4, v4, v36
  v_mfma_f32_16x16x32_bf16 v[80:83], a[160:163], a[56:59], v[80:83]
  ds_read_b64_tr_b16 a[152:153], v190 offset:8192
  v_mul_f32 v5, v5, v37
  v_mfma_f32_16x16x32_bf16 v[84:87], a[160:163], a[60:63], v[84:87]
  ds_read_b64_tr_b16 a[154:155], v190 offset:8704
  v_mul_f32 v6, v6, v38
  v_mfma_f32_16x16x32_bf16 v[88:91], a[164:167], a[56:59], v[88:91]
  ds_read_b64_tr_b16 a[156:157], v191 offset:8192
  v_mul_f32 v7, v7, v39
  v_max_f32 v12, 0, v12
  v_mfma_f32_16x16x32_bf16 v[92:95], a[164:167], a[60:63], v[92:95]
  ds_read_b64_tr_b16 a[158:159], v191 offset:8704
  buffer_load_dwordx4 v204, s[8:11], s44 offen offset:1024 lds
  v_mfma_f32_16x16x32_bf16 v[96:99], a[168:171], a[56:59], v[96:99]
  ds_read_b64_tr_b16 a[160:161], v192 offset:8192
  v_mul_f32 v44, v216, v44
  v_mfma_f32_16x16x32_bf16 v[100:103], a[168:171], a[60:63], v[100:103]
  ds_read_b64_tr_b16 a[162:163], v192 offset:8704
  s_waitcnt lgkmcnt(4)
  v_mfma_f32_16x16x32_bf16 v[104:107], a[172:175], a[56:59], v[104:107]
  ds_read_b64_tr_b16 a[164:165], v193 offset:8192
  v_max_f32 v13, 0, v13
  v_mfma_f32_16x16x32_bf16 v[108:111], a[172:175], a[60:63], v[108:111]
  ds_read_b64_tr_b16 a[166:167], v193 offset:8704
  v_mul_f32 v45, v216, v45
  v_mfma_f32_16x16x32_bf16 v[112:115], a[144:147], a[56:59], v[112:115]
  ds_read_b64_tr_b16 a[168:169], v190 offset:20480
  v_max_f32 v14, 0, v14
  v_mul_f32 v46, v216, v46
  v_mfma_f32_16x16x32_bf16 v[116:119], a[144:147], a[60:63], v[116:119]
  ds_read_b64_tr_b16 a[170:171], v190 offset:20992
  v_max_f32 v15, 0, v15
  v_mfma_f32_16x16x32_bf16 v[120:123], a[148:151], a[56:59], v[120:123]
  ds_read_b64_tr_b16 a[172:173], v191 offset:20480
  buffer_load_dwordx4 v205, s[8:11], s44 offen offset:2048 lds
  v_mfma_f32_16x16x32_bf16 v[124:127], a[148:151], a[60:63], v[124:127]
  ds_read_b64_tr_b16 a[174:175], v191 offset:20992
  v_mul_f32 v47, v216, v47
  v_mfma_f32_16x16x32_bf16 v[64:67], a[152:155], a[64:67], v[64:67]
  ds_read_b64_tr_b16 a[144:145], v192 offset:20480
  v_mul_f32 v12, v12, v44
  v_mfma_f32_16x16x32_bf16 v[68:71], a[152:155], a[68:71], v[68:71]
  ds_read_b64_tr_b16 a[146:147], v192 offset:20992
  v_mul_f32 v13, v13, v45
  s_waitcnt lgkmcnt(4)
  v_mfma_f32_16x16x32_bf16 v[72:75], a[156:159], a[64:67], v[72:75]
  ds_read_b64_tr_b16 a[148:149], v193 offset:20480
  s_waitcnt vmcnt(11)
  v_mfma_f32_16x16x32_bf16 v[76:79], a[156:159], a[68:71], v[76:79]
  ds_read_b64_tr_b16 a[150:151], v193 offset:20992
  s_barrier
  v_mfma_f32_16x16x32_bf16 v[80:83], a[160:163], a[64:67], v[80:83]
  ds_read_b64_tr_b16 a[152:153], v190 offset:24576
  v_mul_f32 v14, v14, v46
  v_mfma_f32_16x16x32_bf16 v[84:87], a[160:163], a[68:71], v[84:87]
  ds_read_b64_tr_b16 a[154:155], v190 offset:25088
  buffer_load_dwordx4 v206, s[8:11], s44 offen offset:3072 lds
  v_mfma_f32_16x16x32_bf16 v[88:91], a[164:167], a[64:67], v[88:91]
  ds_read_b64_tr_b16 a[156:157], v191 offset:24576
  s_add_u32 m0, s46, 102400
  v_mul_f32 v15, v15, v47
  v_mfma_f32_16x16x32_bf16 v[92:95], a[164:167], a[68:71], v[92:95]
  ds_read_b64_tr_b16 a[158:159], v191 offset:25088
  v_cvt_pk_bf16_f32 v36, v4, v5
  v_mfma_f32_16x16x32_bf16 v[96:99], a[168:171], a[64:67], v[96:99]
  ds_read_b64_tr_b16 a[160:161], v192 offset:24576
  v_cvt_pk_bf16_f32 v37, v6, v7
  v_mfma_f32_16x16x32_bf16 v[100:103], a[168:171], a[68:71], v[100:103]
  ds_read_b64_tr_b16 a[162:163], v192 offset:25088
  s_waitcnt lgkmcnt(4)
  v_mfma_f32_16x16x32_bf16 v[104:107], a[172:175], a[64:67], v[104:107]
  ds_read_b64_tr_b16 a[164:165], v193 offset:24576
  v_cvt_pk_bf16_f32 v38, v12, v13
  v_mfma_f32_16x16x32_bf16 v[108:111], a[172:175], a[68:71], v[108:111]
  ds_read_b64_tr_b16 a[166:167], v193 offset:25088
  v_cvt_pk_bf16_f32 v39, v14, v15
  v_mfma_f32_16x16x32_bf16 v[112:115], a[144:147], a[64:67], v[112:115]
  ds_read_b64_tr_b16 a[168:169], v190 offset:36864
  buffer_load_dwordx4 v207, s[8:11], s44 offen lds
  v_accvgpr_write_b32 a244, v36
  v_mfma_f32_16x16x32_bf16 v[116:119], a[144:147], a[68:71], v[116:119]
  ds_read_b64_tr_b16 a[170:171], v190 offset:37376
  v_accvgpr_write_b32 a245, v37
  v_mfma_f32_16x16x32_bf16 v[120:123], a[148:151], a[64:67], v[120:123]
  ds_read_b64_tr_b16 a[172:173], v191 offset:36864
  v_accvgpr_write_b32 a246, v38
  v_mfma_f32_16x16x32_bf16 v[124:127], a[148:151], a[68:71], v[124:127]
  ds_read_b64_tr_b16 a[174:175], v191 offset:37376
  v_accvgpr_write_b32 a247, v39
  v_mfma_f32_16x16x32_bf16 v[64:67], a[152:155], a[72:75], v[64:67]
  ds_read_b64_tr_b16 a[144:145], v192 offset:36864
  v_mul_u32_u24 v253, 96, v252
  v_mfma_f32_16x16x32_bf16 v[68:71], a[152:155], a[76:79], v[68:71]
  ds_read_b64_tr_b16 a[146:147], v192 offset:37376
  s_add_u32 s63, s61, 16384
  buffer_store_dwordx4 v[36:39], v226, s[24:27], s63 offen offset:1024 sc1
  s_waitcnt lgkmcnt(4)
  v_mfma_f32_16x16x32_bf16 v[72:75], a[156:159], a[72:75], v[72:75]
  ds_read_b64_tr_b16 a[148:149], v193 offset:36864
  v_lshrrev_b32 v252, 3, v252
  v_mfma_f32_16x16x32_bf16 v[76:79], a[156:159], a[76:79], v[76:79]
  ds_read_b64_tr_b16 a[150:151], v193 offset:37376
  v_lshrrev_b32 v186, 5, v225
  v_mfma_f32_16x16x32_bf16 v[80:83], a[160:163], a[72:75], v[80:83]
  ds_read_b64_tr_b16 a[152:153], v190 offset:28672
  v_xor_b32 v252, v252, v186
  v_mfma_f32_16x16x32_bf16 v[84:87], a[160:163], a[76:79], v[84:87]
  ds_read_b64_tr_b16 a[154:155], v190 offset:29184
  v_lshlrev_b32 v252, 4, v252
  v_mfma_f32_16x16x32_bf16 v[88:91], a[164:167], a[72:75], v[88:91]
  ds_read_b64_tr_b16 a[156:157], v191 offset:28672
  buffer_load_dwordx4 v208, s[8:11], s44 offen offset:1024 lds
  s_add_u32 s44, s64, 128
  v_mfma_f32_16x16x32_bf16 v[92:95], a[164:167], a[76:79], v[92:95]
  ds_read_b64_tr_b16 a[158:159], v191 offset:29184
  s_add_u32 m0, s46, 122880
  v_mfma_f32_16x16x32_bf16 v[96:99], a[168:171], a[72:75], v[96:99]
  ds_read_b64_tr_b16 a[160:161], v192 offset:28672
  v_add_u32 v252, v252, v253
  v_mfma_f32_16x16x32_bf16 v[100:103], a[168:171], a[76:79], v[100:103]
  ds_read_b64_tr_b16 a[162:163], v192 offset:29184
  s_waitcnt lgkmcnt(4)
  v_mfma_f32_16x16x32_bf16 v[104:107], a[172:175], a[72:75], v[104:107]
  ds_read_b64_tr_b16 a[164:165], v193 offset:28672
  v_bfe_u32 v253, v225, 4, 1
  v_mfma_f32_16x16x32_bf16 v[108:111], a[172:175], a[76:79], v[108:111]
  ds_read_b64_tr_b16 a[166:167], v193 offset:29184
  v_mov_b32 v251, 1
  s_waitcnt vmcnt(14)
  buffer_store_dword v251, v187, s[24:27], 0 offen sc1
  v_mfma_f32_16x16x32_bf16 v[112:115], a[144:147], a[72:75], v[112:115]
  ds_read_b64_tr_b16 a[168:169], v190 offset:40960
  v_lshlrev_b32 v253, 3, v253
  v_mfma_f32_16x16x32_bf16 v[116:119], a[144:147], a[76:79], v[116:119]
  ds_read_b64_tr_b16 a[170:171], v190 offset:41472
  v_add_u32 v184, v252, v253
  v_mfma_f32_16x16x32_bf16 v[120:123], a[148:151], a[72:75], v[120:123]
  ds_read_b64_tr_b16 a[172:173], v191 offset:40960
  v_add_u32 v185, 49152, v184
  v_mfma_f32_16x16x32_bf16 v[124:127], a[148:151], a[76:79], v[124:127]
  ds_read_b64_tr_b16 a[174:175], v191 offset:41472
  v_add_u32 v186, 98304, v184
  v_mfma_f32_16x16x32_bf16 v[64:67], a[152:155], a[80:83], v[64:67]
  ds_read_b64_tr_b16 a[144:145], v192 offset:40960
  buffer_load_dwordx4 v203, s[8:11], s44 offen lds
  v_mfma_f32_16x16x32_bf16 v[68:71], a[152:155], a[84:87], v[68:71]
  ds_read_b64_tr_b16 a[146:147], v192 offset:41472
  s_waitcnt lgkmcnt(4)
  v_mfma_f32_16x16x32_bf16 v[72:75], a[156:159], a[80:83], v[72:75]
  ds_read_b64_tr_b16 a[148:149], v193 offset:40960
  v_mfma_f32_16x16x32_bf16 v[76:79], a[156:159], a[84:87], v[76:79]
  ds_read_b64_tr_b16 a[150:151], v193 offset:41472
  v_mfma_f32_16x16x32_bf16 v[80:83], a[160:163], a[80:83], v[80:83]
  ds_read_b64_tr_b16 a[152:153], v190 offset:32768
  v_mfma_f32_16x16x32_bf16 v[84:87], a[160:163], a[84:87], v[84:87]
  ds_read_b64_tr_b16 a[154:155], v190 offset:33280
  v_mfma_f32_16x16x32_bf16 v[88:91], a[164:167], a[80:83], v[88:91]
  ds_read_b64_tr_b16 a[156:157], v191 offset:32768
  v_mfma_f32_16x16x32_bf16 v[92:95], a[164:167], a[84:87], v[92:95]
  ds_read_b64_tr_b16 a[158:159], v191 offset:33280
  buffer_load_dwordx4 v204, s[8:11], s44 offen offset:1024 lds
  v_mfma_f32_16x16x32_bf16 v[96:99], a[168:171], a[80:83], v[96:99]
  ds_read_b64_tr_b16 a[160:161], v192 offset:32768
  v_mfma_f32_16x16x32_bf16 v[100:103], a[168:171], a[84:87], v[100:103]
  ds_read_b64_tr_b16 a[162:163], v192 offset:33280
  s_waitcnt lgkmcnt(4)
  v_mfma_f32_16x16x32_bf16 v[104:107], a[172:175], a[80:83], v[104:107]
  ds_read_b64_tr_b16 a[164:165], v193 offset:32768
  v_mfma_f32_16x16x32_bf16 v[108:111], a[172:175], a[84:87], v[108:111]
  ds_read_b64_tr_b16 a[166:167], v193 offset:33280
  v_mfma_f32_16x16x32_bf16 v[112:115], a[144:147], a[80:83], v[112:115]
  ds_read_b64_tr_b16 a[168:169], v190 offset:45056
  v_mfma_f32_16x16x32_bf16 v[116:119], a[144:147], a[84:87], v[116:119]
  ds_read_b64_tr_b16 a[170:171], v190 offset:45568
  v_mfma_f32_16x16x32_bf16 v[120:123], a[148:151], a[80:83], v[120:123]
  ds_read_b64_tr_b16 a[172:173], v191 offset:45056
  buffer_load_dwordx4 v205, s[8:11], s44 offen offset:2048 lds
  v_mfma_f32_16x16x32_bf16 v[124:127], a[148:151], a[84:87], v[124:127]
  ds_read_b64_tr_b16 a[174:175], v191 offset:45568
  v_mfma_f32_16x16x32_bf16 v[64:67], a[152:155], a[88:91], v[64:67]
  ds_read_b64_tr_b16 a[144:145], v192 offset:45056
  v_mfma_f32_16x16x32_bf16 v[68:71], a[152:155], a[92:95], v[68:71]
  ds_read_b64_tr_b16 a[146:147], v192 offset:45568
  s_waitcnt lgkmcnt(4)
  v_mfma_f32_16x16x32_bf16 v[72:75], a[156:159], a[88:91], v[72:75]
  ds_read_b64_tr_b16 a[148:149], v193 offset:45056
  s_waitcnt vmcnt(11)
  v_mfma_f32_16x16x32_bf16 v[76:79], a[156:159], a[92:95], v[76:79]
  ds_read_b64_tr_b16 a[150:151], v193 offset:45568
  s_barrier
  v_mfma_f32_16x16x32_bf16 v[80:83], a[160:163], a[88:91], v[80:83]
  ds_read_b64_tr_b16 a[152:153], v194
  v_mfma_f32_16x16x32_bf16 v[84:87], a[160:163], a[92:95], v[84:87]
  ds_read_b64_tr_b16 a[154:155], v194 offset:512
  buffer_load_dwordx4 v206, s[8:11], s44 offen offset:3072 lds
  v_mfma_f32_16x16x32_bf16 v[88:91], a[164:167], a[88:91], v[88:91]
  ds_read_b64_tr_b16 a[156:157], v195
  s_add_u32 m0, s46, 126976
  v_mfma_f32_16x16x32_bf16 v[92:95], a[164:167], a[92:95], v[92:95]
  ds_read_b64_tr_b16 a[158:159], v195 offset:512
  v_mfma_f32_16x16x32_bf16 v[96:99], a[168:171], a[88:91], v[96:99]
  ds_read_b64_tr_b16 a[160:161], v196
  v_mfma_f32_16x16x32_bf16 v[100:103], a[168:171], a[92:95], v[100:103]
  ds_read_b64_tr_b16 a[162:163], v196 offset:512
  s_waitcnt lgkmcnt(4)
  v_mfma_f32_16x16x32_bf16 v[104:107], a[172:175], a[88:91], v[104:107]
  ds_read_b64_tr_b16 a[164:165], v197
  v_mfma_f32_16x16x32_bf16 v[108:111], a[172:175], a[92:95], v[108:111]
  ds_read_b64_tr_b16 a[166:167], v197 offset:512
  v_mfma_f32_16x16x32_bf16 v[112:115], a[144:147], a[88:91], v[112:115]
  ds_read_b64_tr_b16 a[168:169], v194 offset:12288
  buffer_load_dwordx4 v207, s[8:11], s44 offen lds
  v_mfma_f32_16x16x32_bf16 v[116:119], a[144:147], a[92:95], v[116:119]
  ds_read_b64_tr_b16 a[170:171], v194 offset:12800
  v_mfma_f32_16x16x32_bf16 v[120:123], a[148:151], a[88:91], v[120:123]
  ds_read_b64_tr_b16 a[172:173], v195 offset:12288
  v_mfma_f32_16x16x32_bf16 v[124:127], a[148:151], a[92:95], v[124:127]
  ds_read_b64_tr_b16 a[174:175], v195 offset:12800
  v_mfma_f32_16x16x32_bf16 v[64:67], a[152:155], a[96:99], v[64:67]
  ds_read_b64_tr_b16 a[144:145], v196 offset:12288
  v_mfma_f32_16x16x32_bf16 v[68:71], a[152:155], a[100:103], v[68:71]
  ds_read_b64_tr_b16 a[146:147], v196 offset:12800
  s_waitcnt lgkmcnt(4)
  v_mfma_f32_16x16x32_bf16 v[72:75], a[156:159], a[96:99], v[72:75]
  ds_read_b64_tr_b16 a[148:149], v197 offset:12288
  v_mfma_f32_16x16x32_bf16 v[76:79], a[156:159], a[100:103], v[76:79]
  ds_read_b64_tr_b16 a[150:151], v197 offset:12800
  buffer_load_dwordx4 v208, s[8:11], s44 offen offset:1024 lds
  v_mfma_f32_16x16x32_bf16 v[80:83], a[160:163], a[96:99], v[80:83]
  ds_read_b64_tr_b16 a[152:153], v194 offset:4096
  s_add_u32 s44, s44, 884736
  v_mfma_f32_16x16x32_bf16 v[84:87], a[160:163], a[100:103], v[84:87]
  ds_read_b64_tr_b16 a[154:155], v194 offset:4608
  s_add_u32 m0, s46, 73728
  v_mfma_f32_16x16x32_bf16 v[88:91], a[164:167], a[96:99], v[88:91]
  ds_read_b64_tr_b16 a[156:157], v195 offset:4096
  v_mfma_f32_16x16x32_bf16 v[92:95], a[164:167], a[100:103], v[92:95]
  ds_read_b64_tr_b16 a[158:159], v195 offset:4608
  v_mfma_f32_16x16x32_bf16 v[96:99], a[168:171], a[96:99], v[96:99]
  ds_read_b64_tr_b16 a[160:161], v196 offset:4096
  v_mfma_f32_16x16x32_bf16 v[100:103], a[168:171], a[100:103], v[100:103]
  ds_read_b64_tr_b16 a[162:163], v196 offset:4608
  s_waitcnt lgkmcnt(4)
  v_mfma_f32_16x16x32_bf16 v[104:107], a[172:175], a[96:99], v[104:107]
  ds_read_b64_tr_b16 a[164:165], v197 offset:4096
  buffer_load_dwordx4 v203, s[8:11], s44 offen lds
  v_mfma_f32_16x16x32_bf16 v[108:111], a[172:175], a[100:103], v[108:111]
  ds_read_b64_tr_b16 a[166:167], v197 offset:4608
  v_mfma_f32_16x16x32_bf16 v[112:115], a[144:147], a[96:99], v[112:115]
  ds_read_b64_tr_b16 a[168:169], v194 offset:16384
  v_mfma_f32_16x16x32_bf16 v[116:119], a[144:147], a[100:103], v[116:119]
  ds_read_b64_tr_b16 a[170:171], v194 offset:16896
  v_mfma_f32_16x16x32_bf16 v[120:123], a[148:151], a[96:99], v[120:123]
  ds_read_b64_tr_b16 a[172:173], v195 offset:16384
  v_mfma_f32_16x16x32_bf16 v[124:127], a[148:151], a[100:103], v[124:127]
  ds_read_b64_tr_b16 a[174:175], v195 offset:16896
  v_mfma_f32_16x16x32_bf16 v[64:67], a[152:155], a[104:107], v[64:67]
  ds_read_b64_tr_b16 a[144:145], v196 offset:16384
  v_mfma_f32_16x16x32_bf16 v[68:71], a[152:155], a[108:111], v[68:71]
  ds_read_b64_tr_b16 a[146:147], v196 offset:16896
  s_waitcnt lgkmcnt(4)
  v_mfma_f32_16x16x32_bf16 v[72:75], a[156:159], a[104:107], v[72:75]
  ds_read_b64_tr_b16 a[148:149], v197 offset:16384
  buffer_load_dwordx4 v204, s[8:11], s44 offen offset:1024 lds
  v_mfma_f32_16x16x32_bf16 v[76:79], a[156:159], a[108:111], v[76:79]
  ds_read_b64_tr_b16 a[150:151], v197 offset:16896
  v_mfma_f32_16x16x32_bf16 v[80:83], a[160:163], a[104:107], v[80:83]
  ds_read_b64_tr_b16 a[152:153], v194 offset:8192
  v_mfma_f32_16x16x32_bf16 v[84:87], a[160:163], a[108:111], v[84:87]
  ds_read_b64_tr_b16 a[154:155], v194 offset:8704
  v_mfma_f32_16x16x32_bf16 v[88:91], a[164:167], a[104:107], v[88:91]
  ds_read_b64_tr_b16 a[156:157], v195 offset:8192
  v_mfma_f32_16x16x32_bf16 v[92:95], a[164:167], a[108:111], v[92:95]
  ds_read_b64_tr_b16 a[158:159], v195 offset:8704
  v_mfma_f32_16x16x32_bf16 v[96:99], a[168:171], a[104:107], v[96:99]
  ds_read_b64_tr_b16 a[160:161], v196 offset:8192
  v_mfma_f32_16x16x32_bf16 v[100:103], a[168:171], a[108:111], v[100:103]
  ds_read_b64_tr_b16 a[162:163], v196 offset:8704
  s_waitcnt lgkmcnt(4)
  v_mfma_f32_16x16x32_bf16 v[104:107], a[172:175], a[104:107], v[104:107]
  ds_read_b64_tr_b16 a[164:165], v197 offset:8192
  buffer_load_dwordx4 v205, s[8:11], s44 offen offset:2048 lds
  v_mfma_f32_16x16x32_bf16 v[108:111], a[172:175], a[108:111], v[108:111]
  ds_read_b64_tr_b16 a[166:167], v197 offset:8704
  v_mfma_f32_16x16x32_bf16 v[112:115], a[144:147], a[104:107], v[112:115]
  ds_read_b64_tr_b16 a[168:169], v194 offset:20480
  v_mfma_f32_16x16x32_bf16 v[116:119], a[144:147], a[108:111], v[116:119]
  ds_read_b64_tr_b16 a[170:171], v194 offset:20992
  v_mfma_f32_16x16x32_bf16 v[120:123], a[148:151], a[104:107], v[120:123]
  ds_read_b64_tr_b16 a[172:173], v195 offset:20480
  v_mfma_f32_16x16x32_bf16 v[124:127], a[148:151], a[108:111], v[124:127]
  ds_read_b64_tr_b16 a[174:175], v195 offset:20992
  v_mfma_f32_16x16x32_bf16 v[64:67], a[152:155], a[112:115], v[64:67]
  ds_read_b64_tr_b16 a[144:145], v196 offset:20480
  v_mfma_f32_16x16x32_bf16 v[68:71], a[152:155], a[116:119], v[68:71]
  ds_read_b64_tr_b16 a[146:147], v196 offset:20992
  s_waitcnt lgkmcnt(4)
  v_mfma_f32_16x16x32_bf16 v[72:75], a[156:159], a[112:115], v[72:75]
  ds_read_b64_tr_b16 a[148:149], v197 offset:20480
  s_waitcnt vmcnt(10)
  v_mfma_f32_16x16x32_bf16 v[76:79], a[156:159], a[116:119], v[76:79]
  ds_read_b64_tr_b16 a[150:151], v197 offset:20992
  s_barrier
  v_mfma_f32_16x16x32_bf16 v[80:83], a[160:163], a[112:115], v[80:83]
  ds_read_b64_tr_b16 a[152:153], v198
  buffer_load_dwordx4 v206, s[8:11], s44 offen offset:3072 lds
  s_add_u32 m0, s46, 77824
  v_mfma_f32_16x16x32_bf16 v[84:87], a[160:163], a[116:119], v[84:87]
  ds_read_b64_tr_b16 a[154:155], v198 offset:512
  v_mfma_f32_16x16x32_bf16 v[88:91], a[164:167], a[112:115], v[88:91]
  ds_read_b64_tr_b16 a[156:157], v199
  v_mfma_f32_16x16x32_bf16 v[92:95], a[164:167], a[116:119], v[92:95]
  ds_read_b64_tr_b16 a[158:159], v199 offset:512
  v_mfma_f32_16x16x32_bf16 v[96:99], a[168:171], a[112:115], v[96:99]
  ds_read_b64_tr_b16 a[160:161], v200
  v_mfma_f32_16x16x32_bf16 v[100:103], a[168:171], a[116:119], v[100:103]
  ds_read_b64_tr_b16 a[162:163], v200 offset:512
  s_waitcnt lgkmcnt(4)
  v_mfma_f32_16x16x32_bf16 v[104:107], a[172:175], a[112:115], v[104:107]
  ds_read_b64_tr_b16 a[164:165], v201
  v_mfma_f32_16x16x32_bf16 v[108:111], a[172:175], a[116:119], v[108:111]
  ds_read_b64_tr_b16 a[166:167], v201 offset:512
  buffer_load_dwordx4 v207, s[8:11], s44 offen lds
  v_mfma_f32_16x16x32_bf16 v[112:115], a[144:147], a[112:115], v[112:115]
  ds_read_b64_tr_b16 a[168:169], v198 offset:12288
  v_mfma_f32_16x16x32_bf16 v[116:119], a[144:147], a[116:119], v[116:119]
  ds_read_b64_tr_b16 a[170:171], v198 offset:12800
  v_mfma_f32_16x16x32_bf16 v[120:123], a[148:151], a[112:115], v[120:123]
  ds_read_b64_tr_b16 a[172:173], v199 offset:12288
  v_mfma_f32_16x16x32_bf16 v[124:127], a[148:151], a[116:119], v[124:127]
  ds_read_b64_tr_b16 a[174:175], v199 offset:12800
  v_mfma_f32_16x16x32_bf16 v[64:67], a[152:155], a[120:123], v[64:67]
  ds_read_b64_tr_b16 a[144:145], v200 offset:12288
  v_mfma_f32_16x16x32_bf16 v[68:71], a[152:155], a[124:127], v[68:71]
  ds_read_b64_tr_b16 a[146:147], v200 offset:12800
  s_waitcnt lgkmcnt(4)
  v_mfma_f32_16x16x32_bf16 v[72:75], a[156:159], a[120:123], v[72:75]
  ds_read_b64_tr_b16 a[148:149], v201 offset:12288
  buffer_load_dwordx4 v208, s[8:11], s44 offen offset:1024 lds
  v_mfma_f32_16x16x32_bf16 v[76:79], a[156:159], a[124:127], v[76:79]
  ds_read_b64_tr_b16 a[150:151], v201 offset:12800
  s_add_u32 s44, s44, 884736
  v_mfma_f32_16x16x32_bf16 v[80:83], a[160:163], a[120:123], v[80:83]
  ds_read_b64_tr_b16 a[152:153], v198 offset:4096
  s_add_u32 m0, s46, 0
  v_mfma_f32_16x16x32_bf16 v[84:87], a[160:163], a[124:127], v[84:87]
  ds_read_b64_tr_b16 a[154:155], v198 offset:4608
  v_mfma_f32_16x16x32_bf16 v[88:91], a[164:167], a[120:123], v[88:91]
  ds_read_b64_tr_b16 a[156:157], v199 offset:4096
  v_mfma_f32_16x16x32_bf16 v[92:95], a[164:167], a[124:127], v[92:95]
  ds_read_b64_tr_b16 a[158:159], v199 offset:4608
  v_mfma_f32_16x16x32_bf16 v[96:99], a[168:171], a[120:123], v[96:99]
  ds_read_b64_tr_b16 a[160:161], v200 offset:4096
  v_mfma_f32_16x16x32_bf16 v[100:103], a[168:171], a[124:127], v[100:103]
  ds_read_b64_tr_b16 a[162:163], v200 offset:4608
  buffer_load_dwordx4 v203, s[8:11], s44 offen lds
  s_waitcnt lgkmcnt(4)
  v_mfma_f32_16x16x32_bf16 v[104:107], a[172:175], a[120:123], v[104:107]
  ds_read_b64_tr_b16 a[164:165], v201 offset:4096
  v_mfma_f32_16x16x32_bf16 v[108:111], a[172:175], a[124:127], v[108:111]
  ds_read_b64_tr_b16 a[166:167], v201 offset:4608
  v_mfma_f32_16x16x32_bf16 v[112:115], a[144:147], a[120:123], v[112:115]
  ds_read_b64_tr_b16 a[168:169], v198 offset:16384
  v_mfma_f32_16x16x32_bf16 v[116:119], a[144:147], a[124:127], v[116:119]
  ds_read_b64_tr_b16 a[170:171], v198 offset:16896
  v_mfma_f32_16x16x32_bf16 v[120:123], a[148:151], a[120:123], v[120:123]
  ds_read_b64_tr_b16 a[172:173], v199 offset:16384
  v_mfma_f32_16x16x32_bf16 v[124:127], a[148:151], a[124:127], v[124:127]
  ds_read_b64_tr_b16 a[174:175], v199 offset:16896
  v_mfma_f32_16x16x32_bf16 v[64:67], a[152:155], a[128:131], v[64:67]
  ds_read_b64_tr_b16 a[144:145], v200 offset:16384
  buffer_load_dwordx4 v204, s[8:11], s44 offen offset:1024 lds
  v_mfma_f32_16x16x32_bf16 v[68:71], a[152:155], a[132:135], v[68:71]
  ds_read_b64_tr_b16 a[146:147], v200 offset:16896
  s_waitcnt lgkmcnt(4)
  v_mfma_f32_16x16x32_bf16 v[72:75], a[156:159], a[128:131], v[72:75]
  ds_read_b64_tr_b16 a[148:149], v201 offset:16384
  v_mfma_f32_16x16x32_bf16 v[76:79], a[156:159], a[132:135], v[76:79]
  ds_read_b64_tr_b16 a[150:151], v201 offset:16896
  v_mfma_f32_16x16x32_bf16 v[80:83], a[160:163], a[128:131], v[80:83]
  ds_read_b64_tr_b16 a[152:153], v198 offset:8192
  v_mfma_f32_16x16x32_bf16 v[84:87], a[160:163], a[132:135], v[84:87]
  ds_read_b64_tr_b16 a[154:155], v198 offset:8704
  v_mfma_f32_16x16x32_bf16 v[88:91], a[164:167], a[128:131], v[88:91]
  ds_read_b64_tr_b16 a[156:157], v199 offset:8192
  buffer_load_dwordx4 v205, s[8:11], s44 offen offset:2048 lds
  buffer_load_dwordx4 v206, s[8:11], s44 offen offset:3072 lds
  s_add_u32 m0, s46, 4096
  s_nop 0
  buffer_load_dwordx4 v207, s[8:11], s44 offen lds
  buffer_load_dwordx4 v208, s[8:11], s44 offen offset:1024 lds
  v_mfma_f32_16x16x32_bf16 v[92:95], a[164:167], a[132:135], v[92:95]
  ds_read_b64_tr_b16 a[158:159], v199 offset:8704
  s_add_u32 s44, s44, 884736
  s_add_u32 m0, s46, 24576
  v_mfma_f32_16x16x32_bf16 v[96:99], a[168:171], a[128:131], v[96:99]
  ds_read_b64_tr_b16 a[160:161], v200 offset:8192
  v_mfma_f32_16x16x32_bf16 v[100:103], a[168:171], a[132:135], v[100:103]
  ds_read_b64_tr_b16 a[162:163], v200 offset:8704
  s_waitcnt lgkmcnt(4)
  v_mfma_f32_16x16x32_bf16 v[104:107], a[172:175], a[128:131], v[104:107]
  ds_read_b64_tr_b16 a[164:165], v201 offset:8192
  v_mfma_f32_16x16x32_bf16 v[108:111], a[172:175], a[132:135], v[108:111]
  ds_read_b64_tr_b16 a[166:167], v201 offset:8704
  v_mfma_f32_16x16x32_bf16 v[112:115], a[144:147], a[128:131], v[112:115]
  ds_read_b64_tr_b16 a[168:169], v198 offset:20480
  v_mfma_f32_16x16x32_bf16 v[116:119], a[144:147], a[132:135], v[116:119]
  ds_read_b64_tr_b16 a[170:171], v198 offset:20992
  v_mfma_f32_16x16x32_bf16 v[120:123], a[148:151], a[128:131], v[120:123]
  ds_read_b64_tr_b16 a[172:173], v199 offset:20480
  buffer_load_dwordx4 v203, s[8:11], s44 offen lds
  v_mfma_f32_16x16x32_bf16 v[124:127], a[148:151], a[132:135], v[124:127]
  ds_read_b64_tr_b16 a[174:175], v199 offset:20992
  v_mfma_f32_16x16x32_bf16 v[64:67], a[152:155], a[136:139], v[64:67]
  ds_read_b64_tr_b16 a[144:145], v200 offset:20480
  v_mfma_f32_16x16x32_bf16 v[68:71], a[152:155], a[140:143], v[68:71]
  ds_read_b64_tr_b16 a[146:147], v200 offset:20992
  s_waitcnt lgkmcnt(4)
  v_mfma_f32_16x16x32_bf16 v[72:75], a[156:159], a[136:139], v[72:75]
  ds_read_b64_tr_b16 a[148:149], v201 offset:20480
  s_waitcnt vmcnt(13)
  v_mfma_f32_16x16x32_bf16 v[76:79], a[156:159], a[140:143], v[76:79]
  ds_read_b64_tr_b16 a[150:151], v201 offset:20992
  s_barrier
  v_mfma_f32_16x16x32_bf16 v[80:83], a[160:163], a[136:139], v[80:83]
  ds_read_b64_tr_b16 a[152:153], v198 offset:24576
  s_lshl_b32 s49, s42, 4
  s_sub_u32 s50, s41, 256
  v_add_u32 v248, s49, v225
  v_lshlrev_b32 v250, 4, v225
  buffer_load_dwordx4 v204, s[8:11], s44 offen offset:1024 lds
  buffer_load_dwordx4 v205, s[8:11], s44 offen offset:2048 lds
  buffer_load_dwordx4 v206, s[8:11], s44 offen offset:3072 lds
  s_add_u32 m0, s46, 28672
  s_nop 0
  buffer_load_dwordx4 v207, s[8:11], s44 offen lds
  buffer_load_dwordx4 v208, s[8:11], s44 offen offset:1024 lds
  v_mfma_f32_16x16x32_bf16 v[84:87], a[160:163], a[140:143], v[84:87]
  ds_read_b64_tr_b16 a[154:155], v198 offset:25088
  v_add_u32 v250, s50, v250
  v_cmp_gt_u32 vcc, 16, v225
  v_mfma_f32_16x16x32_bf16 v[88:91], a[164:167], a[136:139], v[88:91]
  ds_read_b64_tr_b16 a[156:157], v199 offset:24576
  v_cndmask_b32 v248, v250, v248, vcc
  v_mfma_f32_16x16x32_bf16 v[92:95], a[164:167], a[140:143], v[92:95]
  ds_read_b64_tr_b16 a[158:159], v199 offset:25088
  v_mov_b32 v250, 0x7ffffff0
  v_mfma_f32_16x16x32_bf16 v[96:99], a[168:171], a[136:139], v[96:99]
  ds_read_b64_tr_b16 a[160:161], v200 offset:24576
  v_cmp_gt_u32 vcc, 32, v225
  v_mfma_f32_16x16x32_bf16 v[100:103], a[168:171], a[140:143], v[100:103]
  ds_read_b64_tr_b16 a[162:163], v200 offset:25088
  v_cndmask_b32 v248, v250, v248, vcc
  s_waitcnt lgkmcnt(4)
  v_mfma_f32_16x16x32_bf16 v[104:107], a[172:175], a[136:139], v[104:107]
  ds_read_b64_tr_b16 a[164:165], v201 offset:24576
  buffer_load_ubyte v249, v248, s[32:35], 0 offen sc1
  v_mfma_f32_16x16x32_bf16 v[108:111], a[172:175], a[140:143], v[108:111]
  ds_read_b64_tr_b16 a[166:167], v201 offset:25088
  s_add_u32 s44, s44, 884736
  v_mfma_f32_16x16x32_bf16 v[112:115], a[144:147], a[136:139], v[112:115]
  ds_read_b64_tr_b16 a[168:169], v198 offset:36864
  s_add_u32 m0, s46, 49152
  v_mfma_f32_16x16x32_bf16 v[116:119], a[144:147], a[140:143], v[116:119]
  ds_read_b64_tr_b16 a[170:171], v198 offset:37376
  v_mfma_f32_16x16x32_bf16 v[120:123], a[148:151], a[136:139], v[120:123]
  ds_read_b64_tr_b16 a[172:173], v199 offset:36864
  v_mfma_f32_16x16x32_bf16 v[124:127], a[148:151], a[140:143], v[124:127]
  ds_read_b64_tr_b16 a[174:175], v199 offset:37376
  buffer_load_dwordx4 v203, s[8:11], s44 offen lds
  v_mfma_f32_16x16x32_bf16 v[0:3], a[152:155], a[0:3], 0
  ds_read_b64_tr_b16 a[144:145], v200 offset:36864
  v_mfma_f32_16x16x32_bf16 v[4:7], a[152:155], a[4:7], 0
  ds_read_b64_tr_b16 a[146:147], v200 offset:37376
  s_waitcnt lgkmcnt(4)
  v_mfma_f32_16x16x32_bf16 v[8:11], a[156:159], a[0:3], 0
  ds_read_b64_tr_b16 a[148:149], v201 offset:36864
  v_mfma_f32_16x16x32_bf16 v[12:15], a[156:159], a[4:7], 0
  ds_read_b64_tr_b16 a[150:151], v201 offset:37376
  v_max_f32 v64, 0, v64
  v_mfma_f32_16x16x32_bf16 v[16:19], a[160:163], a[0:3], 0
  ds_read_b64_tr_b16 a[152:153], v198 offset:28672
  v_mul_f32 v96, v215, v96
  v_max_f32 v65, 0, v65
  v_mfma_f32_16x16x32_bf16 v[20:23], a[160:163], a[4:7], 0
  ds_read_b64_tr_b16 a[154:155], v198 offset:29184
  v_mul_f32 v97, v215, v97
  v_mfma_f32_16x16x32_bf16 v[24:27], a[164:167], a[0:3], 0
  ds_read_b64_tr_b16 a[156:157], v199 offset:28672
  buffer_load_dwordx4 v204, s[8:11], s44 offen offset:1024 lds
  v_mfma_f32_16x16x32_bf16 v[28:31], a[164:167], a[4:7], 0
  ds_read_b64_tr_b16 a[158:159], v199 offset:29184
  v_max_f32 v66, 0, v66
  v_mfma_f32_16x16x32_bf16 v[32:35], a[168:171], a[0:3], 0
  ds_read_b64_tr_b16 a[160:161], v200 offset:28672
  v_mul_f32 v98, v215, v98
  v_max_f32 v67, 0, v67
  v_mfma_f32_16x16x32_bf16 v[36:39], a[168:171], a[4:7], 0
  ds_read_b64_tr_b16 a[162:163], v200 offset:29184
  s_waitcnt lgkmcnt(4)
  v_mfma_f32_16x16x32_bf16 v[40:43], a[172:175], a[0:3], 0
  ds_read_b64_tr_b16 a[164:165], v201 offset:28672
  v_mul_f32 v99, v215, v99
  v_mfma_f32_16x16x32_bf16 v[44:47], a[172:175], a[4:7], 0
  ds_read_b64_tr_b16 a[166:167], v201 offset:29184
  v_mul_f32 v64, v64, v96
  v_mfma_f32_16x16x32_bf16 v[48:51], a[144:147], a[0:3], 0
  ds_read_b64_tr_b16 a[168:169], v198 offset:40960
  v_mul_f32 v65, v65, v97
  v_mul_f32 v66, v66, v98
  v_mfma_f32_16x16x32_bf16 v[52:55], a[144:147], a[4:7], 0
  ds_read_b64_tr_b16 a[170:171], v198 offset:41472
  buffer_load_dwordx4 v205, s[8:11], s44 offen offset:2048 lds
  v_mfma_f32_16x16x32_bf16 v[56:59], a[148:151], a[0:3], 0
  ds_read_b64_tr_b16 a[172:173], v199 offset:40960
  v_mul_f32 v67, v67, v99
  v_mfma_f32_16x16x32_bf16 v[60:63], a[148:151], a[4:7], 0
  ds_read_b64_tr_b16 a[174:175], v199 offset:41472
  v_max_f32 v72, 0, v72
  v_mfma_f32_16x16x32_bf16 v[0:3], a[152:155], a[8:11], v[0:3]
  ds_read_b64_tr_b16 a[144:145], v200 offset:40960
  v_mul_f32 v104, v215, v104
  v_max_f32 v73, 0, v73
  v_mfma_f32_16x16x32_bf16 v[4:7], a[152:155], a[12:15], v[4:7]
  ds_read_b64_tr_b16 a[146:147], v200 offset:41472
  s_waitcnt lgkmcnt(4)
  v_mfma_f32_16x16x32_bf16 v[8:11], a[156:159], a[8:11], v[8:11]
  ds_read_b64_tr_b16 a[148:149], v201 offset:40960
  v_mul_f32 v105, v215, v105
  v_mfma_f32_16x16x32_bf16 v[12:15], a[156:159], a[12:15], v[12:15]
  ds_read_b64_tr_b16 a[150:151], v201 offset:41472
  v_max_f32 v74, 0, v74
  v_mul_f32 v106, v215, v106
  v_mfma_f32_16x16x32_bf16 v[16:19], a[160:163], a[8:11], v[16:19]
  ds_read_b64_tr_b16 a[152:153], v198 offset:32768
  buffer_load_dwordx4 v206, s[8:11], s44 offen offset:3072 lds
  v_mfma_f32_16x16x32_bf16 v[20:23], a[160:163], a[12:15], v[20:23]
  ds_read_b64_tr_b16 a[154:155], v198 offset:33280
  s_add_u32 m0, s46, 53248
  v_mfma_f32_16x16x32_bf16 v[24:27], a[164:167], a[8:11], v[24:27]
  ds_read_b64_tr_b16 a[156:157], v199 offset:32768
  v_accvgpr_read_b32 v254, a254
  v_mfma_f32_16x16x32_bf16 v[28:31], a[164:167], a[12:15], v[28:31]
  ds_read_b64_tr_b16 a[158:159], v199 offset:33280
  s_lshl_b32 s73, s41, 2
  s_add_u32 s73, s73, s40
  v_mfma_f32_16x16x32_bf16 v[32:35], a[168:171], a[8:11], v[32:35]
  ds_read_b64_tr_b16 a[160:161], v200 offset:32768
  s_mul_i32 s73, s73, 5248
  v_mfma_f32_16x16x32_bf16 v[36:39], a[168:171], a[12:15], v[36:39]
  ds_read_b64_tr_b16 a[162:163], v200 offset:33280
  s_waitcnt lgkmcnt(4)
  v_mfma_f32_16x16x32_bf16 v[40:43], a[172:175], a[8:11], v[40:43]
  ds_read_b64_tr_b16 a[164:165], v201 offset:32768
  s_mul_i32 s76, s42, 331776
  v_mfma_f32_16x16x32_bf16 v[44:47], a[172:175], a[12:15], v[44:47]
  ds_read_b64_tr_b16 a[166:167], v201 offset:33280
  buffer_load_dwordx4 v207, s[8:11], s44 offen lds
  s_add_u32 s73, s73, s76
  v_mfma_f32_16x16x32_bf16 v[48:51], a[144:147], a[8:11], v[48:51]
  ds_read_b64_tr_b16 a[168:169], v198 offset:45056
  v_max_f32 v75, 0, v75
  v_mfma_f32_16x16x32_bf16 v[52:55], a[144:147], a[12:15], v[52:55]
  ds_read_b64_tr_b16 a[170:171], v198 offset:45568
  v_mul_f32 v107, v215, v107
  v_mfma_f32_16x16x32_bf16 v[56:59], a[148:151], a[8:11], v[56:59]
  ds_read_b64_tr_b16 a[172:173], v199 offset:45056
  v_mul_f32 v72, v72, v104
  v_mfma_f32_16x16x32_bf16 v[60:63], a[148:151], a[12:15], v[60:63]
  ds_read_b64_tr_b16 a[174:175], v199 offset:45568
  v_mul_f32 v73, v73, v105
  v_mul_f32 v74, v74, v106
  buffer_load_dwordx4 v208, s[8:11], s44 offen offset:1024 lds
  v_mfma_f32_16x16x32_bf16 v[0:3], a[152:155], a[16:19], v[0:3]
  ds_read_b64_tr_b16 a[144:145], v200 offset:45056
  v_mul_f32 v75, v75, v107
  v_mfma_f32_16x16x32_bf16 v[4:7], a[152:155], a[20:23], v[4:7]
  ds_read_b64_tr_b16 a[146:147], v200 offset:45568
  s_waitcnt lgkmcnt(4)
  v_mfma_f32_16x16x32_bf16 v[8:11], a[156:159], a[16:19], v[8:11]
  ds_read_b64_tr_b16 a[148:149], v201 offset:45056
  s_waitcnt vmcnt(19)
  v_mfma_f32_16x16x32_bf16 v[12:15], a[156:159], a[20:23], v[12:15]
  ds_read_b64_tr_b16 a[150:151], v201 offset:45568
  v_cvt_pk_bf16_f32 v96, v64, v65
  s_barrier
  v_mfma_f32_16x16x32_bf16 v[16:19], a[160:163], a[16:19], v[16:19]
  ds_read_b64_tr_b16 a[152:153], v194 offset:24576
  v_cvt_pk_bf16_f32 v97, v66, v67
  v_mfma_f32_16x16x32_bf16 v[20:23], a[160:163], a[20:23], v[20:23]
  ds_read_b64_tr_b16 a[154:155], v194 offset:25088
  buffer_load_dword a248, v254, s[12:15], s73 offen sc1
  v_mfma_f32_16x16x32_bf16 v[24:27], a[164:167], a[16:19], v[24:27]
  ds_read_b64_tr_b16 a[156:157], v195 offset:24576
  v_accvgpr_read_b32 v254, a255
  s_mul_i32 s73, s70, 20736
  v_mfma_f32_16x16x32_bf16 v[28:31], a[164:167], a[20:23], v[28:31]
  ds_read_b64_tr_b16 a[158:159], v195 offset:25088
  s_lshl_b32 s76, s43, 1
  v_mfma_f32_16x16x32_bf16 v[32:35], a[168:171], a[16:19], v[32:35]
  ds_read_b64_tr_b16 a[160:161], v196 offset:24576
  s_add_u32 s73, s73, s76
  v_mfma_f32_16x16x32_bf16 v[36:39], a[168:171], a[20:23], v[36:39]
  ds_read_b64_tr_b16 a[162:163], v196 offset:25088
  s_waitcnt lgkmcnt(4)
  v_mfma_f32_16x16x32_bf16 v[40:43], a[172:175], a[16:19], v[40:43]
  ds_read_b64_tr_b16 a[164:165], v197 offset:24576
  buffer_load_dword a251, v254, s[20:23], s73 offen sc1
  v_cvt_pk_bf16_f32 v98, v72, v73
  v_mfma_f32_16x16x32_bf16 v[44:47], a[172:175], a[20:23], v[44:47]
  ds_read_b64_tr_b16 a[166:167], v197 offset:25088
  v_cvt_pk_bf16_f32 v99, v74, v75
  v_mfma_f32_16x16x32_bf16 v[48:51], a[144:147], a[16:19], v[48:51]
  ds_read_b64_tr_b16 a[168:169], v194 offset:36864
  v_accvgpr_write_b32 a176, v96
  v_mfma_f32_16x16x32_bf16 v[52:55], a[144:147], a[20:23], v[52:55]
  ds_read_b64_tr_b16 a[170:171], v194 offset:37376
  v_accvgpr_write_b32 a177, v97
  v_mfma_f32_16x16x32_bf16 v[56:59], a[148:151], a[16:19], v[56:59]
  ds_read_b64_tr_b16 a[172:173], v195 offset:36864
  v_accvgpr_write_b32 a178, v98
  v_accvgpr_write_b32 a179, v99
  v_mfma_f32_16x16x32_bf16 v[60:63], a[148:151], a[20:23], v[60:63]
  ds_read_b64_tr_b16 a[174:175], v195 offset:37376
  s_add_u32 s63, s61, 0
  buffer_store_dwordx4 v[96:99], v226, s[24:27], s63 offen sc1
  v_mfma_f32_16x16x32_bf16 v[0:3], a[152:155], a[24:27], v[0:3]
  ds_read_b64_tr_b16 a[144:145], v196 offset:36864
  v_max_f32 v68, 0, v68
  v_mfma_f32_16x16x32_bf16 v[4:7], a[152:155], a[28:31], v[4:7]
  ds_read_b64_tr_b16 a[146:147], v196 offset:37376
  s_waitcnt lgkmcnt(4)
  v_mfma_f32_16x16x32_bf16 v[8:11], a[156:159], a[24:27], v[8:11]
  ds_read_b64_tr_b16 a[148:149], v197 offset:36864
  v_mul_f32 v100, v216, v100
  v_max_f32 v69, 0, v69
  v_mfma_f32_16x16x32_bf16 v[12:15], a[156:159], a[28:31], v[12:15]
  ds_read_b64_tr_b16 a[150:151], v197 offset:37376
  v_mul_f32 v101, v216, v101
  v_mfma_f32_16x16x32_bf16 v[16:19], a[160:163], a[24:27], v[16:19]
  ds_read_b64_tr_b16 a[152:153], v194 offset:28672
  v_max_f32 v70, 0, v70
  v_mfma_f32_16x16x32_bf16 v[20:23], a[160:163], a[28:31], v[20:23]
  ds_read_b64_tr_b16 a[154:155], v194 offset:29184
  v_mul_f32 v102, v216, v102
  v_mfma_f32_16x16x32_bf16 v[24:27], a[164:167], a[24:27], v[24:27]
  ds_read_b64_tr_b16 a[156:157], v195 offset:28672
  v_max_f32 v71, 0, v71
  v_mul_f32 v103, v216, v103
  v_mfma_f32_16x16x32_bf16 v[28:31], a[164:167], a[28:31], v[28:31]
  ds_read_b64_tr_b16 a[158:159], v195 offset:29184
  v_mul_f32 v68, v68, v100
  v_mfma_f32_16x16x32_bf16 v[32:35], a[168:171], a[24:27], v[32:35]
  ds_read_b64_tr_b16 a[160:161], v196 offset:28672
  v_mul_f32 v69, v69, v101
  v_mfma_f32_16x16x32_bf16 v[36:39], a[168:171], a[28:31], v[36:39]
  ds_read_b64_tr_b16 a[162:163], v196 offset:29184
  v_mul_f32 v70, v70, v102
  s_waitcnt lgkmcnt(4)
  v_mfma_f32_16x16x32_bf16 v[40:43], a[172:175], a[24:27], v[40:43]
  ds_read_b64_tr_b16 a[164:165], v197 offset:28672
  v_mul_f32 v71, v71, v103
  v_mfma_f32_16x16x32_bf16 v[44:47], a[172:175], a[28:31], v[44:47]
  ds_read_b64_tr_b16 a[166:167], v197 offset:29184
  v_max_f32 v76, 0, v76
  v_mfma_f32_16x16x32_bf16 v[48:51], a[144:147], a[24:27], v[48:51]
  ds_read_b64_tr_b16 a[168:169], v194 offset:40960
  v_mul_f32 v108, v216, v108
  v_mfma_f32_16x16x32_bf16 v[52:55], a[144:147], a[28:31], v[52:55]
  ds_read_b64_tr_b16 a[170:171], v194 offset:41472
  v_max_f32 v77, 0, v77
  v_mul_f32 v109, v216, v109
  v_mfma_f32_16x16x32_bf16 v[56:59], a[148:151], a[24:27], v[56:59]
  ds_read_b64_tr_b16 a[172:173], v195 offset:40960
  v_max_f32 v78, 0, v78
  v_mfma_f32_16x16x32_bf16 v[60:63], a[148:151], a[28:31], v[60:63]
  ds_read_b64_tr_b16 a[174:175], v195 offset:41472
  v_mul_f32 v110, v216, v110
  v_mfma_f32_16x16x32_bf16 v[0:3], a[152:155], a[32:35], v[0:3]
  ds_read_b64_tr_b16 a[144:145], v196 offset:40960
  v_max_f32 v79, 0, v79
  v_mfma_f32_16x16x32_bf16 v[4:7], a[152:155], a[36:39], v[4:7]
  ds_read_b64_tr_b16 a[146:147], v196 offset:41472
  v_mul_f32 v111, v216, v111
  s_waitcnt lgkmcnt(4)
  v_mfma_f32_16x16x32_bf16 v[8:11], a[156:159], a[32:35], v[8:11]
  ds_read_b64_tr_b16 a[148:149], v197 offset:40960
  v_mul_f32 v76, v76, v108
  v_mfma_f32_16x16x32_bf16 v[12:15], a[156:159], a[36:39], v[12:15]
  ds_read_b64_tr_b16 a[150:151], v197 offset:41472
  v_mul_f32 v77, v77, v109
  v_mfma_f32_16x16x32_bf16 v[16:19], a[160:163], a[32:35], v[16:19]
  ds_read_b64_tr_b16 a[152:153], v194 offset:32768
  v_mul_f32 v78, v78, v110
  v_mfma_f32_16x16x32_bf16 v[20:23], a[160:163], a[36:39], v[20:23]
  ds_read_b64_tr_b16 a[154:155], v194 offset:33280
  v_mul_f32 v79, v79, v111
  v_cvt_pk_bf16_f32 v100, v68, v69
  v_mfma_f32_16x16x32_bf16 v[24:27], a[164:167], a[32:35], v[24:27]
  ds_read_b64_tr_b16 a[156:157], v195 offset:32768
  v_cvt_pk_bf16_f32 v101, v70, v71
  v_mfma_f32_16x16x32_bf16 v[28:31], a[164:167], a[36:39], v[28:31]
  ds_read_b64_tr_b16 a[158:159], v195 offset:33280
  v_cvt_pk_bf16_f32 v102, v76, v77
  v_mfma_f32_16x16x32_bf16 v[32:35], a[168:171], a[32:35], v[32:35]
  ds_read_b64_tr_b16 a[160:161], v196 offset:32768
  v_cvt_pk_bf16_f32 v103, v78, v79
  v_mfma_f32_16x16x32_bf16 v[36:39], a[168:171], a[36:39], v[36:39]
  ds_read_b64_tr_b16 a[162:163], v196 offset:33280
  v_accvgpr_write_b32 a180, v100
  s_waitcnt lgkmcnt(4)
  v_mfma_f32_16x16x32_bf16 v[40:43], a[172:175], a[32:35], v[40:43]
  ds_read_b64_tr_b16 a[164:165], v197 offset:32768
  v_accvgpr_write_b32 a181, v101
  v_mfma_f32_16x16x32_bf16 v[44:47], a[172:175], a[36:39], v[44:47]
  ds_read_b64_tr_b16 a[166:167], v197 offset:33280
  v_accvgpr_write_b32 a182, v102
  v_mfma_f32_16x16x32_bf16 v[48:51], a[144:147], a[32:35], v[48:51]
  ds_read_b64_tr_b16 a[168:169], v194 offset:45056
  v_accvgpr_write_b32 a183, v103
  s_add_u32 s63, s61, 0
  buffer_store_dwordx4 v[100:103], v226, s[24:27], s63 offen offset:1024 sc1
  v_mfma_f32_16x16x32_bf16 v[52:55], a[144:147], a[36:39], v[52:55]
  ds_read_b64_tr_b16 a[170:171], v194 offset:45568
  v_max_f32 v80, 0, v80
  v_mfma_f32_16x16x32_bf16 v[56:59], a[148:151], a[32:35], v[56:59]
  ds_read_b64_tr_b16 a[172:173], v195 offset:45056
  v_mul_f32 v112, v215, v112
  v_mfma_f32_16x16x32_bf16 v[60:63], a[148:151], a[36:39], v[60:63]
  ds_read_b64_tr_b16 a[174:175], v195 offset:45568
  v_max_f32 v81, 0, v81
  v_mfma_f32_16x16x32_bf16 v[0:3], a[152:155], a[40:43], v[0:3]
  ds_read_b64_tr_b16 a[144:145], v196 offset:45056
  v_mul_f32 v113, v215, v113
  v_max_f32 v82, 0, v82
  v_mfma_f32_16x16x32_bf16 v[4:7], a[152:155], a[44:47], v[4:7]
  ds_read_b64_tr_b16 a[146:147], v196 offset:45568
  s_waitcnt lgkmcnt(4)
  v_mfma_f32_16x16x32_bf16 v[8:11], a[156:159], a[40:43], v[8:11]
  ds_read_b64_tr_b16 a[148:149], v197 offset:45056
  s_waitcnt vmcnt(17)
  v_mfma_f32_16x16x32_bf16 v[12:15], a[156:159], a[44:47], v[12:15]
  ds_read_b64_tr_b16 a[150:151], v197 offset:45568
  s_barrier
  v_mfma_f32_16x16x32_bf16 v[16:19], a[160:163], a[40:43], v[16:19]
  ds_read_b64_tr_b16 a[152:153], v190
  s_waitcnt vmcnt(10)
  v_cmp_ne_u32 vcc, 0, v249
  s_nop 3
  s_or_b32 vcc_hi, vcc_hi, -1
  s_cmp_eq_u64 vcc, -1
  s_cbranch_scc0 L_slow_C0
L_back_C0:
  v_mfma_f32_16x16x32_bf16 v[20:23], a[160:163], a[44:47], v[20:23]
  ds_read_b64_tr_b16 a[154:155], v190 offset:512
  s_lshl_b32 s49, s42, 11
  s_add_u32 s49, s49, 46243840
  v_mfma_f32_16x16x32_bf16 v[24:27], a[164:167], a[40:43], v[24:27]
  ds_read_b64_tr_b16 a[156:157], v191
  v_lshlrev_b32 v248, 7, v225
  v_mfma_f32_16x16x32_bf16 v[28:31], a[164:167], a[44:47], v[28:31]
  ds_read_b64_tr_b16 a[158:159], v191 offset:512
  v_add_u32 v248, s49, v248
  v_mfma_f32_16x16x32_bf16 v[32:35], a[168:171], a[40:43], v[32:35]
  ds_read_b64_tr_b16 a[160:161], v192
  v_cmp_gt_u32 vcc, 16, v225
  v_mov_b32 v250, 0x7ffffff0
  v_mfma_f32_16x16x32_bf16 v[36:39], a[168:171], a[44:47], v[36:39]
  ds_read_b64_tr_b16 a[162:163], v192 offset:512
  s_waitcnt lgkmcnt(4)
  v_mfma_f32_16x16x32_bf16 v[40:43], a[172:175], a[40:43], v[40:43]
  ds_read_b64_tr_b16 a[164:165], v193
  v_cndmask_b32 v248, v250, v248, vcc
  v_mfma_f32_16x16x32_bf16 v[44:47], a[172:175], a[44:47], v[44:47]
  ds_read_b64_tr_b16 a[166:167], v193 offset:512
  buffer_load_dword v249, v248, s[24:27], 0 offen sc1
  v_mfma_f32_16x16x32_bf16 v[48:51], a[144:147], a[40:43], v[48:51]
  ds_read_b64_tr_b16 a[168:169], v190 offset:12288
  v_mul_f32 v114, v215, v114
  v_max_f32 v83, 0, v83
  v_mfma_f32_16x16x32_bf16 v[52:55], a[144:147], a[44:47], v[52:55]
  ds_read_b64_tr_b16 a[170:171], v190 offset:12800
  v_mul_f32 v115, v215, v115
  v_mfma_f32_16x16x32_bf16 v[56:59], a[148:151], a[40:43], v[56:59]
  ds_read_b64_tr_b16 a[172:173], v191 offset:12288
  v_mul_f32 v80, v80, v112
  v_mfma_f32_16x16x32_bf16 v[60:63], a[148:151], a[44:47], v[60:63]
  ds_read_b64_tr_b16 a[174:175], v191 offset:12800
  v_mul_f32 v81, v81, v113
  v_mfma_f32_16x16x32_bf16 v[0:3], a[152:155], a[48:51], v[0:3]
  ds_read_b64_tr_b16 a[144:145], v192 offset:12288
  v_mul_f32 v82, v82, v114
  v_mul_f32 v83, v83, v115
  v_mfma_f32_16x16x32_bf16 v[4:7], a[152:155], a[52:55], v[4:7]
  ds_read_b64_tr_b16 a[146:147], v192 offset:12800
  s_waitcnt lgkmcnt(4)
  v_mfma_f32_16x16x32_bf16 v[8:11], a[156:159], a[48:51], v[8:11]
  ds_read_b64_tr_b16 a[148:149], v193 offset:12288
  v_max_f32 v88, 0, v88
  v_mfma_f32_16x16x32_bf16 v[12:15], a[156:159], a[52:55], v[12:15]
  ds_read_b64_tr_b16 a[150:151], v193 offset:12800
  v_mul_f32 v120, v215, v120
  v_max_f32 v89, 0, v89
  v_mfma_f32_16x16x32_bf16 v[16:19], a[160:163], a[48:51], v[16:19]
  ds_read_b64_tr_b16 a[152:153], v190 offset:4096
  v_mul_f32 v121, v215, v121
  v_mfma_f32_16x16x32_bf16 v[20:23], a[160:163], a[52:55], v[20:23]
  ds_read_b64_tr_b16 a[154:155], v190 offset:4608
  v_max_f32 v90, 0, v90
  v_mfma_f32_16x16x32_bf16 v[24:27], a[164:167], a[48:51], v[24:27]
  ds_read_b64_tr_b16 a[156:157], v191 offset:4096
  v_mul_f32 v122, v215, v122
  v_mfma_f32_16x16x32_bf16 v[28:31], a[164:167], a[52:55], v[28:31]
  ds_read_b64_tr_b16 a[158:159], v191 offset:4608
  v_max_f32 v91, 0, v91
  v_mul_f32 v123, v215, v123
  v_mfma_f32_16x16x32_bf16 v[32:35], a[168:171], a[48:51], v[32:35]
  ds_read_b64_tr_b16 a[160:161], v192 offset:4096
  v_mul_f32 v88, v88, v120
  v_mfma_f32_16x16x32_bf16 v[36:39], a[168:171], a[52:55], v[36:39]
  ds_read_b64_tr_b16 a[162:163], v192 offset:4608
  s_waitcnt lgkmcnt(4)
  v_mfma_f32_16x16x32_bf16 v[40:43], a[172:175], a[48:51], v[40:43]
  ds_read_b64_tr_b16 a[164:165], v193 offset:4096
  v_mul_f32 v89, v89, v121
  v_mfma_f32_16x16x32_bf16 v[44:47], a[172:175], a[52:55], v[44:47]
  ds_read_b64_tr_b16 a[166:167], v193 offset:4608
  v_mul_f32 v90, v90, v122
  v_mul_f32 v91, v91, v123
  v_mfma_f32_16x16x32_bf16 v[48:51], a[144:147], a[48:51], v[48:51]
  ds_read_b64_tr_b16 a[168:169], v190 offset:16384
  v_cvt_pk_bf16_f32 v112, v80, v81
  v_mfma_f32_16x16x32_bf16 v[52:55], a[144:147], a[52:55], v[52:55]
  ds_read_b64_tr_b16 a[170:171], v190 offset:16896
  v_cvt_pk_bf16_f32 v113, v82, v83
  v_mfma_f32_16x16x32_bf16 v[56:59], a[148:151], a[48:51], v[56:59]
  ds_read_b64_tr_b16 a[172:173], v191 offset:16384
  v_cvt_pk_bf16_f32 v114, v88, v89
  v_mfma_f32_16x16x32_bf16 v[60:63], a[148:151], a[52:55], v[60:63]
  ds_read_b64_tr_b16 a[174:175], v191 offset:16896
  v_cvt_pk_bf16_f32 v115, v90, v91
  v_accvgpr_write_b32 a184, v112
  v_mfma_f32_16x16x32_bf16 v[0:3], a[152:155], a[56:59], v[0:3]
  ds_read_b64_tr_b16 a[144:145], v192 offset:16384
  v_accvgpr_write_b32 a185, v113
  v_mfma_f32_16x16x32_bf16 v[4:7], a[152:155], a[60:63], v[4:7]
  ds_read_b64_tr_b16 a[146:147], v192 offset:16896
  s_waitcnt lgkmcnt(4)
  v_mfma_f32_16x16x32_bf16 v[8:11], a[156:159], a[56:59], v[8:11]
  ds_read_b64_tr_b16 a[148:149], v193 offset:16384
  v_accvgpr_write_b32 a186, v114
  v_mfma_f32_16x16x32_bf16 v[12:15], a[156:159], a[60:63], v[12:15]
  ds_read_b64_tr_b16 a[150:151], v193 offset:16896
  v_accvgpr_write_b32 a187, v115
  s_add_u32 s63, s61, 0
  buffer_store_dwordx4 v[112:115], v226, s[24:27], s63 offen offset:2048 sc1
  v_mfma_f32_16x16x32_bf16 v[16:19], a[160:163], a[56:59], v[16:19]
  ds_read_b64_tr_b16 a[152:153], v190 offset:8192
  v_max_f32 v84, 0, v84
  v_mfma_f32_16x16x32_bf16 v[20:23], a[160:163], a[60:63], v[20:23]
  ds_read_b64_tr_b16 a[154:155], v190 offset:8704
  v_mul_f32 v116, v216, v116
  v_mfma_f32_16x16x32_bf16 v[24:27], a[164:167], a[56:59], v[24:27]
  ds_read_b64_tr_b16 a[156:157], v191 offset:8192
  v_max_f32 v85, 0, v85
  v_mfma_f32_16x16x32_bf16 v[28:31], a[164:167], a[60:63], v[28:31]
  ds_read_b64_tr_b16 a[158:159], v191 offset:8704
  v_mul_f32 v117, v216, v117
  v_max_f32 v86, 0, v86
  v_mfma_f32_16x16x32_bf16 v[32:35], a[168:171], a[56:59], v[32:35]
  ds_read_b64_tr_b16 a[160:161], v192 offset:8192
  v_mul_f32 v118, v216, v118
  v_mfma_f32_16x16x32_bf16 v[36:39], a[168:171], a[60:63], v[36:39]
  ds_read_b64_tr_b16 a[162:163], v192 offset:8704
  s_waitcnt lgkmcnt(4)
  v_mfma_f32_16x16x32_bf16 v[40:43], a[172:175], a[56:59], v[40:43]
  ds_read_b64_tr_b16 a[164:165], v193 offset:8192
  v_max_f32 v87, 0, v87
  v_mfma_f32_16x16x32_bf16 v[44:47], a[172:175], a[60:63], v[44:47]
  ds_read_b64_tr_b16 a[166:167], v193 offset:8704
  v_mul_f32 v119, v216, v119
  v_mul_f32 v84, v84, v116
  v_mfma_f32_16x16x32_bf16 v[48:51], a[144:147], a[56:59], v[48:51]
  ds_read_b64_tr_b16 a[168:169], v190 offset:20480
  v_mul_f32 v85, v85, v117
  v_mfma_f32_16x16x32_bf16 v[52:55], a[144:147], a[60:63], v[52:55]
  ds_read_b64_tr_b16 a[170:171], v190 offset:20992
  v_mul_f32 v86, v86, v118
  v_mfma_f32_16x16x32_bf16 v[56:59], a[148:151], a[56:59], v[56:59]
  ds_read_b64_tr_b16 a[172:173], v191 offset:20480
  v_mul_f32 v87, v87, v119
  v_mfma_f32_16x16x32_bf16 v[60:63], a[148:151], a[60:63], v[60:63]
  ds_read_b64_tr_b16 a[174:175], v191 offset:20992
  v_max_f32 v92, 0, v92
  v_mul_f32 v124, v216, v124
  v_mfma_f32_16x16x32_bf16 v[0:3], a[152:155], a[64:67], v[0:3]
  ds_read_b64_tr_b16 a[144:145], v192 offset:20480
  v_max_f32 v93, 0, v93
  v_mfma_f32_16x16x32_bf16 v[4:7], a[152:155], a[68:71], v[4:7]
  ds_read_b64_tr_b16 a[146:147], v192 offset:20992
  s_waitcnt lgkmcnt(4)
  v_mfma_f32_16x16x32_bf16 v[8:11], a[156:159], a[64:67], v[8:11]
  ds_read_b64_tr_b16 a[148:149], v193 offset:20480
  v_mfma_f32_16x16x32_bf16 v[12:15], a[156:159], a[68:71], v[12:15]
  ds_read_b64_tr_b16 a[150:151], v193 offset:20992
  v_mul_f32 v125, v216, v125
  s_barrier
  v_mfma_f32_16x16x32_bf16 v[16:19], a[160:163], a[64:67], v[16:19]
  ds_read_b64_tr_b16 a[152:153], v190 offset:24576
  v_max_f32 v94, 0, v94
  v_mfma_f32_16x16x32_bf16 v[20:23], a[160:163], a[68:71], v[20:23]
  ds_read_b64_tr_b16 a[154:155], v190 offset:25088
  v_mul_f32 v126, v216, v126
  v_mfma_f32_16x16x32_bf16 v[24:27], a[164:167], a[64:67], v[24:27]
  ds_read_b64_tr_b16 a[156:157], v191 offset:24576
  v_max_f32 v95, 0, v95
  v_mul_f32 v127, v216, v127
  v_mfma_f32_16x16x32_bf16 v[28:31], a[164:167], a[68:71], v[28:31]
  ds_read_b64_tr_b16 a[158:159], v191 offset:25088
  v_mul_f32 v92, v92, v124
  v_mfma_f32_16x16x32_bf16 v[32:35], a[168:171], a[64:67], v[32:35]
  ds_read_b64_tr_b16 a[160:161], v192 offset:24576
  v_mul_f32 v93, v93, v125
  v_mfma_f32_16x16x32_bf16 v[36:39], a[168:171], a[68:71], v[36:39]
  ds_read_b64_tr_b16 a[162:163], v192 offset:25088
  s_waitcnt lgkmcnt(4)
  v_mfma_f32_16x16x32_bf16 v[40:43], a[172:175], a[64:67], v[40:43]
  ds_read_b64_tr_b16 a[164:165], v193 offset:24576
  v_mul_f32 v94, v94, v126
  v_mul_f32 v95, v95, v127
  v_mfma_f32_16x16x32_bf16 v[44:47], a[172:175], a[68:71], v[44:47]
  ds_read_b64_tr_b16 a[166:167], v193 offset:25088
  v_cvt_pk_bf16_f32 v116, v84, v85
  v_mfma_f32_16x16x32_bf16 v[48:51], a[144:147], a[64:67], v[48:51]
  ds_read_b64_tr_b16 a[168:169], v190 offset:36864
  v_cvt_pk_bf16_f32 v117, v86, v87
  v_mfma_f32_16x16x32_bf16 v[52:55], a[144:147], a[68:71], v[52:55]
  ds_read_b64_tr_b16 a[170:171], v190 offset:37376
  v_cvt_pk_bf16_f32 v118, v92, v93
  v_mfma_f32_16x16x32_bf16 v[56:59], a[148:151], a[64:67], v[56:59]
  ds_read_b64_tr_b16 a[172:173], v191 offset:36864
  s_add_u32 s44, s44, 884736
  s_add_u32 m0, s46, 98304
  v_mfma_f32_16x16x32_bf16 v[60:63], a[148:151], a[68:71], v[60:63]
  ds_read_b64_tr_b16 a[174:175], v191 offset:37376
  buffer_load_dwordx4 v203, s[8:11], s44 offen lds
  v_mfma_f32_16x16x32_bf16 v[0:3], a[152:155], a[72:75], v[0:3]
  ds_read_b64_tr_b16 a[144:145], v192 offset:36864
  v_cvt_pk_bf16_f32 v119, v94, v95
  v_mfma_f32_16x16x32_bf16 v[4:7], a[152:155], a[76:79], v[4:7]
  ds_read_b64_tr_b16 a[146:147], v192 offset:37376
  s_waitcnt lgkmcnt(4)
  v_mfma_f32_16x16x32_bf16 v[8:11], a[156:159], a[72:75], v[8:11]
  ds_read_b64_tr_b16 a[148:149], v193 offset:36864
  v_accvgpr_write_b32 a188, v116
  v_accvgpr_write_b32 a189, v117
  v_mfma_f32_16x16x32_bf16 v[12:15], a[156:159], a[76:79], v[12:15]
  ds_read_b64_tr_b16 a[150:151], v193 offset:37376
  v_accvgpr_write_b32 a190, v118
  v_mfma_f32_16x16x32_bf16 v[16:19], a[160:163], a[72:75], v[16:19]
  ds_read_b64_tr_b16 a[152:153], v190 offset:28672
  v_accvgpr_write_b32 a191, v119
  v_mfma_f32_16x16x32_bf16 v[20:23], a[160:163], a[76:79], v[20:23]
  ds_read_b64_tr_b16 a[154:155], v190 offset:29184
  s_add_u32 s63, s61, 0
  buffer_store_dwordx4 v[116:119], v226, s[24:27], s63 offen offset:3072 sc1
  v_mfma_f32_16x16x32_bf16 v[24:27], a[164:167], a[72:75], v[24:27]
  ds_read_b64_tr_b16 a[156:157], v191 offset:28672
  v_mfma_f32_16x16x32_bf16 v[28:31], a[164:167], a[76:79], v[28:31]
  ds_read_b64_tr_b16 a[158:159], v191 offset:29184
  v_mfma_f32_16x16x32_bf16 v[32:35], a[168:171], a[72:75], v[32:35]
  ds_read_b64_tr_b16 a[160:161], v192 offset:28672
  v_mfma_f32_16x16x32_bf16 v[36:39], a[168:171], a[76:79], v[36:39]
  ds_read_b64_tr_b16 a[162:163], v192 offset:29184
  s_waitcnt lgkmcnt(4)
  v_mfma_f32_16x16x32_bf16 v[40:43], a[172:175], a[72:75], v[40:43]
  ds_read_b64_tr_b16 a[164:165], v193 offset:28672
  buffer_load_dwordx4 v204, s[8:11], s44 offen offset:1024 lds
  v_mfma_f32_16x16x32_bf16 v[44:47], a[172:175], a[76:79], v[44:47]
  ds_read_b64_tr_b16 a[166:167], v193 offset:29184
  v_mfma_f32_16x16x32_bf16 v[48:51], a[144:147], a[72:75], v[48:51]
  ds_read_b64_tr_b16 a[168:169], v190 offset:40960
  v_mfma_f32_16x16x32_bf16 v[52:55], a[144:147], a[76:79], v[52:55]
  ds_read_b64_tr_b16 a[170:171], v190 offset:41472
  v_mfma_f32_16x16x32_bf16 v[56:59], a[148:151], a[72:75], v[56:59]
  ds_read_b64_tr_b16 a[172:173], v191 offset:40960
  v_mfma_f32_16x16x32_bf16 v[60:63], a[148:151], a[76:79], v[60:63]
  ds_read_b64_tr_b16 a[174:175], v191 offset:41472
  v_mfma_f32_16x16x32_bf16 v[0:3], a[152:155], a[80:83], v[0:3]
  ds_read_b64_tr_b16 a[144:145], v192 offset:40960
  v_mfma_f32_16x16x32_bf16 v[4:7], a[152:155], a[84:87], v[4:7]
  ds_read_b64_tr_b16 a[146:147], v192 offset:41472
  buffer_load_dwordx4 v205, s[8:11], s44 offen offset:2048 lds
  s_waitcnt lgkmcnt(4)
  v_mfma_f32_16x16x32_bf16 v[8:11], a[156:159], a[80:83], v[8:11]
  ds_read_b64_tr_b16 a[148:149], v193 offset:40960
  v_mfma_f32_16x16x32_bf16 v[12:15], a[156:159], a[84:87], v[12:15]
  ds_read_b64_tr_b16 a[150:151], v193 offset:41472
  v_mfma_f32_16x16x32_bf16 v[16:19], a[160:163], a[80:83], v[16:19]
  ds_read_b64_tr_b16 a[152:153], v190 offset:32768
  v_mfma_f32_16x16x32_bf16 v[20:23], a[160:163], a[84:87], v[20:23]
  ds_read_b64_tr_b16 a[154:155], v190 offset:33280
  v_mfma_f32_16x16x32_bf16 v[24:27], a[164:167], a[80:83], v[24:27]
  ds_read_b64_tr_b16 a[156:157], v191 offset:32768
  v_mfma_f32_16x16x32_bf16 v[28:31], a[164:167], a[84:87], v[28:31]
  ds_read_b64_tr_b16 a[158:159], v191 offset:33280
  v_mfma_f32_16x16x32_bf16 v[32:35], a[168:171], a[80:83], v[32:35]
  ds_read_b64_tr_b16 a[160:161], v192 offset:32768
  buffer_load_dwordx4 v206, s[8:11], s44 offen offset:3072 lds
  v_mfma_f32_16x16x32_bf16 v[36:39], a[168:171], a[84:87], v[36:39]
  ds_read_b64_tr_b16 a[162:163], v192 offset:33280
  s_add_u32 m0, s46, 102400
  s_waitcnt lgkmcnt(4)
  v_mfma_f32_16x16x32_bf16 v[40:43], a[172:175], a[80:83], v[40:43]
  ds_read_b64_tr_b16 a[164:165], v193 offset:32768
  v_mfma_f32_16x16x32_bf16 v[44:47], a[172:175], a[84:87], v[44:47]
  ds_read_b64_tr_b16 a[166:167], v193 offset:33280
  v_mfma_f32_16x16x32_bf16 v[48:51], a[144:147], a[80:83], v[48:51]
  ds_read_b64_tr_b16 a[168:169], v190 offset:45056
  v_mfma_f32_16x16x32_bf16 v[52:55], a[144:147], a[84:87], v[52:55]
  ds_read_b64_tr_b16 a[170:171], v190 offset:45568
  v_mfma_f32_16x16x32_bf16 v[56:59], a[148:151], a[80:83], v[56:59]
  ds_read_b64_tr_b16 a[172:173], v191 offset:45056
  v_mfma_f32_16x16x32_bf16 v[60:63], a[148:151], a[84:87], v[60:63]
  ds_read_b64_tr_b16 a[174:175], v191 offset:45568
  buffer_load_dwordx4 v207, s[8:11], s44 offen lds
  v_mfma_f32_16x16x32_bf16 v[0:3], a[152:155], a[88:91], v[0:3]
  ds_read_b64_tr_b16 a[144:145], v192 offset:45056
  v_mfma_f32_16x16x32_bf16 v[4:7], a[152:155], a[92:95], v[4:7]
  ds_read_b64_tr_b16 a[146:147], v192 offset:45568
  s_waitcnt lgkmcnt(4)
  v_mfma_f32_16x16x32_bf16 v[8:11], a[156:159], a[88:91], v[8:11]
  ds_read_b64_tr_b16 a[148:149], v193 offset:45056
  s_waitcnt vmcnt(12)
  v_mfma_f32_16x16x32_bf16 v[12:15], a[156:159], a[92:95], v[12:15]
  ds_read_b64_tr_b16 a[150:151], v193 offset:45568
  s_barrier
  v_mfma_f32_16x16x32_bf16 v[16:19], a[160:163], a[88:91], v[16:19]
  ds_read_b64_tr_b16 a[152:153], v194
  v_mfma_f32_16x16x32_bf16 v[20:23], a[160:163], a[92:95], v[20:23]
  ds_read_b64_tr_b16 a[154:155], v194 offset:512
  s_waitcnt vmcnt(7)
  v_cmp_ne_u32 vcc, 0, v249
  s_nop 3
  s_or_b64 vcc, vcc, s[56:57]
  s_cmp_eq_u64 vcc, -1
  s_cbranch_scc0 L_slow_S0
L_back_S0:
  v_mfma_f32_16x16x32_bf16 v[24:27], a[164:167], a[88:91], v[24:27]
  ds_read_b64_tr_b16 a[156:157], v195
  buffer_load_dwordx4 v208, s[8:11], s44 offen offset:1024 lds
  v_mfma_f32_16x16x32_bf16 v[28:31], a[164:167], a[92:95], v[28:31]
  ds_read_b64_tr_b16 a[158:159], v195 offset:512
  s_add_u32 s44, s64, 256
  s_add_u32 m0, s46, 122880
  v_mfma_f32_16x16x32_bf16 v[32:35], a[168:171], a[88:91], v[32:35]
  ds_read_b64_tr_b16 a[160:161], v196
  s_mul_i32 s49, s41, 384
  v_mfma_f32_16x16x32_bf16 v[36:39], a[168:171], a[92:95], v[36:39]
  ds_read_b64_tr_b16 a[162:163], v196 offset:512
  s_waitcnt lgkmcnt(4)
  v_mfma_f32_16x16x32_bf16 v[40:43], a[172:175], a[88:91], v[40:43]
  ds_read_b64_tr_b16 a[164:165], v197
  v_add_u32 v248, s49, v227
  v_mfma_f32_16x16x32_bf16 v[44:47], a[172:175], a[92:95], v[44:47]
  ds_read_b64_tr_b16 a[166:167], v197 offset:512
  v_subrev_u32 v249, 5760, v248
  v_mfma_f32_16x16x32_bf16 v[48:51], a[144:147], a[88:91], v[48:51]
  ds_read_b64_tr_b16 a[168:169], v194 offset:12288
  buffer_load_dwordx2 v[228:229], v249, s[28:31], 0 offen sc1
  v_mfma_f32_16x16x32_bf16 v[52:55], a[144:147], a[92:95], v[52:55]
  ds_read_b64_tr_b16 a[170:171], v194 offset:12800
  v_subrev_u32 v250, 5376, v248
  v_mfma_f32_16x16x32_bf16 v[56:59], a[148:151], a[88:91], v[56:59]
  ds_read_b64_tr_b16 a[172:173], v195 offset:12288
  v_mfma_f32_16x16x32_bf16 v[60:63], a[148:151], a[92:95], v[60:63]
  ds_read_b64_tr_b16 a[174:175], v195 offset:12800
  v_mfma_f32_16x16x32_bf16 v[0:3], a[152:155], a[96:99], v[0:3]
  ds_read_b64_tr_b16 a[144:145], v196 offset:12288
  v_mfma_f32_16x16x32_bf16 v[4:7], a[152:155], a[100:103], v[4:7]
  ds_read_b64_tr_b16 a[146:147], v196 offset:12800
  buffer_load_dwordx4 v203, s[8:11], s44 offen lds
  s_waitcnt lgkmcnt(4)
  v_mfma_f32_16x16x32_bf16 v[8:11], a[156:159], a[96:99], v[8:11]
  ds_read_b64_tr_b16 a[148:149], v197 offset:12288
  v_mfma_f32_16x16x32_bf16 v[12:15], a[156:159], a[100:103], v[12:15]
  ds_read_b64_tr_b16 a[150:151], v197 offset:12800
  v_mfma_f32_16x16x32_bf16 v[16:19], a[160:163], a[96:99], v[16:19]
  ds_read_b64_tr_b16 a[152:153], v194 offset:4096
  v_mfma_f32_16x16x32_bf16 v[20:23], a[160:163], a[100:103], v[20:23]
  ds_read_b64_tr_b16 a[154:155], v194 offset:4608
  v_mfma_f32_16x16x32_bf16 v[24:27], a[164:167], a[96:99], v[24:27]
  ds_read_b64_tr_b16 a[156:157], v195 offset:4096
  buffer_load_dwordx2 v[230:231], v250, s[28:31], 0 offen sc1
  v_subrev_u32 v249, 4992, v248
  v_mfma_f32_16x16x32_bf16 v[28:31], a[164:167], a[100:103], v[28:31]
  ds_read_b64_tr_b16 a[158:159], v195 offset:4608
  buffer_load_dwordx4 v204, s[8:11], s44 offen offset:1024 lds
  buffer_load_dwordx4 v205, s[8:11], s44 offen offset:2048 lds
  buffer_load_dwordx4 v206, s[8:11], s44 offen offset:3072 lds
  s_add_u32 m0, s46, 126976
  s_nop 0
  buffer_load_dwordx4 v207, s[8:11], s44 offen lds
  buffer_load_dwordx4 v208, s[8:11], s44 offen offset:1024 lds
  v_mfma_f32_16x16x32_bf16 v[32:35], a[168:171], a[96:99], v[32:35]
  ds_read_b64_tr_b16 a[160:161], v196 offset:4096
  s_add_u32 s44, s44, 884736
  v_mfma_f32_16x16x32_bf16 v[36:39], a[168:171], a[100:103], v[36:39]
  ds_read_b64_tr_b16 a[162:163], v196 offset:4608
  s_waitcnt lgkmcnt(4)
  v_mfma_f32_16x16x32_bf16 v[40:43], a[172:175], a[96:99], v[40:43]
  ds_read_b64_tr_b16 a[164:165], v197 offset:4096
  s_add_u32 m0, s46, 73728
  v_mfma_f32_16x16x32_bf16 v[44:47], a[172:175], a[100:103], v[44:47]
  ds_read_b64_tr_b16 a[166:167], v197 offset:4608
  v_mfma_f32_16x16x32_bf16 v[48:51], a[144:147], a[96:99], v[48:51]
  ds_read_b64_tr_b16 a[168:169], v194 offset:16384
  v_mfma_f32_16x16x32_bf16 v[52:55], a[144:147], a[100:103], v[52:55]
  ds_read_b64_tr_b16 a[170:171], v194 offset:16896
  buffer_load_dwordx2 v[232:233], v249, s[28:31], 0 offen sc1
  v_mfma_f32_16x16x32_bf16 v[56:59], a[148:151], a[96:99], v[56:59]
  ds_read_b64_tr_b16 a[172:173], v195 offset:16384
  v_subrev_u32 v250, 4608, v248
  v_mfma_f32_16x16x32_bf16 v[60:63], a[148:151], a[100:103], v[60:63]
  ds_read_b64_tr_b16 a[174:175], v195 offset:16896
  v_mfma_f32_16x16x32_bf16 v[0:3], a[152:155], a[104:107], v[0:3]
  ds_read_b64_tr_b16 a[144:145], v196 offset:16384
  v_mfma_f32_16x16x32_bf16 v[4:7], a[152:155], a[108:111], v[4:7]
  ds_read_b64_tr_b16 a[146:147], v196 offset:16896
  s_waitcnt lgkmcnt(4)
  v_mfma_f32_16x16x32_bf16 v[8:11], a[156:159], a[104:107], v[8:11]
  ds_read_b64_tr_b16 a[148:149], v197 offset:16384
  buffer_load_dwordx4 v203, s[8:11], s44 offen lds
  v_mfma_f32_16x16x32_bf16 v[12:15], a[156:159], a[108:111], v[12:15]
  ds_read_b64_tr_b16 a[150:151], v197 offset:16896
  v_mfma_f32_16x16x32_bf16 v[16:19], a[160:163], a[104:107], v[16:19]
  ds_read_b64_tr_b16 a[152:153], v194 offset:8192
  v_mfma_f32_16x16x32_bf16 v[20:23], a[160:163], a[108:111], v[20:23]
  ds_read_b64_tr_b16 a[154:155], v194 offset:8704
  buffer_load_dwordx4 v204, s[8:11], s44 offen offset:1024 lds
  buffer_load_dwordx4 v205, s[8:11], s44 offen offset:2048 lds
  buffer_load_dwordx4 v206, s[8:11], s44 offen offset:3072 lds
  s_add_u32 m0, s46, 77824
  s_nop 0
  buffer_load_dwordx4 v207, s[8:11], s44 offen lds
  buffer_load_dwordx4 v208, s[8:11], s44 offen offset:1024 lds
  v_mfma_f32_16x16x32_bf16 v[24:27], a[164:167], a[104:107], v[24:27]
  ds_read_b64_tr_b16 a[156:157], v195 offset:8192
  s_add_u32 s44, s44, 884736
  v_mfma_f32_16x16x32_bf16 v[28:31], a[164:167], a[108:111], v[28:31]
  ds_read_b64_tr_b16 a[158:159], v195 offset:8704
  s_add_u32 m0, s46, 0
  v_mfma_f32_16x16x32_bf16 v[32:35], a[168:171], a[104:107], v[32:35]
  ds_read_b64_tr_b16 a[160:161], v196 offset:8192
  v_mfma_f32_16x16x32_bf16 v[36:39], a[168:171], a[108:111], v[36:39]
  ds_read_b64_tr_b16 a[162:163], v196 offset:8704
  s_waitcnt lgkmcnt(4)
  v_mfma_f32_16x16x32_bf16 v[40:43], a[172:175], a[104:107], v[40:43]
  ds_read_b64_tr_b16 a[164:165], v197 offset:8192
  v_mfma_f32_16x16x32_bf16 v[44:47], a[172:175], a[108:111], v[44:47]
  ds_read_b64_tr_b16 a[166:167], v197 offset:8704
  buffer_load_dwordx2 v[234:235], v250, s[28:31], 0 offen sc1
  v_mfma_f32_16x16x32_bf16 v[48:51], a[144:147], a[104:107], v[48:51]
  ds_read_b64_tr_b16 a[168:169], v194 offset:20480
  v_subrev_u32 v249, 4224, v248
  v_mfma_f32_16x16x32_bf16 v[52:55], a[144:147], a[108:111], v[52:55]
  ds_read_b64_tr_b16 a[170:171], v194 offset:20992
  v_mfma_f32_16x16x32_bf16 v[56:59], a[148:151], a[104:107], v[56:59]
  ds_read_b64_tr_b16 a[172:173], v195 offset:20480
  v_mfma_f32_16x16x32_bf16 v[60:63], a[148:151], a[108:111], v[60:63]
  ds_read_b64_tr_b16 a[174:175], v195 offset:20992
  v_mfma_f32_16x16x32_bf16 v[0:3], a[152:155], a[112:115], v[0:3]
  ds_read_b64_tr_b16 a[144:145], v196 offset:20480
  buffer_load_dwordx4 v203, s[8:11], s44 offen lds
  v_mfma_f32_16x16x32_bf16 v[4:7], a[152:155], a[116:119], v[4:7]
  ds_read_b64_tr_b16 a[146:147], v196 offset:20992
  s_waitcnt lgkmcnt(4)
  v_mfma_f32_16x16x32_bf16 v[8:11], a[156:159], a[112:115], v[8:11]
  ds_read_b64_tr_b16 a[148:149], v197 offset:20480
  s_waitcnt vmcnt(17)
  v_mfma_f32_16x16x32_bf16 v[12:15], a[156:159], a[116:119], v[12:15]
  ds_read_b64_tr_b16 a[150:151], v197 offset:20992
  buffer_load_dwordx4 v204, s[8:11], s44 offen offset:1024 lds
  buffer_load_dwordx4 v205, s[8:11], s44 offen offset:2048 lds
  buffer_load_dwordx4 v206, s[8:11], s44 offen offset:3072 lds
  s_add_u32 m0, s46, 4096
  s_nop 0
  buffer_load_dwordx4 v207, s[8:11], s44 offen lds
  buffer_load_dwordx4 v208, s[8:11], s44 offen offset:1024 lds
  s_barrier
  v_mfma_f32_16x16x32_bf16 v[16:19], a[160:163], a[112:115], v[16:19]
  ds_read_b64_tr_b16 a[152:153], v198
  s_add_u32 s44, s44, 884736
  s_add_u32 m0, s46, 24576
  v_mfma_f32_16x16x32_bf16 v[20:23], a[160:163], a[116:119], v[20:23]
  ds_read_b64_tr_b16 a[154:155], v198 offset:512
  v_mfma_f32_16x16x32_bf16 v[24:27], a[164:167], a[112:115], v[24:27]
  ds_read_b64_tr_b16 a[156:157], v199
  v_mfma_f32_16x16x32_bf16 v[28:31], a[164:167], a[116:119], v[28:31]
  ds_read_b64_tr_b16 a[158:159], v199 offset:512
  v_mfma_f32_16x16x32_bf16 v[32:35], a[168:171], a[112:115], v[32:35]
  ds_read_b64_tr_b16 a[160:161], v200
  v_mfma_f32_16x16x32_bf16 v[36:39], a[168:171], a[116:119], v[36:39]
  ds_read_b64_tr_b16 a[162:163], v200 offset:512
  s_waitcnt lgkmcnt(4)
  v_mfma_f32_16x16x32_bf16 v[40:43], a[172:175], a[112:115], v[40:43]
  ds_read_b64_tr_b16 a[164:165], v201
  buffer_load_dwordx2 v[236:237], v249, s[28:31], 0 offen sc1
  v_mfma_f32_16x16x32_bf16 v[44:47], a[172:175], a[116:119], v[44:47]
  ds_read_b64_tr_b16 a[166:167], v201 offset:512
  v_subrev_u32 v250, 3840, v248
  v_mfma_f32_16x16x32_bf16 v[48:51], a[144:147], a[112:115], v[48:51]
  ds_read_b64_tr_b16 a[168:169], v198 offset:12288
  v_mfma_f32_16x16x32_bf16 v[52:55], a[144:147], a[116:119], v[52:55]
  ds_read_b64_tr_b16 a[170:171], v198 offset:12800
  v_mfma_f32_16x16x32_bf16 v[56:59], a[148:151], a[112:115], v[56:59]
  ds_read_b64_tr_b16 a[172:173], v199 offset:12288
  v_mfma_f32_16x16x32_bf16 v[60:63], a[148:151], a[116:119], v[60:63]
  ds_read_b64_tr_b16 a[174:175], v199 offset:12800
  buffer_load_dwordx2 v[238:239], v250, s[28:31], 0 offen sc1
  v_mfma_f32_16x16x32_bf16 v[0:3], a[152:155], a[120:123], v[0:3]
  ds_read_b64_tr_b16 a[144:145], v200 offset:12288
  v_subrev_u32 v249, 3456, v248
  v_mfma_f32_16x16x32_bf16 v[4:7], a[152:155], a[124:127], v[4:7]
  ds_read_b64_tr_b16 a[146:147], v200 offset:12800
  s_waitcnt lgkmcnt(4)
  v_mfma_f32_16x16x32_bf16 v[8:11], a[156:159], a[120:123], v[8:11]
  ds_read_b64_tr_b16 a[148:149], v201 offset:12288
  v_mfma_f32_16x16x32_bf16 v[12:15], a[156:159], a[124:127], v[12:15]
  ds_read_b64_tr_b16 a[150:151], v201 offset:12800
  v_mfma_f32_16x16x32_bf16 v[16:19], a[160:163], a[120:123], v[16:19]
  ds_read_b64_tr_b16 a[152:153], v198 offset:4096
  buffer_load_dwordx2 v[240:241], v249, s[28:31], 0 offen sc1
  v_subrev_u32 v250, 3072, v248
  v_mfma_f32_16x16x32_bf16 v[20:23], a[160:163], a[124:127], v[20:23]
  ds_read_b64_tr_b16 a[154:155], v198 offset:4608
  v_mfma_f32_16x16x32_bf16 v[24:27], a[164:167], a[120:123], v[24:27]
  ds_read_b64_tr_b16 a[156:157], v199 offset:4096
  v_mfma_f32_16x16x32_bf16 v[28:31], a[164:167], a[124:127], v[28:31]
  ds_read_b64_tr_b16 a[158:159], v199 offset:4608
  v_mfma_f32_16x16x32_bf16 v[32:35], a[168:171], a[120:123], v[32:35]
  ds_read_b64_tr_b16 a[160:161], v200 offset:4096
  v_mfma_f32_16x16x32_bf16 v[36:39], a[168:171], a[124:127], v[36:39]
  ds_read_b64_tr_b16 a[162:163], v200 offset:4608
  s_waitcnt lgkmcnt(4)
  v_mfma_f32_16x16x32_bf16 v[40:43], a[172:175], a[120:123], v[40:43]
  ds_read_b64_tr_b16 a[164:165], v201 offset:4096
  buffer_load_dwordx2 v[242:243], v250, s[28:31], 0 offen sc1
  v_mfma_f32_16x16x32_bf16 v[44:47], a[172:175], a[124:127], v[44:47]
  ds_read_b64_tr_b16 a[166:167], v201 offset:4608
  v_mfma_f32_16x16x32_bf16 v[48:51], a[144:147], a[120:123], v[48:51]
  ds_read_b64_tr_b16 a[168:169], v198 offset:16384
  v_mfma_f32_16x16x32_bf16 v[52:55], a[144:147], a[124:127], v[52:55]
  ds_read_b64_tr_b16 a[170:171], v198 offset:16896
  v_mfma_f32_16x16x32_bf16 v[56:59], a[148:151], a[120:123], v[56:59]
  ds_read_b64_tr_b16 a[172:173], v199 offset:16384
  v_mfma_f32_16x16x32_bf16 v[60:63], a[148:151], a[124:127], v[60:63]
  ds_read_b64_tr_b16 a[174:175], v199 offset:16896
  buffer_load_dwordx4 v203, s[8:11], s44 offen lds
  v_mfma_f32_16x16x32_bf16 v[0:3], a[152:155], a[128:131], v[0:3]
  ds_read_b64_tr_b16 a[144:145], v200 offset:16384
  v_mfma_f32_16x16x32_bf16 v[4:7], a[152:155], a[132:135], v[4:7]
  ds_read_b64_tr_b16 a[146:147], v200 offset:16896
  s_waitcnt lgkmcnt(4)
  v_mfma_f32_16x16x32_bf16 v[8:11], a[156:159], a[128:131], v[8:11]
  ds_read_b64_tr_b16 a[148:149], v201 offset:16384
  v_mfma_f32_16x16x32_bf16 v[12:15], a[156:159], a[132:135], v[12:15]
  ds_read_b64_tr_b16 a[150:151], v201 offset:16896
  v_mfma_f32_16x16x32_bf16 v[16:19], a[160:163], a[128:131], v[16:19]
  ds_read_b64_tr_b16 a[152:153], v198 offset:8192
  v_mfma_f32_16x16x32_bf16 v[20:23], a[160:163], a[132:135], v[20:23]
  ds_read_b64_tr_b16 a[154:155], v198 offset:8704
  v_mfma_f32_16x16x32_bf16 v[24:27], a[164:167], a[128:131], v[24:27]
  ds_read_b64_tr_b16 a[156:157], v199 offset:8192
  buffer_load_dwordx4 v204, s[8:11], s44 offen offset:1024 lds
  v_mfma_f32_16x16x32_bf16 v[28:31], a[164:167], a[132:135], v[28:31]
  ds_read_b64_tr_b16 a[158:159], v199 offset:8704
  v_mfma_f32_16x16x32_bf16 v[32:35], a[168:171], a[128:131], v[32:35]
  ds_read_b64_tr_b16 a[160:161], v200 offset:8192
  v_mfma_f32_16x16x32_bf16 v[36:39], a[168:171], a[132:135], v[36:39]
  ds_read_b64_tr_b16 a[162:163], v200 offset:8704
  s_waitcnt lgkmcnt(4)
  v_mfma_f32_16x16x32_bf16 v[40:43], a[172:175], a[128:131], v[40:43]
  ds_read_b64_tr_b16 a[164:165], v201 offset:8192
  v_mfma_f32_16x16x32_bf16 v[44:47], a[172:175], a[132:135], v[44:47]
  ds_read_b64_tr_b16 a[166:167], v201 offset:8704
  v_mfma_f32_16x16x32_bf16 v[48:51], a[144:147], a[128:131], v[48:51]
  ds_read_b64_tr_b16 a[168:169], v198 offset:20480
  v_mfma_f32_16x16x32_bf16 v[52:55], a[144:147], a[132:135], v[52:55]
  ds_read_b64_tr_b16 a[170:171], v198 offset:20992
  buffer_load_dwordx4 v205, s[8:11], s44 offen offset:2048 lds
  v_mfma_f32_16x16x32_bf16 v[56:59], a[148:151], a[128:131], v[56:59]
  ds_read_b64_tr_b16 a[172:173], v199 offset:20480
  v_mfma_f32_16x16x32_bf16 v[60:63], a[148:151], a[132:135], v[60:63]
  ds_read_b64_tr_b16 a[174:175], v199 offset:20992
  buffer_load_dwordx4 v206, s[8:11], s44 offen offset:3072 lds
  s_add_u32 m0, s46, 28672
  s_nop 0
  buffer_load_dwordx4 v207, s[8:11], s44 offen lds
  buffer_load_dwordx4 v208, s[8:11], s44 offen offset:1024 lds
  v_mfma_f32_16x16x32_bf16 v[0:3], a[152:155], a[136:139], v[0:3]
  ds_read_b64_tr_b16 a[144:145], v200 offset:20480
  v_mfma_f32_16x16x32_bf16 v[4:7], a[152:155], a[140:143], v[4:7]
  ds_read_b64_tr_b16 a[146:147], v200 offset:20992
  s_waitcnt lgkmcnt(4)
  v_mfma_f32_16x16x32_bf16 v[8:11], a[156:159], a[136:139], v[8:11]
  ds_read_b64_tr_b16 a[148:149], v201 offset:20480
  s_waitcnt vmcnt(24)
  v_mfma_f32_16x16x32_bf16 v[12:15], a[156:159], a[140:143], v[12:15]
  ds_read_b64_tr_b16 a[150:151], v201 offset:20992
  s_barrier
  v_mfma_f32_16x16x32_bf16 v[16:19], a[160:163], a[136:139], v[16:19]
  ds_read_b64_tr_b16 a[152:153], v198 offset:24576
  s_add_u32 s44, s44, 884736
  s_add_u32 m0, s46, 49152
  v_mfma_f32_16x16x32_bf16 v[20:23], a[160:163], a[140:143], v[20:23]
  ds_read_b64_tr_b16 a[154:155], v198 offset:25088
  v_mfma_f32_16x16x32_bf16 v[24:27], a[164:167], a[136:139], v[24:27]
  ds_read_b64_tr_b16 a[156:157], v199 offset:24576
  v_mfma_f32_16x16x32_bf16 v[28:31], a[164:167], a[140:143], v[28:31]
  ds_read_b64_tr_b16 a[158:159], v199 offset:25088
  buffer_load_dwordx4 v203, s[8:11], s44 offen lds
  v_mfma_f32_16x16x32_bf16 v[32:35], a[168:171], a[136:139], v[32:35]
  ds_read_b64_tr_b16 a[160:161], v200 offset:24576
  v_mfma_f32_16x16x32_bf16 v[36:39], a[168:171], a[140:143], v[36:39]
  ds_read_b64_tr_b16 a[162:163], v200 offset:25088
  s_waitcnt lgkmcnt(4)
  v_mfma_f32_16x16x32_bf16 v[40:43], a[172:175], a[136:139], v[40:43]
  ds_read_b64_tr_b16 a[164:165], v201 offset:24576
  v_mfma_f32_16x16x32_bf16 v[44:47], a[172:175], a[140:143], v[44:47]
  ds_read_b64_tr_b16 a[166:167], v201 offset:25088
  v_mfma_f32_16x16x32_bf16 v[48:51], a[144:147], a[136:139], v[48:51]
  ds_read_b64_tr_b16 a[168:169], v198 offset:36864
  v_mfma_f32_16x16x32_bf16 v[52:55], a[144:147], a[140:143], v[52:55]
  ds_read_b64_tr_b16 a[170:171], v198 offset:37376
  v_mfma_f32_16x16x32_bf16 v[56:59], a[148:151], a[136:139], v[56:59]
  ds_read_b64_tr_b16 a[172:173], v199 offset:36864
  buffer_load_dwordx4 v204, s[8:11], s44 offen offset:1024 lds
  v_mfma_f32_16x16x32_bf16 v[60:63], a[148:151], a[140:143], v[60:63]
  ds_read_b64_tr_b16 a[174:175], v199 offset:37376
  v_mfma_f32_16x16x32_bf16 v[64:67], a[152:155], a[0:3], 0
  ds_read_b64_tr_b16 a[144:145], v200 offset:36864
  v_fmac_f32 v230, v221, v228
  v_mfma_f32_16x16x32_bf16 v[68:71], a[152:155], a[4:7], 0
  ds_read_b64_tr_b16 a[146:147], v200 offset:37376
  s_waitcnt lgkmcnt(4)
  v_mfma_f32_16x16x32_bf16 v[72:75], a[156:159], a[0:3], 0
  ds_read_b64_tr_b16 a[148:149], v201 offset:36864
  v_fmac_f32 v231, v221, v229
  v_fma_f32 v230, -v222, v229, v230
  v_mfma_f32_16x16x32_bf16 v[76:79], a[156:159], a[4:7], 0
  ds_read_b64_tr_b16 a[150:151], v201 offset:37376
  v_fmac_f32 v231, v222, v228
  v_mfma_f32_16x16x32_bf16 v[80:83], a[160:163], a[0:3], 0
  ds_read_b64_tr_b16 a[152:153], v198 offset:28672
  v_max_f32 v0, 0, v0
  v_mul_f32 v32, v215, v32
  v_mfma_f32_16x16x32_bf16 v[84:87], a[160:163], a[4:7], 0
  ds_read_b64_tr_b16 a[154:155], v198 offset:29184
  buffer_load_dwordx4 v205, s[8:11], s44 offen offset:2048 lds
  v_mfma_f32_16x16x32_bf16 v[88:91], a[164:167], a[0:3], 0
  ds_read_b64_tr_b16 a[156:157], v199 offset:28672
  v_max_f32 v1, 0, v1
  v_mfma_f32_16x16x32_bf16 v[92:95], a[164:167], a[4:7], 0
  ds_read_b64_tr_b16 a[158:159], v199 offset:29184
  s_waitcnt vmcnt(26)
  v_fmac_f32 v232, v221, v230
  v_fmac_f32 v233, v221, v231
  v_mfma_f32_16x16x32_bf16 v[96:99], a[168:171], a[0:3], 0
  ds_read_b64_tr_b16 a[160:161], v200 offset:28672
  v_fma_f32 v232, -v222, v231, v232
  v_mfma_f32_16x16x32_bf16 v[100:103], a[168:171], a[4:7], 0
  ds_read_b64_tr_b16 a[162:163], v200 offset:29184
  s_waitcnt lgkmcnt(4)
  v_mfma_f32_16x16x32_bf16 v[104:107], a[172:175], a[0:3], 0
  ds_read_b64_tr_b16 a[164:165], v201 offset:28672
  v_fmac_f32 v233, v222, v230
  v_mul_f32 v33, v215, v33
  v_mfma_f32_16x16x32_bf16 v[108:111], a[172:175], a[4:7], 0
  ds_read_b64_tr_b16 a[166:167], v201 offset:29184
  v_max_f32 v2, 0, v2
  v_mfma_f32_16x16x32_bf16 v[112:115], a[144:147], a[0:3], 0
  ds_read_b64_tr_b16 a[168:169], v198 offset:40960
  buffer_load_dwordx4 v206, s[8:11], s44 offen offset:3072 lds
  v_mfma_f32_16x16x32_bf16 v[116:119], a[144:147], a[4:7], 0
  ds_read_b64_tr_b16 a[170:171], v198 offset:41472
  s_add_u32 m0, s46, 53248
  v_mul_f32 v34, v215, v34
  v_mfma_f32_16x16x32_bf16 v[120:123], a[148:151], a[0:3], 0
  ds_read_b64_tr_b16 a[172:173], v199 offset:40960
  v_max_f32 v3, 0, v3
  v_mfma_f32_16x16x32_bf16 v[124:127], a[148:151], a[4:7], 0
  ds_read_b64_tr_b16 a[174:175], v199 offset:41472
  v_mul_f32 v35, v215, v35
  v_mul_f32 v0, v0, v32
  v_mfma_f32_16x16x32_bf16 v[64:67], a[152:155], a[8:11], v[64:67]
  ds_read_b64_tr_b16 a[144:145], v200 offset:40960
  v_mul_f32 v1, v1, v33
  v_mfma_f32_16x16x32_bf16 v[68:71], a[152:155], a[12:15], v[68:71]
  ds_read_b64_tr_b16 a[146:147], v200 offset:41472
  s_waitcnt lgkmcnt(4)
  v_mfma_f32_16x16x32_bf16 v[72:75], a[156:159], a[8:11], v[72:75]
  ds_read_b64_tr_b16 a[148:149], v201 offset:40960
  v_mul_f32 v2, v2, v34
  v_mul_f32 v3, v3, v35
  v_mfma_f32_16x16x32_bf16 v[76:79], a[156:159], a[12:15], v[76:79]
  ds_read_b64_tr_b16 a[150:151], v201 offset:41472
  buffer_load_dwordx4 v207, s[8:11], s44 offen lds
  v_mfma_f32_16x16x32_bf16 v[80:83], a[160:163], a[8:11], v[80:83]
  ds_read_b64_tr_b16 a[152:153], v198 offset:32768
  v_max_f32 v8, 0, v8
  v_mfma_f32_16x16x32_bf16 v[84:87], a[160:163], a[12:15], v[84:87]
  ds_read_b64_tr_b16 a[154:155], v198 offset:33280
  s_waitcnt vmcnt(21)
  v_fmac_f32 v234, v221, v232
  v_fmac_f32 v235, v221, v233
  v_mfma_f32_16x16x32_bf16 v[88:91], a[164:167], a[8:11], v[88:91]
  ds_read_b64_tr_b16 a[156:157], v199 offset:32768
  v_fma_f32 v234, -v222, v233, v234
  v_mfma_f32_16x16x32_bf16 v[92:95], a[164:167], a[12:15], v[92:95]
  ds_read_b64_tr_b16 a[158:159], v199 offset:33280
  v_fmac_f32 v235, v222, v232
  v_mfma_f32_16x16x32_bf16 v[96:99], a[168:171], a[8:11], v[96:99]
  ds_read_b64_tr_b16 a[160:161], v200 offset:32768
  v_mul_f32 v40, v215, v40
  v_max_f32 v9, 0, v9
  v_mfma_f32_16x16x32_bf16 v[100:103], a[168:171], a[12:15], v[100:103]
  ds_read_b64_tr_b16 a[162:163], v200 offset:33280
  s_waitcnt lgkmcnt(4)
  v_mfma_f32_16x16x32_bf16 v[104:107], a[172:175], a[8:11], v[104:107]
  ds_read_b64_tr_b16 a[164:165], v201 offset:32768
  buffer_load_dwordx4 v208, s[8:11], s44 offen offset:1024 lds
  v_mul_f32 v41, v215, v41
  v_mfma_f32_16x16x32_bf16 v[108:111], a[172:175], a[12:15], v[108:111]
  ds_read_b64_tr_b16 a[166:167], v201 offset:33280
  v_max_f32 v10, 0, v10
  v_mfma_f32_16x16x32_bf16 v[112:115], a[144:147], a[8:11], v[112:115]
  ds_read_b64_tr_b16 a[168:169], v198 offset:45056
  v_mul_f32 v42, v215, v42
  v_mfma_f32_16x16x32_bf16 v[116:119], a[144:147], a[12:15], v[116:119]
  ds_read_b64_tr_b16 a[170:171], v198 offset:45568
  v_max_f32 v11, 0, v11
  v_mul_f32 v43, v215, v43
  v_mfma_f32_16x16x32_bf16 v[120:123], a[148:151], a[8:11], v[120:123]
  ds_read_b64_tr_b16 a[172:173], v199 offset:45056
  v_mul_f32 v8, v8, v40
  v_mfma_f32_16x16x32_bf16 v[124:127], a[148:151], a[12:15], v[124:127]
  ds_read_b64_tr_b16 a[174:175], v199 offset:45568
  v_mul_f32 v9, v9, v41
  v_mfma_f32_16x16x32_bf16 v[64:67], a[152:155], a[16:19], v[64:67]
  ds_read_b64_tr_b16 a[144:145], v200 offset:45056
  v_mul_f32 v10, v10, v42
  v_mul_f32 v11, v11, v43
  v_mfma_f32_16x16x32_bf16 v[68:71], a[152:155], a[20:23], v[68:71]
  ds_read_b64_tr_b16 a[146:147], v200 offset:45568
  s_waitcnt lgkmcnt(4)
  v_mfma_f32_16x16x32_bf16 v[72:75], a[156:159], a[16:19], v[72:75]
  ds_read_b64_tr_b16 a[148:149], v201 offset:45056
  v_mfma_f32_16x16x32_bf16 v[76:79], a[156:159], a[20:23], v[76:79]
  ds_read_b64_tr_b16 a[150:151], v201 offset:45568
  v_cvt_pk_bf16_f32 v32, v0, v1
  s_barrier
  v_mfma_f32_16x16x32_bf16 v[80:83], a[160:163], a[16:19], v[80:83]
  ds_read_b64_tr_b16 a[152:153], v194 offset:24576
  s_waitcnt vmcnt(15)
  v_fmac_f32 v236, v221, v234
  v_mfma_f32_16x16x32_bf16 v[84:87], a[160:163], a[20:23], v[84:87]
  ds_read_b64_tr_b16 a[154:155], v194 offset:25088
  v_fmac_f32 v237, v221, v235
  v_fma_f32 v236, -v222, v235, v236
  v_mfma_f32_16x16x32_bf16 v[88:91], a[164:167], a[16:19], v[88:91]
  ds_read_b64_tr_b16 a[156:157], v195 offset:24576
  v_fmac_f32 v237, v222, v234
  v_mfma_f32_16x16x32_bf16 v[92:95], a[164:167], a[20:23], v[92:95]
  ds_read_b64_tr_b16 a[158:159], v195 offset:25088
  s_add_u32 s44, s44, 884736
  v_mfma_f32_16x16x32_bf16 v[96:99], a[168:171], a[16:19], v[96:99]
  ds_read_b64_tr_b16 a[160:161], v196 offset:24576
  s_add_u32 m0, s46, 98304
  s_nop 0
  buffer_load_dwordx4 v203, s[8:11], s44 offen lds
  v_mfma_f32_16x16x32_bf16 v[100:103], a[168:171], a[20:23], v[100:103]
  ds_read_b64_tr_b16 a[162:163], v196 offset:25088
  s_waitcnt lgkmcnt(4)
  v_mfma_f32_16x16x32_bf16 v[104:107], a[172:175], a[16:19], v[104:107]
  ds_read_b64_tr_b16 a[164:165], v197 offset:24576
  s_waitcnt vmcnt(15)
  v_fmac_f32 v238, v221, v236
  v_mfma_f32_16x16x32_bf16 v[108:111], a[172:175], a[20:23], v[108:111]
  ds_read_b64_tr_b16 a[166:167], v197 offset:25088
  v_fmac_f32 v239, v221, v237
  v_fma_f32 v238, -v222, v237, v238
  v_mfma_f32_16x16x32_bf16 v[112:115], a[144:147], a[16:19], v[112:115]
  ds_read_b64_tr_b16 a[168:169], v194 offset:36864
  v_fmac_f32 v239, v222, v236
  v_mfma_f32_16x16x32_bf16 v[116:119], a[144:147], a[20:23], v[116:119]
  ds_read_b64_tr_b16 a[170:171], v194 offset:37376
  v_cvt_pk_bf16_f32 v33, v2, v3
  v_cvt_pk_bf16_f32 v34, v8, v9
  v_mfma_f32_16x16x32_bf16 v[120:123], a[148:151], a[16:19], v[120:123]
  ds_read_b64_tr_b16 a[172:173], v195 offset:36864
  s_waitcnt vmcnt(14)
  v_fmac_f32 v240, v221, v238
  v_mfma_f32_16x16x32_bf16 v[124:127], a[148:151], a[20:23], v[124:127]
  ds_read_b64_tr_b16 a[174:175], v195 offset:37376
  buffer_load_dwordx4 v204, s[8:11], s44 offen offset:1024 lds
  v_mfma_f32_16x16x32_bf16 v[64:67], a[152:155], a[24:27], v[64:67]
  ds_read_b64_tr_b16 a[144:145], v196 offset:36864
  v_fmac_f32 v241, v221, v239
  v_fma_f32 v240, -v222, v239, v240
  v_mfma_f32_16x16x32_bf16 v[68:71], a[152:155], a[28:31], v[68:71]
  ds_read_b64_tr_b16 a[146:147], v196 offset:37376
  s_waitcnt lgkmcnt(4)
  v_mfma_f32_16x16x32_bf16 v[72:75], a[156:159], a[24:27], v[72:75]
  ds_read_b64_tr_b16 a[148:149], v197 offset:36864
  v_fmac_f32 v241, v222, v238
  v_mfma_f32_16x16x32_bf16 v[76:79], a[156:159], a[28:31], v[76:79]
  ds_read_b64_tr_b16 a[150:151], v197 offset:37376
  v_cvt_pk_bf16_f32 v35, v10, v11
  v_accvgpr_write_b32 a192, v32
  v_mfma_f32_16x16x32_bf16 v[80:83], a[160:163], a[24:27], v[80:83]
  ds_read_b64_tr_b16 a[152:153], v194 offset:28672
  s_waitcnt vmcnt(14)
  v_fmac_f32 v242, v221, v240
  v_mfma_f32_16x16x32_bf16 v[84:87], a[160:163], a[28:31], v[84:87]
  ds_read_b64_tr_b16 a[154:155], v194 offset:29184
  v_fmac_f32 v243, v221, v241
  v_mfma_f32_16x16x32_bf16 v[88:91], a[164:167], a[24:27], v[88:91]
  ds_read_b64_tr_b16 a[156:157], v195 offset:28672
  buffer_load_dwordx4 v205, s[8:11], s44 offen offset:2048 lds
  v_fma_f32 v242, -v222, v241, v242
  v_mfma_f32_16x16x32_bf16 v[92:95], a[164:167], a[28:31], v[92:95]
  ds_read_b64_tr_b16 a[158:159], v195 offset:29184
  v_fmac_f32 v243, v222, v240
  v_mfma_f32_16x16x32_bf16 v[96:99], a[168:171], a[24:27], v[96:99]
  ds_read_b64_tr_b16 a[160:161], v196 offset:28672
  v_mov_b32 v250, v242
  v_mov_b32 v251, v243
  v_mfma_f32_16x16x32_bf16 v[100:103], a[168:171], a[28:31], v[100:103]
  ds_read_b64_tr_b16 a[162:163], v196 offset:29184
  s_waitcnt lgkmcnt(4)
  v_mfma_f32_16x16x32_bf16 v[104:107], a[172:175], a[24:27], v[104:107]
  ds_read_b64_tr_b16 a[164:165], v197 offset:28672
  v_subrev_u32 v249, 2688, v248
  v_mfma_f32_16x16x32_bf16 v[108:111], a[172:175], a[28:31], v[108:111]
  ds_read_b64_tr_b16 a[166:167], v197 offset:29184
  buffer_load_dwordx2 v[228:229], v249, s[28:31], 0 offen sc1
  v_subrev_u32 v249, 2304, v248
  v_mfma_f32_16x16x32_bf16 v[112:115], a[144:147], a[24:27], v[112:115]
  ds_read_b64_tr_b16 a[168:169], v194 offset:40960
  v_accvgpr_write_b32 a193, v33
  v_mfma_f32_16x16x32_bf16 v[116:119], a[144:147], a[28:31], v[116:119]
  ds_read_b64_tr_b16 a[170:171], v194 offset:41472
  v_accvgpr_write_b32 a194, v34
  v_mfma_f32_16x16x32_bf16 v[120:123], a[148:151], a[24:27], v[120:123]
  ds_read_b64_tr_b16 a[172:173], v195 offset:40960
  v_accvgpr_write_b32 a195, v35
  v_mfma_f32_16x16x32_bf16 v[124:127], a[148:151], a[28:31], v[124:127]
  ds_read_b64_tr_b16 a[174:175], v195 offset:41472
  v_mfma_f32_16x16x32_bf16 v[64:67], a[152:155], a[32:35], v[64:67]
  ds_read_b64_tr_b16 a[144:145], v196 offset:40960
  buffer_load_dwordx4 v206, s[8:11], s44 offen offset:3072 lds
  v_mfma_f32_16x16x32_bf16 v[68:71], a[152:155], a[36:39], v[68:71]
  ds_read_b64_tr_b16 a[146:147], v196 offset:41472
  s_add_u32 m0, s46, 102400
  s_waitcnt lgkmcnt(4)
  v_mfma_f32_16x16x32_bf16 v[72:75], a[156:159], a[32:35], v[72:75]
  ds_read_b64_tr_b16 a[148:149], v197 offset:40960
  v_mfma_f32_16x16x32_bf16 v[76:79], a[156:159], a[36:39], v[76:79]
  ds_read_b64_tr_b16 a[150:151], v197 offset:41472
  v_mfma_f32_16x16x32_bf16 v[80:83], a[160:163], a[32:35], v[80:83]
  ds_read_b64_tr_b16 a[152:153], v194 offset:32768
  v_mfma_f32_16x16x32_bf16 v[84:87], a[160:163], a[36:39], v[84:87]
  ds_read_b64_tr_b16 a[154:155], v194 offset:33280
  buffer_load_dwordx2 v[230:231], v249, s[28:31], 0 offen sc1
  v_mfma_f32_16x16x32_bf16 v[88:91], a[164:167], a[32:35], v[88:91]
  ds_read_b64_tr_b16 a[156:157], v195 offset:32768
  v_subrev_u32 v249, 1920, v248
  v_mfma_f32_16x16x32_bf16 v[92:95], a[164:167], a[36:39], v[92:95]
  ds_read_b64_tr_b16 a[158:159], v195 offset:33280
  v_mfma_f32_16x16x32_bf16 v[96:99], a[168:171], a[32:35], v[96:99]
  ds_read_b64_tr_b16 a[160:161], v196 offset:32768
  v_mfma_f32_16x16x32_bf16 v[100:103], a[168:171], a[36:39], v[100:103]
  ds_read_b64_tr_b16 a[162:163], v196 offset:33280
  s_waitcnt lgkmcnt(4)
  v_mfma_f32_16x16x32_bf16 v[104:107], a[172:175], a[32:35], v[104:107]
  ds_read_b64_tr_b16 a[164:165], v197 offset:32768
  buffer_load_dwordx4 v207, s[8:11], s44 offen lds
  v_mfma_f32_16x16x32_bf16 v[108:111], a[172:175], a[36:39], v[108:111]
  ds_read_b64_tr_b16 a[166:167], v197 offset:33280
  v_mfma_f32_16x16x32_bf16 v[112:115], a[144:147], a[32:35], v[112:115]
  ds_read_b64_tr_b16 a[168:169], v194 offset:45056
  v_mfma_f32_16x16x32_bf16 v[116:119], a[144:147], a[36:39], v[116:119]
  ds_read_b64_tr_b16 a[170:171], v194 offset:45568
  v_mfma_f32_16x16x32_bf16 v[120:123], a[148:151], a[32:35], v[120:123]
  ds_read_b64_tr_b16 a[172:173], v195 offset:45056
  v_mfma_f32_16x16x32_bf16 v[124:127], a[148:151], a[36:39], v[124:127]
  ds_read_b64_tr_b16 a[174:175], v195 offset:45568
  buffer_load_dwordx2 v[232:233], v249, s[28:31], 0 offen sc1
  buffer_load_dwordx4 v208, s[8:11], s44 offen offset:1024 lds
  v_mfma_f32_16x16x32_bf16 v[64:67], a[152:155], a[40:43], v[64:67]
  ds_read_b64_tr_b16 a[144:145], v196 offset:45056
  v_subrev_u32 v249, 1536, v248
  v_mfma_f32_16x16x32_bf16 v[68:71], a[152:155], a[44:47], v[68:71]
  ds_read_b64_tr_b16 a[146:147], v196 offset:45568
  s_waitcnt lgkmcnt(4)
  v_mfma_f32_16x16x32_bf16 v[72:75], a[156:159], a[40:43], v[72:75]
  ds_read_b64_tr_b16 a[148:149], v197 offset:45056
  v_mfma_f32_16x16x32_bf16 v[76:79], a[156:159], a[44:47], v[76:79]
  ds_read_b64_tr_b16 a[150:151], v197 offset:45568
  s_barrier
  v_mfma_f32_16x16x32_bf16 v[80:83], a[160:163], a[40:43], v[80:83]
  ds_read_b64_tr_b16 a[152:153], v190
  s_add_u32 s44, s64, 384
  v_mfma_f32_16x16x32_bf16 v[84:87], a[160:163], a[44:47], v[84:87]
  ds_read_b64_tr_b16 a[154:155], v190 offset:512
  buffer_load_dwordx2 v[234:235], v249, s[28:31], 0 offen sc1
  v_mfma_f32_16x16x32_bf16 v[88:91], a[164:167], a[40:43], v[88:91]
  ds_read_b64_tr_b16 a[156:157], v191
  v_subrev_u32 v249, 1152, v248
  s_add_u32 m0, s46, 122880
  v_mfma_f32_16x16x32_bf16 v[92:95], a[164:167], a[44:47], v[92:95]
  ds_read_b64_tr_b16 a[158:159], v191 offset:512
  v_mfma_f32_16x16x32_bf16 v[96:99], a[168:171], a[40:43], v[96:99]
  ds_read_b64_tr_b16 a[160:161], v192
  v_mfma_f32_16x16x32_bf16 v[100:103], a[168:171], a[44:47], v[100:103]
  ds_read_b64_tr_b16 a[162:163], v192 offset:512
  s_waitcnt lgkmcnt(4)
  v_mfma_f32_16x16x32_bf16 v[104:107], a[172:175], a[40:43], v[104:107]
  ds_read_b64_tr_b16 a[164:165], v193
  buffer_load_dwordx2 v[236:237], v249, s[28:31], 0 offen sc1
  v_mfma_f32_16x16x32_bf16 v[108:111], a[172:175], a[44:47], v[108:111]
  ds_read_b64_tr_b16 a[166:167], v193 offset:512
  v_subrev_u32 v249, 768, v248
  v_mfma_f32_16x16x32_bf16 v[112:115], a[144:147], a[40:43], v[112:115]
  ds_read_b64_tr_b16 a[168:169], v190 offset:12288
  v_mfma_f32_16x16x32_bf16 v[116:119], a[144:147], a[44:47], v[116:119]
  ds_read_b64_tr_b16 a[170:171], v190 offset:12800
  v_mfma_f32_16x16x32_bf16 v[120:123], a[148:151], a[40:43], v[120:123]
  ds_read_b64_tr_b16 a[172:173], v191 offset:12288
  v_mfma_f32_16x16x32_bf16 v[124:127], a[148:151], a[44:47], v[124:127]
  ds_read_b64_tr_b16 a[174:175], v191 offset:12800
  buffer_load_dwordx4 v203, s[8:11], s44 offen lds
  v_mfma_f32_16x16x32_bf16 v[64:67], a[152:155], a[48:51], v[64:67]
  ds_read_b64_tr_b16 a[144:145], v192 offset:12288
  v_mfma_f32_16x16x32_bf16 v[68:71], a[152:155], a[52:55], v[68:71]
  ds_read_b64_tr_b16 a[146:147], v192 offset:12800
  s_waitcnt lgkmcnt(4)
  v_mfma_f32_16x16x32_bf16 v[72:75], a[156:159], a[48:51], v[72:75]
  ds_read_b64_tr_b16 a[148:149], v193 offset:12288
  v_mfma_f32_16x16x32_bf16 v[76:79], a[156:159], a[52:55], v[76:79]
  ds_read_b64_tr_b16 a[150:151], v193 offset:12800
  v_mfma_f32_16x16x32_bf16 v[80:83], a[160:163], a[48:51], v[80:83]
  ds_read_b64_tr_b16 a[152:153], v190 offset:4096
  buffer_load_dwordx2 v[238:239], v249, s[28:31], 0 offen sc1
  v_mfma_f32_16x16x32_bf16 v[84:87], a[160:163], a[52:55], v[84:87]
  ds_read_b64_tr_b16 a[154:155], v190 offset:4608
  v_subrev_u32 v249, 384, v248
  v_mfma_f32_16x16x32_bf16 v[88:91], a[164:167], a[48:51], v[88:91]
  ds_read_b64_tr_b16 a[156:157], v191 offset:4096
  v_mfma_f32_16x16x32_bf16 v[92:95], a[164:167], a[52:55], v[92:95]
  ds_read_b64_tr_b16 a[158:159], v191 offset:4608
  v_mfma_f32_16x16x32_bf16 v[96:99], a[168:171], a[48:51], v[96:99]
  ds_read_b64_tr_b16 a[160:161], v192 offset:4096
  v_mfma_f32_16x16x32_bf16 v[100:103], a[168:171], a[52:55], v[100:103]
  ds_read_b64_tr_b16 a[162:163], v192 offset:4608
  s_waitcnt lgkmcnt(4)
  v_mfma_f32_16x16x32_bf16 v[104:107], a[172:175], a[48:51], v[104:107]
  ds_read_b64_tr_b16 a[164:165], v193 offset:4096
  buffer_load_dwordx4 v204, s[8:11], s44 offen offset:1024 lds
  v_mfma_f32_16x16x32_bf16 v[108:111], a[172:175], a[52:55], v[108:111]
  ds_read_b64_tr_b16 a[166:167], v193 offset:4608
  v_mfma_f32_16x16x32_bf16 v[112:115], a[144:147], a[48:51], v[112:115]
  ds_read_b64_tr_b16 a[168:169], v190 offset:16384
  v_mfma_f32_16x16x32_bf16 v[116:119], a[144:147], a[52:55], v[116:119]
  ds_read_b64_tr_b16 a[170:171], v190 offset:16896
  v_mfma_f32_16x16x32_bf16 v[120:123], a[148:151], a[48:51], v[120:123]
  ds_read_b64_tr_b16 a[172:173], v191 offset:16384
  v_mfma_f32_16x16x32_bf16 v[124:127], a[148:151], a[52:55], v[124:127]
  ds_read_b64_tr_b16 a[174:175], v191 offset:16896
  buffer_load_dwordx2 v[240:241], v249, s[28:31], 0 offen sc1
  v_mfma_f32_16x16x32_bf16 v[64:67], a[152:155], a[56:59], v[64:67]
  ds_read_b64_tr_b16 a[144:145], v192 offset:16384
  v_mfma_f32_16x16x32_bf16 v[68:71], a[152:155], a[60:63], v[68:71]
  ds_read_b64_tr_b16 a[146:147], v192 offset:16896
  s_waitcnt lgkmcnt(4)
  v_mfma_f32_16x16x32_bf16 v[72:75], a[156:159], a[56:59], v[72:75]
  ds_read_b64_tr_b16 a[148:149], v193 offset:16384
  v_mfma_f32_16x16x32_bf16 v[76:79], a[156:159], a[60:63], v[76:79]
  ds_read_b64_tr_b16 a[150:151], v193 offset:16896
  v_mfma_f32_16x16x32_bf16 v[80:83], a[160:163], a[56:59], v[80:83]
  ds_read_b64_tr_b16 a[152:153], v190 offset:8192
  buffer_load_dwordx4 v205, s[8:11], s44 offen offset:2048 lds
  v_mfma_f32_16x16x32_bf16 v[84:87], a[160:163], a[60:63], v[84:87]
  ds_read_b64_tr_b16 a[154:155], v190 offset:8704
  v_mfma_f32_16x16x32_bf16 v[88:91], a[164:167], a[56:59], v[88:91]
  ds_read_b64_tr_b16 a[156:157], v191 offset:8192
  v_mfma_f32_16x16x32_bf16 v[92:95], a[164:167], a[60:63], v[92:95]
  ds_read_b64_tr_b16 a[158:159], v191 offset:8704
  v_mfma_f32_16x16x32_bf16 v[96:99], a[168:171], a[56:59], v[96:99]
  ds_read_b64_tr_b16 a[160:161], v192 offset:8192
  v_mfma_f32_16x16x32_bf16 v[100:103], a[168:171], a[60:63], v[100:103]
  ds_read_b64_tr_b16 a[162:163], v192 offset:8704
  s_waitcnt lgkmcnt(4)
  v_mfma_f32_16x16x32_bf16 v[104:107], a[172:175], a[56:59], v[104:107]
  ds_read_b64_tr_b16 a[164:165], v193 offset:8192
  s_add_u32 s63, s61, 4096
  buffer_store_dwordx4 v[32:35], v226, s[24:27], s63 offen sc1
  v_mfma_f32_16x16x32_bf16 v[108:111], a[172:175], a[60:63], v[108:111]
  ds_read_b64_tr_b16 a[166:167], v193 offset:8704
  v_max_f32 v4, 0, v4
  v_mfma_f32_16x16x32_bf16 v[112:115], a[144:147], a[56:59], v[112:115]
  ds_read_b64_tr_b16 a[168:169], v190 offset:20480
  v_mul_f32 v36, v216, v36
  v_max_f32 v5, 0, v5
  v_mfma_f32_16x16x32_bf16 v[116:119], a[144:147], a[60:63], v[116:119]
  ds_read_b64_tr_b16 a[170:171], v190 offset:20992
  v_mul_f32 v37, v216, v37
  v_mfma_f32_16x16x32_bf16 v[120:123], a[148:151], a[56:59], v[120:123]
  ds_read_b64_tr_b16 a[172:173], v191 offset:20480
  v_max_f32 v6, 0, v6
  v_mul_f32 v38, v216, v38
  v_mfma_f32_16x16x32_bf16 v[124:127], a[148:151], a[60:63], v[124:127]
  ds_read_b64_tr_b16 a[174:175], v191 offset:20992
  buffer_load_dwordx4 v206, s[8:11], s44 offen offset:3072 lds
  s_add_u32 m0, s46, 126976
  v_max_f32 v7, 0, v7
  v_mul_f32 v39, v216, v39
  buffer_load_dwordx4 v207, s[8:11], s44 offen lds
  buffer_load_dwordx4 v208, s[8:11], s44 offen offset:1024 lds
  v_mfma_f32_16x16x32_bf16 v[64:67], a[152:155], a[64:67], v[64:67]
  ds_read_b64_tr_b16 a[144:145], v192 offset:20480
  v_mul_f32 v4, v4, v36
  v_mul_f32 v5, v5, v37
  v_mfma_f32_16x16x32_bf16 v[68:71], a[152:155], a[68:71], v[68:71]
  ds_read_b64_tr_b16 a[146:147], v192 offset:20992
  s_waitcnt lgkmcnt(4)
  v_mfma_f32_16x16x32_bf16 v[72:75], a[156:159], a[64:67], v[72:75]
  ds_read_b64_tr_b16 a[148:149], v193 offset:20480
  v_mul_f32 v6, v6, v38
  s_waitcnt vmcnt(26)
  v_mfma_f32_16x16x32_bf16 v[76:79], a[156:159], a[68:71], v[76:79]
  ds_read_b64_tr_b16 a[150:151], v193 offset:20992
  s_barrier
  v_mfma_f32_16x16x32_bf16 v[80:83], a[160:163], a[64:67], v[80:83]
  ds_read_b64_tr_b16 a[152:153], v190 offset:24576
  s_add_u32 s44, s44, 884736
  s_add_u32 m0, s46, 73728
  v_mfma_f32_16x16x32_bf16 v[84:87], a[160:163], a[68:71], v[84:87]
  ds_read_b64_tr_b16 a[154:155], v190 offset:25088
  v_mul_f32 v7, v7, v39
  v_mfma_f32_16x16x32_bf16 v[88:91], a[164:167], a[64:67], v[88:91]
  ds_read_b64_tr_b16 a[156:157], v191 offset:24576
  v_max_f32 v12, 0, v12
  v_mul_f32 v44, v216, v44
  v_mfma_f32_16x16x32_bf16 v[92:95], a[164:167], a[68:71], v[92:95]
  ds_read_b64_tr_b16 a[158:159], v191 offset:25088
  buffer_load_dwordx4 v203, s[8:11], s44 offen lds
  v_mfma_f32_16x16x32_bf16 v[96:99], a[168:171], a[64:67], v[96:99]
  ds_read_b64_tr_b16 a[160:161], v192 offset:24576
  v_max_f32 v13, 0, v13
  v_mfma_f32_16x16x32_bf16 v[100:103], a[168:171], a[68:71], v[100:103]
  ds_read_b64_tr_b16 a[162:163], v192 offset:25088
  v_mul_f32 v45, v216, v45
  s_waitcnt lgkmcnt(4)
  v_mfma_f32_16x16x32_bf16 v[104:107], a[172:175], a[64:67], v[104:107]
  ds_read_b64_tr_b16 a[164:165], v193 offset:24576
  v_max_f32 v14, 0, v14
  v_mfma_f32_16x16x32_bf16 v[108:111], a[172:175], a[68:71], v[108:111]
  ds_read_b64_tr_b16 a[166:167], v193 offset:25088
  v_mul_f32 v46, v216, v46
  v_max_f32 v15, 0, v15
  v_mfma_f32_16x16x32_bf16 v[112:115], a[144:147], a[64:67], v[112:115]
  ds_read_b64_tr_b16 a[168:169], v190 offset:36864
  v_mul_f32 v47, v216, v47
  v_mfma_f32_16x16x32_bf16 v[116:119], a[144:147], a[68:71], v[116:119]
  ds_read_b64_tr_b16 a[170:171], v190 offset:37376
  v_mul_f32 v12, v12, v44
  v_mul_f32 v13, v13, v45
  v_mfma_f32_16x16x32_bf16 v[120:123], a[148:151], a[64:67], v[120:123]
  ds_read_b64_tr_b16 a[172:173], v191 offset:36864
  buffer_load_dwordx4 v204, s[8:11], s44 offen offset:1024 lds
  v_mfma_f32_16x16x32_bf16 v[124:127], a[148:151], a[68:71], v[124:127]
  ds_read_b64_tr_b16 a[174:175], v191 offset:37376
  v_mul_f32 v14, v14, v46
  v_mul_f32 v15, v15, v47
  v_mfma_f32_16x16x32_bf16 v[64:67], a[152:155], a[72:75], v[64:67]
  ds_read_b64_tr_b16 a[144:145], v192 offset:36864
  v_cvt_pk_bf16_f32 v36, v4, v5
  v_mfma_f32_16x16x32_bf16 v[68:71], a[152:155], a[76:79], v[68:71]
  ds_read_b64_tr_b16 a[146:147], v192 offset:37376
  s_waitcnt lgkmcnt(4)
  v_mfma_f32_16x16x32_bf16 v[72:75], a[156:159], a[72:75], v[72:75]
  ds_read_b64_tr_b16 a[148:149], v193 offset:36864
  v_cvt_pk_bf16_f32 v37, v6, v7
  v_cvt_pk_bf16_f32 v38, v12, v13
  v_mfma_f32_16x16x32_bf16 v[76:79], a[156:159], a[76:79], v[76:79]
  ds_read_b64_tr_b16 a[150:151], v193 offset:37376
  v_cvt_pk_bf16_f32 v39, v14, v15
  v_mfma_f32_16x16x32_bf16 v[80:83], a[160:163], a[72:75], v[80:83]
  ds_read_b64_tr_b16 a[152:153], v190 offset:28672
  v_accvgpr_write_b32 a196, v36
  v_accvgpr_write_b32 a197, v37
  v_mfma_f32_16x16x32_bf16 v[84:87], a[160:163], a[76:79], v[84:87]
  ds_read_b64_tr_b16 a[154:155], v190 offset:29184
  buffer_load_dwordx4 v205, s[8:11], s44 offen offset:2048 lds
  v_mfma_f32_16x16x32_bf16 v[88:91], a[164:167], a[72:75], v[88:91]
  ds_read_b64_tr_b16 a[156:157], v191 offset:28672
  s_waitcnt vmcnt(19)
  v_fmac_f32 v228, v221, v250
  v_fmac_f32 v229, v221, v251
  v_mfma_f32_16x16x32_bf16 v[92:95], a[164:167], a[76:79], v[92:95]
  ds_read_b64_tr_b16 a[158:159], v191 offset:29184
  v_fma_f32 v228, -v222, v251, v228
  v_mfma_f32_16x16x32_bf16 v[96:99], a[168:171], a[72:75], v[96:99]
  ds_read_b64_tr_b16 a[160:161], v192 offset:28672
  v_fmac_f32 v229, v222, v250
  v_accvgpr_write_b32 a198, v38
  v_mfma_f32_16x16x32_bf16 v[100:103], a[168:171], a[76:79], v[100:103]
  ds_read_b64_tr_b16 a[162:163], v192 offset:29184
  s_waitcnt lgkmcnt(4)
  v_mfma_f32_16x16x32_bf16 v[104:107], a[172:175], a[72:75], v[104:107]
  ds_read_b64_tr_b16 a[164:165], v193 offset:28672
  v_accvgpr_write_b32 a199, v39
  v_mfma_f32_16x16x32_bf16 v[108:111], a[172:175], a[76:79], v[108:111]
  ds_read_b64_tr_b16 a[166:167], v193 offset:29184
  s_add_u32 s63, s61, 4096
  buffer_store_dwordx4 v[36:39], v226, s[24:27], s63 offen offset:1024 sc1
  v_mfma_f32_16x16x32_bf16 v[112:115], a[144:147], a[72:75], v[112:115]
  ds_read_b64_tr_b16 a[168:169], v190 offset:40960
  v_max_f32 v16, 0, v16
  v_mfma_f32_16x16x32_bf16 v[116:119], a[144:147], a[76:79], v[116:119]
  ds_read_b64_tr_b16 a[170:171], v190 offset:41472
  v_mul_f32 v48, v215, v48
  v_max_f32 v17, 0, v17
  v_mfma_f32_16x16x32_bf16 v[120:123], a[148:151], a[72:75], v[120:123]
  ds_read_b64_tr_b16 a[172:173], v191 offset:40960
  v_mul_f32 v49, v215, v49
  v_mfma_f32_16x16x32_bf16 v[124:127], a[148:151], a[76:79], v[124:127]
  ds_read_b64_tr_b16 a[174:175], v191 offset:41472
  s_waitcnt vmcnt(18)
  v_fmac_f32 v230, v221, v228
  v_fmac_f32 v231, v221, v229
  v_mfma_f32_16x16x32_bf16 v[64:67], a[152:155], a[80:83], v[64:67]
  ds_read_b64_tr_b16 a[144:145], v192 offset:40960
  buffer_load_dwordx4 v206, s[8:11], s44 offen offset:3072 lds
  v_mfma_f32_16x16x32_bf16 v[68:71], a[152:155], a[84:87], v[68:71]
  ds_read_b64_tr_b16 a[146:147], v192 offset:41472
  s_add_u32 m0, s46, 77824
  s_waitcnt lgkmcnt(4)
  v_mfma_f32_16x16x32_bf16 v[72:75], a[156:159], a[80:83], v[72:75]
  ds_read_b64_tr_b16 a[148:149], v193 offset:40960
  v_fma_f32 v230, -v222, v229, v230
  v_mfma_f32_16x16x32_bf16 v[76:79], a[156:159], a[84:87], v[76:79]
  ds_read_b64_tr_b16 a[150:151], v193 offset:41472
  v_fmac_f32 v231, v222, v228
  v_mfma_f32_16x16x32_bf16 v[80:83], a[160:163], a[80:83], v[80:83]
  ds_read_b64_tr_b16 a[152:153], v190 offset:32768
  v_max_f32 v18, 0, v18
  v_mul_f32 v50, v215, v50
  v_mfma_f32_16x16x32_bf16 v[84:87], a[160:163], a[84:87], v[84:87]
  ds_read_b64_tr_b16 a[154:155], v190 offset:33280
  v_max_f32 v19, 0, v19
  v_mfma_f32_16x16x32_bf16 v[88:91], a[164:167], a[80:83], v[88:91]
  ds_read_b64_tr_b16 a[156:157], v191 offset:32768
  v_mul_f32 v51, v215, v51
  v_mul_f32 v16, v16, v48
  v_mfma_f32_16x16x32_bf16 v[92:95], a[164:167], a[84:87], v[92:95]
  ds_read_b64_tr_b16 a[158:159], v191 offset:33280
  buffer_load_dwordx4 v207, s[8:11], s44 offen lds
  v_mfma_f32_16x16x32_bf16 v[96:99], a[168:171], a[80:83], v[96:99]
  ds_read_b64_tr_b16 a[160:161], v192 offset:32768
  v_mul_f32 v17, v17, v49
  v_mul_f32 v18, v18, v50
  v_mfma_f32_16x16x32_bf16 v[100:103], a[168:171], a[84:87], v[100:103]
  ds_read_b64_tr_b16 a[162:163], v192 offset:33280
  s_waitcnt lgkmcnt(4)
  v_mfma_f32_16x16x32_bf16 v[104:107], a[172:175], a[80:83], v[104:107]
  ds_read_b64_tr_b16 a[164:165], v193 offset:32768
  s_waitcnt vmcnt(18)
  v_fmac_f32 v232, v221, v230
  v_fmac_f32 v233, v221, v231
  v_mfma_f32_16x16x32_bf16 v[108:111], a[172:175], a[84:87], v[108:111]
  ds_read_b64_tr_b16 a[166:167], v193 offset:33280
  v_fma_f32 v232, -v222, v231, v232
  v_mfma_f32_16x16x32_bf16 v[112:115], a[144:147], a[80:83], v[112:115]
  ds_read_b64_tr_b16 a[168:169], v190 offset:45056
  v_fmac_f32 v233, v222, v230
  v_mfma_f32_16x16x32_bf16 v[116:119], a[144:147], a[84:87], v[116:119]
  ds_read_b64_tr_b16 a[170:171], v190 offset:45568
  v_mul_f32 v19, v19, v51
  v_max_f32 v24, 0, v24
  v_mfma_f32_16x16x32_bf16 v[120:123], a[148:151], a[80:83], v[120:123]
  ds_read_b64_tr_b16 a[172:173], v191 offset:45056
  buffer_load_dwordx4 v208, s[8:11], s44 offen offset:1024 lds
  v_mfma_f32_16x16x32_bf16 v[124:127], a[148:151], a[84:87], v[124:127]
  ds_read_b64_tr_b16 a[174:175], v191 offset:45568
  s_waitcnt vmcnt(17)
  v_fmac_f32 v234, v221, v232
  v_mul_f32 v56, v215, v56
  v_mfma_f32_16x16x32_bf16 v[64:67], a[152:155], a[88:91], v[64:67]
  ds_read_b64_tr_b16 a[144:145], v192 offset:45056
  v_max_f32 v25, 0, v25
  v_mfma_f32_16x16x32_bf16 v[68:71], a[152:155], a[92:95], v[68:71]
  ds_read_b64_tr_b16 a[146:147], v192 offset:45568
  v_mul_f32 v57, v215, v57
  s_waitcnt lgkmcnt(4)
  v_mfma_f32_16x16x32_bf16 v[72:75], a[156:159], a[88:91], v[72:75]
  ds_read_b64_tr_b16 a[148:149], v193 offset:45056
  v_mfma_f32_16x16x32_bf16 v[76:79], a[156:159], a[92:95], v[76:79]
  ds_read_b64_tr_b16 a[150:151], v193 offset:45568
  v_max_f32 v26, 0, v26
  s_barrier
  v_mfma_f32_16x16x32_bf16 v[80:83], a[160:163], a[88:91], v[80:83]
  ds_read_b64_tr_b16 a[152:153], v194
  s_add_u32 s44, s44, 884736
  v_mfma_f32_16x16x32_bf16 v[84:87], a[160:163], a[92:95], v[84:87]
  ds_read_b64_tr_b16 a[154:155], v194 offset:512
  s_add_u32 m0, s46, 0
  s_nop 0
  buffer_load_dwordx4 v203, s[8:11], s44 offen lds
  v_mfma_f32_16x16x32_bf16 v[88:91], a[164:167], a[88:91], v[88:91]
  ds_read_b64_tr_b16 a[156:157], v195
  v_mul_f32 v58, v215, v58
  v_mfma_f32_16x16x32_bf16 v[92:95], a[164:167], a[92:95], v[92:95]
  ds_read_b64_tr_b16 a[158:159], v195 offset:512
  v_max_f32 v27, 0, v27
  v_mfma_f32_16x16x32_bf16 v[96:99], a[168:171], a[88:91], v[96:99]
  ds_read_b64_tr_b16 a[160:161], v196
  v_mul_f32 v59, v215, v59
  v_mul_f32 v24, v24, v56
  v_mfma_f32_16x16x32_bf16 v[100:103], a[168:171], a[92:95], v[100:103]
  ds_read_b64_tr_b16 a[162:163], v196 offset:512
  s_waitcnt lgkmcnt(4)
  v_mfma_f32_16x16x32_bf16 v[104:107], a[172:175], a[88:91], v[104:107]
  ds_read_b64_tr_b16 a[164:165], v197
  v_mul_f32 v25, v25, v57
  v_mul_f32 v26, v26, v58
  v_mfma_f32_16x16x32_bf16 v[108:111], a[172:175], a[92:95], v[108:111]
  ds_read_b64_tr_b16 a[166:167], v197 offset:512
  v_mul_f32 v27, v27, v59
  v_mfma_f32_16x16x32_bf16 v[112:115], a[144:147], a[88:91], v[112:115]
  ds_read_b64_tr_b16 a[168:169], v194 offset:12288
  buffer_load_dwordx4 v204, s[8:11], s44 offen offset:1024 lds
  v_cvt_pk_bf16_f32 v48, v16, v17
  v_mfma_f32_16x16x32_bf16 v[116:119], a[144:147], a[92:95], v[116:119]
  ds_read_b64_tr_b16 a[170:171], v194 offset:12800
  v_cvt_pk_bf16_f32 v49, v18, v19
  v_mfma_f32_16x16x32_bf16 v[120:123], a[148:151], a[88:91], v[120:123]
  ds_read_b64_tr_b16 a[172:173], v195 offset:12288
  v_cvt_pk_bf16_f32 v50, v24, v25
  v_cvt_pk_bf16_f32 v51, v26, v27
  v_mfma_f32_16x16x32_bf16 v[124:127], a[148:151], a[92:95], v[124:127]
  ds_read_b64_tr_b16 a[174:175], v195 offset:12800
  v_accvgpr_write_b32 a200, v48
  v_mfma_f32_16x16x32_bf16 v[64:67], a[152:155], a[96:99], v[64:67]
  ds_read_b64_tr_b16 a[144:145], v196 offset:12288
  v_accvgpr_write_b32 a201, v49
  v_mfma_f32_16x16x32_bf16 v[68:71], a[152:155], a[100:103], v[68:71]
  ds_read_b64_tr_b16 a[146:147], v196 offset:12800
  v_accvgpr_write_b32 a202, v50
  s_waitcnt lgkmcnt(4)
  v_mfma_f32_16x16x32_bf16 v[72:75], a[156:159], a[96:99], v[72:75]
  ds_read_b64_tr_b16 a[148:149], v197 offset:12288
  v_accvgpr_write_b32 a203, v51
  v_mfma_f32_16x16x32_bf16 v[76:79], a[156:159], a[100:103], v[76:79]
  ds_read_b64_tr_b16 a[150:151], v197 offset:12800
  buffer_load_dwordx4 v205, s[8:11], s44 offen offset:2048 lds
  v_fmac_f32 v235, v221, v233
  v_mfma_f32_16x16x32_bf16 v[80:83], a[160:163], a[96:99], v[80:83]
  ds_read_b64_tr_b16 a[152:153], v194 offset:4096
  v_fma_f32 v234, -v222, v233, v234
  v_mfma_f32_16x16x32_bf16 v[84:87], a[160:163], a[100:103], v[84:87]
  ds_read_b64_tr_b16 a[154:155], v194 offset:4608
  v_fmac_f32 v235, v222, v232
  s_waitcnt vmcnt(19)
  v_fmac_f32 v236, v221, v234
  v_mfma_f32_16x16x32_bf16 v[88:91], a[164:167], a[96:99], v[88:91]
  ds_read_b64_tr_b16 a[156:157], v195 offset:4096
  v_fmac_f32 v237, v221, v235
  v_mfma_f32_16x16x32_bf16 v[92:95], a[164:167], a[100:103], v[92:95]
  ds_read_b64_tr_b16 a[158:159], v195 offset:4608
  v_fma_f32 v236, -v222, v235, v236
  v_fmac_f32 v237, v222, v234
  v_mfma_f32_16x16x32_bf16 v[96:99], a[168:171], a[96:99], v[96:99]
  ds_read_b64_tr_b16 a[160:161], v196 offset:4096
  s_add_u32 s63, s61, 4096
  buffer_store_dwordx4 v[48:51], v226, s[24:27], s63 offen offset:2048 sc1
  v_mfma_f32_16x16x32_bf16 v[100:103], a[168:171], a[100:103], v[100:103]
  ds_read_b64_tr_b16 a[162:163], v196 offset:4608
  v_max_f32 v20, 0, v20
  s_waitcnt lgkmcnt(4)
  v_mfma_f32_16x16x32_bf16 v[104:107], a[172:175], a[96:99], v[104:107]
  ds_read_b64_tr_b16 a[164:165], v197 offset:4096
  v_mul_f32 v52, v216, v52
  v_max_f32 v21, 0, v21
  v_mfma_f32_16x16x32_bf16 v[108:111], a[172:175], a[100:103], v[108:111]
  ds_read_b64_tr_b16 a[166:167], v197 offset:4608
  v_mul_f32 v53, v216, v53
  v_mfma_f32_16x16x32_bf16 v[112:115], a[144:147], a[96:99], v[112:115]
  ds_read_b64_tr_b16 a[168:169], v194 offset:16384
  v_max_f32 v22, 0, v22
  v_mul_f32 v54, v216, v54
  v_mfma_f32_16x16x32_bf16 v[116:119], a[144:147], a[100:103], v[116:119]
  ds_read_b64_tr_b16 a[170:171], v194 offset:16896
  buffer_load_dwordx4 v206, s[8:11], s44 offen offset:3072 lds
  s_add_u32 m0, s46, 4096
  v_mfma_f32_16x16x32_bf16 v[120:123], a[148:151], a[96:99], v[120:123]
  ds_read_b64_tr_b16 a[172:173], v195 offset:16384
  v_max_f32 v23, 0, v23
  v_mfma_f32_16x16x32_bf16 v[124:127], a[148:151], a[100:103], v[124:127]
  ds_read_b64_tr_b16 a[174:175], v195 offset:16896
  v_mul_f32 v55, v216, v55
  v_mul_f32 v20, v20, v52
  v_mfma_f32_16x16x32_bf16 v[64:67], a[152:155], a[104:107], v[64:67]
  ds_read_b64_tr_b16 a[144:145], v196 offset:16384
  v_mul_f32 v21, v21, v53
  v_mfma_f32_16x16x32_bf16 v[68:71], a[152:155], a[108:111], v[68:71]
  ds_read_b64_tr_b16 a[146:147], v196 offset:16896
  v_mul_f32 v22, v22, v54
  s_waitcnt lgkmcnt(4)
  v_mfma_f32_16x16x32_bf16 v[72:75], a[156:159], a[104:107], v[72:75]
  ds_read_b64_tr_b16 a[148:149], v197 offset:16384
  v_mul_f32 v23, v23, v55
  v_max_f32 v28, 0, v28
  v_mfma_f32_16x16x32_bf16 v[76:79], a[156:159], a[108:111], v[76:79]
  ds_read_b64_tr_b16 a[150:151], v197 offset:16896
  v_mul_f32 v60, v216, v60
  v_mfma_f32_16x16x32_bf16 v[80:83], a[160:163], a[104:107], v[80:83]
  ds_read_b64_tr_b16 a[152:153], v194 offset:8192
  buffer_load_dwordx4 v207, s[8:11], s44 offen lds
  v_max_f32 v29, 0, v29
  v_mfma_f32_16x16x32_bf16 v[84:87], a[160:163], a[108:111], v[84:87]
  ds_read_b64_tr_b16 a[154:155], v194 offset:8704
  v_mul_f32 v61, v216, v61
  v_mfma_f32_16x16x32_bf16 v[88:91], a[164:167], a[104:107], v[88:91]
  ds_read_b64_tr_b16 a[156:157], v195 offset:8192
  v_max_f32 v30, 0, v30
  v_mul_f32 v62, v216, v62
  v_mfma_f32_16x16x32_bf16 v[92:95], a[164:167], a[108:111], v[92:95]
  ds_read_b64_tr_b16 a[158:159], v195 offset:8704
  v_max_f32 v31, 0, v31
  v_mul_f32 v63, v216, v63
  v_mfma_f32_16x16x32_bf16 v[96:99], a[168:171], a[104:107], v[96:99]
  ds_read_b64_tr_b16 a[160:161], v196 offset:8192
  v_mul_f32 v28, v28, v60
  v_mfma_f32_16x16x32_bf16 v[100:103], a[168:171], a[108:111], v[100:103]
  ds_read_b64_tr_b16 a[162:163], v196 offset:8704
  v_mul_f32 v29, v29, v61
  s_waitcnt lgkmcnt(4)
  v_mfma_f32_16x16x32_bf16 v[104:107], a[172:175], a[104:107], v[104:107]
  ds_read_b64_tr_b16 a[164:165], v197 offset:8192
  v_mul_f32 v30, v30, v62
  v_mfma_f32_16x16x32_bf16 v[108:111], a[172:175], a[108:111], v[108:111]
  ds_read_b64_tr_b16 a[166:167], v197 offset:8704
  buffer_load_dwordx4 v208, s[8:11], s44 offen offset:1024 lds
  v_mul_f32 v31, v31, v63
  v_mfma_f32_16x16x32_bf16 v[112:115], a[144:147], a[104:107], v[112:115]
  ds_read_b64_tr_b16 a[168:169], v194 offset:20480
  v_cvt_pk_bf16_f32 v52, v20, v21
  v_cvt_pk_bf16_f32 v53, v22, v23
  v_mfma_f32_16x16x32_bf16 v[116:119], a[144:147], a[108:111], v[116:119]
  ds_read_b64_tr_b16 a[170:171], v194 offset:20992
  v_cvt_pk_bf16_f32 v54, v28, v29
  v_mfma_f32_16x16x32_bf16 v[120:123], a[148:151], a[104:107], v[120:123]
  ds_read_b64_tr_b16 a[172:173], v195 offset:20480
  v_cvt_pk_bf16_f32 v55, v30, v31
  v_accvgpr_write_b32 a204, v52
  v_mfma_f32_16x16x32_bf16 v[124:127], a[148:151], a[108:111], v[124:127]
  ds_read_b64_tr_b16 a[174:175], v195 offset:20992
  v_accvgpr_write_b32 a205, v53
  v_accvgpr_write_b32 a206, v54
  v_mfma_f32_16x16x32_bf16 v[64:67], a[152:155], a[112:115], v[64:67]
  ds_read_b64_tr_b16 a[144:145], v196 offset:20480
  v_accvgpr_write_b32 a207, v55
  v_mfma_f32_16x16x32_bf16 v[68:71], a[152:155], a[116:119], v[68:71]
  ds_read_b64_tr_b16 a[146:147], v196 offset:20992
  s_add_u32 s63, s61, 4096
  buffer_store_dwordx4 v[52:55], v226, s[24:27], s63 offen offset:3072 sc1
  s_waitcnt lgkmcnt(4)
  v_mfma_f32_16x16x32_bf16 v[72:75], a[156:159], a[112:115], v[72:75]
  ds_read_b64_tr_b16 a[148:149], v197 offset:20480
  v_mfma_f32_16x16x32_bf16 v[76:79], a[156:159], a[116:119], v[76:79]
  ds_read_b64_tr_b16 a[150:151], v197 offset:20992
  s_waitcnt vmcnt(22)
  v_fmac_f32 v238, v221, v236
  s_barrier
  v_mfma_f32_16x16x32_bf16 v[80:83], a[160:163], a[112:115], v[80:83]
  ds_read_b64_tr_b16 a[152:153], v198
  v_fmac_f32 v239, v221, v237
  v_mfma_f32_16x16x32_bf16 v[84:87], a[160:163], a[116:119], v[84:87]
  ds_read_b64_tr_b16 a[154:155], v198 offset:512
  v_fma_f32 v238, -v222, v237, v238
  v_mfma_f32_16x16x32_bf16 v[88:91], a[164:167], a[112:115], v[88:91]
  ds_read_b64_tr_b16 a[156:157], v199
  v_fmac_f32 v239, v222, v236
  s_waitcnt vmcnt(20)
  v_fmac_f32 v240, v221, v238
  v_mfma_f32_16x16x32_bf16 v[92:95], a[164:167], a[116:119], v[92:95]
  ds_read_b64_tr_b16 a[158:159], v199 offset:512
  v_fmac_f32 v241, v221, v239
  v_mfma_f32_16x16x32_bf16 v[96:99], a[168:171], a[112:115], v[96:99]
  ds_read_b64_tr_b16 a[160:161], v200
  v_fma_f32 v240, -v222, v239, v240
  v_fmac_f32 v241, v222, v238
  v_mfma_f32_16x16x32_bf16 v[100:103], a[168:171], a[116:119], v[100:103]
  ds_read_b64_tr_b16 a[162:163], v200 offset:512
  s_waitcnt lgkmcnt(4)
  v_mfma_f32_16x16x32_bf16 v[104:107], a[172:175], a[112:115], v[104:107]
  ds_read_b64_tr_b16 a[164:165], v201
  v_mov_b32 v250, v240
  v_mov_b32 v251, v241
  v_mfma_f32_16x16x32_bf16 v[108:111], a[172:175], a[116:119], v[108:111]
  ds_read_b64_tr_b16 a[166:167], v201 offset:512
  s_sub_u32 s49, s40, 3
  s_max_i32 s49, s49, 0
  s_mul_i32 s49, s49, 384
  s_add_u32 s49, s49, 159744
  v_mfma_f32_16x16x32_bf16 v[112:115], a[144:147], a[112:115], v[112:115]
  ds_read_b64_tr_b16 a[168:169], v198 offset:12288
  s_add_u32 s44, s44, 884736
  v_mfma_f32_16x16x32_bf16 v[116:119], a[144:147], a[116:119], v[116:119]
  ds_read_b64_tr_b16 a[170:171], v198 offset:12800
  s_add_u32 m0, s46, 24576
  s_nop 0
  buffer_load_dwordx4 v203, s[8:11], s44 offen lds
  v_mfma_f32_16x16x32_bf16 v[120:123], a[148:151], a[112:115], v[120:123]
  ds_read_b64_tr_b16 a[172:173], v199 offset:12288
  v_add_u32 v248, s49, v227
  v_mfma_f32_16x16x32_bf16 v[124:127], a[148:151], a[116:119], v[124:127]
  ds_read_b64_tr_b16 a[174:175], v199 offset:12800
  ds_read_b64 v[228:229], v248
  s_sub_u32 s49, s40, 2
  s_max_i32 s49, s49, 0
  s_mul_i32 s49, s49, 384
  s_add_u32 s49, s49, 159744
  v_mfma_f32_16x16x32_bf16 v[64:67], a[152:155], a[120:123], v[64:67]
  ds_read_b64_tr_b16 a[144:145], v200 offset:12288
  v_add_u32 v248, s49, v227
  v_mfma_f32_16x16x32_bf16 v[68:71], a[152:155], a[124:127], v[68:71]
  ds_read_b64_tr_b16 a[146:147], v200 offset:12800
  s_waitcnt lgkmcnt(5)
  v_mfma_f32_16x16x32_bf16 v[72:75], a[156:159], a[120:123], v[72:75]
  ds_read_b64_tr_b16 a[148:149], v201 offset:12288
  ds_read_b64 v[230:231], v248
  s_sub_u32 s49, s40, 1
  s_max_i32 s49, s49, 0
  s_mul_i32 s49, s49, 384
  s_add_u32 s49, s49, 159744
  v_mfma_f32_16x16x32_bf16 v[76:79], a[156:159], a[124:127], v[76:79]
  ds_read_b64_tr_b16 a[150:151], v201 offset:12800
  v_add_u32 v248, s49, v227
  v_mfma_f32_16x16x32_bf16 v[80:83], a[160:163], a[120:123], v[80:83]
  ds_read_b64_tr_b16 a[152:153], v198 offset:4096
  buffer_load_dwordx4 v204, s[8:11], s44 offen offset:1024 lds
  ds_read_b64 v[232:233], v248
  v_mfma_f32_16x16x32_bf16 v[84:87], a[160:163], a[124:127], v[84:87]
  ds_read_b64_tr_b16 a[154:155], v198 offset:4608
  v_mfma_f32_16x16x32_bf16 v[88:91], a[164:167], a[120:123], v[88:91]
  ds_read_b64_tr_b16 a[156:157], v199 offset:4096
  v_mfma_f32_16x16x32_bf16 v[92:95], a[164:167], a[124:127], v[92:95]
  ds_read_b64_tr_b16 a[158:159], v199 offset:4608
  s_waitcnt lgkmcnt(10)
  v_mul_f32 v228, s60, v228
  v_mul_f32 v229, s60, v229
  v_mfma_f32_16x16x32_bf16 v[96:99], a[168:171], a[120:123], v[96:99]
  ds_read_b64_tr_b16 a[160:161], v200 offset:4096
  v_mfma_f32_16x16x32_bf16 v[100:103], a[168:171], a[124:127], v[100:103]
  ds_read_b64_tr_b16 a[162:163], v200 offset:4608
  s_waitcnt lgkmcnt(4)
  v_mfma_f32_16x16x32_bf16 v[104:107], a[172:175], a[120:123], v[104:107]
  ds_read_b64_tr_b16 a[164:165], v201 offset:4096
  v_mul_f32 v230, s59, v230
  v_mfma_f32_16x16x32_bf16 v[108:111], a[172:175], a[124:127], v[108:111]
  ds_read_b64_tr_b16 a[166:167], v201 offset:4608
  buffer_load_dwordx4 v205, s[8:11], s44 offen offset:2048 lds
  v_mul_f32 v231, s59, v231
  v_mfma_f32_16x16x32_bf16 v[112:115], a[144:147], a[120:123], v[112:115]
  ds_read_b64_tr_b16 a[168:169], v198 offset:16384
  v_mul_f32 v232, s58, v232
  v_mfma_f32_16x16x32_bf16 v[116:119], a[144:147], a[124:127], v[116:119]
  ds_read_b64_tr_b16 a[170:171], v198 offset:16896
  v_mul_f32 v233, s58, v233
  v_mfma_f32_16x16x32_bf16 v[120:123], a[148:151], a[120:123], v[120:123]
  ds_read_b64_tr_b16 a[172:173], v199 offset:16384
  v_fmac_f32 v230, v219, v228
  v_fmac_f32 v231, v219, v229
  v_mfma_f32_16x16x32_bf16 v[124:127], a[148:151], a[124:127], v[124:127]
  ds_read_b64_tr_b16 a[174:175], v199 offset:16896
  v_fma_f32 v230, -v220, v229, v230
  v_mfma_f32_16x16x32_bf16 v[64:67], a[152:155], a[128:131], v[64:67]
  ds_read_b64_tr_b16 a[144:145], v200 offset:16384
  v_fmac_f32 v231, v220, v228
  v_fmac_f32 v232, v219, v230
  v_mfma_f32_16x16x32_bf16 v[68:71], a[152:155], a[132:135], v[68:71]
  ds_read_b64_tr_b16 a[146:147], v200 offset:16896
  s_waitcnt lgkmcnt(4)
  v_mfma_f32_16x16x32_bf16 v[72:75], a[156:159], a[128:131], v[72:75]
  ds_read_b64_tr_b16 a[148:149], v201 offset:16384
  buffer_load_dwordx4 v206, s[8:11], s44 offen offset:3072 lds
  v_mfma_f32_16x16x32_bf16 v[76:79], a[156:159], a[132:135], v[76:79]
  ds_read_b64_tr_b16 a[150:151], v201 offset:16896
  s_add_u32 m0, s46, 28672
  v_fmac_f32 v233, v219, v231
  v_mfma_f32_16x16x32_bf16 v[80:83], a[160:163], a[128:131], v[80:83]
  ds_read_b64_tr_b16 a[152:153], v198 offset:8192
  v_fma_f32 v232, -v220, v231, v232
  v_mfma_f32_16x16x32_bf16 v[84:87], a[160:163], a[132:135], v[84:87]
  ds_read_b64_tr_b16 a[154:155], v198 offset:8704
  v_fmac_f32 v233, v220, v230
  v_fmac_f32 v232, v223, v250
  v_mfma_f32_16x16x32_bf16 v[88:91], a[164:167], a[128:131], v[88:91]
  ds_read_b64_tr_b16 a[156:157], v199 offset:8192
  v_fmac_f32 v233, v223, v251
  v_mfma_f32_16x16x32_bf16 v[92:95], a[164:167], a[132:135], v[92:95]
  ds_read_b64_tr_b16 a[158:159], v199 offset:8704
  v_fma_f32 v232, -v224, v251, v232
  v_mfma_f32_16x16x32_bf16 v[96:99], a[168:171], a[128:131], v[96:99]
  ds_read_b64_tr_b16 a[160:161], v200 offset:8192
  v_fmac_f32 v233, v224, v250
  v_mov_b32 v250, v232
  v_mfma_f32_16x16x32_bf16 v[100:103], a[168:171], a[132:135], v[100:103]
  ds_read_b64_tr_b16 a[162:163], v200 offset:8704
  s_waitcnt lgkmcnt(4)
  v_mfma_f32_16x16x32_bf16 v[104:107], a[172:175], a[128:131], v[104:107]
  ds_read_b64_tr_b16 a[164:165], v201 offset:8192
  buffer_load_dwordx4 v207, s[8:11], s44 offen lds
  v_mov_b32 v251, v233
  v_mfma_f32_16x16x32_bf16 v[108:111], a[172:175], a[132:135], v[108:111]
  ds_read_b64_tr_b16 a[166:167], v201 offset:8704
  ds_read_b64 v[228:229], v246 offset:0
  v_mfma_f32_16x16x32_bf16 v[112:115], a[144:147], a[128:131], v[112:115]
  ds_read_b64_tr_b16 a[168:169], v198 offset:20480
  ds_read_b64 v[230:231], v246 offset:384
  ds_read_b64 v[232:233], v246 offset:768
  v_mfma_f32_16x16x32_bf16 v[116:119], a[144:147], a[132:135], v[116:119]
  ds_read_b64_tr_b16 a[170:171], v198 offset:20992
  ds_read_b64 v[234:235], v246 offset:1152
  v_mfma_f32_16x16x32_bf16 v[120:123], a[148:151], a[128:131], v[120:123]
  ds_read_b64_tr_b16 a[172:173], v199 offset:20480
  ds_read_b64 v[236:237], v246 offset:1536
  v_mfma_f32_16x16x32_bf16 v[124:127], a[148:151], a[132:135], v[124:127]
  ds_read_b64_tr_b16 a[174:175], v199 offset:20992
  s_waitcnt lgkmcnt(14)
  ds_read_b64 v[238:239], v246 offset:1920
  s_waitcnt lgkmcnt(14)
  ds_read_b64 v[240:241], v246 offset:2304
  buffer_load_dwordx4 v208, s[8:11], s44 offen offset:1024 lds
  v_mfma_f32_16x16x32_bf16 v[64:67], a[152:155], a[136:139], v[64:67]
  s_waitcnt lgkmcnt(14)
  ds_read_b64_tr_b16 a[144:145], v200 offset:20480
  s_waitcnt lgkmcnt(14)
  ds_write_b64 v246, v[250:251]
  v_mfma_f32_16x16x32_bf16 v[68:71], a[152:155], a[140:143], v[68:71]
  s_waitcnt lgkmcnt(14)
  ds_read_b64_tr_b16 a[146:147], v200 offset:20992
  s_waitcnt lgkmcnt(9)
  v_mfma_f32_16x16x32_bf16 v[72:75], a[156:159], a[136:139], v[72:75]
  ds_read_b64_tr_b16 a[148:149], v201 offset:20480
  s_waitcnt vmcnt(21)
  v_mfma_f32_16x16x32_bf16 v[76:79], a[156:159], a[140:143], v[76:79]
  ds_read_b64_tr_b16 a[150:151], v201 offset:20992
  s_barrier
  v_mfma_f32_16x16x32_bf16 v[80:83], a[160:163], a[136:139], v[80:83]
  ds_read_b64_tr_b16 a[152:153], v198 offset:24576
  s_add_u32 s44, s44, 884736
  s_add_u32 m0, s46, 49152
  v_mfma_f32_16x16x32_bf16 v[84:87], a[160:163], a[140:143], v[84:87]
  ds_read_b64_tr_b16 a[154:155], v198 offset:25088
  v_fmac_f32 v228, v217, v250
  v_mfma_f32_16x16x32_bf16 v[88:91], a[164:167], a[136:139], v[88:91]
  ds_read_b64_tr_b16 a[156:157], v199 offset:24576
  v_fmac_f32 v229, v217, v251
  v_fma_f32 v228, -v218, v251, v228
  v_mfma_f32_16x16x32_bf16 v[92:95], a[164:167], a[140:143], v[92:95]
  ds_read_b64_tr_b16 a[158:159], v199 offset:25088
  buffer_load_dwordx4 v203, s[8:11], s44 offen lds
  v_mfma_f32_16x16x32_bf16 v[96:99], a[168:171], a[136:139], v[96:99]
  s_waitcnt lgkmcnt(14)
  ds_read_b64_tr_b16 a[160:161], v200 offset:24576
  v_fmac_f32 v229, v218, v250
  v_mfma_f32_16x16x32_bf16 v[100:103], a[168:171], a[140:143], v[100:103]
  s_waitcnt lgkmcnt(14)
  ds_read_b64_tr_b16 a[162:163], v200 offset:25088
  s_waitcnt lgkmcnt(14)
  ds_write_b64 v246, v[228:229] offset:384
  s_waitcnt lgkmcnt(5)
  v_mfma_f32_16x16x32_bf16 v[104:107], a[172:175], a[136:139], v[104:107]
  ds_read_b64_tr_b16 a[164:165], v201 offset:24576
  v_fmac_f32 v230, v217, v228
  v_mfma_f32_16x16x32_bf16 v[108:111], a[172:175], a[140:143], v[108:111]
  ds_read_b64_tr_b16 a[166:167], v201 offset:25088
  v_fmac_f32 v231, v217, v229
  v_fma_f32 v230, -v218, v229, v230
  v_mfma_f32_16x16x32_bf16 v[112:115], a[144:147], a[136:139], v[112:115]
  ds_read_b64_tr_b16 a[168:169], v198 offset:36864
  v_fmac_f32 v231, v218, v228
  v_mfma_f32_16x16x32_bf16 v[116:119], a[144:147], a[140:143], v[116:119]
  ds_read_b64_tr_b16 a[170:171], v198 offset:37376
  ds_write_b64 v246, v[230:231] offset:768
  v_fmac_f32 v232, v217, v230
  v_mfma_f32_16x16x32_bf16 v[120:123], a[148:151], a[136:139], v[120:123]
  ds_read_b64_tr_b16 a[172:173], v199 offset:36864
  buffer_load_dwordx4 v204, s[8:11], s44 offen offset:1024 lds
  v_mfma_f32_16x16x32_bf16 v[124:127], a[148:151], a[140:143], v[124:127]
  ds_read_b64_tr_b16 a[174:175], v199 offset:37376
  v_fmac_f32 v233, v217, v231
  v_mfma_f32_16x16x32_bf16 v[0:3], a[152:155], a[0:3], 0
  ds_read_b64_tr_b16 a[144:145], v200 offset:36864
  v_fma_f32 v232, -v218, v231, v232
  v_fmac_f32 v233, v218, v230
  v_mfma_f32_16x16x32_bf16 v[4:7], a[152:155], a[4:7], 0
  ds_read_b64_tr_b16 a[146:147], v200 offset:37376
  s_waitcnt lgkmcnt(5)
  v_mfma_f32_16x16x32_bf16 v[8:11], a[156:159], a[0:3], 0
  ds_read_b64_tr_b16 a[148:149], v201 offset:36864
  ds_write_b64 v246, v[232:233] offset:1152
  v_fmac_f32 v234, v217, v232
  v_mfma_f32_16x16x32_bf16 v[12:15], a[156:159], a[4:7], 0
  ds_read_b64_tr_b16 a[150:151], v201 offset:37376
  v_fmac_f32 v235, v217, v233
  v_mfma_f32_16x16x32_bf16 v[16:19], a[160:163], a[0:3], 0
  ds_read_b64_tr_b16 a[152:153], v198 offset:28672
  v_fma_f32 v234, -v218, v233, v234
  v_mfma_f32_16x16x32_bf16 v[20:23], a[160:163], a[4:7], 0
  ds_read_b64_tr_b16 a[154:155], v198 offset:29184
  buffer_load_dwordx4 v205, s[8:11], s44 offen offset:2048 lds
  v_fmac_f32 v235, v218, v232
  v_mfma_f32_16x16x32_bf16 v[24:27], a[164:167], a[0:3], 0
  ds_read_b64_tr_b16 a[156:157], v199 offset:28672
  ds_write_b64 v246, v[234:235] offset:1536
  v_mfma_f32_16x16x32_bf16 v[28:31], a[164:167], a[4:7], 0
  ds_read_b64_tr_b16 a[158:159], v199 offset:29184
  v_fmac_f32 v236, v217, v234
  v_fmac_f32 v237, v217, v235
  v_mfma_f32_16x16x32_bf16 v[32:35], a[168:171], a[0:3], 0
  ds_read_b64_tr_b16 a[160:161], v200 offset:28672
  v_fma_f32 v236, -v218, v235, v236
  v_mfma_f32_16x16x32_bf16 v[36:39], a[168:171], a[4:7], 0
  ds_read_b64_tr_b16 a[162:163], v200 offset:29184
  s_waitcnt lgkmcnt(5)
  v_mfma_f32_16x16x32_bf16 v[40:43], a[172:175], a[0:3], 0
  ds_read_b64_tr_b16 a[164:165], v201 offset:28672
  v_fmac_f32 v237, v218, v234
  ds_write_b64 v246, v[236:237] offset:1920
  v_mfma_f32_16x16x32_bf16 v[44:47], a[172:175], a[4:7], 0
  ds_read_b64_tr_b16 a[166:167], v201 offset:29184
  v_fmac_f32 v238, v217, v236
  v_mfma_f32_16x16x32_bf16 v[48:51], a[144:147], a[0:3], 0
  ds_read_b64_tr_b16 a[168:169], v198 offset:40960
  buffer_load_dwordx4 v206, s[8:11], s44 offen offset:3072 lds
  s_add_u32 m0, s46, 53248
  v_mfma_f32_16x16x32_bf16 v[52:55], a[144:147], a[4:7], 0
  ds_read_b64_tr_b16 a[170:171], v198 offset:41472
  v_fmac_f32 v239, v217, v237
  v_mfma_f32_16x16x32_bf16 v[56:59], a[148:151], a[0:3], 0
  ds_read_b64_tr_b16 a[172:173], v199 offset:40960
  v_fma_f32 v238, -v218, v237, v238
  v_fmac_f32 v239, v218, v236
  v_mfma_f32_16x16x32_bf16 v[60:63], a[148:151], a[4:7], 0
  ds_read_b64_tr_b16 a[174:175], v199 offset:41472
  ds_write_b64 v246, v[238:239] offset:2304
  v_mfma_f32_16x16x32_bf16 v[0:3], a[152:155], a[8:11], v[0:3]
  ds_read_b64_tr_b16 a[144:145], v200 offset:40960
  v_fmac_f32 v240, v217, v238
  v_mfma_f32_16x16x32_bf16 v[4:7], a[152:155], a[12:15], v[4:7]
  ds_read_b64_tr_b16 a[146:147], v200 offset:41472
  v_fmac_f32 v241, v217, v239
  s_waitcnt lgkmcnt(5)
  v_mfma_f32_16x16x32_bf16 v[8:11], a[156:159], a[8:11], v[8:11]
  ds_read_b64_tr_b16 a[148:149], v201 offset:40960
  v_fma_f32 v240, -v218, v239, v240
  v_mfma_f32_16x16x32_bf16 v[12:15], a[156:159], a[12:15], v[12:15]
  ds_read_b64_tr_b16 a[150:151], v201 offset:41472
  buffer_load_dwordx4 v207, s[8:11], s44 offen lds
  v_fmac_f32 v241, v218, v238
  v_mfma_f32_16x16x32_bf16 v[16:19], a[160:163], a[8:11], v[16:19]
  ds_read_b64_tr_b16 a[152:153], v198 offset:32768
  ds_write_b64 v246, v[240:241] offset:2688
  v_mfma_f32_16x16x32_bf16 v[20:23], a[160:163], a[12:15], v[20:23]
  ds_read_b64_tr_b16 a[154:155], v198 offset:33280
  v_and_b32 v248, 15, v225
  v_mfma_f32_16x16x32_bf16 v[24:27], a[164:167], a[8:11], v[24:27]
  ds_read_b64_tr_b16 a[156:157], v199 offset:32768
  v_lshlrev_b32 v248, 5, v248
  v_lshrrev_b32 v249, 4, v225
  v_mfma_f32_16x16x32_bf16 v[28:31], a[164:167], a[12:15], v[28:31]
  ds_read_b64_tr_b16 a[158:159], v199 offset:33280
  v_lshlrev_b32 v249, 3, v249
  v_mfma_f32_16x16x32_bf16 v[32:35], a[168:171], a[8:11], v[32:35]
  ds_read_b64_tr_b16 a[160:161], v200 offset:32768
  v_add_u32 v248, v248, v249
  v_max_f32 v64, 0, v64
  v_mfma_f32_16x16x32_bf16 v[36:39], a[168:171], a[12:15], v[36:39]
  ds_read_b64_tr_b16 a[162:163], v200 offset:33280
  s_waitcnt lgkmcnt(4)
  v_mfma_f32_16x16x32_bf16 v[40:43], a[172:175], a[8:11], v[40:43]
  ds_read_b64_tr_b16 a[164:165], v201 offset:32768
  buffer_load_dwordx4 v208, s[8:11], s44 offen offset:1024 lds
  v_mfma_f32_16x16x32_bf16 v[44:47], a[172:175], a[12:15], v[44:47]
  ds_read_b64_tr_b16 a[166:167], v201 offset:33280
  v_add_u32 v248, s47, v248
  v_mul_f32 v96, v215, v96
  v_mfma_f32_16x16x32_bf16 v[48:51], a[144:147], a[8:11], v[48:51]
  ds_read_b64_tr_b16 a[168:169], v198 offset:45056
  v_add_u32 v248, 147456, v248
  v_mfma_f32_16x16x32_bf16 v[52:55], a[144:147], a[12:15], v[52:55]
  ds_read_b64_tr_b16 a[170:171], v198 offset:45568
  v_lshlrev_b32 v249, 3, v225
  v_max_f32 v65, 0, v65
  v_mfma_f32_16x16x32_bf16 v[56:59], a[148:151], a[8:11], v[56:59]
  ds_read_b64_tr_b16 a[172:173], v199 offset:45056
  v_add_u32 v249, s47, v249
  v_mfma_f32_16x16x32_bf16 v[60:63], a[148:151], a[12:15], v[60:63]
  ds_read_b64_tr_b16 a[174:175], v199 offset:45568
  v_add_u32 v249, 147456, v249
  v_mfma_f32_16x16x32_bf16 v[0:3], a[152:155], a[16:19], v[0:3]
  ds_read_b64_tr_b16 a[144:145], v200 offset:45056
  ds_read_b64 v[228:229], v244 offset:0
  ds_read_b64 v[230:231], v244 offset:128
  v_mfma_f32_16x16x32_bf16 v[4:7], a[152:155], a[20:23], v[4:7]
  ds_read_b64_tr_b16 a[146:147], v200 offset:45568
  s_waitcnt lgkmcnt(6)
  v_mfma_f32_16x16x32_bf16 v[8:11], a[156:159], a[16:19], v[8:11]
  ds_read_b64_tr_b16 a[148:149], v201 offset:45056
  ds_read_b128 v[234:237], v247 offset:0
  s_waitcnt vmcnt(20)
  v_mfma_f32_16x16x32_bf16 v[12:15], a[156:159], a[20:23], v[12:15]
  ds_read_b64_tr_b16 a[150:151], v201 offset:45568
  s_barrier
  v_mfma_f32_16x16x32_bf16 v[16:19], a[160:163], a[16:19], v[16:19]
  ds_read_b64_tr_b16 a[152:153], v194 offset:24576
  s_add_u32 s44, s44, 884736
  s_add_u32 m0, s46, 98304
  v_mfma_f32_16x16x32_bf16 v[20:23], a[160:163], a[20:23], v[20:23]
  ds_read_b64_tr_b16 a[154:155], v194 offset:25088
  buffer_load_dwordx4 v203, s[8:11], s44 offen lds
  v_mfma_f32_16x16x32_bf16 v[24:27], a[164:167], a[16:19], v[24:27]
  ds_read_b64_tr_b16 a[156:157], v195 offset:24576
  ds_read_b128 v[238:241], v247 offset:16
  v_mfma_f32_16x16x32_bf16 v[28:31], a[164:167], a[20:23], v[28:31]
  ds_read_b64_tr_b16 a[158:159], v195 offset:25088
  ds_read_b64 v[242:243], v247 offset:32
  v_mul_f32 v97, v215, v97
  v_mfma_f32_16x16x32_bf16 v[32:35], a[168:171], a[16:19], v[32:35]
  s_waitcnt lgkmcnt(14)
  ds_read_b64_tr_b16 a[160:161], v196 offset:24576
  v_max_f32 v66, 0, v66
  v_mfma_f32_16x16x32_bf16 v[36:39], a[168:171], a[20:23], v[36:39]
  s_waitcnt lgkmcnt(14)
  ds_read_b64_tr_b16 a[162:163], v196 offset:25088
  v_mul_f32 v98, v215, v98
  s_waitcnt lgkmcnt(6)
  v_mfma_f32_16x16x32_bf16 v[40:43], a[172:175], a[16:19], v[40:43]
  ds_read_b64_tr_b16 a[164:165], v197 offset:24576
  v_fmac_f32 v128, v234, v228
  v_mfma_f32_16x16x32_bf16 v[44:47], a[172:175], a[20:23], v[44:47]
  ds_read_b64_tr_b16 a[166:167], v197 offset:25088
  v_fmac_f32 v136, v234, v229
  v_mfma_f32_16x16x32_bf16 v[48:51], a[144:147], a[16:19], v[48:51]
  ds_read_b64_tr_b16 a[168:169], v194 offset:36864
  buffer_load_dwordx4 v204, s[8:11], s44 offen offset:1024 lds
  v_fma_f32 v128, -v235, v229, v128
  v_mfma_f32_16x16x32_bf16 v[52:55], a[144:147], a[20:23], v[52:55]
  ds_read_b64_tr_b16 a[170:171], v194 offset:37376
  v_fmac_f32 v136, v235, v228
  v_mfma_f32_16x16x32_bf16 v[56:59], a[148:151], a[16:19], v[56:59]
  ds_read_b64_tr_b16 a[172:173], v195 offset:36864
  v_fmac_f32 v129, v236, v228
  v_fmac_f32 v137, v236, v229
  v_mfma_f32_16x16x32_bf16 v[60:63], a[148:151], a[20:23], v[60:63]
  ds_read_b64_tr_b16 a[174:175], v195 offset:37376
  v_fma_f32 v129, -v237, v229, v129
  v_mfma_f32_16x16x32_bf16 v[0:3], a[152:155], a[24:27], v[0:3]
  ds_read_b64_tr_b16 a[144:145], v196 offset:36864
  v_fmac_f32 v137, v237, v228
  v_mfma_f32_16x16x32_bf16 v[4:7], a[152:155], a[28:31], v[4:7]
  ds_read_b64_tr_b16 a[146:147], v196 offset:37376
  s_waitcnt lgkmcnt(12)
  v_fmac_f32 v130, v238, v228
  s_waitcnt lgkmcnt(4)
  v_mfma_f32_16x16x32_bf16 v[8:11], a[156:159], a[24:27], v[8:11]
  ds_read_b64_tr_b16 a[148:149], v197 offset:36864
  v_fmac_f32 v138, v238, v229
  v_mfma_f32_16x16x32_bf16 v[12:15], a[156:159], a[28:31], v[12:15]
  ds_read_b64_tr_b16 a[150:151], v197 offset:37376
  buffer_load_dwordx4 v205, s[8:11], s44 offen offset:2048 lds
  v_fma_f32 v130, -v239, v229, v130
  v_mfma_f32_16x16x32_bf16 v[16:19], a[160:163], a[24:27], v[16:19]
  ds_read_b64_tr_b16 a[152:153], v194 offset:28672
  v_fmac_f32 v138, v239, v228
  v_mfma_f32_16x16x32_bf16 v[20:23], a[160:163], a[28:31], v[20:23]
  ds_read_b64_tr_b16 a[154:155], v194 offset:29184
  v_fmac_f32 v131, v240, v228
  v_fmac_f32 v139, v240, v229
  v_mfma_f32_16x16x32_bf16 v[24:27], a[164:167], a[24:27], v[24:27]
  ds_read_b64_tr_b16 a[156:157], v195 offset:28672
  v_fma_f32 v131, -v241, v229, v131
  v_mfma_f32_16x16x32_bf16 v[28:31], a[164:167], a[28:31], v[28:31]
  ds_read_b64_tr_b16 a[158:159], v195 offset:29184
  v_fmac_f32 v139, v241, v228
  v_mfma_f32_16x16x32_bf16 v[32:35], a[168:171], a[24:27], v[32:35]
  ds_read_b64_tr_b16 a[160:161], v196 offset:28672
  v_mul_f32 v250, v242, v128
  v_max_f32 v67, 0, v67
  v_mfma_f32_16x16x32_bf16 v[36:39], a[168:171], a[28:31], v[36:39]
  ds_read_b64_tr_b16 a[162:163], v196 offset:29184
  s_waitcnt lgkmcnt(4)
  v_mfma_f32_16x16x32_bf16 v[40:43], a[172:175], a[24:27], v[40:43]
  ds_read_b64_tr_b16 a[164:165], v197 offset:28672
  buffer_load_dwordx4 v206, s[8:11], s44 offen offset:3072 lds
  s_add_u32 m0, s46, 102400
  v_mfma_f32_16x16x32_bf16 v[44:47], a[172:175], a[28:31], v[44:47]
  ds_read_b64_tr_b16 a[166:167], v197 offset:29184
  v_fma_f32 v250, -v243, v136, v250
  v_mfma_f32_16x16x32_bf16 v[48:51], a[144:147], a[24:27], v[48:51]
  ds_read_b64_tr_b16 a[168:169], v194 offset:40960
  v_mul_f32 v136, v242, v136
  v_mfma_f32_16x16x32_bf16 v[52:55], a[144:147], a[28:31], v[52:55]
  ds_read_b64_tr_b16 a[170:171], v194 offset:41472
  v_fmac_f32 v136, v243, v128
  v_mul_f32 v128, v176, v250
  v_mfma_f32_16x16x32_bf16 v[56:59], a[148:151], a[24:27], v[56:59]
  ds_read_b64_tr_b16 a[172:173], v195 offset:40960
  v_mul_f32_e64 v136, -v176, v136
  v_mfma_f32_16x16x32_bf16 v[60:63], a[148:151], a[28:31], v[60:63]
  ds_read_b64_tr_b16 a[174:175], v195 offset:41472
  v_mul_f32 v251, v242, v129
  v_mul_f32 v99, v215, v99
  v_mfma_f32_16x16x32_bf16 v[0:3], a[152:155], a[32:35], v[0:3]
  ds_read_b64_tr_b16 a[144:145], v196 offset:40960
  v_fma_f32 v251, -v243, v137, v251
  v_mfma_f32_16x16x32_bf16 v[4:7], a[152:155], a[36:39], v[4:7]
  ds_read_b64_tr_b16 a[146:147], v196 offset:41472
  s_waitcnt lgkmcnt(4)
  v_mfma_f32_16x16x32_bf16 v[8:11], a[156:159], a[32:35], v[8:11]
  ds_read_b64_tr_b16 a[148:149], v197 offset:40960
  buffer_load_dwordx4 v207, s[8:11], s44 offen lds
  v_mul_f32 v137, v242, v137
  v_mfma_f32_16x16x32_bf16 v[12:15], a[156:159], a[36:39], v[12:15]
  ds_read_b64_tr_b16 a[150:151], v197 offset:41472
  v_fmac_f32 v137, v243, v129
  v_mfma_f32_16x16x32_bf16 v[16:19], a[160:163], a[32:35], v[16:19]
  ds_read_b64_tr_b16 a[152:153], v194 offset:32768
  v_mul_f32 v129, v177, v251
  v_mul_f32_e64 v137, -v177, v137
  v_mfma_f32_16x16x32_bf16 v[20:23], a[160:163], a[36:39], v[20:23]
  ds_read_b64_tr_b16 a[154:155], v194 offset:33280
  v_mul_f32 v250, v242, v130
  v_mfma_f32_16x16x32_bf16 v[24:27], a[164:167], a[32:35], v[24:27]
  ds_read_b64_tr_b16 a[156:157], v195 offset:32768
  v_fma_f32 v250, -v243, v138, v250
  v_mul_f32 v138, v242, v138
  v_mfma_f32_16x16x32_bf16 v[28:31], a[164:167], a[36:39], v[28:31]
  ds_read_b64_tr_b16 a[158:159], v195 offset:33280
  v_fmac_f32 v138, v243, v130
  v_mfma_f32_16x16x32_bf16 v[32:35], a[168:171], a[32:35], v[32:35]
  ds_read_b64_tr_b16 a[160:161], v196 offset:32768
  v_mul_f32 v130, v178, v250
  v_mfma_f32_16x16x32_bf16 v[36:39], a[168:171], a[36:39], v[36:39]
  ds_read_b64_tr_b16 a[162:163], v196 offset:33280
  buffer_load_dwordx4 v208, s[8:11], s44 offen offset:1024 lds
  s_waitcnt lgkmcnt(4)
  v_mfma_f32_16x16x32_bf16 v[40:43], a[172:175], a[32:35], v[40:43]
  ds_read_b64_tr_b16 a[164:165], v197 offset:32768
  v_mul_f32_e64 v138, -v178, v138
  v_mfma_f32_16x16x32_bf16 v[44:47], a[172:175], a[36:39], v[44:47]
  ds_read_b64_tr_b16 a[166:167], v197 offset:33280
  v_mul_f32 v251, v242, v131
  v_mul_f32 v64, v64, v96
  v_mfma_f32_16x16x32_bf16 v[48:51], a[144:147], a[32:35], v[48:51]
  ds_read_b64_tr_b16 a[168:169], v194 offset:45056
  v_fma_f32 v251, -v243, v139, v251
  v_mfma_f32_16x16x32_bf16 v[52:55], a[144:147], a[36:39], v[52:55]
  ds_read_b64_tr_b16 a[170:171], v194 offset:45568
  v_mul_f32 v139, v242, v139
  v_mfma_f32_16x16x32_bf16 v[56:59], a[148:151], a[32:35], v[56:59]
  ds_read_b64_tr_b16 a[172:173], v195 offset:45056
  v_fmac_f32 v139, v243, v131
  v_mul_f32 v131, v179, v251
  v_mfma_f32_16x16x32_bf16 v[60:63], a[148:151], a[36:39], v[60:63]
  ds_read_b64_tr_b16 a[174:175], v195 offset:45568
  v_mul_f32_e64 v139, -v179, v139
  v_mfma_f32_16x16x32_bf16 v[0:3], a[152:155], a[40:43], v[0:3]
  ds_read_b64_tr_b16 a[144:145], v196 offset:45056
  v_cvt_pk_bf16_f32 v128, v128, v129
  v_cvt_pk_bf16_f32 v129, v130, v131
  v_mfma_f32_16x16x32_bf16 v[4:7], a[152:155], a[44:47], v[4:7]
  ds_read_b64_tr_b16 a[146:147], v196 offset:45568
  s_waitcnt lgkmcnt(4)
  v_mfma_f32_16x16x32_bf16 v[8:11], a[156:159], a[40:43], v[8:11]
  ds_read_b64_tr_b16 a[148:149], v197 offset:45056
  s_waitcnt vmcnt(18)
  v_mfma_f32_16x16x32_bf16 v[12:15], a[156:159], a[44:47], v[12:15]
  ds_read_b64_tr_b16 a[150:151], v197 offset:45568
  v_cvt_pk_bf16_f32 v136, v136, v137
  s_barrier
  v_mfma_f32_16x16x32_bf16 v[16:19], a[160:163], a[40:43], v[16:19]
  ds_read_b64_tr_b16 a[152:153], v190
  v_mov_b32 v189, 2
  v_mfma_f32_16x16x32_bf16 v[20:23], a[160:163], a[44:47], v[20:23]
  ds_read_b64_tr_b16 a[154:155], v190 offset:512
  buffer_store_dword v189, v187, s[24:27], 0 offen sc1
  s_add_u32 s44, s66, 0
  v_mfma_f32_16x16x32_bf16 v[24:27], a[164:167], a[40:43], v[24:27]
  ds_read_b64_tr_b16 a[156:157], v191
  s_add_u32 m0, s46, 122880
  v_mfma_f32_16x16x32_bf16 v[28:31], a[164:167], a[44:47], v[28:31]
  ds_read_b64_tr_b16 a[158:159], v191 offset:512
  v_cvt_pk_bf16_f32 v137, v138, v139
  ds_write_b64 v248, v[128:129] offset:0
  v_mfma_f32_16x16x32_bf16 v[32:35], a[168:171], a[40:43], v[32:35]
  ds_read_b64_tr_b16 a[160:161], v192
  ds_write_b64 v248, v[136:137] offset:512
  v_mfma_f32_16x16x32_bf16 v[36:39], a[168:171], a[44:47], v[36:39]
  ds_read_b64_tr_b16 a[162:163], v192 offset:512
  s_waitcnt lgkmcnt(6)
  v_mfma_f32_16x16x32_bf16 v[40:43], a[172:175], a[40:43], v[40:43]
  ds_read_b64_tr_b16 a[164:165], v193
  buffer_load_dwordx4 v209, s[12:15], s44 offen lds
  ds_read_b64_tr_b16 v[128:129], v249 offset:0
  v_mfma_f32_16x16x32_bf16 v[44:47], a[172:175], a[44:47], v[44:47]
  ds_read_b64_tr_b16 a[166:167], v193 offset:512
  ds_read_b64_tr_b16 v[130:131], v249 offset:512
  v_mfma_f32_16x16x32_bf16 v[48:51], a[144:147], a[40:43], v[48:51]
  ds_read_b64_tr_b16 a[168:169], v190 offset:12288
  ds_read_b128 v[234:237], v247 offset:768
  ds_read_b128 v[238:241], v247 offset:784
  v_mfma_f32_16x16x32_bf16 v[52:55], a[144:147], a[44:47], v[52:55]
  ds_read_b64_tr_b16 a[170:171], v190 offset:12800
  ds_read_b64 v[242:243], v247 offset:800
  v_mfma_f32_16x16x32_bf16 v[56:59], a[148:151], a[40:43], v[56:59]
  s_waitcnt lgkmcnt(14)
  ds_read_b64_tr_b16 a[172:173], v191 offset:12288
  v_mul_f32 v65, v65, v97
  v_mfma_f32_16x16x32_bf16 v[60:63], a[148:151], a[44:47], v[60:63]
  s_waitcnt lgkmcnt(14)
  ds_read_b64_tr_b16 a[174:175], v191 offset:12800
  v_mul_f32 v66, v66, v98
  v_mul_f32 v67, v67, v99
  v_mfma_f32_16x16x32_bf16 v[0:3], a[152:155], a[48:51], v[0:3]
  s_waitcnt lgkmcnt(14)
  ds_read_b64_tr_b16 a[144:145], v192 offset:12288
  v_max_f32 v72, 0, v72
  v_mfma_f32_16x16x32_bf16 v[4:7], a[152:155], a[52:55], v[4:7]
  s_waitcnt lgkmcnt(14)
  ds_read_b64_tr_b16 a[146:147], v192 offset:12800
  buffer_load_dwordx4 v210, s[12:15], s44 offen offset:1024 lds
  s_waitcnt lgkmcnt(5)
  v_mfma_f32_16x16x32_bf16 v[8:11], a[156:159], a[48:51], v[8:11]
  ds_read_b64_tr_b16 a[148:149], v193 offset:12288
  v_mul_f32 v104, v215, v104
  v_mfma_f32_16x16x32_bf16 v[12:15], a[156:159], a[52:55], v[12:15]
  ds_read_b64_tr_b16 a[150:151], v193 offset:12800
  v_max_f32 v73, 0, v73
  v_mfma_f32_16x16x32_bf16 v[16:19], a[160:163], a[48:51], v[16:19]
  ds_read_b64_tr_b16 a[152:153], v190 offset:4096
  v_fmac_f32 v144, v234, v230
  v_mul_f32 v105, v215, v105
  v_mfma_f32_16x16x32_bf16 v[20:23], a[160:163], a[52:55], v[20:23]
  ds_read_b64_tr_b16 a[154:155], v190 offset:4608
  v_max_f32 v74, 0, v74
  v_mfma_f32_16x16x32_bf16 v[24:27], a[164:167], a[48:51], v[24:27]
  ds_read_b64_tr_b16 a[156:157], v191 offset:4096
  v_mul_f32 v106, v215, v106
  v_max_f32 v75, 0, v75
  v_mfma_f32_16x16x32_bf16 v[28:31], a[164:167], a[52:55], v[28:31]
  ds_read_b64_tr_b16 a[158:159], v191 offset:4608
  v_mul_f32 v107, v215, v107
  v_mfma_f32_16x16x32_bf16 v[32:35], a[168:171], a[48:51], v[32:35]
  ds_read_b64_tr_b16 a[160:161], v192 offset:4096
  buffer_load_dwordx4 v211, s[12:15], s44 offen offset:2048 lds
  v_mul_f32 v72, v72, v104
  v_mfma_f32_16x16x32_bf16 v[36:39], a[168:171], a[52:55], v[36:39]
  ds_read_b64_tr_b16 a[162:163], v192 offset:4608
  s_waitcnt lgkmcnt(4)
  v_mfma_f32_16x16x32_bf16 v[40:43], a[172:175], a[48:51], v[40:43]
  ds_read_b64_tr_b16 a[164:165], v193 offset:4096
  v_mul_f32 v73, v73, v105
  v_mfma_f32_16x16x32_bf16 v[44:47], a[172:175], a[52:55], v[44:47]
  ds_read_b64_tr_b16 a[166:167], v193 offset:4608
  v_mul_f32 v74, v74, v106
  v_mul_f32 v75, v75, v107
  v_mfma_f32_16x16x32_bf16 v[48:51], a[144:147], a[48:51], v[48:51]
  ds_read_b64_tr_b16 a[168:169], v190 offset:16384
  v_cvt_pk_bf16_f32 v96, v64, v65
  v_mfma_f32_16x16x32_bf16 v[52:55], a[144:147], a[52:55], v[52:55]
  ds_read_b64_tr_b16 a[170:171], v190 offset:16896
  v_cvt_pk_bf16_f32 v97, v66, v67
  v_cvt_pk_bf16_f32 v98, v72, v73
  v_mfma_f32_16x16x32_bf16 v[56:59], a[148:151], a[48:51], v[56:59]
  ds_read_b64_tr_b16 a[172:173], v191 offset:16384
  v_cvt_pk_bf16_f32 v99, v74, v75
  v_mfma_f32_16x16x32_bf16 v[60:63], a[148:151], a[52:55], v[60:63]
  ds_read_b64_tr_b16 a[174:175], v191 offset:16896
  buffer_load_dwordx4 v212, s[12:15], s44 offen offset:3072 lds
  v_mfma_f32_16x16x32_bf16 v[0:3], a[152:155], a[56:59], v[0:3]
  ds_read_b64_tr_b16 a[144:145], v192 offset:16384
  s_add_u32 m0, s46, 126976
  v_accvgpr_write_b32 a208, v96
  v_mfma_f32_16x16x32_bf16 v[4:7], a[152:155], a[60:63], v[4:7]
  ds_read_b64_tr_b16 a[146:147], v192 offset:16896
  s_waitcnt lgkmcnt(4)
  v_mfma_f32_16x16x32_bf16 v[8:11], a[156:159], a[56:59], v[8:11]
  ds_read_b64_tr_b16 a[148:149], v193 offset:16384
  v_accvgpr_write_b32 a209, v97
  v_accvgpr_write_b32 a210, v98
  v_mfma_f32_16x16x32_bf16 v[12:15], a[156:159], a[60:63], v[12:15]
  ds_read_b64_tr_b16 a[150:151], v193 offset:16896
  v_accvgpr_write_b32 a211, v99
  v_mfma_f32_16x16x32_bf16 v[16:19], a[160:163], a[56:59], v[16:19]
  ds_read_b64_tr_b16 a[152:153], v190 offset:8192
  s_add_u32 s63, s61, 8192
  buffer_store_dwordx4 v[96:99], v226, s[24:27], s63 offen sc1
  v_mfma_f32_16x16x32_bf16 v[20:23], a[160:163], a[60:63], v[20:23]
  ds_read_b64_tr_b16 a[154:155], v190 offset:8704
  v_max_f32 v68, 0, v68
  v_mul_f32 v100, v216, v100
  v_mfma_f32_16x16x32_bf16 v[24:27], a[164:167], a[56:59], v[24:27]
  ds_read_b64_tr_b16 a[156:157], v191 offset:8192
  v_max_f32 v69, 0, v69
  v_mfma_f32_16x16x32_bf16 v[28:31], a[164:167], a[60:63], v[28:31]
  ds_read_b64_tr_b16 a[158:159], v191 offset:8704
  v_mul_f32 v101, v216, v101
  v_max_f32 v70, 0, v70
  v_mfma_f32_16x16x32_bf16 v[32:35], a[168:171], a[56:59], v[32:35]
  ds_read_b64_tr_b16 a[160:161], v192 offset:8192
  v_mul_f32 v102, v216, v102
  v_mfma_f32_16x16x32_bf16 v[36:39], a[168:171], a[60:63], v[36:39]
  ds_read_b64_tr_b16 a[162:163], v192 offset:8704
  buffer_load_dwordx4 v213, s[12:15], s44 offen lds
  s_waitcnt lgkmcnt(4)
  v_mfma_f32_16x16x32_bf16 v[40:43], a[172:175], a[56:59], v[40:43]
  ds_read_b64_tr_b16 a[164:165], v193 offset:8192
  v_max_f32 v71, 0, v71
  v_mfma_f32_16x16x32_bf16 v[44:47], a[172:175], a[60:63], v[44:47]
  ds_read_b64_tr_b16 a[166:167], v193 offset:8704
  v_mul_f32 v103, v216, v103
  v_mfma_f32_16x16x32_bf16 v[48:51], a[144:147], a[56:59], v[48:51]
  ds_read_b64_tr_b16 a[168:169], v190 offset:20480
  v_mul_f32 v68, v68, v100
  v_mul_f32 v69, v69, v101
  v_mfma_f32_16x16x32_bf16 v[52:55], a[144:147], a[60:63], v[52:55]
  ds_read_b64_tr_b16 a[170:171], v190 offset:20992
  v_mul_f32 v70, v70, v102
  v_mfma_f32_16x16x32_bf16 v[56:59], a[148:151], a[56:59], v[56:59]
  ds_read_b64_tr_b16 a[172:173], v191 offset:20480
  v_mul_f32 v71, v71, v103
  v_max_f32 v76, 0, v76
  v_mfma_f32_16x16x32_bf16 v[60:63], a[148:151], a[60:63], v[60:63]
  ds_read_b64_tr_b16 a[174:175], v191 offset:20992
  v_mul_f32 v108, v216, v108
  buffer_load_dwordx4 v214, s[12:15], s44 offen offset:1024 lds
  v_mfma_f32_16x16x32_bf16 v[0:3], a[152:155], a[64:67], v[0:3]
  ds_read_b64_tr_b16 a[144:145], v192 offset:20480
  v_max_f32 v77, 0, v77
  v_mfma_f32_16x16x32_bf16 v[4:7], a[152:155], a[68:71], v[4:7]
  ds_read_b64_tr_b16 a[146:147], v192 offset:20992
  v_mul_f32 v109, v216, v109
  s_waitcnt lgkmcnt(4)
  v_mfma_f32_16x16x32_bf16 v[8:11], a[156:159], a[64:67], v[8:11]
  ds_read_b64_tr_b16 a[148:149], v193 offset:20480
  s_waitcnt vmcnt(20)
  v_mfma_f32_16x16x32_bf16 v[12:15], a[156:159], a[68:71], v[12:15]
  ds_read_b64_tr_b16 a[150:151], v193 offset:20992
  v_max_f32 v78, 0, v78
  s_barrier
  v_mfma_f32_16x16x32_bf16 v[16:19], a[160:163], a[64:67], v[16:19]
  ds_read_b64_tr_b16 a[152:153], v190 offset:24576
  s_add_u32 s44, s66, 110592
  v_mfma_f32_16x16x32_bf16 v[20:23], a[160:163], a[68:71], v[20:23]
  ds_read_b64_tr_b16 a[154:155], v190 offset:25088
  s_add_u32 m0, s46, 73728
  v_mfma_f32_16x16x32_bf16 v[24:27], a[164:167], a[64:67], v[24:27]
  ds_read_b64_tr_b16 a[156:157], v191 offset:24576
  v_mul_f32 v110, v216, v110
  v_max_f32 v79, 0, v79
  v_mfma_f32_16x16x32_bf16 v[28:31], a[164:167], a[68:71], v[28:31]
  ds_read_b64_tr_b16 a[158:159], v191 offset:25088
  buffer_load_dwordx4 v209, s[12:15], s44 offen lds
  v_mfma_f32_16x16x32_bf16 v[32:35], a[168:171], a[64:67], v[32:35]
  ds_read_b64_tr_b16 a[160:161], v192 offset:24576
  v_mul_f32 v111, v216, v111
  v_mul_f32 v76, v76, v108
  v_mfma_f32_16x16x32_bf16 v[36:39], a[168:171], a[68:71], v[36:39]
  ds_read_b64_tr_b16 a[162:163], v192 offset:25088
  s_waitcnt lgkmcnt(4)
  v_mfma_f32_16x16x32_bf16 v[40:43], a[172:175], a[64:67], v[40:43]
  ds_read_b64_tr_b16 a[164:165], v193 offset:24576
  v_mul_f32 v77, v77, v109
  v_mfma_f32_16x16x32_bf16 v[44:47], a[172:175], a[68:71], v[44:47]
  ds_read_b64_tr_b16 a[166:167], v193 offset:25088
  v_mul_f32 v78, v78, v110
  v_mul_f32 v79, v79, v111
  v_mfma_f32_16x16x32_bf16 v[48:51], a[144:147], a[64:67], v[48:51]
  ds_read_b64_tr_b16 a[168:169], v190 offset:36864
  v_cvt_pk_bf16_f32 v100, v68, v69
  v_mfma_f32_16x16x32_bf16 v[52:55], a[144:147], a[68:71], v[52:55]
  ds_read_b64_tr_b16 a[170:171], v190 offset:37376
  v_cvt_pk_bf16_f32 v101, v70, v71
  v_cvt_pk_bf16_f32 v102, v76, v77
  v_mfma_f32_16x16x32_bf16 v[56:59], a[148:151], a[64:67], v[56:59]
  ds_read_b64_tr_b16 a[172:173], v191 offset:36864
  buffer_load_dwordx4 v210, s[12:15], s44 offen offset:1024 lds
  v_mfma_f32_16x16x32_bf16 v[60:63], a[148:151], a[68:71], v[60:63]
  ds_read_b64_tr_b16 a[174:175], v191 offset:37376
  v_cvt_pk_bf16_f32 v103, v78, v79
  v_mfma_f32_16x16x32_bf16 v[0:3], a[152:155], a[72:75], v[0:3]
  ds_read_b64_tr_b16 a[144:145], v192 offset:36864
  v_accvgpr_write_b32 a212, v100
  v_accvgpr_write_b32 a213, v101
  v_mfma_f32_16x16x32_bf16 v[4:7], a[152:155], a[76:79], v[4:7]
  ds_read_b64_tr_b16 a[146:147], v192 offset:37376
  s_waitcnt lgkmcnt(4)
  v_mfma_f32_16x16x32_bf16 v[8:11], a[156:159], a[72:75], v[8:11]
  ds_read_b64_tr_b16 a[148:149], v193 offset:36864
  v_accvgpr_write_b32 a214, v102
  v_accvgpr_write_b32 a215, v103
  v_mfma_f32_16x16x32_bf16 v[12:15], a[156:159], a[76:79], v[12:15]
  ds_read_b64_tr_b16 a[150:151], v193 offset:37376
  s_add_u32 s63, s61, 8192
  buffer_store_dwordx4 v[100:103], v226, s[24:27], s63 offen offset:1024 sc1
  v_mfma_f32_16x16x32_bf16 v[16:19], a[160:163], a[72:75], v[16:19]
  ds_read_b64_tr_b16 a[152:153], v190 offset:28672
  v_max_f32 v80, 0, v80
  v_mul_f32 v112, v215, v112
  v_mfma_f32_16x16x32_bf16 v[20:23], a[160:163], a[76:79], v[20:23]
  ds_read_b64_tr_b16 a[154:155], v190 offset:29184
  v_max_f32 v81, 0, v81
  v_mfma_f32_16x16x32_bf16 v[24:27], a[164:167], a[72:75], v[24:27]
  ds_read_b64_tr_b16 a[156:157], v191 offset:28672
  v_mul_f32 v113, v215, v113
  v_mfma_f32_16x16x32_bf16 v[28:31], a[164:167], a[76:79], v[28:31]
  ds_read_b64_tr_b16 a[158:159], v191 offset:29184
  v_max_f32 v82, 0, v82
  v_mul_f32 v114, v215, v114
  v_mfma_f32_16x16x32_bf16 v[32:35], a[168:171], a[72:75], v[32:35]
  ds_read_b64_tr_b16 a[160:161], v192 offset:28672
  buffer_load_dwordx4 v211, s[12:15], s44 offen offset:2048 lds
  v_mfma_f32_16x16x32_bf16 v[36:39], a[168:171], a[76:79], v[36:39]
  ds_read_b64_tr_b16 a[162:163], v192 offset:29184
  v_max_f32 v83, 0, v83
  s_waitcnt lgkmcnt(4)
  v_mfma_f32_16x16x32_bf16 v[40:43], a[172:175], a[72:75], v[40:43]
  ds_read_b64_tr_b16 a[164:165], v193 offset:28672
  v_mul_f32 v115, v215, v115
  v_mfma_f32_16x16x32_bf16 v[44:47], a[172:175], a[76:79], v[44:47]
  ds_read_b64_tr_b16 a[166:167], v193 offset:29184
  v_mul_f32 v80, v80, v112
  v_mfma_f32_16x16x32_bf16 v[48:51], a[144:147], a[72:75], v[48:51]
  ds_read_b64_tr_b16 a[168:169], v190 offset:40960
  v_mul_f32 v81, v81, v113
  v_mul_f32 v82, v82, v114
  v_mfma_f32_16x16x32_bf16 v[52:55], a[144:147], a[76:79], v[52:55]
  ds_read_b64_tr_b16 a[170:171], v190 offset:41472
  v_mul_f32 v83, v83, v115
  v_mfma_f32_16x16x32_bf16 v[56:59], a[148:151], a[72:75], v[56:59]
  ds_read_b64_tr_b16 a[172:173], v191 offset:40960
  v_max_f32 v88, 0, v88
  v_mul_f32 v120, v215, v120
  v_mfma_f32_16x16x32_bf16 v[60:63], a[148:151], a[76:79], v[60:63]
  ds_read_b64_tr_b16 a[174:175], v191 offset:41472
  buffer_load_dwordx4 v212, s[12:15], s44 offen offset:3072 lds
  v_mfma_f32_16x16x32_bf16 v[0:3], a[152:155], a[80:83], v[0:3]
  ds_read_b64_tr_b16 a[144:145], v192 offset:40960
  s_add_u32 m0, s46, 77824
  v_mfma_f32_16x16x32_bf16 v[4:7], a[152:155], a[84:87], v[4:7]
  ds_read_b64_tr_b16 a[146:147], v192 offset:41472
  v_max_f32 v89, 0, v89
  s_waitcnt lgkmcnt(4)
  v_mfma_f32_16x16x32_bf16 v[8:11], a[156:159], a[80:83], v[8:11]
  ds_read_b64_tr_b16 a[148:149], v193 offset:40960
  v_mul_f32 v121, v215, v121
  v_mfma_f32_16x16x32_bf16 v[12:15], a[156:159], a[84:87], v[12:15]
  ds_read_b64_tr_b16 a[150:151], v193 offset:41472
  v_max_f32 v90, 0, v90
  v_mul_f32 v122, v215, v122
  v_mfma_f32_16x16x32_bf16 v[16:19], a[160:163], a[80:83], v[16:19]
  ds_read_b64_tr_b16 a[152:153], v190 offset:32768
  v_max_f32 v91, 0, v91
  v_mfma_f32_16x16x32_bf16 v[20:23], a[160:163], a[84:87], v[20:23]
  ds_read_b64_tr_b16 a[154:155], v190 offset:33280
  v_mul_f32 v123, v215, v123
  v_mfma_f32_16x16x32_bf16 v[24:27], a[164:167], a[80:83], v[24:27]
  ds_read_b64_tr_b16 a[156:157], v191 offset:32768
  buffer_load_dwordx4 v213, s[12:15], s44 offen lds
  v_mul_f32 v88, v88, v120
  v_mfma_f32_16x16x32_bf16 v[28:31], a[164:167], a[84:87], v[28:31]
  ds_read_b64_tr_b16 a[158:159], v191 offset:33280
  v_mul_f32 v89, v89, v121
  v_mfma_f32_16x16x32_bf16 v[32:35], a[168:171], a[80:83], v[32:35]
  ds_read_b64_tr_b16 a[160:161], v192 offset:32768
  v_mul_f32 v90, v90, v122
  v_mul_f32 v91, v91, v123
  v_mfma_f32_16x16x32_bf16 v[36:39], a[168:171], a[84:87], v[36:39]
  ds_read_b64_tr_b16 a[162:163], v192 offset:33280
  s_waitcnt lgkmcnt(4)
  v_mfma_f32_16x16x32_bf16 v[40:43], a[172:175], a[80:83], v[40:43]
  ds_read_b64_tr_b16 a[164:165], v193 offset:32768
  v_cvt_pk_bf16_f32 v112, v80, v81
  v_mfma_f32_16x16x32_bf16 v[44:47], a[172:175], a[84:87], v[44:47]
  ds_read_b64_tr_b16 a[166:167], v193 offset:33280
  v_cvt_pk_bf16_f32 v113, v82, v83
  v_cvt_pk_bf16_f32 v114, v88, v89
  v_mfma_f32_16x16x32_bf16 v[48:51], a[144:147], a[80:83], v[48:51]
  ds_read_b64_tr_b16 a[168:169], v190 offset:45056
  v_cvt_pk_bf16_f32 v115, v90, v91
  v_mfma_f32_16x16x32_bf16 v[52:55], a[144:147], a[84:87], v[52:55]
  ds_read_b64_tr_b16 a[170:171], v190 offset:45568
  buffer_load_dwordx4 v214, s[12:15], s44 offen offset:1024 lds
  v_accvgpr_write_b32 a216, v112
  v_mfma_f32_16x16x32_bf16 v[56:59], a[148:151], a[80:83], v[56:59]
  ds_read_b64_tr_b16 a[172:173], v191 offset:45056
  v_accvgpr_write_b32 a217, v113
  v_mfma_f32_16x16x32_bf16 v[60:63], a[148:151], a[84:87], v[60:63]
  ds_read_b64_tr_b16 a[174:175], v191 offset:45568
  v_accvgpr_write_b32 a218, v114
  v_mfma_f32_16x16x32_bf16 v[0:3], a[152:155], a[88:91], v[0:3]
  ds_read_b64_tr_b16 a[144:145], v192 offset:45056
  v_accvgpr_write_b32 a219, v115
  v_fmac_f32 v152, v234, v231
  v_mfma_f32_16x16x32_bf16 v[4:7], a[152:155], a[92:95], v[4:7]
  ds_read_b64_tr_b16 a[146:147], v192 offset:45568
  s_waitcnt lgkmcnt(4)
  v_mfma_f32_16x16x32_bf16 v[8:11], a[156:159], a[88:91], v[8:11]
  ds_read_b64_tr_b16 a[148:149], v193 offset:45056
  s_add_u32 s63, s61, 8192
  buffer_store_dwordx4 v[112:115], v226, s[24:27], s63 offen offset:2048 sc1
  s_waitcnt vmcnt(22)
  v_mfma_f32_16x16x32_bf16 v[12:15], a[156:159], a[92:95], v[12:15]
  ds_read_b64_tr_b16 a[150:151], v193 offset:45568
  s_barrier
  v_mfma_f32_16x16x32_bf16 v[16:19], a[160:163], a[88:91], v[16:19]
  ds_read_b64_tr_b16 a[152:153], v194
  s_add_u32 s44, s67, 512
  v_mfma_f32_16x16x32_bf16 v[20:23], a[160:163], a[92:95], v[20:23]
  ds_read_b64_tr_b16 a[154:155], v194 offset:512
  s_add_u32 m0, s46, 0
  v_lshrrev_b32 v254, 4, v225
  v_mfma_f32_16x16x32_bf16 v[24:27], a[164:167], a[88:91], v[24:27]
  ds_read_b64_tr_b16 a[156:157], v195
  v_lshlrev_b32 v254, 9, v254
  v_mfma_f32_16x16x32_bf16 v[28:31], a[164:167], a[92:95], v[28:31]
  ds_read_b64_tr_b16 a[158:159], v195 offset:512
  buffer_load_dwordx4 v209, s[12:15], s44 offen lds
  v_sub_u32 v190, v190, v254
  v_mfma_f32_16x16x32_bf16 v[32:35], a[168:171], a[88:91], v[32:35]
  ds_read_b64_tr_b16 a[160:161], v196
  v_sub_u32 v191, v191, v254
  v_mfma_f32_16x16x32_bf16 v[36:39], a[168:171], a[92:95], v[36:39]
  ds_read_b64_tr_b16 a[162:163], v196 offset:512
  s_waitcnt lgkmcnt(4)
  v_mfma_f32_16x16x32_bf16 v[40:43], a[172:175], a[88:91], v[40:43]
  ds_read_b64_tr_b16 a[164:165], v197
  v_sub_u32 v192, v192, v254
  v_sub_u32 v193, v193, v254
  v_mfma_f32_16x16x32_bf16 v[44:47], a[172:175], a[92:95], v[44:47]
  ds_read_b64_tr_b16 a[166:167], v197 offset:512
  v_max_f32 v84, 0, v84
  v_mfma_f32_16x16x32_bf16 v[48:51], a[144:147], a[88:91], v[48:51]
  ds_read_b64_tr_b16 a[168:169], v194 offset:12288
  v_mul_f32 v116, v216, v116
  v_max_f32 v85, 0, v85
  v_mfma_f32_16x16x32_bf16 v[52:55], a[144:147], a[92:95], v[52:55]
  ds_read_b64_tr_b16 a[170:171], v194 offset:12800
  v_mul_f32 v117, v216, v117
  v_mfma_f32_16x16x32_bf16 v[56:59], a[148:151], a[88:91], v[56:59]
  ds_read_b64_tr_b16 a[172:173], v195 offset:12288
  buffer_load_dwordx4 v210, s[12:15], s44 offen offset:1024 lds
  v_mfma_f32_16x16x32_bf16 v[60:63], a[148:151], a[92:95], v[60:63]
  ds_read_b64_tr_b16 a[174:175], v195 offset:12800
  v_max_f32 v86, 0, v86
  v_mul_f32 v118, v216, v118
  v_mfma_f32_16x16x32_bf16 v[0:3], a[152:155], a[96:99], v[0:3]
  ds_read_b64_tr_b16 a[144:145], v196 offset:12288
  v_max_f32 v87, 0, v87
  v_mfma_f32_16x16x32_bf16 v[4:7], a[152:155], a[100:103], v[4:7]
  ds_read_b64_tr_b16 a[146:147], v196 offset:12800
  v_mul_f32 v119, v216, v119
  s_waitcnt lgkmcnt(4)
  v_mfma_f32_16x16x32_bf16 v[8:11], a[156:159], a[96:99], v[8:11]
  ds_read_b64_tr_b16 a[148:149], v197 offset:12288
  v_mul_f32 v84, v84, v116
  v_mfma_f32_16x16x32_bf16 v[12:15], a[156:159], a[100:103], v[12:15]
  ds_read_b64_tr_b16 a[150:151], v197 offset:12800
  v_mul_f32 v85, v85, v117
  v_mfma_f32_16x16x32_bf16 v[16:19], a[160:163], a[96:99], v[16:19]
  ds_read_b64_tr_b16 a[152:153], v194 offset:4096
  v_mul_f32 v86, v86, v118
  v_mul_f32 v87, v87, v119
  v_mfma_f32_16x16x32_bf16 v[20:23], a[160:163], a[100:103], v[20:23]
  ds_read_b64_tr_b16 a[154:155], v194 offset:4608
  buffer_load_dwordx4 v211, s[12:15], s44 offen offset:2048 lds
  v_mfma_f32_16x16x32_bf16 v[24:27], a[164:167], a[96:99], v[24:27]
  ds_read_b64_tr_b16 a[156:157], v195 offset:4096
  v_max_f32 v92, 0, v92
  v_mul_f32 v124, v216, v124
  v_mfma_f32_16x16x32_bf16 v[28:31], a[164:167], a[100:103], v[28:31]
  ds_read_b64_tr_b16 a[158:159], v195 offset:4608
  v_max_f32 v93, 0, v93
  v_mfma_f32_16x16x32_bf16 v[32:35], a[168:171], a[96:99], v[32:35]
  ds_read_b64_tr_b16 a[160:161], v196 offset:4096
  v_mul_f32 v125, v216, v125
  v_mfma_f32_16x16x32_bf16 v[36:39], a[168:171], a[100:103], v[36:39]
  ds_read_b64_tr_b16 a[162:163], v196 offset:4608
  v_max_f32 v94, 0, v94
  s_waitcnt lgkmcnt(4)
  v_mfma_f32_16x16x32_bf16 v[40:43], a[172:175], a[96:99], v[40:43]
  ds_read_b64_tr_b16 a[164:165], v197 offset:4096
  v_mul_f32 v126, v216, v126
  v_mfma_f32_16x16x32_bf16 v[44:47], a[172:175], a[100:103], v[44:47]
  ds_read_b64_tr_b16 a[166:167], v197 offset:4608
  v_max_f32 v95, 0, v95
  v_mul_f32 v127, v216, v127
  v_mfma_f32_16x16x32_bf16 v[48:51], a[144:147], a[96:99], v[48:51]
  ds_read_b64_tr_b16 a[168:169], v194 offset:16384
  buffer_load_dwordx4 v212, s[12:15], s44 offen offset:3072 lds
  v_mfma_f32_16x16x32_bf16 v[52:55], a[144:147], a[100:103], v[52:55]
  ds_read_b64_tr_b16 a[170:171], v194 offset:16896
  s_add_u32 m0, s46, 4096
  v_mfma_f32_16x16x32_bf16 v[56:59], a[148:151], a[96:99], v[56:59]
  ds_read_b64_tr_b16 a[172:173], v195 offset:16384
  v_mul_f32 v92, v92, v124
  v_mul_f32 v93, v93, v125
  v_mfma_f32_16x16x32_bf16 v[60:63], a[148:151], a[100:103], v[60:63]
  ds_read_b64_tr_b16 a[174:175], v195 offset:16896
  v_mul_f32 v94, v94, v126
  v_mfma_f32_16x16x32_bf16 v[0:3], a[152:155], a[104:107], v[0:3]
  ds_read_b64_tr_b16 a[144:145], v196 offset:16384
  v_mul_f32 v95, v95, v127
  v_cvt_pk_bf16_f32 v116, v84, v85
  v_mfma_f32_16x16x32_bf16 v[4:7], a[152:155], a[108:111], v[4:7]
  ds_read_b64_tr_b16 a[146:147], v196 offset:16896
  s_waitcnt lgkmcnt(4)
  v_mfma_f32_16x16x32_bf16 v[8:11], a[156:159], a[104:107], v[8:11]
  ds_read_b64_tr_b16 a[148:149], v197 offset:16384
  v_cvt_pk_bf16_f32 v117, v86, v87
  v_mfma_f32_16x16x32_bf16 v[12:15], a[156:159], a[108:111], v[12:15]
  ds_read_b64_tr_b16 a[150:151], v197 offset:16896
  buffer_load_dwordx4 v213, s[12:15], s44 offen lds
  v_cvt_pk_bf16_f32 v118, v92, v93
  v_mfma_f32_16x16x32_bf16 v[16:19], a[160:163], a[104:107], v[16:19]
  ds_read_b64_tr_b16 a[152:153], v194 offset:8192
  v_cvt_pk_bf16_f32 v119, v94, v95
  v_mfma_f32_16x16x32_bf16 v[20:23], a[160:163], a[108:111], v[20:23]
  ds_read_b64_tr_b16 a[154:155], v194 offset:8704
  v_accvgpr_write_b32 a220, v116
  v_accvgpr_write_b32 a221, v117
  v_mfma_f32_16x16x32_bf16 v[24:27], a[164:167], a[104:107], v[24:27]
  ds_read_b64_tr_b16 a[156:157], v195 offset:8192
  v_accvgpr_write_b32 a222, v118
  v_mfma_f32_16x16x32_bf16 v[28:31], a[164:167], a[108:111], v[28:31]
  ds_read_b64_tr_b16 a[158:159], v195 offset:8704
  v_accvgpr_write_b32 a223, v119
  v_mfma_f32_16x16x32_bf16 v[32:35], a[168:171], a[104:107], v[32:35]
  ds_read_b64_tr_b16 a[160:161], v196 offset:8192
  s_add_u32 s63, s61, 8192
  buffer_store_dwordx4 v[116:119], v226, s[24:27], s63 offen offset:3072 sc1
  v_mfma_f32_16x16x32_bf16 v[36:39], a[168:171], a[108:111], v[36:39]
  ds_read_b64_tr_b16 a[162:163], v196 offset:8704
  s_waitcnt lgkmcnt(4)
  v_mfma_f32_16x16x32_bf16 v[40:43], a[172:175], a[104:107], v[40:43]
  ds_read_b64_tr_b16 a[164:165], v197 offset:8192
  v_fma_f32 v144, -v235, v231, v144
  v_fmac_f32 v152, v235, v230
  v_mfma_f32_16x16x32_bf16 v[44:47], a[172:175], a[108:111], v[44:47]
  ds_read_b64_tr_b16 a[166:167], v197 offset:8704
  v_fmac_f32 v145, v236, v230
  v_mfma_f32_16x16x32_bf16 v[48:51], a[144:147], a[104:107], v[48:51]
  ds_read_b64_tr_b16 a[168:169], v194 offset:20480
  v_fmac_f32 v153, v236, v231
  v_mfma_f32_16x16x32_bf16 v[52:55], a[144:147], a[108:111], v[52:55]
  ds_read_b64_tr_b16 a[170:171], v194 offset:20992
  buffer_load_dwordx4 v214, s[12:15], s44 offen offset:1024 lds
  v_fma_f32 v145, -v237, v231, v145
  v_mfma_f32_16x16x32_bf16 v[56:59], a[148:151], a[104:107], v[56:59]
  ds_read_b64_tr_b16 a[172:173], v195 offset:20480
  v_fmac_f32 v153, v237, v230
  v_mfma_f32_16x16x32_bf16 v[60:63], a[148:151], a[108:111], v[60:63]
  ds_read_b64_tr_b16 a[174:175], v195 offset:20992
  v_fmac_f32 v146, v238, v230
  v_fmac_f32 v154, v238, v231
  v_mfma_f32_16x16x32_bf16 v[0:3], a[152:155], a[112:115], v[0:3]
  ds_read_b64_tr_b16 a[144:145], v196 offset:20480
  v_fma_f32 v146, -v239, v231, v146
  v_mfma_f32_16x16x32_bf16 v[4:7], a[152:155], a[116:119], v[4:7]
  ds_read_b64_tr_b16 a[146:147], v196 offset:20992
  s_waitcnt lgkmcnt(4)
  v_mfma_f32_16x16x32_bf16 v[8:11], a[156:159], a[112:115], v[8:11]
  ds_read_b64_tr_b16 a[148:149], v197 offset:20480
  v_fmac_f32 v154, v239, v230
  s_waitcnt vmcnt(23)
  v_mfma_f32_16x16x32_bf16 v[12:15], a[156:159], a[116:119], v[12:15]
  ds_read_b64_tr_b16 a[150:151], v197 offset:20992
  s_barrier
  v_mfma_f32_16x16x32_bf16 v[16:19], a[160:163], a[112:115], v[16:19]
  ds_read_b64_tr_b16 a[152:153], v198
  s_add_u32 s44, s66, 256
  s_add_u32 m0, s46, 24576
  v_mfma_f32_16x16x32_bf16 v[20:23], a[160:163], a[116:119], v[20:23]
  ds_read_b64_tr_b16 a[154:155], v198 offset:512
  buffer_load_dwordx4 v209, s[12:15], s44 offen lds
  v_mfma_f32_16x16x32_bf16 v[24:27], a[164:167], a[112:115], v[24:27]
  ds_read_b64_tr_b16 a[156:157], v199
  v_sub_u32 v194, v194, v254
  v_mfma_f32_16x16x32_bf16 v[28:31], a[164:167], a[116:119], v[28:31]
  ds_read_b64_tr_b16 a[158:159], v199 offset:512
  v_sub_u32 v195, v195, v254
  v_sub_u32 v196, v196, v254
  v_mfma_f32_16x16x32_bf16 v[32:35], a[168:171], a[112:115], v[32:35]
  ds_read_b64_tr_b16 a[160:161], v200
  v_sub_u32 v197, v197, v254
  v_mfma_f32_16x16x32_bf16 v[36:39], a[168:171], a[116:119], v[36:39]
  ds_read_b64_tr_b16 a[162:163], v200 offset:512
  v_fmac_f32 v147, v240, v230
  s_waitcnt lgkmcnt(4)
  v_mfma_f32_16x16x32_bf16 v[40:43], a[172:175], a[112:115], v[40:43]
  ds_read_b64_tr_b16 a[164:165], v201
  v_fmac_f32 v155, v240, v231
  v_mfma_f32_16x16x32_bf16 v[44:47], a[172:175], a[116:119], v[44:47]
  ds_read_b64_tr_b16 a[166:167], v201 offset:512
  v_fma_f32 v147, -v241, v231, v147
  v_mfma_f32_16x16x32_bf16 v[48:51], a[144:147], a[112:115], v[48:51]
  ds_read_b64_tr_b16 a[168:169], v198 offset:12288
  buffer_load_dwordx4 v210, s[12:15], s44 offen offset:1024 lds
  v_fmac_f32 v155, v241, v230
  v_mfma_f32_16x16x32_bf16 v[52:55], a[144:147], a[116:119], v[52:55]
  ds_read_b64_tr_b16 a[170:171], v198 offset:12800
  v_mul_f32 v250, v242, v144
  v_mfma_f32_16x16x32_bf16 v[56:59], a[148:151], a[112:115], v[56:59]
  ds_read_b64_tr_b16 a[172:173], v199 offset:12288
  v_fma_f32 v250, -v243, v152, v250
  v_mul_f32 v152, v242, v152
  v_mfma_f32_16x16x32_bf16 v[60:63], a[148:151], a[116:119], v[60:63]
  ds_read_b64_tr_b16 a[174:175], v199 offset:12800
  v_fmac_f32 v152, v243, v144
  v_mfma_f32_16x16x32_bf16 v[0:3], a[152:155], a[120:123], v[0:3]
  ds_read_b64_tr_b16 a[144:145], v200 offset:12288
  v_mul_f32 v144, v176, v250
  v_mfma_f32_16x16x32_bf16 v[4:7], a[152:155], a[124:127], v[4:7]
  ds_read_b64_tr_b16 a[146:147], v200 offset:12800
  v_mul_f32_e64 v152, -v176, v152
  s_waitcnt lgkmcnt(4)
  v_mfma_f32_16x16x32_bf16 v[8:11], a[156:159], a[120:123], v[8:11]
  ds_read_b64_tr_b16 a[148:149], v201 offset:12288
  v_mul_f32 v251, v242, v145
  v_mfma_f32_16x16x32_bf16 v[12:15], a[156:159], a[124:127], v[12:15]
  ds_read_b64_tr_b16 a[150:151], v201 offset:12800
  buffer_load_dwordx4 v211, s[12:15], s44 offen offset:2048 lds
  v_fma_f32 v251, -v243, v153, v251
  v_mfma_f32_16x16x32_bf16 v[16:19], a[160:163], a[120:123], v[16:19]
  ds_read_b64_tr_b16 a[152:153], v198 offset:4096
  v_mul_f32 v153, v242, v153
  v_mfma_f32_16x16x32_bf16 v[20:23], a[160:163], a[124:127], v[20:23]
  ds_read_b64_tr_b16 a[154:155], v198 offset:4608
  v_fmac_f32 v153, v243, v145
  v_mfma_f32_16x16x32_bf16 v[24:27], a[164:167], a[120:123], v[24:27]
  ds_read_b64_tr_b16 a[156:157], v199 offset:4096
  v_mul_f32 v145, v177, v251
  v_mul_f32_e64 v153, -v177, v153
  v_mfma_f32_16x16x32_bf16 v[28:31], a[164:167], a[124:127], v[28:31]
  ds_read_b64_tr_b16 a[158:159], v199 offset:4608
  v_mul_f32 v250, v242, v146
  v_mfma_f32_16x16x32_bf16 v[32:35], a[168:171], a[120:123], v[32:35]
  ds_read_b64_tr_b16 a[160:161], v200 offset:4096
  v_fma_f32 v250, -v243, v154, v250
  v_mul_f32 v154, v242, v154
  v_mfma_f32_16x16x32_bf16 v[36:39], a[168:171], a[124:127], v[36:39]
  ds_read_b64_tr_b16 a[162:163], v200 offset:4608
  s_waitcnt lgkmcnt(4)
  v_mfma_f32_16x16x32_bf16 v[40:43], a[172:175], a[120:123], v[40:43]
  ds_read_b64_tr_b16 a[164:165], v201 offset:4096
  buffer_load_dwordx4 v212, s[12:15], s44 offen offset:3072 lds
  v_mfma_f32_16x16x32_bf16 v[44:47], a[172:175], a[124:127], v[44:47]
  ds_read_b64_tr_b16 a[166:167], v201 offset:4608
  s_add_u32 m0, s46, 28672
  v_fmac_f32 v154, v243, v146
  v_mfma_f32_16x16x32_bf16 v[48:51], a[144:147], a[120:123], v[48:51]
  ds_read_b64_tr_b16 a[168:169], v198 offset:16384
  v_mul_f32 v146, v178, v250
  v_mfma_f32_16x16x32_bf16 v[52:55], a[144:147], a[124:127], v[52:55]
  ds_read_b64_tr_b16 a[170:171], v198 offset:16896
  v_mul_f32_e64 v154, -v178, v154
  v_mul_f32 v251, v242, v147
  v_mfma_f32_16x16x32_bf16 v[56:59], a[148:151], a[120:123], v[56:59]
  ds_read_b64_tr_b16 a[172:173], v199 offset:16384
  v_fma_f32 v251, -v243, v155, v251
  v_mfma_f32_16x16x32_bf16 v[60:63], a[148:151], a[124:127], v[60:63]
  ds_read_b64_tr_b16 a[174:175], v199 offset:16896
  v_mul_f32 v155, v242, v155
  v_mfma_f32_16x16x32_bf16 v[0:3], a[152:155], a[128:131], v[0:3]
  ds_read_b64_tr_b16 a[144:145], v200 offset:16384
  v_fmac_f32 v155, v243, v147
  v_mul_f32 v147, v179, v251
  v_mfma_f32_16x16x32_bf16 v[4:7], a[152:155], a[132:135], v[4:7]
  ds_read_b64_tr_b16 a[146:147], v200 offset:16896
  s_waitcnt lgkmcnt(4)
  v_mfma_f32_16x16x32_bf16 v[8:11], a[156:159], a[128:131], v[8:11]
  ds_read_b64_tr_b16 a[148:149], v201 offset:16384
  buffer_load_dwordx4 v213, s[12:15], s44 offen lds
  v_mul_f32_e64 v155, -v179, v155
  v_mfma_f32_16x16x32_bf16 v[12:15], a[156:159], a[132:135], v[12:15]
  ds_read_b64_tr_b16 a[150:151], v201 offset:16896
  v_cvt_pk_bf16_f32 v144, v144, v145
  v_mfma_f32_16x16x32_bf16 v[16:19], a[160:163], a[128:131], v[16:19]
  ds_read_b64_tr_b16 a[152:153], v198 offset:8192
  v_cvt_pk_bf16_f32 v145, v146, v147
  v_mfma_f32_16x16x32_bf16 v[20:23], a[160:163], a[132:135], v[20:23]
  ds_read_b64_tr_b16 a[154:155], v198 offset:8704
  v_cvt_pk_bf16_f32 v152, v152, v153
  v_cvt_pk_bf16_f32 v153, v154, v155
  v_mfma_f32_16x16x32_bf16 v[24:27], a[164:167], a[128:131], v[24:27]
  ds_read_b64_tr_b16 a[156:157], v199 offset:8192
  ds_write_b64 v248, v[144:145] offset:0
  v_mfma_f32_16x16x32_bf16 v[28:31], a[164:167], a[132:135], v[28:31]
  ds_read_b64_tr_b16 a[158:159], v199 offset:8704
  ds_write_b64 v248, v[152:153] offset:512
  ds_read_b64_tr_b16 v[144:145], v249 offset:0
  v_mfma_f32_16x16x32_bf16 v[32:35], a[168:171], a[128:131], v[32:35]
  ds_read_b64_tr_b16 a[160:161], v200 offset:8192
  ds_read_b64_tr_b16 v[146:147], v249 offset:512
  v_mfma_f32_16x16x32_bf16 v[36:39], a[168:171], a[132:135], v[36:39]
  s_waitcnt lgkmcnt(14)
  ds_read_b64_tr_b16 a[162:163], v200 offset:8704
  s_waitcnt lgkmcnt(8)
  v_mfma_f32_16x16x32_bf16 v[40:43], a[172:175], a[128:131], v[40:43]
  ds_read_b64_tr_b16 a[164:165], v201 offset:8192
  buffer_load_dwordx4 v214, s[12:15], s44 offen offset:1024 lds
  ds_read_b64 v[228:229], v245 offset:0
  v_mfma_f32_16x16x32_bf16 v[44:47], a[172:175], a[132:135], v[44:47]
  ds_read_b64_tr_b16 a[166:167], v201 offset:8704
  ds_read_b64 v[230:231], v245 offset:128
  v_mfma_f32_16x16x32_bf16 v[48:51], a[144:147], a[128:131], v[48:51]
  ds_read_b64_tr_b16 a[168:169], v198 offset:20480
  ds_read_b128 v[234:237], v247 offset:0
  ds_read_b128 v[238:241], v247 offset:16
  v_mfma_f32_16x16x32_bf16 v[52:55], a[144:147], a[132:135], v[52:55]
  s_waitcnt lgkmcnt(14)
  ds_read_b64_tr_b16 a[170:171], v198 offset:20992
  s_waitcnt lgkmcnt(14)
  ds_read_b64 v[242:243], v247 offset:32
  v_mfma_f32_16x16x32_bf16 v[56:59], a[148:151], a[128:131], v[56:59]
  s_waitcnt lgkmcnt(14)
  ds_read_b64_tr_b16 a[172:173], v199 offset:20480
  v_add_u32 v252, 0, v225
  v_mfma_f32_16x16x32_bf16 v[60:63], a[148:151], a[132:135], v[60:63]
  s_waitcnt lgkmcnt(14)
  ds_read_b64_tr_b16 a[174:175], v199 offset:20992
  v_mul_u32_u24 v253, 10923, v252
  v_mfma_f32_16x16x32_bf16 v[0:3], a[152:155], a[136:139], v[0:3]
  s_waitcnt lgkmcnt(14)
  ds_read_b64_tr_b16 a[144:145], v200 offset:20480
  v_lshrrev_b32 v253, 16, v253
  v_mfma_f32_16x16x32_bf16 v[4:7], a[152:155], a[140:143], v[4:7]
  s_waitcnt lgkmcnt(14)
  ds_read_b64_tr_b16 a[146:147], v200 offset:20992
  v_mul_u32_u24 v203, 6, v253
  s_waitcnt lgkmcnt(5)
  v_mfma_f32_16x16x32_bf16 v[8:11], a[156:159], a[136:139], v[8:11]
  ds_read_b64_tr_b16 a[148:149], v201 offset:20480
  v_sub_u32 v203, v252, v203
  v_bfe_u32 v252, v253, 3, 1
  s_waitcnt vmcnt(21)
  v_mfma_f32_16x16x32_bf16 v[12:15], a[156:159], a[140:143], v[12:15]
  ds_read_b64_tr_b16 a[150:151], v201 offset:20992
  v_xor_b32 v203, v203, v252
  v_sub_u32 v198, v198, v254
  v_sub_u32 v199, v199, v254
  v_sub_u32 v200, v200, v254
  v_sub_u32 v201, v201, v254
  s_barrier
  v_mfma_f32_16x16x32_bf16 v[16:19], a[160:163], a[136:139], v[16:19]
  ds_read_b64_tr_b16 a[152:153], v198 offset:24576
  s_add_u32 s44, s66, 110848
  v_mfma_f32_16x16x32_bf16 v[20:23], a[160:163], a[140:143], v[20:23]
  ds_read_b64_tr_b16 a[154:155], v198 offset:26624
  s_add_u32 m0, s46, 49152
  s_nop 0
  buffer_load_dwordx4 v209, s[12:15], s44 offen lds
  v_mfma_f32_16x16x32_bf16 v[24:27], a[164:167], a[136:139], v[24:27]
  ds_read_b64_tr_b16 a[156:157], v199 offset:24576
  v_fmac_f32 v132, v234, v228
  v_mfma_f32_16x16x32_bf16 v[28:31], a[164:167], a[140:143], v[28:31]
  ds_read_b64_tr_b16 a[158:159], v199 offset:26624
  v_fmac_f32 v140, v234, v229
  v_mfma_f32_16x16x32_bf16 v[32:35], a[168:171], a[136:139], v[32:35]
  ds_read_b64_tr_b16 a[160:161], v200 offset:24576
  v_fma_f32 v132, -v235, v229, v132
  v_fmac_f32 v140, v235, v228
  v_mfma_f32_16x16x32_bf16 v[36:39], a[168:171], a[140:143], v[36:39]
  ds_read_b64_tr_b16 a[162:163], v200 offset:26624
  s_waitcnt lgkmcnt(4)
  v_mfma_f32_16x16x32_bf16 v[40:43], a[172:175], a[136:139], v[40:43]
  ds_read_b64_tr_b16 a[164:165], v201 offset:24576
  v_fmac_f32 v133, v236, v228
  v_mfma_f32_16x16x32_bf16 v[44:47], a[172:175], a[140:143], v[44:47]
  ds_read_b64_tr_b16 a[166:167], v201 offset:26624
  v_fmac_f32 v141, v236, v229
  v_fma_f32 v133, -v237, v229, v133
  v_mfma_f32_16x16x32_bf16 v[48:51], a[144:147], a[136:139], v[48:51]
  ds_read_b64_tr_b16 a[168:169], v198 offset:36864
  buffer_load_dwordx4 v210, s[12:15], s44 offen offset:1024 lds
  v_mfma_f32_16x16x32_bf16 v[52:55], a[144:147], a[140:143], v[52:55]
  ds_read_b64_tr_b16 a[170:171], v198 offset:38912
  v_fmac_f32 v141, v237, v228
  v_fmac_f32 v134, v238, v228
  v_mfma_f32_16x16x32_bf16 v[56:59], a[148:151], a[136:139], v[56:59]
  ds_read_b64_tr_b16 a[172:173], v199 offset:36864
  v_fmac_f32 v142, v238, v229
  v_mfma_f32_16x16x32_bf16 v[60:63], a[148:151], a[140:143], v[60:63]
  ds_read_b64_tr_b16 a[174:175], v199 offset:38912
  v_fma_f32 v134, -v239, v229, v134
  v_mfma_f32_16x16x32_bf16 v[64:67], a[152:155], a[176:179], 0
  ds_read_b64_tr_b16 a[144:145], v200 offset:36864
  v_fmac_f32 v142, v239, v228
  v_fmac_f32 v135, v240, v228
  v_mfma_f32_16x16x32_bf16 v[68:71], a[152:155], a[180:183], 0
  ds_read_b64_tr_b16 a[146:147], v200 offset:38912
  s_waitcnt lgkmcnt(4)
  v_mfma_f32_16x16x32_bf16 v[72:75], a[156:159], a[176:179], 0
  ds_read_b64_tr_b16 a[148:149], v201 offset:36864
  v_fmac_f32 v143, v240, v229
  v_mfma_f32_16x16x32_bf16 v[76:79], a[156:159], a[180:183], 0
  ds_read_b64_tr_b16 a[150:151], v201 offset:38912
  buffer_load_dwordx4 v211, s[12:15], s44 offen offset:2048 lds
  v_fma_f32 v135, -v241, v229, v135
  v_mfma_f32_16x16x32_bf16 v[80:83], a[160:163], a[176:179], 0
  ds_read_b64_tr_b16 a[152:153], v198 offset:28672
  v_max_f32 v0, 0, v0
  v_mfma_f32_16x16x32_bf16 v[84:87], a[160:163], a[180:183], 0
  ds_read_b64_tr_b16 a[154:155], v198 offset:30720
  v_mul_f32 v32, v215, v32
  v_mfma_f32_16x16x32_bf16 v[88:91], a[164:167], a[176:179], 0
  ds_read_b64_tr_b16 a[156:157], v199 offset:28672
  v_max_f32 v1, 0, v1
  v_mul_f32 v33, v215, v33
  v_mfma_f32_16x16x32_bf16 v[92:95], a[164:167], a[180:183], 0
  ds_read_b64_tr_b16 a[158:159], v199 offset:30720
  v_max_f32 v2, 0, v2
  v_mfma_f32_16x16x32_bf16 v[96:99], a[168:171], a[176:179], 0
  ds_read_b64_tr_b16 a[160:161], v200 offset:28672
  v_mul_f32 v34, v215, v34
  v_max_f32 v3, 0, v3
  v_mfma_f32_16x16x32_bf16 v[100:103], a[168:171], a[180:183], 0
  ds_read_b64_tr_b16 a[162:163], v200 offset:30720
  s_waitcnt lgkmcnt(4)
  v_mfma_f32_16x16x32_bf16 v[104:107], a[172:175], a[176:179], 0
  ds_read_b64_tr_b16 a[164:165], v201 offset:28672
  buffer_load_dwordx4 v212, s[12:15], s44 offen offset:3072 lds
  v_mfma_f32_16x16x32_bf16 v[108:111], a[172:175], a[180:183], 0
  ds_read_b64_tr_b16 a[166:167], v201 offset:30720
  s_add_u32 m0, s46, 53248
  v_mul_f32 v35, v215, v35
  v_mfma_f32_16x16x32_bf16 v[112:115], a[144:147], a[176:179], 0
  ds_read_b64_tr_b16 a[168:169], v198 offset:40960
  v_mul_f32 v0, v0, v32
  v_mfma_f32_16x16x32_bf16 v[116:119], a[144:147], a[180:183], 0
  ds_read_b64_tr_b16 a[170:171], v198 offset:43008
  v_mul_f32 v1, v1, v33
  v_mfma_f32_16x16x32_bf16 v[120:123], a[148:151], a[176:179], 0
  ds_read_b64_tr_b16 a[172:173], v199 offset:40960
  v_mul_f32 v2, v2, v34
  v_mul_f32 v3, v3, v35
  v_mfma_f32_16x16x32_bf16 v[124:127], a[148:151], a[180:183], 0
  ds_read_b64_tr_b16 a[174:175], v199 offset:43008
  v_max_f32 v8, 0, v8
  v_mfma_f32_16x16x32_bf16 v[64:67], a[152:155], a[184:187], v[64:67]
  ds_read_b64_tr_b16 a[144:145], v200 offset:40960
  v_mul_f32 v40, v215, v40
  v_max_f32 v9, 0, v9
  v_mfma_f32_16x16x32_bf16 v[68:71], a[152:155], a[188:191], v[68:71]
  ds_read_b64_tr_b16 a[146:147], v200 offset:43008
  s_waitcnt lgkmcnt(4)
  v_mfma_f32_16x16x32_bf16 v[72:75], a[156:159], a[184:187], v[72:75]
  ds_read_b64_tr_b16 a[148:149], v201 offset:40960
  buffer_load_dwordx4 v213, s[12:15], s44 offen lds
  v_mfma_f32_16x16x32_bf16 v[76:79], a[156:159], a[188:191], v[76:79]
  ds_read_b64_tr_b16 a[150:151], v201 offset:43008
  v_mul_f32 v41, v215, v41
  v_max_f32 v10, 0, v10
  v_mfma_f32_16x16x32_bf16 v[80:83], a[160:163], a[184:187], v[80:83]
  ds_read_b64_tr_b16 a[152:153], v198 offset:32768
  v_mul_f32 v42, v215, v42
  v_mfma_f32_16x16x32_bf16 v[84:87], a[160:163], a[188:191], v[84:87]
  ds_read_b64_tr_b16 a[154:155], v198 offset:34816
  v_max_f32 v11, 0, v11
  v_mfma_f32_16x16x32_bf16 v[88:91], a[164:167], a[184:187], v[88:91]
  ds_read_b64_tr_b16 a[156:157], v199 offset:32768
  v_mul_f32 v43, v215, v43
  v_mul_f32 v8, v8, v40
  v_mfma_f32_16x16x32_bf16 v[92:95], a[164:167], a[188:191], v[92:95]
  ds_read_b64_tr_b16 a[158:159], v199 offset:34816
  v_mul_f32 v9, v9, v41
  v_mfma_f32_16x16x32_bf16 v[96:99], a[168:171], a[184:187], v[96:99]
  ds_read_b64_tr_b16 a[160:161], v200 offset:32768
  v_mul_f32 v10, v10, v42
  v_mul_f32 v11, v11, v43
  v_mfma_f32_16x16x32_bf16 v[100:103], a[168:171], a[188:191], v[100:103]
  ds_read_b64_tr_b16 a[162:163], v200 offset:34816
  s_waitcnt lgkmcnt(4)
  v_mfma_f32_16x16x32_bf16 v[104:107], a[172:175], a[184:187], v[104:107]
  ds_read_b64_tr_b16 a[164:165], v201 offset:32768
  buffer_load_dwordx4 v214, s[12:15], s44 offen offset:1024 lds
  v_mfma_f32_16x16x32_bf16 v[108:111], a[172:175], a[188:191], v[108:111]
  ds_read_b64_tr_b16 a[166:167], v201 offset:34816
  v_cvt_pk_bf16_f32 v32, v0, v1
  v_cvt_pk_bf16_f32 v33, v2, v3
  v_mfma_f32_16x16x32_bf16 v[112:115], a[144:147], a[184:187], v[112:115]
  ds_read_b64_tr_b16 a[168:169], v198 offset:45056
  v_cvt_pk_bf16_f32 v34, v8, v9
  v_mfma_f32_16x16x32_bf16 v[116:119], a[144:147], a[188:191], v[116:119]
  ds_read_b64_tr_b16 a[170:171], v198 offset:47104
  v_cvt_pk_bf16_f32 v35, v10, v11
  v_mfma_f32_16x16x32_bf16 v[120:123], a[148:151], a[184:187], v[120:123]
  ds_read_b64_tr_b16 a[172:173], v199 offset:45056
  v_accvgpr_write_b32 a224, v32
  v_accvgpr_write_b32 a225, v33
  v_mfma_f32_16x16x32_bf16 v[124:127], a[148:151], a[188:191], v[124:127]
  ds_read_b64_tr_b16 a[174:175], v199 offset:47104
  v_accvgpr_write_b32 a226, v34
  v_mfma_f32_16x16x32_bf16 v[64:67], a[152:155], a[192:195], v[64:67]
  ds_read_b64_tr_b16 a[144:145], v200 offset:45056
  v_accvgpr_write_b32 a227, v35
  v_mfma_f32_16x16x32_bf16 v[68:71], a[152:155], a[196:199], v[68:71]
  ds_read_b64_tr_b16 a[146:147], v200 offset:47104
  s_add_u32 s63, s61, 12288
  buffer_store_dwordx4 v[32:35], v226, s[24:27], s63 offen sc1
  s_waitcnt lgkmcnt(4)
  v_mfma_f32_16x16x32_bf16 v[72:75], a[156:159], a[192:195], v[72:75]
  ds_read_b64_tr_b16 a[148:149], v201 offset:45056
  s_waitcnt vmcnt(21)
  v_mfma_f32_16x16x32_bf16 v[76:79], a[156:159], a[196:199], v[76:79]
  ds_read_b64_tr_b16 a[150:151], v201 offset:47104
  v_max_f32 v4, 0, v4
  s_barrier
  v_mfma_f32_16x16x32_bf16 v[80:83], a[160:163], a[192:195], v[80:83]
  ds_read_b64_tr_b16 a[152:153], v194 offset:24576
  s_add_u32 s44, s66, 221184
  v_mfma_f32_16x16x32_bf16 v[84:87], a[160:163], a[196:199], v[84:87]
  ds_read_b64_tr_b16 a[154:155], v194 offset:26624
  s_add_u32 m0, s46, 98304
  v_mfma_f32_16x16x32_bf16 v[88:91], a[164:167], a[192:195], v[88:91]
  ds_read_b64_tr_b16 a[156:157], v195 offset:24576
  buffer_load_dwordx4 v209, s[12:15], s44 offen lds
  v_mul_f32 v36, v216, v36
  v_mfma_f32_16x16x32_bf16 v[92:95], a[164:167], a[196:199], v[92:95]
  ds_read_b64_tr_b16 a[158:159], v195 offset:26624
  v_max_f32 v5, 0, v5
  v_mfma_f32_16x16x32_bf16 v[96:99], a[168:171], a[192:195], v[96:99]
  ds_read_b64_tr_b16 a[160:161], v196 offset:24576
  v_mul_f32 v37, v216, v37
  v_mfma_f32_16x16x32_bf16 v[100:103], a[168:171], a[196:199], v[100:103]
  ds_read_b64_tr_b16 a[162:163], v196 offset:26624
  v_max_f32 v6, 0, v6
  s_waitcnt lgkmcnt(4)
  v_mfma_f32_16x16x32_bf16 v[104:107], a[172:175], a[192:195], v[104:107]
  ds_read_b64_tr_b16 a[164:165], v197 offset:24576
  v_mul_f32 v38, v216, v38
  v_mfma_f32_16x16x32_bf16 v[108:111], a[172:175], a[196:199], v[108:111]
  ds_read_b64_tr_b16 a[166:167], v197 offset:26624
  v_max_f32 v7, 0, v7
  v_mul_f32 v39, v216, v39
  v_mfma_f32_16x16x32_bf16 v[112:115], a[144:147], a[192:195], v[112:115]
  ds_read_b64_tr_b16 a[168:169], v194 offset:36864
  v_mul_f32 v4, v4, v36
  v_mfma_f32_16x16x32_bf16 v[116:119], a[144:147], a[196:199], v[116:119]
  ds_read_b64_tr_b16 a[170:171], v194 offset:38912
  buffer_load_dwordx4 v210, s[12:15], s44 offen offset:1024 lds
  v_mfma_f32_16x16x32_bf16 v[120:123], a[148:151], a[192:195], v[120:123]
  ds_read_b64_tr_b16 a[172:173], v195 offset:36864
  v_mul_f32 v5, v5, v37
  v_mul_f32 v6, v6, v38
  v_mfma_f32_16x16x32_bf16 v[124:127], a[148:151], a[196:199], v[124:127]
  ds_read_b64_tr_b16 a[174:175], v195 offset:38912
  v_mul_f32 v7, v7, v39
  v_mfma_f32_16x16x32_bf16 v[64:67], a[152:155], a[200:203], v[64:67]
  ds_read_b64_tr_b16 a[144:145], v196 offset:36864
  v_max_f32 v12, 0, v12
  v_mfma_f32_16x16x32_bf16 v[68:71], a[152:155], a[204:207], v[68:71]
  ds_read_b64_tr_b16 a[146:147], v196 offset:38912
  v_mul_f32 v44, v216, v44
  s_waitcnt lgkmcnt(4)
  v_mfma_f32_16x16x32_bf16 v[72:75], a[156:159], a[200:203], v[72:75]
  ds_read_b64_tr_b16 a[148:149], v197 offset:36864
  v_max_f32 v13, 0, v13
  v_mfma_f32_16x16x32_bf16 v[76:79], a[156:159], a[204:207], v[76:79]
  ds_read_b64_tr_b16 a[150:151], v197 offset:38912
  v_mul_f32 v45, v216, v45
  v_mfma_f32_16x16x32_bf16 v[80:83], a[160:163], a[200:203], v[80:83]
  ds_read_b64_tr_b16 a[152:153], v194 offset:28672
  buffer_load_dwordx4 v211, s[12:15], s44 offen offset:2048 lds
  v_max_f32 v14, 0, v14
  v_mfma_f32_16x16x32_bf16 v[84:87], a[160:163], a[204:207], v[84:87]
  ds_read_b64_tr_b16 a[154:155], v194 offset:30720
  v_mul_f32 v46, v216, v46
  v_mfma_f32_16x16x32_bf16 v[88:91], a[164:167], a[200:203], v[88:91]
  ds_read_b64_tr_b16 a[156:157], v195 offset:28672
  v_max_f32 v15, 0, v15
  v_mul_f32 v47, v216, v47
  v_mfma_f32_16x16x32_bf16 v[92:95], a[164:167], a[204:207], v[92:95]
  ds_read_b64_tr_b16 a[158:159], v195 offset:30720
  v_mul_f32 v12, v12, v44
  v_mfma_f32_16x16x32_bf16 v[96:99], a[168:171], a[200:203], v[96:99]
  ds_read_b64_tr_b16 a[160:161], v196 offset:28672
  v_mul_f32 v13, v13, v45
  v_mfma_f32_16x16x32_bf16 v[100:103], a[168:171], a[204:207], v[100:103]
  ds_read_b64_tr_b16 a[162:163], v196 offset:30720
  v_mul_f32 v14, v14, v46
  s_waitcnt lgkmcnt(4)
  v_mfma_f32_16x16x32_bf16 v[104:107], a[172:175], a[200:203], v[104:107]
  ds_read_b64_tr_b16 a[164:165], v197 offset:28672
  v_mul_f32 v15, v15, v47
  v_mfma_f32_16x16x32_bf16 v[108:111], a[172:175], a[204:207], v[108:111]
  ds_read_b64_tr_b16 a[166:167], v197 offset:30720
  buffer_load_dwordx4 v212, s[12:15], s44 offen offset:3072 lds
  v_mfma_f32_16x16x32_bf16 v[112:115], a[144:147], a[200:203], v[112:115]
  ds_read_b64_tr_b16 a[168:169], v194 offset:40960
  s_add_u32 m0, s46, 102400
  v_cvt_pk_bf16_f32 v36, v4, v5
  v_mfma_f32_16x16x32_bf16 v[116:119], a[144:147], a[204:207], v[116:119]
  ds_read_b64_tr_b16 a[170:171], v194 offset:43008
  v_cvt_pk_bf16_f32 v37, v6, v7
  v_mfma_f32_16x16x32_bf16 v[120:123], a[148:151], a[200:203], v[120:123]
  ds_read_b64_tr_b16 a[172:173], v195 offset:40960
  v_cvt_pk_bf16_f32 v38, v12, v13
  v_mfma_f32_16x16x32_bf16 v[124:127], a[148:151], a[204:207], v[124:127]
  ds_read_b64_tr_b16 a[174:175], v195 offset:43008
  v_cvt_pk_bf16_f32 v39, v14, v15
  v_accvgpr_write_b32 a228, v36
  v_mfma_f32_16x16x32_bf16 v[64:67], a[152:155], a[208:211], v[64:67]
  ds_read_b64_tr_b16 a[144:145], v196 offset:40960
  v_accvgpr_write_b32 a229, v37
  v_mfma_f32_16x16x32_bf16 v[68:71], a[152:155], a[212:215], v[68:71]
  ds_read_b64_tr_b16 a[146:147], v196 offset:43008
  v_accvgpr_write_b32 a230, v38
  s_waitcnt lgkmcnt(4)
  v_mfma_f32_16x16x32_bf16 v[72:75], a[156:159], a[208:211], v[72:75]
  ds_read_b64_tr_b16 a[148:149], v197 offset:40960
  buffer_load_dwordx4 v213, s[12:15], s44 offen lds
  v_mfma_f32_16x16x32_bf16 v[76:79], a[156:159], a[212:215], v[76:79]
  ds_read_b64_tr_b16 a[150:151], v197 offset:43008
  v_accvgpr_write_b32 a231, v39
  v_mfma_f32_16x16x32_bf16 v[80:83], a[160:163], a[208:211], v[80:83]
  ds_read_b64_tr_b16 a[152:153], v194 offset:32768
  v_fmac_f32 v143, v241, v228
  v_mul_f32 v250, v242, v132
  v_mfma_f32_16x16x32_bf16 v[84:87], a[160:163], a[212:215], v[84:87]
  ds_read_b64_tr_b16 a[154:155], v194 offset:34816
  v_fma_f32 v250, -v243, v140, v250
  v_mfma_f32_16x16x32_bf16 v[88:91], a[164:167], a[208:211], v[88:91]
  ds_read_b64_tr_b16 a[156:157], v195 offset:32768
  v_mul_f32 v140, v242, v140
  v_mfma_f32_16x16x32_bf16 v[92:95], a[164:167], a[212:215], v[92:95]
  ds_read_b64_tr_b16 a[158:159], v195 offset:34816
  s_add_u32 s63, s61, 12288
  buffer_store_dwordx4 v[36:39], v226, s[24:27], s63 offen offset:1024 sc1
  v_mfma_f32_16x16x32_bf16 v[96:99], a[168:171], a[208:211], v[96:99]
  ds_read_b64_tr_b16 a[160:161], v196 offset:32768
  v_max_f32 v16, 0, v16
  v_mfma_f32_16x16x32_bf16 v[100:103], a[168:171], a[212:215], v[100:103]
  ds_read_b64_tr_b16 a[162:163], v196 offset:34816
  s_waitcnt lgkmcnt(4)
  v_mfma_f32_16x16x32_bf16 v[104:107], a[172:175], a[208:211], v[104:107]
  ds_read_b64_tr_b16 a[164:165], v197 offset:32768
  v_mul_f32 v48, v215, v48
  v_max_f32 v17, 0, v17
  v_mfma_f32_16x16x32_bf16 v[108:111], a[172:175], a[212:215], v[108:111]
  ds_read_b64_tr_b16 a[166:167], v197 offset:34816
  v_mul_f32 v49, v215, v49
  v_mfma_f32_16x16x32_bf16 v[112:115], a[144:147], a[208:211], v[112:115]
  ds_read_b64_tr_b16 a[168:169], v194 offset:45056
  buffer_load_dwordx4 v214, s[12:15], s44 offen offset:1024 lds
  v_max_f32 v18, 0, v18
  v_mfma_f32_16x16x32_bf16 v[116:119], a[144:147], a[212:215], v[116:119]
  ds_read_b64_tr_b16 a[170:171], v194 offset:47104
  v_mul_f32 v50, v215, v50
  v_mfma_f32_16x16x32_bf16 v[120:123], a[148:151], a[208:211], v[120:123]
  ds_read_b64_tr_b16 a[172:173], v195 offset:45056
  v_max_f32 v19, 0, v19
  v_mfma_f32_16x16x32_bf16 v[124:127], a[148:151], a[212:215], v[124:127]
  ds_read_b64_tr_b16 a[174:175], v195 offset:47104
  v_mul_f32 v51, v215, v51
  v_mul_f32 v16, v16, v48
  v_mfma_f32_16x16x32_bf16 v[64:67], a[152:155], a[216:219], v[64:67]
  ds_read_b64_tr_b16 a[144:145], v196 offset:45056
  v_mul_f32 v17, v17, v49
  v_mfma_f32_16x16x32_bf16 v[68:71], a[152:155], a[220:223], v[68:71]
  ds_read_b64_tr_b16 a[146:147], v196 offset:47104
  s_waitcnt lgkmcnt(4)
  v_mfma_f32_16x16x32_bf16 v[72:75], a[156:159], a[216:219], v[72:75]
  ds_read_b64_tr_b16 a[148:149], v197 offset:45056
  v_mul_f32 v18, v18, v50
  s_waitcnt vmcnt(20)
  v_mfma_f32_16x16x32_bf16 v[76:79], a[156:159], a[220:223], v[76:79]
  ds_read_b64_tr_b16 a[150:151], v197 offset:47104
  s_barrier
  v_mfma_f32_16x16x32_bf16 v[80:83], a[160:163], a[216:219], v[80:83]
  ds_read_b64_tr_b16 a[152:153], v190
  s_add_u32 s44, s66, 221440
  v_mfma_f32_16x16x32_bf16 v[84:87], a[160:163], a[220:223], v[84:87]
  ds_read_b64_tr_b16 a[154:155], v190 offset:2048
  s_add_u32 m0, s46, 122880
  s_nop 0
  buffer_load_dwordx4 v209, s[12:15], s44 offen lds
  v_mfma_f32_16x16x32_bf16 v[88:91], a[164:167], a[216:219], v[88:91]
  ds_read_b64_tr_b16 a[156:157], v191
  v_mul_f32 v19, v19, v51
  v_mfma_f32_16x16x32_bf16 v[92:95], a[164:167], a[220:223], v[92:95]
  ds_read_b64_tr_b16 a[158:159], v191 offset:2048
  v_max_f32 v24, 0, v24
  v_mul_f32 v56, v215, v56
  v_mfma_f32_16x16x32_bf16 v[96:99], a[168:171], a[216:219], v[96:99]
  ds_read_b64_tr_b16 a[160:161], v192
  v_max_f32 v25, 0, v25
  v_mfma_f32_16x16x32_bf16 v[100:103], a[168:171], a[220:223], v[100:103]
  ds_read_b64_tr_b16 a[162:163], v192 offset:2048
  s_waitcnt lgkmcnt(4)
  v_mfma_f32_16x16x32_bf16 v[104:107], a[172:175], a[216:219], v[104:107]
  ds_read_b64_tr_b16 a[164:165], v193
  v_mul_f32 v57, v215, v57
  v_max_f32 v26, 0, v26
  v_mfma_f32_16x16x32_bf16 v[108:111], a[172:175], a[220:223], v[108:111]
  ds_read_b64_tr_b16 a[166:167], v193 offset:2048
  v_mul_f32 v58, v215, v58
  v_mfma_f32_16x16x32_bf16 v[112:115], a[144:147], a[216:219], v[112:115]
  ds_read_b64_tr_b16 a[168:169], v190 offset:4096
  buffer_load_dwordx4 v210, s[12:15], s44 offen offset:1024 lds
  v_mfma_f32_16x16x32_bf16 v[116:119], a[144:147], a[220:223], v[116:119]
  ds_read_b64_tr_b16 a[170:171], v190 offset:6144
  v_max_f32 v27, 0, v27
  v_mul_f32 v59, v215, v59
  v_mfma_f32_16x16x32_bf16 v[120:123], a[148:151], a[216:219], v[120:123]
  ds_read_b64_tr_b16 a[172:173], v191 offset:4096
  v_mul_f32 v24, v24, v56
  v_mfma_f32_16x16x32_bf16 v[124:127], a[148:151], a[220:223], v[124:127]
  ds_read_b64_tr_b16 a[174:175], v191 offset:6144
  v_mul_f32 v25, v25, v57
  v_mfma_f32_16x16x32_bf16 a[96:99], a[152:155], a[176:179], 0
  ds_read_b64_tr_b16 a[144:145], v192 offset:4096
  v_mul_f32 v26, v26, v58
  v_mul_f32 v27, v27, v59
  v_mfma_f32_16x16x32_bf16 a[100:103], a[152:155], a[180:183], 0
  ds_read_b64_tr_b16 a[146:147], v192 offset:6144
  s_waitcnt lgkmcnt(4)
  v_mfma_f32_16x16x32_bf16 a[104:107], a[156:159], a[176:179], 0
  ds_read_b64_tr_b16 a[148:149], v193 offset:4096
  buffer_load_dword v202, v188, s[24:27], 0 offen sc1
  v_cvt_pk_bf16_f32 v48, v16, v17
  v_mfma_f32_16x16x32_bf16 a[108:111], a[156:159], a[180:183], 0
  ds_read_b64_tr_b16 a[150:151], v193 offset:6144
  v_cvt_pk_bf16_f32 v49, v18, v19
  v_mfma_f32_16x16x32_bf16 a[112:115], a[160:163], a[176:179], 0
  ds_read_b64_tr_b16 a[152:153], v190 offset:8192
  v_cvt_pk_bf16_f32 v50, v24, v25
  v_mfma_f32_16x16x32_bf16 a[116:119], a[160:163], a[180:183], 0
  ds_read_b64_tr_b16 a[154:155], v190 offset:10240
  v_cvt_pk_bf16_f32 v51, v26, v27
  v_accvgpr_write_b32 a232, v48
  v_mfma_f32_16x16x32_bf16 a[120:123], a[164:167], a[176:179], 0
  ds_read_b64_tr_b16 a[156:157], v191 offset:8192
  v_accvgpr_write_b32 a233, v49
  v_mfma_f32_16x16x32_bf16 a[124:127], a[164:167], a[180:183], 0
  ds_read_b64_tr_b16 a[158:159], v191 offset:10240
  buffer_load_dwordx4 v211, s[12:15], s44 offen offset:2048 lds
  v_mfma_f32_16x16x32_bf16 a[96:99], a[168:171], a[184:187], a[96:99]
  ds_read_b64_tr_b16 a[160:161], v192 offset:8192
  v_accvgpr_write_b32 a234, v50
  v_accvgpr_write_b32 a235, v51
  v_mfma_f32_16x16x32_bf16 a[100:103], a[168:171], a[188:191], a[100:103]
  ds_read_b64_tr_b16 a[162:163], v192 offset:10240
  s_waitcnt lgkmcnt(4)
  v_mfma_f32_16x16x32_bf16 a[104:107], a[172:175], a[184:187], a[104:107]
  ds_read_b64_tr_b16 a[164:165], v193 offset:8192
  v_fmac_f32 v140, v243, v132
  v_mfma_f32_16x16x32_bf16 a[108:111], a[172:175], a[188:191], a[108:111]
  ds_read_b64_tr_b16 a[166:167], v193 offset:10240
  v_mul_f32 v132, v180, v250
  v_mul_f32_e64 v140, -v180, v140
  v_mfma_f32_16x16x32_bf16 a[112:115], a[144:147], a[184:187], a[112:115]
  ds_read_b64_tr_b16 a[168:169], v190 offset:12288
  s_add_u32 s63, s61, 12288
  buffer_store_dwordx4 v[48:51], v226, s[24:27], s63 offen offset:2048 sc1
  v_mfma_f32_16x16x32_bf16 a[116:119], a[144:147], a[188:191], a[116:119]
  ds_read_b64_tr_b16 a[170:171], v190 offset:14336
  v_max_f32 v20, 0, v20
  v_mul_f32 v52, v216, v52
  v_mfma_f32_16x16x32_bf16 a[120:123], a[148:151], a[184:187], a[120:123]
  ds_read_b64_tr_b16 a[172:173], v191 offset:12288
  v_max_f32 v21, 0, v21
  v_mfma_f32_16x16x32_bf16 a[124:127], a[148:151], a[188:191], a[124:127]
  ds_read_b64_tr_b16 a[174:175], v191 offset:14336
  v_mul_f32 v53, v216, v53
  v_mfma_f32_16x16x32_bf16 a[96:99], a[152:155], a[192:195], a[96:99]
  ds_read_b64_tr_b16 a[144:145], v192 offset:12288
  v_max_f32 v22, 0, v22
  v_mul_f32 v54, v216, v54
  v_mfma_f32_16x16x32_bf16 a[100:103], a[152:155], a[196:199], a[100:103]
  ds_read_b64_tr_b16 a[146:147], v192 offset:14336
  s_waitcnt lgkmcnt(4)
  v_mfma_f32_16x16x32_bf16 a[104:107], a[156:159], a[192:195], a[104:107]
  ds_read_b64_tr_b16 a[148:149], v193 offset:12288
  buffer_load_dwordx4 v212, s[12:15], s44 offen offset:3072 lds
  s_add_u32 m0, s46, 126976
  v_mfma_f32_16x16x32_bf16 a[108:111], a[156:159], a[196:199], a[108:111]
  ds_read_b64_tr_b16 a[150:151], v193 offset:14336
  v_max_f32 v23, 0, v23
  v_mfma_f32_16x16x32_bf16 a[112:115], a[160:163], a[192:195], a[112:115]
  ds_read_b64_tr_b16 a[152:153], v190 offset:16384
  v_mul_f32 v55, v216, v55
  v_mul_f32 v20, v20, v52
  v_mfma_f32_16x16x32_bf16 a[116:119], a[160:163], a[196:199], a[116:119]
  ds_read_b64_tr_b16 a[154:155], v190 offset:18432
  v_mul_f32 v21, v21, v53
  v_mfma_f32_16x16x32_bf16 a[120:123], a[164:167], a[192:195], a[120:123]
  ds_read_b64_tr_b16 a[156:157], v191 offset:16384
  v_mul_f32 v22, v22, v54
  v_mfma_f32_16x16x32_bf16 a[124:127], a[164:167], a[196:199], a[124:127]
  ds_read_b64_tr_b16 a[158:159], v191 offset:18432
  v_mul_f32 v23, v23, v55
  v_max_f32 v28, 0, v28
  v_mfma_f32_16x16x32_bf16 a[96:99], a[168:171], a[200:203], a[96:99]
  ds_read_b64_tr_b16 a[160:161], v192 offset:16384
  v_mul_f32 v60, v216, v60
  v_mfma_f32_16x16x32_bf16 a[100:103], a[168:171], a[204:207], a[100:103]
  ds_read_b64_tr_b16 a[162:163], v192 offset:18432
  buffer_load_dwordx4 v213, s[12:15], s44 offen lds
  s_waitcnt lgkmcnt(4)
  v_mfma_f32_16x16x32_bf16 a[104:107], a[172:175], a[200:203], a[104:107]
  ds_read_b64_tr_b16 a[164:165], v193 offset:16384
  v_max_f32 v29, 0, v29
  v_mfma_f32_16x16x32_bf16 a[108:111], a[172:175], a[204:207], a[108:111]
  ds_read_b64_tr_b16 a[166:167], v193 offset:18432
  v_mul_f32 v61, v216, v61
  v_mfma_f32_16x16x32_bf16 a[112:115], a[144:147], a[200:203], a[112:115]
  ds_read_b64_tr_b16 a[168:169], v190 offset:20480
  v_max_f32 v30, 0, v30
  v_mul_f32 v62, v216, v62
  v_mfma_f32_16x16x32_bf16 a[116:119], a[144:147], a[204:207], a[116:119]
  ds_read_b64_tr_b16 a[170:171], v190 offset:22528
  v_max_f32 v31, 0, v31
  v_mfma_f32_16x16x32_bf16 a[120:123], a[148:151], a[200:203], a[120:123]
  ds_read_b64_tr_b16 a[172:173], v191 offset:20480
  v_mul_f32 v63, v216, v63
  v_mul_f32 v28, v28, v60
  v_mfma_f32_16x16x32_bf16 a[124:127], a[148:151], a[204:207], a[124:127]
  ds_read_b64_tr_b16 a[174:175], v191 offset:22528
  v_mul_f32 v29, v29, v61
  buffer_load_dwordx4 v214, s[12:15], s44 offen offset:1024 lds
  v_mfma_f32_16x16x32_bf16 a[96:99], a[152:155], a[208:211], a[96:99]
  ds_read_b64_tr_b16 a[144:145], v192 offset:20480
  v_mul_f32 v30, v30, v62
  v_mfma_f32_16x16x32_bf16 a[100:103], a[152:155], a[212:215], a[100:103]
  ds_read_b64_tr_b16 a[146:147], v192 offset:22528
  v_mul_f32 v31, v31, v63
  s_waitcnt lgkmcnt(4)
  v_mfma_f32_16x16x32_bf16 a[104:107], a[156:159], a[208:211], a[104:107]
  ds_read_b64_tr_b16 a[148:149], v193 offset:20480
  s_waitcnt vmcnt(22)
  v_mfma_f32_16x16x32_bf16 a[108:111], a[156:159], a[212:215], a[108:111]
  ds_read_b64_tr_b16 a[150:151], v193 offset:22528
  s_barrier
  v_mfma_f32_16x16x32_bf16 a[112:115], a[160:163], a[208:211], a[112:115]
  ds_read_b64_tr_b16 a[152:153], v190 offset:24576
  v_cvt_pk_bf16_f32 v52, v20, v21
  v_cvt_pk_bf16_f32 v53, v22, v23
  v_mfma_f32_16x16x32_bf16 a[116:119], a[160:163], a[212:215], a[116:119]
  ds_read_b64_tr_b16 a[154:155], v190 offset:26624
  v_cvt_pk_bf16_f32 v54, v28, v29
  v_mfma_f32_16x16x32_bf16 a[120:123], a[164:167], a[208:211], a[120:123]
  ds_read_b64_tr_b16 a[156:157], v191 offset:24576
  v_cvt_pk_bf16_f32 v55, v30, v31
  v_mfma_f32_16x16x32_bf16 a[124:127], a[164:167], a[212:215], a[124:127]
  ds_read_b64_tr_b16 a[158:159], v191 offset:26624
  v_accvgpr_write_b32 a236, v52
  v_accvgpr_write_b32 a237, v53
  v_mfma_f32_16x16x32_bf16 a[96:99], a[168:171], a[216:219], a[96:99]
  ds_read_b64_tr_b16 a[160:161], v192 offset:24576
  v_accvgpr_write_b32 a238, v54
  v_mfma_f32_16x16x32_bf16 a[100:103], a[168:171], a[220:223], a[100:103]
  ds_read_b64_tr_b16 a[162:163], v192 offset:26624
  s_waitcnt lgkmcnt(4)
  v_mfma_f32_16x16x32_bf16 a[104:107], a[172:175], a[216:219], a[104:107]
  ds_read_b64_tr_b16 a[164:165], v193 offset:24576
  v_accvgpr_write_b32 a239, v55
  s_add_u32 s63, s61, 12288
  buffer_store_dwordx4 v[52:55], v226, s[24:27], s63 offen offset:3072 sc1
  v_mfma_f32_16x16x32_bf16 a[108:111], a[172:175], a[220:223], a[108:111]
  ds_read_b64_tr_b16 a[166:167], v193 offset:26624
  v_mul_f32 v251, v242, v133
  v_mfma_f32_16x16x32_bf16 a[112:115], a[144:147], a[216:219], a[112:115]
  ds_read_b64_tr_b16 a[168:169], v190 offset:36864
  v_fma_f32 v251, -v243, v141, v251
  v_mfma_f32_16x16x32_bf16 a[116:119], a[144:147], a[220:223], a[116:119]
  ds_read_b64_tr_b16 a[170:171], v190 offset:38912
  v_mul_f32 v141, v242, v141
  s_add_u32 s44, s68, 512
  v_mfma_f32_16x16x32_bf16 a[120:123], a[148:151], a[216:219], a[120:123]
  ds_read_b64_tr_b16 a[172:173], v191 offset:36864
  v_fmac_f32 v141, v243, v133
  v_mfma_f32_16x16x32_bf16 a[124:127], a[148:151], a[220:223], a[124:127]
  ds_read_b64_tr_b16 a[174:175], v191 offset:38912
  v_mul_f32 v133, v181, v251
  v_mfma_f32_16x16x32_bf16 v[0:3], a[152:155], a[176:179], 0
  ds_read_b64_tr_b16 a[144:145], v192 offset:36864
  v_mul_f32_e64 v141, -v181, v141
  v_mul_f32 v250, v242, v134
  v_mfma_f32_16x16x32_bf16 v[4:7], a[152:155], a[180:183], 0
  ds_read_b64_tr_b16 a[146:147], v192 offset:38912
  s_waitcnt lgkmcnt(4)
  v_mfma_f32_16x16x32_bf16 v[8:11], a[156:159], a[176:179], 0
  ds_read_b64_tr_b16 a[148:149], v193 offset:36864
  v_fma_f32 v250, -v243, v142, v250
  v_mfma_f32_16x16x32_bf16 v[12:15], a[156:159], a[180:183], 0
  ds_read_b64_tr_b16 a[150:151], v193 offset:38912
  v_mul_f32 v142, v242, v142
  v_mfma_f32_16x16x32_bf16 v[16:19], a[160:163], a[176:179], 0
  ds_read_b64_tr_b16 a[152:153], v190 offset:28672
  v_fmac_f32 v142, v243, v134
  s_add_u32 m0, s47, 73728
  v_mfma_f32_16x16x32_bf16 v[20:23], a[160:163], a[180:183], 0
  ds_read_b64_tr_b16 a[154:155], v190 offset:30720
  buffer_load_dwordx4 v209, s[12:15], s44 offen lds
  v_mfma_f32_16x16x32_bf16 v[24:27], a[164:167], a[176:179], 0
  ds_read_b64_tr_b16 a[156:157], v191 offset:28672
  v_mul_f32 v134, v182, v250
  v_mfma_f32_16x16x32_bf16 v[28:31], a[164:167], a[180:183], 0
  ds_read_b64_tr_b16 a[158:159], v191 offset:30720
  v_mul_f32_e64 v142, -v182, v142
  v_mfma_f32_16x16x32_bf16 v[32:35], a[168:171], a[176:179], 0
  ds_read_b64_tr_b16 a[160:161], v192 offset:28672
  v_lshlrev_b32 v203, 4, v203
  v_mul_u32_u24 v253, 1152, v253
  v_mfma_f32_16x16x32_bf16 v[36:39], a[168:171], a[180:183], 0
  ds_read_b64_tr_b16 a[162:163], v192 offset:30720
  s_waitcnt lgkmcnt(4)
  v_mfma_f32_16x16x32_bf16 v[40:43], a[172:175], a[176:179], 0
  ds_read_b64_tr_b16 a[164:165], v193 offset:28672
  v_add_u32 v203, v203, v253
  v_mfma_f32_16x16x32_bf16 v[44:47], a[172:175], a[180:183], 0
  ds_read_b64_tr_b16 a[166:167], v193 offset:30720
  v_add_u32 v252, 64, v225
  v_mul_f32 v251, v242, v135
  v_mfma_f32_16x16x32_bf16 v[48:51], a[144:147], a[176:179], 0
  ds_read_b64_tr_b16 a[168:169], v190 offset:40960
  buffer_load_dwordx4 v210, s[12:15], s44 offen offset:1024 lds
  v_mfma_f32_16x16x32_bf16 v[52:55], a[144:147], a[180:183], 0
  ds_read_b64_tr_b16 a[170:171], v190 offset:43008
  v_mul_u32_u24 v253, 10923, v252
  v_mfma_f32_16x16x32_bf16 v[56:59], a[148:151], a[176:179], 0
  ds_read_b64_tr_b16 a[172:173], v191 offset:40960
  v_lshrrev_b32 v253, 16, v253
  v_mfma_f32_16x16x32_bf16 v[60:63], a[148:151], a[180:183], 0
  ds_read_b64_tr_b16 a[174:175], v191 offset:43008
  v_mul_u32_u24 v204, 6, v253
  v_fma_f32 v251, -v243, v143, v251
  v_mfma_f32_16x16x32_bf16 v[0:3], a[152:155], a[184:187], v[0:3]
  ds_read_b64_tr_b16 a[144:145], v192 offset:40960
  v_sub_u32 v204, v252, v204
  v_mfma_f32_16x16x32_bf16 v[4:7], a[152:155], a[188:191], v[4:7]
  ds_read_b64_tr_b16 a[146:147], v192 offset:43008
  s_waitcnt lgkmcnt(4)
  v_mfma_f32_16x16x32_bf16 v[8:11], a[156:159], a[184:187], v[8:11]
  ds_read_b64_tr_b16 a[148:149], v193 offset:40960
  v_bfe_u32 v252, v253, 3, 1
  v_mul_f32 v143, v242, v143
  v_mfma_f32_16x16x32_bf16 v[12:15], a[156:159], a[188:191], v[12:15]
  ds_read_b64_tr_b16 a[150:151], v193 offset:43008
  buffer_load_dwordx4 v211, s[12:15], s44 offen offset:2048 lds
  v_mfma_f32_16x16x32_bf16 v[16:19], a[160:163], a[184:187], v[16:19]
  ds_read_b64_tr_b16 a[152:153], v190 offset:32768
  v_xor_b32 v204, v204, v252
  v_fmac_f32 v143, v243, v135
  v_mfma_f32_16x16x32_bf16 v[20:23], a[160:163], a[188:191], v[20:23]
  ds_read_b64_tr_b16 a[154:155], v190 offset:34816
  v_lshlrev_b32 v204, 4, v204
  v_mfma_f32_16x16x32_bf16 v[24:27], a[164:167], a[184:187], v[24:27]
  ds_read_b64_tr_b16 a[156:157], v191 offset:32768
  v_mul_u32_u24 v253, 1152, v253
  v_mul_f32 v135, v183, v251
  v_mfma_f32_16x16x32_bf16 v[28:31], a[164:167], a[188:191], v[28:31]
  ds_read_b64_tr_b16 a[158:159], v191 offset:34816
  v_add_u32 v204, v204, v253
  v_mfma_f32_16x16x32_bf16 v[32:35], a[168:171], a[184:187], v[32:35]
  ds_read_b64_tr_b16 a[160:161], v192 offset:32768
  v_subrev_u32 v204, 1024, v204
  v_add_u32 v252, 128, v225
  v_mfma_f32_16x16x32_bf16 v[36:39], a[168:171], a[188:191], v[36:39]
  ds_read_b64_tr_b16 a[162:163], v192 offset:34816
  s_waitcnt lgkmcnt(4)
  v_mfma_f32_16x16x32_bf16 v[40:43], a[172:175], a[184:187], v[40:43]
  ds_read_b64_tr_b16 a[164:165], v193 offset:32768
  v_mul_u32_u24 v253, 10923, v252
  v_mul_f32_e64 v143, -v183, v143
  v_mfma_f32_16x16x32_bf16 v[44:47], a[172:175], a[188:191], v[44:47]
  ds_read_b64_tr_b16 a[166:167], v193 offset:34816
  v_lshrrev_b32 v253, 16, v253
  v_cvt_pk_bf16_f32 v132, v132, v133
  v_mfma_f32_16x16x32_bf16 v[48:51], a[144:147], a[184:187], v[48:51]
  ds_read_b64_tr_b16 a[168:169], v190 offset:45056
  v_mul_u32_u24 v205, 6, v253
  v_mfma_f32_16x16x32_bf16 v[52:55], a[144:147], a[188:191], v[52:55]
  ds_read_b64_tr_b16 a[170:171], v190 offset:47104
  v_sub_u32 v205, v252, v205
  v_bfe_u32 v252, v253, 3, 1
  v_mfma_f32_16x16x32_bf16 v[56:59], a[148:151], a[184:187], v[56:59]
  ds_read_b64_tr_b16 a[172:173], v191 offset:45056
  v_xor_b32 v205, v205, v252
  v_cvt_pk_bf16_f32 v133, v134, v135
  v_mfma_f32_16x16x32_bf16 v[60:63], a[148:151], a[188:191], v[60:63]
  ds_read_b64_tr_b16 a[174:175], v191 offset:47104
  v_lshlrev_b32 v205, 4, v205
  v_mul_u32_u24 v253, 1152, v253
  v_mfma_f32_16x16x32_bf16 v[0:3], a[152:155], a[192:195], v[0:3]
  ds_read_b64_tr_b16 a[144:145], v192 offset:45056
  v_add_u32 v205, v205, v253
  v_cvt_pk_bf16_f32 v140, v140, v141
  v_mfma_f32_16x16x32_bf16 v[4:7], a[152:155], a[196:199], v[4:7]
  ds_read_b64_tr_b16 a[146:147], v192 offset:47104
  v_subrev_u32 v205, 2048, v205
  s_waitcnt lgkmcnt(4)
  v_mfma_f32_16x16x32_bf16 v[8:11], a[156:159], a[192:195], v[8:11]
  ds_read_b64_tr_b16 a[148:149], v193 offset:45056
  v_add_u32 v206, 33792, v203
  v_add_u32 v207, 37888, v204
  s_waitcnt vmcnt(20)
  v_mfma_f32_16x16x32_bf16 v[12:15], a[156:159], a[196:199], v[12:15]
  ds_read_b64_tr_b16 a[150:151], v193 offset:47104
  v_add_u32 v208, 37888, v205
  s_barrier
  v_mfma_f32_16x16x32_bf16 v[16:19], a[160:163], a[192:195], v[16:19]
  ds_read_b64_tr_b16 a[152:153], v194
  v_cvt_pk_bf16_f32 v141, v142, v143
  v_mfma_f32_16x16x32_bf16 v[20:23], a[160:163], a[196:199], v[20:23]
  ds_read_b64_tr_b16 a[154:155], v194 offset:2048
  ds_write_b64 v248, v[132:133] offset:1536
  v_mfma_f32_16x16x32_bf16 v[24:27], a[164:167], a[192:195], v[24:27]
  ds_read_b64_tr_b16 a[156:157], v195
  ds_write_b64 v248, v[140:141] offset:2048
  v_mfma_f32_16x16x32_bf16 v[28:31], a[164:167], a[196:199], v[28:31]
  ds_read_b64_tr_b16 a[158:159], v195 offset:2048
  ds_read_b64_tr_b16 v[132:133], v249 offset:1536
  v_mfma_f32_16x16x32_bf16 v[32:35], a[168:171], a[192:195], v[32:35]
  ds_read_b64_tr_b16 a[160:161], v196
  ds_read_b64_tr_b16 v[134:135], v249 offset:2048
  v_mfma_f32_16x16x32_bf16 v[36:39], a[168:171], a[196:199], v[36:39]
  s_waitcnt lgkmcnt(14)
  ds_read_b64_tr_b16 a[162:163], v196 offset:2048
  s_waitcnt lgkmcnt(8)
  v_mfma_f32_16x16x32_bf16 v[40:43], a[172:175], a[192:195], v[40:43]
  ds_read_b64_tr_b16 a[164:165], v197
  ds_read_b128 v[234:237], v247 offset:768
  v_mfma_f32_16x16x32_bf16 v[44:47], a[172:175], a[196:199], v[44:47]
  ds_read_b64_tr_b16 a[166:167], v197 offset:2048
  ds_read_b128 v[238:241], v247 offset:784
  v_mfma_f32_16x16x32_bf16 v[48:51], a[144:147], a[192:195], v[48:51]
  ds_read_b64_tr_b16 a[168:169], v194 offset:12288
  s_waitcnt vmcnt(9)
  v_cmp_le_u32 vcc, 2, v202
  s_nop 3
  s_cmp_eq_u64 vcc, -1
  s_cbranch_scc0 L_slow_A0
L_back_A0:
  v_mfma_f32_16x16x32_bf16 v[52:55], a[144:147], a[196:199], v[52:55]
  ds_read_b64_tr_b16 a[170:171], v194 offset:14336
  ds_read_b64 v[242:243], v247 offset:800
  v_mfma_f32_16x16x32_bf16 v[56:59], a[148:151], a[192:195], v[56:59]
  s_waitcnt lgkmcnt(14)
  ds_read_b64_tr_b16 a[172:173], v195 offset:12288
  s_add_u32 s44, s52, 0
  v_mfma_f32_16x16x32_bf16 v[60:63], a[148:151], a[196:199], v[60:63]
  s_waitcnt lgkmcnt(14)
  ds_read_b64_tr_b16 a[174:175], v195 offset:14336
  s_add_u32 m0, s46, 0
  v_mfma_f32_16x16x32_bf16 v[0:3], a[152:155], a[200:203], v[0:3]
  s_waitcnt lgkmcnt(14)
  ds_read_b64_tr_b16 a[144:145], v196 offset:12288
  buffer_load_dwordx4 v203, s[20:23], s44 offen lds
  v_mfma_f32_16x16x32_bf16 v[4:7], a[152:155], a[204:207], v[4:7]
  s_waitcnt lgkmcnt(14)
  ds_read_b64_tr_b16 a[146:147], v196 offset:14336
  s_waitcnt lgkmcnt(5)
  v_mfma_f32_16x16x32_bf16 v[8:11], a[156:159], a[200:203], v[8:11]
  ds_read_b64_tr_b16 a[148:149], v197 offset:12288
  v_fmac_f32 v148, v234, v230
  v_mfma_f32_16x16x32_bf16 v[12:15], a[156:159], a[204:207], v[12:15]
  ds_read_b64_tr_b16 a[150:151], v197 offset:14336
  v_fmac_f32 v156, v234, v231
  v_mfma_f32_16x16x32_bf16 v[16:19], a[160:163], a[200:203], v[16:19]
  ds_read_b64_tr_b16 a[152:153], v194 offset:4096
  v_fma_f32 v148, -v235, v231, v148
  v_mfma_f32_16x16x32_bf16 v[20:23], a[160:163], a[204:207], v[20:23]
  ds_read_b64_tr_b16 a[154:155], v194 offset:6144
  v_fmac_f32 v156, v235, v230
  v_mfma_f32_16x16x32_bf16 v[24:27], a[164:167], a[200:203], v[24:27]
  ds_read_b64_tr_b16 a[156:157], v195 offset:4096
  v_fmac_f32 v149, v236, v230
  v_mfma_f32_16x16x32_bf16 v[28:31], a[164:167], a[204:207], v[28:31]
  ds_read_b64_tr_b16 a[158:159], v195 offset:6144
  buffer_load_dwordx4 v204, s[20:23], s44 offen offset:1024 lds
  v_mfma_f32_16x16x32_bf16 v[32:35], a[168:171], a[200:203], v[32:35]
  ds_read_b64_tr_b16 a[160:161], v196 offset:4096
  v_fmac_f32 v157, v236, v231
  v_mfma_f32_16x16x32_bf16 v[36:39], a[168:171], a[204:207], v[36:39]
  ds_read_b64_tr_b16 a[162:163], v196 offset:6144
  s_waitcnt lgkmcnt(4)
  v_mfma_f32_16x16x32_bf16 v[40:43], a[172:175], a[200:203], v[40:43]
  ds_read_b64_tr_b16 a[164:165], v197 offset:4096
  v_fma_f32 v149, -v237, v231, v149
  v_mfma_f32_16x16x32_bf16 v[44:47], a[172:175], a[204:207], v[44:47]
  ds_read_b64_tr_b16 a[166:167], v197 offset:6144
  v_fmac_f32 v157, v237, v230
  v_mfma_f32_16x16x32_bf16 v[48:51], a[144:147], a[200:203], v[48:51]
  ds_read_b64_tr_b16 a[168:169], v194 offset:16384
  v_fmac_f32 v150, v238, v230
  v_mfma_f32_16x16x32_bf16 v[52:55], a[144:147], a[204:207], v[52:55]
  ds_read_b64_tr_b16 a[170:171], v194 offset:18432
  v_fmac_f32 v158, v238, v231
  v_mfma_f32_16x16x32_bf16 v[56:59], a[148:151], a[200:203], v[56:59]
  ds_read_b64_tr_b16 a[172:173], v195 offset:16384
  buffer_load_dwordx4 v205, s[20:23], s44 offen offset:2048 lds
  v_mfma_f32_16x16x32_bf16 v[60:63], a[148:151], a[204:207], v[60:63]
  ds_read_b64_tr_b16 a[174:175], v195 offset:18432
  v_fma_f32 v150, -v239, v231, v150
  v_mfma_f32_16x16x32_bf16 v[0:3], a[152:155], a[208:211], v[0:3]
  ds_read_b64_tr_b16 a[144:145], v196 offset:16384
  v_fmac_f32 v158, v239, v230
  v_mfma_f32_16x16x32_bf16 v[4:7], a[152:155], a[212:215], v[4:7]
  ds_read_b64_tr_b16 a[146:147], v196 offset:18432
  s_waitcnt lgkmcnt(4)
  v_mfma_f32_16x16x32_bf16 v[8:11], a[156:159], a[208:211], v[8:11]
  ds_read_b64_tr_b16 a[148:149], v197 offset:16384
  v_fmac_f32 v151, v240, v230
  v_mfma_f32_16x16x32_bf16 v[12:15], a[156:159], a[212:215], v[12:15]
  ds_read_b64_tr_b16 a[150:151], v197 offset:18432
  v_fmac_f32 v159, v240, v231
  v_mfma_f32_16x16x32_bf16 v[16:19], a[160:163], a[208:211], v[16:19]
  ds_read_b64_tr_b16 a[152:153], v194 offset:8192
  v_fma_f32 v151, -v241, v231, v151
  v_mfma_f32_16x16x32_bf16 v[20:23], a[160:163], a[212:215], v[20:23]
  ds_read_b64_tr_b16 a[154:155], v194 offset:10240
  buffer_load_dwordx4 v206, s[20:23], s44 offen offset:3072 lds
  v_mfma_f32_16x16x32_bf16 v[24:27], a[164:167], a[208:211], v[24:27]
  ds_read_b64_tr_b16 a[156:157], v195 offset:8192
  s_add_u32 m0, s46, 4096
  v_mfma_f32_16x16x32_bf16 v[28:31], a[164:167], a[212:215], v[28:31]
  ds_read_b64_tr_b16 a[158:159], v195 offset:10240
  v_fmac_f32 v159, v241, v230
  v_mfma_f32_16x16x32_bf16 v[32:35], a[168:171], a[208:211], v[32:35]
  ds_read_b64_tr_b16 a[160:161], v196 offset:8192
  v_mul_f32 v250, v242, v148
  v_mfma_f32_16x16x32_bf16 v[36:39], a[168:171], a[212:215], v[36:39]
  ds_read_b64_tr_b16 a[162:163], v196 offset:10240
  s_waitcnt lgkmcnt(4)
  v_mfma_f32_16x16x32_bf16 v[40:43], a[172:175], a[208:211], v[40:43]
  ds_read_b64_tr_b16 a[164:165], v197 offset:8192
  v_fma_f32 v250, -v243, v156, v250
  v_mfma_f32_16x16x32_bf16 v[44:47], a[172:175], a[212:215], v[44:47]
  ds_read_b64_tr_b16 a[166:167], v197 offset:10240
  v_mul_f32 v156, v242, v156
  v_mfma_f32_16x16x32_bf16 v[48:51], a[144:147], a[208:211], v[48:51]
  ds_read_b64_tr_b16 a[168:169], v194 offset:20480
  buffer_load_dwordx4 v207, s[20:23], s44 offen lds
  v_mfma_f32_16x16x32_bf16 v[52:55], a[144:147], a[212:215], v[52:55]
  ds_read_b64_tr_b16 a[170:171], v194 offset:22528
  v_fmac_f32 v156, v243, v148
  v_mfma_f32_16x16x32_bf16 v[56:59], a[148:151], a[208:211], v[56:59]
  ds_read_b64_tr_b16 a[172:173], v195 offset:20480
  v_mul_f32 v148, v180, v250
  v_mfma_f32_16x16x32_bf16 v[60:63], a[148:151], a[212:215], v[60:63]
  ds_read_b64_tr_b16 a[174:175], v195 offset:22528
  v_mul_f32_e64 v156, -v180, v156
  buffer_load_dwordx4 v208, s[20:23], s44 offen offset:1024 lds
  v_mfma_f32_16x16x32_bf16 v[0:3], a[152:155], a[216:219], v[0:3]
  ds_read_b64_tr_b16 a[144:145], v196 offset:20480
  v_mul_f32 v251, v242, v149
  v_mfma_f32_16x16x32_bf16 v[4:7], a[152:155], a[220:223], v[4:7]
  ds_read_b64_tr_b16 a[146:147], v196 offset:22528
  s_waitcnt lgkmcnt(4)
  v_mfma_f32_16x16x32_bf16 v[8:11], a[156:159], a[216:219], v[8:11]
  ds_read_b64_tr_b16 a[148:149], v197 offset:20480
  v_mfma_f32_16x16x32_bf16 v[12:15], a[156:159], a[220:223], v[12:15]
  ds_read_b64_tr_b16 a[150:151], v197 offset:22528
  s_barrier
  v_mfma_f32_16x16x32_bf16 v[16:19], a[160:163], a[216:219], v[16:19]
  ds_read_b64_tr_b16 a[152:153], v198
  v_fma_f32 v251, -v243, v157, v251
  v_mfma_f32_16x16x32_bf16 v[20:23], a[160:163], a[220:223], v[20:23]
  ds_read_b64_tr_b16 a[154:155], v198 offset:2048
  v_mul_f32 v157, v242, v157
  v_mfma_f32_16x16x32_bf16 v[24:27], a[164:167], a[216:219], v[24:27]
  ds_read_b64_tr_b16 a[156:157], v199
  v_fmac_f32 v157, v243, v149
  v_mfma_f32_16x16x32_bf16 v[28:31], a[164:167], a[220:223], v[28:31]
  ds_read_b64_tr_b16 a[158:159], v199 offset:2048
  s_add_u32 s44, s52, 147456
  v_mfma_f32_16x16x32_bf16 v[32:35], a[168:171], a[216:219], v[32:35]
  ds_read_b64_tr_b16 a[160:161], v200
  s_add_u32 m0, s46, 24576
  v_mfma_f32_16x16x32_bf16 v[36:39], a[168:171], a[220:223], v[36:39]
  ds_read_b64_tr_b16 a[162:163], v200 offset:2048
  s_waitcnt lgkmcnt(4)
  v_mfma_f32_16x16x32_bf16 v[40:43], a[172:175], a[216:219], v[40:43]
  ds_read_b64_tr_b16 a[164:165], v201
  buffer_load_dwordx4 v203, s[20:23], s44 offen lds
  v_mfma_f32_16x16x32_bf16 v[44:47], a[172:175], a[220:223], v[44:47]
  ds_read_b64_tr_b16 a[166:167], v201 offset:2048
  v_mul_f32 v149, v181, v251
  v_mfma_f32_16x16x32_bf16 v[48:51], a[144:147], a[216:219], v[48:51]
  ds_read_b64_tr_b16 a[168:169], v198 offset:12288
  v_mul_f32_e64 v157, -v181, v157
  v_mfma_f32_16x16x32_bf16 v[52:55], a[144:147], a[220:223], v[52:55]
  ds_read_b64_tr_b16 a[170:171], v198 offset:14336
  v_mul_f32 v250, v242, v150
  v_mfma_f32_16x16x32_bf16 v[56:59], a[148:151], a[216:219], v[56:59]
  ds_read_b64_tr_b16 a[172:173], v199 offset:12288
  v_fma_f32 v250, -v243, v158, v250
  v_mfma_f32_16x16x32_bf16 v[60:63], a[148:151], a[220:223], v[60:63]
  ds_read_b64_tr_b16 a[174:175], v199 offset:14336
  v_mul_f32 v158, v242, v158
  v_mfma_f32_16x16x32_bf16 v[64:67], a[152:155], a[224:227], v[64:67]
  ds_read_b64_tr_b16 a[144:145], v200 offset:12288
  v_fmac_f32 v158, v243, v150
  v_mfma_f32_16x16x32_bf16 v[68:71], a[152:155], a[228:231], v[68:71]
  ds_read_b64_tr_b16 a[146:147], v200 offset:14336
  s_waitcnt lgkmcnt(4)
  v_mfma_f32_16x16x32_bf16 v[72:75], a[156:159], a[224:227], v[72:75]
  ds_read_b64_tr_b16 a[148:149], v201 offset:12288
  buffer_load_dwordx4 v204, s[20:23], s44 offen offset:1024 lds
  v_mfma_f32_16x16x32_bf16 v[76:79], a[156:159], a[228:231], v[76:79]
  ds_read_b64_tr_b16 a[150:151], v201 offset:14336
  v_mul_f32 v150, v182, v250
  v_mfma_f32_16x16x32_bf16 v[80:83], a[160:163], a[224:227], v[80:83]
  ds_read_b64_tr_b16 a[152:153], v198 offset:4096
  v_mul_f32_e64 v158, -v182, v158
  v_mfma_f32_16x16x32_bf16 v[84:87], a[160:163], a[228:231], v[84:87]
  ds_read_b64_tr_b16 a[154:155], v198 offset:6144
  v_mul_f32 v251, v242, v151
  v_mfma_f32_16x16x32_bf16 v[88:91], a[164:167], a[224:227], v[88:91]
  ds_read_b64_tr_b16 a[156:157], v199 offset:4096
  v_fma_f32 v251, -v243, v159, v251
  v_mfma_f32_16x16x32_bf16 v[92:95], a[164:167], a[228:231], v[92:95]
  ds_read_b64_tr_b16 a[158:159], v199 offset:6144
  s_add_u32 s74, s62, 16384
  buffer_load_dwordx4 a[0:3], v226, s[24:27], s74 offen sc1
  v_mfma_f32_16x16x32_bf16 v[96:99], a[168:171], a[224:227], v[96:99]
  ds_read_b64_tr_b16 a[160:161], v200 offset:4096
  v_mul_f32 v159, v242, v159
  v_mfma_f32_16x16x32_bf16 v[100:103], a[168:171], a[228:231], v[100:103]
  ds_read_b64_tr_b16 a[162:163], v200 offset:6144
  s_waitcnt lgkmcnt(4)
  v_mfma_f32_16x16x32_bf16 v[104:107], a[172:175], a[224:227], v[104:107]
  ds_read_b64_tr_b16 a[164:165], v201 offset:4096
  v_fmac_f32 v159, v243, v151
  v_mfma_f32_16x16x32_bf16 v[108:111], a[172:175], a[228:231], v[108:111]
  ds_read_b64_tr_b16 a[166:167], v201 offset:6144
  v_mul_f32 v151, v183, v251
  v_mfma_f32_16x16x32_bf16 v[112:115], a[144:147], a[224:227], v[112:115]
  ds_read_b64_tr_b16 a[168:169], v198 offset:16384
  buffer_load_dwordx4 v205, s[20:23], s44 offen offset:2048 lds
  v_mfma_f32_16x16x32_bf16 v[116:119], a[144:147], a[228:231], v[116:119]
  ds_read_b64_tr_b16 a[170:171], v198 offset:18432
  v_mul_f32_e64 v159, -v183, v159
  v_mfma_f32_16x16x32_bf16 v[120:123], a[148:151], a[224:227], v[120:123]
  ds_read_b64_tr_b16 a[172:173], v199 offset:16384
  v_cvt_pk_bf16_f32 v148, v148, v149
  v_mfma_f32_16x16x32_bf16 v[124:127], a[148:151], a[228:231], v[124:127]
  ds_read_b64_tr_b16 a[174:175], v199 offset:18432
  v_cvt_pk_bf16_f32 v149, v150, v151
  v_mfma_f32_16x16x32_bf16 v[64:67], a[152:155], a[232:235], v[64:67]
  ds_read_b64_tr_b16 a[144:145], v200 offset:16384
  v_cvt_pk_bf16_f32 v156, v156, v157
  v_mfma_f32_16x16x32_bf16 v[68:71], a[152:155], a[236:239], v[68:71]
  ds_read_b64_tr_b16 a[146:147], v200 offset:18432
  s_waitcnt lgkmcnt(4)
  v_mfma_f32_16x16x32_bf16 v[72:75], a[156:159], a[232:235], v[72:75]
  ds_read_b64_tr_b16 a[148:149], v201 offset:16384
  s_add_u32 s74, s62, 16384
  buffer_load_dwordx4 a[4:7], v226, s[24:27], s74 offen offset:1024 sc1
  v_mfma_f32_16x16x32_bf16 v[76:79], a[156:159], a[236:239], v[76:79]
  ds_read_b64_tr_b16 a[150:151], v201 offset:18432
  v_cvt_pk_bf16_f32 v157, v158, v159
  v_mfma_f32_16x16x32_bf16 v[80:83], a[160:163], a[232:235], v[80:83]
  ds_read_b64_tr_b16 a[152:153], v198 offset:8192
  ds_write_b64 v248, v[148:149] offset:1536
  v_mfma_f32_16x16x32_bf16 v[84:87], a[160:163], a[236:239], v[84:87]
  ds_read_b64_tr_b16 a[154:155], v198 offset:10240
  ds_write_b64 v248, v[156:157] offset:2048
  v_mfma_f32_16x16x32_bf16 v[88:91], a[164:167], a[232:235], v[88:91]
  ds_read_b64_tr_b16 a[156:157], v199 offset:8192
  ds_read_b64_tr_b16 v[148:149], v249 offset:1536
  v_mfma_f32_16x16x32_bf16 v[92:95], a[164:167], a[236:239], v[92:95]
  ds_read_b64_tr_b16 a[158:159], v199 offset:10240
  buffer_load_dwordx4 v206, s[20:23], s44 offen offset:3072 lds
  v_mfma_f32_16x16x32_bf16 v[96:99], a[168:171], a[232:235], v[96:99]
  ds_read_b64_tr_b16 a[160:161], v200 offset:8192
  s_add_u32 m0, s46, 28672
  v_mfma_f32_16x16x32_bf16 v[100:103], a[168:171], a[236:239], v[100:103]
  ds_read_b64_tr_b16 a[162:163], v200 offset:10240
  s_waitcnt lgkmcnt(6)
  v_mfma_f32_16x16x32_bf16 v[104:107], a[172:175], a[232:235], v[104:107]
  ds_read_b64_tr_b16 a[164:165], v201 offset:8192
  ds_read_b64_tr_b16 v[150:151], v249 offset:2048
  v_mfma_f32_16x16x32_bf16 v[108:111], a[172:175], a[236:239], v[108:111]
  ds_read_b64_tr_b16 a[166:167], v201 offset:10240
  v_mfma_f32_16x16x32_bf16 v[112:115], a[144:147], a[232:235], v[112:115]
  ds_read_b64_tr_b16 a[168:169], v198 offset:20480
  s_add_u32 s74, s62, 0
  buffer_load_dwordx4 a[8:11], v226, s[24:27], s74 offen sc1
  v_mfma_f32_16x16x32_bf16 v[116:119], a[144:147], a[236:239], v[116:119]
  ds_read_b64_tr_b16 a[170:171], v198 offset:22528
  v_mfma_f32_16x16x32_bf16 v[120:123], a[148:151], a[232:235], v[120:123]
  ds_read_b64_tr_b16 a[172:173], v199 offset:20480
  v_mfma_f32_16x16x32_bf16 v[124:127], a[148:151], a[236:239], v[124:127]
  ds_read_b64_tr_b16 a[174:175], v199 offset:22528
  buffer_load_dwordx4 v207, s[20:23], s44 offen lds
  buffer_load_dwordx4 v208, s[20:23], s44 offen offset:1024 lds
  v_mfma_f32_16x16x32_bf16 v[64:67], a[152:155], a[240:243], v[64:67]
  ds_read_b64_tr_b16 a[144:145], v200 offset:20480
  v_mfma_f32_16x16x32_bf16 v[68:71], a[152:155], a[244:247], v[68:71]
  ds_read_b64_tr_b16 a[146:147], v200 offset:22528
  s_waitcnt lgkmcnt(4)
  v_mfma_f32_16x16x32_bf16 v[72:75], a[156:159], a[240:243], v[72:75]
  ds_read_b64_tr_b16 a[148:149], v201 offset:20480
  s_waitcnt vmcnt(18)
  v_mfma_f32_16x16x32_bf16 v[76:79], a[156:159], a[244:247], v[76:79]
  ds_read_b64_tr_b16 a[150:151], v201 offset:22528
  s_barrier
  v_mfma_f32_16x16x32_bf16 v[80:83], a[160:163], a[240:243], v[80:83]
  ds_read_b64_tr_b16 a[152:153], v198 offset:24576
  v_mov_b32 v189, 3
  v_mfma_f32_16x16x32_bf16 v[84:87], a[160:163], a[244:247], v[84:87]
  ds_read_b64_tr_b16 a[154:155], v198 offset:26624
  buffer_store_dword v189, v187, s[24:27], 0 offen sc1
  s_add_u32 s44, s69, 294912
  v_mfma_f32_16x16x32_bf16 v[88:91], a[164:167], a[240:243], v[88:91]
  ds_read_b64_tr_b16 a[156:157], v199 offset:24576
  s_add_u32 m0, s47, 49152
  v_mfma_f32_16x16x32_bf16 v[92:95], a[164:167], a[244:247], v[92:95]
  ds_read_b64_tr_b16 a[158:159], v199 offset:26624
  v_mfma_f32_16x16x32_bf16 v[96:99], a[168:171], a[240:243], v[96:99]
  ds_read_b64_tr_b16 a[160:161], v200 offset:24576
  v_mfma_f32_16x16x32_bf16 v[100:103], a[168:171], a[244:247], v[100:103]
  ds_read_b64_tr_b16 a[162:163], v200 offset:26624
  s_waitcnt lgkmcnt(4)
  v_mfma_f32_16x16x32_bf16 v[104:107], a[172:175], a[240:243], v[104:107]
  ds_read_b64_tr_b16 a[164:165], v201 offset:24576
  s_add_u32 s74, s62, 0
  buffer_load_dwordx4 a[12:15], v226, s[24:27], s74 offen offset:1024 sc1
  v_mfma_f32_16x16x32_bf16 v[108:111], a[172:175], a[244:247], v[108:111]
  ds_read_b64_tr_b16 a[166:167], v201 offset:26624
  v_mfma_f32_16x16x32_bf16 v[112:115], a[144:147], a[240:243], v[112:115]
  ds_read_b64_tr_b16 a[168:169], v198 offset:36864
  v_mfma_f32_16x16x32_bf16 v[116:119], a[144:147], a[244:247], v[116:119]
  ds_read_b64_tr_b16 a[170:171], v198 offset:38912
  v_mfma_f32_16x16x32_bf16 v[120:123], a[148:151], a[240:243], v[120:123]
  ds_read_b64_tr_b16 a[172:173], v199 offset:36864
  v_mfma_f32_16x16x32_bf16 v[124:127], a[148:151], a[244:247], v[124:127]
  ds_read_b64_tr_b16 a[174:175], v199 offset:38912
  s_add_u32 s74, s62, 0
  buffer_load_dwordx4 a[16:19], v226, s[24:27], s74 offen offset:2048 sc1
  s_add_u32 s74, s62, 0
  buffer_load_dwordx4 a[20:23], v226, s[24:27], s74 offen offset:3072 sc1
  s_add_u32 s74, s62, 4096
  buffer_load_dwordx4 a[24:27], v226, s[24:27], s74 offen sc1
  s_add_u32 s74, s62, 4096
  buffer_load_dwordx4 a[28:31], v226, s[24:27], s74 offen offset:1024 sc1
  s_add_u32 s74, s62, 4096
  buffer_load_dwordx4 a[32:35], v226, s[24:27], s74 offen offset:2048 sc1
  s_add_u32 s74, s62, 4096
  buffer_load_dwordx4 a[36:39], v226, s[24:27], s74 offen offset:3072 sc1
  v_mfma_f32_16x16x32_bf16 v[0:3], a[152:155], a[224:227], v[0:3]
  ds_read_b64_tr_b16 a[144:145], v200 offset:36864
  v_mfma_f32_16x16x32_bf16 v[4:7], a[152:155], a[228:231], v[4:7]
  ds_read_b64_tr_b16 a[146:147], v200 offset:38912
  s_waitcnt lgkmcnt(4)
  v_mfma_f32_16x16x32_bf16 v[8:11], a[156:159], a[224:227], v[8:11]
  ds_read_b64_tr_b16 a[148:149], v201 offset:36864
  v_mfma_f32_16x16x32_bf16 v[12:15], a[156:159], a[228:231], v[12:15]
  ds_read_b64_tr_b16 a[150:151], v201 offset:38912
  v_mfma_f32_16x16x32_bf16 v[16:19], a[160:163], a[224:227], v[16:19]
  ds_read_b64_tr_b16 a[152:153], v198 offset:28672
  v_mfma_f32_16x16x32_bf16 v[20:23], a[160:163], a[228:231], v[20:23]
  ds_read_b64_tr_b16 a[154:155], v198 offset:30720
  s_add_u32 s49, s61, 16384
  buffer_store_dwordx4 v[128:131], v226, s[24:27], s49 offen offset:2048 sc1
  v_mfma_f32_16x16x32_bf16 v[24:27], a[164:167], a[224:227], v[24:27]
  ds_read_b64_tr_b16 a[156:157], v199 offset:28672
  v_mfma_f32_16x16x32_bf16 v[28:31], a[164:167], a[228:231], v[28:31]
  ds_read_b64_tr_b16 a[158:159], v199 offset:30720
  v_mfma_f32_16x16x32_bf16 v[32:35], a[168:171], a[224:227], v[32:35]
  ds_read_b64_tr_b16 a[160:161], v200 offset:28672
  v_mfma_f32_16x16x32_bf16 v[36:39], a[168:171], a[228:231], v[36:39]
  ds_read_b64_tr_b16 a[162:163], v200 offset:30720
  s_waitcnt lgkmcnt(4)
  v_mfma_f32_16x16x32_bf16 v[40:43], a[172:175], a[224:227], v[40:43]
  ds_read_b64_tr_b16 a[164:165], v201 offset:28672
  buffer_load_dwordx4 v203, s[20:23], s44 offen lds
  v_mfma_f32_16x16x32_bf16 v[44:47], a[172:175], a[228:231], v[44:47]
  ds_read_b64_tr_b16 a[166:167], v201 offset:30720
  v_mfma_f32_16x16x32_bf16 v[48:51], a[144:147], a[224:227], v[48:51]
  ds_read_b64_tr_b16 a[168:169], v198 offset:40960
  v_mfma_f32_16x16x32_bf16 v[52:55], a[144:147], a[228:231], v[52:55]
  ds_read_b64_tr_b16 a[170:171], v198 offset:43008
  v_mfma_f32_16x16x32_bf16 v[56:59], a[148:151], a[224:227], v[56:59]
  ds_read_b64_tr_b16 a[172:173], v199 offset:40960
  v_mfma_f32_16x16x32_bf16 v[60:63], a[148:151], a[228:231], v[60:63]
  ds_read_b64_tr_b16 a[174:175], v199 offset:43008
  s_add_u32 s49, s61, 20480
  buffer_store_dwordx4 v[144:147], v226, s[24:27], s49 offen sc1
  v_mfma_f32_16x16x32_bf16 v[0:3], a[152:155], a[232:235], v[0:3]
  ds_read_b64_tr_b16 a[144:145], v200 offset:40960
  v_mfma_f32_16x16x32_bf16 v[4:7], a[152:155], a[236:239], v[4:7]
  ds_read_b64_tr_b16 a[146:147], v200 offset:43008
  s_waitcnt lgkmcnt(4)
  v_mfma_f32_16x16x32_bf16 v[8:11], a[156:159], a[232:235], v[8:11]
  ds_read_b64_tr_b16 a[148:149], v201 offset:40960
  v_mfma_f32_16x16x32_bf16 v[12:15], a[156:159], a[236:239], v[12:15]
  ds_read_b64_tr_b16 a[150:151], v201 offset:43008
  v_mfma_f32_16x16x32_bf16 v[16:19], a[160:163], a[232:235], v[16:19]
  ds_read_b64_tr_b16 a[152:153], v198 offset:32768
  buffer_load_dword v202, v188, s[24:27], 0 offen sc1
  v_mfma_f32_16x16x32_bf16 v[20:23], a[160:163], a[236:239], v[20:23]
  ds_read_b64_tr_b16 a[154:155], v198 offset:34816
  v_mfma_f32_16x16x32_bf16 v[24:27], a[164:167], a[232:235], v[24:27]
  ds_read_b64_tr_b16 a[156:157], v199 offset:32768
  v_mfma_f32_16x16x32_bf16 v[28:31], a[164:167], a[236:239], v[28:31]
  ds_read_b64_tr_b16 a[158:159], v199 offset:34816
  v_mfma_f32_16x16x32_bf16 v[32:35], a[168:171], a[232:235], v[32:35]
  ds_read_b64_tr_b16 a[160:161], v200 offset:32768
  v_mfma_f32_16x16x32_bf16 v[36:39], a[168:171], a[236:239], v[36:39]
  ds_read_b64_tr_b16 a[162:163], v200 offset:34816
  s_waitcnt lgkmcnt(4)
  v_mfma_f32_16x16x32_bf16 v[40:43], a[172:175], a[232:235], v[40:43]
  ds_read_b64_tr_b16 a[164:165], v201 offset:32768
  buffer_load_dwordx4 v204, s[20:23], s44 offen offset:1024 lds
  v_mfma_f32_16x16x32_bf16 v[44:47], a[172:175], a[236:239], v[44:47]
  ds_read_b64_tr_b16 a[166:167], v201 offset:34816
  v_mfma_f32_16x16x32_bf16 v[48:51], a[144:147], a[232:235], v[48:51]
  ds_read_b64_tr_b16 a[168:169], v198 offset:45056
  v_mfma_f32_16x16x32_bf16 v[52:55], a[144:147], a[236:239], v[52:55]
  ds_read_b64_tr_b16 a[170:171], v198 offset:47104
  v_mfma_f32_16x16x32_bf16 v[56:59], a[148:151], a[232:235], v[56:59]
  ds_read_b64_tr_b16 a[172:173], v199 offset:45056
  v_mfma_f32_16x16x32_bf16 v[60:63], a[148:151], a[236:239], v[60:63]
  ds_read_b64_tr_b16 a[174:175], v199 offset:47104
  s_add_u32 s49, s61, 16384
  buffer_store_dwordx4 v[132:135], v226, s[24:27], s49 offen offset:3072 sc1
  buffer_load_dwordx4 v205, s[20:23], s44 offen offset:2048 lds
  v_mfma_f32_16x16x32_bf16 v[0:3], a[152:155], a[240:243], v[0:3]
  ds_read_b64_tr_b16 a[144:145], v200 offset:45056
  v_mfma_f32_16x16x32_bf16 v[4:7], a[152:155], a[244:247], v[4:7]
  ds_read_b64_tr_b16 a[146:147], v200 offset:47104
  s_waitcnt lgkmcnt(4)
  v_mfma_f32_16x16x32_bf16 v[8:11], a[156:159], a[240:243], v[8:11]
  ds_read_b64_tr_b16 a[148:149], v201 offset:45056
  s_waitcnt vmcnt(30)
  v_mfma_f32_16x16x32_bf16 v[12:15], a[156:159], a[244:247], v[12:15]
  ds_read_b64_tr_b16 a[150:151], v201 offset:47104
  s_barrier
  v_mfma_f32_16x16x32_bf16 v[16:19], a[160:163], a[240:243], v[16:19]
  ds_read_b64_tr_b16 a[152:153], v194 offset:24576
  s_add_u32 s44, s66, 331776
  v_mfma_f32_16x16x32_bf16 v[20:23], a[160:163], a[244:247], v[20:23]
  ds_read_b64_tr_b16 a[154:155], v194 offset:26624
  s_add_u32 s49, s61, 20480
  buffer_store_dwordx4 v[148:151], v226, s[24:27], s49 offen offset:1024 sc1
  v_mfma_f32_16x16x32_bf16 v[24:27], a[164:167], a[240:243], v[24:27]
  ds_read_b64_tr_b16 a[156:157], v195 offset:24576
  s_add_u32 m0, s46, 98304
  v_mfma_f32_16x16x32_bf16 v[28:31], a[164:167], a[244:247], v[28:31]
  ds_read_b64_tr_b16 a[158:159], v195 offset:26624
  v_mfma_f32_16x16x32_bf16 v[32:35], a[168:171], a[240:243], v[32:35]
  ds_read_b64_tr_b16 a[160:161], v196 offset:24576
  v_mfma_f32_16x16x32_bf16 v[36:39], a[168:171], a[244:247], v[36:39]
  ds_read_b64_tr_b16 a[162:163], v196 offset:26624
  s_waitcnt lgkmcnt(4)
  v_mfma_f32_16x16x32_bf16 v[40:43], a[172:175], a[240:243], v[40:43]
  ds_read_b64_tr_b16 a[164:165], v197 offset:24576
  buffer_load_dwordx4 v209, s[12:15], s44 offen lds
  v_mfma_f32_16x16x32_bf16 v[44:47], a[172:175], a[244:247], v[44:47]
  ds_read_b64_tr_b16 a[166:167], v197 offset:26624
  v_mfma_f32_16x16x32_bf16 v[48:51], a[144:147], a[240:243], v[48:51]
  ds_read_b64_tr_b16 a[168:169], v194 offset:28672
  v_mfma_f32_16x16x32_bf16 v[52:55], a[144:147], a[244:247], v[52:55]
  ds_read_b64_tr_b16 a[170:171], v194 offset:30720
  v_mfma_f32_16x16x32_bf16 v[56:59], a[148:151], a[240:243], v[56:59]
  ds_read_b64_tr_b16 a[172:173], v195 offset:28672
  v_mfma_f32_16x16x32_bf16 v[60:63], a[148:151], a[244:247], v[60:63]
  ds_read_b64_tr_b16 a[174:175], v195 offset:30720
  v_mfma_f32_16x16x32_bf16 a[96:99], a[152:155], a[224:227], a[96:99]
  ds_read_b64_tr_b16 a[144:145], v196 offset:28672
  v_mfma_f32_16x16x32_bf16 a[100:103], a[152:155], a[228:231], a[100:103]
  ds_read_b64_tr_b16 a[146:147], v196 offset:30720
  s_waitcnt lgkmcnt(4)
  v_mfma_f32_16x16x32_bf16 a[104:107], a[156:159], a[224:227], a[104:107]
  ds_read_b64_tr_b16 a[148:149], v197 offset:28672
  buffer_load_dwordx4 v210, s[12:15], s44 offen offset:1024 lds
  v_mfma_f32_16x16x32_bf16 a[108:111], a[156:159], a[228:231], a[108:111]
  ds_read_b64_tr_b16 a[150:151], v197 offset:30720
  v_mfma_f32_16x16x32_bf16 a[112:115], a[160:163], a[224:227], a[112:115]
  ds_read_b64_tr_b16 a[152:153], v194 offset:32768
  v_mfma_f32_16x16x32_bf16 a[116:119], a[160:163], a[228:231], a[116:119]
  ds_read_b64_tr_b16 a[154:155], v194 offset:34816
  v_mfma_f32_16x16x32_bf16 a[120:123], a[164:167], a[224:227], a[120:123]
  ds_read_b64_tr_b16 a[156:157], v195 offset:32768
  v_mfma_f32_16x16x32_bf16 a[124:127], a[164:167], a[228:231], a[124:127]
  ds_read_b64_tr_b16 a[158:159], v195 offset:34816
  v_mfma_f32_16x16x32_bf16 a[96:99], a[168:171], a[232:235], a[96:99]
  ds_read_b64_tr_b16 a[160:161], v196 offset:32768
  v_mfma_f32_16x16x32_bf16 a[100:103], a[168:171], a[236:239], a[100:103]
  ds_read_b64_tr_b16 a[162:163], v196 offset:34816
  s_waitcnt lgkmcnt(4)
  v_mfma_f32_16x16x32_bf16 a[104:107], a[172:175], a[232:235], a[104:107]
  ds_read_b64_tr_b16 a[164:165], v197 offset:32768
  s_waitcnt vmcnt(27)
  v_mfma_f32_16x16x32_bf16 a[108:111], a[172:175], a[236:239], a[108:111]
  ds_read_b64_tr_b16 a[166:167], v197 offset:34816
  s_barrier
  v_mfma_f32_16x16x32_bf16 a[112:115], a[144:147], a[232:235], a[112:115]
  ds_read_b64 a[168:169], v184
  buffer_load_dwordx4 v211, s[12:15], s44 offen offset:2048 lds
  v_mfma_f32_16x16x32_bf16 a[116:119], a[144:147], a[236:239], a[116:119]
  ds_read_b64 a[170:171], v184 offset:12288
  v_mfma_f32_16x16x32_bf16 a[120:123], a[148:151], a[232:235], a[120:123]
  ds_read_b64 a[172:173], v184 offset:1536
  v_mfma_f32_16x16x32_bf16 a[124:127], a[148:151], a[236:239], a[124:127]
  ds_read_b64 a[174:175], v184 offset:13824
  v_mfma_f32_16x16x32_bf16 a[96:99], a[152:155], a[240:243], a[96:99]
  ds_read_b64 a[144:145], v184 offset:3072
  v_mfma_f32_16x16x32_bf16 a[100:103], a[152:155], a[244:247], a[100:103]
  ds_read_b64 a[146:147], v184 offset:15360
  s_waitcnt lgkmcnt(4)
  v_mfma_f32_16x16x32_bf16 a[104:107], a[156:159], a[240:243], a[104:107]
  ds_read_b64 a[148:149], v184 offset:4608
  v_mfma_f32_16x16x32_bf16 a[108:111], a[156:159], a[244:247], a[108:111]
  ds_read_b64 a[150:151], v184 offset:16896
  buffer_load_dwordx4 v212, s[12:15], s44 offen offset:3072 lds
  v_mfma_f32_16x16x32_bf16 a[112:115], a[160:163], a[240:243], a[112:115]
  ds_read_b64 a[152:153], v184 offset:6144
  s_add_u32 m0, s46, 102400
  v_mfma_f32_16x16x32_bf16 a[116:119], a[160:163], a[244:247], a[116:119]
  ds_read_b64 a[154:155], v184 offset:18432
  v_mfma_f32_16x16x32_bf16 a[120:123], a[164:167], a[240:243], a[120:123]
  ds_read_b64 a[156:157], v184 offset:7680
  v_mfma_f32_16x16x32_bf16 a[124:127], a[164:167], a[244:247], a[124:127]
  ds_read_b64 a[158:159], v184 offset:19968
  v_mfma_f32_16x16x32_bf16 v[64:67], a[168:171], v[128:131], v[64:67]
  ds_read_b64 a[160:161], v184 offset:9216
  v_mfma_f32_16x16x32_bf16 v[68:71], a[168:171], v[132:135], v[68:71]
  ds_read_b64 a[162:163], v184 offset:21504
  s_waitcnt lgkmcnt(4)
  v_mfma_f32_16x16x32_bf16 v[72:75], a[172:175], v[128:131], v[72:75]
  ds_read_b64 a[164:165], v184 offset:10752
  buffer_load_dwordx4 v213, s[12:15], s44 offen lds
  v_mfma_f32_16x16x32_bf16 v[76:79], a[172:175], v[132:135], v[76:79]
  ds_read_b64 a[166:167], v184 offset:23040
  v_mfma_f32_16x16x32_bf16 v[80:83], a[144:147], v[128:131], v[80:83]
  ds_read_b64 a[168:169], v184 offset:32
  v_mfma_f32_16x16x32_bf16 v[84:87], a[144:147], v[132:135], v[84:87]
  ds_read_b64 a[170:171], v184 offset:12320
  v_mfma_f32_16x16x32_bf16 v[88:91], a[148:151], v[128:131], v[88:91]
  ds_read_b64 a[172:173], v184 offset:1568
  v_mfma_f32_16x16x32_bf16 v[92:95], a[148:151], v[132:135], v[92:95]
  ds_read_b64 a[174:175], v184 offset:13856
  buffer_load_dwordx4 v214, s[12:15], s44 offen offset:1024 lds
  v_mfma_f32_16x16x32_bf16 v[96:99], a[152:155], v[128:131], v[96:99]
  ds_read_b64 a[144:145], v184 offset:3104
  s_add_u32 s44, s66, 332032
  s_add_u32 m0, s46, 122880
  v_mfma_f32_16x16x32_bf16 v[100:103], a[152:155], v[132:135], v[100:103]
  ds_read_b64 a[146:147], v184 offset:15392
  s_waitcnt lgkmcnt(4)
  v_mfma_f32_16x16x32_bf16 v[104:107], a[156:159], v[128:131], v[104:107]
  ds_read_b64 a[148:149], v184 offset:4640
  v_mfma_f32_16x16x32_bf16 v[108:111], a[156:159], v[132:135], v[108:111]
  ds_read_b64 a[150:151], v184 offset:16928
  v_mfma_f32_16x16x32_bf16 v[112:115], a[160:163], v[128:131], v[112:115]
  ds_read_b64 a[152:153], v184 offset:6176
  v_mfma_f32_16x16x32_bf16 v[116:119], a[160:163], v[132:135], v[116:119]
  ds_read_b64 a[154:155], v184 offset:18464
  v_mfma_f32_16x16x32_bf16 v[120:123], a[164:167], v[128:131], v[120:123]
  ds_read_b64 a[156:157], v184 offset:7712
  v_mfma_f32_16x16x32_bf16 v[124:127], a[164:167], v[132:135], v[124:127]
  ds_read_b64 a[158:159], v184 offset:20000
  buffer_load_dwordx4 v209, s[12:15], s44 offen lds
  v_mfma_f32_16x16x32_bf16 v[64:67], a[168:171], v[144:147], v[64:67]
  ds_read_b64 a[160:161], v184 offset:9248
  v_mfma_f32_16x16x32_bf16 v[68:71], a[168:171], v[148:151], v[68:71]
  ds_read_b64 a[162:163], v184 offset:21536
  s_waitcnt lgkmcnt(4)
  v_mfma_f32_16x16x32_bf16 v[72:75], a[172:175], v[144:147], v[72:75]
  ds_read_b64 a[164:165], v184 offset:10784
  s_waitcnt vmcnt(23)
  v_mfma_f32_16x16x32_bf16 v[76:79], a[172:175], v[148:151], v[76:79]
  ds_read_b64 a[166:167], v184 offset:23072
  s_barrier
  v_mfma_f32_16x16x32_bf16 v[80:83], a[144:147], v[144:147], v[80:83]
  ds_read_b64 a[168:169], v184 offset:24576
  v_mfma_f32_16x16x32_bf16 v[84:87], a[144:147], v[148:151], v[84:87]
  ds_read_b64 a[170:171], v184 offset:36864
  v_mfma_f32_16x16x32_bf16 v[88:91], a[148:151], v[144:147], v[88:91]
  ds_read_b64 a[172:173], v184 offset:26112
  buffer_load_dwordx4 v210, s[12:15], s44 offen offset:1024 lds
  v_mfma_f32_16x16x32_bf16 v[92:95], a[148:151], v[148:151], v[92:95]
  ds_read_b64 a[174:175], v184 offset:38400
  v_mfma_f32_16x16x32_bf16 v[96:99], a[152:155], v[144:147], v[96:99]
  ds_read_b64 a[144:145], v184 offset:27648
  v_mfma_f32_16x16x32_bf16 v[100:103], a[152:155], v[148:151], v[100:103]
  ds_read_b64 a[146:147], v184 offset:39936
  s_waitcnt lgkmcnt(4)
  v_mfma_f32_16x16x32_bf16 v[104:107], a[156:159], v[144:147], v[104:107]
  ds_read_b64 a[148:149], v184 offset:29184
  v_mfma_f32_16x16x32_bf16 v[108:111], a[156:159], v[148:151], v[108:111]
  ds_read_b64 a[150:151], v184 offset:41472
  v_mfma_f32_16x16x32_bf16 v[112:115], a[160:163], v[144:147], v[112:115]
  ds_read_b64 a[152:153], v184 offset:30720
  v_mfma_f32_16x16x32_bf16 v[116:119], a[160:163], v[148:151], v[116:119]
  ds_read_b64 a[154:155], v184 offset:43008
  buffer_load_dwordx4 v211, s[12:15], s44 offen offset:2048 lds
  v_mfma_f32_16x16x32_bf16 v[120:123], a[164:167], v[144:147], v[120:123]
  ds_read_b64 a[156:157], v184 offset:32256
  v_mfma_f32_16x16x32_bf16 v[124:127], a[164:167], v[148:151], v[124:127]
  ds_read_b64 a[158:159], v184 offset:44544
  buffer_load_dwordx4 v212, s[12:15], s44 offen offset:3072 lds
  s_add_u32 m0, s46, 126976
  s_nop 0
  buffer_load_dwordx4 v213, s[12:15], s44 offen lds
  buffer_load_dwordx4 v214, s[12:15], s44 offen offset:1024 lds
  v_mfma_f32_16x16x32_bf16 v[0:3], a[168:171], v[128:131], v[0:3]
  ds_read_b64 a[160:161], v184 offset:33792
  s_add_u32 s44, s66, 442368
  v_mfma_f32_16x16x32_bf16 v[4:7], a[168:171], v[132:135], v[4:7]
  ds_read_b64 a[162:163], v184 offset:46080
  s_add_u32 m0, s46, 73728
  s_waitcnt lgkmcnt(4)
  v_mfma_f32_16x16x32_bf16 v[8:11], a[172:175], v[128:131], v[8:11]
  ds_read_b64 a[164:165], v184 offset:35328
  v_mfma_f32_16x16x32_bf16 v[12:15], a[172:175], v[132:135], v[12:15]
  ds_read_b64 a[166:167], v184 offset:47616
  s_waitcnt vmcnt(16)
  v_cmp_le_u32 vcc, 3, v202
  s_nop 3
  s_cmp_eq_u64 vcc, -1
  s_cbranch_scc0 L_slow_B0
L_back_B0:
  v_mfma_f32_16x16x32_bf16 v[16:19], a[144:147], v[128:131], v[16:19]
  ds_read_b64 a[168:169], v184 offset:24608
  v_mfma_f32_16x16x32_bf16 v[20:23], a[144:147], v[132:135], v[20:23]
  ds_read_b64 a[170:171], v184 offset:36896
  s_add_u32 s74, s62, 8192
  buffer_load_dwordx4 a[40:43], v226, s[24:27], s74 offen sc1
  v_mfma_f32_16x16x32_bf16 v[24:27], a[148:151], v[128:131], v[24:27]
  ds_read_b64 a[172:173], v184 offset:26144
  v_mfma_f32_16x16x32_bf16 v[28:31], a[148:151], v[132:135], v[28:31]
  ds_read_b64 a[174:175], v184 offset:38432
  v_mfma_f32_16x16x32_bf16 v[32:35], a[152:155], v[128:131], v[32:35]
  ds_read_b64 a[144:145], v184 offset:27680
  v_mfma_f32_16x16x32_bf16 v[36:39], a[152:155], v[132:135], v[36:39]
  ds_read_b64 a[146:147], v184 offset:39968
  s_waitcnt lgkmcnt(4)
  v_mfma_f32_16x16x32_bf16 v[40:43], a[156:159], v[128:131], v[40:43]
  ds_read_b64 a[148:149], v184 offset:29216
  buffer_load_dwordx4 v209, s[12:15], s44 offen lds
  v_mfma_f32_16x16x32_bf16 v[44:47], a[156:159], v[132:135], v[44:47]
  ds_read_b64 a[150:151], v184 offset:41504
  v_mfma_f32_16x16x32_bf16 v[48:51], a[160:163], v[128:131], v[48:51]
  ds_read_b64 a[152:153], v184 offset:30752
  v_mfma_f32_16x16x32_bf16 v[52:55], a[160:163], v[132:135], v[52:55]
  ds_read_b64 a[154:155], v184 offset:43040
  v_mfma_f32_16x16x32_bf16 v[56:59], a[164:167], v[128:131], v[56:59]
  ds_read_b64 a[156:157], v184 offset:32288
  v_mfma_f32_16x16x32_bf16 v[60:63], a[164:167], v[132:135], v[60:63]
  ds_read_b64 a[158:159], v184 offset:44576
  s_add_u32 s74, s62, 8192
  buffer_load_dwordx4 a[44:47], v226, s[24:27], s74 offen offset:1024 sc1
  v_mfma_f32_16x16x32_bf16 v[0:3], a[168:171], v[144:147], v[0:3]
  ds_read_b64 a[160:161], v184 offset:33824
  v_mfma_f32_16x16x32_bf16 v[4:7], a[168:171], v[148:151], v[4:7]
  ds_read_b64 a[162:163], v184 offset:46112
  s_waitcnt lgkmcnt(4)
  v_mfma_f32_16x16x32_bf16 v[8:11], a[172:175], v[144:147], v[8:11]
  ds_read_b64 a[164:165], v184 offset:35360
  s_waitcnt vmcnt(16)
  v_mfma_f32_16x16x32_bf16 v[12:15], a[172:175], v[148:151], v[12:15]
  ds_read_b64 a[166:167], v184 offset:47648
  s_barrier
  v_mfma_f32_16x16x32_bf16 v[16:19], a[144:147], v[144:147], v[16:19]
  ds_read_b64 a[168:169], v185
  buffer_load_dwordx4 v210, s[12:15], s44 offen offset:1024 lds
  v_mfma_f32_16x16x32_bf16 v[20:23], a[144:147], v[148:151], v[20:23]
  ds_read_b64 a[170:171], v185 offset:6144
  v_mfma_f32_16x16x32_bf16 v[24:27], a[148:151], v[144:147], v[24:27]
  ds_read_b64 a[172:173], v185 offset:1536
  v_mfma_f32_16x16x32_bf16 v[28:31], a[148:151], v[148:151], v[28:31]
  ds_read_b64 a[174:175], v185 offset:7680
  v_mfma_f32_16x16x32_bf16 v[32:35], a[152:155], v[144:147], v[32:35]
  ds_read_b64 a[144:145], v185 offset:3072
  v_mfma_f32_16x16x32_bf16 v[36:39], a[152:155], v[148:151], v[36:39]
  ds_read_b64 a[146:147], v185 offset:9216
  s_add_u32 s74, s62, 8192
  buffer_load_dwordx4 a[48:51], v226, s[24:27], s74 offen offset:2048 sc1
  s_waitcnt lgkmcnt(4)
  v_mfma_f32_16x16x32_bf16 v[40:43], a[156:159], v[144:147], v[40:43]
  ds_read_b64 a[148:149], v185 offset:4608
  v_mfma_f32_16x16x32_bf16 v[44:47], a[156:159], v[148:151], v[44:47]
  ds_read_b64 a[150:151], v185 offset:10752
  v_mfma_f32_16x16x32_bf16 v[48:51], a[160:163], v[144:147], v[48:51]
  ds_read_b64 a[152:153], v185 offset:32
  v_mfma_f32_16x16x32_bf16 v[52:55], a[160:163], v[148:151], v[52:55]
  ds_read_b64 a[154:155], v185 offset:6176
  v_mfma_f32_16x16x32_bf16 v[56:59], a[164:167], v[144:147], v[56:59]
  ds_read_b64 a[156:157], v185 offset:1568
  buffer_load_dwordx4 v211, s[12:15], s44 offen offset:2048 lds
  v_mfma_f32_16x16x32_bf16 v[60:63], a[164:167], v[148:151], v[60:63]
  ds_read_b64 a[158:159], v185 offset:7712
  buffer_load_dwordx4 v212, s[12:15], s44 offen offset:3072 lds
  s_add_u32 m0, s46, 77824
  s_nop 0
  buffer_load_dwordx4 v213, s[12:15], s44 offen lds
  buffer_load_dwordx4 v214, s[12:15], s44 offen offset:1024 lds
  v_mfma_f32_16x16x32_bf16 a[96:99], a[168:171], v[128:131], a[96:99]
  ds_read_b64 a[160:161], v185 offset:3104
  s_add_u32 s44, s66, 442624
  s_add_u32 m0, s46, 0
  v_mfma_f32_16x16x32_bf16 a[100:103], a[168:171], v[132:135], a[100:103]
  ds_read_b64 a[162:163], v185 offset:9248
  s_waitcnt lgkmcnt(4)
  v_mfma_f32_16x16x32_bf16 a[104:107], a[172:175], v[128:131], a[104:107]
  ds_read_b64 a[164:165], v185 offset:4640
  s_waitcnt vmcnt(15)
  v_mfma_f32_16x16x32_bf16 a[108:111], a[172:175], v[132:135], a[108:111]
  ds_read_b64 a[166:167], v185 offset:10784
  s_barrier
  v_mfma_f32_16x16x32_bf16 a[112:115], a[144:147], v[128:131], a[112:115]
  ds_read_b64_tr_b16 a[168:169], v198
  v_mov_b32 v189, 4
  v_mfma_f32_16x16x32_bf16 a[116:119], a[144:147], v[132:135], a[116:119]
  ds_read_b64_tr_b16 a[170:171], v198 offset:2048
  buffer_store_dword v189, v187, s[24:27], 0 offen sc1
  v_mfma_f32_16x16x32_bf16 a[120:123], a[148:151], v[128:131], a[120:123]
  ds_read_b64_tr_b16 a[172:173], v199
  v_mfma_f32_16x16x32_bf16 a[124:127], a[148:151], v[132:135], a[124:127]
  ds_read_b64_tr_b16 a[174:175], v199 offset:2048
  v_mfma_f32_16x16x32_bf16 a[96:99], a[152:155], v[144:147], a[96:99]
  ds_read_b64_tr_b16 a[144:145], v200
  v_mfma_f32_16x16x32_bf16 a[100:103], a[152:155], v[148:151], a[100:103]
  ds_read_b64_tr_b16 a[146:147], v200 offset:2048
  s_waitcnt lgkmcnt(4)
  v_mfma_f32_16x16x32_bf16 a[104:107], a[156:159], v[144:147], a[104:107]
  ds_read_b64_tr_b16 a[148:149], v201
  buffer_load_dwordx4 v209, s[12:15], s44 offen lds
  v_mfma_f32_16x16x32_bf16 a[108:111], a[156:159], v[148:151], a[108:111]
  ds_read_b64_tr_b16 a[150:151], v201 offset:2048
  v_mfma_f32_16x16x32_bf16 a[112:115], a[160:163], v[144:147], a[112:115]
  ds_read_b64_tr_b16 a[152:153], v198 offset:12288
  v_mfma_f32_16x16x32_bf16 a[116:119], a[160:163], v[148:151], a[116:119]
  ds_read_b64_tr_b16 a[154:155], v198 offset:14336
  v_mfma_f32_16x16x32_bf16 a[120:123], a[164:167], v[144:147], a[120:123]
  ds_read_b64_tr_b16 a[156:157], v199 offset:12288
  v_mfma_f32_16x16x32_bf16 a[124:127], a[164:167], v[148:151], a[124:127]
  ds_read_b64_tr_b16 a[158:159], v199 offset:14336
  s_add_u32 s74, s62, 8192
  buffer_load_dwordx4 a[52:55], v226, s[24:27], s74 offen offset:3072 sc1
  v_mfma_f32_16x16x32_bf16 v[64:67], a[168:171], a[0:3], v[64:67]
  ds_read_b64_tr_b16 a[160:161], v200 offset:12288
  v_mfma_f32_16x16x32_bf16 v[68:71], a[168:171], a[4:7], v[68:71]
  ds_read_b64_tr_b16 a[162:163], v200 offset:14336
  s_waitcnt lgkmcnt(4)
  v_mfma_f32_16x16x32_bf16 v[72:75], a[172:175], a[0:3], v[72:75]
  ds_read_b64_tr_b16 a[164:165], v201 offset:12288
  v_mfma_f32_16x16x32_bf16 v[76:79], a[172:175], a[4:7], v[76:79]
  ds_read_b64_tr_b16 a[166:167], v201 offset:14336
  v_accvgpr_read_b32 v228, a96
  v_accvgpr_read_b32 v229, a97
  v_mfma_f32_16x16x32_bf16 v[80:83], a[144:147], a[0:3], v[80:83]
  ds_read_b64_tr_b16 a[168:169], v198 offset:4096
  buffer_load_dwordx4 v210, s[12:15], s44 offen offset:1024 lds
  v_accvgpr_read_b32 v230, a98
  v_accvgpr_read_b32 v231, a99
  v_mfma_f32_16x16x32_bf16 v[84:87], a[144:147], a[4:7], v[84:87]
  ds_read_b64_tr_b16 a[170:171], v198 offset:6144
  v_accvgpr_read_b32 v232, a100
  v_accvgpr_read_b32 v233, a101
  v_mfma_f32_16x16x32_bf16 v[88:91], a[148:151], a[0:3], v[88:91]
  ds_read_b64_tr_b16 a[172:173], v199 offset:4096
  v_accvgpr_read_b32 v234, a102
  v_accvgpr_read_b32 v235, a103
  v_cvt_pk_bf16_f32 v228, v228, v229
  v_mfma_f32_16x16x32_bf16 v[92:95], a[148:151], a[4:7], v[92:95]
  ds_read_b64_tr_b16 a[174:175], v199 offset:6144
  v_cvt_pk_bf16_f32 v229, v230, v231
  v_cvt_pk_bf16_f32 v230, v232, v233
  v_mfma_f32_16x16x32_bf16 v[96:99], a[152:155], a[0:3], v[96:99]
  ds_read_b64_tr_b16 a[144:145], v200 offset:4096
  v_cvt_pk_bf16_f32 v231, v234, v235
  v_mfma_f32_16x16x32_bf16 v[100:103], a[152:155], a[4:7], v[100:103]
  ds_read_b64_tr_b16 a[146:147], v200 offset:6144
  s_add_u32 s74, s62, 12288
  buffer_load_dwordx4 a[56:59], v226, s[24:27], s74 offen sc1
  s_waitcnt lgkmcnt(4)
  v_mfma_f32_16x16x32_bf16 v[104:107], a[156:159], a[0:3], v[104:107]
  ds_read_b64_tr_b16 a[148:149], v201 offset:4096
  v_mfma_f32_16x16x32_bf16 v[108:111], a[156:159], a[4:7], v[108:111]
  ds_read_b64_tr_b16 a[150:151], v201 offset:6144
  v_mfma_f32_16x16x32_bf16 v[112:115], a[160:163], a[0:3], v[112:115]
  ds_read_b64_tr_b16 a[152:153], v198 offset:16384
  v_mfma_f32_16x16x32_bf16 v[116:119], a[160:163], a[4:7], v[116:119]
  ds_read_b64_tr_b16 a[154:155], v198 offset:18432
  v_mfma_f32_16x16x32_bf16 v[120:123], a[164:167], a[0:3], v[120:123]
  ds_read_b64_tr_b16 a[156:157], v199 offset:16384
  buffer_load_dwordx4 v211, s[12:15], s44 offen offset:2048 lds
  v_mfma_f32_16x16x32_bf16 v[124:127], a[164:167], a[4:7], v[124:127]
  ds_read_b64_tr_b16 a[158:159], v199 offset:18432
  buffer_load_dwordx4 v212, s[12:15], s44 offen offset:3072 lds
  s_add_u32 m0, s46, 4096
  s_nop 0
  buffer_load_dwordx4 v213, s[12:15], s44 offen lds
  buffer_load_dwordx4 v214, s[12:15], s44 offen offset:1024 lds
  v_mfma_f32_16x16x32_bf16 v[64:67], a[168:171], a[8:11], v[64:67]
  ds_read_b64_tr_b16 a[160:161], v200 offset:16384
  s_add_u32 s44, s66, 552960
  s_add_u32 m0, s46, 24576
  v_mfma_f32_16x16x32_bf16 v[68:71], a[168:171], a[12:15], v[68:71]
  ds_read_b64_tr_b16 a[162:163], v200 offset:18432
  s_waitcnt lgkmcnt(4)
  v_mfma_f32_16x16x32_bf16 v[72:75], a[172:175], a[8:11], v[72:75]
  ds_read_b64_tr_b16 a[164:165], v201 offset:16384
  v_mfma_f32_16x16x32_bf16 v[76:79], a[172:175], a[12:15], v[76:79]
  ds_read_b64_tr_b16 a[166:167], v201 offset:18432
  v_mfma_f32_16x16x32_bf16 v[80:83], a[144:147], a[8:11], v[80:83]
  ds_read_b64_tr_b16 a[168:169], v198 offset:8192
  v_mfma_f32_16x16x32_bf16 v[84:87], a[144:147], a[12:15], v[84:87]
  ds_read_b64_tr_b16 a[170:171], v198 offset:10240
  s_add_u32 s74, s62, 12288
  buffer_load_dwordx4 a[60:63], v226, s[24:27], s74 offen offset:1024 sc1
  v_mfma_f32_16x16x32_bf16 v[88:91], a[148:151], a[8:11], v[88:91]
  ds_read_b64_tr_b16 a[172:173], v199 offset:8192
  v_mfma_f32_16x16x32_bf16 v[92:95], a[148:151], a[12:15], v[92:95]
  ds_read_b64_tr_b16 a[174:175], v199 offset:10240
  v_mfma_f32_16x16x32_bf16 v[96:99], a[152:155], a[8:11], v[96:99]
  ds_read_b64_tr_b16 a[144:145], v200 offset:8192
  v_mfma_f32_16x16x32_bf16 v[100:103], a[152:155], a[12:15], v[100:103]
  ds_read_b64_tr_b16 a[146:147], v200 offset:10240
  s_add_u32 s74, s62, 12288
  buffer_load_dwordx4 a[64:67], v226, s[24:27], s74 offen offset:2048 sc1
  s_add_u32 s74, s62, 12288
  buffer_load_dwordx4 a[68:71], v226, s[24:27], s74 offen offset:3072 sc1
  s_waitcnt lgkmcnt(4)
  v_mfma_f32_16x16x32_bf16 v[104:107], a[156:159], a[8:11], v[104:107]
  ds_read_b64_tr_b16 a[148:149], v201 offset:8192
  v_mfma_f32_16x16x32_bf16 v[108:111], a[156:159], a[12:15], v[108:111]
  ds_read_b64_tr_b16 a[150:151], v201 offset:10240
  v_mfma_f32_16x16x32_bf16 v[112:115], a[160:163], a[8:11], v[112:115]
  ds_read_b64_tr_b16 a[152:153], v198 offset:20480
  v_mfma_f32_16x16x32_bf16 v[116:119], a[160:163], a[12:15], v[116:119]
  ds_read_b64_tr_b16 a[154:155], v198 offset:22528
  v_mfma_f32_16x16x32_bf16 v[120:123], a[164:167], a[8:11], v[120:123]
  ds_read_b64_tr_b16 a[156:157], v199 offset:20480
  v_mfma_f32_16x16x32_bf16 v[124:127], a[164:167], a[12:15], v[124:127]
  ds_read_b64_tr_b16 a[158:159], v199 offset:22528
  buffer_load_dwordx4 v209, s[12:15], s44 offen lds
  buffer_load_dwordx4 v210, s[12:15], s44 offen offset:1024 lds
  buffer_load_dwordx4 v211, s[12:15], s44 offen offset:2048 lds
  buffer_load_dwordx4 v212, s[12:15], s44 offen offset:3072 lds
  s_add_u32 m0, s46, 28672
  s_nop 0
  buffer_load_dwordx4 v213, s[12:15], s44 offen lds
  buffer_load_dwordx4 v214, s[12:15], s44 offen offset:1024 lds
  v_mfma_f32_16x16x32_bf16 v[64:67], a[168:171], a[16:19], v[64:67]
  ds_read_b64_tr_b16 a[160:161], v200 offset:20480
  v_mfma_f32_16x16x32_bf16 v[68:71], a[168:171], a[20:23], v[68:71]
  ds_read_b64_tr_b16 a[162:163], v200 offset:22528
  s_waitcnt lgkmcnt(4)
  v_mfma_f32_16x16x32_bf16 v[72:75], a[172:175], a[16:19], v[72:75]
  ds_read_b64_tr_b16 a[164:165], v201 offset:20480
  s_waitcnt vmcnt(27)
  v_mfma_f32_16x16x32_bf16 v[76:79], a[172:175], a[20:23], v[76:79]
  ds_read_b64_tr_b16 a[166:167], v201 offset:22528
  buffer_store_dwordx4 v[228:231], v226, s[24:27], s54 offen sc1
  v_accvgpr_read_b32 v236, a104
  v_accvgpr_read_b32 v237, a105
  v_accvgpr_read_b32 v238, a106
  v_accvgpr_read_b32 v239, a107
  v_accvgpr_read_b32 v240, a108
  v_accvgpr_read_b32 v241, a109
  v_accvgpr_read_b32 v242, a110
  v_accvgpr_read_b32 v243, a111
  v_cvt_pk_bf16_f32 v236, v236, v237
  v_cvt_pk_bf16_f32 v237, v238, v239
  v_cvt_pk_bf16_f32 v238, v240, v241
  v_cvt_pk_bf16_f32 v239, v242, v243
  buffer_store_dwordx4 v[236:239], v226, s[24:27], s54 offen offset:1024 sc1
  v_accvgpr_read_b32 v228, a112
  v_accvgpr_read_b32 v229, a113
  v_accvgpr_read_b32 v230, a114
  v_accvgpr_read_b32 v231, a115
  v_accvgpr_read_b32 v232, a116
  v_accvgpr_read_b32 v233, a117
  v_accvgpr_read_b32 v234, a118
  v_accvgpr_read_b32 v235, a119
  v_cvt_pk_bf16_f32 v228, v228, v229
  v_cvt_pk_bf16_f32 v229, v230, v231
  v_cvt_pk_bf16_f32 v230, v232, v233
  v_cvt_pk_bf16_f32 v231, v234, v235
  buffer_store_dwordx4 v[228:231], v226, s[24:27], s54 offen offset:2048 sc1
  v_accvgpr_read_b32 v236, a120
  v_accvgpr_read_b32 v237, a121
  v_accvgpr_read_b32 v238, a122
  v_accvgpr_read_b32 v239, a123
  v_accvgpr_read_b32 v240, a124
  v_accvgpr_read_b32 v241, a125
  v_accvgpr_read_b32 v242, a126
  v_accvgpr_read_b32 v243, a127
  v_cvt_pk_bf16_f32 v236, v236, v237
  v_cvt_pk_bf16_f32 v237, v238, v239
  v_cvt_pk_bf16_f32 v238, v240, v241
  v_cvt_pk_bf16_f32 v239, v242, v243
  buffer_store_dwordx4 v[236:239], v226, s[24:27], s54 offen offset:3072 sc1
  s_add_u32 s54, s54, 4096
  s_barrier
  v_mfma_f32_16x16x32_bf16 v[80:83], a[144:147], a[16:19], v[80:83]
  ds_read_b64_tr_b16 a[168:169], v198 offset:24576
  s_add_u32 s44, s72, 0
  v_mfma_f32_16x16x32_bf16 v[84:87], a[144:147], a[20:23], v[84:87]
  ds_read_b64_tr_b16 a[170:171], v198 offset:26624
  s_add_u32 m0, s46, 49152
  v_mfma_f32_16x16x32_bf16 v[88:91], a[148:151], a[16:19], v[88:91]
  ds_read_b64_tr_b16 a[172:173], v199 offset:24576
  v_mfma_f32_16x16x32_bf16 v[92:95], a[148:151], a[20:23], v[92:95]
  ds_read_b64_tr_b16 a[174:175], v199 offset:26624
  v_mfma_f32_16x16x32_bf16 v[96:99], a[152:155], a[16:19], v[96:99]
  ds_read_b64_tr_b16 a[144:145], v200 offset:24576
  v_mfma_f32_16x16x32_bf16 v[100:103], a[152:155], a[20:23], v[100:103]
  ds_read_b64_tr_b16 a[146:147], v200 offset:26624
  s_waitcnt lgkmcnt(4)
  v_mfma_f32_16x16x32_bf16 v[104:107], a[156:159], a[16:19], v[104:107]
  ds_read_b64_tr_b16 a[148:149], v201 offset:24576
  buffer_load_dwordx4 v203, s[20:23], s44 offen lds
  v_mfma_f32_16x16x32_bf16 v[108:111], a[156:159], a[20:23], v[108:111]
  ds_read_b64_tr_b16 a[150:151], v201 offset:26624
  v_mfma_f32_16x16x32_bf16 v[112:115], a[160:163], a[16:19], v[112:115]
  ds_read_b64_tr_b16 a[152:153], v198 offset:36864
  v_mfma_f32_16x16x32_bf16 v[116:119], a[160:163], a[20:23], v[116:119]
  ds_read_b64_tr_b16 a[154:155], v198 offset:38912
  v_mfma_f32_16x16x32_bf16 v[120:123], a[164:167], a[16:19], v[120:123]
  ds_read_b64_tr_b16 a[156:157], v199 offset:36864
  v_mfma_f32_16x16x32_bf16 v[124:127], a[164:167], a[20:23], v[124:127]
  ds_read_b64_tr_b16 a[158:159], v199 offset:38912
  v_mfma_f32_16x16x32_bf16 v[0:3], a[168:171], a[0:3], v[0:3]
  ds_read_b64_tr_b16 a[160:161], v200 offset:36864
  v_mfma_f32_16x16x32_bf16 v[4:7], a[168:171], a[4:7], v[4:7]
  ds_read_b64_tr_b16 a[162:163], v200 offset:38912
  s_waitcnt lgkmcnt(4)
  v_mfma_f32_16x16x32_bf16 v[8:11], a[172:175], a[0:3], v[8:11]
  ds_read_b64_tr_b16 a[164:165], v201 offset:36864
  buffer_load_dword v202, v188, s[24:27], 0 offen sc1
  v_mfma_f32_16x16x32_bf16 v[12:15], a[172:175], a[4:7], v[12:15]
  ds_read_b64_tr_b16 a[166:167], v201 offset:38912
  v_mfma_f32_16x16x32_bf16 v[16:19], a[144:147], a[0:3], v[16:19]
  ds_read_b64_tr_b16 a[168:169], v198 offset:28672
  v_mfma_f32_16x16x32_bf16 v[20:23], a[144:147], a[4:7], v[20:23]
  ds_read_b64_tr_b16 a[170:171], v198 offset:30720
  v_mfma_f32_16x16x32_bf16 v[24:27], a[148:151], a[0:3], v[24:27]
  ds_read_b64_tr_b16 a[172:173], v199 offset:28672
  v_mfma_f32_16x16x32_bf16 v[28:31], a[148:151], a[4:7], v[28:31]
  ds_read_b64_tr_b16 a[174:175], v199 offset:30720
  buffer_load_dwordx4 v204, s[20:23], s44 offen offset:1024 lds
  v_mfma_f32_16x16x32_bf16 v[32:35], a[152:155], a[0:3], v[32:35]
  ds_read_b64_tr_b16 a[144:145], v200 offset:28672
  v_mfma_f32_16x16x32_bf16 v[36:39], a[152:155], a[4:7], v[36:39]
  ds_read_b64_tr_b16 a[146:147], v200 offset:30720
  s_waitcnt lgkmcnt(4)
  v_mfma_f32_16x16x32_bf16 v[40:43], a[156:159], a[0:3], v[40:43]
  ds_read_b64_tr_b16 a[148:149], v201 offset:28672
  v_mfma_f32_16x16x32_bf16 v[44:47], a[156:159], a[4:7], v[44:47]
  ds_read_b64_tr_b16 a[150:151], v201 offset:30720
  v_mfma_f32_16x16x32_bf16 v[48:51], a[160:163], a[0:3], v[48:51]
  ds_read_b64_tr_b16 a[152:153], v198 offset:40960
  v_mfma_f32_16x16x32_bf16 v[52:55], a[160:163], a[4:7], v[52:55]
  ds_read_b64_tr_b16 a[154:155], v198 offset:43008
  v_mfma_f32_16x16x32_bf16 v[56:59], a[164:167], a[0:3], v[56:59]
  ds_read_b64_tr_b16 a[156:157], v199 offset:40960
  buffer_load_dwordx4 v205, s[20:23], s44 offen offset:2048 lds
  v_mfma_f32_16x16x32_bf16 v[60:63], a[164:167], a[4:7], v[60:63]
  ds_read_b64_tr_b16 a[158:159], v199 offset:43008
  v_mfma_f32_16x16x32_bf16 v[0:3], a[168:171], a[8:11], v[0:3]
  ds_read_b64_tr_b16 a[160:161], v200 offset:40960
  v_mfma_f32_16x16x32_bf16 v[4:7], a[168:171], a[12:15], v[4:7]
  ds_read_b64_tr_b16 a[162:163], v200 offset:43008
  s_waitcnt lgkmcnt(4)
  v_mfma_f32_16x16x32_bf16 v[8:11], a[172:175], a[8:11], v[8:11]
  ds_read_b64_tr_b16 a[164:165], v201 offset:40960
  v_mfma_f32_16x16x32_bf16 v[12:15], a[172:175], a[12:15], v[12:15]
  ds_read_b64_tr_b16 a[166:167], v201 offset:43008
  v_mfma_f32_16x16x32_bf16 v[16:19], a[144:147], a[8:11], v[16:19]
  ds_read_b64_tr_b16 a[168:169], v198 offset:32768
  v_mfma_f32_16x16x32_bf16 v[20:23], a[144:147], a[12:15], v[20:23]
  ds_read_b64_tr_b16 a[170:171], v198 offset:34816
  buffer_load_dwordx4 v206, s[20:23], s44 offen offset:3072 lds
  v_mfma_f32_16x16x32_bf16 v[24:27], a[148:151], a[8:11], v[24:27]
  ds_read_b64_tr_b16 a[172:173], v199 offset:32768
  s_add_u32 m0, s46, 53248
  v_mfma_f32_16x16x32_bf16 v[28:31], a[148:151], a[12:15], v[28:31]
  ds_read_b64_tr_b16 a[174:175], v199 offset:34816
  v_mfma_f32_16x16x32_bf16 v[32:35], a[152:155], a[8:11], v[32:35]
  ds_read_b64_tr_b16 a[144:145], v200 offset:32768
  v_mfma_f32_16x16x32_bf16 v[36:39], a[152:155], a[12:15], v[36:39]
  ds_read_b64_tr_b16 a[146:147], v200 offset:34816
  s_waitcnt lgkmcnt(4)
  v_mfma_f32_16x16x32_bf16 v[40:43], a[156:159], a[8:11], v[40:43]
  ds_read_b64_tr_b16 a[148:149], v201 offset:32768
  v_mfma_f32_16x16x32_bf16 v[44:47], a[156:159], a[12:15], v[44:47]
  ds_read_b64_tr_b16 a[150:151], v201 offset:34816
  v_mfma_f32_16x16x32_bf16 v[48:51], a[160:163], a[8:11], v[48:51]
  ds_read_b64_tr_b16 a[152:153], v198 offset:45056
  buffer_load_dwordx4 v207, s[20:23], s44 offen lds
  v_mfma_f32_16x16x32_bf16 v[52:55], a[160:163], a[12:15], v[52:55]
  ds_read_b64_tr_b16 a[154:155], v198 offset:47104
  v_mfma_f32_16x16x32_bf16 v[56:59], a[164:167], a[8:11], v[56:59]
  ds_read_b64_tr_b16 a[156:157], v199 offset:45056
  v_mfma_f32_16x16x32_bf16 v[60:63], a[164:167], a[12:15], v[60:63]
  ds_read_b64_tr_b16 a[158:159], v199 offset:47104
  buffer_load_dwordx4 v208, s[20:23], s44 offen offset:1024 lds
  v_mfma_f32_16x16x32_bf16 v[0:3], a[168:171], a[16:19], v[0:3]
  ds_read_b64_tr_b16 a[160:161], v200 offset:45056
  v_mfma_f32_16x16x32_bf16 v[4:7], a[168:171], a[20:23], v[4:7]
  ds_read_b64_tr_b16 a[162:163], v200 offset:47104
  s_waitcnt lgkmcnt(4)
  v_mfma_f32_16x16x32_bf16 v[8:11], a[172:175], a[16:19], v[8:11]
  ds_read_b64_tr_b16 a[164:165], v201 offset:45056
  s_waitcnt vmcnt(29)
  v_mfma_f32_16x16x32_bf16 v[12:15], a[172:175], a[20:23], v[12:15]
  ds_read_b64_tr_b16 a[166:167], v201 offset:47104
  s_barrier
  v_mfma_f32_16x16x32_bf16 v[16:19], a[144:147], a[16:19], v[16:19]
  ds_read_b64_tr_b16 a[168:169], v194 offset:24576
  s_add_u32 s44, s66, 553216
  v_mfma_f32_16x16x32_bf16 v[20:23], a[144:147], a[20:23], v[20:23]
  ds_read_b64_tr_b16 a[170:171], v194 offset:26624
  s_add_u32 m0, s46, 98304
  v_mfma_f32_16x16x32_bf16 v[24:27], a[148:151], a[16:19], v[24:27]
  ds_read_b64_tr_b16 a[172:173], v195 offset:24576
  v_mfma_f32_16x16x32_bf16 v[28:31], a[148:151], a[20:23], v[28:31]
  ds_read_b64_tr_b16 a[174:175], v195 offset:26624
  buffer_load_dwordx4 v209, s[12:15], s44 offen lds
  v_mfma_f32_16x16x32_bf16 v[32:35], a[152:155], a[16:19], v[32:35]
  ds_read_b64_tr_b16 a[144:145], v196 offset:24576
  v_mfma_f32_16x16x32_bf16 v[36:39], a[152:155], a[20:23], v[36:39]
  ds_read_b64_tr_b16 a[146:147], v196 offset:26624
  s_waitcnt lgkmcnt(4)
  v_mfma_f32_16x16x32_bf16 v[40:43], a[156:159], a[16:19], v[40:43]
  ds_read_b64_tr_b16 a[148:149], v197 offset:24576
  v_mfma_f32_16x16x32_bf16 v[44:47], a[156:159], a[20:23], v[44:47]
  ds_read_b64_tr_b16 a[150:151], v197 offset:26624
  v_mfma_f32_16x16x32_bf16 v[48:51], a[160:163], a[16:19], v[48:51]
  ds_read_b64_tr_b16 a[152:153], v194 offset:36864
  v_mfma_f32_16x16x32_bf16 v[52:55], a[160:163], a[20:23], v[52:55]
  ds_read_b64_tr_b16 a[154:155], v194 offset:38912
  v_mfma_f32_16x16x32_bf16 v[56:59], a[164:167], a[16:19], v[56:59]
  ds_read_b64_tr_b16 a[156:157], v195 offset:36864
  buffer_load_dwordx4 v210, s[12:15], s44 offen offset:1024 lds
  v_mfma_f32_16x16x32_bf16 v[60:63], a[164:167], a[20:23], v[60:63]
  ds_read_b64_tr_b16 a[158:159], v195 offset:38912
  v_mfma_f32_16x16x32_bf16 v[64:67], a[168:171], a[24:27], v[64:67]
  ds_read_b64_tr_b16 a[160:161], v196 offset:36864
  v_mfma_f32_16x16x32_bf16 v[68:71], a[168:171], a[28:31], v[68:71]
  ds_read_b64_tr_b16 a[162:163], v196 offset:38912
  s_waitcnt lgkmcnt(4)
  v_mfma_f32_16x16x32_bf16 v[72:75], a[172:175], a[24:27], v[72:75]
  ds_read_b64_tr_b16 a[164:165], v197 offset:36864
  v_mfma_f32_16x16x32_bf16 v[76:79], a[172:175], a[28:31], v[76:79]
  ds_read_b64_tr_b16 a[166:167], v197 offset:38912
  v_mfma_f32_16x16x32_bf16 v[80:83], a[144:147], a[24:27], v[80:83]
  ds_read_b64_tr_b16 a[168:169], v194 offset:28672
  v_mfma_f32_16x16x32_bf16 v[84:87], a[144:147], a[28:31], v[84:87]
  ds_read_b64_tr_b16 a[170:171], v194 offset:30720
  buffer_load_dwordx4 v211, s[12:15], s44 offen offset:2048 lds
  v_mfma_f32_16x16x32_bf16 v[88:91], a[148:151], a[24:27], v[88:91]
  ds_read_b64_tr_b16 a[172:173], v195 offset:28672
  v_mfma_f32_16x16x32_bf16 v[92:95], a[148:151], a[28:31], v[92:95]
  ds_read_b64_tr_b16 a[174:175], v195 offset:30720
  v_mfma_f32_16x16x32_bf16 v[96:99], a[152:155], a[24:27], v[96:99]
  ds_read_b64_tr_b16 a[144:145], v196 offset:28672
  v_mfma_f32_16x16x32_bf16 v[100:103], a[152:155], a[28:31], v[100:103]
  ds_read_b64_tr_b16 a[146:147], v196 offset:30720
  s_waitcnt lgkmcnt(4)
  v_mfma_f32_16x16x32_bf16 v[104:107], a[156:159], a[24:27], v[104:107]
  ds_read_b64_tr_b16 a[148:149], v197 offset:28672
  v_mfma_f32_16x16x32_bf16 v[108:111], a[156:159], a[28:31], v[108:111]
  ds_read_b64_tr_b16 a[150:151], v197 offset:30720
  v_mfma_f32_16x16x32_bf16 v[112:115], a[160:163], a[24:27], v[112:115]
  ds_read_b64_tr_b16 a[152:153], v194 offset:40960
  buffer_load_dwordx4 v212, s[12:15], s44 offen offset:3072 lds
  v_mfma_f32_16x16x32_bf16 v[116:119], a[160:163], a[28:31], v[116:119]
  ds_read_b64_tr_b16 a[154:155], v194 offset:43008
  s_add_u32 m0, s46, 102400
  v_mfma_f32_16x16x32_bf16 v[120:123], a[164:167], a[24:27], v[120:123]
  ds_read_b64_tr_b16 a[156:157], v195 offset:40960
  v_mfma_f32_16x16x32_bf16 v[124:127], a[164:167], a[28:31], v[124:127]
  ds_read_b64_tr_b16 a[158:159], v195 offset:43008
  v_mfma_f32_16x16x32_bf16 v[64:67], a[168:171], a[32:35], v[64:67]
  ds_read_b64_tr_b16 a[160:161], v196 offset:40960
  v_mfma_f32_16x16x32_bf16 v[68:71], a[168:171], a[36:39], v[68:71]
  ds_read_b64_tr_b16 a[162:163], v196 offset:43008
  s_waitcnt lgkmcnt(4)
  v_mfma_f32_16x16x32_bf16 v[72:75], a[172:175], a[32:35], v[72:75]
  ds_read_b64_tr_b16 a[164:165], v197 offset:40960
  v_mfma_f32_16x16x32_bf16 v[76:79], a[172:175], a[36:39], v[76:79]
  ds_read_b64_tr_b16 a[166:167], v197 offset:43008
  buffer_load_dwordx4 v213, s[12:15], s44 offen lds
  v_mfma_f32_16x16x32_bf16 v[80:83], a[144:147], a[32:35], v[80:83]
  ds_read_b64_tr_b16 a[168:169], v194 offset:32768
  v_mfma_f32_16x16x32_bf16 v[84:87], a[144:147], a[36:39], v[84:87]
  ds_read_b64_tr_b16 a[170:171], v194 offset:34816
  v_mfma_f32_16x16x32_bf16 v[88:91], a[148:151], a[32:35], v[88:91]
  ds_read_b64_tr_b16 a[172:173], v195 offset:32768
  v_mfma_f32_16x16x32_bf16 v[92:95], a[148:151], a[36:39], v[92:95]
  ds_read_b64_tr_b16 a[174:175], v195 offset:34816
  v_mfma_f32_16x16x32_bf16 v[96:99], a[152:155], a[32:35], v[96:99]
  ds_read_b64_tr_b16 a[144:145], v196 offset:32768
  v_mfma_f32_16x16x32_bf16 v[100:103], a[152:155], a[36:39], v[100:103]
  ds_read_b64_tr_b16 a[146:147], v196 offset:34816
  s_waitcnt lgkmcnt(4)
  v_mfma_f32_16x16x32_bf16 v[104:107], a[156:159], a[32:35], v[104:107]
  ds_read_b64_tr_b16 a[148:149], v197 offset:32768
  buffer_load_dwordx4 v214, s[12:15], s44 offen offset:1024 lds
  v_mfma_f32_16x16x32_bf16 v[108:111], a[156:159], a[36:39], v[108:111]
  ds_read_b64_tr_b16 a[150:151], v197 offset:34816
  v_mfma_f32_16x16x32_bf16 v[112:115], a[160:163], a[32:35], v[112:115]
  ds_read_b64_tr_b16 a[152:153], v194 offset:45056
  v_mfma_f32_16x16x32_bf16 v[116:119], a[160:163], a[36:39], v[116:119]
  ds_read_b64_tr_b16 a[154:155], v194 offset:47104
  v_mfma_f32_16x16x32_bf16 v[120:123], a[164:167], a[32:35], v[120:123]
  ds_read_b64_tr_b16 a[156:157], v195 offset:45056
  v_mfma_f32_16x16x32_bf16 v[124:127], a[164:167], a[36:39], v[124:127]
  ds_read_b64_tr_b16 a[158:159], v195 offset:47104
  v_mfma_f32_16x16x32_bf16 v[64:67], a[168:171], a[40:43], v[64:67]
  ds_read_b64_tr_b16 a[160:161], v196 offset:45056
  v_mfma_f32_16x16x32_bf16 v[68:71], a[168:171], a[44:47], v[68:71]
  ds_read_b64_tr_b16 a[162:163], v196 offset:47104
  s_waitcnt vmcnt(11)
  v_cmp_le_u32 vcc, 4, v202
  s_nop 3
  s_cmp_eq_u64 vcc, -1
  s_cbranch_scc0 L_slow_D0
L_back_D0:
  s_waitcnt lgkmcnt(4)
  v_mfma_f32_16x16x32_bf16 v[72:75], a[172:175], a[40:43], v[72:75]
  ds_read_b64_tr_b16 a[164:165], v197 offset:45056
  v_mfma_f32_16x16x32_bf16 v[76:79], a[172:175], a[44:47], v[76:79]
  ds_read_b64_tr_b16 a[166:167], v197 offset:47104
  s_barrier
  v_mfma_f32_16x16x32_bf16 v[80:83], a[144:147], a[40:43], v[80:83]
  ds_read_b64_tr_b16 a[168:169], v190
  v_mov_b32 v189, 5
  v_mfma_f32_16x16x32_bf16 v[84:87], a[144:147], a[44:47], v[84:87]
  ds_read_b64_tr_b16 a[170:171], v190 offset:2048
  buffer_store_dword v189, v187, s[24:27], 0 offen sc1
  v_mfma_f32_16x16x32_bf16 v[88:91], a[148:151], a[40:43], v[88:91]
  ds_read_b64_tr_b16 a[172:173], v191
  s_add_u32 s44, s72, 147456
  v_mfma_f32_16x16x32_bf16 v[92:95], a[148:151], a[44:47], v[92:95]
  ds_read_b64_tr_b16 a[174:175], v191 offset:2048
  s_add_u32 m0, s46, 122880
  v_mfma_f32_16x16x32_bf16 v[96:99], a[152:155], a[40:43], v[96:99]
  ds_read_b64_tr_b16 a[144:145], v192
  v_mfma_f32_16x16x32_bf16 v[100:103], a[152:155], a[44:47], v[100:103]
  ds_read_b64_tr_b16 a[146:147], v192 offset:2048
  s_waitcnt lgkmcnt(4)
  v_mfma_f32_16x16x32_bf16 v[104:107], a[156:159], a[40:43], v[104:107]
  ds_read_b64_tr_b16 a[148:149], v193
  s_add_u32 s74, s62, 16384
  buffer_load_dwordx4 a[72:75], v226, s[24:27], s74 offen offset:2048 sc1
  v_mfma_f32_16x16x32_bf16 v[108:111], a[156:159], a[44:47], v[108:111]
  ds_read_b64_tr_b16 a[150:151], v193 offset:2048
  s_mov_b32 s36, s92
  v_mfma_f32_16x16x32_bf16 v[112:115], a[160:163], a[40:43], v[112:115]
  ds_read_b64_tr_b16 a[152:153], v190 offset:12288
  s_mov_b32 s37, s93
  v_mfma_f32_16x16x32_bf16 v[116:119], a[160:163], a[44:47], v[116:119]
  ds_read_b64_tr_b16 a[154:155], v190 offset:14336
  s_mov_b32 s38, 4718592
  v_mfma_f32_16x16x32_bf16 v[120:123], a[164:167], a[40:43], v[120:123]
  ds_read_b64_tr_b16 a[156:157], v191 offset:12288
  s_mov_b32 s39, 0x20000
  v_mfma_f32_16x16x32_bf16 v[124:127], a[164:167], a[44:47], v[124:127]
  ds_read_b64_tr_b16 a[158:159], v191 offset:14336
  s_add_u32 s74, s62, 16384
  buffer_load_dwordx4 a[76:79], v226, s[24:27], s74 offen offset:3072 sc1
  v_mfma_f32_16x16x32_bf16 v[0:3], a[168:171], a[24:27], v[0:3]
  ds_read_b64_tr_b16 a[160:161], v192 offset:12288
  s_mov_b32 s16, s80
  v_mfma_f32_16x16x32_bf16 v[4:7], a[168:171], a[28:31], v[4:7]
  ds_read_b64_tr_b16 a[162:163], v192 offset:14336
  s_waitcnt lgkmcnt(4)
  v_mfma_f32_16x16x32_bf16 v[8:11], a[172:175], a[24:27], v[8:11]
  ds_read_b64_tr_b16 a[164:165], v193 offset:12288
  s_mov_b32 s17, s81
  v_mfma_f32_16x16x32_bf16 v[12:15], a[172:175], a[28:31], v[12:15]
  ds_read_b64_tr_b16 a[166:167], v193 offset:14336
  s_mov_b32 s18, 1152
  v_mfma_f32_16x16x32_bf16 v[16:19], a[144:147], a[24:27], v[16:19]
  ds_read_b64_tr_b16 a[168:169], v190 offset:4096
  s_add_u32 s74, s62, 20480
  buffer_load_dwordx4 a[80:83], v226, s[24:27], s74 offen sc1
  v_mfma_f32_16x16x32_bf16 v[20:23], a[144:147], a[28:31], v[20:23]
  ds_read_b64_tr_b16 a[170:171], v190 offset:6144
  s_mov_b32 s19, 0x20000
  v_mfma_f32_16x16x32_bf16 v[24:27], a[148:151], a[24:27], v[24:27]
  ds_read_b64_tr_b16 a[172:173], v191 offset:4096
  s_mov_b32 s56, 0xffff0000
  v_mfma_f32_16x16x32_bf16 v[28:31], a[148:151], a[28:31], v[28:31]
  ds_read_b64_tr_b16 a[174:175], v191 offset:6144
  s_mov_b32 s57, -1
  v_mfma_f32_16x16x32_bf16 v[32:35], a[152:155], a[24:27], v[32:35]
  ds_read_b64_tr_b16 a[144:145], v192 offset:4096
  s_mov_b32 s58, 0xffffaaaa
  v_mfma_f32_16x16x32_bf16 v[36:39], a[152:155], a[28:31], v[36:39]
  ds_read_b64_tr_b16 a[146:147], v192 offset:6144
  s_waitcnt lgkmcnt(4)
  v_mfma_f32_16x16x32_bf16 v[40:43], a[156:159], a[24:27], v[40:43]
  ds_read_b64_tr_b16 a[148:149], v193 offset:4096
  s_add_u32 s74, s62, 20480
  buffer_load_dwordx4 a[84:87], v226, s[24:27], s74 offen offset:1024 sc1
  v_mfma_f32_16x16x32_bf16 v[44:47], a[156:159], a[28:31], v[44:47]
  ds_read_b64_tr_b16 a[150:151], v193 offset:6144
  s_mov_b32 s59, -1
  v_mfma_f32_16x16x32_bf16 v[48:51], a[160:163], a[24:27], v[48:51]
  ds_read_b64_tr_b16 a[152:153], v190 offset:16384
  s_lshl_b32 s49, s41, 7
  s_add_u32 s49, s49, 46243840
  v_mfma_f32_16x16x32_bf16 v[52:55], a[160:163], a[28:31], v[52:55]
  ds_read_b64_tr_b16 a[154:155], v190 offset:18432
  v_lshlrev_b32 v217, 11, v225
  v_mfma_f32_16x16x32_bf16 v[56:59], a[164:167], a[24:27], v[56:59]
  ds_read_b64_tr_b16 a[156:157], v191 offset:16384
  v_add_u32 v217, s49, v217
  v_mfma_f32_16x16x32_bf16 v[60:63], a[164:167], a[28:31], v[60:63]
  ds_read_b64_tr_b16 a[158:159], v191 offset:18432
  s_add_u32 s74, s62, 20480
  buffer_load_dwordx4 a[88:91], v226, s[24:27], s74 offen offset:2048 sc1
  v_mfma_f32_16x16x32_bf16 v[0:3], a[168:171], a[32:35], v[0:3]
  ds_read_b64_tr_b16 a[160:161], v192 offset:16384
  v_cmp_gt_u32 vcc, 16, v225
  v_mov_b32 v218, 0x7ffffff0
  s_nop 0
  v_cndmask_b32 v217, v218, v217, vcc
  v_mfma_f32_16x16x32_bf16 v[4:7], a[168:171], a[36:39], v[4:7]
  ds_read_b64_tr_b16 a[162:163], v192 offset:18432
  s_waitcnt lgkmcnt(4)
  v_mfma_f32_16x16x32_bf16 v[8:11], a[172:175], a[32:35], v[8:11]
  ds_read_b64_tr_b16 a[164:165], v193 offset:16384
  v_and_b32 v219, 15, v225
  v_mfma_f32_16x16x32_bf16 v[12:15], a[172:175], a[36:39], v[12:15]
  ds_read_b64_tr_b16 a[166:167], v193 offset:18432
  v_lshrrev_b32 v220, 4, v225
  v_mfma_f32_16x16x32_bf16 v[16:19], a[144:147], a[32:35], v[16:19]
  ds_read_b64_tr_b16 a[168:169], v190 offset:8192
  s_add_u32 s74, s62, 20480
  buffer_load_dwordx4 a[92:95], v226, s[24:27], s74 offen offset:3072 sc1
  v_mfma_f32_16x16x32_bf16 v[20:23], a[144:147], a[36:39], v[20:23]
  ds_read_b64_tr_b16 a[170:171], v190 offset:10240
  s_lshr_b32 s82, s42, 1
  v_mfma_f32_16x16x32_bf16 v[24:27], a[148:151], a[32:35], v[24:27]
  ds_read_b64_tr_b16 a[172:173], v191 offset:8192
  s_lshr_b32 s49, s42, 2
  s_and_b32 s85, s42, 3
  s_and_b32 s55, s40, 1
  s_lshr_b32 s50, s40, 1
  s_lshl_b32 s89, s41, 2
  s_add_u32 s89, s89, s49
  s_lshl_b32 s89, s89, 2
  s_add_u32 s89, s89, s85
  v_mfma_f32_16x16x32_bf16 v[28:31], a[148:151], a[36:39], v[28:31]
  ds_read_b64_tr_b16 a[174:175], v191 offset:10240
  s_lshl_b32 s89, s89, 10
  v_mfma_f32_16x16x32_bf16 v[32:35], a[152:155], a[32:35], v[32:35]
  ds_read_b64_tr_b16 a[144:145], v192 offset:8192
  s_mul_i32 s50, s50, 2097152
  v_mfma_f32_16x16x32_bf16 v[36:39], a[152:155], a[36:39], v[36:39]
  ds_read_b64_tr_b16 a[146:147], v192 offset:10240
  s_waitcnt lgkmcnt(4)
  v_mfma_f32_16x16x32_bf16 v[40:43], a[156:159], a[32:35], v[40:43]
  ds_read_b64_tr_b16 a[148:149], v193 offset:8192
  buffer_load_dwordx4 v203, s[20:23], s44 offen lds
  v_mfma_f32_16x16x32_bf16 v[44:47], a[156:159], a[36:39], v[44:47]
  ds_read_b64_tr_b16 a[150:151], v193 offset:10240
  s_add_u32 s89, s89, s50
  v_mfma_f32_16x16x32_bf16 v[48:51], a[160:163], a[32:35], v[48:51]
  ds_read_b64_tr_b16 a[152:153], v190 offset:20480
  s_lshl_b32 s51, s55, 3
  s_add_u32 s89, s89, s51
  v_mfma_f32_16x16x32_bf16 v[52:55], a[160:163], a[36:39], v[52:55]
  ds_read_b64_tr_b16 a[154:155], v190 offset:22528
  s_add_u32 s89, s89, 16777216
  s_lshl_b32 s86, s41, 2
  s_add_u32 s86, s86, s40
  v_mfma_f32_16x16x32_bf16 v[56:59], a[164:167], a[32:35], v[56:59]
  ds_read_b64_tr_b16 a[156:157], v191 offset:20480
  s_lshl_b32 s86, s86, 15
  s_lshl_b32 s49, s82, 10
  s_add_u32 s86, s86, s49
  v_mfma_f32_16x16x32_bf16 v[60:63], a[164:167], a[36:39], v[60:63]
  ds_read_b64_tr_b16 a[158:159], v191 offset:22528
  s_add_u32 s86, s86, 0
  s_lshl_b32 s87, s82, 4
  s_add_u32 s87, s87, 0
  s_lshl_b32 s83, s41, 7
  s_lshl_b32 s49, s40, 5
  s_add_u32 s83, s83, s49
  buffer_load_dwordx4 v204, s[20:23], s44 offen offset:1024 lds
  buffer_load_dwordx4 v205, s[20:23], s44 offen offset:2048 lds
  buffer_load_dwordx4 v206, s[20:23], s44 offen offset:3072 lds
  s_add_u32 m0, s46, 126976
  s_nop 0
  buffer_load_dwordx4 v207, s[20:23], s44 offen lds
  buffer_load_dwordx4 v208, s[20:23], s44 offen offset:1024 lds
  v_mfma_f32_16x16x32_bf16 v[0:3], a[168:171], a[40:43], v[0:3]
  ds_read_b64_tr_b16 a[160:161], v192 offset:20480
  v_add_u32 v136, s83, v219
  v_mfma_f32_16x16x32_bf16 v[4:7], a[168:171], a[44:47], v[4:7]
  ds_read_b64_tr_b16 a[162:163], v192 offset:22528
  s_waitcnt lgkmcnt(4)
  v_mfma_f32_16x16x32_bf16 v[8:11], a[172:175], a[40:43], v[8:11]
  ds_read_b64_tr_b16 a[164:165], v193 offset:20480
  v_mfma_f32_16x16x32_bf16 v[12:15], a[172:175], a[44:47], v[12:15]
  ds_read_b64_tr_b16 a[166:167], v193 offset:22528
  s_barrier
  v_mfma_f32_16x16x32_bf16 v[16:19], a[144:147], a[40:43], v[16:19]
  ds_read_b64_tr_b16 a[168:169], v190 offset:24576
  v_lshlrev_b32 v138, 2, v220
  v_mfma_f32_16x16x32_bf16 v[20:23], a[144:147], a[44:47], v[20:23]
  ds_read_b64_tr_b16 a[170:171], v190 offset:26624
  v_add_u32 v138, s87, v138
  v_mfma_f32_16x16x32_bf16 v[24:27], a[148:151], a[40:43], v[24:27]
  ds_read_b64_tr_b16 a[172:173], v191 offset:24576
  v_mul_u32_u24 v136, 576, v136
  v_mfma_f32_16x16x32_bf16 v[28:31], a[148:151], a[44:47], v[28:31]
  ds_read_b64_tr_b16 a[174:175], v191 offset:26624
  v_add_u32 v136, v136, v138
  v_mfma_f32_16x16x32_bf16 v[32:35], a[152:155], a[40:43], v[32:35]
  ds_read_b64_tr_b16 a[144:145], v192 offset:24576
  v_lshlrev_b32 v137, 1, v136
  v_mfma_f32_16x16x32_bf16 v[36:39], a[152:155], a[44:47], v[36:39]
  ds_read_b64_tr_b16 a[146:147], v192 offset:26624
  s_waitcnt lgkmcnt(4)
  v_mfma_f32_16x16x32_bf16 v[40:43], a[156:159], a[40:43], v[40:43]
  ds_read_b64_tr_b16 a[148:149], v193 offset:24576
  v_lshlrev_b32 v138, 1, v138
  v_mfma_f32_16x16x32_bf16 v[44:47], a[156:159], a[44:47], v[44:47]
  ds_read_b64_tr_b16 a[150:151], v193 offset:26624
  v_lshlrev_b32 v136, 2, v136
  v_mfma_f32_16x16x32_bf16 v[48:51], a[160:163], a[40:43], v[48:51]
  ds_read_b64_tr_b16 a[152:153], v190 offset:36864
  v_accvgpr_read_b32 v222, a249
  v_mfma_f32_16x16x32_bf16 v[52:55], a[160:163], a[44:47], v[52:55]
  ds_read_b64_tr_b16 a[154:155], v190 offset:38912
  v_accvgpr_read_b32 v223, a250
  v_mfma_f32_16x16x32_bf16 v[56:59], a[164:167], a[40:43], v[56:59]
  ds_read_b64_tr_b16 a[156:157], v191 offset:36864
  s_mov_b32 s49, 0
  buffer_load_dwordx2 v[228:229], v137, s[4:7], s49 offen
  v_mfma_f32_16x16x32_bf16 v[60:63], a[164:167], a[44:47], v[60:63]
  ds_read_b64_tr_b16 a[158:159], v191 offset:38912
  v_mfma_f32_16x16x32_bf16 v[64:67], a[168:171], a[48:51], v[64:67]
  ds_read_b64_tr_b16 a[160:161], v192 offset:36864
  v_mfma_f32_16x16x32_bf16 v[68:71], a[168:171], a[52:55], v[68:71]
  ds_read_b64_tr_b16 a[162:163], v192 offset:38912
  s_waitcnt lgkmcnt(4)
  v_mfma_f32_16x16x32_bf16 v[72:75], a[172:175], a[48:51], v[72:75]
  ds_read_b64_tr_b16 a[164:165], v193 offset:36864
  v_mfma_f32_16x16x32_bf16 v[76:79], a[172:175], a[52:55], v[76:79]
  ds_read_b64_tr_b16 a[166:167], v193 offset:38912
  s_mov_b32 s50, 18432
  buffer_load_dwordx2 v[230:231], v137, s[4:7], s50 offen
  v_mfma_f32_16x16x32_bf16 v[80:83], a[144:147], a[48:51], v[80:83]
  ds_read_b64_tr_b16 a[168:169], v190 offset:28672
  v_mfma_f32_16x16x32_bf16 v[84:87], a[144:147], a[52:55], v[84:87]
  ds_read_b64_tr_b16 a[170:171], v190 offset:30720
  v_mfma_f32_16x16x32_bf16 v[88:91], a[148:151], a[48:51], v[88:91]
  ds_read_b64_tr_b16 a[172:173], v191 offset:28672
  v_mfma_f32_16x16x32_bf16 v[92:95], a[148:151], a[52:55], v[92:95]
  ds_read_b64_tr_b16 a[174:175], v191 offset:30720
  v_mfma_f32_16x16x32_bf16 v[96:99], a[152:155], a[48:51], v[96:99]
  ds_read_b64_tr_b16 a[144:145], v192 offset:28672
  s_mov_b32 s49, 0
  buffer_load_dwordx2 v[232:233], v138, s[16:19], s49 offen
  v_mfma_f32_16x16x32_bf16 v[100:103], a[152:155], a[52:55], v[100:103]
  ds_read_b64_tr_b16 a[146:147], v192 offset:30720
  s_waitcnt lgkmcnt(4)
  v_mfma_f32_16x16x32_bf16 v[104:107], a[156:159], a[48:51], v[104:107]
  ds_read_b64_tr_b16 a[148:149], v193 offset:28672
  v_mfma_f32_16x16x32_bf16 v[108:111], a[156:159], a[52:55], v[108:111]
  ds_read_b64_tr_b16 a[150:151], v193 offset:30720
  v_mfma_f32_16x16x32_bf16 v[112:115], a[160:163], a[48:51], v[112:115]
  ds_read_b64_tr_b16 a[152:153], v190 offset:40960
  v_mfma_f32_16x16x32_bf16 v[116:119], a[160:163], a[52:55], v[116:119]
  ds_read_b64_tr_b16 a[154:155], v190 offset:43008
  s_mov_b32 s49, 256
  buffer_load_dwordx2 v[234:235], v137, s[4:7], s49 offen
  v_mfma_f32_16x16x32_bf16 v[120:123], a[164:167], a[48:51], v[120:123]
  ds_read_b64_tr_b16 a[156:157], v191 offset:40960
  v_mfma_f32_16x16x32_bf16 v[124:127], a[164:167], a[52:55], v[124:127]
  ds_read_b64_tr_b16 a[158:159], v191 offset:43008
  v_mfma_f32_16x16x32_bf16 v[64:67], a[168:171], a[56:59], v[64:67]
  ds_read_b64_tr_b16 a[160:161], v192 offset:40960
  v_mfma_f32_16x16x32_bf16 v[68:71], a[168:171], a[60:63], v[68:71]
  ds_read_b64_tr_b16 a[162:163], v192 offset:43008
  s_waitcnt lgkmcnt(4)
  v_mfma_f32_16x16x32_bf16 v[72:75], a[172:175], a[56:59], v[72:75]
  ds_read_b64_tr_b16 a[164:165], v193 offset:40960
  s_mov_b32 s50, 18688
  buffer_load_dwordx2 v[236:237], v137, s[4:7], s50 offen
  v_mfma_f32_16x16x32_bf16 v[76:79], a[172:175], a[60:63], v[76:79]
  ds_read_b64_tr_b16 a[166:167], v193 offset:43008
  v_mfma_f32_16x16x32_bf16 v[80:83], a[144:147], a[56:59], v[80:83]
  ds_read_b64_tr_b16 a[168:169], v190 offset:32768
  v_mfma_f32_16x16x32_bf16 v[84:87], a[144:147], a[60:63], v[84:87]
  ds_read_b64_tr_b16 a[170:171], v190 offset:34816
  v_mfma_f32_16x16x32_bf16 v[88:91], a[148:151], a[56:59], v[88:91]
  ds_read_b64_tr_b16 a[172:173], v191 offset:32768
  v_mfma_f32_16x16x32_bf16 v[92:95], a[148:151], a[60:63], v[92:95]
  ds_read_b64_tr_b16 a[174:175], v191 offset:34816
  s_mov_b32 s49, 256
  buffer_load_dwordx2 v[238:239], v138, s[16:19], s49 offen
  v_mfma_f32_16x16x32_bf16 v[96:99], a[152:155], a[56:59], v[96:99]
  ds_read_b64_tr_b16 a[144:145], v192 offset:32768
  s_lshr_b32 s49, s42, 2
  s_lshl_b32 s83, s41, 7
  s_lshl_b32 s49, s49, 5
  s_add_u32 s83, s83, s49
  s_lshl_b32 s51, s55, 4
  v_mfma_f32_16x16x32_bf16 v[100:103], a[152:155], a[60:63], v[100:103]
  ds_read_b64_tr_b16 a[146:147], v192 offset:34816
  s_waitcnt lgkmcnt(4)
  v_mfma_f32_16x16x32_bf16 v[104:107], a[156:159], a[56:59], v[104:107]
  ds_read_b64_tr_b16 a[148:149], v193 offset:32768
  s_add_u32 s83, s83, s51
  v_mfma_f32_16x16x32_bf16 v[108:111], a[156:159], a[60:63], v[108:111]
  ds_read_b64_tr_b16 a[150:151], v193 offset:34816
  s_lshl_b32 s85, s85, 4
  v_mfma_f32_16x16x32_bf16 v[112:115], a[160:163], a[56:59], v[112:115]
  ds_read_b64_tr_b16 a[152:153], v190 offset:45056
  s_add_u32 s85, s85, 256
  v_mfma_f32_16x16x32_bf16 v[116:119], a[160:163], a[60:63], v[116:119]
  ds_read_b64_tr_b16 a[154:155], v190 offset:47104
  v_add_u32 v180, s83, v219
  v_mfma_f32_16x16x32_bf16 v[120:123], a[164:167], a[56:59], v[120:123]
  ds_read_b64_tr_b16 a[156:157], v191 offset:45056
  v_lshlrev_b32 v242, 2, v220
  v_mfma_f32_16x16x32_bf16 v[124:127], a[164:167], a[60:63], v[124:127]
  ds_read_b64_tr_b16 a[158:159], v191 offset:47104
  v_add_u32 v242, s85, v242
  v_mfma_f32_16x16x32_bf16 v[64:67], a[168:171], a[64:67], v[64:67]
  ds_read_b64_tr_b16 a[160:161], v192 offset:45056
  v_mul_u32_u24 v139, 576, v180
  v_mfma_f32_16x16x32_bf16 v[68:71], a[168:171], a[68:71], v[68:71]
  ds_read_b64_tr_b16 a[162:163], v192 offset:47104
  s_waitcnt lgkmcnt(4)
  v_mfma_f32_16x16x32_bf16 v[72:75], a[172:175], a[64:67], v[72:75]
  ds_read_b64_tr_b16 a[164:165], v193 offset:45056
  s_waitcnt vmcnt(25)
  v_mfma_f32_16x16x32_bf16 v[76:79], a[172:175], a[68:71], v[76:79]
  ds_read_b64_tr_b16 a[166:167], v193 offset:47104
  s_barrier
  v_mfma_f32_16x16x32_bf16 v[80:83], a[144:147], a[64:67], v[80:83]
  ds_read_b64 a[168:169], v185
  v_add_u32 v139, v139, v242
  v_mfma_f32_16x16x32_bf16 v[84:87], a[144:147], a[68:71], v[84:87]
  ds_read_b64 a[170:171], v185 offset:12288
  v_lshlrev_b32 v240, 1, v139
  v_mfma_f32_16x16x32_bf16 v[88:91], a[148:151], a[64:67], v[88:91]
  ds_read_b64 a[172:173], v185 offset:1536
  v_lshlrev_b32 v242, 1, v242
  v_mfma_f32_16x16x32_bf16 v[92:95], a[148:151], a[68:71], v[92:95]
  ds_read_b64 a[174:175], v185 offset:13824
  v_lshlrev_b32 v180, 2, v180
  v_mfma_f32_16x16x32_bf16 v[96:99], a[152:155], a[64:67], v[96:99]
  ds_read_b64 a[144:145], v185 offset:3072
  v_lshlrev_b32 v139, 2, v139
  v_mfma_f32_16x16x32_bf16 v[100:103], a[152:155], a[68:71], v[100:103]
  ds_read_b64 a[146:147], v185 offset:15360
  s_waitcnt lgkmcnt(4)
  v_mfma_f32_16x16x32_bf16 v[104:107], a[156:159], a[64:67], v[104:107]
  ds_read_b64 a[148:149], v185 offset:4608
  buffer_load_dwordx2 v[240:241], v240, s[4:7], 0 offen
  v_mfma_f32_16x16x32_bf16 v[108:111], a[156:159], a[68:71], v[108:111]
  ds_read_b64 a[150:151], v185 offset:16896
  v_mfma_f32_16x16x32_bf16 v[112:115], a[160:163], a[64:67], v[112:115]
  ds_read_b64 a[152:153], v185 offset:6144
  v_mfma_f32_16x16x32_bf16 v[116:119], a[160:163], a[68:71], v[116:119]
  ds_read_b64 a[154:155], v185 offset:18432
  v_mfma_f32_16x16x32_bf16 v[120:123], a[164:167], a[64:67], v[120:123]
  ds_read_b64 a[156:157], v185 offset:7680
  v_mfma_f32_16x16x32_bf16 v[124:127], a[164:167], a[68:71], v[124:127]
  ds_read_b64 a[158:159], v185 offset:19968
  buffer_load_dword v218, v217, s[24:27], 0 offen sc1
  s_waitcnt vmcnt(19)
  v_mfma_f32_16x16x32_bf16 v[64:67], a[168:171], a[72:75], v[64:67]
  ds_read_b64 a[160:161], v185 offset:9216
  s_waitcnt vmcnt(18)
  v_mfma_f32_16x16x32_bf16 v[68:71], a[168:171], a[76:79], v[68:71]
  ds_read_b64 a[162:163], v185 offset:21504
  s_waitcnt lgkmcnt(4)
  v_mfma_f32_16x16x32_bf16 v[72:75], a[172:175], a[72:75], v[72:75]
  ds_read_b64 a[164:165], v185 offset:10752
  v_mfma_f32_16x16x32_bf16 v[76:79], a[172:175], a[76:79], v[76:79]
  ds_read_b64 a[166:167], v185 offset:23040
  v_mfma_f32_16x16x32_bf16 v[80:83], a[144:147], a[72:75], v[80:83]
  ds_read_b64 a[168:169], v185 offset:32
  buffer_load_dwordx2 v[242:243], v242, s[16:19], 0 offen
  v_mfma_f32_16x16x32_bf16 v[84:87], a[144:147], a[76:79], v[84:87]
  ds_read_b64 a[170:171], v185 offset:12320
  s_mov_b32 s50, 46235648
  v_mfma_f32_16x16x32_bf16 v[88:91], a[148:151], a[72:75], v[88:91]
  ds_read_b64 a[172:173], v185 offset:1568
  v_mfma_f32_16x16x32_bf16 v[92:95], a[148:151], a[76:79], v[92:95]
  ds_read_b64 a[174:175], v185 offset:13856
  v_mfma_f32_16x16x32_bf16 v[96:99], a[152:155], a[72:75], v[96:99]
  ds_read_b64 a[144:145], v185 offset:3104
  v_mfma_f32_16x16x32_bf16 v[100:103], a[152:155], a[76:79], v[100:103]
  ds_read_b64 a[146:147], v185 offset:15392
  s_waitcnt lgkmcnt(4)
  v_mfma_f32_16x16x32_bf16 v[104:107], a[156:159], a[72:75], v[104:107]
  ds_read_b64 a[148:149], v185 offset:4640
  v_mfma_f32_16x16x32_bf16 v[108:111], a[156:159], a[76:79], v[108:111]
  ds_read_b64 a[150:151], v185 offset:16928
  v_mfma_f32_16x16x32_bf16 v[112:115], a[160:163], a[72:75], v[112:115]
  ds_read_b64 a[152:153], v185 offset:6176
  v_mfma_f32_16x16x32_bf16 v[116:119], a[160:163], a[76:79], v[116:119]
  ds_read_b64 a[154:155], v185 offset:18464
  v_mfma_f32_16x16x32_bf16 v[120:123], a[164:167], a[72:75], v[120:123]
  ds_read_b64 a[156:157], v185 offset:7712
  v_mfma_f32_16x16x32_bf16 v[124:127], a[164:167], a[76:79], v[124:127]
  ds_read_b64 a[158:159], v185 offset:20000
  s_waitcnt vmcnt(18)
  v_mfma_f32_16x16x32_bf16 v[64:67], a[168:171], a[80:83], v[64:67]
  ds_read_b64 a[160:161], v185 offset:9248
  s_waitcnt vmcnt(17)
  v_mfma_f32_16x16x32_bf16 v[68:71], a[168:171], a[84:87], v[68:71]
  ds_read_b64 a[162:163], v185 offset:21536
  s_waitcnt lgkmcnt(4)
  v_mfma_f32_16x16x32_bf16 v[72:75], a[172:175], a[80:83], v[72:75]
  ds_read_b64 a[164:165], v185 offset:10784
  v_mfma_f32_16x16x32_bf16 v[76:79], a[172:175], a[84:87], v[76:79]
  ds_read_b64 a[166:167], v185 offset:23072
  v_mfma_f32_16x16x32_bf16 v[80:83], a[144:147], a[80:83], v[80:83]
  ds_read_b64 a[168:169], v185 offset:64
  v_mfma_f32_16x16x32_bf16 v[84:87], a[144:147], a[84:87], v[84:87]
  ds_read_b64 a[170:171], v185 offset:12352
  v_mfma_f32_16x16x32_bf16 v[88:91], a[148:151], a[80:83], v[88:91]
  ds_read_b64 a[172:173], v185 offset:1600
  v_mfma_f32_16x16x32_bf16 v[92:95], a[148:151], a[84:87], v[92:95]
  ds_read_b64 a[174:175], v185 offset:13888
  v_mfma_f32_16x16x32_bf16 v[96:99], a[152:155], a[80:83], v[96:99]
  ds_read_b64 a[144:145], v185 offset:3136
  v_mfma_f32_16x16x32_bf16 v[100:103], a[152:155], a[84:87], v[100:103]
  ds_read_b64 a[146:147], v185 offset:15424
  s_waitcnt lgkmcnt(4)
  v_mfma_f32_16x16x32_bf16 v[104:107], a[156:159], a[80:83], v[104:107]
  ds_read_b64 a[148:149], v185 offset:4672
  v_mfma_f32_16x16x32_bf16 v[108:111], a[156:159], a[84:87], v[108:111]
  ds_read_b64 a[150:151], v185 offset:16960
  v_mfma_f32_16x16x32_bf16 v[112:115], a[160:163], a[80:83], v[112:115]
  ds_read_b64 a[152:153], v185 offset:6208
  v_mfma_f32_16x16x32_bf16 v[116:119], a[160:163], a[84:87], v[116:119]
  ds_read_b64 a[154:155], v185 offset:18496
  v_mfma_f32_16x16x32_bf16 v[120:123], a[164:167], a[80:83], v[120:123]
  ds_read_b64 a[156:157], v185 offset:7744
  v_mfma_f32_16x16x32_bf16 v[124:127], a[164:167], a[84:87], v[124:127]
  ds_read_b64 a[158:159], v185 offset:20032
  s_waitcnt vmcnt(16)
  v_mfma_f32_16x16x32_bf16 v[64:67], a[168:171], a[88:91], v[64:67]
  ds_read_b64 a[160:161], v185 offset:9280
  s_waitcnt vmcnt(15)
  v_mfma_f32_16x16x32_bf16 v[68:71], a[168:171], a[92:95], v[68:71]
  ds_read_b64 a[162:163], v185 offset:21568
  s_waitcnt lgkmcnt(4)
  v_mfma_f32_16x16x32_bf16 v[72:75], a[172:175], a[88:91], v[72:75]
  ds_read_b64 a[164:165], v185 offset:10816
  v_mfma_f32_16x16x32_bf16 v[76:79], a[172:175], a[92:95], v[76:79]
  ds_read_b64 a[166:167], v185 offset:23104
  s_barrier
  v_mfma_f32_16x16x32_bf16 v[80:83], a[144:147], a[88:91], v[80:83]
  ds_read_b64_tr_b16 a[168:169], v198
  v_mfma_f32_16x16x32_bf16 v[84:87], a[144:147], a[92:95], v[84:87]
  ds_read_b64_tr_b16 a[170:171], v198 offset:2048
  v_mfma_f32_16x16x32_bf16 v[88:91], a[148:151], a[88:91], v[88:91]
  ds_read_b64_tr_b16 a[172:173], v199
  v_mfma_f32_16x16x32_bf16 v[92:95], a[148:151], a[92:95], v[92:95]
  ds_read_b64_tr_b16 a[174:175], v199 offset:2048
  v_mfma_f32_16x16x32_bf16 v[96:99], a[152:155], a[88:91], v[96:99]
  ds_read_b64_tr_b16 a[144:145], v200
  v_mfma_f32_16x16x32_bf16 v[100:103], a[152:155], a[92:95], v[100:103]
  ds_read_b64_tr_b16 a[146:147], v200 offset:2048
  s_waitcnt lgkmcnt(4)
  v_mfma_f32_16x16x32_bf16 v[104:107], a[156:159], a[88:91], v[104:107]
  ds_read_b64_tr_b16 a[148:149], v201
  v_mfma_f32_16x16x32_bf16 v[108:111], a[156:159], a[92:95], v[108:111]
  ds_read_b64_tr_b16 a[150:151], v201 offset:2048
  v_mfma_f32_16x16x32_bf16 v[112:115], a[160:163], a[88:91], v[112:115]
  ds_read_b64_tr_b16 a[152:153], v198 offset:12288
  v_mfma_f32_16x16x32_bf16 v[116:119], a[160:163], a[92:95], v[116:119]
  ds_read_b64_tr_b16 a[154:155], v198 offset:14336
  v_mfma_f32_16x16x32_bf16 v[120:123], a[164:167], a[88:91], v[120:123]
  ds_read_b64_tr_b16 a[156:157], v199 offset:12288
  v_mfma_f32_16x16x32_bf16 v[124:127], a[164:167], a[92:95], v[124:127]
  ds_read_b64_tr_b16 a[158:159], v199 offset:14336
  v_mfma_f32_16x16x32_bf16 v[0:3], a[168:171], a[48:51], v[0:3]
  ds_read_b64_tr_b16 a[160:161], v200 offset:12288
  v_mfma_f32_16x16x32_bf16 v[4:7], a[168:171], a[52:55], v[4:7]
  ds_read_b64_tr_b16 a[162:163], v200 offset:14336
  s_waitcnt lgkmcnt(4)
  v_mfma_f32_16x16x32_bf16 v[8:11], a[172:175], a[48:51], v[8:11]
  ds_read_b64_tr_b16 a[164:165], v201 offset:12288
  v_mfma_f32_16x16x32_bf16 v[12:15], a[172:175], a[52:55], v[12:15]
  ds_read_b64_tr_b16 a[166:167], v201 offset:14336
  v_cvt_pk_bf16_f32 v64, v64, v65
  v_mfma_f32_16x16x32_bf16 v[16:19], a[144:147], a[48:51], v[16:19]
  ds_read_b64_tr_b16 a[168:169], v198 offset:4096
  v_cvt_pk_bf16_f32 v65, v66, v67
  v_mfma_f32_16x16x32_bf16 v[20:23], a[144:147], a[52:55], v[20:23]
  ds_read_b64_tr_b16 a[170:171], v198 offset:6144
  v_cvt_pk_bf16_f32 v66, v68, v69
  v_mfma_f32_16x16x32_bf16 v[24:27], a[148:151], a[48:51], v[24:27]
  ds_read_b64_tr_b16 a[172:173], v199 offset:4096
  v_cvt_pk_bf16_f32 v67, v70, v71
  v_mfma_f32_16x16x32_bf16 v[28:31], a[148:151], a[52:55], v[28:31]
  ds_read_b64_tr_b16 a[174:175], v199 offset:6144
  buffer_store_dwordx4 v[64:67], v226, s[24:27], s48 offen sc1
  v_mfma_f32_16x16x32_bf16 v[32:35], a[152:155], a[48:51], v[32:35]
  ds_read_b64_tr_b16 a[144:145], v200 offset:4096
  v_cvt_pk_bf16_f32 v72, v72, v73
  v_mfma_f32_16x16x32_bf16 v[36:39], a[152:155], a[52:55], v[36:39]
  ds_read_b64_tr_b16 a[146:147], v200 offset:6144
  s_waitcnt lgkmcnt(4)
  v_mfma_f32_16x16x32_bf16 v[40:43], a[156:159], a[48:51], v[40:43]
  ds_read_b64_tr_b16 a[148:149], v201 offset:4096
  v_cvt_pk_bf16_f32 v73, v74, v75
  v_mfma_f32_16x16x32_bf16 v[44:47], a[156:159], a[52:55], v[44:47]
  ds_read_b64_tr_b16 a[150:151], v201 offset:6144
  v_cvt_pk_bf16_f32 v74, v76, v77
  v_mfma_f32_16x16x32_bf16 v[48:51], a[160:163], a[48:51], v[48:51]
  ds_read_b64_tr_b16 a[152:153], v198 offset:16384
  v_cvt_pk_bf16_f32 v75, v78, v79
  v_mfma_f32_16x16x32_bf16 v[52:55], a[160:163], a[52:55], v[52:55]
  ds_read_b64_tr_b16 a[154:155], v198 offset:18432
  buffer_store_dwordx4 v[72:75], v226, s[24:27], s48 offen offset:1024 sc1
  v_mfma_f32_16x16x32_bf16 v[56:59], a[164:167], a[48:51], v[56:59]
  ds_read_b64_tr_b16 a[156:157], v199 offset:16384
  v_cvt_pk_bf16_f32 v80, v80, v81
  v_mfma_f32_16x16x32_bf16 v[60:63], a[164:167], a[52:55], v[60:63]
  ds_read_b64_tr_b16 a[158:159], v199 offset:18432
  v_cvt_pk_bf16_f32 v81, v82, v83
  v_mfma_f32_16x16x32_bf16 v[0:3], a[168:171], a[56:59], v[0:3]
  ds_read_b64_tr_b16 a[160:161], v200 offset:16384
  v_cvt_pk_bf16_f32 v82, v84, v85
  v_mfma_f32_16x16x32_bf16 v[4:7], a[168:171], a[60:63], v[4:7]
  ds_read_b64_tr_b16 a[162:163], v200 offset:18432
  s_waitcnt lgkmcnt(4)
  v_mfma_f32_16x16x32_bf16 v[8:11], a[172:175], a[56:59], v[8:11]
  ds_read_b64_tr_b16 a[164:165], v201 offset:16384
  v_cvt_pk_bf16_f32 v83, v86, v87
  v_mfma_f32_16x16x32_bf16 v[12:15], a[172:175], a[60:63], v[12:15]
  ds_read_b64_tr_b16 a[166:167], v201 offset:18432
  buffer_store_dwordx4 v[80:83], v226, s[24:27], s48 offen offset:2048 sc1
  v_mfma_f32_16x16x32_bf16 v[16:19], a[144:147], a[56:59], v[16:19]
  ds_read_b64_tr_b16 a[168:169], v198 offset:8192
  v_cvt_pk_bf16_f32 v88, v88, v89
  v_mfma_f32_16x16x32_bf16 v[20:23], a[144:147], a[60:63], v[20:23]
  ds_read_b64_tr_b16 a[170:171], v198 offset:10240
  v_cvt_pk_bf16_f32 v89, v90, v91
  v_mfma_f32_16x16x32_bf16 v[24:27], a[148:151], a[56:59], v[24:27]
  ds_read_b64_tr_b16 a[172:173], v199 offset:8192
  v_cvt_pk_bf16_f32 v90, v92, v93
  v_mfma_f32_16x16x32_bf16 v[28:31], a[148:151], a[60:63], v[28:31]
  ds_read_b64_tr_b16 a[174:175], v199 offset:10240
  v_cvt_pk_bf16_f32 v91, v94, v95
  v_mfma_f32_16x16x32_bf16 v[32:35], a[152:155], a[56:59], v[32:35]
  ds_read_b64_tr_b16 a[144:145], v200 offset:8192
  buffer_store_dwordx4 v[88:91], v226, s[24:27], s48 offen offset:3072 sc1
  v_mfma_f32_16x16x32_bf16 v[36:39], a[152:155], a[60:63], v[36:39]
  ds_read_b64_tr_b16 a[146:147], v200 offset:10240
  s_waitcnt lgkmcnt(4)
  v_mfma_f32_16x16x32_bf16 v[40:43], a[156:159], a[56:59], v[40:43]
  ds_read_b64_tr_b16 a[148:149], v201 offset:8192
  s_add_u32 s48, s48, 4096
  v_mfma_f32_16x16x32_bf16 v[44:47], a[156:159], a[60:63], v[44:47]
  ds_read_b64_tr_b16 a[150:151], v201 offset:10240
  v_cvt_pk_bf16_f32 v96, v96, v97
  v_mfma_f32_16x16x32_bf16 v[48:51], a[160:163], a[56:59], v[48:51]
  ds_read_b64_tr_b16 a[152:153], v198 offset:20480
  v_cvt_pk_bf16_f32 v97, v98, v99
  v_mfma_f32_16x16x32_bf16 v[52:55], a[160:163], a[60:63], v[52:55]
  ds_read_b64_tr_b16 a[154:155], v198 offset:22528
  v_cvt_pk_bf16_f32 v98, v100, v101
  v_mfma_f32_16x16x32_bf16 v[56:59], a[164:167], a[56:59], v[56:59]
  ds_read_b64_tr_b16 a[156:157], v199 offset:20480
  v_cvt_pk_bf16_f32 v99, v102, v103
  v_mfma_f32_16x16x32_bf16 v[60:63], a[164:167], a[60:63], v[60:63]
  ds_read_b64_tr_b16 a[158:159], v199 offset:22528
  buffer_store_dwordx4 v[96:99], v226, s[24:27], s48 offen sc1
  v_mfma_f32_16x16x32_bf16 v[0:3], a[168:171], a[64:67], v[0:3]
  ds_read_b64_tr_b16 a[160:161], v200 offset:20480
  v_cvt_pk_bf16_f32 v104, v104, v105
  v_mfma_f32_16x16x32_bf16 v[4:7], a[168:171], a[68:71], v[4:7]
  ds_read_b64_tr_b16 a[162:163], v200 offset:22528
  s_waitcnt lgkmcnt(4)
  v_mfma_f32_16x16x32_bf16 v[8:11], a[172:175], a[64:67], v[8:11]
  ds_read_b64_tr_b16 a[164:165], v201 offset:20480
  s_waitcnt vmcnt(14)
  v_mfma_f32_16x16x32_bf16 v[12:15], a[172:175], a[68:71], v[12:15]
  ds_read_b64_tr_b16 a[166:167], v201 offset:22528
  s_barrier
  v_mfma_f32_16x16x32_bf16 v[16:19], a[144:147], a[64:67], v[16:19]
  ds_read_b64 a[168:169], v186 offset:24576
  v_cvt_pk_bf16_f32 v105, v106, v107
  v_mfma_f32_16x16x32_bf16 v[20:23], a[144:147], a[68:71], v[20:23]
  ds_read_b64 a[170:171], v186 offset:36864
  v_cvt_pk_bf16_f32 v106, v108, v109
  v_mfma_f32_16x16x32_bf16 v[24:27], a[148:151], a[64:67], v[24:27]
  ds_read_b64 a[172:173], v186 offset:26112
  v_cvt_pk_bf16_f32 v107, v110, v111
  v_mfma_f32_16x16x32_bf16 v[28:31], a[148:151], a[68:71], v[28:31]
  ds_read_b64 a[174:175], v186 offset:38400
  buffer_store_dwordx4 v[104:107], v226, s[24:27], s48 offen offset:1024 sc1
  v_mfma_f32_16x16x32_bf16 v[32:35], a[152:155], a[64:67], v[32:35]
  ds_read_b64 a[144:145], v186 offset:27648
  v_cvt_pk_bf16_f32 v112, v112, v113
  v_cvt_pk_bf16_f32 v113, v114, v115
  v_mfma_f32_16x16x32_bf16 v[36:39], a[152:155], a[68:71], v[36:39]
  ds_read_b64 a[146:147], v186 offset:39936
  s_waitcnt vmcnt(7)
  v_cmp_le_u32 vcc, 5, v218
  s_nop 3
  s_or_b64 vcc, vcc, s[56:57]
  s_cmp_eq_u64 vcc, -1
  s_cselect_b32 s88, 1, 0
  s_cselect_b32 s84, s89, 0x7ff00000
  s_cselect_b32 s49, s50, 0x7ff00000
  s_waitcnt lgkmcnt(4)
  v_mfma_f32_16x16x32_bf16 v[40:43], a[156:159], a[64:67], v[40:43]
  ds_read_b64 a[148:149], v186 offset:29184
  v_cvt_pk_bf16_f32 v114, v116, v117
  v_mfma_f32_16x16x32_bf16 v[44:47], a[156:159], a[68:71], v[44:47]
  ds_read_b64 a[150:151], v186 offset:41472
  v_cvt_pk_bf16_f32 v115, v118, v119
  v_mfma_f32_16x16x32_bf16 v[48:51], a[160:163], a[64:67], v[48:51]
  ds_read_b64 a[152:153], v186 offset:30720
  buffer_store_dwordx4 v[112:115], v226, s[24:27], s48 offen offset:2048 sc1
  v_mfma_f32_16x16x32_bf16 v[52:55], a[160:163], a[68:71], v[52:55]
  ds_read_b64 a[154:155], v186 offset:43008
  v_cvt_pk_bf16_f32 v120, v120, v121
  v_mfma_f32_16x16x32_bf16 v[56:59], a[164:167], a[64:67], v[56:59]
  ds_read_b64 a[156:157], v186 offset:32256
  v_cvt_pk_bf16_f32 v121, v122, v123
  v_mfma_f32_16x16x32_bf16 v[60:63], a[164:167], a[68:71], v[60:63]
  ds_read_b64 a[158:159], v186 offset:44544
  v_cvt_pk_bf16_f32 v122, v124, v125
  v_mfma_f32_16x16x32_bf16 v[0:3], a[168:171], a[72:75], v[0:3]
  ds_read_b64 a[160:161], v186 offset:33792
  v_cvt_pk_bf16_f32 v123, v126, v127
  v_mfma_f32_16x16x32_bf16 v[4:7], a[168:171], a[76:79], v[4:7]
  ds_read_b64 a[162:163], v186 offset:46080
  s_waitcnt lgkmcnt(4)
  v_mfma_f32_16x16x32_bf16 v[8:11], a[172:175], a[72:75], v[8:11]
  ds_read_b64 a[164:165], v186 offset:35328
  buffer_store_dwordx4 v[120:123], v226, s[24:27], s48 offen offset:3072 sc1
  v_mfma_f32_16x16x32_bf16 v[12:15], a[172:175], a[76:79], v[12:15]
  ds_read_b64 a[166:167], v186 offset:47616
  s_add_u32 s48, s48, 4096
  v_mfma_f32_16x16x32_bf16 v[16:19], a[144:147], a[72:75], v[16:19]
  ds_read_b64 a[168:169], v186 offset:24608
  v_mfma_f32_16x16x32_bf16 v[20:23], a[144:147], a[76:79], v[20:23]
  ds_read_b64 a[170:171], v186 offset:36896
  v_mfma_f32_16x16x32_bf16 v[24:27], a[148:151], a[72:75], v[24:27]
  ds_read_b64 a[172:173], v186 offset:26144
  v_mfma_f32_16x16x32_bf16 v[28:31], a[148:151], a[76:79], v[28:31]
  ds_read_b64 a[174:175], v186 offset:38432
  buffer_load_dword v181, v180, s[24:27], s49 offen sc1
  v_mfma_f32_16x16x32_bf16 v[32:35], a[152:155], a[72:75], v[32:35]
  ds_read_b64 a[144:145], v186 offset:27680
  v_mfma_f32_16x16x32_bf16 v[36:39], a[152:155], a[76:79], v[36:39]
  ds_read_b64 a[146:147], v186 offset:39968
  s_waitcnt lgkmcnt(4)
  v_mfma_f32_16x16x32_bf16 v[40:43], a[156:159], a[72:75], v[40:43]
  ds_read_b64 a[148:149], v186 offset:29216
  v_mfma_f32_16x16x32_bf16 v[44:47], a[156:159], a[76:79], v[44:47]
  ds_read_b64 a[150:151], v186 offset:41504
  v_mfma_f32_16x16x32_bf16 v[48:51], a[160:163], a[72:75], v[48:51]
  ds_read_b64 a[152:153], v186 offset:30752
  buffer_load_dwordx2 a[96:97], v226, s[24:27], s84 offen sc1
  v_mfma_f32_16x16x32_bf16 v[52:55], a[160:163], a[76:79], v[52:55]
  ds_read_b64 a[154:155], v186 offset:43040
  s_add_u32 s84, s84, 262144
  v_mfma_f32_16x16x32_bf16 v[56:59], a[164:167], a[72:75], v[56:59]
  ds_read_b64 a[156:157], v186 offset:32288
  v_mfma_f32_16x16x32_bf16 v[60:63], a[164:167], a[76:79], v[60:63]
  ds_read_b64 a[158:159], v186 offset:44576
  v_mfma_f32_16x16x32_bf16 v[0:3], a[168:171], a[80:83], v[0:3]
  ds_read_b64 a[160:161], v186 offset:33824
  v_mfma_f32_16x16x32_bf16 v[4:7], a[168:171], a[84:87], v[4:7]
  ds_read_b64 a[162:163], v186 offset:46112
  s_waitcnt lgkmcnt(4)
  v_mfma_f32_16x16x32_bf16 v[8:11], a[172:175], a[80:83], v[8:11]
  ds_read_b64 a[164:165], v186 offset:35360
  buffer_load_dwordx2 a[98:99], v226, s[24:27], s84 offen sc1
  v_mfma_f32_16x16x32_bf16 v[12:15], a[172:175], a[84:87], v[12:15]
  ds_read_b64 a[166:167], v186 offset:47648
  s_add_u32 s84, s84, 262144
  v_mfma_f32_16x16x32_bf16 v[16:19], a[144:147], a[80:83], v[16:19]
  ds_read_b64 a[168:169], v186 offset:24640
  v_mfma_f32_16x16x32_bf16 v[20:23], a[144:147], a[84:87], v[20:23]
  ds_read_b64 a[170:171], v186 offset:36928
  v_mfma_f32_16x16x32_bf16 v[24:27], a[148:151], a[80:83], v[24:27]
  ds_read_b64 a[172:173], v186 offset:26176
  v_mfma_f32_16x16x32_bf16 v[28:31], a[148:151], a[84:87], v[28:31]
  ds_read_b64 a[174:175], v186 offset:38464
  buffer_load_dwordx2 a[100:101], v226, s[24:27], s84 offen sc1
  v_mfma_f32_16x16x32_bf16 v[32:35], a[152:155], a[80:83], v[32:35]
  ds_read_b64 a[144:145], v186 offset:27712
  s_add_u32 s84, s84, 262144
  v_mfma_f32_16x16x32_bf16 v[36:39], a[152:155], a[84:87], v[36:39]
  ds_read_b64 a[146:147], v186 offset:40000
  s_waitcnt lgkmcnt(4)
  v_mfma_f32_16x16x32_bf16 v[40:43], a[156:159], a[80:83], v[40:43]
  ds_read_b64 a[148:149], v186 offset:29248
  v_mfma_f32_16x16x32_bf16 v[44:47], a[156:159], a[84:87], v[44:47]
  ds_read_b64 a[150:151], v186 offset:41536
  v_mfma_f32_16x16x32_bf16 v[48:51], a[160:163], a[80:83], v[48:51]
  ds_read_b64 a[152:153], v186 offset:30784
  buffer_load_dwordx2 a[102:103], v226, s[24:27], s84 offen sc1
  v_mfma_f32_16x16x32_bf16 v[52:55], a[160:163], a[84:87], v[52:55]
  ds_read_b64 a[154:155], v186 offset:43072
  s_add_u32 s84, s84, 262144
  v_mfma_f32_16x16x32_bf16 v[56:59], a[164:167], a[80:83], v[56:59]
  ds_read_b64 a[156:157], v186 offset:32320
  v_mfma_f32_16x16x32_bf16 v[60:63], a[164:167], a[84:87], v[60:63]
  ds_read_b64 a[158:159], v186 offset:44608
  v_mfma_f32_16x16x32_bf16 v[0:3], a[168:171], a[88:91], v[0:3]
  ds_read_b64 a[160:161], v186 offset:33856
  v_mfma_f32_16x16x32_bf16 v[4:7], a[168:171], a[92:95], v[4:7]
  ds_read_b64 a[162:163], v186 offset:46144
  s_waitcnt lgkmcnt(4)
  v_mfma_f32_16x16x32_bf16 v[8:11], a[172:175], a[88:91], v[8:11]
  ds_read_b64 a[164:165], v186 offset:35392
  buffer_load_dwordx2 a[104:105], v226, s[24:27], s84 offen sc1
  v_mfma_f32_16x16x32_bf16 v[12:15], a[172:175], a[92:95], v[12:15]
  ds_read_b64 a[166:167], v186 offset:47680
  s_add_u32 s84, s84, 262144
  v_mfma_f32_16x16x32_bf16 v[16:19], a[144:147], a[88:91], v[16:19]
  v_mfma_f32_16x16x32_bf16 v[20:23], a[144:147], a[92:95], v[20:23]
  v_mfma_f32_16x16x32_bf16 v[24:27], a[148:151], a[88:91], v[24:27]
  v_mfma_f32_16x16x32_bf16 v[28:31], a[148:151], a[92:95], v[28:31]
  buffer_load_dwordx2 a[106:107], v226, s[24:27], s84 offen sc1
  s_add_u32 s84, s84, 262144
  v_mfma_f32_16x16x32_bf16 v[32:35], a[152:155], a[88:91], v[32:35]
  v_mfma_f32_16x16x32_bf16 v[36:39], a[152:155], a[92:95], v[36:39]
  s_waitcnt lgkmcnt(0)
  v_mfma_f32_16x16x32_bf16 v[40:43], a[156:159], a[88:91], v[40:43]
  v_mfma_f32_16x16x32_bf16 v[44:47], a[156:159], a[92:95], v[44:47]
  v_mfma_f32_16x16x32_bf16 v[48:51], a[160:163], a[88:91], v[48:51]
  buffer_load_dwordx2 a[108:109], v226, s[24:27], s84 offen sc1
  s_add_u32 s84, s84, 262144
  v_mfma_f32_16x16x32_bf16 v[52:55], a[160:163], a[92:95], v[52:55]
  v_mfma_f32_16x16x32_bf16 v[56:59], a[164:167], a[88:91], v[56:59]
  v_mfma_f32_16x16x32_bf16 v[60:63], a[164:167], a[92:95], v[60:63]
  v_cvt_pk_bf16_f32 v0, v0, v1
  v_cvt_pk_bf16_f32 v1, v2, v3
  v_cvt_pk_bf16_f32 v2, v4, v5
  v_cvt_pk_bf16_f32 v3, v6, v7
  buffer_store_dwordx4 v[0:3], v226, s[24:27], s48 offen sc1
  v_cvt_pk_bf16_f32 v8, v8, v9
  v_cvt_pk_bf16_f32 v9, v10, v11
  v_cvt_pk_bf16_f32 v10, v12, v13
  v_cvt_pk_bf16_f32 v11, v14, v15
  buffer_store_dwordx4 v[8:11], v226, s[24:27], s48 offen offset:1024 sc1
  v_cvt_pk_bf16_f32 v16, v16, v17
  v_cvt_pk_bf16_f32 v17, v18, v19
  v_cvt_pk_bf16_f32 v18, v20, v21
  v_cvt_pk_bf16_f32 v19, v22, v23
  buffer_store_dwordx4 v[16:19], v226, s[24:27], s48 offen offset:2048 sc1
  v_cvt_pk_bf16_f32 v24, v24, v25
  v_cvt_pk_bf16_f32 v25, v26, v27
  v_cvt_pk_bf16_f32 v26, v28, v29
  v_cvt_pk_bf16_f32 v27, v30, v31
  buffer_store_dwordx4 v[24:27], v226, s[24:27], s48 offen offset:3072 sc1
  s_add_u32 s48, s48, 4096
  v_cvt_pk_bf16_f32 v32, v32, v33
  v_cvt_pk_bf16_f32 v33, v34, v35
  v_cvt_pk_bf16_f32 v34, v36, v37
  v_cvt_pk_bf16_f32 v35, v38, v39
  buffer_store_dwordx4 v[32:35], v226, s[24:27], s48 offen sc1
  v_cvt_pk_bf16_f32 v40, v40, v41
  v_cvt_pk_bf16_f32 v41, v42, v43
  v_cvt_pk_bf16_f32 v42, v44, v45
  v_cvt_pk_bf16_f32 v43, v46, v47
  buffer_store_dwordx4 v[40:43], v226, s[24:27], s48 offen offset:1024 sc1
  v_cvt_pk_bf16_f32 v48, v48, v49
  v_cvt_pk_bf16_f32 v49, v50, v51
  v_cvt_pk_bf16_f32 v50, v52, v53
  v_cvt_pk_bf16_f32 v51, v54, v55
  buffer_store_dwordx4 v[48:51], v226, s[24:27], s48 offen offset:2048 sc1
  v_cvt_pk_bf16_f32 v56, v56, v57
  v_cvt_pk_bf16_f32 v57, v58, v59
  v_cvt_pk_bf16_f32 v58, v60, v61
  v_cvt_pk_bf16_f32 v59, v62, v63
  buffer_store_dwordx4 v[56:59], v226, s[24:27], s48 offen offset:3072 sc1
  s_add_u32 s48, s48, 4096
  buffer_load_dwordx2 a[110:111], v226, s[24:27], s84 offen sc1
  v_lshlrev_b32 v176, 16, v228
  v_and_b32 v177, 0xffff0000, v228
  v_lshlrev_b32 v178, 16, v232
  v_and_b32 v179, 0xffff0000, v232
  v_mul_f32 v176, v176, v178
  v_mul_f32 v177, v177, v179
  v_cvt_pk_bf16_f32 v176, v176, v177
  v_and_b32 v177, 0xffff0000, v176
  v_lshlrev_b32 v176, 16, v176
  v_mul_f32 v152, v222, v176
  v_mul_f32 v153, v222, v177
  v_lshlrev_b32 v176, 16, v229
  v_and_b32 v177, 0xffff0000, v229
  v_lshlrev_b32 v178, 16, v233
  v_and_b32 v179, 0xffff0000, v233
  v_mul_f32 v176, v176, v178
  v_mul_f32 v177, v177, v179
  v_cvt_pk_bf16_f32 v176, v176, v177
  v_and_b32 v177, 0xffff0000, v176
  v_lshlrev_b32 v176, 16, v176
  v_mul_f32 v154, v222, v176
  v_mul_f32 v155, v222, v177
  v_lshlrev_b32 v176, 16, v230
  v_and_b32 v177, 0xffff0000, v230
  v_lshlrev_b32 v178, 16, v232
  v_and_b32 v179, 0xffff0000, v232
  v_mul_f32 v176, v176, v178
  v_mul_f32 v177, v177, v179
  v_cvt_pk_bf16_f32 v176, v176, v177
  v_and_b32 v177, 0xffff0000, v176
  v_lshlrev_b32 v176, 16, v176
  v_mul_f32 v156, v223, v176
  v_mul_f32 v157, v223, v177
  v_lshlrev_b32 v176, 16, v231
  v_and_b32 v177, 0xffff0000, v231
  v_lshlrev_b32 v178, 16, v233
  v_and_b32 v179, 0xffff0000, v233
  v_mul_f32 v176, v176, v178
  v_mul_f32 v177, v177, v179
  v_cvt_pk_bf16_f32 v176, v176, v177
  v_and_b32 v177, 0xffff0000, v176
  v_lshlrev_b32 v176, 16, v176
  v_mul_f32 v158, v223, v176
  v_mul_f32 v159, v223, v177
  v_lshlrev_b32 v176, 16, v234
  v_and_b32 v177, 0xffff0000, v234
  v_lshlrev_b32 v178, 16, v238
  v_and_b32 v179, 0xffff0000, v238
  v_mul_f32 v176, v176, v178
  v_mul_f32 v177, v177, v179
  v_cvt_pk_bf16_f32 v176, v176, v177
  v_and_b32 v177, 0xffff0000, v176
  v_lshlrev_b32 v176, 16, v176
  v_mul_f32 v168, v222, v176
  v_mul_f32 v169, v222, v177
  v_lshlrev_b32 v176, 16, v235
  v_and_b32 v177, 0xffff0000, v235
  v_lshlrev_b32 v178, 16, v239
  v_and_b32 v179, 0xffff0000, v239
  v_mul_f32 v176, v176, v178
  v_mul_f32 v177, v177, v179
  v_cvt_pk_bf16_f32 v176, v176, v177
  v_and_b32 v177, 0xffff0000, v176
  v_lshlrev_b32 v176, 16, v176
  v_mul_f32 v170, v222, v176
  v_mul_f32 v171, v222, v177
  v_lshlrev_b32 v176, 16, v236
  v_and_b32 v177, 0xffff0000, v236
  v_lshlrev_b32 v178, 16, v238
  v_and_b32 v179, 0xffff0000, v238
  v_mul_f32 v176, v176, v178
  v_mul_f32 v177, v177, v179
  v_cvt_pk_bf16_f32 v176, v176, v177
  v_and_b32 v177, 0xffff0000, v176
  v_lshlrev_b32 v176, 16, v176
  v_mul_f32 v172, v223, v176
  v_mul_f32 v173, v223, v177
  v_lshlrev_b32 v176, 16, v237
  v_and_b32 v177, 0xffff0000, v237
  v_lshlrev_b32 v178, 16, v239
  v_and_b32 v179, 0xffff0000, v239
  v_mul_f32 v176, v176, v178
  v_mul_f32 v177, v177, v179
  v_cvt_pk_bf16_f32 v176, v176, v177
  v_and_b32 v177, 0xffff0000, v176
  v_lshlrev_b32 v176, 16, v176
  v_mul_f32 v174, v223, v176
  v_mul_f32 v175, v223, v177
  v_lshrrev_b32 v229, 2, v219
  v_xor_b32 v231, v229, v220
  v_and_b32 v229, 1, v219
  v_lshlrev_b32 v229, 4, v229
  v_mov_b32 v230, 0x3f80
  v_lshlrev_b32 v229, v229, v230
  v_cmp_eq_u32 vcc, 0, v231
  s_nop 1
  v_cndmask_b32 v229, 0, v229, vcc
  v_and_b32 v228, 2, v219
  v_cmp_eq_u32 vcc, 0, v228
  s_nop 1
  v_cndmask_b32 v228, 0, v229, vcc
  v_cndmask_b32 v229, v229, 0, vcc
  v_mov_b32 v230, 0
  v_accvgpr_write_b32 a112, v228
  v_accvgpr_write_b32 a114, v228
  v_accvgpr_write_b32 a116, v228
  v_accvgpr_write_b32 a122, v228
  v_accvgpr_write_b32 a113, v229
  v_accvgpr_write_b32 a115, v229
  v_accvgpr_write_b32 a117, v229
  v_accvgpr_write_b32 a123, v229
  v_accvgpr_write_b32 a118, v230
  v_accvgpr_write_b32 a119, v230
  v_accvgpr_write_b32 a120, v230
  v_accvgpr_write_b32 a121, v230
  s_waitcnt vmcnt(17)
  s_barrier
  v_mov_b32 v189, 6
  buffer_store_dword v189, v187, s[24:27], 0 offen sc1
  s_waitcnt vmcnt(1)
  s_cmp_eq_u32 s88, 1
  s_cbranch_scc0 L_slow_M0
L_back_M0:
  s_cmp_lt_u32 s40, 2
  s_cselect_b32 s49, 1.0, 0
  v_mul_f32 v181, s49, v181
  v_lshlrev_b32 v176, 16, v240
  v_and_b32 v177, 0xffff0000, v240
  v_lshlrev_b32 v178, 16, v242
  v_and_b32 v179, 0xffff0000, v242
  v_mul_f32 v176, v176, v178
  v_mul_f32 v177, v177, v179
  v_cvt_pk_bf16_f32 v176, v176, v177
  v_and_b32 v177, 0xffff0000, v176
  v_lshlrev_b32 v176, 16, v176
  v_mul_f32 v140, v181, v176
  v_mul_f32 v141, v181, v177
  v_lshlrev_b32 v176, 16, v241
  v_and_b32 v177, 0xffff0000, v241
  v_lshlrev_b32 v178, 16, v243
  v_and_b32 v179, 0xffff0000, v243
  v_mul_f32 v176, v176, v178
  v_mul_f32 v177, v177, v179
  v_cvt_pk_bf16_f32 v176, v176, v177
  v_and_b32 v177, 0xffff0000, v176
  v_lshlrev_b32 v176, 16, v176
  v_mul_f32 v142, v181, v176
  v_mul_f32 v143, v181, v177
  s_nop 1
  v_mfma_f32_16x16x32_bf16 v[140:143], a[112:115], a[96:99], v[140:143]
  v_mfma_f32_16x16x32_bf16 v[140:143], a[112:115], a[100:103], v[140:143]
  v_mfma_f32_16x16x32_bf16 v[140:143], a[112:115], a[104:107], v[140:143]
  v_mfma_f32_16x16x32_bf16 v[140:143], a[112:115], a[108:111], v[140:143]
  s_and_b32 s49, s40, 1
  s_lshl_b32 s49, s49, 10
  v_add_u32 v240, s49, v226
  s_cmp_ge_u32 s40, 2
  s_cselect_b32 s50, 0, 2048
  v_add_u32 v241, s50, v240
  s_nop 1
  ds_write_b128 v241, v[140:143]
  buffer_load_dword v218, v217, s[24:27], 0 offen sc1
  s_waitcnt lgkmcnt(0)
  s_barrier
  v_mov_b32 v189, 7
  buffer_store_dword v189, v187, s[24:27], 0 offen sc1
  ds_read_b128 v[180:183], v240
  s_waitcnt vmcnt(1)
  v_cmp_le_u32 vcc, 6, v218
  s_nop 3
  s_or_b64 vcc, vcc, s[58:59]
  s_cmp_eq_u64 vcc, -1
  s_cbranch_scc0 L_slow_PA0
L_back_PA0:
  s_add_u32 s84, s86, 0
  buffer_load_dwordx4 v[32:35], v226, s[24:27], s84 offen sc1
  s_add_u32 s84, s84, 2097152
  buffer_load_dwordx4 v[36:39], v226, s[24:27], s84 offen sc1
  s_add_u32 s84, s84, 2097152
  buffer_load_dwordx4 v[40:43], v226, s[24:27], s84 offen sc1
  s_add_u32 s84, s84, 2097152
  buffer_load_dwordx4 v[44:47], v226, s[24:27], s84 offen sc1
  s_add_u32 s84, s84, 2097152
  buffer_load_dwordx4 v[48:51], v226, s[24:27], s84 offen sc1
  s_add_u32 s84, s84, 2097152
  buffer_load_dwordx4 v[52:55], v226, s[24:27], s84 offen sc1
  s_add_u32 s84, s84, 2097152
  buffer_load_dwordx4 v[56:59], v226, s[24:27], s84 offen sc1
  s_add_u32 s84, s84, 2097152
  buffer_load_dwordx4 v[60:63], v226, s[24:27], s84 offen sc1
  buffer_load_dword v218, v217, s[24:27], 0 offen sc1
  s_waitcnt lgkmcnt(0)
  v_add_f32 v140, v140, v180
  v_add_f32 v141, v141, v181
  v_add_f32 v142, v142, v182
  v_add_f32 v143, v143, v183
  s_cmp_lt_u32 s40, 2
  s_cselect_b32 s49, 0, 0x7ff00000
  buffer_store_dwordx4 v[140:143], v139, s[36:39], s49 offen nt
  s_waitcnt vmcnt(9)
  v_mfma_f32_16x16x32_bf16 v[152:155], a[116:119], v[32:35], v[152:155]
  v_mfma_f32_16x16x32_bf16 v[156:159], a[120:123], v[32:35], v[156:159]
  s_waitcnt vmcnt(8)
  v_mfma_f32_16x16x32_bf16 v[152:155], a[116:119], v[36:39], v[152:155]
  v_mfma_f32_16x16x32_bf16 v[156:159], a[120:123], v[36:39], v[156:159]
  s_waitcnt vmcnt(7)
  v_mfma_f32_16x16x32_bf16 v[152:155], a[116:119], v[40:43], v[152:155]
  v_mfma_f32_16x16x32_bf16 v[156:159], a[120:123], v[40:43], v[156:159]
  s_waitcnt vmcnt(6)
  v_mfma_f32_16x16x32_bf16 v[152:155], a[116:119], v[44:47], v[152:155]
  v_mfma_f32_16x16x32_bf16 v[156:159], a[120:123], v[44:47], v[156:159]
  s_waitcnt vmcnt(5)
  v_mfma_f32_16x16x32_bf16 v[152:155], a[116:119], v[48:51], v[152:155]
  v_mfma_f32_16x16x32_bf16 v[156:159], a[120:123], v[48:51], v[156:159]
  s_waitcnt vmcnt(4)
  v_mfma_f32_16x16x32_bf16 v[152:155], a[116:119], v[52:55], v[152:155]
  v_mfma_f32_16x16x32_bf16 v[156:159], a[120:123], v[52:55], v[156:159]
  s_waitcnt vmcnt(3)
  v_mfma_f32_16x16x32_bf16 v[152:155], a[116:119], v[56:59], v[152:155]
  v_mfma_f32_16x16x32_bf16 v[156:159], a[120:123], v[56:59], v[156:159]
  s_waitcnt vmcnt(2)
  v_mfma_f32_16x16x32_bf16 v[152:155], a[116:119], v[60:63], v[152:155]
  v_mfma_f32_16x16x32_bf16 v[156:159], a[120:123], v[60:63], v[156:159]
  s_mov_b32 s49, 0
  s_mov_b32 s50, 36864
  s_nop 4
  buffer_store_dwordx4 v[152:155], v136, s[36:39], s49 offen nt
  buffer_store_dwordx4 v[156:159], v136, s[36:39], s50 offen nt
  s_waitcnt vmcnt(3)
  v_cmp_le_u32 vcc, 7, v218
  s_nop 3
  s_or_b64 vcc, vcc, s[58:59]
  s_cmp_eq_u64 vcc, -1
  s_cbranch_scc0 L_slow_PB0
L_back_PB0:
  s_add_u32 s84, s86, 8192
  buffer_load_dwordx4 v[64:67], v226, s[24:27], s84 offen sc1
  s_add_u32 s84, s84, 2097152
  buffer_load_dwordx4 v[68:71], v226, s[24:27], s84 offen sc1
  s_add_u32 s84, s84, 2097152
  buffer_load_dwordx4 v[72:75], v226, s[24:27], s84 offen sc1
  s_add_u32 s84, s84, 2097152
  buffer_load_dwordx4 v[76:79], v226, s[24:27], s84 offen sc1
  s_add_u32 s84, s84, 2097152
  buffer_load_dwordx4 v[80:83], v226, s[24:27], s84 offen sc1
  s_add_u32 s84, s84, 2097152
  buffer_load_dwordx4 v[84:87], v226, s[24:27], s84 offen sc1
  s_add_u32 s84, s84, 2097152
  buffer_load_dwordx4 v[88:91], v226, s[24:27], s84 offen sc1
  s_add_u32 s84, s84, 2097152
  buffer_load_dwordx4 v[92:95], v226, s[24:27], s84 offen sc1
  s_waitcnt vmcnt(7)
  v_mfma_f32_16x16x32_bf16 v[168:171], a[116:119], v[64:67], v[168:171]
  v_mfma_f32_16x16x32_bf16 v[172:175], a[120:123], v[64:67], v[172:175]
  s_waitcnt vmcnt(6)
  v_mfma_f32_16x16x32_bf16 v[168:171], a[116:119], v[68:71], v[168:171]
  v_mfma_f32_16x16x32_bf16 v[172:175], a[120:123], v[68:71], v[172:175]
  s_waitcnt vmcnt(5)
  v_mfma_f32_16x16x32_bf16 v[168:171], a[116:119], v[72:75], v[168:171]
  v_mfma_f32_16x16x32_bf16 v[172:175], a[120:123], v[72:75], v[172:175]
  s_waitcnt vmcnt(4)
  v_mfma_f32_16x16x32_bf16 v[168:171], a[116:119], v[76:79], v[168:171]
  v_mfma_f32_16x16x32_bf16 v[172:175], a[120:123], v[76:79], v[172:175]
  s_waitcnt vmcnt(3)
  v_mfma_f32_16x16x32_bf16 v[168:171], a[116:119], v[80:83], v[168:171]
  v_mfma_f32_16x16x32_bf16 v[172:175], a[120:123], v[80:83], v[172:175]
  s_waitcnt vmcnt(2)
  v_mfma_f32_16x16x32_bf16 v[168:171], a[116:119], v[84:87], v[168:171]
  v_mfma_f32_16x16x32_bf16 v[172:175], a[120:123], v[84:87], v[172:175]
  s_waitcnt vmcnt(1)
  v_mfma_f32_16x16x32_bf16 v[168:171], a[116:119], v[88:91], v[168:171]
  v_mfma_f32_16x16x32_bf16 v[172:175], a[120:123], v[88:91], v[172:175]
  s_waitcnt vmcnt(0)
  v_mfma_f32_16x16x32_bf16 v[168:171], a[116:119], v[92:95], v[168:171]
  v_mfma_f32_16x16x32_bf16 v[172:175], a[120:123], v[92:95], v[172:175]
  s_mov_b32 s49, 512
  s_mov_b32 s50, 37376
  s_nop 4
  buffer_store_dwordx4 v[168:171], v136, s[36:39], s49 offen nt
  buffer_store_dwordx4 v[172:175], v136, s[36:39], s50 offen nt
  s_endpgm
L_slow_C0:
  s_mov_b32 s51, 0
L_slowl_C0:
  s_sleep 1
  buffer_load_ubyte v249, v248, s[32:35], 0 offen sc1
  s_waitcnt vmcnt(0)
  v_cmp_ne_u32 vcc, 0, v249
  s_nop 4
  s_or_b32 vcc_hi, vcc_hi, -1
  s_cmp_eq_u64 vcc, -1
  s_cbranch_scc1 L_back_C0
  s_add_u32 s51, s51, 1
  s_cmp_lt_u32 s51, 0x40000
  s_cbranch_scc1 L_slowl_C0
  s_branch L_back_C0
L_slow_S0:
  s_mov_b32 s51, 0
L_slowl_S0:
  s_sleep 1
  buffer_load_dword v249, v248, s[24:27], 0 offen sc1
  s_waitcnt vmcnt(0)
  v_cmp_ne_u32 vcc, 0, v249
  s_nop 4
  s_or_b64 vcc, vcc, s[56:57]
  s_cmp_eq_u64 vcc, -1
  s_cbranch_scc1 L_back_S0
  s_add_u32 s51, s51, 1
  s_cmp_lt_u32 s51, 0x40000
  s_cbranch_scc1 L_slowl_S0
  s_branch L_back_S0
L_slow_A0:
  s_mov_b32 s75, 0
L_slowl_A0:
  s_sleep 1
  buffer_load_dword v202, v188, s[24:27], 0 offen sc1
  s_waitcnt vmcnt(0)
  v_cmp_le_u32 vcc, 2, v202
  s_nop 4
  s_cmp_eq_u64 vcc, -1
  s_cbranch_scc1 L_back_A0
  s_add_u32 s75, s75, 1
  s_cmp_lt_u32 s75, 0x40000
  s_cbranch_scc1 L_slowl_A0
  s_branch L_back_A0
L_slow_B0:
  s_mov_b32 s75, 0
L_slowl_B0:
  s_sleep 1
  buffer_load_dword v202, v188, s[24:27], 0 offen sc1
  s_waitcnt vmcnt(0)
  v_cmp_le_u32 vcc, 3, v202
  s_nop 4
  s_cmp_eq_u64 vcc, -1
  s_cbranch_scc1 L_back_B0
  s_add_u32 s75, s75, 1
  s_cmp_lt_u32 s75, 0x40000
  s_cbranch_scc1 L_slowl_B0
  s_branch L_back_B0
L_slow_D0:
  s_mov_b32 s75, 0
L_slowl_D0:
  s_sleep 1
  buffer_load_dword v202, v188, s[24:27], 0 offen sc1
  s_waitcnt vmcnt(0)
  v_cmp_le_u32 vcc, 4, v202
  s_nop 4
  s_cmp_eq_u64 vcc, -1
  s_cbranch_scc1 L_back_D0
  s_add_u32 s75, s75, 1
  s_cmp_lt_u32 s75, 0x40000
  s_cbranch_scc1 L_slowl_D0
  s_branch L_back_D0
L_slow_M0:
  s_mov_b32 s51, 0
L_slowl_M0:
  buffer_load_dword v218, v217, s[24:27], 0 offen sc1
  s_waitcnt vmcnt(0)
  v_cmp_le_u32 vcc, 5, v218
  s_nop 4
  s_or_b64 vcc, vcc, s[56:57]
  s_cmp_eq_u64 vcc, -1
  s_cbranch_scc1 L_slowd_M0
  s_add_u32 s51, s51, 1
  s_cmp_lt_u32 s51, 0x40000
  s_cbranch_scc1 L_slowl_M0
L_slowd_M0:
  s_mov_b32 s84, s89
  s_mov_b32 s49, 46235648
  buffer_load_dword v181, v180, s[24:27], s49 offen sc1
  buffer_load_dwordx2 a[96:97], v226, s[24:27], s84 offen sc1
  s_add_u32 s84, s84, 262144
  buffer_load_dwordx2 a[98:99], v226, s[24:27], s84 offen sc1
  s_add_u32 s84, s84, 262144
  buffer_load_dwordx2 a[100:101], v226, s[24:27], s84 offen sc1
  s_add_u32 s84, s84, 262144
  buffer_load_dwordx2 a[102:103], v226, s[24:27], s84 offen sc1
  s_add_u32 s84, s84, 262144
  buffer_load_dwordx2 a[104:105], v226, s[24:27], s84 offen sc1
  s_add_u32 s84, s84, 262144
  buffer_load_dwordx2 a[106:107], v226, s[24:27], s84 offen sc1
  s_add_u32 s84, s84, 262144
  buffer_load_dwordx2 a[108:109], v226, s[24:27], s84 offen sc1
  s_add_u32 s84, s84, 262144
  buffer_load_dwordx2 a[110:111], v226, s[24:27], s84 offen sc1
  buffer_load_dword v218, v217, s[24:27], 0 offen sc1
  s_waitcnt vmcnt(0)
  s_branch L_back_M0
L_slow_PA0:
  s_mov_b32 s51, 0
L_slowl_PA0:
  buffer_load_dword v218, v217, s[24:27], 0 offen sc1
  s_waitcnt vmcnt(0)
  v_cmp_le_u32 vcc, 6, v218
  s_nop 4
  s_or_b64 vcc, vcc, s[58:59]
  s_cmp_eq_u64 vcc, -1
  s_cbranch_scc1 L_slowd_PA0
  s_add_u32 s51, s51, 1
  s_cmp_lt_u32 s51, 0x40000
  s_cbranch_scc1 L_slowl_PA0
L_slowd_PA0:
  s_waitcnt vmcnt(0)
  s_branch L_back_PA0
L_slow_PB0:
  s_mov_b32 s51, 0
L_slowl_PB0:
  buffer_load_dword v218, v217, s[24:27], 0 offen sc1
  s_waitcnt vmcnt(0)
  v_cmp_le_u32 vcc, 7, v218
  s_nop 4
  s_or_b64 vcc, vcc, s[58:59]
  s_cmp_eq_u64 vcc, -1
  s_cbranch_scc1 L_slowd_PB0
  s_add_u32 s51, s51, 1
  s_cmp_lt_u32 s51, 0x40000
  s_cbranch_scc1 L_slowl_PB0
L_slowd_PB0:
  s_waitcnt vmcnt(0)
  s_branch L_back_PB0
L_end0:
.p2align 6
L_var1:
  s_mul_i32 s43, s42, 9
  s_lshr_b32 s43, s43, 1
  s_lshl_b32 s43, s43, 3
  s_mul_i32 s46, s40, 6144
  s_mul_i32 s47, s40, 3072
  v_lshrrev_b32 v203, 4, v225
  v_and_b32 v10, 7, v225
  v_xor_b32 v203, v203, v10
  v_lshlrev_b32 v203, 4, v203
  v_lshrrev_b32 v10, 3, v225
  v_mul_u32_u24 v10, 1152, v10
  v_xor_b32 v204, 64, v203
  v_add_u32 v203, v203, v10
  v_add_u32 v204, v204, v10
  v_add_u32 v204, 8192, v204
  v_add_u32 v205, 16384, v203
  v_add_u32 v206, 16384, v204
  v_add_u32 v207, 36864, v203
  v_add_u32 v208, 36864, v204
  s_and_b32 s55, s40, 1
  s_mul_i32 s44, s43, 1152
  s_lshl_b32 s49, s55, 7
  s_add_u32 s44, s44, s49
  s_lshl_b32 s49, s41, 7
  s_lshl_b32 s50, s40, 5
  s_add_u32 s49, s49, s50
  s_mul_i32 s98, s49, 1152
  s_lshl_b32 s99, s40, 12
  s_add_u32 s99, s99, 49152
  s_waitcnt lgkmcnt(0)
  s_mov_b32 s4, s64
  s_mov_b32 s5, s65
  s_mov_b32 s6, 2359296
  s_mov_b32 s7, 0x20000
  s_cmp_lt_u32 s40, 2
  s_cselect_b32 s16, s70, s72
  s_cselect_b32 s17, s71, s73
  s_mov_b32 s18, 663552
  s_mov_b32 s19, 0x20000
  s_add_u32 m0, s46, 0
  s_nop 0
  buffer_load_dwordx4 v203, s[16:19], s44 offen lds
  v_and_b32 v14, 15, v225
  v_lshrrev_b32 v15, 1, v14
  v_lshlrev_b32 v14, 7, v14
  v_lshrrev_b32 v196, 4, v225
  v_add_u32 v196, 0, v196
  v_xor_b32 v196, v196, v15
  v_lshlrev_b32 v196, 4, v196
  v_add_u32 v196, v196, v14
  v_add_u32 v198, 49152, v196
  v_add_u32 v200, 98304, v196
  v_lshrrev_b32 v197, 4, v225
  v_add_u32 v197, 4, v197
  buffer_load_dwordx4 v204, s[16:19], s44 offen offset:1024 lds
  v_xor_b32 v197, v197, v15
  v_lshlrev_b32 v197, 4, v197
  v_add_u32 v197, v197, v14
  v_add_u32 v199, 49152, v197
  v_add_u32 v201, 98304, v197
  v_add_u32 v252, s99, v196
  v_add_u32 v253, s99, v197
  v_add_u32 v66, 49152, v252
  v_add_u32 v67, 49152, v253
  v_lshrrev_b32 v3, 4, v225
  v_lshlrev_b32 v202, 4, v3
  v_add_u32 v202, s47, v202
  buffer_load_dwordx4 v205, s[16:19], s44 offen offset:2048 lds
  v_add_u32 v202, 147456, v202
  v_lshrrev_b32 v209, 5, v225
  v_lshlrev_b32 v209, 1, v209
  v_and_b32 v14, 3, v225
  v_xor_b32 v209, v209, v14
  v_lshlrev_b32 v209, 4, v209
  v_lshrrev_b32 v14, 2, v225
  v_mul_u32_u24 v14, 9216, v14
  v_add_u32 v209, v209, v14
  v_add_u32 v210, 146432, v209
  v_add_u32 v211, 292864, v209
  v_add_u32 v212, 439296, v209
  buffer_load_dwordx4 v206, s[16:19], s44 offen offset:3072 lds
  v_add_u32 v213, 589824, v209
  v_add_u32 v214, 736256, v209
  v_lshrrev_b32 v14, 4, v225
  v_lshlrev_b32 v14, 3, v14
  v_bfe_u32 v15, v225, 2, 2
  v_add_u32 v14, v14, v15
  v_lshlrev_b32 v14, 6, v14
  v_and_b32 v15, 3, v225
  v_lshlrev_b32 v15, 3, v15
  v_add_u32 v14, v14, v15
  v_bfe_u32 v15, v225, 4, 1
  v_xor_b32 v184, 0, v15
  s_add_u32 m0, s46, 4096
  s_nop 0
  buffer_load_dwordx4 v207, s[16:19], s44 offen lds
  v_lshlrev_b32 v184, 5, v184
  v_add_u32 v184, v184, v14
  v_add_u32 v186, 49152, v184
  v_add_u32 v188, 98304, v184
  v_xor_b32 v185, 1, v15
  v_lshlrev_b32 v185, 5, v185
  v_add_u32 v185, v185, v14
  v_add_u32 v187, 49152, v185
  v_add_u32 v189, 98304, v185
  s_mul_i32 s49, s42, 576
  s_mul_i32 s50, s55, 442368
  s_add_u32 s64, s49, s50
  buffer_load_dwordx4 v208, s[16:19], s44 offen offset:1024 lds
  s_add_u32 s64, s64, 64
  s_mul_i32 s50, s55, 884736
  s_add_u32 s65, s49, s50
  s_add_u32 s65, s65, 0
  s_cmp_lt_u32 s40, 2
  s_cselect_b32 s20, s74, s76
  s_cselect_b32 s21, s75, s77
  s_mov_b32 s22, 663552
  s_mov_b32 s23, 0x20000
  s_mov_b32 s12, s88
  s_mov_b32 s13, s89
  s_mov_b32 s14, 5308416
  s_add_u32 s45, s98, 0
  s_add_u32 m0, s99, 0
  s_nop 0
  buffer_load_dwordx4 v203, s[4:7], s45 offen lds
  s_mov_b32 s15, 0x20000
  s_mov_b32 s24, s96
  s_mov_b32 s25, s97
  s_mov_b32 s26, 46276608
  s_mov_b32 s27, 0x20000
  s_mul_i32 s49, s42, 6144
  s_add_u32 s49, s49, 46137344
  s_add_u32 s28, s96, s49
  s_addc_u32 s29, s97, 0
  s_mov_b32 s30, 6144
  s_mov_b32 s31, 0x20000
  s_mov_b32 s32, s94
  buffer_load_dwordx4 v204, s[4:7], s45 offen offset:1024 lds
  s_mov_b32 s33, s95
  s_mov_b32 s34, 256
  s_mov_b32 s35, 0x20000
  buffer_load_dwordx4 v205, s[4:7], s45 offen offset:2048 lds
  buffer_load_dwordx4 v206, s[4:7], s45 offen offset:3072 lds
  s_add_u32 s45, s98, 128
  s_add_u32 m0, s99, 16384
  s_nop 0
  buffer_load_dwordx4 v203, s[4:7], s45 offen lds
  buffer_load_dwordx4 v204, s[4:7], s45 offen offset:1024 lds
  buffer_load_dwordx4 v205, s[4:7], s45 offen offset:2048 lds
  buffer_load_dwordx4 v206, s[4:7], s45 offen offset:3072 lds
  v_lshlrev_b32 v226, 4, v225
  v_min_u32 v8, 47, v225
  v_lshlrev_b32 v227, 3, v8
  v_add_u32 v9, s43, v8
  v_lshlrev_b32 v9, 1, v9
  s_mov_b32 s36, s66
  s_mov_b32 s37, s67
  s_mov_b32 s38, 1152
  s_mov_b32 s39, 0x20000
  buffer_load_ushort v228, v9, s[36:39], 0 offen
  s_mov_b32 s56, s68
  s_mov_b32 s57, s69
  s_mov_b32 s58, 1152
  s_mov_b32 s59, 0x20000
  buffer_load_ushort v229, v9, s[56:59], 0 offen
  s_mov_b32 s60, s78
  s_mov_b32 s61, s79
  s_mov_b32 s62, 1152
  s_mov_b32 s63, 0x20000
  buffer_load_ushort v230, v9, s[60:63], 0 offen
  s_mov_b32 s36, s90
  s_mov_b32 s37, s91
  s_mov_b32 s38, 1152
  s_mov_b32 s39, 0x20000
  s_add_u32 m0, s47, 147456
  s_nop 0
  buffer_load_dwordx4 v226, s[36:39], 0 offen lds
  buffer_load_dwordx4 v226, s[36:39], 0 offen offset:1024 lds
  s_add_u32 s45, s98, 256
  s_add_u32 m0, s99, 32768
  s_nop 0
  buffer_load_dwordx4 v203, s[4:7], s45 offen lds
  buffer_load_dwordx4 v204, s[4:7], s45 offen offset:1024 lds
  buffer_load_dwordx4 v205, s[4:7], s45 offen offset:2048 lds
  buffer_load_dwordx4 v206, s[4:7], s45 offen offset:3072 lds
  s_add_u32 s45, s98, 384
  s_add_u32 m0, s99, 49152
  s_nop 0
  buffer_load_dwordx4 v203, s[4:7], s45 offen lds
  buffer_load_dwordx4 v204, s[4:7], s45 offen offset:1024 lds
  buffer_load_dwordx4 v205, s[4:7], s45 offen offset:2048 lds
  buffer_load_dwordx4 v206, s[4:7], s45 offen offset:3072 lds
  s_add_u32 s44, s44, 256
  s_add_u32 m0, s46, 24576
  s_nop 0
  buffer_load_dwordx4 v203, s[16:19], s44 offen lds
  buffer_load_dwordx4 v204, s[16:19], s44 offen offset:1024 lds
  buffer_load_dwordx4 v205, s[16:19], s44 offen offset:2048 lds
  buffer_load_dwordx4 v206, s[16:19], s44 offen offset:3072 lds
  s_add_u32 m0, s46, 28672
  s_nop 0
  buffer_load_dwordx4 v207, s[16:19], s44 offen lds
  buffer_load_dwordx4 v208, s[16:19], s44 offen offset:1024 lds
  s_add_u32 s45, s98, 512
  s_add_u32 m0, s99, 65536
  s_nop 0
  buffer_load_dwordx4 v203, s[4:7], s45 offen lds
  buffer_load_dwordx4 v204, s[4:7], s45 offen offset:1024 lds
  buffer_load_dwordx4 v205, s[4:7], s45 offen offset:2048 lds
  buffer_load_dwordx4 v206, s[4:7], s45 offen offset:3072 lds
  s_add_u32 s45, s98, 640
  s_add_u32 m0, s99, 81920
  s_nop 0
  buffer_load_dwordx4 v203, s[4:7], s45 offen lds
  buffer_load_dwordx4 v204, s[4:7], s45 offen offset:1024 lds
  buffer_load_dwordx4 v205, s[4:7], s45 offen offset:2048 lds
  buffer_load_dwordx4 v206, s[4:7], s45 offen offset:3072 lds
  s_cmp_lt_u32 s40, 2
  s_cselect_b32 s8, s84, s86
  s_cselect_b32 s9, s85, s87
  s_mov_b32 s10, 5308416
  s_mov_b32 s11, 0x20000
  s_getpc_b64 s[100:101]
L_pc1:
  s_lshl_b32 s49, s41, 2
  s_add_u32 s49, s49, s40
  s_mul_i32 s49, s49, 1152
  v_lshlrev_b32 v12, 7, v225
  v_add_u32 v12, s49, v12
  v_min_u32 v12, CODE_SPAN1, v12
  v_cmp_gt_u32 vcc, 9, v225
  s_nop 3
  s_and_saveexec_b64 s[62:63], vcc
  global_load_dword a247, v12, s[100:101]
  s_mov_b64 exec, s[62:63]
  s_lshl_b32 s70, s41, 1
  s_add_u32 s70, s70, s55
  s_mul_i32 s100, s70, 1792
  s_mul_i32 s49, s43, 1152
  s_add_u32 s100, s100, s49
  v_lshlrev_b32 v12, 7, v225
  v_mov_b32 v13, 0x7ffffff0
  v_cmp_gt_u32 vcc, 14, v225
  s_nop 1
  v_cndmask_b32 v12, v13, v12, vcc
  buffer_load_dword a248, v12, s[16:19], s100 offen sc1
  v_mul_u32_u24 v12, 57, v225
  v_lshrrev_b32 v12, 10, v12
  v_mul_u32_u24 v13, 18, v12
  v_sub_u32 v13, v225, v13
  v_mul_u32_u24 v13, 9216, v13
  v_mul_i32_i24 v12, 64, v12
  v_add_u32 v12, 0, v12
  v_add_u32 v12, v12, v13
  v_mov_b32 v13, 0x7ffffff0
  v_cmp_gt_u32 vcc, 36, v225
  s_nop 1
  v_cndmask_b32 v12, v13, v12, vcc
  s_mul_i32 s100, s70, 165888
  s_mul_i32 s49, s42, 576
  s_add_u32 s100, s100, s49
  buffer_load_dword a251, v12, s[8:11], s100 offen sc1
  s_waitcnt vmcnt(34)
  ds_read_b128 a[0:3], v252 offset:0
  ds_read_b128 a[4:7], v252 offset:2048
  ds_read_b128 a[8:11], v253 offset:0
  ds_read_b128 a[12:15], v253 offset:2048
  s_waitcnt vmcnt(30)
  ds_read_b128 a[16:19], v252 offset:16384
  ds_read_b128 a[20:23], v252 offset:18432
  ds_read_b128 a[24:27], v253 offset:16384
  ds_read_b128 a[28:31], v253 offset:18432
  s_waitcnt vmcnt(25) lgkmcnt(0)
  s_barrier
  ds_read_b128 a[144:147], v196
  ds_read_b128 a[148:151], v196 offset:12288
  ds_read_b128 a[152:155], v196 offset:2048
  ds_read_b128 a[156:159], v196 offset:14336
  ds_read_b128 a[160:163], v196 offset:4096
  ds_read_b128 a[164:167], v196 offset:16384
  s_waitcnt lgkmcnt(3)
  v_mfma_f32_16x16x32_bf16 v[128:131], a[0:3], a[144:147], 0
  ds_read_b128 a[168:171], v202
  s_waitcnt vmcnt(21)
  v_mfma_f32_16x16x32_bf16 v[132:135], a[4:7], a[144:147], 0
  ds_read_b128 a[32:35], v252 offset:32768
  ds_read_b128 a[36:39], v252 offset:34816
  v_mfma_f32_16x16x32_bf16 v[136:139], a[0:3], a[148:151], 0
  ds_read_b128 a[172:175], v197
  ds_read_b128 a[40:43], v253 offset:32768
  v_mfma_f32_16x16x32_bf16 v[140:143], a[4:7], a[148:151], 0
  ds_read_b128 a[44:47], v253 offset:34816
  s_waitcnt vmcnt(17)
  ds_read_b128 a[48:51], v66 offset:0
  v_mfma_f32_16x16x32_bf16 v[144:147], a[0:3], a[152:155], 0
  ds_read_b128 a[144:147], v197 offset:12288
  ds_read_b128 a[52:55], v66 offset:2048
  v_mfma_f32_16x16x32_bf16 v[148:151], a[4:7], a[152:155], 0
  ds_read_b128 a[56:59], v67 offset:0
  s_waitcnt lgkmcnt(9)
  v_mfma_f32_16x16x32_bf16 v[152:155], a[0:3], a[156:159], 0
  ds_read_b128 a[148:151], v197 offset:2048
  ds_read_b128 a[60:63], v67 offset:2048
  v_mfma_f32_16x16x32_bf16 v[156:159], a[4:7], a[156:159], 0
  s_add_u32 s44, s44, 256
  s_add_u32 m0, s46, 49152
  s_nop 0
  buffer_load_dwordx4 v203, s[16:19], s44 offen lds
  v_mfma_f32_16x16x32_bf16 v[160:163], a[0:3], a[160:163], 0
  ds_read_b128 a[152:155], v197 offset:14336
  s_lshl_b32 s49, s42, 4
  s_add_u32 s49, s49, s41
  s_lshl_b32 s50, s49, 7
  s_add_u32 s50, s50, 46243840
  s_cmp_eq_u32 s40, 0
  s_cselect_b32 s51, 1, 0
  v_mfma_f32_16x16x32_bf16 v[164:167], a[4:7], a[160:163], 0
  v_cmp_gt_u32 vcc, s51, v225
  v_mov_b32 v248, 0x7ffffff0
  v_mfma_f32_16x16x32_bf16 v[168:171], a[0:3], a[164:167], 0
  ds_read_b128 a[156:159], v197 offset:4096
  v_mov_b32 v249, s50
  v_mfma_f32_16x16x32_bf16 v[172:175], a[4:7], a[164:167], 0
  v_mov_b32 v250, s49
  v_mov_b32 v251, 0
  v_cndmask_b32 v249, v248, v249, vcc
  v_mfma_f32_16x16x32_bf16 v[176:179], a[0:3], a[168:171], 0
  ds_read_b128 a[160:163], v197 offset:16384
  buffer_load_dwordx4 v204, s[16:19], s44 offen offset:1024 lds
  v_mfma_f32_16x16x32_bf16 v[180:183], a[4:7], a[168:171], 0
  v_cndmask_b32 v254, v248, v250, vcc
  s_waitcnt lgkmcnt(2)
  v_mfma_f32_16x16x32_bf16 v[128:131], a[8:11], a[172:175], v[128:131]
  ds_read_b128 a[164:167], v202 offset:64
  v_mfma_f32_16x16x32_bf16 v[132:135], a[12:15], a[172:175], v[132:135]
  v_mfma_f32_16x16x32_bf16 v[136:139], a[8:11], a[144:147], v[136:139]
  ds_read_b128 a[168:171], v196 offset:6144
  v_mfma_f32_16x16x32_bf16 v[140:143], a[12:15], a[144:147], v[140:143]
  buffer_load_dwordx4 v205, s[16:19], s44 offen offset:2048 lds
  v_mfma_f32_16x16x32_bf16 v[144:147], a[8:11], a[148:151], v[144:147]
  ds_read_b128 a[172:175], v196 offset:18432
  v_mfma_f32_16x16x32_bf16 v[148:151], a[12:15], a[148:151], v[148:151]
  v_mfma_f32_16x16x32_bf16 v[152:155], a[8:11], a[152:155], v[152:155]
  ds_read_b128 a[144:147], v196 offset:8192
  v_mfma_f32_16x16x32_bf16 v[156:159], a[12:15], a[152:155], v[156:159]
  s_waitcnt lgkmcnt(2)
  v_mfma_f32_16x16x32_bf16 v[160:163], a[8:11], a[156:159], v[160:163]
  ds_read_b128 a[148:151], v196 offset:20480
  buffer_load_dwordx4 v206, s[16:19], s44 offen offset:3072 lds
  s_add_u32 m0, s46, 53248
  v_mfma_f32_16x16x32_bf16 v[164:167], a[12:15], a[156:159], v[164:167]
  v_mfma_f32_16x16x32_bf16 v[168:171], a[8:11], a[160:163], v[168:171]
  ds_read_b128 a[152:155], v196 offset:10240
  v_mfma_f32_16x16x32_bf16 v[172:175], a[12:15], a[160:163], v[172:175]
  v_mfma_f32_16x16x32_bf16 v[176:179], a[8:11], a[164:167], v[176:179]
  ds_read_b128 a[156:159], v196 offset:22528
  v_mfma_f32_16x16x32_bf16 v[180:183], a[12:15], a[164:167], v[180:183]
  buffer_load_dwordx4 v207, s[16:19], s44 offen lds
  v_mfma_f32_16x16x32_bf16 v[128:131], a[16:19], a[168:171], v[128:131]
  ds_read_b128 a[160:163], v202 offset:128
  v_mfma_f32_16x16x32_bf16 v[132:135], a[20:23], a[168:171], v[132:135]
  s_waitcnt lgkmcnt(2)
  v_mfma_f32_16x16x32_bf16 v[136:139], a[16:19], a[172:175], v[136:139]
  ds_read_b128 a[164:167], v197 offset:6144
  v_mfma_f32_16x16x32_bf16 v[140:143], a[20:23], a[172:175], v[140:143]
  v_mfma_f32_16x16x32_bf16 v[144:147], a[16:19], a[144:147], v[144:147]
  ds_read_b128 a[168:171], v197 offset:18432
  buffer_load_dwordx4 v208, s[16:19], s44 offen offset:1024 lds
  v_mfma_f32_16x16x32_bf16 v[148:151], a[20:23], a[144:147], v[148:151]
  s_add_u32 s45, s98, 768
  v_mfma_f32_16x16x32_bf16 v[152:155], a[16:19], a[148:151], v[152:155]
  ds_read_b128 a[172:175], v197 offset:8192
  s_add_u32 m0, s99, 49152
  v_mfma_f32_16x16x32_bf16 v[156:159], a[20:23], a[148:151], v[156:159]
  v_mfma_f32_16x16x32_bf16 v[160:163], a[16:19], a[152:155], v[160:163]
  ds_read_b128 a[144:147], v197 offset:20480
  v_mfma_f32_16x16x32_bf16 v[164:167], a[20:23], a[152:155], v[164:167]
  buffer_load_dwordx4 v203, s[4:7], s45 offen lds
  s_waitcnt lgkmcnt(2)
  v_mfma_f32_16x16x32_bf16 v[168:171], a[16:19], a[156:159], v[168:171]
  ds_read_b128 a[148:151], v197 offset:10240
  v_mfma_f32_16x16x32_bf16 v[172:175], a[20:23], a[156:159], v[172:175]
  v_mfma_f32_16x16x32_bf16 v[176:179], a[16:19], a[160:163], v[176:179]
  ds_read_b128 a[152:155], v197 offset:22528
  v_mfma_f32_16x16x32_bf16 v[180:183], a[20:23], a[160:163], v[180:183]
  v_mfma_f32_16x16x32_bf16 v[128:131], a[24:27], a[164:167], v[128:131]
  ds_read_b128 a[156:159], v202 offset:192
  s_waitcnt vmcnt(18)
  v_mfma_f32_16x16x32_bf16 v[132:135], a[28:31], a[164:167], v[132:135]
  buffer_load_dwordx4 v204, s[4:7], s45 offen offset:1024 lds
  s_barrier
  v_mfma_f32_16x16x32_bf16 v[136:139], a[24:27], a[168:171], v[136:139]
  ds_read_b128 a[160:163], v196 offset:24576
  v_mfma_f32_16x16x32_bf16 v[140:143], a[28:31], a[168:171], v[140:143]
  buffer_load_dwordx4 v205, s[4:7], s45 offen offset:2048 lds
  buffer_load_dwordx4 v206, s[4:7], s45 offen offset:3072 lds
  s_waitcnt lgkmcnt(2)
  v_mfma_f32_16x16x32_bf16 v[144:147], a[24:27], a[172:175], v[144:147]
  ds_read_b128 a[164:167], v196 offset:36864
  s_add_u32 s44, s44, 256
  v_mfma_f32_16x16x32_bf16 v[148:151], a[28:31], a[172:175], v[148:151]
  s_add_u32 m0, s46, 73728
  v_mfma_f32_16x16x32_bf16 v[152:155], a[24:27], a[144:147], v[152:155]
  ds_read_b128 a[168:171], v196 offset:26624
  v_mfma_f32_16x16x32_bf16 v[156:159], a[28:31], a[144:147], v[156:159]
  v_mfma_f32_16x16x32_bf16 v[160:163], a[24:27], a[148:151], v[160:163]
  ds_read_b128 a[172:175], v196 offset:38912
  v_mfma_f32_16x16x32_bf16 v[164:167], a[28:31], a[148:151], v[164:167]
  buffer_load_dwordx4 v203, s[16:19], s44 offen lds
  v_mfma_f32_16x16x32_bf16 v[168:171], a[24:27], a[152:155], v[168:171]
  ds_read_b128 a[144:147], v196 offset:28672
  v_mfma_f32_16x16x32_bf16 v[172:175], a[28:31], a[152:155], v[172:175]
  s_waitcnt lgkmcnt(2)
  v_mfma_f32_16x16x32_bf16 v[176:179], a[24:27], a[156:159], v[176:179]
  ds_read_b128 a[148:151], v196 offset:40960
  v_mfma_f32_16x16x32_bf16 v[180:183], a[28:31], a[156:159], v[180:183]
  v_mfma_f32_16x16x32_bf16 v[128:131], a[32:35], a[160:163], v[128:131]
  ds_read_b128 a[152:155], v202 offset:256
  buffer_load_dwordx4 v204, s[16:19], s44 offen offset:1024 lds
  v_mfma_f32_16x16x32_bf16 v[132:135], a[36:39], a[160:163], v[132:135]
  v_mfma_f32_16x16x32_bf16 v[136:139], a[32:35], a[164:167], v[136:139]
  ds_read_b128 a[156:159], v197 offset:24576
  v_mfma_f32_16x16x32_bf16 v[140:143], a[36:39], a[164:167], v[140:143]
  buffer_load_dwordx4 v205, s[16:19], s44 offen offset:2048 lds
  buffer_load_dwordx4 v206, s[16:19], s44 offen offset:3072 lds
  s_add_u32 m0, s46, 77824
  s_nop 0
  buffer_load_dwordx4 v207, s[16:19], s44 offen lds
  buffer_load_dwordx4 v208, s[16:19], s44 offen offset:1024 lds
  buffer_store_dword v251, v249, s[24:27], 0 offen sc1
  v_mfma_f32_16x16x32_bf16 v[144:147], a[32:35], a[168:171], v[144:147]
  ds_read_b128 a[160:163], v197 offset:36864
  s_waitcnt vmcnt(24)
  v_mfma_f32_16x16x32_bf16 v[148:151], a[36:39], a[168:171], v[148:151]
  ds_read_b128 a[64:67], v66 offset:16384
  ds_read_b128 a[68:71], v66 offset:18432
  s_waitcnt lgkmcnt(4)
  v_mfma_f32_16x16x32_bf16 v[152:155], a[32:35], a[172:175], v[152:155]
  ds_read_b128 a[164:167], v197 offset:26624
  ds_read_b128 a[72:75], v67 offset:16384
  v_mfma_f32_16x16x32_bf16 v[156:159], a[36:39], a[172:175], v[156:159]
  ds_read_b128 a[76:79], v67 offset:18432
  s_lshr_b32 s49, s42, 1
  v_mfma_f32_16x16x32_bf16 v[160:163], a[32:35], a[144:147], v[160:163]
  ds_read_b128 a[168:171], v197 offset:38912
  s_mul_i32 s49, s49, 663552
  s_mul_i32 s50, s55, 55296
  v_mfma_f32_16x16x32_bf16 v[164:167], a[36:39], a[144:147], v[164:167]
  s_lshr_b32 s51, s40, 1
  s_lshl_b32 s51, s51, 7
  v_mfma_f32_16x16x32_bf16 v[168:171], a[32:35], a[148:151], v[168:171]
  ds_read_b128 a[172:175], v197 offset:28672
  s_add_u32 s66, s49, s50
  v_mfma_f32_16x16x32_bf16 v[172:175], a[36:39], a[148:151], v[172:175]
  s_add_u32 s66, s66, s51
  s_add_u32 s49, s49, 331776
  s_mul_i32 s50, s40, 55296
  v_mfma_f32_16x16x32_bf16 v[176:179], a[32:35], a[152:155], v[176:179]
  ds_read_b128 a[144:147], v197 offset:40960
  s_add_u32 s67, s49, s50
  v_mfma_f32_16x16x32_bf16 v[180:183], a[36:39], a[152:155], v[180:183]
  s_mul_i32 s50, s40, 27648
  s_waitcnt lgkmcnt(2)
  v_mfma_f32_16x16x32_bf16 v[128:131], a[40:43], a[156:159], v[128:131]
  ds_read_b128 a[148:151], v202 offset:320
  s_add_u32 s68, s49, s50
  s_add_u32 s68, s68, 221184
  v_mfma_f32_16x16x32_bf16 v[132:135], a[44:47], a[156:159], v[132:135]
  s_add_u32 s45, s98, 896
  v_mfma_f32_16x16x32_bf16 v[136:139], a[40:43], a[160:163], v[136:139]
  ds_read_b128 a[152:155], v196 offset:30720
  s_add_u32 m0, s99, 65536
  v_mfma_f32_16x16x32_bf16 v[140:143], a[44:47], a[160:163], v[140:143]
  buffer_load_dwordx4 v203, s[4:7], s45 offen lds
  s_add_u32 s71, s43, 4294967264
  s_mul_i32 s50, s55, 73728
  v_mfma_f32_16x16x32_bf16 v[144:147], a[40:43], a[164:167], v[144:147]
  ds_read_b128 a[156:159], v196 offset:43008
  s_lshl_b32 s51, s43, 1
  v_mfma_f32_16x16x32_bf16 v[148:151], a[44:47], a[164:167], v[148:151]
  s_add_u32 s52, s50, s51
  s_lshl_b32 s49, s71, 1
  v_mfma_f32_16x16x32_bf16 v[152:155], a[40:43], a[168:171], v[152:155]
  ds_read_b128 a[160:163], v196 offset:32768
  s_add_u32 s72, s50, s49
  s_mul_i32 s50, s55, 36864
  v_mfma_f32_16x16x32_bf16 v[156:159], a[44:47], a[168:171], v[156:159]
  s_add_u32 s69, s50, s51
  s_lshr_b32 s48, s42, 1
  s_lshl_b32 s48, s48, 4
  buffer_load_dwordx4 v204, s[4:7], s45 offen offset:1024 lds
  buffer_load_dwordx4 v205, s[4:7], s45 offen offset:2048 lds
  buffer_load_dwordx4 v206, s[4:7], s45 offen offset:3072 lds
  s_waitcnt lgkmcnt(2)
  v_mfma_f32_16x16x32_bf16 v[160:163], a[40:43], a[172:175], v[160:163]
  ds_read_b128 a[164:167], v196 offset:45056
  s_waitcnt vmcnt(24)
  v_mfma_f32_16x16x32_bf16 v[164:167], a[44:47], a[172:175], v[164:167]
  ds_read_b128 a[80:83], v66 offset:32768
  ds_read_b128 a[84:87], v66 offset:34816
  v_mfma_f32_16x16x32_bf16 v[168:171], a[40:43], a[144:147], v[168:171]
  ds_read_b128 a[168:171], v196 offset:34816
  ds_read_b128 a[88:91], v67 offset:32768
  ds_read_b128 a[92:95], v67 offset:34816
  v_mfma_f32_16x16x32_bf16 v[172:175], a[44:47], a[144:147], v[172:175]
  s_add_u32 s48, s48, s41
  s_lshl_b32 s48, s48, 2
  v_mfma_f32_16x16x32_bf16 v[176:179], a[40:43], a[148:151], v[176:179]
  ds_read_b128 a[172:175], v196 offset:47104
  s_add_u32 s48, s48, s40
  v_mfma_f32_16x16x32_bf16 v[180:183], a[44:47], a[148:151], v[180:183]
  s_lshl_b32 s48, s48, 15
  s_add_u32 s48, s48, 16384
  s_lshl_b32 s54, s42, 4
  v_mfma_f32_16x16x32_bf16 v[128:131], a[48:51], a[152:155], v[128:131]
  ds_read_b128 a[144:147], v202 offset:384
  s_add_u32 s54, s54, s41
  v_mfma_f32_16x16x32_bf16 v[132:135], a[52:55], a[152:155], v[132:135]
  s_lshl_b32 s54, s54, 2
  s_waitcnt lgkmcnt(4)
  v_mfma_f32_16x16x32_bf16 v[136:139], a[48:51], a[156:159], v[136:139]
  ds_read_b128 a[148:151], v197 offset:30720
  s_add_u32 s54, s54, s40
  s_lshl_b32 s54, s54, 12
  v_mfma_f32_16x16x32_bf16 v[140:143], a[52:55], a[156:159], v[140:143]
  s_add_u32 s54, s54, 16777216
  s_lshl_b32 s61, s41, 4
  v_mfma_f32_16x16x32_bf16 v[144:147], a[48:51], a[160:163], v[144:147]
  ds_read_b128 a[152:155], v197 offset:43008
  s_waitcnt lgkmcnt(4)
  v_mfma_f32_16x16x32_bf16 v[148:151], a[52:55], a[160:163], v[148:151]
  s_add_u32 s45, s98, 1024
  s_add_u32 m0, s99, 81920
  s_nop 0
  buffer_load_dwordx4 v203, s[4:7], s45 offen lds
  v_mfma_f32_16x16x32_bf16 v[152:155], a[48:51], a[164:167], v[152:155]
  ds_read_b128 a[156:159], v197 offset:32768
  s_add_u32 s62, s61, s42
  v_mfma_f32_16x16x32_bf16 v[156:159], a[52:55], a[164:167], v[156:159]
  s_lshl_b32 s62, s62, 2
  s_add_u32 s62, s62, s40
  v_mfma_f32_16x16x32_bf16 v[160:163], a[48:51], a[168:171], v[160:163]
  ds_read_b128 a[160:163], v197 offset:45056
  s_mul_i32 s61, s62, 24576
  s_add_u32 s61, s61, 20971520
  v_mfma_f32_16x16x32_bf16 v[164:167], a[52:55], a[168:171], v[164:167]
  s_add_u32 s62, s61, 4294868992
  s_waitcnt lgkmcnt(2)
  v_mfma_f32_16x16x32_bf16 v[168:171], a[48:51], a[172:175], v[168:171]
  ds_read_b128 a[164:167], v197 offset:34816
  buffer_load_dwordx4 v204, s[4:7], s45 offen offset:1024 lds
  v_mfma_f32_16x16x32_bf16 v[172:175], a[52:55], a[172:175], v[172:175]
  s_bfm_b64 s[56:57], s41, 0
  s_not_b64 s[56:57], s[56:57]
  v_mfma_f32_16x16x32_bf16 v[176:179], a[48:51], a[144:147], v[176:179]
  ds_read_b128 a[168:171], v197 offset:47104
  s_cmp_ge_u32 s40, 1
  s_cselect_b32 s58, 1.0, 0
  v_mfma_f32_16x16x32_bf16 v[180:183], a[52:55], a[144:147], v[180:183]
  s_cmp_ge_u32 s40, 2
  s_cselect_b32 s59, 1.0, 0
  v_mfma_f32_16x16x32_bf16 v[128:131], a[56:59], a[148:151], v[128:131]
  ds_read_b128 a[172:175], v202 offset:448
  s_waitcnt vmcnt(17)
  v_mfma_f32_16x16x32_bf16 v[132:135], a[60:63], a[148:151], v[132:135]
  buffer_load_dwordx4 v205, s[4:7], s45 offen offset:2048 lds
  s_cmp_ge_u32 s40, 3
  s_cselect_b32 s60, 1.0, 0
  s_barrier
  v_mfma_f32_16x16x32_bf16 v[136:139], a[56:59], a[152:155], v[136:139]
  ds_read_b128 a[144:147], v198
  v_mul_u32_u24 v248, 57, v225
  v_mfma_f32_16x16x32_bf16 v[140:143], a[60:63], a[152:155], v[140:143]
  v_lshrrev_b32 v248, 10, v248
  s_waitcnt lgkmcnt(2)
  v_mfma_f32_16x16x32_bf16 v[144:147], a[56:59], a[156:159], v[144:147]
  ds_read_b128 a[148:151], v198 offset:12288
  v_mul_u32_u24 v249, 18, v248
  v_mfma_f32_16x16x32_bf16 v[148:151], a[60:63], a[156:159], v[148:151]
  v_sub_u32 v249, v225, v249
  buffer_load_dwordx4 v206, s[4:7], s45 offen offset:3072 lds
  v_mfma_f32_16x16x32_bf16 v[152:155], a[56:59], a[160:163], v[152:155]
  ds_read_b128 a[152:155], v198 offset:2048
  s_add_u32 s44, s44, 256
  v_mfma_f32_16x16x32_bf16 v[156:159], a[60:63], a[160:163], v[156:159]
  s_add_u32 m0, s46, 0
  v_mul_u32_u24 v249, 9216, v249
  v_lshlrev_b32 v248, 7, v248
  v_mfma_f32_16x16x32_bf16 v[160:163], a[56:59], a[164:167], v[160:163]
  ds_read_b128 a[156:159], v198 offset:14336
  v_add_u32 v248, 192, v248
  v_mfma_f32_16x16x32_bf16 v[164:167], a[60:63], a[164:167], v[164:167]
  v_add_u32 v249, v249, v248
  v_mov_b32 v250, 0x7ffffff0
  v_mfma_f32_16x16x32_bf16 v[168:171], a[56:59], a[168:171], v[168:171]
  ds_read_b128 a[160:163], v198 offset:4096
  v_cmp_gt_u32 vcc, 54, v225
  v_mfma_f32_16x16x32_bf16 v[172:175], a[60:63], a[168:171], v[172:175]
  buffer_load_dwordx4 v203, s[16:19], s44 offen lds
  s_waitcnt lgkmcnt(2)
  v_mfma_f32_16x16x32_bf16 v[176:179], a[56:59], a[172:175], v[176:179]
  ds_read_b128 a[164:167], v198 offset:16384
  v_cndmask_b32 v249, v250, v249, vcc
  v_mfma_f32_16x16x32_bf16 v[180:183], a[60:63], a[172:175], v[180:183]
  v_accvgpr_write_b32 a253, v249
  v_lshlrev_b32 v248, 7, v225
  v_cmp_gt_u32 vcc, 41, v225
  v_mfma_f32_16x16x32_bf16 v[128:131], a[64:67], a[144:147], v[128:131]
  ds_read_b128 a[168:171], v202 offset:512
  v_cndmask_b32 v248, v250, v248, vcc
  v_mfma_f32_16x16x32_bf16 v[132:135], a[68:71], a[144:147], v[132:135]
  v_accvgpr_write_b32 a254, v248
  v_lshrrev_b32 v248, 1, v225
  v_mfma_f32_16x16x32_bf16 v[136:139], a[64:67], a[148:151], v[136:139]
  ds_read_b128 a[172:175], v199
  buffer_load_dwordx4 v204, s[16:19], s44 offen offset:1024 lds
  v_mul_u32_u24 v248, 1152, v248
  v_mfma_f32_16x16x32_bf16 v[140:143], a[68:71], a[148:151], v[140:143]
  v_and_b32 v249, 1, v225
  v_mfma_f32_16x16x32_bf16 v[144:147], a[64:67], a[152:155], v[144:147]
  ds_read_b128 a[144:147], v199 offset:12288
  v_mul_u32_u24 v249, 92, v249
  v_mfma_f32_16x16x32_bf16 v[148:151], a[68:71], a[152:155], v[148:151]
  v_add_u32 v248, v248, v249
  v_cmp_gt_u32 vcc, 36, v225
  s_waitcnt lgkmcnt(2)
  v_mfma_f32_16x16x32_bf16 v[152:155], a[64:67], a[156:159], v[152:155]
  ds_read_b128 a[148:151], v199 offset:2048
  v_cndmask_b32 v248, v250, v248, vcc
  v_mfma_f32_16x16x32_bf16 v[156:159], a[68:71], a[156:159], v[156:159]
  buffer_load_dwordx4 v205, s[16:19], s44 offen offset:2048 lds
  v_accvgpr_write_b32 a255, v248
  v_lshlrev_b32 v231, 16, v228
  v_lshlrev_b32 v232, 16, v229
  v_lshlrev_b32 v233, 16, v230
  buffer_load_dwordx4 v206, s[16:19], s44 offen offset:3072 lds
  s_add_u32 m0, s46, 4096
  s_nop 0
  buffer_load_dwordx4 v207, s[16:19], s44 offen lds
  buffer_load_dwordx4 v208, s[16:19], s44 offen offset:1024 lds
  v_mfma_f32_16x16x32_bf16 v[160:163], a[64:67], a[160:163], v[160:163]
  ds_read_b128 a[152:155], v199 offset:14336
  v_mul_f32 v233, 0x3fb8aa3b, v233
  v_mfma_f32_16x16x32_bf16 v[164:167], a[68:71], a[160:163], v[164:167]
  v_exp_f32 v233, v233
  v_mfma_f32_16x16x32_bf16 v[168:171], a[64:67], a[164:167], v[168:171]
  ds_read_b128 a[156:159], v199 offset:4096
  v_lshrrev_b32 v250, 3, v227
  v_cvt_pk_bf16_f32 v233, v233, v233
  v_mfma_f32_16x16x32_bf16 v[172:175], a[68:71], a[164:167], v[172:175]
  v_lshlrev_b32 v233, 16, v233
  v_mfma_f32_16x16x32_bf16 v[176:179], a[64:67], a[168:171], v[176:179]
  ds_read_b128 a[160:163], v199 offset:16384
  v_mul_f32 v234, v233, v231
  v_mfma_f32_16x16x32_bf16 v[180:183], a[68:71], a[168:171], v[180:183]
  v_mul_f32 v235, v233, v232
  s_waitcnt lgkmcnt(2)
  v_mfma_f32_16x16x32_bf16 v[128:131], a[72:75], a[172:175], v[128:131]
  ds_read_b128 a[164:167], v202 offset:576
  v_mul_f32 v234, 0x3fb8aa3b, v234
  v_mul_f32 v235, 0x3e22f983, v235
  v_mfma_f32_16x16x32_bf16 v[132:135], a[76:79], a[172:175], v[132:135]
  v_mul_f32 v248, 1.0, v234
  v_mul_f32 v249, 1.0, v235
  v_mfma_f32_16x16x32_bf16 v[136:139], a[72:75], a[144:147], v[136:139]
  ds_read_b128 a[168:171], v198 offset:6144
  v_exp_f32 v248, v248
  v_mfma_f32_16x16x32_bf16 v[140:143], a[76:79], a[144:147], v[140:143]
  v_fract_f32 v249, v249
  v_mfma_f32_16x16x32_bf16 v[144:147], a[72:75], a[148:151], v[144:147]
  ds_read_b128 a[172:175], v198 offset:18432
  v_cos_f32 v236, v249
  v_mfma_f32_16x16x32_bf16 v[148:151], a[76:79], a[148:151], v[148:151]
  v_sin_f32 v237, v249
  v_mfma_f32_16x16x32_bf16 v[152:155], a[72:75], a[152:155], v[152:155]
  ds_read_b128 a[144:147], v198 offset:8192
  v_mul_f32 v236, v248, v236
  v_mul_f32 v237, v248, v237
  v_mfma_f32_16x16x32_bf16 v[156:159], a[76:79], a[152:155], v[156:159]
  v_mul_f32 v248, 2.0, v234
  s_waitcnt lgkmcnt(2)
  v_mfma_f32_16x16x32_bf16 v[160:163], a[72:75], a[156:159], v[160:163]
  ds_read_b128 a[148:151], v198 offset:20480
  v_mul_f32 v249, 2.0, v235
  v_mfma_f32_16x16x32_bf16 v[164:167], a[76:79], a[156:159], v[164:167]
  v_exp_f32 v248, v248
  v_fract_f32 v249, v249
  v_mfma_f32_16x16x32_bf16 v[168:171], a[72:75], a[160:163], v[168:171]
  ds_read_b128 a[152:155], v198 offset:10240
  s_waitcnt vmcnt(21)
  v_mfma_f32_16x16x32_bf16 v[172:175], a[76:79], a[160:163], v[172:175]
  ds_read_b128 a[96:99], v66 offset:0
  ds_read_b128 a[100:103], v66 offset:2048
  v_mfma_f32_16x16x32_bf16 v[176:179], a[72:75], a[164:167], v[176:179]
  ds_read_b128 a[156:159], v198 offset:22528
  ds_read_b128 a[104:107], v67 offset:0
  ds_read_b128 a[108:111], v67 offset:2048
  v_mfma_f32_16x16x32_bf16 v[180:183], a[76:79], a[164:167], v[180:183]
  v_cos_f32 v238, v249
  v_mfma_f32_16x16x32_bf16 v[128:131], a[80:83], a[168:171], v[128:131]
  ds_read_b128 a[160:163], v202 offset:640
  v_sin_f32 v239, v249
  v_mfma_f32_16x16x32_bf16 v[132:135], a[84:87], a[168:171], v[132:135]
  v_mul_f32 v238, v248, v238
  v_mul_f32 v239, v248, v239
  s_waitcnt lgkmcnt(6)
  v_mfma_f32_16x16x32_bf16 v[136:139], a[80:83], a[172:175], v[136:139]
  ds_read_b128 a[164:167], v199 offset:6144
  s_mov_b32 s49, 0x40400000
  v_mfma_f32_16x16x32_bf16 v[140:143], a[84:87], a[172:175], v[140:143]
  v_mul_f32 v248, s49, v234
  v_mul_f32 v249, s49, v235
  v_mfma_f32_16x16x32_bf16 v[144:147], a[80:83], a[144:147], v[144:147]
  ds_read_b128 a[168:171], v199 offset:18432
  v_exp_f32 v248, v248
  v_mfma_f32_16x16x32_bf16 v[148:151], a[84:87], a[144:147], v[148:151]
  v_fract_f32 v249, v249
  v_mfma_f32_16x16x32_bf16 v[152:155], a[80:83], a[148:151], v[152:155]
  ds_read_b128 a[172:175], v199 offset:8192
  v_cos_f32 v240, v249
  v_mfma_f32_16x16x32_bf16 v[156:159], a[84:87], a[148:151], v[156:159]
  v_sin_f32 v241, v249
  v_mul_f32 v240, v248, v240
  v_mfma_f32_16x16x32_bf16 v[160:163], a[80:83], a[152:155], v[160:163]
  ds_read_b128 a[144:147], v199 offset:20480
  v_mul_f32 v241, v248, v241
  v_mfma_f32_16x16x32_bf16 v[164:167], a[84:87], a[152:155], v[164:167]
  v_mul_f32 v248, 4.0, v234
  s_waitcnt lgkmcnt(2)
  v_mfma_f32_16x16x32_bf16 v[168:171], a[80:83], a[156:159], v[168:171]
  ds_read_b128 a[148:151], v199 offset:10240
  v_mov_b32 v64, 1
  s_waitcnt vmcnt(14)
  buffer_store_byte v64, v254, s[32:35], 0 offen sc1
  v_mfma_f32_16x16x32_bf16 v[172:175], a[84:87], a[156:159], v[172:175]
  v_mul_f32 v249, 4.0, v235
  v_exp_f32 v248, v248
  v_mfma_f32_16x16x32_bf16 v[176:179], a[80:83], a[160:163], v[176:179]
  ds_read_b128 a[152:155], v199 offset:22528
  v_fract_f32 v249, v249
  v_mfma_f32_16x16x32_bf16 v[180:183], a[84:87], a[160:163], v[180:183]
  v_cos_f32 v242, v249
  v_sin_f32 v243, v249
  v_mul_f32 v242, v248, v242
  s_waitcnt vmcnt(11)
  ds_read_b128 a[112:115], v66 offset:16384
  ds_read_b128 a[116:119], v66 offset:18432
  ds_read_b128 a[120:123], v67 offset:16384
  ds_read_b128 a[124:127], v67 offset:18432
  v_mfma_f32_16x16x32_bf16 v[128:131], a[88:91], a[164:167], v[128:131]
  ds_read_b128 a[156:159], v202 offset:704
  v_mfma_f32_16x16x32_bf16 v[132:135], a[92:95], a[164:167], v[132:135]
  v_mul_f32 v243, v248, v243
  v_mov_b32 v217, v242
  s_barrier
  v_mfma_f32_16x16x32_bf16 v[136:139], a[88:91], a[168:171], v[136:139]
  ds_read_b128 a[160:163], v198 offset:24576
  s_mov_b32 s44, s65
  v_mfma_f32_16x16x32_bf16 v[140:143], a[92:95], a[168:171], v[140:143]
  s_add_u32 m0, s46, 24576
  s_waitcnt lgkmcnt(6)
  v_mfma_f32_16x16x32_bf16 v[144:147], a[88:91], a[172:175], v[144:147]
  ds_read_b128 a[164:167], v198 offset:36864
  buffer_load_dwordx4 v209, s[8:11], s44 offen lds
  v_mov_b32 v218, v243
  v_mfma_f32_16x16x32_bf16 v[148:151], a[92:95], a[172:175], v[148:151]
  s_mov_b32 s49, 0x42000000
  v_mul_f32 v248, s49, v234
  v_mfma_f32_16x16x32_bf16 v[152:155], a[88:91], a[144:147], v[152:155]
  ds_read_b128 a[168:171], v198 offset:26624
  v_mul_f32 v249, s49, v235
  v_mfma_f32_16x16x32_bf16 v[156:159], a[92:95], a[144:147], v[156:159]
  v_exp_f32 v248, v248
  v_fract_f32 v249, v249
  v_mfma_f32_16x16x32_bf16 v[160:163], a[88:91], a[148:151], v[160:163]
  ds_read_b128 a[172:175], v198 offset:38912
  v_cos_f32 v219, v249
  v_mfma_f32_16x16x32_bf16 v[164:167], a[92:95], a[148:151], v[164:167]
  buffer_load_dwordx4 v210, s[8:11], s44 offen offset:1024 lds
  v_sin_f32 v220, v249
  v_mfma_f32_16x16x32_bf16 v[168:171], a[88:91], a[152:155], v[168:171]
  ds_read_b128 a[144:147], v198 offset:28672
  v_mul_f32 v219, v248, v219
  v_mfma_f32_16x16x32_bf16 v[172:175], a[92:95], a[152:155], v[172:175]
  v_mul_f32 v220, v248, v220
  s_mov_b32 s49, 0x43000000
  s_waitcnt lgkmcnt(2)
  v_mfma_f32_16x16x32_bf16 v[176:179], a[88:91], a[156:159], v[176:179]
  ds_read_b128 a[148:151], v198 offset:40960
  v_mul_f32 v248, s49, v234
  v_mfma_f32_16x16x32_bf16 v[180:183], a[92:95], a[156:159], v[180:183]
  v_mul_f32 v249, s49, v235
  v_exp_f32 v248, v248
  v_mfma_f32_16x16x32_bf16 v[128:131], a[96:99], a[160:163], v[128:131]
  ds_read_b128 a[152:155], v202 offset:768
  buffer_load_dwordx4 v211, s[8:11], s44 offen offset:2048 lds
  v_bfe_u32 v203, v225, 4, 1
  v_mfma_f32_16x16x32_bf16 v[132:135], a[100:103], a[160:163], v[132:135]
  v_lshlrev_b32 v203, 1, v203
  v_and_b32 v254, 7, v225
  v_mfma_f32_16x16x32_bf16 v[136:139], a[96:99], a[164:167], v[136:139]
  ds_read_b128 a[156:159], v199 offset:24576
  v_xor_b32 v203, v203, v254
  v_fract_f32 v249, v249
  v_mfma_f32_16x16x32_bf16 v[140:143], a[100:103], a[164:167], v[140:143]
  v_lshlrev_b32 v203, 4, v203
  v_lshrrev_b32 v254, 3, v225
  v_cos_f32 v221, v249
  buffer_load_dwordx4 v212, s[8:11], s44 offen offset:3072 lds
  s_add_u32 m0, s46, 28672
  s_nop 0
  buffer_load_dwordx4 v213, s[8:11], s44 offen lds
  buffer_load_dwordx4 v214, s[8:11], s44 offen offset:1024 lds
  v_mfma_f32_16x16x32_bf16 v[144:147], a[96:99], a[168:171], v[144:147]
  ds_read_b128 a[160:163], v199 offset:36864
  v_mul_u32_u24 v254, 9216, v254
  v_mfma_f32_16x16x32_bf16 v[148:151], a[100:103], a[168:171], v[148:151]
  v_xor_b32 v204, 64, v203
  s_waitcnt lgkmcnt(2)
  v_mfma_f32_16x16x32_bf16 v[152:155], a[96:99], a[172:175], v[152:155]
  ds_read_b128 a[164:167], v199 offset:26624
  v_add_u32 v203, v203, v254
  v_mfma_f32_16x16x32_bf16 v[156:159], a[100:103], a[172:175], v[156:159]
  v_add_u32 v204, v204, v254
  v_sin_f32 v222, v249
  v_mfma_f32_16x16x32_bf16 v[160:163], a[96:99], a[144:147], v[160:163]
  ds_read_b128 a[168:171], v199 offset:38912
  v_add_u32 v204, 72704, v204
  v_mfma_f32_16x16x32_bf16 v[164:167], a[100:103], a[144:147], v[164:167]
  v_add_u32 v205, 145408, v203
  v_add_u32 v206, 145408, v204
  v_mfma_f32_16x16x32_bf16 v[168:171], a[96:99], a[148:151], v[168:171]
  ds_read_b128 a[172:175], v199 offset:28672
  v_add_u32 v207, 294912, v203
  v_add_u32 v208, 294912, v204
  v_mfma_f32_16x16x32_bf16 v[172:175], a[100:103], a[148:151], v[172:175]
  v_mul_f32 v221, v248, v221
  v_mul_f32 v222, v248, v222
  v_mfma_f32_16x16x32_bf16 v[176:179], a[96:99], a[152:155], v[176:179]
  ds_read_b128 a[144:147], v199 offset:40960
  s_lshl_b32 s49, s40, 5
  v_mfma_f32_16x16x32_bf16 v[180:183], a[100:103], a[152:155], v[180:183]
  v_cvt_f32_u32 v251, s49
  s_waitcnt lgkmcnt(2)
  v_mfma_f32_16x16x32_bf16 v[128:131], a[104:107], a[156:159], v[128:131]
  ds_read_b128 a[148:151], v202 offset:832
  v_mul_f32 v248, v251, v234
  v_mfma_f32_16x16x32_bf16 v[132:135], a[108:111], a[156:159], v[132:135]
  v_mul_f32 v249, v251, v235
  v_exp_f32 v248, v248
  v_mfma_f32_16x16x32_bf16 v[136:139], a[104:107], a[160:163], v[136:139]
  ds_read_b128 a[152:155], v198 offset:30720
  v_fract_f32 v249, v249
  v_mfma_f32_16x16x32_bf16 v[140:143], a[108:111], a[160:163], v[140:143]
  v_cos_f32 v223, v249
  v_mfma_f32_16x16x32_bf16 v[144:147], a[104:107], a[164:167], v[144:147]
  ds_read_b128 a[156:159], v198 offset:43008
  v_sin_f32 v224, v249
  v_mfma_f32_16x16x32_bf16 v[148:151], a[108:111], a[164:167], v[148:151]
  v_mul_f32 v223, v248, v223
  v_mul_f32 v224, v248, v224
  v_add_f32 v248, -1.0, v236
  v_mfma_f32_16x16x32_bf16 v[152:155], a[104:107], a[168:171], v[152:155]
  ds_read_b128 a[160:163], v198 offset:32768
  v_mul_f32 v249, v231, v231
  v_mfma_f32_16x16x32_bf16 v[156:159], a[108:111], a[168:171], v[156:159]
  v_fmac_f32 v249, v232, v232
  s_waitcnt lgkmcnt(2)
  v_mfma_f32_16x16x32_bf16 v[160:163], a[104:107], a[172:175], v[160:163]
  ds_read_b128 a[164:167], v198 offset:45056
  v_rcp_f32 v249, v249
  v_mfma_f32_16x16x32_bf16 v[164:167], a[108:111], a[172:175], v[164:167]
  v_mul_f32 v228, v248, v231
  v_mfma_f32_16x16x32_bf16 v[168:171], a[104:107], a[144:147], v[168:171]
  ds_read_b128 a[168:171], v198 offset:34816
  v_fmac_f32 v228, v237, v232
  v_mfma_f32_16x16x32_bf16 v[172:175], a[108:111], a[144:147], v[172:175]
  v_mul_f32 v229, v237, v231
  v_mfma_f32_16x16x32_bf16 v[176:179], a[104:107], a[148:151], v[176:179]
  ds_read_b128 a[172:175], v198 offset:47104
  s_waitcnt vmcnt(13)
  ds_read_b128 a[128:131], v66 offset:32768
  v_mfma_f32_16x16x32_bf16 v[180:183], a[108:111], a[148:151], v[180:183]
  ds_read_b128 a[132:135], v66 offset:34816
  ds_read_b128 a[136:139], v67 offset:32768
  v_mfma_f32_16x16x32_bf16 v[128:131], a[112:115], a[152:155], v[128:131]
  ds_read_b128 a[144:147], v202 offset:896
  ds_read_b128 a[140:143], v67 offset:34816
  v_mfma_f32_16x16x32_bf16 v[132:135], a[116:119], a[152:155], v[132:135]
  v_fma_f32 v229, -v248, v232, v229
  v_mul_f32 v228, v228, v249
  s_waitcnt lgkmcnt(6)
  v_mfma_f32_16x16x32_bf16 v[136:139], a[112:115], a[156:159], v[136:139]
  ds_read_b128 a[148:151], v199 offset:30720
  v_mul_f32 v229, v229, v249
  v_mfma_f32_16x16x32_bf16 v[140:143], a[116:119], a[156:159], v[140:143]
  v_cmp_gt_u32 vcc, 40, v250
  v_mul_u32_u24 v250, 48, v250
  v_mfma_f32_16x16x32_bf16 v[144:147], a[112:115], a[160:163], v[144:147]
  ds_read_b128 a[152:155], v199 offset:43008
  v_add_u32 v250, 161280, v250
  v_cndmask_b32 v228, 0, v228, vcc
  v_mfma_f32_16x16x32_bf16 v[148:151], a[116:119], a[160:163], v[148:151]
  v_cndmask_b32 v229, 0, v229, vcc
  v_mov_b32 v230, 0
  v_mfma_f32_16x16x32_bf16 v[152:155], a[112:115], a[164:167], v[152:155]
  ds_read_b128 a[156:159], v199 offset:32768
  v_mov_b32 v231, 0
  v_mfma_f32_16x16x32_bf16 v[156:159], a[116:119], a[164:167], v[156:159]
  ds_write_b128 v250, v[236:239]
  ds_write_b128 v250, v[240:243] offset:16
  ds_write_b128 v250, v[228:231] offset:32
  v_mfma_f32_16x16x32_bf16 v[160:163], a[112:115], a[168:171], v[160:163]
  ds_read_b128 a[160:163], v199 offset:45056
  v_mfma_f32_16x16x32_bf16 v[164:167], a[116:119], a[168:171], v[164:167]
  s_waitcnt lgkmcnt(5)
  v_mfma_f32_16x16x32_bf16 v[168:171], a[112:115], a[172:175], v[168:171]
  ds_read_b128 a[164:167], v199 offset:34816
  v_mfma_f32_16x16x32_bf16 v[172:175], a[116:119], a[172:175], v[172:175]
  v_mfma_f32_16x16x32_bf16 v[176:179], a[112:115], a[144:147], v[176:179]
  ds_read_b128 a[168:171], v199 offset:47104
  v_mfma_f32_16x16x32_bf16 v[180:183], a[116:119], a[144:147], v[180:183]
  v_mfma_f32_16x16x32_bf16 v[128:131], a[120:123], a[148:151], v[128:131]
  ds_read_b128 a[172:175], v202 offset:960
  s_waitcnt vmcnt(7)
  v_mfma_f32_16x16x32_bf16 v[132:135], a[124:127], a[148:151], v[132:135]
  s_barrier
  v_mfma_f32_16x16x32_bf16 v[136:139], a[120:123], a[152:155], v[136:139]
  ds_read_b128 a[144:147], v196
  s_add_u32 s44, s44, 1769472
  s_add_u32 m0, s46, 49152
  v_mfma_f32_16x16x32_bf16 v[140:143], a[124:127], a[152:155], v[140:143]
  buffer_load_dwordx4 v209, s[8:11], s44 offen lds
  v_lshrrev_b32 v252, 4, v225
  s_waitcnt lgkmcnt(2)
  v_mfma_f32_16x16x32_bf16 v[144:147], a[120:123], a[156:159], v[144:147]
  ds_read_b128 a[148:151], v196 offset:12288
  v_mul_u32_u24 v252, 8, v252
  v_bfe_u32 v253, v225, 2, 2
  v_mfma_f32_16x16x32_bf16 v[148:151], a[124:127], a[156:159], v[148:151]
  v_add_u32 v252, v252, v253
  buffer_load_dwordx4 v210, s[8:11], s44 offen offset:1024 lds
  buffer_load_dwordx4 v211, s[8:11], s44 offen offset:2048 lds
  buffer_load_dwordx4 v212, s[8:11], s44 offen offset:3072 lds
  s_add_u32 m0, s46, 53248
  s_nop 0
  buffer_load_dwordx4 v213, s[8:11], s44 offen lds
  buffer_load_dwordx4 v214, s[8:11], s44 offen offset:1024 lds
  v_mfma_f32_16x16x32_bf16 v[152:155], a[120:123], a[160:163], v[152:155]
  ds_read_b128 a[152:155], v196 offset:2048
  s_add_u32 s44, s44, 1769472
  s_add_u32 m0, s46, 98304
  v_mfma_f32_16x16x32_bf16 v[156:159], a[124:127], a[160:163], v[156:159]
  v_lshlrev_b32 v252, 7, v252
  v_and_b32 v253, 3, v225
  v_mfma_f32_16x16x32_bf16 v[160:163], a[120:123], a[164:167], v[160:163]
  ds_read_b128 a[156:159], v196 offset:14336
  v_lshlrev_b32 v253, 3, v253
  v_mfma_f32_16x16x32_bf16 v[164:167], a[124:127], a[164:167], v[164:167]
  v_add_u32 v252, v252, v253
  v_bfe_u32 v253, v225, 3, 2
  v_mfma_f32_16x16x32_bf16 v[168:171], a[120:123], a[168:171], v[168:171]
  ds_read_b128 a[160:163], v196 offset:4096
  v_xor_b32 v190, 0, v253
  v_mfma_f32_16x16x32_bf16 v[172:175], a[124:127], a[168:171], v[172:175]
  buffer_load_dwordx4 v209, s[8:11], s44 offen lds
  v_lshlrev_b32 v190, 5, v190
  s_waitcnt lgkmcnt(2)
  v_mfma_f32_16x16x32_bf16 v[176:179], a[120:123], a[172:175], v[176:179]
  ds_read_b128 a[164:167], v196 offset:16384
  v_add_u32 v190, v190, v252
  v_mfma_f32_16x16x32_bf16 v[180:183], a[124:127], a[172:175], v[180:183]
  v_xor_b32 v191, 1, v253
  v_mfma_f32_16x16x32_bf16 v[128:131], a[128:131], a[144:147], v[128:131]
  ds_read_b128 a[168:171], v202 offset:1024
  v_lshlrev_b32 v191, 5, v191
  v_mfma_f32_16x16x32_bf16 v[132:135], a[132:135], a[144:147], v[132:135]
  v_add_u32 v191, v191, v252
  v_xor_b32 v192, 2, v253
  v_mfma_f32_16x16x32_bf16 v[136:139], a[128:131], a[148:151], v[136:139]
  ds_read_b128 a[172:175], v197
  buffer_load_dwordx4 v210, s[8:11], s44 offen offset:1024 lds
  v_mfma_f32_16x16x32_bf16 v[140:143], a[132:135], a[148:151], v[140:143]
  v_lshlrev_b32 v192, 5, v192
  v_mfma_f32_16x16x32_bf16 v[144:147], a[128:131], a[152:155], v[144:147]
  ds_read_b128 a[144:147], v197 offset:12288
  v_add_u32 v192, v192, v252
  v_mfma_f32_16x16x32_bf16 v[148:151], a[132:135], a[152:155], v[148:151]
  v_xor_b32 v193, 3, v253
  s_waitcnt lgkmcnt(2)
  v_mfma_f32_16x16x32_bf16 v[152:155], a[128:131], a[156:159], v[152:155]
  ds_read_b128 a[148:151], v197 offset:2048
  v_lshlrev_b32 v193, 5, v193
  v_mfma_f32_16x16x32_bf16 v[156:159], a[132:135], a[156:159], v[156:159]
  v_add_u32 v193, v193, v252
  v_xor_b32 v194, 0, v253
  v_mfma_f32_16x16x32_bf16 v[160:163], a[128:131], a[160:163], v[160:163]
  ds_read_b128 a[152:155], v197 offset:14336
  v_lshlrev_b32 v194, 5, v194
  v_mfma_f32_16x16x32_bf16 v[164:167], a[132:135], a[160:163], v[164:167]
  buffer_load_dwordx4 v211, s[8:11], s44 offen offset:2048 lds
  v_add_u32 v194, v194, v252
  v_mfma_f32_16x16x32_bf16 v[168:171], a[128:131], a[164:167], v[168:171]
  ds_read_b128 a[156:159], v197 offset:4096
  v_add_u32 v194, 49152, v194
  v_mfma_f32_16x16x32_bf16 v[172:175], a[132:135], a[164:167], v[172:175]
  v_xor_b32 v195, 1, v253
  v_mfma_f32_16x16x32_bf16 v[176:179], a[128:131], a[168:171], v[176:179]
  ds_read_b128 a[160:163], v197 offset:16384
  v_lshlrev_b32 v195, 5, v195
  v_mfma_f32_16x16x32_bf16 v[180:183], a[132:135], a[168:171], v[180:183]
  v_add_u32 v195, v195, v252
  s_waitcnt lgkmcnt(2)
  v_mfma_f32_16x16x32_bf16 v[128:131], a[136:139], a[172:175], v[128:131]
  ds_read_b128 a[164:167], v202 offset:1088
  s_waitcnt vmcnt(9)
  v_mfma_f32_16x16x32_bf16 v[132:135], a[140:143], a[172:175], v[132:135]
  v_add_u32 v195, 49152, v195
  s_barrier
  v_mfma_f32_16x16x32_bf16 v[136:139], a[136:139], a[144:147], v[136:139]
  ds_read_b64_tr_b16 a[168:169], v184 offset:24576
  buffer_load_dwordx4 v212, s[8:11], s44 offen offset:3072 lds
  s_add_u32 m0, s46, 102400
  v_mfma_f32_16x16x32_bf16 v[140:143], a[140:143], a[144:147], v[140:143]
  ds_read_b64_tr_b16 a[170:171], v184 offset:24832
  v_mfma_f32_16x16x32_bf16 v[144:147], a[136:139], a[148:151], v[144:147]
  ds_read_b64_tr_b16 a[172:173], v185 offset:24576
  v_mfma_f32_16x16x32_bf16 v[148:151], a[140:143], a[148:151], v[148:151]
  ds_read_b64_tr_b16 a[174:175], v185 offset:24832
  v_mfma_f32_16x16x32_bf16 v[152:155], a[136:139], a[152:155], v[152:155]
  ds_read_b64_tr_b16 a[144:145], v184 offset:36864
  v_mfma_f32_16x16x32_bf16 v[156:159], a[140:143], a[152:155], v[156:159]
  ds_read_b64_tr_b16 a[146:147], v184 offset:37120
  s_waitcnt lgkmcnt(4)
  v_mfma_f32_16x16x32_bf16 v[160:163], a[136:139], a[156:159], v[160:163]
  ds_read_b64_tr_b16 a[148:149], v185 offset:36864
  v_mfma_f32_16x16x32_bf16 v[164:167], a[140:143], a[156:159], v[164:167]
  ds_read_b64_tr_b16 a[150:151], v185 offset:37120
  buffer_load_dwordx4 v213, s[8:11], s44 offen lds
  v_mfma_f32_16x16x32_bf16 v[168:171], a[136:139], a[160:163], v[168:171]
  ds_read_b64_tr_b16 a[152:153], v184 offset:26624
  v_mfma_f32_16x16x32_bf16 v[172:175], a[140:143], a[160:163], v[172:175]
  ds_read_b64_tr_b16 a[154:155], v184 offset:26880
  v_mfma_f32_16x16x32_bf16 v[176:179], a[136:139], a[164:167], v[176:179]
  ds_read_b64_tr_b16 a[156:157], v185 offset:26624
  v_mfma_f32_16x16x32_bf16 v[180:183], a[140:143], a[164:167], v[180:183]
  ds_read_b64_tr_b16 a[158:159], v185 offset:26880
  v_mfma_f32_16x16x32_bf16 v[0:3], a[168:171], a[0:3], 0
  ds_read_b64_tr_b16 a[160:161], v184 offset:38912
  v_xor_b32 v196, 2, v253
  v_mfma_f32_16x16x32_bf16 v[4:7], a[168:171], a[4:7], 0
  ds_read_b64_tr_b16 a[162:163], v184 offset:39168
  s_waitcnt lgkmcnt(4)
  v_mfma_f32_16x16x32_bf16 v[8:11], a[172:175], a[0:3], 0
  ds_read_b64_tr_b16 a[164:165], v185 offset:38912
  buffer_load_dwordx4 v214, s[8:11], s44 offen offset:1024 lds
  s_add_u32 s44, s64, 0
  v_mfma_f32_16x16x32_bf16 v[12:15], a[172:175], a[4:7], 0
  ds_read_b64_tr_b16 a[166:167], v185 offset:39168
  s_add_u32 m0, s46, 122880
  v_mfma_f32_16x16x32_bf16 v[32:35], a[144:147], a[0:3], 0
  ds_read_b64_tr_b16 a[168:169], v184 offset:28672
  v_lshlrev_b32 v196, 5, v196
  v_lshrrev_b32 v228, 4, v225
  v_mfma_f32_16x16x32_bf16 v[36:39], a[144:147], a[4:7], 0
  ds_read_b64_tr_b16 a[170:171], v184 offset:28928
  v_add_u32 v196, v196, v252
  v_mfma_f32_16x16x32_bf16 v[40:43], a[148:151], a[0:3], 0
  ds_read_b64_tr_b16 a[172:173], v185 offset:28672
  v_add_u32 v196, 49152, v196
  v_xor_b32 v197, 3, v253
  v_mfma_f32_16x16x32_bf16 v[44:47], a[148:151], a[4:7], 0
  ds_read_b64_tr_b16 a[174:175], v185 offset:28928
  v_lshlrev_b32 v197, 5, v197
  v_mfma_f32_16x16x32_bf16 v[0:3], a[152:155], a[8:11], v[0:3]
  ds_read_b64_tr_b16 a[144:145], v184 offset:40960
  v_add_u32 v197, v197, v252
  v_lshlrev_b32 v228, 4, v228
  v_mfma_f32_16x16x32_bf16 v[4:7], a[152:155], a[12:15], v[4:7]
  ds_read_b64_tr_b16 a[146:147], v184 offset:41216
  s_waitcnt lgkmcnt(4)
  v_mfma_f32_16x16x32_bf16 v[8:11], a[156:159], a[8:11], v[8:11]
  ds_read_b64_tr_b16 a[148:149], v185 offset:40960
  buffer_load_dwordx4 v203, s[8:11], s44 offen lds
  v_add_u32 v197, 49152, v197
  v_mfma_f32_16x16x32_bf16 v[12:15], a[156:159], a[12:15], v[12:15]
  ds_read_b64_tr_b16 a[150:151], v185 offset:41216
  v_xor_b32 v198, 0, v253
  v_mfma_f32_16x16x32_bf16 v[32:35], a[160:163], a[8:11], v[32:35]
  ds_read_b64_tr_b16 a[152:153], v184 offset:30720
  v_lshlrev_b32 v198, 5, v198
  v_add_u32 v228, s47, v228
  v_mfma_f32_16x16x32_bf16 v[36:39], a[160:163], a[12:15], v[36:39]
  ds_read_b64_tr_b16 a[154:155], v184 offset:30976
  v_add_u32 v198, v198, v252
  v_mfma_f32_16x16x32_bf16 v[40:43], a[164:167], a[8:11], v[40:43]
  ds_read_b64_tr_b16 a[156:157], v185 offset:30720
  v_add_u32 v198, 98304, v198
  v_xor_b32 v199, 1, v253
  v_mfma_f32_16x16x32_bf16 v[44:47], a[164:167], a[12:15], v[44:47]
  ds_read_b64_tr_b16 a[158:159], v185 offset:30976
  v_lshlrev_b32 v199, 5, v199
  v_mfma_f32_16x16x32_bf16 v[0:3], a[168:171], a[16:19], v[0:3]
  ds_read_b64_tr_b16 a[160:161], v184 offset:43008
  v_add_u32 v199, v199, v252
  v_mfma_f32_16x16x32_bf16 v[4:7], a[168:171], a[20:23], v[4:7]
  ds_read_b64_tr_b16 a[162:163], v184 offset:43264
  buffer_load_dwordx4 v204, s[8:11], s44 offen offset:1024 lds
  s_waitcnt lgkmcnt(4)
  v_mfma_f32_16x16x32_bf16 v[8:11], a[172:175], a[16:19], v[8:11]
  ds_read_b64_tr_b16 a[164:165], v185 offset:43008
  v_add_u32 v199, 98304, v199
  v_mfma_f32_16x16x32_bf16 v[12:15], a[172:175], a[20:23], v[12:15]
  ds_read_b64_tr_b16 a[166:167], v185 offset:43264
  v_xor_b32 v200, 2, v253
  v_add_u32 v228, 147456, v228
  v_mfma_f32_16x16x32_bf16 v[32:35], a[144:147], a[16:19], v[32:35]
  ds_read_b64_tr_b16 a[168:169], v184 offset:32768
  v_lshlrev_b32 v200, 5, v200
  v_mfma_f32_16x16x32_bf16 v[36:39], a[144:147], a[20:23], v[36:39]
  ds_read_b64_tr_b16 a[170:171], v184 offset:33024
  v_add_u32 v200, v200, v252
  ds_write_b128 v228, v[176:179] offset:0
  v_mfma_f32_16x16x32_bf16 v[40:43], a[148:151], a[16:19], v[40:43]
  ds_read_b64_tr_b16 a[172:173], v185 offset:32768
  v_add_u32 v200, 98304, v200
  v_mfma_f32_16x16x32_bf16 v[44:47], a[148:151], a[20:23], v[44:47]
  ds_read_b64_tr_b16 a[174:175], v185 offset:33024
  v_xor_b32 v201, 3, v253
  ds_write_b128 v228, v[180:183] offset:64
  v_mfma_f32_16x16x32_bf16 v[0:3], a[152:155], a[24:27], v[0:3]
  ds_read_b64_tr_b16 a[144:145], v184 offset:45056
  buffer_load_dwordx4 v205, s[8:11], s44 offen offset:2048 lds
  v_mfma_f32_16x16x32_bf16 v[4:7], a[152:155], a[28:31], v[4:7]
  ds_read_b64_tr_b16 a[146:147], v184 offset:45312
  v_lshlrev_b32 v201, 5, v201
  s_waitcnt lgkmcnt(6)
  v_mfma_f32_16x16x32_bf16 v[8:11], a[156:159], a[24:27], v[8:11]
  ds_read_b64_tr_b16 a[148:149], v185 offset:45056
  v_add_u32 v201, v201, v252
  v_mfma_f32_16x16x32_bf16 v[12:15], a[156:159], a[28:31], v[12:15]
  ds_read_b64_tr_b16 a[150:151], v185 offset:45312
  v_add_u32 v201, 98304, v201
  v_and_b32 v229, 31, v225
  v_mfma_f32_16x16x32_bf16 v[32:35], a[160:163], a[24:27], v[32:35]
  ds_read_b64_tr_b16 a[152:153], v184 offset:34816
  v_lshlrev_b32 v229, 2, v229
  v_mfma_f32_16x16x32_bf16 v[36:39], a[160:163], a[28:31], v[36:39]
  ds_read_b64_tr_b16 a[154:155], v184 offset:35072
  v_add_u32 v229, s47, v229
  v_lshrrev_b32 v209, 4, v225
  v_mfma_f32_16x16x32_bf16 v[40:43], a[164:167], a[24:27], v[40:43]
  ds_read_b64_tr_b16 a[156:157], v185 offset:34816
  v_accvgpr_read_b32 v254, a253
  v_mfma_f32_16x16x32_bf16 v[44:47], a[164:167], a[28:31], v[44:47]
  ds_read_b64_tr_b16 a[158:159], v185 offset:35072
  buffer_load_dwordx4 v206, s[8:11], s44 offen offset:3072 lds
  s_add_u32 m0, s46, 126976
  v_mfma_f32_16x16x32_bf16 v[0:3], a[168:171], a[32:35], v[0:3]
  ds_read_b64_tr_b16 a[160:161], v184 offset:47104
  s_mul_i32 s73, s70, 165888
  v_mfma_f32_16x16x32_bf16 v[4:7], a[168:171], a[36:39], v[4:7]
  ds_read_b64_tr_b16 a[162:163], v184 offset:47360
  s_mul_i32 s76, s42, 576
  s_waitcnt lgkmcnt(4)
  v_mfma_f32_16x16x32_bf16 v[8:11], a[172:175], a[32:35], v[8:11]
  ds_read_b64_tr_b16 a[164:165], v185 offset:47104
  s_waitcnt vmcnt(10)
  v_mfma_f32_16x16x32_bf16 v[12:15], a[172:175], a[36:39], v[12:15]
  ds_read_b64_tr_b16 a[166:167], v185 offset:47360
  s_barrier
  v_mfma_f32_16x16x32_bf16 v[32:35], a[144:147], a[32:35], v[32:35]
  ds_read_b64_tr_b16 a[168:169], v186
  s_add_u32 s73, s73, s76
  buffer_load_dword a252, v254, s[8:11], s73 offen sc1
  v_mfma_f32_16x16x32_bf16 v[36:39], a[144:147], a[36:39], v[36:39]
  ds_read_b64_tr_b16 a[170:171], v186 offset:256
  v_add_u32 v229, 147456, v229
  v_mfma_f32_16x16x32_bf16 v[40:43], a[148:151], a[32:35], v[40:43]
  ds_read_b64_tr_b16 a[172:173], v187
  ds_read_b32 v230, v229
  v_and_b32 v247, 15, v225
  v_mfma_f32_16x16x32_bf16 v[44:47], a[148:151], a[36:39], v[44:47]
  ds_read_b64_tr_b16 a[174:175], v187 offset:256
  v_mul_u32_u24 v247, 48, v247
  v_mfma_f32_16x16x32_bf16 v[0:3], a[152:155], a[40:43], v[0:3]
  ds_read_b64_tr_b16 a[144:145], v186 offset:12288
  v_add_u32 v247, 161280, v247
  ds_read_b64 v[236:237], v247 offset:0
  v_mfma_f32_16x16x32_bf16 v[4:7], a[152:155], a[44:47], v[4:7]
  ds_read_b64_tr_b16 a[146:147], v186 offset:12544
  s_waitcnt lgkmcnt(6)
  v_mfma_f32_16x16x32_bf16 v[8:11], a[156:159], a[40:43], v[8:11]
  ds_read_b64_tr_b16 a[148:149], v187 offset:12288
  buffer_load_dwordx4 v207, s[8:11], s44 offen lds
  ds_read_b64 v[238:239], v247 offset:768
  v_mfma_f32_16x16x32_bf16 v[12:15], a[156:159], a[44:47], v[12:15]
  ds_read_b64_tr_b16 a[150:151], v187 offset:12544
  ds_read_b64 v[240:241], v247 offset:1536
  v_mfma_f32_16x16x32_bf16 v[32:35], a[160:163], a[40:43], v[32:35]
  ds_read_b64_tr_b16 a[152:153], v186 offset:2048
  v_lshlrev_b32 v209, 1, v209
  v_and_b32 v252, 7, v225
  v_mfma_f32_16x16x32_bf16 v[36:39], a[160:163], a[44:47], v[36:39]
  ds_read_b64_tr_b16 a[154:155], v186 offset:2304
  v_xor_b32 v209, v209, v252
  v_mfma_f32_16x16x32_bf16 v[40:43], a[164:167], a[40:43], v[40:43]
  ds_read_b64_tr_b16 a[156:157], v187 offset:2048
  s_waitcnt lgkmcnt(11)
  v_cvt_pk_bf16_f32 v230, v230, v230
  v_lshlrev_b32 v209, 4, v209
  v_mfma_f32_16x16x32_bf16 v[44:47], a[164:167], a[44:47], v[44:47]
  ds_read_b64_tr_b16 a[158:159], v187 offset:2304
  v_lshlrev_b32 v230, 16, v230
  v_mfma_f32_16x16x32_bf16 v[0:3], a[168:171], a[48:51], v[0:3]
  ds_read_b64_tr_b16 a[160:161], v186 offset:14336
  v_mul_f32 v230, 0xbfb8aa3b, v230
  v_lshrrev_b32 v252, 3, v225
  v_mfma_f32_16x16x32_bf16 v[4:7], a[168:171], a[52:55], v[4:7]
  ds_read_b64_tr_b16 a[162:163], v186 offset:14592
  s_waitcnt lgkmcnt(4)
  v_mfma_f32_16x16x32_bf16 v[8:11], a[172:175], a[48:51], v[8:11]
  ds_read_b64_tr_b16 a[164:165], v187 offset:14336
  buffer_load_dwordx4 v208, s[8:11], s44 offen offset:1024 lds
  s_add_u32 s44, s44, 884736
  v_mfma_f32_16x16x32_bf16 v[12:15], a[172:175], a[52:55], v[12:15]
  ds_read_b64_tr_b16 a[166:167], v187 offset:14592
  s_add_u32 m0, s46, 73728
  v_mfma_f32_16x16x32_bf16 v[32:35], a[144:147], a[48:51], v[32:35]
  ds_read_b64_tr_b16 a[168:169], v186 offset:4096
  v_exp_f32 v230, v230
  v_mfma_f32_16x16x32_bf16 v[36:39], a[144:147], a[52:55], v[36:39]
  ds_read_b64_tr_b16 a[170:171], v186 offset:4352
  v_lshrrev_b32 v244, 4, v225
  v_mfma_f32_16x16x32_bf16 v[40:43], a[148:151], a[48:51], v[40:43]
  ds_read_b64_tr_b16 a[172:173], v187 offset:4096
  v_add_f32 v230, 1.0, v230
  v_mul_u32_u24 v252, 1152, v252
  v_mfma_f32_16x16x32_bf16 v[44:47], a[148:151], a[52:55], v[44:47]
  ds_read_b64_tr_b16 a[174:175], v187 offset:4352
  v_rcp_f32 v230, v230
  v_mfma_f32_16x16x32_bf16 v[0:3], a[152:155], a[56:59], v[0:3]
  ds_read_b64_tr_b16 a[144:145], v186 offset:16384
  v_mul_u32_u24 v244, 384, v244
  v_cvt_pk_bf16_f32 v230, v230, v230
  v_mfma_f32_16x16x32_bf16 v[4:7], a[152:155], a[60:63], v[4:7]
  ds_read_b64_tr_b16 a[146:147], v186 offset:16640
  s_waitcnt lgkmcnt(4)
  v_mfma_f32_16x16x32_bf16 v[8:11], a[156:159], a[56:59], v[8:11]
  ds_read_b64_tr_b16 a[148:149], v187 offset:16384
  buffer_load_dwordx4 v203, s[8:11], s44 offen lds
  v_lshlrev_b32 v230, 16, v230
  v_mfma_f32_16x16x32_bf16 v[12:15], a[156:159], a[60:63], v[12:15]
  ds_read_b64_tr_b16 a[150:151], v187 offset:16640
  v_sub_f32 v231, 1.0, v230
  v_mfma_f32_16x16x32_bf16 v[32:35], a[160:163], a[56:59], v[32:35]
  ds_read_b64_tr_b16 a[152:153], v186 offset:6144
  v_cvt_pk_bf16_f32 v231, v231, v231
  v_add_u32 v209, v209, v252
  v_mfma_f32_16x16x32_bf16 v[36:39], a[160:163], a[60:63], v[36:39]
  ds_read_b64_tr_b16 a[154:155], v186 offset:6400
  v_lshlrev_b32 v231, 16, v231
  v_add_f32 v232, v230, v230
  v_mfma_f32_16x16x32_bf16 v[40:43], a[164:167], a[56:59], v[40:43]
  ds_read_b64_tr_b16 a[156:157], v187 offset:6144
  ds_write_b32 v229, v231 offset:128
  v_mfma_f32_16x16x32_bf16 v[44:47], a[164:167], a[60:63], v[44:47]
  ds_read_b64_tr_b16 a[158:159], v187 offset:6400
  ds_write_b32 v229, v232 offset:256
  ds_write_b32 v229, v230 offset:384
  v_mfma_f32_16x16x32_bf16 v[0:3], a[168:171], a[64:67], v[0:3]
  ds_read_b64_tr_b16 a[160:161], v186 offset:18432
  v_and_b32 v235, 15, v225
  v_mfma_f32_16x16x32_bf16 v[4:7], a[168:171], a[68:71], v[4:7]
  ds_read_b64_tr_b16 a[162:163], v186 offset:18688
  buffer_load_dwordx4 v204, s[8:11], s44 offen offset:1024 lds
  s_waitcnt lgkmcnt(7)
  v_mfma_f32_16x16x32_bf16 v[8:11], a[172:175], a[64:67], v[8:11]
  ds_read_b64_tr_b16 a[164:165], v187 offset:18432
  v_lshlrev_b32 v235, 2, v235
  v_mfma_f32_16x16x32_bf16 v[12:15], a[172:175], a[68:71], v[12:15]
  ds_read_b64_tr_b16 a[166:167], v187 offset:18688
  v_add_u32 v235, s47, v235
  v_add_u32 v210, 8192, v209
  v_mfma_f32_16x16x32_bf16 v[32:35], a[144:147], a[64:67], v[32:35]
  ds_read_b64_tr_b16 a[168:169], v186 offset:8192
  v_add_u32 v235, 147456, v235
  v_mfma_f32_16x16x32_bf16 v[36:39], a[144:147], a[68:71], v[36:39]
  ds_read_b64_tr_b16 a[170:171], v186 offset:8448
  ds_read_b32 v215, v235 offset:128
  ds_read_b32 v216, v235 offset:192
  v_mfma_f32_16x16x32_bf16 v[40:43], a[148:151], a[64:67], v[40:43]
  ds_read_b64_tr_b16 a[172:173], v187 offset:8192
  ds_read_b128 v[176:179], v228 offset:256
  v_mfma_f32_16x16x32_bf16 v[44:47], a[148:151], a[68:71], v[44:47]
  s_waitcnt lgkmcnt(14)
  ds_read_b64_tr_b16 a[174:175], v187 offset:8448
  s_waitcnt lgkmcnt(14)
  ds_read_b128 v[180:183], v228 offset:320
  s_waitcnt lgkmcnt(14)
  ds_read_b32 v233, v235 offset:384
  v_mfma_f32_16x16x32_bf16 v[0:3], a[152:155], a[72:75], v[0:3]
  s_waitcnt lgkmcnt(14)
  ds_read_b64_tr_b16 a[144:145], v186 offset:20480
  buffer_load_dwordx4 v205, s[8:11], s44 offen offset:2048 lds
  v_mfma_f32_16x16x32_bf16 v[4:7], a[152:155], a[76:79], v[4:7]
  s_waitcnt lgkmcnt(14)
  ds_read_b64_tr_b16 a[146:147], v186 offset:20736
  s_waitcnt lgkmcnt(14)
  ds_read_b32 v234, v235 offset:448
  s_waitcnt lgkmcnt(10)
  v_mfma_f32_16x16x32_bf16 v[8:11], a[156:159], a[72:75], v[8:11]
  ds_read_b64_tr_b16 a[148:149], v187 offset:20480
  v_and_b32 v245, 15, v225
  v_add_u32 v211, 16384, v209
  v_mfma_f32_16x16x32_bf16 v[12:15], a[156:159], a[76:79], v[12:15]
  ds_read_b64_tr_b16 a[150:151], v187 offset:20736
  v_lshlrev_b32 v245, 3, v245
  v_mfma_f32_16x16x32_bf16 v[32:35], a[160:163], a[72:75], v[32:35]
  ds_read_b64_tr_b16 a[152:153], v186 offset:10240
  v_add_u32 v244, v244, v245
  v_add_u32 v212, 24576, v209
  v_mfma_f32_16x16x32_bf16 v[36:39], a[160:163], a[76:79], v[36:39]
  ds_read_b64_tr_b16 a[154:155], v186 offset:10496
  v_add_u32 v244, s47, v244
  v_mfma_f32_16x16x32_bf16 v[40:43], a[164:167], a[72:75], v[40:43]
  ds_read_b64_tr_b16 a[156:157], v187 offset:10240
  v_add_u32 v244, 147456, v244
  v_add_u32 v213, 36864, v209
  v_mfma_f32_16x16x32_bf16 v[44:47], a[164:167], a[76:79], v[44:47]
  s_waitcnt lgkmcnt(14)
  ds_read_b64_tr_b16 a[158:159], v187 offset:10496
  buffer_load_dwordx4 v206, s[8:11], s44 offen offset:3072 lds
  v_mfma_f32_16x16x32_bf16 v[0:3], a[168:171], a[80:83], v[0:3]
  s_waitcnt lgkmcnt(14)
  ds_read_b64_tr_b16 a[160:161], v186 offset:22528
  s_add_u32 m0, s46, 77824
  v_add_u32 v245, 1536, v244
  v_mfma_f32_16x16x32_bf16 v[4:7], a[168:171], a[84:87], v[4:7]
  s_waitcnt lgkmcnt(14)
  ds_read_b64_tr_b16 a[162:163], v186 offset:22784
  s_waitcnt lgkmcnt(12)
  s_waitcnt lgkmcnt(4)
  v_mfma_f32_16x16x32_bf16 v[8:11], a[172:175], a[80:83], v[8:11]
  ds_read_b64_tr_b16 a[164:165], v187 offset:22528
  s_waitcnt vmcnt(11)
  v_mfma_f32_16x16x32_bf16 v[12:15], a[172:175], a[84:87], v[12:15]
  ds_read_b64_tr_b16 a[166:167], v187 offset:22784
  v_accvgpr_write_b32 a249, v233
  s_barrier
  v_mfma_f32_16x16x32_bf16 v[32:35], a[144:147], a[80:83], v[32:35]
  ds_read_b64_tr_b16 a[168:169], v188
  v_accvgpr_write_b32 a250, v234
  v_mfma_f32_16x16x32_bf16 v[36:39], a[144:147], a[84:87], v[36:39]
  ds_read_b64_tr_b16 a[170:171], v188 offset:256
  v_fmac_f32 v129, v236, v128
  v_fmac_f32 v137, v236, v136
  v_mfma_f32_16x16x32_bf16 v[40:43], a[148:151], a[80:83], v[40:43]
  ds_read_b64_tr_b16 a[172:173], v189
  buffer_load_dwordx4 v207, s[8:11], s44 offen lds
  v_mfma_f32_16x16x32_bf16 v[44:47], a[148:151], a[84:87], v[44:47]
  ds_read_b64_tr_b16 a[174:175], v189 offset:256
  v_fmac_f32 v133, v236, v132
  v_fmac_f32 v141, v236, v140
  v_mfma_f32_16x16x32_bf16 v[0:3], a[152:155], a[88:91], v[0:3]
  ds_read_b64_tr_b16 a[144:145], v188 offset:12288
  v_fma_f32 v129, -v237, v136, v129
  v_fmac_f32 v137, v237, v128
  v_mfma_f32_16x16x32_bf16 v[4:7], a[152:155], a[92:95], v[4:7]
  ds_read_b64_tr_b16 a[146:147], v188 offset:12544
  s_waitcnt lgkmcnt(4)
  v_mfma_f32_16x16x32_bf16 v[8:11], a[156:159], a[88:91], v[8:11]
  ds_read_b64_tr_b16 a[148:149], v189 offset:12288
  v_fma_f32 v133, -v237, v140, v133
  v_fmac_f32 v141, v237, v132
  v_mfma_f32_16x16x32_bf16 v[12:15], a[156:159], a[92:95], v[12:15]
  ds_read_b64_tr_b16 a[150:151], v189 offset:12544
  v_fmac_f32 v145, v238, v144
  v_mfma_f32_16x16x32_bf16 v[32:35], a[160:163], a[88:91], v[32:35]
  ds_read_b64_tr_b16 a[152:153], v188 offset:2048
  v_fmac_f32 v153, v238, v152
  v_fmac_f32 v149, v238, v148
  v_mfma_f32_16x16x32_bf16 v[36:39], a[160:163], a[92:95], v[36:39]
  ds_read_b64_tr_b16 a[154:155], v188 offset:2304
  buffer_load_dwordx4 v208, s[8:11], s44 offen offset:1024 lds
  v_mfma_f32_16x16x32_bf16 v[40:43], a[164:167], a[88:91], v[40:43]
  ds_read_b64_tr_b16 a[156:157], v189 offset:2048
  s_add_u32 s44, s44, 884736
  s_add_u32 m0, s46, 0
  v_mfma_f32_16x16x32_bf16 v[44:47], a[164:167], a[92:95], v[44:47]
  ds_read_b64_tr_b16 a[158:159], v189 offset:2304
  v_fmac_f32 v157, v238, v156
  v_mfma_f32_16x16x32_bf16 v[0:3], a[168:171], a[96:99], v[0:3]
  ds_read_b64_tr_b16 a[160:161], v188 offset:14336
  v_fma_f32 v145, -v239, v152, v145
  v_fmac_f32 v153, v239, v144
  v_mfma_f32_16x16x32_bf16 v[4:7], a[168:171], a[100:103], v[4:7]
  ds_read_b64_tr_b16 a[162:163], v188 offset:14592
  v_fma_f32 v149, -v239, v156, v149
  s_waitcnt lgkmcnt(4)
  v_mfma_f32_16x16x32_bf16 v[8:11], a[172:175], a[96:99], v[8:11]
  ds_read_b64_tr_b16 a[164:165], v189 offset:14336
  v_fmac_f32 v157, v239, v148
  v_mfma_f32_16x16x32_bf16 v[12:15], a[172:175], a[100:103], v[12:15]
  ds_read_b64_tr_b16 a[166:167], v189 offset:14592
  v_fmac_f32 v161, v240, v160
  v_fmac_f32 v169, v240, v168
  v_mfma_f32_16x16x32_bf16 v[32:35], a[144:147], a[96:99], v[32:35]
  ds_read_b64_tr_b16 a[168:169], v188 offset:4096
  buffer_load_dwordx4 v203, s[8:11], s44 offen lds
  v_mfma_f32_16x16x32_bf16 v[36:39], a[144:147], a[100:103], v[36:39]
  ds_read_b64_tr_b16 a[170:171], v188 offset:4352
  v_fmac_f32 v165, v240, v164
  v_fmac_f32 v173, v240, v172
  v_mfma_f32_16x16x32_bf16 v[40:43], a[148:151], a[96:99], v[40:43]
  ds_read_b64_tr_b16 a[172:173], v189 offset:4096
  v_fma_f32 v161, -v241, v168, v161
  v_mfma_f32_16x16x32_bf16 v[44:47], a[148:151], a[100:103], v[44:47]
  ds_read_b64_tr_b16 a[174:175], v189 offset:4352
  v_fmac_f32 v169, v241, v160
  v_fma_f32 v165, -v241, v172, v165
  v_mfma_f32_16x16x32_bf16 v[0:3], a[152:155], a[104:107], v[0:3]
  ds_read_b64_tr_b16 a[144:145], v188 offset:16384
  v_fmac_f32 v173, v241, v164
  v_fmac_f32 v130, v236, v129
  v_mfma_f32_16x16x32_bf16 v[4:7], a[152:155], a[108:111], v[4:7]
  ds_read_b64_tr_b16 a[146:147], v188 offset:16640
  s_waitcnt lgkmcnt(4)
  v_mfma_f32_16x16x32_bf16 v[8:11], a[156:159], a[104:107], v[8:11]
  ds_read_b64_tr_b16 a[148:149], v189 offset:16384
  v_fmac_f32 v138, v236, v137
  v_fmac_f32 v134, v236, v133
  v_mfma_f32_16x16x32_bf16 v[12:15], a[156:159], a[108:111], v[12:15]
  ds_read_b64_tr_b16 a[150:151], v189 offset:16640
  buffer_load_dwordx4 v204, s[8:11], s44 offen offset:1024 lds
  v_mfma_f32_16x16x32_bf16 v[32:35], a[160:163], a[104:107], v[32:35]
  ds_read_b64_tr_b16 a[152:153], v188 offset:6144
  v_fmac_f32 v142, v236, v141
  v_fma_f32 v130, -v237, v137, v130
  v_mfma_f32_16x16x32_bf16 v[36:39], a[160:163], a[108:111], v[36:39]
  ds_read_b64_tr_b16 a[154:155], v188 offset:6400
  v_fmac_f32 v138, v237, v129
  v_mfma_f32_16x16x32_bf16 v[40:43], a[164:167], a[104:107], v[40:43]
  ds_read_b64_tr_b16 a[156:157], v189 offset:6144
  v_fma_f32 v134, -v237, v141, v134
  v_fmac_f32 v142, v237, v133
  v_mfma_f32_16x16x32_bf16 v[44:47], a[164:167], a[108:111], v[44:47]
  ds_read_b64_tr_b16 a[158:159], v189 offset:6400
  v_fmac_f32 v146, v238, v145
  v_fmac_f32 v154, v238, v153
  v_mfma_f32_16x16x32_bf16 v[0:3], a[168:171], a[112:115], v[0:3]
  ds_read_b64_tr_b16 a[160:161], v188 offset:18432
  v_fmac_f32 v150, v238, v149
  v_mfma_f32_16x16x32_bf16 v[4:7], a[168:171], a[116:119], v[4:7]
  ds_read_b64_tr_b16 a[162:163], v188 offset:18688
  v_fmac_f32 v158, v238, v157
  s_waitcnt lgkmcnt(4)
  v_mfma_f32_16x16x32_bf16 v[8:11], a[172:175], a[112:115], v[8:11]
  ds_read_b64_tr_b16 a[164:165], v189 offset:18432
  buffer_load_dwordx4 v205, s[8:11], s44 offen offset:2048 lds
  v_mfma_f32_16x16x32_bf16 v[12:15], a[172:175], a[116:119], v[12:15]
  ds_read_b64_tr_b16 a[166:167], v189 offset:18688
  v_fma_f32 v146, -v239, v153, v146
  v_fmac_f32 v154, v239, v145
  v_mfma_f32_16x16x32_bf16 v[32:35], a[144:147], a[112:115], v[32:35]
  ds_read_b64_tr_b16 a[168:169], v188 offset:8192
  v_fma_f32 v150, -v239, v157, v150
  v_mfma_f32_16x16x32_bf16 v[36:39], a[144:147], a[116:119], v[36:39]
  ds_read_b64_tr_b16 a[170:171], v188 offset:8448
  v_fmac_f32 v158, v239, v149
  v_fmac_f32 v162, v240, v161
  v_mfma_f32_16x16x32_bf16 v[40:43], a[148:151], a[112:115], v[40:43]
  ds_read_b64_tr_b16 a[172:173], v189 offset:8192
  v_fmac_f32 v170, v240, v169
  v_fmac_f32 v166, v240, v165
  v_mfma_f32_16x16x32_bf16 v[44:47], a[148:151], a[116:119], v[44:47]
  ds_read_b64_tr_b16 a[174:175], v189 offset:8448
  v_fmac_f32 v174, v240, v173
  v_mfma_f32_16x16x32_bf16 v[0:3], a[152:155], a[120:123], v[0:3]
  ds_read_b64_tr_b16 a[144:145], v188 offset:20480
  v_fma_f32 v162, -v241, v169, v162
  v_fmac_f32 v170, v241, v161
  v_mfma_f32_16x16x32_bf16 v[4:7], a[152:155], a[124:127], v[4:7]
  ds_read_b64_tr_b16 a[146:147], v188 offset:20736
  s_waitcnt lgkmcnt(4)
  v_mfma_f32_16x16x32_bf16 v[8:11], a[156:159], a[120:123], v[8:11]
  ds_read_b64_tr_b16 a[148:149], v189 offset:20480
  buffer_load_dwordx4 v206, s[8:11], s44 offen offset:3072 lds
  s_add_u32 m0, s46, 4096
  v_mfma_f32_16x16x32_bf16 v[12:15], a[156:159], a[124:127], v[12:15]
  ds_read_b64_tr_b16 a[150:151], v189 offset:20736
  v_fma_f32 v166, -v241, v173, v166
  v_mfma_f32_16x16x32_bf16 v[32:35], a[160:163], a[120:123], v[32:35]
  ds_read_b64_tr_b16 a[152:153], v188 offset:10240
  v_fmac_f32 v174, v241, v165
  v_fmac_f32 v131, v236, v130
  v_mfma_f32_16x16x32_bf16 v[36:39], a[160:163], a[124:127], v[36:39]
  ds_read_b64_tr_b16 a[154:155], v188 offset:10496
  v_fmac_f32 v139, v236, v138
  v_fmac_f32 v135, v236, v134
  v_mfma_f32_16x16x32_bf16 v[40:43], a[164:167], a[120:123], v[40:43]
  ds_read_b64_tr_b16 a[156:157], v189 offset:10240
  v_fmac_f32 v143, v236, v142
  v_mfma_f32_16x16x32_bf16 v[44:47], a[164:167], a[124:127], v[44:47]
  ds_read_b64_tr_b16 a[158:159], v189 offset:10496
  v_fma_f32 v131, -v237, v138, v131
  v_fmac_f32 v139, v237, v130
  v_mfma_f32_16x16x32_bf16 v[0:3], a[168:171], a[128:131], v[0:3]
  ds_read_b64_tr_b16 a[160:161], v188 offset:22528
  v_fma_f32 v135, -v237, v142, v135
  v_mfma_f32_16x16x32_bf16 v[4:7], a[168:171], a[132:135], v[4:7]
  ds_read_b64_tr_b16 a[162:163], v188 offset:22784
  buffer_load_dwordx4 v207, s[8:11], s44 offen lds
  s_waitcnt lgkmcnt(4)
  v_mfma_f32_16x16x32_bf16 v[8:11], a[172:175], a[128:131], v[8:11]
  ds_read_b64_tr_b16 a[164:165], v189 offset:22528
  s_waitcnt vmcnt(11)
  v_mfma_f32_16x16x32_bf16 v[12:15], a[172:175], a[132:135], v[12:15]
  ds_read_b64_tr_b16 a[166:167], v189 offset:22784
  v_fmac_f32 v143, v237, v134
  s_barrier
  v_mfma_f32_16x16x32_bf16 v[32:35], a[144:147], a[128:131], v[32:35]
  ds_read_b64_tr_b16 a[168:169], v198 offset:24576
  v_fmac_f32 v147, v238, v146
  v_fmac_f32 v155, v238, v154
  v_mfma_f32_16x16x32_bf16 v[36:39], a[144:147], a[132:135], v[36:39]
  ds_read_b64_tr_b16 a[170:171], v198 offset:25088
  v_fmac_f32 v151, v238, v150
  v_mfma_f32_16x16x32_bf16 v[40:43], a[148:151], a[128:131], v[40:43]
  ds_read_b64_tr_b16 a[172:173], v199 offset:24576
  v_fmac_f32 v159, v238, v158
  v_fma_f32 v147, -v239, v154, v147
  v_mfma_f32_16x16x32_bf16 v[44:47], a[148:151], a[132:135], v[44:47]
  ds_read_b64_tr_b16 a[174:175], v199 offset:25088
  v_fmac_f32 v155, v239, v146
  v_mfma_f32_16x16x32_bf16 v[0:3], a[152:155], a[136:139], v[0:3]
  ds_read_b64_tr_b16 a[144:145], v200 offset:24576
  buffer_load_dwordx4 v208, s[8:11], s44 offen offset:1024 lds
  v_fma_f32 v151, -v239, v158, v151
  v_mfma_f32_16x16x32_bf16 v[4:7], a[152:155], a[140:143], v[4:7]
  ds_read_b64_tr_b16 a[146:147], v200 offset:25088
  s_waitcnt lgkmcnt(4)
  v_mfma_f32_16x16x32_bf16 v[8:11], a[156:159], a[136:139], v[8:11]
  ds_read_b64_tr_b16 a[148:149], v201 offset:24576
  v_fmac_f32 v159, v239, v150
  v_fmac_f32 v163, v240, v162
  v_mfma_f32_16x16x32_bf16 v[12:15], a[156:159], a[140:143], v[12:15]
  ds_read_b64_tr_b16 a[150:151], v201 offset:25088
  v_fmac_f32 v171, v240, v170
  v_fmac_f32 v167, v240, v166
  v_mfma_f32_16x16x32_bf16 v[32:35], a[160:163], a[136:139], v[32:35]
  ds_read_b64_tr_b16 a[152:153], v198 offset:36864
  v_fmac_f32 v175, v240, v174
  v_mfma_f32_16x16x32_bf16 v[36:39], a[160:163], a[140:143], v[36:39]
  ds_read_b64_tr_b16 a[154:155], v198 offset:37376
  v_fma_f32 v163, -v241, v170, v163
  v_fmac_f32 v171, v241, v162
  v_mfma_f32_16x16x32_bf16 v[40:43], a[164:167], a[136:139], v[40:43]
  ds_read_b64_tr_b16 a[156:157], v199 offset:36864
  v_fma_f32 v167, -v241, v174, v167
  v_mfma_f32_16x16x32_bf16 v[44:47], a[164:167], a[140:143], v[44:47]
  ds_read_b64_tr_b16 a[158:159], v199 offset:37376
  v_fmac_f32 v175, v241, v166
  ds_write2_b32 v244, v131, v139 offset0:0 offset1:1
  v_mfma_f32_16x16x32_bf16 v[64:67], a[168:171], a[0:3], 0
  ds_read_b64_tr_b16 a[160:161], v200 offset:36864
  ds_write2_b32 v245, v135, v143 offset0:0 offset1:1
  v_mfma_f32_16x16x32_bf16 v[68:71], a[168:171], a[4:7], 0
  ds_read_b64_tr_b16 a[162:163], v200 offset:37376
  ds_write2_b32 v244, v147, v155 offset0:32 offset1:33
  s_waitcnt lgkmcnt(7)
  v_mfma_f32_16x16x32_bf16 v[72:75], a[172:175], a[0:3], 0
  ds_read_b64_tr_b16 a[164:165], v201 offset:36864
  ds_write2_b32 v245, v151, v159 offset0:32 offset1:33
  ds_write2_b32 v244, v163, v171 offset0:64 offset1:65
  v_mfma_f32_16x16x32_bf16 v[76:79], a[172:175], a[4:7], 0
  ds_read_b64_tr_b16 a[166:167], v201 offset:37376
  ds_write2_b32 v245, v167, v175 offset0:64 offset1:65
  v_mfma_f32_16x16x32_bf16 v[80:83], a[144:147], a[0:3], 0
  ds_read_b64_tr_b16 a[168:169], v198 offset:28672
  v_add_u32 v246, s47, v227
  s_lshl_b32 s74, s42, 4
  s_add_u32 s74, s74, s41
  s_lshl_b32 s74, s74, 7
  s_add_u32 s74, s74, 46243840
  s_cmp_eq_u32 s40, 0
  s_cselect_b32 s75, 1, 0
  v_mfma_f32_16x16x32_bf16 v[84:87], a[144:147], a[4:7], 0
  ds_read_b64_tr_b16 a[170:171], v198 offset:29184
  v_add_u32 v246, 147456, v246
  v_mfma_f32_16x16x32_bf16 v[88:91], a[148:151], a[0:3], 0
  ds_read_b64_tr_b16 a[172:173], v199 offset:28672
  s_waitcnt lgkmcnt(14)
  ds_read_b64 v[228:229], v246 offset:0
  s_waitcnt lgkmcnt(14)
  ds_read_b64 v[230:231], v246 offset:384
  v_mfma_f32_16x16x32_bf16 v[92:95], a[148:151], a[4:7], 0
  s_waitcnt lgkmcnt(14)
  ds_read_b64_tr_b16 a[174:175], v199 offset:29184
  s_waitcnt lgkmcnt(14)
  ds_read_b64 v[232:233], v246 offset:768
  v_mfma_f32_16x16x32_bf16 v[96:99], a[152:155], a[0:3], 0
  s_waitcnt lgkmcnt(14)
  ds_read_b64_tr_b16 a[144:145], v200 offset:28672
  s_waitcnt lgkmcnt(14)
  ds_read_b64 v[234:235], v246 offset:1152
  s_waitcnt lgkmcnt(14)
  ds_read_b64 v[236:237], v246 offset:1536
  v_mfma_f32_16x16x32_bf16 v[100:103], a[152:155], a[4:7], 0
  s_waitcnt lgkmcnt(14)
  ds_read_b64_tr_b16 a[146:147], v200 offset:29184
  s_waitcnt lgkmcnt(14)
  ds_read_b64 v[238:239], v246 offset:1920
  s_waitcnt lgkmcnt(10)
  v_mfma_f32_16x16x32_bf16 v[104:107], a[156:159], a[0:3], 0
  ds_read_b64_tr_b16 a[148:149], v201 offset:28672
  ds_read_b64 v[240:241], v246 offset:2304
  v_mfma_f32_16x16x32_bf16 v[108:111], a[156:159], a[4:7], 0
  ds_read_b64_tr_b16 a[150:151], v201 offset:29184
  ds_read_b64 v[242:243], v246 offset:2688
  s_mul_i32 s49, s40, 384
  s_add_u32 s49, s49, 159744
  v_mfma_f32_16x16x32_bf16 v[112:115], a[160:163], a[0:3], 0
  ds_read_b64_tr_b16 a[152:153], v198 offset:40960
  v_add_u32 v248, s49, v227
  v_mfma_f32_16x16x32_bf16 v[116:119], a[160:163], a[4:7], 0
  s_waitcnt lgkmcnt(14)
  ds_read_b64_tr_b16 a[154:155], v198 offset:41472
  v_mov_b32 v187, s74
  v_cmp_gt_u32 vcc, s75, v225
  v_mfma_f32_16x16x32_bf16 v[120:123], a[164:167], a[0:3], 0
  s_waitcnt lgkmcnt(14)
  ds_read_b64_tr_b16 a[156:157], v199 offset:40960
  s_waitcnt lgkmcnt(14)
  v_fmac_f32 v230, v217, v228
  v_mfma_f32_16x16x32_bf16 v[124:127], a[164:167], a[4:7], 0
  ds_read_b64_tr_b16 a[158:159], v199 offset:41472
  v_fmac_f32 v231, v217, v229
  v_fma_f32 v230, -v218, v229, v230
  v_mfma_f32_16x16x32_bf16 v[64:67], a[168:171], a[8:11], v[64:67]
  s_waitcnt lgkmcnt(14)
  ds_read_b64_tr_b16 a[160:161], v200 offset:40960
  v_fmac_f32 v231, v218, v228
  s_waitcnt lgkmcnt(14)
  v_fmac_f32 v232, v217, v230
  v_mfma_f32_16x16x32_bf16 v[68:71], a[168:171], a[12:15], v[68:71]
  ds_read_b64_tr_b16 a[162:163], v200 offset:41472
  s_waitcnt lgkmcnt(4)
  v_mfma_f32_16x16x32_bf16 v[72:75], a[172:175], a[8:11], v[72:75]
  ds_read_b64_tr_b16 a[164:165], v201 offset:40960
  v_fmac_f32 v233, v217, v231
  v_fma_f32 v232, -v218, v231, v232
  v_mfma_f32_16x16x32_bf16 v[76:79], a[172:175], a[12:15], v[76:79]
  ds_read_b64_tr_b16 a[166:167], v201 offset:41472
  v_fmac_f32 v233, v218, v230
  v_mfma_f32_16x16x32_bf16 v[80:83], a[144:147], a[8:11], v[80:83]
  ds_read_b64_tr_b16 a[168:169], v198 offset:32768
  v_fmac_f32 v234, v217, v232
  v_fmac_f32 v235, v217, v233
  v_mfma_f32_16x16x32_bf16 v[84:87], a[144:147], a[12:15], v[84:87]
  ds_read_b64_tr_b16 a[170:171], v198 offset:33280
  v_fma_f32 v234, -v218, v233, v234
  v_fmac_f32 v235, v218, v232
  v_mfma_f32_16x16x32_bf16 v[88:91], a[148:151], a[8:11], v[88:91]
  ds_read_b64_tr_b16 a[172:173], v199 offset:32768
  v_fmac_f32 v236, v217, v234
  v_mfma_f32_16x16x32_bf16 v[92:95], a[148:151], a[12:15], v[92:95]
  ds_read_b64_tr_b16 a[174:175], v199 offset:33280
  v_fmac_f32 v237, v217, v235
  v_fma_f32 v236, -v218, v235, v236
  v_mfma_f32_16x16x32_bf16 v[96:99], a[152:155], a[8:11], v[96:99]
  ds_read_b64_tr_b16 a[144:145], v200 offset:32768
  v_fmac_f32 v237, v218, v234
  v_mfma_f32_16x16x32_bf16 v[100:103], a[152:155], a[12:15], v[100:103]
  ds_read_b64_tr_b16 a[146:147], v200 offset:33280
  v_fmac_f32 v238, v217, v236
  s_waitcnt lgkmcnt(4)
  v_mfma_f32_16x16x32_bf16 v[104:107], a[156:159], a[8:11], v[104:107]
  ds_read_b64_tr_b16 a[148:149], v201 offset:32768
  v_fmac_f32 v239, v217, v237
  v_fma_f32 v238, -v218, v237, v238
  v_mfma_f32_16x16x32_bf16 v[108:111], a[156:159], a[12:15], v[108:111]
  ds_read_b64_tr_b16 a[150:151], v201 offset:33280
  v_fmac_f32 v239, v218, v236
  v_mfma_f32_16x16x32_bf16 v[112:115], a[160:163], a[8:11], v[112:115]
  ds_read_b64_tr_b16 a[152:153], v198 offset:45056
  v_fmac_f32 v240, v217, v238
  v_fmac_f32 v241, v217, v239
  v_mfma_f32_16x16x32_bf16 v[116:119], a[160:163], a[12:15], v[116:119]
  ds_read_b64_tr_b16 a[154:155], v198 offset:45568
  v_fma_f32 v240, -v218, v239, v240
  v_fmac_f32 v241, v218, v238
  v_mfma_f32_16x16x32_bf16 v[120:123], a[164:167], a[8:11], v[120:123]
  ds_read_b64_tr_b16 a[156:157], v199 offset:45056
  v_fmac_f32 v242, v217, v240
  v_mfma_f32_16x16x32_bf16 v[124:127], a[164:167], a[12:15], v[124:127]
  ds_read_b64_tr_b16 a[158:159], v199 offset:45568
  v_fmac_f32 v243, v217, v241
  v_fma_f32 v242, -v218, v241, v242
  v_mfma_f32_16x16x32_bf16 v[64:67], a[168:171], a[16:19], v[64:67]
  ds_read_b64_tr_b16 a[160:161], v200 offset:45056
  v_fmac_f32 v243, v218, v240
  v_mfma_f32_16x16x32_bf16 v[68:71], a[168:171], a[20:23], v[68:71]
  ds_read_b64_tr_b16 a[162:163], v200 offset:45568
  ds_write_b64 v248, v[242:243]
  s_waitcnt lgkmcnt(5)
  v_mfma_f32_16x16x32_bf16 v[72:75], a[172:175], a[16:19], v[72:75]
  ds_read_b64_tr_b16 a[164:165], v201 offset:45056
  v_mov_b32 v189, 0x7ffffff0
  s_waitcnt vmcnt(6) lgkmcnt(1)
  v_mfma_f32_16x16x32_bf16 v[76:79], a[172:175], a[20:23], v[76:79]
  ds_read_b64_tr_b16 a[166:167], v201 offset:45568
  s_barrier
  v_mfma_f32_16x16x32_bf16 v[80:83], a[144:147], a[16:19], v[80:83]
  ds_read_b64_tr_b16 a[168:169], v194 offset:24576
  v_cndmask_b32 v187, v189, v187, vcc
  v_mfma_f32_16x16x32_bf16 v[84:87], a[144:147], a[20:23], v[84:87]
  ds_read_b64_tr_b16 a[170:171], v194 offset:25088
  s_sub_u32 s74, s74, 46243840
  s_xor_b32 s74, s74, 2048
  s_add_u32 s74, s74, 46243840
  v_mfma_f32_16x16x32_bf16 v[88:91], a[148:151], a[16:19], v[88:91]
  ds_read_b64_tr_b16 a[172:173], v195 offset:24576
  v_mov_b32 v188, s74
  s_add_u32 s44, s44, 884736
  v_mfma_f32_16x16x32_bf16 v[92:95], a[148:151], a[20:23], v[92:95]
  ds_read_b64_tr_b16 a[174:175], v195 offset:25088
  s_add_u32 m0, s46, 24576
  v_mfma_f32_16x16x32_bf16 v[96:99], a[152:155], a[16:19], v[96:99]
  ds_read_b64_tr_b16 a[144:145], v196 offset:24576
  buffer_load_dwordx4 v203, s[8:11], s44 offen lds
  v_mfma_f32_16x16x32_bf16 v[100:103], a[152:155], a[20:23], v[100:103]
  ds_read_b64_tr_b16 a[146:147], v196 offset:25088
  s_waitcnt lgkmcnt(4)
  v_mfma_f32_16x16x32_bf16 v[104:107], a[156:159], a[16:19], v[104:107]
  ds_read_b64_tr_b16 a[148:149], v197 offset:24576
  v_add_u32 v248, 159744, v227
  ds_read_b64 v[228:229], v248 offset:0
  v_mfma_f32_16x16x32_bf16 v[108:111], a[156:159], a[20:23], v[108:111]
  ds_read_b64_tr_b16 a[150:151], v197 offset:25088
  ds_read_b64 v[230:231], v248 offset:384
  v_mfma_f32_16x16x32_bf16 v[112:115], a[160:163], a[16:19], v[112:115]
  ds_read_b64_tr_b16 a[152:153], v194 offset:36864
  ds_read_b64 v[232:233], v248 offset:768
  v_mfma_f32_16x16x32_bf16 v[116:119], a[160:163], a[20:23], v[116:119]
  ds_read_b64_tr_b16 a[154:155], v194 offset:37376
  ds_read_b64 v[234:235], v248 offset:1152
  v_mfma_f32_16x16x32_bf16 v[120:123], a[164:167], a[16:19], v[120:123]
  ds_read_b64_tr_b16 a[156:157], v195 offset:36864
  s_mul_i32 s49, s41, 384
  s_cmp_eq_u32 s40, 0
  s_cselect_b32 s50, 48, 0
  v_mfma_f32_16x16x32_bf16 v[124:127], a[164:167], a[20:23], v[124:127]
  ds_read_b64_tr_b16 a[158:159], v195 offset:37376
  buffer_load_dwordx4 v204, s[8:11], s44 offen offset:1024 lds
  v_mfma_f32_16x16x32_bf16 v[64:67], a[168:171], a[24:27], v[64:67]
  ds_read_b64_tr_b16 a[160:161], v196 offset:36864
  v_add_u32 v249, s49, v227
  v_mfma_f32_16x16x32_bf16 v[68:71], a[168:171], a[28:31], v[68:71]
  s_waitcnt lgkmcnt(14)
  ds_read_b64_tr_b16 a[162:163], v196 offset:37376
  s_waitcnt lgkmcnt(5)
  v_mfma_f32_16x16x32_bf16 v[72:75], a[172:175], a[24:27], v[72:75]
  ds_read_b64_tr_b16 a[164:165], v197 offset:36864
  v_cmp_gt_u32 vcc, s50, v225
  v_mov_b32 v250, 0x7ffffff0
  v_mfma_f32_16x16x32_bf16 v[76:79], a[172:175], a[28:31], v[76:79]
  ds_read_b64_tr_b16 a[166:167], v197 offset:37376
  v_fmac_f32 v230, v219, v228
  v_mfma_f32_16x16x32_bf16 v[80:83], a[144:147], a[24:27], v[80:83]
  ds_read_b64_tr_b16 a[168:169], v194 offset:28672
  v_fmac_f32 v231, v219, v229
  v_mfma_f32_16x16x32_bf16 v[84:87], a[144:147], a[28:31], v[84:87]
  ds_read_b64_tr_b16 a[170:171], v194 offset:29184
  v_fma_f32 v230, -v220, v229, v230
  v_fmac_f32 v231, v220, v228
  v_mfma_f32_16x16x32_bf16 v[88:91], a[148:151], a[24:27], v[88:91]
  ds_read_b64_tr_b16 a[172:173], v195 offset:28672
  buffer_load_dwordx4 v205, s[8:11], s44 offen offset:2048 lds
  v_mfma_f32_16x16x32_bf16 v[92:95], a[148:151], a[28:31], v[92:95]
  ds_read_b64_tr_b16 a[174:175], v195 offset:29184
  v_fmac_f32 v232, v219, v230
  v_fmac_f32 v233, v219, v231
  v_mfma_f32_16x16x32_bf16 v[96:99], a[152:155], a[24:27], v[96:99]
  ds_read_b64_tr_b16 a[144:145], v196 offset:28672
  v_fma_f32 v232, -v220, v231, v232
  v_fmac_f32 v233, v220, v230
  s_waitcnt lgkmcnt(11)
  v_fmac_f32 v234, v219, v232
  v_fmac_f32 v235, v219, v233
  buffer_load_dwordx4 v206, s[8:11], s44 offen offset:3072 lds
  s_add_u32 m0, s46, 28672
  s_nop 0
  buffer_load_dwordx4 v207, s[8:11], s44 offen lds
  buffer_load_dwordx4 v208, s[8:11], s44 offen offset:1024 lds
  v_mfma_f32_16x16x32_bf16 v[100:103], a[152:155], a[28:31], v[100:103]
  ds_read_b64_tr_b16 a[146:147], v196 offset:29184
  s_waitcnt lgkmcnt(4)
  v_mfma_f32_16x16x32_bf16 v[104:107], a[156:159], a[24:27], v[104:107]
  ds_read_b64_tr_b16 a[148:149], v197 offset:28672
  s_add_u32 s44, s44, 884736
  s_add_u32 m0, s46, 49152
  v_mfma_f32_16x16x32_bf16 v[108:111], a[156:159], a[28:31], v[108:111]
  ds_read_b64_tr_b16 a[150:151], v197 offset:29184
  v_fma_f32 v234, -v220, v233, v234
  v_mfma_f32_16x16x32_bf16 v[112:115], a[160:163], a[24:27], v[112:115]
  ds_read_b64_tr_b16 a[152:153], v194 offset:40960
  v_fmac_f32 v235, v220, v232
  v_mfma_f32_16x16x32_bf16 v[116:119], a[160:163], a[28:31], v[116:119]
  ds_read_b64_tr_b16 a[154:155], v194 offset:41472
  v_cndmask_b32 v249, v250, v249, vcc
  v_mfma_f32_16x16x32_bf16 v[120:123], a[164:167], a[24:27], v[120:123]
  ds_read_b64_tr_b16 a[156:157], v195 offset:40960
  buffer_store_dwordx2 v[234:235], v249, s[28:31], 0 offen sc1
  v_max_f32 v0, 0, v0
  v_mfma_f32_16x16x32_bf16 v[124:127], a[164:167], a[28:31], v[124:127]
  ds_read_b64_tr_b16 a[158:159], v195 offset:41472
  v_mul_f32 v32, v215, v32
  v_mfma_f32_16x16x32_bf16 v[64:67], a[168:171], a[32:35], v[64:67]
  ds_read_b64_tr_b16 a[160:161], v196 offset:40960
  v_max_f32 v1, 0, v1
  v_mfma_f32_16x16x32_bf16 v[68:71], a[168:171], a[36:39], v[68:71]
  ds_read_b64_tr_b16 a[162:163], v196 offset:41472
  s_waitcnt lgkmcnt(4)
  v_mfma_f32_16x16x32_bf16 v[72:75], a[172:175], a[32:35], v[72:75]
  ds_read_b64_tr_b16 a[164:165], v197 offset:40960
  v_mul_f32 v33, v215, v33
  v_max_f32 v2, 0, v2
  v_mfma_f32_16x16x32_bf16 v[76:79], a[172:175], a[36:39], v[76:79]
  ds_read_b64_tr_b16 a[166:167], v197 offset:41472
  buffer_load_dwordx4 v203, s[8:11], s44 offen lds
  v_mfma_f32_16x16x32_bf16 v[80:83], a[144:147], a[32:35], v[80:83]
  ds_read_b64_tr_b16 a[168:169], v194 offset:32768
  v_mul_f32 v34, v215, v34
  v_mfma_f32_16x16x32_bf16 v[84:87], a[144:147], a[36:39], v[84:87]
  ds_read_b64_tr_b16 a[170:171], v194 offset:33280
  v_max_f32 v3, 0, v3
  v_mfma_f32_16x16x32_bf16 v[88:91], a[148:151], a[32:35], v[88:91]
  ds_read_b64_tr_b16 a[172:173], v195 offset:32768
  v_mul_f32 v35, v215, v35
  v_mul_f32 v0, v0, v32
  v_mfma_f32_16x16x32_bf16 v[92:95], a[148:151], a[36:39], v[92:95]
  ds_read_b64_tr_b16 a[174:175], v195 offset:33280
  v_mul_f32 v1, v1, v33
  v_mfma_f32_16x16x32_bf16 v[96:99], a[152:155], a[32:35], v[96:99]
  ds_read_b64_tr_b16 a[144:145], v196 offset:32768
  v_mul_f32 v2, v2, v34
  v_mfma_f32_16x16x32_bf16 v[100:103], a[152:155], a[36:39], v[100:103]
  ds_read_b64_tr_b16 a[146:147], v196 offset:33280
  v_mul_f32 v3, v3, v35
  s_waitcnt lgkmcnt(4)
  v_mfma_f32_16x16x32_bf16 v[104:107], a[156:159], a[32:35], v[104:107]
  ds_read_b64_tr_b16 a[148:149], v197 offset:32768
  buffer_load_dwordx4 v204, s[8:11], s44 offen offset:1024 lds
  v_mfma_f32_16x16x32_bf16 v[108:111], a[156:159], a[36:39], v[108:111]
  ds_read_b64_tr_b16 a[150:151], v197 offset:33280
  v_max_f32 v8, 0, v8
  v_mfma_f32_16x16x32_bf16 v[112:115], a[160:163], a[32:35], v[112:115]
  ds_read_b64_tr_b16 a[152:153], v194 offset:45056
  v_mul_f32 v40, v215, v40
  v_mfma_f32_16x16x32_bf16 v[116:119], a[160:163], a[36:39], v[116:119]
  ds_read_b64_tr_b16 a[154:155], v194 offset:45568
  v_max_f32 v9, 0, v9
  v_mul_f32 v41, v215, v41
  v_mfma_f32_16x16x32_bf16 v[120:123], a[164:167], a[32:35], v[120:123]
  ds_read_b64_tr_b16 a[156:157], v195 offset:45056
  v_max_f32 v10, 0, v10
  v_mfma_f32_16x16x32_bf16 v[124:127], a[164:167], a[36:39], v[124:127]
  ds_read_b64_tr_b16 a[158:159], v195 offset:45568
  v_mul_f32 v42, v215, v42
  v_mfma_f32_16x16x32_bf16 v[64:67], a[168:171], a[40:43], v[64:67]
  ds_read_b64_tr_b16 a[160:161], v196 offset:45056
  v_max_f32 v11, 0, v11
  v_mfma_f32_16x16x32_bf16 v[68:71], a[168:171], a[44:47], v[68:71]
  ds_read_b64_tr_b16 a[162:163], v196 offset:45568
  buffer_load_dwordx4 v205, s[8:11], s44 offen offset:2048 lds
  s_waitcnt lgkmcnt(4)
  v_mfma_f32_16x16x32_bf16 v[72:75], a[172:175], a[40:43], v[72:75]
  ds_read_b64_tr_b16 a[164:165], v197 offset:45056
  s_waitcnt vmcnt(10)
  v_mfma_f32_16x16x32_bf16 v[76:79], a[172:175], a[44:47], v[76:79]
  ds_read_b64_tr_b16 a[166:167], v197 offset:45568
  s_barrier
  v_mfma_f32_16x16x32_bf16 v[80:83], a[144:147], a[40:43], v[80:83]
  ds_read_b64_tr_b16 a[168:169], v190
  v_mul_f32 v43, v215, v43
  v_mfma_f32_16x16x32_bf16 v[84:87], a[144:147], a[44:47], v[84:87]
  ds_read_b64_tr_b16 a[170:171], v190 offset:512
  v_mul_f32 v8, v8, v40
  v_mul_f32 v9, v9, v41
  v_mfma_f32_16x16x32_bf16 v[88:91], a[148:151], a[40:43], v[88:91]
  ds_read_b64_tr_b16 a[172:173], v191
  v_mul_f32 v10, v10, v42
  v_mfma_f32_16x16x32_bf16 v[92:95], a[148:151], a[44:47], v[92:95]
  ds_read_b64_tr_b16 a[174:175], v191 offset:512
  v_mul_f32 v11, v11, v43
  v_mfma_f32_16x16x32_bf16 v[96:99], a[152:155], a[40:43], v[96:99]
  ds_read_b64_tr_b16 a[144:145], v192
  buffer_load_dwordx4 v206, s[8:11], s44 offen offset:3072 lds
  v_mfma_f32_16x16x32_bf16 v[100:103], a[152:155], a[44:47], v[100:103]
  ds_read_b64_tr_b16 a[146:147], v192 offset:512
  s_add_u32 m0, s46, 53248
  s_waitcnt lgkmcnt(4)
  v_mfma_f32_16x16x32_bf16 v[104:107], a[156:159], a[40:43], v[104:107]
  ds_read_b64_tr_b16 a[148:149], v193
  v_cvt_pk_bf16_f32 v32, v0, v1
  v_mfma_f32_16x16x32_bf16 v[108:111], a[156:159], a[44:47], v[108:111]
  ds_read_b64_tr_b16 a[150:151], v193 offset:512
  v_cvt_pk_bf16_f32 v33, v2, v3
  v_mfma_f32_16x16x32_bf16 v[112:115], a[160:163], a[40:43], v[112:115]
  ds_read_b64_tr_b16 a[152:153], v190 offset:12288
  v_cvt_pk_bf16_f32 v34, v8, v9
  v_mfma_f32_16x16x32_bf16 v[116:119], a[160:163], a[44:47], v[116:119]
  ds_read_b64_tr_b16 a[154:155], v190 offset:12800
  v_cvt_pk_bf16_f32 v35, v10, v11
  v_accvgpr_write_b32 a240, v32
  v_mfma_f32_16x16x32_bf16 v[120:123], a[164:167], a[40:43], v[120:123]
  ds_read_b64_tr_b16 a[156:157], v191 offset:12288
  v_accvgpr_write_b32 a241, v33
  v_mfma_f32_16x16x32_bf16 v[124:127], a[164:167], a[44:47], v[124:127]
  ds_read_b64_tr_b16 a[158:159], v191 offset:12800
  buffer_load_dwordx4 v207, s[8:11], s44 offen lds
  v_mfma_f32_16x16x32_bf16 v[64:67], a[168:171], a[48:51], v[64:67]
  ds_read_b64_tr_b16 a[160:161], v192 offset:12288
  v_accvgpr_write_b32 a242, v34
  v_mfma_f32_16x16x32_bf16 v[68:71], a[168:171], a[52:55], v[68:71]
  ds_read_b64_tr_b16 a[162:163], v192 offset:12800
  v_accvgpr_write_b32 a243, v35
  s_waitcnt lgkmcnt(4)
  v_mfma_f32_16x16x32_bf16 v[72:75], a[172:175], a[48:51], v[72:75]
  ds_read_b64_tr_b16 a[164:165], v193 offset:12288
  v_add_u32 v214, 45056, v209
  v_mfma_f32_16x16x32_bf16 v[76:79], a[172:175], a[52:55], v[76:79]
  ds_read_b64_tr_b16 a[166:167], v193 offset:12800
  v_and_b32 v252, 15, v225
  v_mfma_f32_16x16x32_bf16 v[80:83], a[144:147], a[48:51], v[80:83]
  ds_read_b64_tr_b16 a[168:169], v190 offset:4096
  s_add_u32 s63, s61, 16384
  buffer_store_dwordx4 v[32:35], v226, s[24:27], s63 offen sc1
  v_mfma_f32_16x16x32_bf16 v[84:87], a[144:147], a[52:55], v[84:87]
  ds_read_b64_tr_b16 a[170:171], v190 offset:4608
  v_max_f32 v4, 0, v4
  v_mul_f32 v36, v216, v36
  v_mfma_f32_16x16x32_bf16 v[88:91], a[148:151], a[48:51], v[88:91]
  ds_read_b64_tr_b16 a[172:173], v191 offset:4096
  v_max_f32 v5, 0, v5
  v_mfma_f32_16x16x32_bf16 v[92:95], a[148:151], a[52:55], v[92:95]
  ds_read_b64_tr_b16 a[174:175], v191 offset:4608
  v_mul_f32 v37, v216, v37
  v_mfma_f32_16x16x32_bf16 v[96:99], a[152:155], a[48:51], v[96:99]
  ds_read_b64_tr_b16 a[144:145], v192 offset:4096
  v_max_f32 v6, 0, v6
  buffer_load_dwordx4 v208, s[8:11], s44 offen offset:1024 lds
  v_mfma_f32_16x16x32_bf16 v[100:103], a[152:155], a[52:55], v[100:103]
  ds_read_b64_tr_b16 a[146:147], v192 offset:4608
  s_add_u32 s44, s44, 884736
  s_waitcnt lgkmcnt(4)
  v_mfma_f32_16x16x32_bf16 v[104:107], a[156:159], a[48:51], v[104:107]
  ds_read_b64_tr_b16 a[148:149], v193 offset:4096
  s_add_u32 m0, s46, 98304
  v_mfma_f32_16x16x32_bf16 v[108:111], a[156:159], a[52:55], v[108:111]
  ds_read_b64_tr_b16 a[150:151], v193 offset:4608
  v_mul_f32 v38, v216, v38
  v_mfma_f32_16x16x32_bf16 v[112:115], a[160:163], a[48:51], v[112:115]
  ds_read_b64_tr_b16 a[152:153], v190 offset:16384
  v_max_f32 v7, 0, v7
  v_mfma_f32_16x16x32_bf16 v[116:119], a[160:163], a[52:55], v[116:119]
  ds_read_b64_tr_b16 a[154:155], v190 offset:16896
  v_mul_f32 v39, v216, v39
  v_mul_f32 v4, v4, v36
  v_mfma_f32_16x16x32_bf16 v[120:123], a[164:167], a[48:51], v[120:123]
  ds_read_b64_tr_b16 a[156:157], v191 offset:16384
  v_mul_f32 v5, v5, v37
  v_mfma_f32_16x16x32_bf16 v[124:127], a[164:167], a[52:55], v[124:127]
  ds_read_b64_tr_b16 a[158:159], v191 offset:16896
  v_mul_f32 v6, v6, v38
  v_mfma_f32_16x16x32_bf16 v[64:67], a[168:171], a[56:59], v[64:67]
  ds_read_b64_tr_b16 a[160:161], v192 offset:16384
  buffer_load_dwordx4 v203, s[8:11], s44 offen lds
  v_mfma_f32_16x16x32_bf16 v[68:71], a[168:171], a[60:63], v[68:71]
  ds_read_b64_tr_b16 a[162:163], v192 offset:16896
  v_mul_f32 v7, v7, v39
  s_waitcnt lgkmcnt(4)
  v_mfma_f32_16x16x32_bf16 v[72:75], a[172:175], a[56:59], v[72:75]
  ds_read_b64_tr_b16 a[164:165], v193 offset:16384
  v_max_f32 v12, 0, v12
  v_mfma_f32_16x16x32_bf16 v[76:79], a[172:175], a[60:63], v[76:79]
  ds_read_b64_tr_b16 a[166:167], v193 offset:16896
  v_mul_f32 v44, v216, v44
  v_mfma_f32_16x16x32_bf16 v[80:83], a[144:147], a[56:59], v[80:83]
  ds_read_b64_tr_b16 a[168:169], v190 offset:8192
  v_max_f32 v13, 0, v13
  v_mfma_f32_16x16x32_bf16 v[84:87], a[144:147], a[60:63], v[84:87]
  ds_read_b64_tr_b16 a[170:171], v190 offset:8704
  v_mul_f32 v45, v216, v45
  v_max_f32 v14, 0, v14
  v_mfma_f32_16x16x32_bf16 v[88:91], a[148:151], a[56:59], v[88:91]
  ds_read_b64_tr_b16 a[172:173], v191 offset:8192
  v_mul_f32 v46, v216, v46
  v_mfma_f32_16x16x32_bf16 v[92:95], a[148:151], a[60:63], v[92:95]
  ds_read_b64_tr_b16 a[174:175], v191 offset:8704
  buffer_load_dwordx4 v204, s[8:11], s44 offen offset:1024 lds
  v_mfma_f32_16x16x32_bf16 v[96:99], a[152:155], a[56:59], v[96:99]
  ds_read_b64_tr_b16 a[144:145], v192 offset:8192
  v_max_f32 v15, 0, v15
  v_mul_f32 v47, v216, v47
  v_mfma_f32_16x16x32_bf16 v[100:103], a[152:155], a[60:63], v[100:103]
  ds_read_b64_tr_b16 a[146:147], v192 offset:8704
  s_waitcnt lgkmcnt(4)
  v_mfma_f32_16x16x32_bf16 v[104:107], a[156:159], a[56:59], v[104:107]
  ds_read_b64_tr_b16 a[148:149], v193 offset:8192
  v_mul_f32 v12, v12, v44
  v_mfma_f32_16x16x32_bf16 v[108:111], a[156:159], a[60:63], v[108:111]
  ds_read_b64_tr_b16 a[150:151], v193 offset:8704
  v_mul_f32 v13, v13, v45
  v_mfma_f32_16x16x32_bf16 v[112:115], a[160:163], a[56:59], v[112:115]
  ds_read_b64_tr_b16 a[152:153], v190 offset:20480
  v_mul_f32 v14, v14, v46
  v_mul_f32 v15, v15, v47
  v_mfma_f32_16x16x32_bf16 v[116:119], a[160:163], a[60:63], v[116:119]
  ds_read_b64_tr_b16 a[154:155], v190 offset:20992
  v_cvt_pk_bf16_f32 v36, v4, v5
  v_mfma_f32_16x16x32_bf16 v[120:123], a[164:167], a[56:59], v[120:123]
  ds_read_b64_tr_b16 a[156:157], v191 offset:20480
  buffer_load_dwordx4 v205, s[8:11], s44 offen offset:2048 lds
  v_mfma_f32_16x16x32_bf16 v[124:127], a[164:167], a[60:63], v[124:127]
  ds_read_b64_tr_b16 a[158:159], v191 offset:20992
  v_cvt_pk_bf16_f32 v37, v6, v7
  v_mfma_f32_16x16x32_bf16 v[64:67], a[168:171], a[64:67], v[64:67]
  ds_read_b64_tr_b16 a[160:161], v192 offset:20480
  v_cvt_pk_bf16_f32 v38, v12, v13
  v_cvt_pk_bf16_f32 v39, v14, v15
  v_mfma_f32_16x16x32_bf16 v[68:71], a[168:171], a[68:71], v[68:71]
  ds_read_b64_tr_b16 a[162:163], v192 offset:20992
  s_waitcnt lgkmcnt(4)
  v_mfma_f32_16x16x32_bf16 v[72:75], a[172:175], a[64:67], v[72:75]
  ds_read_b64_tr_b16 a[164:165], v193 offset:20480
  s_waitcnt vmcnt(11)
  v_mfma_f32_16x16x32_bf16 v[76:79], a[172:175], a[68:71], v[76:79]
  ds_read_b64_tr_b16 a[166:167], v193 offset:20992
  s_barrier
  v_mfma_f32_16x16x32_bf16 v[80:83], a[144:147], a[64:67], v[80:83]
  ds_read_b64_tr_b16 a[168:169], v190 offset:24576
  v_accvgpr_write_b32 a244, v36
  v_accvgpr_write_b32 a245, v37
  v_mfma_f32_16x16x32_bf16 v[84:87], a[144:147], a[68:71], v[84:87]
  ds_read_b64_tr_b16 a[170:171], v190 offset:25088
  buffer_load_dwordx4 v206, s[8:11], s44 offen offset:3072 lds
  v_mfma_f32_16x16x32_bf16 v[88:91], a[148:151], a[64:67], v[88:91]
  ds_read_b64_tr_b16 a[172:173], v191 offset:24576
  s_add_u32 m0, s46, 102400
  v_mfma_f32_16x16x32_bf16 v[92:95], a[148:151], a[68:71], v[92:95]
  ds_read_b64_tr_b16 a[174:175], v191 offset:25088
  v_accvgpr_write_b32 a246, v38
  v_mfma_f32_16x16x32_bf16 v[96:99], a[152:155], a[64:67], v[96:99]
  ds_read_b64_tr_b16 a[144:145], v192 offset:24576
  v_accvgpr_write_b32 a247, v39
  v_mul_u32_u24 v253, 96, v252
  v_mfma_f32_16x16x32_bf16 v[100:103], a[152:155], a[68:71], v[100:103]
  ds_read_b64_tr_b16 a[146:147], v192 offset:25088
  s_waitcnt lgkmcnt(4)
  v_mfma_f32_16x16x32_bf16 v[104:107], a[156:159], a[64:67], v[104:107]
  ds_read_b64_tr_b16 a[148:149], v193 offset:24576
  s_add_u32 s63, s61, 16384
  buffer_store_dwordx4 v[36:39], v226, s[24:27], s63 offen offset:1024 sc1
  v_mfma_f32_16x16x32_bf16 v[108:111], a[156:159], a[68:71], v[108:111]
  ds_read_b64_tr_b16 a[150:151], v193 offset:25088
  v_lshrrev_b32 v252, 3, v252
  v_mfma_f32_16x16x32_bf16 v[112:115], a[160:163], a[64:67], v[112:115]
  ds_read_b64_tr_b16 a[152:153], v190 offset:36864
  v_lshrrev_b32 v186, 5, v225
  v_mfma_f32_16x16x32_bf16 v[116:119], a[160:163], a[68:71], v[116:119]
  ds_read_b64_tr_b16 a[154:155], v190 offset:37376
  v_xor_b32 v252, v252, v186
  v_mfma_f32_16x16x32_bf16 v[120:123], a[164:167], a[64:67], v[120:123]
  ds_read_b64_tr_b16 a[156:157], v191 offset:36864
  v_lshlrev_b32 v252, 4, v252
  v_mfma_f32_16x16x32_bf16 v[124:127], a[164:167], a[68:71], v[124:127]
  ds_read_b64_tr_b16 a[158:159], v191 offset:37376
  buffer_load_dwordx4 v207, s[8:11], s44 offen lds
  v_mfma_f32_16x16x32_bf16 v[64:67], a[168:171], a[72:75], v[64:67]
  ds_read_b64_tr_b16 a[160:161], v192 offset:36864
  v_add_u32 v252, v252, v253
  v_bfe_u32 v253, v225, 4, 1
  v_mfma_f32_16x16x32_bf16 v[68:71], a[168:171], a[76:79], v[68:71]
  ds_read_b64_tr_b16 a[162:163], v192 offset:37376
  s_waitcnt lgkmcnt(4)
  v_mfma_f32_16x16x32_bf16 v[72:75], a[172:175], a[72:75], v[72:75]
  ds_read_b64_tr_b16 a[164:165], v193 offset:36864
  v_lshlrev_b32 v253, 3, v253
  v_mfma_f32_16x16x32_bf16 v[76:79], a[172:175], a[76:79], v[76:79]
  ds_read_b64_tr_b16 a[166:167], v193 offset:37376
  v_add_u32 v184, v252, v253
  v_mfma_f32_16x16x32_bf16 v[80:83], a[144:147], a[72:75], v[80:83]
  ds_read_b64_tr_b16 a[168:169], v190 offset:28672
  v_add_u32 v185, 49152, v184
  v_add_u32 v186, 98304, v184
  v_mfma_f32_16x16x32_bf16 v[84:87], a[144:147], a[76:79], v[84:87]
  ds_read_b64_tr_b16 a[170:171], v190 offset:29184
  v_mfma_f32_16x16x32_bf16 v[88:91], a[148:151], a[72:75], v[88:91]
  ds_read_b64_tr_b16 a[172:173], v191 offset:28672
  buffer_load_dwordx4 v208, s[8:11], s44 offen offset:1024 lds
  v_mfma_f32_16x16x32_bf16 v[92:95], a[148:151], a[76:79], v[92:95]
  ds_read_b64_tr_b16 a[174:175], v191 offset:29184
  s_add_u32 s44, s64, 128
  v_mfma_f32_16x16x32_bf16 v[96:99], a[152:155], a[72:75], v[96:99]
  ds_read_b64_tr_b16 a[144:145], v192 offset:28672
  s_add_u32 m0, s46, 122880
  v_mfma_f32_16x16x32_bf16 v[100:103], a[152:155], a[76:79], v[100:103]
  ds_read_b64_tr_b16 a[146:147], v192 offset:29184
  s_waitcnt lgkmcnt(4)
  v_mfma_f32_16x16x32_bf16 v[104:107], a[156:159], a[72:75], v[104:107]
  ds_read_b64_tr_b16 a[148:149], v193 offset:28672
  v_mfma_f32_16x16x32_bf16 v[108:111], a[156:159], a[76:79], v[108:111]
  ds_read_b64_tr_b16 a[150:151], v193 offset:29184
  v_mov_b32 v251, 1
  s_waitcnt vmcnt(14)
  buffer_store_dword v251, v187, s[24:27], 0 offen sc1
  v_mfma_f32_16x16x32_bf16 v[112:115], a[160:163], a[72:75], v[112:115]
  ds_read_b64_tr_b16 a[152:153], v190 offset:40960
  v_mfma_f32_16x16x32_bf16 v[116:119], a[160:163], a[76:79], v[116:119]
  ds_read_b64_tr_b16 a[154:155], v190 offset:41472
  v_mfma_f32_16x16x32_bf16 v[120:123], a[164:167], a[72:75], v[120:123]
  ds_read_b64_tr_b16 a[156:157], v191 offset:40960
  v_mfma_f32_16x16x32_bf16 v[124:127], a[164:167], a[76:79], v[124:127]
  ds_read_b64_tr_b16 a[158:159], v191 offset:41472
  v_mfma_f32_16x16x32_bf16 v[64:67], a[168:171], a[80:83], v[64:67]
  ds_read_b64_tr_b16 a[160:161], v192 offset:40960
  buffer_load_dwordx4 v203, s[8:11], s44 offen lds
  v_mfma_f32_16x16x32_bf16 v[68:71], a[168:171], a[84:87], v[68:71]
  ds_read_b64_tr_b16 a[162:163], v192 offset:41472
  s_waitcnt lgkmcnt(4)
  v_mfma_f32_16x16x32_bf16 v[72:75], a[172:175], a[80:83], v[72:75]
  ds_read_b64_tr_b16 a[164:165], v193 offset:40960
  v_mfma_f32_16x16x32_bf16 v[76:79], a[172:175], a[84:87], v[76:79]
  ds_read_b64_tr_b16 a[166:167], v193 offset:41472
  v_mfma_f32_16x16x32_bf16 v[80:83], a[144:147], a[80:83], v[80:83]
  ds_read_b64_tr_b16 a[168:169], v190 offset:32768
  v_mfma_f32_16x16x32_bf16 v[84:87], a[144:147], a[84:87], v[84:87]
  ds_read_b64_tr_b16 a[170:171], v190 offset:33280
  v_mfma_f32_16x16x32_bf16 v[88:91], a[148:151], a[80:83], v[88:91]
  ds_read_b64_tr_b16 a[172:173], v191 offset:32768
  v_mfma_f32_16x16x32_bf16 v[92:95], a[148:151], a[84:87], v[92:95]
  ds_read_b64_tr_b16 a[174:175], v191 offset:33280
  buffer_load_dwordx4 v204, s[8:11], s44 offen offset:1024 lds
  v_mfma_f32_16x16x32_bf16 v[96:99], a[152:155], a[80:83], v[96:99]
  ds_read_b64_tr_b16 a[144:145], v192 offset:32768
  v_mfma_f32_16x16x32_bf16 v[100:103], a[152:155], a[84:87], v[100:103]
  ds_read_b64_tr_b16 a[146:147], v192 offset:33280
  s_waitcnt lgkmcnt(4)
  v_mfma_f32_16x16x32_bf16 v[104:107], a[156:159], a[80:83], v[104:107]
  ds_read_b64_tr_b16 a[148:149], v193 offset:32768
  v_mfma_f32_16x16x32_bf16 v[108:111], a[156:159], a[84:87], v[108:111]
  ds_read_b64_tr_b16 a[150:151], v193 offset:33280
  v_mfma_f32_16x16x32_bf16 v[112:115], a[160:163], a[80:83], v[112:115]
  ds_read_b64_tr_b16 a[152:153], v190 offset:45056
  v_mfma_f32_16x16x32_bf16 v[116:119], a[160:163], a[84:87], v[116:119]
  ds_read_b64_tr_b16 a[154:155], v190 offset:45568
  v_mfma_f32_16x16x32_bf16 v[120:123], a[164:167], a[80:83], v[120:123]
  ds_read_b64_tr_b16 a[156:157], v191 offset:45056
  buffer_load_dwordx4 v205, s[8:11], s44 offen offset:2048 lds
  v_mfma_f32_16x16x32_bf16 v[124:127], a[164:167], a[84:87], v[124:127]
  ds_read_b64_tr_b16 a[158:159], v191 offset:45568
  v_mfma_f32_16x16x32_bf16 v[64:67], a[168:171], a[88:91], v[64:67]
  ds_read_b64_tr_b16 a[160:161], v192 offset:45056
  v_mfma_f32_16x16x32_bf16 v[68:71], a[168:171], a[92:95], v[68:71]
  ds_read_b64_tr_b16 a[162:163], v192 offset:45568
  s_waitcnt lgkmcnt(4)
  v_mfma_f32_16x16x32_bf16 v[72:75], a[172:175], a[88:91], v[72:75]
  ds_read_b64_tr_b16 a[164:165], v193 offset:45056
  s_waitcnt vmcnt(11)
  v_mfma_f32_16x16x32_bf16 v[76:79], a[172:175], a[92:95], v[76:79]
  ds_read_b64_tr_b16 a[166:167], v193 offset:45568
  s_barrier
  v_mfma_f32_16x16x32_bf16 v[80:83], a[144:147], a[88:91], v[80:83]
  ds_read_b64_tr_b16 a[168:169], v194
  v_mfma_f32_16x16x32_bf16 v[84:87], a[144:147], a[92:95], v[84:87]
  ds_read_b64_tr_b16 a[170:171], v194 offset:512
  buffer_load_dwordx4 v206, s[8:11], s44 offen offset:3072 lds
  v_mfma_f32_16x16x32_bf16 v[88:91], a[148:151], a[88:91], v[88:91]
  ds_read_b64_tr_b16 a[172:173], v195
  s_add_u32 m0, s46, 126976
  v_mfma_f32_16x16x32_bf16 v[92:95], a[148:151], a[92:95], v[92:95]
  ds_read_b64_tr_b16 a[174:175], v195 offset:512
  v_mfma_f32_16x16x32_bf16 v[96:99], a[152:155], a[88:91], v[96:99]
  ds_read_b64_tr_b16 a[144:145], v196
  v_mfma_f32_16x16x32_bf16 v[100:103], a[152:155], a[92:95], v[100:103]
  ds_read_b64_tr_b16 a[146:147], v196 offset:512
  s_waitcnt lgkmcnt(4)
  v_mfma_f32_16x16x32_bf16 v[104:107], a[156:159], a[88:91], v[104:107]
  ds_read_b64_tr_b16 a[148:149], v197
  v_mfma_f32_16x16x32_bf16 v[108:111], a[156:159], a[92:95], v[108:111]
  ds_read_b64_tr_b16 a[150:151], v197 offset:512
  v_mfma_f32_16x16x32_bf16 v[112:115], a[160:163], a[88:91], v[112:115]
  ds_read_b64_tr_b16 a[152:153], v194 offset:12288
  buffer_load_dwordx4 v207, s[8:11], s44 offen lds
  v_mfma_f32_16x16x32_bf16 v[116:119], a[160:163], a[92:95], v[116:119]
  ds_read_b64_tr_b16 a[154:155], v194 offset:12800
  v_mfma_f32_16x16x32_bf16 v[120:123], a[164:167], a[88:91], v[120:123]
  ds_read_b64_tr_b16 a[156:157], v195 offset:12288
  v_mfma_f32_16x16x32_bf16 v[124:127], a[164:167], a[92:95], v[124:127]
  ds_read_b64_tr_b16 a[158:159], v195 offset:12800
  v_mfma_f32_16x16x32_bf16 v[64:67], a[168:171], a[96:99], v[64:67]
  ds_read_b64_tr_b16 a[160:161], v196 offset:12288
  v_mfma_f32_16x16x32_bf16 v[68:71], a[168:171], a[100:103], v[68:71]
  ds_read_b64_tr_b16 a[162:163], v196 offset:12800
  s_waitcnt lgkmcnt(4)
  v_mfma_f32_16x16x32_bf16 v[72:75], a[172:175], a[96:99], v[72:75]
  ds_read_b64_tr_b16 a[164:165], v197 offset:12288
  v_mfma_f32_16x16x32_bf16 v[76:79], a[172:175], a[100:103], v[76:79]
  ds_read_b64_tr_b16 a[166:167], v197 offset:12800
  buffer_load_dwordx4 v208, s[8:11], s44 offen offset:1024 lds
  v_mfma_f32_16x16x32_bf16 v[80:83], a[144:147], a[96:99], v[80:83]
  ds_read_b64_tr_b16 a[168:169], v194 offset:4096
  s_add_u32 s44, s44, 884736
  s_add_u32 m0, s46, 73728
  v_mfma_f32_16x16x32_bf16 v[84:87], a[144:147], a[100:103], v[84:87]
  ds_read_b64_tr_b16 a[170:171], v194 offset:4608
  v_mfma_f32_16x16x32_bf16 v[88:91], a[148:151], a[96:99], v[88:91]
  ds_read_b64_tr_b16 a[172:173], v195 offset:4096
  v_mfma_f32_16x16x32_bf16 v[92:95], a[148:151], a[100:103], v[92:95]
  ds_read_b64_tr_b16 a[174:175], v195 offset:4608
  v_mfma_f32_16x16x32_bf16 v[96:99], a[152:155], a[96:99], v[96:99]
  ds_read_b64_tr_b16 a[144:145], v196 offset:4096
  v_mfma_f32_16x16x32_bf16 v[100:103], a[152:155], a[100:103], v[100:103]
  ds_read_b64_tr_b16 a[146:147], v196 offset:4608
  s_waitcnt lgkmcnt(4)
  v_mfma_f32_16x16x32_bf16 v[104:107], a[156:159], a[96:99], v[104:107]
  ds_read_b64_tr_b16 a[148:149], v197 offset:4096
  buffer_load_dwordx4 v203, s[8:11], s44 offen lds
  v_mfma_f32_16x16x32_bf16 v[108:111], a[156:159], a[100:103], v[108:111]
  ds_read_b64_tr_b16 a[150:151], v197 offset:4608
  v_mfma_f32_16x16x32_bf16 v[112:115], a[160:163], a[96:99], v[112:115]
  ds_read_b64_tr_b16 a[152:153], v194 offset:16384
  v_mfma_f32_16x16x32_bf16 v[116:119], a[160:163], a[100:103], v[116:119]
  ds_read_b64_tr_b16 a[154:155], v194 offset:16896
  v_mfma_f32_16x16x32_bf16 v[120:123], a[164:167], a[96:99], v[120:123]
  ds_read_b64_tr_b16 a[156:157], v195 offset:16384
  v_mfma_f32_16x16x32_bf16 v[124:127], a[164:167], a[100:103], v[124:127]
  ds_read_b64_tr_b16 a[158:159], v195 offset:16896
  v_mfma_f32_16x16x32_bf16 v[64:67], a[168:171], a[104:107], v[64:67]
  ds_read_b64_tr_b16 a[160:161], v196 offset:16384
  v_mfma_f32_16x16x32_bf16 v[68:71], a[168:171], a[108:111], v[68:71]
  ds_read_b64_tr_b16 a[162:163], v196 offset:16896
  s_waitcnt lgkmcnt(4)
  v_mfma_f32_16x16x32_bf16 v[72:75], a[172:175], a[104:107], v[72:75]
  ds_read_b64_tr_b16 a[164:165], v197 offset:16384
  buffer_load_dwordx4 v204, s[8:11], s44 offen offset:1024 lds
  v_mfma_f32_16x16x32_bf16 v[76:79], a[172:175], a[108:111], v[76:79]
  ds_read_b64_tr_b16 a[166:167], v197 offset:16896
  v_mfma_f32_16x16x32_bf16 v[80:83], a[144:147], a[104:107], v[80:83]
  ds_read_b64_tr_b16 a[168:169], v194 offset:8192
  v_mfma_f32_16x16x32_bf16 v[84:87], a[144:147], a[108:111], v[84:87]
  ds_read_b64_tr_b16 a[170:171], v194 offset:8704
  v_mfma_f32_16x16x32_bf16 v[88:91], a[148:151], a[104:107], v[88:91]
  ds_read_b64_tr_b16 a[172:173], v195 offset:8192
  v_mfma_f32_16x16x32_bf16 v[92:95], a[148:151], a[108:111], v[92:95]
  ds_read_b64_tr_b16 a[174:175], v195 offset:8704
  v_mfma_f32_16x16x32_bf16 v[96:99], a[152:155], a[104:107], v[96:99]
  ds_read_b64_tr_b16 a[144:145], v196 offset:8192
  v_mfma_f32_16x16x32_bf16 v[100:103], a[152:155], a[108:111], v[100:103]
  ds_read_b64_tr_b16 a[146:147], v196 offset:8704
  buffer_load_dwordx4 v205, s[8:11], s44 offen offset:2048 lds
  s_waitcnt lgkmcnt(4)
  v_mfma_f32_16x16x32_bf16 v[104:107], a[156:159], a[104:107], v[104:107]
  ds_read_b64_tr_b16 a[148:149], v197 offset:8192
  v_mfma_f32_16x16x32_bf16 v[108:111], a[156:159], a[108:111], v[108:111]
  ds_read_b64_tr_b16 a[150:151], v197 offset:8704
  v_mfma_f32_16x16x32_bf16 v[112:115], a[160:163], a[104:107], v[112:115]
  ds_read_b64_tr_b16 a[152:153], v194 offset:20480
  v_mfma_f32_16x16x32_bf16 v[116:119], a[160:163], a[108:111], v[116:119]
  ds_read_b64_tr_b16 a[154:155], v194 offset:20992
  v_mfma_f32_16x16x32_bf16 v[120:123], a[164:167], a[104:107], v[120:123]
  ds_read_b64_tr_b16 a[156:157], v195 offset:20480
  v_mfma_f32_16x16x32_bf16 v[124:127], a[164:167], a[108:111], v[124:127]
  ds_read_b64_tr_b16 a[158:159], v195 offset:20992
  v_mfma_f32_16x16x32_bf16 v[64:67], a[168:171], a[112:115], v[64:67]
  ds_read_b64_tr_b16 a[160:161], v196 offset:20480
  buffer_load_dwordx4 v206, s[8:11], s44 offen offset:3072 lds
  v_mfma_f32_16x16x32_bf16 v[68:71], a[168:171], a[116:119], v[68:71]
  ds_read_b64_tr_b16 a[162:163], v196 offset:20992
  s_waitcnt lgkmcnt(4)
  v_mfma_f32_16x16x32_bf16 v[72:75], a[172:175], a[112:115], v[72:75]
  ds_read_b64_tr_b16 a[164:165], v197 offset:20480
  s_add_u32 m0, s46, 77824
  s_waitcnt vmcnt(11)
  v_mfma_f32_16x16x32_bf16 v[76:79], a[172:175], a[116:119], v[76:79]
  ds_read_b64_tr_b16 a[166:167], v197 offset:20992
  s_barrier
  v_mfma_f32_16x16x32_bf16 v[80:83], a[144:147], a[112:115], v[80:83]
  ds_read_b64_tr_b16 a[168:169], v198
  v_mfma_f32_16x16x32_bf16 v[84:87], a[144:147], a[116:119], v[84:87]
  ds_read_b64_tr_b16 a[170:171], v198 offset:512
  v_mfma_f32_16x16x32_bf16 v[88:91], a[148:151], a[112:115], v[88:91]
  ds_read_b64_tr_b16 a[172:173], v199
  v_mfma_f32_16x16x32_bf16 v[92:95], a[148:151], a[116:119], v[92:95]
  ds_read_b64_tr_b16 a[174:175], v199 offset:512
  buffer_load_dwordx4 v207, s[8:11], s44 offen lds
  v_mfma_f32_16x16x32_bf16 v[96:99], a[152:155], a[112:115], v[96:99]
  ds_read_b64_tr_b16 a[144:145], v200
  v_mfma_f32_16x16x32_bf16 v[100:103], a[152:155], a[116:119], v[100:103]
  ds_read_b64_tr_b16 a[146:147], v200 offset:512
  s_waitcnt lgkmcnt(4)
  v_mfma_f32_16x16x32_bf16 v[104:107], a[156:159], a[112:115], v[104:107]
  ds_read_b64_tr_b16 a[148:149], v201
  v_mfma_f32_16x16x32_bf16 v[108:111], a[156:159], a[116:119], v[108:111]
  ds_read_b64_tr_b16 a[150:151], v201 offset:512
  v_mfma_f32_16x16x32_bf16 v[112:115], a[160:163], a[112:115], v[112:115]
  ds_read_b64_tr_b16 a[152:153], v198 offset:12288
  v_mfma_f32_16x16x32_bf16 v[116:119], a[160:163], a[116:119], v[116:119]
  ds_read_b64_tr_b16 a[154:155], v198 offset:12800
  v_mfma_f32_16x16x32_bf16 v[120:123], a[164:167], a[112:115], v[120:123]
  ds_read_b64_tr_b16 a[156:157], v199 offset:12288
  buffer_load_dwordx4 v208, s[8:11], s44 offen offset:1024 lds
  v_mfma_f32_16x16x32_bf16 v[124:127], a[164:167], a[116:119], v[124:127]
  ds_read_b64_tr_b16 a[158:159], v199 offset:12800
  s_add_u32 s44, s44, 884736
  s_add_u32 m0, s46, 0
  v_mfma_f32_16x16x32_bf16 v[64:67], a[168:171], a[120:123], v[64:67]
  ds_read_b64_tr_b16 a[160:161], v200 offset:12288
  v_mfma_f32_16x16x32_bf16 v[68:71], a[168:171], a[124:127], v[68:71]
  ds_read_b64_tr_b16 a[162:163], v200 offset:12800
  s_waitcnt lgkmcnt(4)
  v_mfma_f32_16x16x32_bf16 v[72:75], a[172:175], a[120:123], v[72:75]
  ds_read_b64_tr_b16 a[164:165], v201 offset:12288
  v_mfma_f32_16x16x32_bf16 v[76:79], a[172:175], a[124:127], v[76:79]
  ds_read_b64_tr_b16 a[166:167], v201 offset:12800
  v_mfma_f32_16x16x32_bf16 v[80:83], a[144:147], a[120:123], v[80:83]
  ds_read_b64_tr_b16 a[168:169], v198 offset:4096
  v_mfma_f32_16x16x32_bf16 v[84:87], a[144:147], a[124:127], v[84:87]
  ds_read_b64_tr_b16 a[170:171], v198 offset:4608
  buffer_load_dwordx4 v203, s[8:11], s44 offen lds
  v_mfma_f32_16x16x32_bf16 v[88:91], a[148:151], a[120:123], v[88:91]
  ds_read_b64_tr_b16 a[172:173], v199 offset:4096
  v_mfma_f32_16x16x32_bf16 v[92:95], a[148:151], a[124:127], v[92:95]
  ds_read_b64_tr_b16 a[174:175], v199 offset:4608
  v_mfma_f32_16x16x32_bf16 v[96:99], a[152:155], a[120:123], v[96:99]
  ds_read_b64_tr_b16 a[144:145], v200 offset:4096
  v_mfma_f32_16x16x32_bf16 v[100:103], a[152:155], a[124:127], v[100:103]
  ds_read_b64_tr_b16 a[146:147], v200 offset:4608
  s_waitcnt lgkmcnt(4)
  v_mfma_f32_16x16x32_bf16 v[104:107], a[156:159], a[120:123], v[104:107]
  ds_read_b64_tr_b16 a[148:149], v201 offset:4096
  v_mfma_f32_16x16x32_bf16 v[108:111], a[156:159], a[124:127], v[108:111]
  ds_read_b64_tr_b16 a[150:151], v201 offset:4608
  v_mfma_f32_16x16x32_bf16 v[112:115], a[160:163], a[120:123], v[112:115]
  ds_read_b64_tr_b16 a[152:153], v198 offset:16384
  buffer_load_dwordx4 v204, s[8:11], s44 offen offset:1024 lds
  v_mfma_f32_16x16x32_bf16 v[116:119], a[160:163], a[124:127], v[116:119]
  ds_read_b64_tr_b16 a[154:155], v198 offset:16896
  v_mfma_f32_16x16x32_bf16 v[120:123], a[164:167], a[120:123], v[120:123]
  ds_read_b64_tr_b16 a[156:157], v199 offset:16384
  v_mfma_f32_16x16x32_bf16 v[124:127], a[164:167], a[124:127], v[124:127]
  ds_read_b64_tr_b16 a[158:159], v199 offset:16896
  v_mfma_f32_16x16x32_bf16 v[64:67], a[168:171], a[128:131], v[64:67]
  ds_read_b64_tr_b16 a[160:161], v200 offset:16384
  v_mfma_f32_16x16x32_bf16 v[68:71], a[168:171], a[132:135], v[68:71]
  ds_read_b64_tr_b16 a[162:163], v200 offset:16896
  s_waitcnt lgkmcnt(4)
  v_mfma_f32_16x16x32_bf16 v[72:75], a[172:175], a[128:131], v[72:75]
  ds_read_b64_tr_b16 a[164:165], v201 offset:16384
  v_mfma_f32_16x16x32_bf16 v[76:79], a[172:175], a[132:135], v[76:79]
  ds_read_b64_tr_b16 a[166:167], v201 offset:16896
  buffer_load_dwordx4 v205, s[8:11], s44 offen offset:2048 lds
  v_mfma_f32_16x16x32_bf16 v[80:83], a[144:147], a[128:131], v[80:83]
  ds_read_b64_tr_b16 a[168:169], v198 offset:8192
  v_mfma_f32_16x16x32_bf16 v[84:87], a[144:147], a[132:135], v[84:87]
  ds_read_b64_tr_b16 a[170:171], v198 offset:8704
  v_mfma_f32_16x16x32_bf16 v[88:91], a[148:151], a[128:131], v[88:91]
  ds_read_b64_tr_b16 a[172:173], v199 offset:8192
  buffer_load_dwordx4 v206, s[8:11], s44 offen offset:3072 lds
  s_add_u32 m0, s46, 4096
  s_nop 0
  buffer_load_dwordx4 v207, s[8:11], s44 offen lds
  buffer_load_dwordx4 v208, s[8:11], s44 offen offset:1024 lds
  v_mfma_f32_16x16x32_bf16 v[92:95], a[148:151], a[132:135], v[92:95]
  ds_read_b64_tr_b16 a[174:175], v199 offset:8704
  s_add_u32 s44, s44, 884736
  v_mfma_f32_16x16x32_bf16 v[96:99], a[152:155], a[128:131], v[96:99]
  ds_read_b64_tr_b16 a[144:145], v200 offset:8192
  s_add_u32 m0, s46, 24576
  v_mfma_f32_16x16x32_bf16 v[100:103], a[152:155], a[132:135], v[100:103]
  ds_read_b64_tr_b16 a[146:147], v200 offset:8704
  s_waitcnt lgkmcnt(4)
  v_mfma_f32_16x16x32_bf16 v[104:107], a[156:159], a[128:131], v[104:107]
  ds_read_b64_tr_b16 a[148:149], v201 offset:8192
  v_mfma_f32_16x16x32_bf16 v[108:111], a[156:159], a[132:135], v[108:111]
  ds_read_b64_tr_b16 a[150:151], v201 offset:8704
  v_mfma_f32_16x16x32_bf16 v[112:115], a[160:163], a[128:131], v[112:115]
  ds_read_b64_tr_b16 a[152:153], v198 offset:20480
  v_mfma_f32_16x16x32_bf16 v[116:119], a[160:163], a[132:135], v[116:119]
  ds_read_b64_tr_b16 a[154:155], v198 offset:20992
  v_mfma_f32_16x16x32_bf16 v[120:123], a[164:167], a[128:131], v[120:123]
  ds_read_b64_tr_b16 a[156:157], v199 offset:20480
  buffer_load_dwordx4 v203, s[8:11], s44 offen lds
  v_mfma_f32_16x16x32_bf16 v[124:127], a[164:167], a[132:135], v[124:127]
  ds_read_b64_tr_b16 a[158:159], v199 offset:20992
  v_mfma_f32_16x16x32_bf16 v[64:67], a[168:171], a[136:139], v[64:67]
  ds_read_b64_tr_b16 a[160:161], v200 offset:20480
  v_mfma_f32_16x16x32_bf16 v[68:71], a[168:171], a[140:143], v[68:71]
  ds_read_b64_tr_b16 a[162:163], v200 offset:20992
  s_waitcnt lgkmcnt(4)
  v_mfma_f32_16x16x32_bf16 v[72:75], a[172:175], a[136:139], v[72:75]
  ds_read_b64_tr_b16 a[164:165], v201 offset:20480
  s_waitcnt vmcnt(13)
  v_mfma_f32_16x16x32_bf16 v[76:79], a[172:175], a[140:143], v[76:79]
  ds_read_b64_tr_b16 a[166:167], v201 offset:20992
  s_barrier
  v_mfma_f32_16x16x32_bf16 v[80:83], a[144:147], a[136:139], v[80:83]
  ds_read_b64_tr_b16 a[168:169], v198 offset:24576
  s_lshl_b32 s49, s42, 4
  s_sub_u32 s50, s41, 256
  v_add_u32 v248, s49, v225
  v_lshlrev_b32 v250, 4, v225
  buffer_load_dwordx4 v204, s[8:11], s44 offen offset:1024 lds
  buffer_load_dwordx4 v205, s[8:11], s44 offen offset:2048 lds
  buffer_load_dwordx4 v206, s[8:11], s44 offen offset:3072 lds
  s_add_u32 m0, s46, 28672
  s_nop 0
  buffer_load_dwordx4 v207, s[8:11], s44 offen lds
  buffer_load_dwordx4 v208, s[8:11], s44 offen offset:1024 lds
  v_mfma_f32_16x16x32_bf16 v[84:87], a[144:147], a[140:143], v[84:87]
  ds_read_b64_tr_b16 a[170:171], v198 offset:25088
  v_add_u32 v250, s50, v250
  v_cmp_gt_u32 vcc, 16, v225
  v_mfma_f32_16x16x32_bf16 v[88:91], a[148:151], a[136:139], v[88:91]
  ds_read_b64_tr_b16 a[172:173], v199 offset:24576
  v_cndmask_b32 v248, v250, v248, vcc
  v_mfma_f32_16x16x32_bf16 v[92:95], a[148:151], a[140:143], v[92:95]
  ds_read_b64_tr_b16 a[174:175], v199 offset:25088
  v_mov_b32 v250, 0x7ffffff0
  v_mfma_f32_16x16x32_bf16 v[96:99], a[152:155], a[136:139], v[96:99]
  ds_read_b64_tr_b16 a[144:145], v200 offset:24576
  v_cmp_gt_u32 vcc, 32, v225
  s_add_u32 s44, s44, 884736
  v_mfma_f32_16x16x32_bf16 v[100:103], a[152:155], a[140:143], v[100:103]
  ds_read_b64_tr_b16 a[146:147], v200 offset:25088
  s_waitcnt lgkmcnt(4)
  v_mfma_f32_16x16x32_bf16 v[104:107], a[156:159], a[136:139], v[104:107]
  ds_read_b64_tr_b16 a[148:149], v201 offset:24576
  v_cndmask_b32 v248, v250, v248, vcc
  v_mfma_f32_16x16x32_bf16 v[108:111], a[156:159], a[140:143], v[108:111]
  ds_read_b64_tr_b16 a[150:151], v201 offset:25088
  buffer_load_ubyte v249, v248, s[32:35], 0 offen sc1
  s_add_u32 m0, s46, 49152
  v_mfma_f32_16x16x32_bf16 v[112:115], a[160:163], a[136:139], v[112:115]
  ds_read_b64_tr_b16 a[152:153], v198 offset:36864
  v_mfma_f32_16x16x32_bf16 v[116:119], a[160:163], a[140:143], v[116:119]
  ds_read_b64_tr_b16 a[154:155], v198 offset:37376
  v_mfma_f32_16x16x32_bf16 v[120:123], a[164:167], a[136:139], v[120:123]
  ds_read_b64_tr_b16 a[156:157], v199 offset:36864
  v_mfma_f32_16x16x32_bf16 v[124:127], a[164:167], a[140:143], v[124:127]
  ds_read_b64_tr_b16 a[158:159], v199 offset:37376
  v_mfma_f32_16x16x32_bf16 v[0:3], a[168:171], a[0:3], 0
  ds_read_b64_tr_b16 a[160:161], v200 offset:36864
  buffer_load_dwordx4 v203, s[8:11], s44 offen lds
  v_mfma_f32_16x16x32_bf16 v[4:7], a[168:171], a[4:7], 0
  ds_read_b64_tr_b16 a[162:163], v200 offset:37376
  s_waitcnt lgkmcnt(4)
  v_mfma_f32_16x16x32_bf16 v[8:11], a[172:175], a[0:3], 0
  ds_read_b64_tr_b16 a[164:165], v201 offset:36864
  v_mfma_f32_16x16x32_bf16 v[12:15], a[172:175], a[4:7], 0
  ds_read_b64_tr_b16 a[166:167], v201 offset:37376
  v_max_f32 v64, 0, v64
  v_mfma_f32_16x16x32_bf16 v[16:19], a[144:147], a[0:3], 0
  ds_read_b64_tr_b16 a[168:169], v198 offset:28672
  v_mul_f32 v96, v215, v96
  v_max_f32 v65, 0, v65
  v_mfma_f32_16x16x32_bf16 v[20:23], a[144:147], a[4:7], 0
  ds_read_b64_tr_b16 a[170:171], v198 offset:29184
  v_mul_f32 v97, v215, v97
  v_mfma_f32_16x16x32_bf16 v[24:27], a[148:151], a[0:3], 0
  ds_read_b64_tr_b16 a[172:173], v199 offset:28672
  v_max_f32 v66, 0, v66
  v_mfma_f32_16x16x32_bf16 v[28:31], a[148:151], a[4:7], 0
  ds_read_b64_tr_b16 a[174:175], v199 offset:29184
  buffer_load_dwordx4 v204, s[8:11], s44 offen offset:1024 lds
  v_mul_f32 v98, v215, v98
  v_mfma_f32_16x16x32_bf16 v[32:35], a[152:155], a[0:3], 0
  ds_read_b64_tr_b16 a[144:145], v200 offset:28672
  v_max_f32 v67, 0, v67
  v_mfma_f32_16x16x32_bf16 v[36:39], a[152:155], a[4:7], 0
  ds_read_b64_tr_b16 a[146:147], v200 offset:29184
  s_waitcnt lgkmcnt(4)
  v_mfma_f32_16x16x32_bf16 v[40:43], a[156:159], a[0:3], 0
  ds_read_b64_tr_b16 a[148:149], v201 offset:28672
  v_mul_f32 v99, v215, v99
  v_mul_f32 v64, v64, v96
  v_mfma_f32_16x16x32_bf16 v[44:47], a[156:159], a[4:7], 0
  ds_read_b64_tr_b16 a[150:151], v201 offset:29184
  v_mul_f32 v65, v65, v97
  v_mfma_f32_16x16x32_bf16 v[48:51], a[160:163], a[0:3], 0
  ds_read_b64_tr_b16 a[152:153], v198 offset:40960
  v_mul_f32 v66, v66, v98
  v_mfma_f32_16x16x32_bf16 v[52:55], a[160:163], a[4:7], 0
  ds_read_b64_tr_b16 a[154:155], v198 offset:41472
  v_mul_f32 v67, v67, v99
  v_max_f32 v72, 0, v72
  v_mfma_f32_16x16x32_bf16 v[56:59], a[164:167], a[0:3], 0
  ds_read_b64_tr_b16 a[156:157], v199 offset:40960
  buffer_load_dwordx4 v205, s[8:11], s44 offen offset:2048 lds
  v_mfma_f32_16x16x32_bf16 v[60:63], a[164:167], a[4:7], 0
  ds_read_b64_tr_b16 a[158:159], v199 offset:41472
  v_mul_f32 v104, v215, v104
  v_max_f32 v73, 0, v73
  v_mfma_f32_16x16x32_bf16 v[0:3], a[168:171], a[8:11], v[0:3]
  ds_read_b64_tr_b16 a[160:161], v200 offset:40960
  v_mul_f32 v105, v215, v105
  v_mfma_f32_16x16x32_bf16 v[4:7], a[168:171], a[12:15], v[4:7]
  ds_read_b64_tr_b16 a[162:163], v200 offset:41472
  s_waitcnt lgkmcnt(4)
  v_mfma_f32_16x16x32_bf16 v[8:11], a[172:175], a[8:11], v[8:11]
  ds_read_b64_tr_b16 a[164:165], v201 offset:40960
  v_max_f32 v74, 0, v74
  v_mul_f32 v106, v215, v106
  v_mfma_f32_16x16x32_bf16 v[12:15], a[172:175], a[12:15], v[12:15]
  ds_read_b64_tr_b16 a[166:167], v201 offset:41472
  v_max_f32 v75, 0, v75
  v_mfma_f32_16x16x32_bf16 v[16:19], a[144:147], a[8:11], v[16:19]
  ds_read_b64_tr_b16 a[168:169], v198 offset:32768
  v_mul_f32 v107, v215, v107
  v_mfma_f32_16x16x32_bf16 v[20:23], a[144:147], a[12:15], v[20:23]
  ds_read_b64_tr_b16 a[170:171], v198 offset:33280
  buffer_load_dwordx4 v206, s[8:11], s44 offen offset:3072 lds
  s_add_u32 m0, s46, 53248
  v_mfma_f32_16x16x32_bf16 v[24:27], a[148:151], a[8:11], v[24:27]
  ds_read_b64_tr_b16 a[172:173], v199 offset:32768
  v_accvgpr_read_b32 v254, a254
  v_mfma_f32_16x16x32_bf16 v[28:31], a[148:151], a[12:15], v[28:31]
  ds_read_b64_tr_b16 a[174:175], v199 offset:33280
  s_lshl_b32 s73, s41, 2
  v_mfma_f32_16x16x32_bf16 v[32:35], a[152:155], a[8:11], v[32:35]
  ds_read_b64_tr_b16 a[144:145], v200 offset:32768
  s_add_u32 s73, s73, s40
  s_mul_i32 s73, s73, 5248
  v_mfma_f32_16x16x32_bf16 v[36:39], a[152:155], a[12:15], v[36:39]
  ds_read_b64_tr_b16 a[146:147], v200 offset:33280
  s_waitcnt lgkmcnt(4)
  v_mfma_f32_16x16x32_bf16 v[40:43], a[156:159], a[8:11], v[40:43]
  ds_read_b64_tr_b16 a[148:149], v201 offset:32768
  s_mul_i32 s76, s42, 331776
  v_mfma_f32_16x16x32_bf16 v[44:47], a[156:159], a[12:15], v[44:47]
  ds_read_b64_tr_b16 a[150:151], v201 offset:33280
  s_add_u32 s73, s73, s76
  v_mul_f32 v72, v72, v104
  v_mfma_f32_16x16x32_bf16 v[48:51], a[160:163], a[8:11], v[48:51]
  ds_read_b64_tr_b16 a[152:153], v198 offset:45056
  buffer_load_dwordx4 v207, s[8:11], s44 offen lds
  v_mfma_f32_16x16x32_bf16 v[52:55], a[160:163], a[12:15], v[52:55]
  ds_read_b64_tr_b16 a[154:155], v198 offset:45568
  v_mul_f32 v73, v73, v105
  v_mfma_f32_16x16x32_bf16 v[56:59], a[164:167], a[8:11], v[56:59]
  ds_read_b64_tr_b16 a[156:157], v199 offset:45056
  v_mul_f32 v74, v74, v106
  v_mul_f32 v75, v75, v107
  v_mfma_f32_16x16x32_bf16 v[60:63], a[164:167], a[12:15], v[60:63]
  ds_read_b64_tr_b16 a[158:159], v199 offset:45568
  v_cvt_pk_bf16_f32 v96, v64, v65
  buffer_load_dwordx4 v208, s[8:11], s44 offen offset:1024 lds
  v_mfma_f32_16x16x32_bf16 v[0:3], a[168:171], a[16:19], v[0:3]
  ds_read_b64_tr_b16 a[160:161], v200 offset:45056
  v_cvt_pk_bf16_f32 v97, v66, v67
  v_mfma_f32_16x16x32_bf16 v[4:7], a[168:171], a[20:23], v[4:7]
  ds_read_b64_tr_b16 a[162:163], v200 offset:45568
  v_cvt_pk_bf16_f32 v98, v72, v73
  s_waitcnt lgkmcnt(4)
  v_mfma_f32_16x16x32_bf16 v[8:11], a[172:175], a[16:19], v[8:11]
  ds_read_b64_tr_b16 a[164:165], v201 offset:45056
  s_waitcnt vmcnt(19)
  v_mfma_f32_16x16x32_bf16 v[12:15], a[172:175], a[20:23], v[12:15]
  ds_read_b64_tr_b16 a[166:167], v201 offset:45568
  v_cvt_pk_bf16_f32 v99, v74, v75
  s_barrier
  v_mfma_f32_16x16x32_bf16 v[16:19], a[144:147], a[16:19], v[16:19]
  ds_read_b64_tr_b16 a[168:169], v194 offset:24576
  v_accvgpr_write_b32 a176, v96
  v_mfma_f32_16x16x32_bf16 v[20:23], a[144:147], a[20:23], v[20:23]
  ds_read_b64_tr_b16 a[170:171], v194 offset:25088
  buffer_load_dword a248, v254, s[12:15], s73 offen sc1
  v_mfma_f32_16x16x32_bf16 v[24:27], a[148:151], a[16:19], v[24:27]
  ds_read_b64_tr_b16 a[172:173], v195 offset:24576
  v_accvgpr_read_b32 v254, a255
  s_mul_i32 s73, s70, 20736
  v_mfma_f32_16x16x32_bf16 v[28:31], a[148:151], a[20:23], v[28:31]
  ds_read_b64_tr_b16 a[174:175], v195 offset:25088
  s_lshl_b32 s76, s43, 1
  v_mfma_f32_16x16x32_bf16 v[32:35], a[152:155], a[16:19], v[32:35]
  ds_read_b64_tr_b16 a[144:145], v196 offset:24576
  s_add_u32 s73, s73, s76
  v_mfma_f32_16x16x32_bf16 v[36:39], a[152:155], a[20:23], v[36:39]
  ds_read_b64_tr_b16 a[146:147], v196 offset:25088
  v_accvgpr_write_b32 a177, v97
  s_waitcnt lgkmcnt(4)
  v_mfma_f32_16x16x32_bf16 v[40:43], a[156:159], a[16:19], v[40:43]
  ds_read_b64_tr_b16 a[148:149], v197 offset:24576
  buffer_load_dword a251, v254, s[20:23], s73 offen sc1
  v_mfma_f32_16x16x32_bf16 v[44:47], a[156:159], a[20:23], v[44:47]
  ds_read_b64_tr_b16 a[150:151], v197 offset:25088
  v_accvgpr_write_b32 a178, v98
  v_mfma_f32_16x16x32_bf16 v[48:51], a[160:163], a[16:19], v[48:51]
  ds_read_b64_tr_b16 a[152:153], v194 offset:36864
  v_accvgpr_write_b32 a179, v99
  v_mfma_f32_16x16x32_bf16 v[52:55], a[160:163], a[20:23], v[52:55]
  ds_read_b64_tr_b16 a[154:155], v194 offset:37376
  v_mfma_f32_16x16x32_bf16 v[56:59], a[164:167], a[16:19], v[56:59]
  ds_read_b64_tr_b16 a[156:157], v195 offset:36864
  v_mfma_f32_16x16x32_bf16 v[60:63], a[164:167], a[20:23], v[60:63]
  ds_read_b64_tr_b16 a[158:159], v195 offset:37376
  s_add_u32 s63, s61, 0
  buffer_store_dwordx4 v[96:99], v226, s[24:27], s63 offen sc1
  v_mfma_f32_16x16x32_bf16 v[0:3], a[168:171], a[24:27], v[0:3]
  ds_read_b64_tr_b16 a[160:161], v196 offset:36864
  v_max_f32 v68, 0, v68
  v_mfma_f32_16x16x32_bf16 v[4:7], a[168:171], a[28:31], v[4:7]
  ds_read_b64_tr_b16 a[162:163], v196 offset:37376
  s_waitcnt lgkmcnt(4)
  v_mfma_f32_16x16x32_bf16 v[8:11], a[172:175], a[24:27], v[8:11]
  ds_read_b64_tr_b16 a[164:165], v197 offset:36864
  v_mul_f32 v100, v216, v100
  v_max_f32 v69, 0, v69
  v_mfma_f32_16x16x32_bf16 v[12:15], a[172:175], a[28:31], v[12:15]
  ds_read_b64_tr_b16 a[166:167], v197 offset:37376
  v_mul_f32 v101, v216, v101
  v_mfma_f32_16x16x32_bf16 v[16:19], a[144:147], a[24:27], v[16:19]
  ds_read_b64_tr_b16 a[168:169], v194 offset:28672
  v_max_f32 v70, 0, v70
  v_mfma_f32_16x16x32_bf16 v[20:23], a[144:147], a[28:31], v[20:23]
  ds_read_b64_tr_b16 a[170:171], v194 offset:29184
  v_mul_f32 v102, v216, v102
  v_max_f32 v71, 0, v71
  v_mfma_f32_16x16x32_bf16 v[24:27], a[148:151], a[24:27], v[24:27]
  ds_read_b64_tr_b16 a[172:173], v195 offset:28672
  v_mul_f32 v103, v216, v103
  v_mfma_f32_16x16x32_bf16 v[28:31], a[148:151], a[28:31], v[28:31]
  ds_read_b64_tr_b16 a[174:175], v195 offset:29184
  v_mul_f32 v68, v68, v100
  v_mul_f32 v69, v69, v101
  v_mfma_f32_16x16x32_bf16 v[32:35], a[152:155], a[24:27], v[32:35]
  ds_read_b64_tr_b16 a[144:145], v196 offset:28672
  v_mul_f32 v70, v70, v102
  v_mfma_f32_16x16x32_bf16 v[36:39], a[152:155], a[28:31], v[36:39]
  ds_read_b64_tr_b16 a[146:147], v196 offset:29184
  s_waitcnt lgkmcnt(4)
  v_mfma_f32_16x16x32_bf16 v[40:43], a[156:159], a[24:27], v[40:43]
  ds_read_b64_tr_b16 a[148:149], v197 offset:28672
  v_mul_f32 v71, v71, v103
  v_max_f32 v76, 0, v76
  v_mfma_f32_16x16x32_bf16 v[44:47], a[156:159], a[28:31], v[44:47]
  ds_read_b64_tr_b16 a[150:151], v197 offset:29184
  v_mul_f32 v108, v216, v108
  v_mfma_f32_16x16x32_bf16 v[48:51], a[160:163], a[24:27], v[48:51]
  ds_read_b64_tr_b16 a[152:153], v194 offset:40960
  v_max_f32 v77, 0, v77
  v_mfma_f32_16x16x32_bf16 v[52:55], a[160:163], a[28:31], v[52:55]
  ds_read_b64_tr_b16 a[154:155], v194 offset:41472
  v_mul_f32 v109, v216, v109
  v_max_f32 v78, 0, v78
  v_mfma_f32_16x16x32_bf16 v[56:59], a[164:167], a[24:27], v[56:59]
  ds_read_b64_tr_b16 a[156:157], v195 offset:40960
  v_mul_f32 v110, v216, v110
  v_mfma_f32_16x16x32_bf16 v[60:63], a[164:167], a[28:31], v[60:63]
  ds_read_b64_tr_b16 a[158:159], v195 offset:41472
  v_max_f32 v79, 0, v79
  v_mfma_f32_16x16x32_bf16 v[0:3], a[168:171], a[32:35], v[0:3]
  ds_read_b64_tr_b16 a[160:161], v196 offset:40960
  v_mul_f32 v111, v216, v111
  v_mul_f32 v76, v76, v108
  v_mfma_f32_16x16x32_bf16 v[4:7], a[168:171], a[36:39], v[4:7]
  ds_read_b64_tr_b16 a[162:163], v196 offset:41472
  s_waitcnt lgkmcnt(4)
  v_mfma_f32_16x16x32_bf16 v[8:11], a[172:175], a[32:35], v[8:11]
  ds_read_b64_tr_b16 a[164:165], v197 offset:40960
  v_mul_f32 v77, v77, v109
  v_mfma_f32_16x16x32_bf16 v[12:15], a[172:175], a[36:39], v[12:15]
  ds_read_b64_tr_b16 a[166:167], v197 offset:41472
  v_mul_f32 v78, v78, v110
  v_mul_f32 v79, v79, v111
  v_mfma_f32_16x16x32_bf16 v[16:19], a[144:147], a[32:35], v[16:19]
  ds_read_b64_tr_b16 a[168:169], v194 offset:32768
  v_cvt_pk_bf16_f32 v100, v68, v69
  v_mfma_f32_16x16x32_bf16 v[20:23], a[144:147], a[36:39], v[20:23]
  ds_read_b64_tr_b16 a[170:171], v194 offset:33280
  v_cvt_pk_bf16_f32 v101, v70, v71
  v_mfma_f32_16x16x32_bf16 v[24:27], a[148:151], a[32:35], v[24:27]
  ds_read_b64_tr_b16 a[172:173], v195 offset:32768
  v_cvt_pk_bf16_f32 v102, v76, v77
  v_cvt_pk_bf16_f32 v103, v78, v79
  v_mfma_f32_16x16x32_bf16 v[28:31], a[148:151], a[36:39], v[28:31]
  ds_read_b64_tr_b16 a[174:175], v195 offset:33280
  v_accvgpr_write_b32 a180, v100
  v_mfma_f32_16x16x32_bf16 v[32:35], a[152:155], a[32:35], v[32:35]
  ds_read_b64_tr_b16 a[144:145], v196 offset:32768
  v_accvgpr_write_b32 a181, v101
  v_accvgpr_write_b32 a182, v102
  v_mfma_f32_16x16x32_bf16 v[36:39], a[152:155], a[36:39], v[36:39]
  ds_read_b64_tr_b16 a[146:147], v196 offset:33280
  s_waitcnt lgkmcnt(4)
  v_mfma_f32_16x16x32_bf16 v[40:43], a[156:159], a[32:35], v[40:43]
  ds_read_b64_tr_b16 a[148:149], v197 offset:32768
  v_accvgpr_write_b32 a183, v103
  v_mfma_f32_16x16x32_bf16 v[44:47], a[156:159], a[36:39], v[44:47]
  ds_read_b64_tr_b16 a[150:151], v197 offset:33280
  s_add_u32 s63, s61, 0
  buffer_store_dwordx4 v[100:103], v226, s[24:27], s63 offen offset:1024 sc1
  v_mfma_f32_16x16x32_bf16 v[48:51], a[160:163], a[32:35], v[48:51]
  ds_read_b64_tr_b16 a[152:153], v194 offset:45056
  v_max_f32 v80, 0, v80
  v_mfma_f32_16x16x32_bf16 v[52:55], a[160:163], a[36:39], v[52:55]
  ds_read_b64_tr_b16 a[154:155], v194 offset:45568
  v_mul_f32 v112, v215, v112
  v_mfma_f32_16x16x32_bf16 v[56:59], a[164:167], a[32:35], v[56:59]
  ds_read_b64_tr_b16 a[156:157], v195 offset:45056
  v_max_f32 v81, 0, v81
  v_mul_f32 v113, v215, v113
  v_mfma_f32_16x16x32_bf16 v[60:63], a[164:167], a[36:39], v[60:63]
  ds_read_b64_tr_b16 a[158:159], v195 offset:45568
  v_max_f32 v82, 0, v82
  v_mfma_f32_16x16x32_bf16 v[0:3], a[168:171], a[40:43], v[0:3]
  ds_read_b64_tr_b16 a[160:161], v196 offset:45056
  v_mul_f32 v114, v215, v114
  v_mfma_f32_16x16x32_bf16 v[4:7], a[168:171], a[44:47], v[4:7]
  ds_read_b64_tr_b16 a[162:163], v196 offset:45568
  v_max_f32 v83, 0, v83
  s_waitcnt lgkmcnt(4)
  v_mfma_f32_16x16x32_bf16 v[8:11], a[172:175], a[40:43], v[8:11]
  ds_read_b64_tr_b16 a[164:165], v197 offset:45056
  s_waitcnt vmcnt(17)
  v_mfma_f32_16x16x32_bf16 v[12:15], a[172:175], a[44:47], v[12:15]
  ds_read_b64_tr_b16 a[166:167], v197 offset:45568
  s_barrier
  v_mfma_f32_16x16x32_bf16 v[16:19], a[144:147], a[40:43], v[16:19]
  ds_read_b64_tr_b16 a[168:169], v190
  v_mul_f32 v115, v215, v115
  v_mul_f32 v80, v80, v112
  v_mfma_f32_16x16x32_bf16 v[20:23], a[144:147], a[44:47], v[20:23]
  ds_read_b64_tr_b16 a[170:171], v190 offset:512
  s_waitcnt vmcnt(10)
  v_cmp_ne_u32 vcc, 0, v249
  s_nop 3
  s_or_b32 vcc_hi, vcc_hi, -1
  s_cmp_eq_u64 vcc, -1
  s_cbranch_scc0 L_slow_C1
L_back_C1:
  v_mfma_f32_16x16x32_bf16 v[24:27], a[148:151], a[40:43], v[24:27]
  ds_read_b64_tr_b16 a[172:173], v191
  s_lshl_b32 s49, s42, 11
  s_add_u32 s49, s49, 46243840
  v_mfma_f32_16x16x32_bf16 v[28:31], a[148:151], a[44:47], v[28:31]
  ds_read_b64_tr_b16 a[174:175], v191 offset:512
  v_lshlrev_b32 v248, 7, v225
  v_mul_f32 v81, v81, v113
  v_mfma_f32_16x16x32_bf16 v[32:35], a[152:155], a[40:43], v[32:35]
  ds_read_b64_tr_b16 a[144:145], v192
  v_add_u32 v248, s49, v248
  v_mfma_f32_16x16x32_bf16 v[36:39], a[152:155], a[44:47], v[36:39]
  ds_read_b64_tr_b16 a[146:147], v192 offset:512
  s_waitcnt lgkmcnt(4)
  v_mfma_f32_16x16x32_bf16 v[40:43], a[156:159], a[40:43], v[40:43]
  ds_read_b64_tr_b16 a[148:149], v193
  v_cmp_gt_u32 vcc, 16, v225
  v_mov_b32 v250, 0x7ffffff0
  v_mfma_f32_16x16x32_bf16 v[44:47], a[156:159], a[44:47], v[44:47]
  ds_read_b64_tr_b16 a[150:151], v193 offset:512
  v_cndmask_b32 v248, v250, v248, vcc
  v_mfma_f32_16x16x32_bf16 v[48:51], a[160:163], a[40:43], v[48:51]
  ds_read_b64_tr_b16 a[152:153], v190 offset:12288
  buffer_load_dword v249, v248, s[24:27], 0 offen sc1
  v_mul_f32 v82, v82, v114
  v_mfma_f32_16x16x32_bf16 v[52:55], a[160:163], a[44:47], v[52:55]
  ds_read_b64_tr_b16 a[154:155], v190 offset:12800
  v_mul_f32 v83, v83, v115
  v_mfma_f32_16x16x32_bf16 v[56:59], a[164:167], a[40:43], v[56:59]
  ds_read_b64_tr_b16 a[156:157], v191 offset:12288
  v_max_f32 v88, 0, v88
  v_mfma_f32_16x16x32_bf16 v[60:63], a[164:167], a[44:47], v[60:63]
  ds_read_b64_tr_b16 a[158:159], v191 offset:12800
  v_mul_f32 v120, v215, v120
  v_max_f32 v89, 0, v89
  v_mfma_f32_16x16x32_bf16 v[0:3], a[168:171], a[48:51], v[0:3]
  ds_read_b64_tr_b16 a[160:161], v192 offset:12288
  v_mul_f32 v121, v215, v121
  v_mfma_f32_16x16x32_bf16 v[4:7], a[168:171], a[52:55], v[4:7]
  ds_read_b64_tr_b16 a[162:163], v192 offset:12800
  s_waitcnt lgkmcnt(4)
  v_mfma_f32_16x16x32_bf16 v[8:11], a[172:175], a[48:51], v[8:11]
  ds_read_b64_tr_b16 a[164:165], v193 offset:12288
  v_max_f32 v90, 0, v90
  v_mul_f32 v122, v215, v122
  v_mfma_f32_16x16x32_bf16 v[12:15], a[172:175], a[52:55], v[12:15]
  ds_read_b64_tr_b16 a[166:167], v193 offset:12800
  v_max_f32 v91, 0, v91
  v_mfma_f32_16x16x32_bf16 v[16:19], a[144:147], a[48:51], v[16:19]
  ds_read_b64_tr_b16 a[168:169], v190 offset:4096
  v_mul_f32 v123, v215, v123
  v_mfma_f32_16x16x32_bf16 v[20:23], a[144:147], a[52:55], v[20:23]
  ds_read_b64_tr_b16 a[170:171], v190 offset:4608
  v_mul_f32 v88, v88, v120
  v_mul_f32 v89, v89, v121
  v_mfma_f32_16x16x32_bf16 v[24:27], a[148:151], a[48:51], v[24:27]
  ds_read_b64_tr_b16 a[172:173], v191 offset:4096
  v_mul_f32 v90, v90, v122
  v_mfma_f32_16x16x32_bf16 v[28:31], a[148:151], a[52:55], v[28:31]
  ds_read_b64_tr_b16 a[174:175], v191 offset:4608
  v_mul_f32 v91, v91, v123
  v_mfma_f32_16x16x32_bf16 v[32:35], a[152:155], a[48:51], v[32:35]
  ds_read_b64_tr_b16 a[144:145], v192 offset:4096
  v_cvt_pk_bf16_f32 v112, v80, v81
  v_cvt_pk_bf16_f32 v113, v82, v83
  v_mfma_f32_16x16x32_bf16 v[36:39], a[152:155], a[52:55], v[36:39]
  ds_read_b64_tr_b16 a[146:147], v192 offset:4608
  s_waitcnt lgkmcnt(4)
  v_mfma_f32_16x16x32_bf16 v[40:43], a[156:159], a[48:51], v[40:43]
  ds_read_b64_tr_b16 a[148:149], v193 offset:4096
  v_cvt_pk_bf16_f32 v114, v88, v89
  v_mfma_f32_16x16x32_bf16 v[44:47], a[156:159], a[52:55], v[44:47]
  ds_read_b64_tr_b16 a[150:151], v193 offset:4608
  v_cvt_pk_bf16_f32 v115, v90, v91
  v_accvgpr_write_b32 a184, v112
  v_mfma_f32_16x16x32_bf16 v[48:51], a[160:163], a[48:51], v[48:51]
  ds_read_b64_tr_b16 a[152:153], v190 offset:16384
  v_accvgpr_write_b32 a185, v113
  v_mfma_f32_16x16x32_bf16 v[52:55], a[160:163], a[52:55], v[52:55]
  ds_read_b64_tr_b16 a[154:155], v190 offset:16896
  v_accvgpr_write_b32 a186, v114
  v_mfma_f32_16x16x32_bf16 v[56:59], a[164:167], a[48:51], v[56:59]
  ds_read_b64_tr_b16 a[156:157], v191 offset:16384
  v_accvgpr_write_b32 a187, v115
  s_add_u32 s63, s61, 0
  buffer_store_dwordx4 v[112:115], v226, s[24:27], s63 offen offset:2048 sc1
  v_mfma_f32_16x16x32_bf16 v[60:63], a[164:167], a[52:55], v[60:63]
  ds_read_b64_tr_b16 a[158:159], v191 offset:16896
  v_max_f32 v84, 0, v84
  v_mfma_f32_16x16x32_bf16 v[0:3], a[168:171], a[56:59], v[0:3]
  ds_read_b64_tr_b16 a[160:161], v192 offset:16384
  v_mul_f32 v116, v216, v116
  v_mfma_f32_16x16x32_bf16 v[4:7], a[168:171], a[60:63], v[4:7]
  ds_read_b64_tr_b16 a[162:163], v192 offset:16896
  v_max_f32 v85, 0, v85
  s_waitcnt lgkmcnt(4)
  v_mfma_f32_16x16x32_bf16 v[8:11], a[172:175], a[56:59], v[8:11]
  ds_read_b64_tr_b16 a[164:165], v193 offset:16384
  v_mul_f32 v117, v216, v117
  v_mfma_f32_16x16x32_bf16 v[12:15], a[172:175], a[60:63], v[12:15]
  ds_read_b64_tr_b16 a[166:167], v193 offset:16896
  v_max_f32 v86, 0, v86
  v_mfma_f32_16x16x32_bf16 v[16:19], a[144:147], a[56:59], v[16:19]
  ds_read_b64_tr_b16 a[168:169], v190 offset:8192
  v_mul_f32 v118, v216, v118
  v_max_f32 v87, 0, v87
  v_mfma_f32_16x16x32_bf16 v[20:23], a[144:147], a[60:63], v[20:23]
  ds_read_b64_tr_b16 a[170:171], v190 offset:8704
  v_mul_f32 v119, v216, v119
  v_mfma_f32_16x16x32_bf16 v[24:27], a[148:151], a[56:59], v[24:27]
  ds_read_b64_tr_b16 a[172:173], v191 offset:8192
  v_mul_f32 v84, v84, v116
  v_mul_f32 v85, v85, v117
  v_mfma_f32_16x16x32_bf16 v[28:31], a[148:151], a[60:63], v[28:31]
  ds_read_b64_tr_b16 a[174:175], v191 offset:8704
  v_mul_f32 v86, v86, v118
  v_mfma_f32_16x16x32_bf16 v[32:35], a[152:155], a[56:59], v[32:35]
  ds_read_b64_tr_b16 a[144:145], v192 offset:8192
  v_mul_f32 v87, v87, v119
  v_mfma_f32_16x16x32_bf16 v[36:39], a[152:155], a[60:63], v[36:39]
  ds_read_b64_tr_b16 a[146:147], v192 offset:8704
  v_max_f32 v92, 0, v92
  s_waitcnt lgkmcnt(4)
  v_mfma_f32_16x16x32_bf16 v[40:43], a[156:159], a[56:59], v[40:43]
  ds_read_b64_tr_b16 a[148:149], v193 offset:8192
  v_mul_f32 v124, v216, v124
  v_mfma_f32_16x16x32_bf16 v[44:47], a[156:159], a[60:63], v[44:47]
  ds_read_b64_tr_b16 a[150:151], v193 offset:8704
  v_max_f32 v93, 0, v93
  v_mfma_f32_16x16x32_bf16 v[48:51], a[160:163], a[56:59], v[48:51]
  ds_read_b64_tr_b16 a[152:153], v190 offset:20480
  v_mul_f32 v125, v216, v125
  v_max_f32 v94, 0, v94
  v_mfma_f32_16x16x32_bf16 v[52:55], a[160:163], a[60:63], v[52:55]
  ds_read_b64_tr_b16 a[154:155], v190 offset:20992
  v_mul_f32 v126, v216, v126
  v_mfma_f32_16x16x32_bf16 v[56:59], a[164:167], a[56:59], v[56:59]
  ds_read_b64_tr_b16 a[156:157], v191 offset:20480
  v_max_f32 v95, 0, v95
  v_mfma_f32_16x16x32_bf16 v[60:63], a[164:167], a[60:63], v[60:63]
  ds_read_b64_tr_b16 a[158:159], v191 offset:20992
  v_mul_f32 v127, v216, v127
  v_mul_f32 v92, v92, v124
  v_mfma_f32_16x16x32_bf16 v[0:3], a[168:171], a[64:67], v[0:3]
  ds_read_b64_tr_b16 a[160:161], v192 offset:20480
  v_mul_f32 v93, v93, v125
  v_mfma_f32_16x16x32_bf16 v[4:7], a[168:171], a[68:71], v[4:7]
  ds_read_b64_tr_b16 a[162:163], v192 offset:20992
  s_waitcnt lgkmcnt(4)
  v_mfma_f32_16x16x32_bf16 v[8:11], a[172:175], a[64:67], v[8:11]
  ds_read_b64_tr_b16 a[164:165], v193 offset:20480
  v_mul_f32 v94, v94, v126
  v_mfma_f32_16x16x32_bf16 v[12:15], a[172:175], a[68:71], v[12:15]
  ds_read_b64_tr_b16 a[166:167], v193 offset:20992
  s_barrier
  v_mfma_f32_16x16x32_bf16 v[16:19], a[144:147], a[64:67], v[16:19]
  ds_read_b64_tr_b16 a[168:169], v190 offset:24576
  v_mul_f32 v95, v95, v127
  v_mfma_f32_16x16x32_bf16 v[20:23], a[144:147], a[68:71], v[20:23]
  ds_read_b64_tr_b16 a[170:171], v190 offset:25088
  v_cvt_pk_bf16_f32 v116, v84, v85
  v_cvt_pk_bf16_f32 v117, v86, v87
  v_mfma_f32_16x16x32_bf16 v[24:27], a[148:151], a[64:67], v[24:27]
  ds_read_b64_tr_b16 a[172:173], v191 offset:24576
  v_cvt_pk_bf16_f32 v118, v92, v93
  v_mfma_f32_16x16x32_bf16 v[28:31], a[148:151], a[68:71], v[28:31]
  ds_read_b64_tr_b16 a[174:175], v191 offset:25088
  v_cvt_pk_bf16_f32 v119, v94, v95
  v_mfma_f32_16x16x32_bf16 v[32:35], a[152:155], a[64:67], v[32:35]
  ds_read_b64_tr_b16 a[144:145], v192 offset:24576
  v_accvgpr_write_b32 a188, v116
  v_accvgpr_write_b32 a189, v117
  v_mfma_f32_16x16x32_bf16 v[36:39], a[152:155], a[68:71], v[36:39]
  ds_read_b64_tr_b16 a[146:147], v192 offset:25088
  s_waitcnt lgkmcnt(4)
  v_mfma_f32_16x16x32_bf16 v[40:43], a[156:159], a[64:67], v[40:43]
  ds_read_b64_tr_b16 a[148:149], v193 offset:24576
  v_accvgpr_write_b32 a190, v118
  v_mfma_f32_16x16x32_bf16 v[44:47], a[156:159], a[68:71], v[44:47]
  ds_read_b64_tr_b16 a[150:151], v193 offset:25088
  v_accvgpr_write_b32 a191, v119
  s_add_u32 s63, s61, 0
  buffer_store_dwordx4 v[116:119], v226, s[24:27], s63 offen offset:3072 sc1
  v_mfma_f32_16x16x32_bf16 v[48:51], a[160:163], a[64:67], v[48:51]
  ds_read_b64_tr_b16 a[152:153], v190 offset:36864
  v_mfma_f32_16x16x32_bf16 v[52:55], a[160:163], a[68:71], v[52:55]
  ds_read_b64_tr_b16 a[154:155], v190 offset:37376
  v_mfma_f32_16x16x32_bf16 v[56:59], a[164:167], a[64:67], v[56:59]
  ds_read_b64_tr_b16 a[156:157], v191 offset:36864
  s_add_u32 s44, s44, 884736
  s_add_u32 m0, s46, 98304
  v_mfma_f32_16x16x32_bf16 v[60:63], a[164:167], a[68:71], v[60:63]
  ds_read_b64_tr_b16 a[158:159], v191 offset:37376
  v_mfma_f32_16x16x32_bf16 v[0:3], a[168:171], a[72:75], v[0:3]
  ds_read_b64_tr_b16 a[160:161], v192 offset:36864
  buffer_load_dwordx4 v203, s[8:11], s44 offen lds
  v_mfma_f32_16x16x32_bf16 v[4:7], a[168:171], a[76:79], v[4:7]
  ds_read_b64_tr_b16 a[162:163], v192 offset:37376
  s_waitcnt lgkmcnt(4)
  v_mfma_f32_16x16x32_bf16 v[8:11], a[172:175], a[72:75], v[8:11]
  ds_read_b64_tr_b16 a[164:165], v193 offset:36864
  v_mfma_f32_16x16x32_bf16 v[12:15], a[172:175], a[76:79], v[12:15]
  ds_read_b64_tr_b16 a[166:167], v193 offset:37376
  v_mfma_f32_16x16x32_bf16 v[16:19], a[144:147], a[72:75], v[16:19]
  ds_read_b64_tr_b16 a[168:169], v190 offset:28672
  v_mfma_f32_16x16x32_bf16 v[20:23], a[144:147], a[76:79], v[20:23]
  ds_read_b64_tr_b16 a[170:171], v190 offset:29184
  v_mfma_f32_16x16x32_bf16 v[24:27], a[148:151], a[72:75], v[24:27]
  ds_read_b64_tr_b16 a[172:173], v191 offset:28672
  v_mfma_f32_16x16x32_bf16 v[28:31], a[148:151], a[76:79], v[28:31]
  ds_read_b64_tr_b16 a[174:175], v191 offset:29184
  buffer_load_dwordx4 v204, s[8:11], s44 offen offset:1024 lds
  v_mfma_f32_16x16x32_bf16 v[32:35], a[152:155], a[72:75], v[32:35]
  ds_read_b64_tr_b16 a[144:145], v192 offset:28672
  v_mfma_f32_16x16x32_bf16 v[36:39], a[152:155], a[76:79], v[36:39]
  ds_read_b64_tr_b16 a[146:147], v192 offset:29184
  s_waitcnt lgkmcnt(4)
  v_mfma_f32_16x16x32_bf16 v[40:43], a[156:159], a[72:75], v[40:43]
  ds_read_b64_tr_b16 a[148:149], v193 offset:28672
  v_mfma_f32_16x16x32_bf16 v[44:47], a[156:159], a[76:79], v[44:47]
  ds_read_b64_tr_b16 a[150:151], v193 offset:29184
  v_mfma_f32_16x16x32_bf16 v[48:51], a[160:163], a[72:75], v[48:51]
  ds_read_b64_tr_b16 a[152:153], v190 offset:40960
  v_mfma_f32_16x16x32_bf16 v[52:55], a[160:163], a[76:79], v[52:55]
  ds_read_b64_tr_b16 a[154:155], v190 offset:41472
  v_mfma_f32_16x16x32_bf16 v[56:59], a[164:167], a[72:75], v[56:59]
  ds_read_b64_tr_b16 a[156:157], v191 offset:40960
  buffer_load_dwordx4 v205, s[8:11], s44 offen offset:2048 lds
  v_mfma_f32_16x16x32_bf16 v[60:63], a[164:167], a[76:79], v[60:63]
  ds_read_b64_tr_b16 a[158:159], v191 offset:41472
  v_mfma_f32_16x16x32_bf16 v[0:3], a[168:171], a[80:83], v[0:3]
  ds_read_b64_tr_b16 a[160:161], v192 offset:40960
  v_mfma_f32_16x16x32_bf16 v[4:7], a[168:171], a[84:87], v[4:7]
  ds_read_b64_tr_b16 a[162:163], v192 offset:41472
  s_waitcnt lgkmcnt(4)
  v_mfma_f32_16x16x32_bf16 v[8:11], a[172:175], a[80:83], v[8:11]
  ds_read_b64_tr_b16 a[164:165], v193 offset:40960
  v_mfma_f32_16x16x32_bf16 v[12:15], a[172:175], a[84:87], v[12:15]
  ds_read_b64_tr_b16 a[166:167], v193 offset:41472
  v_mfma_f32_16x16x32_bf16 v[16:19], a[144:147], a[80:83], v[16:19]
  ds_read_b64_tr_b16 a[168:169], v190 offset:32768
  v_mfma_f32_16x16x32_bf16 v[20:23], a[144:147], a[84:87], v[20:23]
  ds_read_b64_tr_b16 a[170:171], v190 offset:33280
  buffer_load_dwordx4 v206, s[8:11], s44 offen offset:3072 lds
  v_mfma_f32_16x16x32_bf16 v[24:27], a[148:151], a[80:83], v[24:27]
  ds_read_b64_tr_b16 a[172:173], v191 offset:32768
  s_add_u32 m0, s46, 102400
  v_mfma_f32_16x16x32_bf16 v[28:31], a[148:151], a[84:87], v[28:31]
  ds_read_b64_tr_b16 a[174:175], v191 offset:33280
  v_mfma_f32_16x16x32_bf16 v[32:35], a[152:155], a[80:83], v[32:35]
  ds_read_b64_tr_b16 a[144:145], v192 offset:32768
  v_mfma_f32_16x16x32_bf16 v[36:39], a[152:155], a[84:87], v[36:39]
  ds_read_b64_tr_b16 a[146:147], v192 offset:33280
  s_waitcnt lgkmcnt(4)
  v_mfma_f32_16x16x32_bf16 v[40:43], a[156:159], a[80:83], v[40:43]
  ds_read_b64_tr_b16 a[148:149], v193 offset:32768
  v_mfma_f32_16x16x32_bf16 v[44:47], a[156:159], a[84:87], v[44:47]
  ds_read_b64_tr_b16 a[150:151], v193 offset:33280
  v_mfma_f32_16x16x32_bf16 v[48:51], a[160:163], a[80:83], v[48:51]
  ds_read_b64_tr_b16 a[152:153], v190 offset:45056
  buffer_load_dwordx4 v207, s[8:11], s44 offen lds
  v_mfma_f32_16x16x32_bf16 v[52:55], a[160:163], a[84:87], v[52:55]
  ds_read_b64_tr_b16 a[154:155], v190 offset:45568
  v_mfma_f32_16x16x32_bf16 v[56:59], a[164:167], a[80:83], v[56:59]
  ds_read_b64_tr_b16 a[156:157], v191 offset:45056
  v_mfma_f32_16x16x32_bf16 v[60:63], a[164:167], a[84:87], v[60:63]
  ds_read_b64_tr_b16 a[158:159], v191 offset:45568
  v_mfma_f32_16x16x32_bf16 v[0:3], a[168:171], a[88:91], v[0:3]
  ds_read_b64_tr_b16 a[160:161], v192 offset:45056
  v_mfma_f32_16x16x32_bf16 v[4:7], a[168:171], a[92:95], v[4:7]
  ds_read_b64_tr_b16 a[162:163], v192 offset:45568
  s_waitcnt lgkmcnt(4)
  v_mfma_f32_16x16x32_bf16 v[8:11], a[172:175], a[88:91], v[8:11]
  ds_read_b64_tr_b16 a[164:165], v193 offset:45056
  s_waitcnt vmcnt(12)
  v_mfma_f32_16x16x32_bf16 v[12:15], a[172:175], a[92:95], v[12:15]
  ds_read_b64_tr_b16 a[166:167], v193 offset:45568
  s_barrier
  v_mfma_f32_16x16x32_bf16 v[16:19], a[144:147], a[88:91], v[16:19]
  ds_read_b64_tr_b16 a[168:169], v194
  buffer_load_dwordx4 v208, s[8:11], s44 offen offset:1024 lds
  s_add_u32 s44, s64, 256
  v_mfma_f32_16x16x32_bf16 v[20:23], a[144:147], a[92:95], v[20:23]
  ds_read_b64_tr_b16 a[170:171], v194 offset:512
  s_add_u32 m0, s46, 122880
  v_mfma_f32_16x16x32_bf16 v[24:27], a[148:151], a[88:91], v[24:27]
  ds_read_b64_tr_b16 a[172:173], v195
  s_waitcnt vmcnt(8)
  v_cmp_ne_u32 vcc, 0, v249
  s_nop 3
  s_or_b64 vcc, vcc, s[56:57]
  s_cmp_eq_u64 vcc, -1
  s_cbranch_scc0 L_slow_S1
L_back_S1:
  v_mfma_f32_16x16x32_bf16 v[28:31], a[148:151], a[92:95], v[28:31]
  ds_read_b64_tr_b16 a[174:175], v195 offset:512
  s_mul_i32 s49, s41, 384
  v_mfma_f32_16x16x32_bf16 v[32:35], a[152:155], a[88:91], v[32:35]
  ds_read_b64_tr_b16 a[144:145], v196
  v_add_u32 v248, s49, v227
  v_mfma_f32_16x16x32_bf16 v[36:39], a[152:155], a[92:95], v[36:39]
  ds_read_b64_tr_b16 a[146:147], v196 offset:512
  v_subrev_u32 v249, 5760, v248
  s_waitcnt lgkmcnt(4)
  v_mfma_f32_16x16x32_bf16 v[40:43], a[156:159], a[88:91], v[40:43]
  ds_read_b64_tr_b16 a[148:149], v197
  buffer_load_dwordx2 v[228:229], v249, s[28:31], 0 offen sc1
  v_mfma_f32_16x16x32_bf16 v[44:47], a[156:159], a[92:95], v[44:47]
  ds_read_b64_tr_b16 a[150:151], v197 offset:512
  v_subrev_u32 v250, 5376, v248
  v_mfma_f32_16x16x32_bf16 v[48:51], a[160:163], a[88:91], v[48:51]
  ds_read_b64_tr_b16 a[152:153], v194 offset:12288
  v_mfma_f32_16x16x32_bf16 v[52:55], a[160:163], a[92:95], v[52:55]
  ds_read_b64_tr_b16 a[154:155], v194 offset:12800
  v_mfma_f32_16x16x32_bf16 v[56:59], a[164:167], a[88:91], v[56:59]
  ds_read_b64_tr_b16 a[156:157], v195 offset:12288
  v_mfma_f32_16x16x32_bf16 v[60:63], a[164:167], a[92:95], v[60:63]
  ds_read_b64_tr_b16 a[158:159], v195 offset:12800
  buffer_load_dwordx4 v203, s[8:11], s44 offen lds
  v_mfma_f32_16x16x32_bf16 v[0:3], a[168:171], a[96:99], v[0:3]
  ds_read_b64_tr_b16 a[160:161], v196 offset:12288
  v_mfma_f32_16x16x32_bf16 v[4:7], a[168:171], a[100:103], v[4:7]
  ds_read_b64_tr_b16 a[162:163], v196 offset:12800
  s_waitcnt lgkmcnt(4)
  v_mfma_f32_16x16x32_bf16 v[8:11], a[172:175], a[96:99], v[8:11]
  ds_read_b64_tr_b16 a[164:165], v197 offset:12288
  v_mfma_f32_16x16x32_bf16 v[12:15], a[172:175], a[100:103], v[12:15]
  ds_read_b64_tr_b16 a[166:167], v197 offset:12800
  v_mfma_f32_16x16x32_bf16 v[16:19], a[144:147], a[96:99], v[16:19]
  ds_read_b64_tr_b16 a[168:169], v194 offset:4096
  buffer_load_dwordx2 v[230:231], v250, s[28:31], 0 offen sc1
  v_mfma_f32_16x16x32_bf16 v[20:23], a[144:147], a[100:103], v[20:23]
  ds_read_b64_tr_b16 a[170:171], v194 offset:4608
  v_subrev_u32 v249, 4992, v248
  v_mfma_f32_16x16x32_bf16 v[24:27], a[148:151], a[96:99], v[24:27]
  ds_read_b64_tr_b16 a[172:173], v195 offset:4096
  v_mfma_f32_16x16x32_bf16 v[28:31], a[148:151], a[100:103], v[28:31]
  ds_read_b64_tr_b16 a[174:175], v195 offset:4608
  buffer_load_dwordx4 v204, s[8:11], s44 offen offset:1024 lds
  buffer_load_dwordx4 v205, s[8:11], s44 offen offset:2048 lds
  buffer_load_dwordx4 v206, s[8:11], s44 offen offset:3072 lds
  s_add_u32 m0, s46, 126976
  s_nop 0
  buffer_load_dwordx4 v207, s[8:11], s44 offen lds
  buffer_load_dwordx4 v208, s[8:11], s44 offen offset:1024 lds
  v_mfma_f32_16x16x32_bf16 v[32:35], a[152:155], a[96:99], v[32:35]
  ds_read_b64_tr_b16 a[144:145], v196 offset:4096
  s_add_u32 s44, s44, 884736
  s_add_u32 m0, s46, 73728
  v_mfma_f32_16x16x32_bf16 v[36:39], a[152:155], a[100:103], v[36:39]
  ds_read_b64_tr_b16 a[146:147], v196 offset:4608
  s_waitcnt lgkmcnt(4)
  v_mfma_f32_16x16x32_bf16 v[40:43], a[156:159], a[96:99], v[40:43]
  ds_read_b64_tr_b16 a[148:149], v197 offset:4096
  v_mfma_f32_16x16x32_bf16 v[44:47], a[156:159], a[100:103], v[44:47]
  ds_read_b64_tr_b16 a[150:151], v197 offset:4608
  v_mfma_f32_16x16x32_bf16 v[48:51], a[160:163], a[96:99], v[48:51]
  ds_read_b64_tr_b16 a[152:153], v194 offset:16384
  v_mfma_f32_16x16x32_bf16 v[52:55], a[160:163], a[100:103], v[52:55]
  ds_read_b64_tr_b16 a[154:155], v194 offset:16896
  buffer_load_dwordx2 v[232:233], v249, s[28:31], 0 offen sc1
  v_mfma_f32_16x16x32_bf16 v[56:59], a[164:167], a[96:99], v[56:59]
  ds_read_b64_tr_b16 a[156:157], v195 offset:16384
  v_subrev_u32 v250, 4608, v248
  v_mfma_f32_16x16x32_bf16 v[60:63], a[164:167], a[100:103], v[60:63]
  ds_read_b64_tr_b16 a[158:159], v195 offset:16896
  v_mfma_f32_16x16x32_bf16 v[0:3], a[168:171], a[104:107], v[0:3]
  ds_read_b64_tr_b16 a[160:161], v196 offset:16384
  v_mfma_f32_16x16x32_bf16 v[4:7], a[168:171], a[108:111], v[4:7]
  ds_read_b64_tr_b16 a[162:163], v196 offset:16896
  s_waitcnt lgkmcnt(4)
  v_mfma_f32_16x16x32_bf16 v[8:11], a[172:175], a[104:107], v[8:11]
  ds_read_b64_tr_b16 a[164:165], v197 offset:16384
  buffer_load_dwordx4 v203, s[8:11], s44 offen lds
  v_mfma_f32_16x16x32_bf16 v[12:15], a[172:175], a[108:111], v[12:15]
  ds_read_b64_tr_b16 a[166:167], v197 offset:16896
  v_mfma_f32_16x16x32_bf16 v[16:19], a[144:147], a[104:107], v[16:19]
  ds_read_b64_tr_b16 a[168:169], v194 offset:8192
  v_mfma_f32_16x16x32_bf16 v[20:23], a[144:147], a[108:111], v[20:23]
  ds_read_b64_tr_b16 a[170:171], v194 offset:8704
  buffer_load_dwordx4 v204, s[8:11], s44 offen offset:1024 lds
  buffer_load_dwordx4 v205, s[8:11], s44 offen offset:2048 lds
  buffer_load_dwordx4 v206, s[8:11], s44 offen offset:3072 lds
  s_add_u32 m0, s46, 77824
  s_nop 0
  buffer_load_dwordx4 v207, s[8:11], s44 offen lds
  buffer_load_dwordx4 v208, s[8:11], s44 offen offset:1024 lds
  v_mfma_f32_16x16x32_bf16 v[24:27], a[148:151], a[104:107], v[24:27]
  ds_read_b64_tr_b16 a[172:173], v195 offset:8192
  s_add_u32 s44, s44, 884736
  v_mfma_f32_16x16x32_bf16 v[28:31], a[148:151], a[108:111], v[28:31]
  ds_read_b64_tr_b16 a[174:175], v195 offset:8704
  s_add_u32 m0, s46, 0
  v_mfma_f32_16x16x32_bf16 v[32:35], a[152:155], a[104:107], v[32:35]
  ds_read_b64_tr_b16 a[144:145], v196 offset:8192
  v_mfma_f32_16x16x32_bf16 v[36:39], a[152:155], a[108:111], v[36:39]
  ds_read_b64_tr_b16 a[146:147], v196 offset:8704
  s_waitcnt lgkmcnt(4)
  v_mfma_f32_16x16x32_bf16 v[40:43], a[156:159], a[104:107], v[40:43]
  ds_read_b64_tr_b16 a[148:149], v197 offset:8192
  v_mfma_f32_16x16x32_bf16 v[44:47], a[156:159], a[108:111], v[44:47]
  ds_read_b64_tr_b16 a[150:151], v197 offset:8704
  buffer_load_dwordx2 v[234:235], v250, s[28:31], 0 offen sc1
  v_mfma_f32_16x16x32_bf16 v[48:51], a[160:163], a[104:107], v[48:51]
  ds_read_b64_tr_b16 a[152:153], v194 offset:20480
  v_subrev_u32 v249, 4224, v248
  v_mfma_f32_16x16x32_bf16 v[52:55], a[160:163], a[108:111], v[52:55]
  ds_read_b64_tr_b16 a[154:155], v194 offset:20992
  v_mfma_f32_16x16x32_bf16 v[56:59], a[164:167], a[104:107], v[56:59]
  ds_read_b64_tr_b16 a[156:157], v195 offset:20480
  v_mfma_f32_16x16x32_bf16 v[60:63], a[164:167], a[108:111], v[60:63]
  ds_read_b64_tr_b16 a[158:159], v195 offset:20992
  v_mfma_f32_16x16x32_bf16 v[0:3], a[168:171], a[112:115], v[0:3]
  ds_read_b64_tr_b16 a[160:161], v196 offset:20480
  buffer_load_dwordx4 v203, s[8:11], s44 offen lds
  v_mfma_f32_16x16x32_bf16 v[4:7], a[168:171], a[116:119], v[4:7]
  ds_read_b64_tr_b16 a[162:163], v196 offset:20992
  s_waitcnt lgkmcnt(4)
  v_mfma_f32_16x16x32_bf16 v[8:11], a[172:175], a[112:115], v[8:11]
  ds_read_b64_tr_b16 a[164:165], v197 offset:20480
  s_waitcnt vmcnt(17)
  v_mfma_f32_16x16x32_bf16 v[12:15], a[172:175], a[116:119], v[12:15]
  ds_read_b64_tr_b16 a[166:167], v197 offset:20992
  buffer_load_dwordx4 v204, s[8:11], s44 offen offset:1024 lds
  buffer_load_dwordx4 v205, s[8:11], s44 offen offset:2048 lds
  buffer_load_dwordx4 v206, s[8:11], s44 offen offset:3072 lds
  s_add_u32 m0, s46, 4096
  s_nop 0
  buffer_load_dwordx4 v207, s[8:11], s44 offen lds
  buffer_load_dwordx4 v208, s[8:11], s44 offen offset:1024 lds
  s_barrier
  v_mfma_f32_16x16x32_bf16 v[16:19], a[144:147], a[112:115], v[16:19]
  ds_read_b64_tr_b16 a[168:169], v198
  s_add_u32 s44, s44, 884736
  s_add_u32 m0, s46, 24576
  v_mfma_f32_16x16x32_bf16 v[20:23], a[144:147], a[116:119], v[20:23]
  ds_read_b64_tr_b16 a[170:171], v198 offset:512
  v_mfma_f32_16x16x32_bf16 v[24:27], a[148:151], a[112:115], v[24:27]
  ds_read_b64_tr_b16 a[172:173], v199
  v_mfma_f32_16x16x32_bf16 v[28:31], a[148:151], a[116:119], v[28:31]
  ds_read_b64_tr_b16 a[174:175], v199 offset:512
  v_mfma_f32_16x16x32_bf16 v[32:35], a[152:155], a[112:115], v[32:35]
  ds_read_b64_tr_b16 a[144:145], v200
  v_mfma_f32_16x16x32_bf16 v[36:39], a[152:155], a[116:119], v[36:39]
  ds_read_b64_tr_b16 a[146:147], v200 offset:512
  buffer_load_dwordx2 v[236:237], v249, s[28:31], 0 offen sc1
  s_waitcnt lgkmcnt(4)
  v_mfma_f32_16x16x32_bf16 v[40:43], a[156:159], a[112:115], v[40:43]
  ds_read_b64_tr_b16 a[148:149], v201
  v_subrev_u32 v250, 3840, v248
  v_mfma_f32_16x16x32_bf16 v[44:47], a[156:159], a[116:119], v[44:47]
  ds_read_b64_tr_b16 a[150:151], v201 offset:512
  v_mfma_f32_16x16x32_bf16 v[48:51], a[160:163], a[112:115], v[48:51]
  ds_read_b64_tr_b16 a[152:153], v198 offset:12288
  v_mfma_f32_16x16x32_bf16 v[52:55], a[160:163], a[116:119], v[52:55]
  ds_read_b64_tr_b16 a[154:155], v198 offset:12800
  v_mfma_f32_16x16x32_bf16 v[56:59], a[164:167], a[112:115], v[56:59]
  ds_read_b64_tr_b16 a[156:157], v199 offset:12288
  buffer_load_dwordx2 v[238:239], v250, s[28:31], 0 offen sc1
  v_mfma_f32_16x16x32_bf16 v[60:63], a[164:167], a[116:119], v[60:63]
  ds_read_b64_tr_b16 a[158:159], v199 offset:12800
  v_subrev_u32 v249, 3456, v248
  v_mfma_f32_16x16x32_bf16 v[0:3], a[168:171], a[120:123], v[0:3]
  ds_read_b64_tr_b16 a[160:161], v200 offset:12288
  v_mfma_f32_16x16x32_bf16 v[4:7], a[168:171], a[124:127], v[4:7]
  ds_read_b64_tr_b16 a[162:163], v200 offset:12800
  buffer_load_dwordx2 v[240:241], v249, s[28:31], 0 offen sc1
  s_waitcnt lgkmcnt(4)
  v_mfma_f32_16x16x32_bf16 v[8:11], a[172:175], a[120:123], v[8:11]
  ds_read_b64_tr_b16 a[164:165], v201 offset:12288
  v_subrev_u32 v250, 3072, v248
  v_mfma_f32_16x16x32_bf16 v[12:15], a[172:175], a[124:127], v[12:15]
  ds_read_b64_tr_b16 a[166:167], v201 offset:12800
  v_mfma_f32_16x16x32_bf16 v[16:19], a[144:147], a[120:123], v[16:19]
  ds_read_b64_tr_b16 a[168:169], v198 offset:4096
  buffer_load_dwordx2 v[242:243], v250, s[28:31], 0 offen sc1
  v_mfma_f32_16x16x32_bf16 v[20:23], a[144:147], a[124:127], v[20:23]
  ds_read_b64_tr_b16 a[170:171], v198 offset:4608
  v_mfma_f32_16x16x32_bf16 v[24:27], a[148:151], a[120:123], v[24:27]
  ds_read_b64_tr_b16 a[172:173], v199 offset:4096
  v_mfma_f32_16x16x32_bf16 v[28:31], a[148:151], a[124:127], v[28:31]
  ds_read_b64_tr_b16 a[174:175], v199 offset:4608
  v_mfma_f32_16x16x32_bf16 v[32:35], a[152:155], a[120:123], v[32:35]
  ds_read_b64_tr_b16 a[144:145], v200 offset:4096
  v_mfma_f32_16x16x32_bf16 v[36:39], a[152:155], a[124:127], v[36:39]
  ds_read_b64_tr_b16 a[146:147], v200 offset:4608
  s_waitcnt lgkmcnt(4)
  v_mfma_f32_16x16x32_bf16 v[40:43], a[156:159], a[120:123], v[40:43]
  ds_read_b64_tr_b16 a[148:149], v201 offset:4096
  buffer_load_dwordx4 v203, s[8:11], s44 offen lds
  v_mfma_f32_16x16x32_bf16 v[44:47], a[156:159], a[124:127], v[44:47]
  ds_read_b64_tr_b16 a[150:151], v201 offset:4608
  v_mfma_f32_16x16x32_bf16 v[48:51], a[160:163], a[120:123], v[48:51]
  ds_read_b64_tr_b16 a[152:153], v198 offset:16384
  v_mfma_f32_16x16x32_bf16 v[52:55], a[160:163], a[124:127], v[52:55]
  ds_read_b64_tr_b16 a[154:155], v198 offset:16896
  v_mfma_f32_16x16x32_bf16 v[56:59], a[164:167], a[120:123], v[56:59]
  ds_read_b64_tr_b16 a[156:157], v199 offset:16384
  v_mfma_f32_16x16x32_bf16 v[60:63], a[164:167], a[124:127], v[60:63]
  ds_read_b64_tr_b16 a[158:159], v199 offset:16896
  v_mfma_f32_16x16x32_bf16 v[0:3], a[168:171], a[128:131], v[0:3]
  ds_read_b64_tr_b16 a[160:161], v200 offset:16384
  v_mfma_f32_16x16x32_bf16 v[4:7], a[168:171], a[132:135], v[4:7]
  ds_read_b64_tr_b16 a[162:163], v200 offset:16896
  buffer_load_dwordx4 v204, s[8:11], s44 offen offset:1024 lds
  s_waitcnt lgkmcnt(4)
  v_mfma_f32_16x16x32_bf16 v[8:11], a[172:175], a[128:131], v[8:11]
  ds_read_b64_tr_b16 a[164:165], v201 offset:16384
  v_mfma_f32_16x16x32_bf16 v[12:15], a[172:175], a[132:135], v[12:15]
  ds_read_b64_tr_b16 a[166:167], v201 offset:16896
  v_mfma_f32_16x16x32_bf16 v[16:19], a[144:147], a[128:131], v[16:19]
  ds_read_b64_tr_b16 a[168:169], v198 offset:8192
  v_mfma_f32_16x16x32_bf16 v[20:23], a[144:147], a[132:135], v[20:23]
  ds_read_b64_tr_b16 a[170:171], v198 offset:8704
  v_mfma_f32_16x16x32_bf16 v[24:27], a[148:151], a[128:131], v[24:27]
  ds_read_b64_tr_b16 a[172:173], v199 offset:8192
  v_mfma_f32_16x16x32_bf16 v[28:31], a[148:151], a[132:135], v[28:31]
  ds_read_b64_tr_b16 a[174:175], v199 offset:8704
  v_mfma_f32_16x16x32_bf16 v[32:35], a[152:155], a[128:131], v[32:35]
  ds_read_b64_tr_b16 a[144:145], v200 offset:8192
  buffer_load_dwordx4 v205, s[8:11], s44 offen offset:2048 lds
  v_mfma_f32_16x16x32_bf16 v[36:39], a[152:155], a[132:135], v[36:39]
  ds_read_b64_tr_b16 a[146:147], v200 offset:8704
  s_waitcnt lgkmcnt(4)
  v_mfma_f32_16x16x32_bf16 v[40:43], a[156:159], a[128:131], v[40:43]
  ds_read_b64_tr_b16 a[148:149], v201 offset:8192
  v_mfma_f32_16x16x32_bf16 v[44:47], a[156:159], a[132:135], v[44:47]
  ds_read_b64_tr_b16 a[150:151], v201 offset:8704
  v_mfma_f32_16x16x32_bf16 v[48:51], a[160:163], a[128:131], v[48:51]
  ds_read_b64_tr_b16 a[152:153], v198 offset:20480
  v_mfma_f32_16x16x32_bf16 v[52:55], a[160:163], a[132:135], v[52:55]
  ds_read_b64_tr_b16 a[154:155], v198 offset:20992
  v_mfma_f32_16x16x32_bf16 v[56:59], a[164:167], a[128:131], v[56:59]
  ds_read_b64_tr_b16 a[156:157], v199 offset:20480
  v_mfma_f32_16x16x32_bf16 v[60:63], a[164:167], a[132:135], v[60:63]
  ds_read_b64_tr_b16 a[158:159], v199 offset:20992
  buffer_load_dwordx4 v206, s[8:11], s44 offen offset:3072 lds
  s_add_u32 m0, s46, 28672
  s_nop 0
  buffer_load_dwordx4 v207, s[8:11], s44 offen lds
  buffer_load_dwordx4 v208, s[8:11], s44 offen offset:1024 lds
  v_mfma_f32_16x16x32_bf16 v[0:3], a[168:171], a[136:139], v[0:3]
  ds_read_b64_tr_b16 a[160:161], v200 offset:20480
  v_mfma_f32_16x16x32_bf16 v[4:7], a[168:171], a[140:143], v[4:7]
  ds_read_b64_tr_b16 a[162:163], v200 offset:20992
  s_waitcnt lgkmcnt(4)
  v_mfma_f32_16x16x32_bf16 v[8:11], a[172:175], a[136:139], v[8:11]
  ds_read_b64_tr_b16 a[164:165], v201 offset:20480
  s_waitcnt vmcnt(24)
  v_mfma_f32_16x16x32_bf16 v[12:15], a[172:175], a[140:143], v[12:15]
  ds_read_b64_tr_b16 a[166:167], v201 offset:20992
  s_barrier
  v_mfma_f32_16x16x32_bf16 v[16:19], a[144:147], a[136:139], v[16:19]
  ds_read_b64_tr_b16 a[168:169], v198 offset:24576
  s_add_u32 s44, s44, 884736
  v_mfma_f32_16x16x32_bf16 v[20:23], a[144:147], a[140:143], v[20:23]
  ds_read_b64_tr_b16 a[170:171], v198 offset:25088
  s_add_u32 m0, s46, 49152
  v_mfma_f32_16x16x32_bf16 v[24:27], a[148:151], a[136:139], v[24:27]
  ds_read_b64_tr_b16 a[172:173], v199 offset:24576
  v_mfma_f32_16x16x32_bf16 v[28:31], a[148:151], a[140:143], v[28:31]
  ds_read_b64_tr_b16 a[174:175], v199 offset:25088
  buffer_load_dwordx4 v203, s[8:11], s44 offen lds
  v_mfma_f32_16x16x32_bf16 v[32:35], a[152:155], a[136:139], v[32:35]
  ds_read_b64_tr_b16 a[144:145], v200 offset:24576
  v_mfma_f32_16x16x32_bf16 v[36:39], a[152:155], a[140:143], v[36:39]
  ds_read_b64_tr_b16 a[146:147], v200 offset:25088
  s_waitcnt lgkmcnt(4)
  v_mfma_f32_16x16x32_bf16 v[40:43], a[156:159], a[136:139], v[40:43]
  ds_read_b64_tr_b16 a[148:149], v201 offset:24576
  v_mfma_f32_16x16x32_bf16 v[44:47], a[156:159], a[140:143], v[44:47]
  ds_read_b64_tr_b16 a[150:151], v201 offset:25088
  v_mfma_f32_16x16x32_bf16 v[48:51], a[160:163], a[136:139], v[48:51]
  ds_read_b64_tr_b16 a[152:153], v198 offset:36864
  v_mfma_f32_16x16x32_bf16 v[52:55], a[160:163], a[140:143], v[52:55]
  ds_read_b64_tr_b16 a[154:155], v198 offset:37376
  v_mfma_f32_16x16x32_bf16 v[56:59], a[164:167], a[136:139], v[56:59]
  ds_read_b64_tr_b16 a[156:157], v199 offset:36864
  v_fmac_f32 v230, v221, v228
  v_mfma_f32_16x16x32_bf16 v[60:63], a[164:167], a[140:143], v[60:63]
  ds_read_b64_tr_b16 a[158:159], v199 offset:37376
  v_fmac_f32 v231, v221, v229
  buffer_load_dwordx4 v204, s[8:11], s44 offen offset:1024 lds
  v_mfma_f32_16x16x32_bf16 v[64:67], a[168:171], a[0:3], 0
  ds_read_b64_tr_b16 a[160:161], v200 offset:36864
  v_fma_f32 v230, -v222, v229, v230
  v_mfma_f32_16x16x32_bf16 v[68:71], a[168:171], a[4:7], 0
  ds_read_b64_tr_b16 a[162:163], v200 offset:37376
  v_fmac_f32 v231, v222, v228
  s_waitcnt lgkmcnt(4)
  v_mfma_f32_16x16x32_bf16 v[72:75], a[172:175], a[0:3], 0
  ds_read_b64_tr_b16 a[164:165], v201 offset:36864
  v_mfma_f32_16x16x32_bf16 v[76:79], a[172:175], a[4:7], 0
  ds_read_b64_tr_b16 a[166:167], v201 offset:37376
  v_max_f32 v0, 0, v0
  v_mul_f32 v32, v215, v32
  v_mfma_f32_16x16x32_bf16 v[80:83], a[144:147], a[0:3], 0
  ds_read_b64_tr_b16 a[168:169], v198 offset:28672
  v_max_f32 v1, 0, v1
  v_mfma_f32_16x16x32_bf16 v[84:87], a[144:147], a[4:7], 0
  ds_read_b64_tr_b16 a[170:171], v198 offset:29184
  v_mul_f32 v33, v215, v33
  v_mfma_f32_16x16x32_bf16 v[88:91], a[148:151], a[0:3], 0
  ds_read_b64_tr_b16 a[172:173], v199 offset:28672
  buffer_load_dwordx4 v205, s[8:11], s44 offen offset:2048 lds
  v_max_f32 v2, 0, v2
  v_mfma_f32_16x16x32_bf16 v[92:95], a[148:151], a[4:7], 0
  ds_read_b64_tr_b16 a[174:175], v199 offset:29184
  s_waitcnt vmcnt(26)
  v_fmac_f32 v232, v221, v230
  v_mfma_f32_16x16x32_bf16 v[96:99], a[152:155], a[0:3], 0
  ds_read_b64_tr_b16 a[144:145], v200 offset:28672
  v_fmac_f32 v233, v221, v231
  v_fma_f32 v232, -v222, v231, v232
  v_mfma_f32_16x16x32_bf16 v[100:103], a[152:155], a[4:7], 0
  ds_read_b64_tr_b16 a[146:147], v200 offset:29184
  s_waitcnt lgkmcnt(4)
  v_mfma_f32_16x16x32_bf16 v[104:107], a[156:159], a[0:3], 0
  ds_read_b64_tr_b16 a[148:149], v201 offset:28672
  v_fmac_f32 v233, v222, v230
  v_mul_f32 v34, v215, v34
  v_mfma_f32_16x16x32_bf16 v[108:111], a[156:159], a[4:7], 0
  ds_read_b64_tr_b16 a[150:151], v201 offset:29184
  v_max_f32 v3, 0, v3
  v_mfma_f32_16x16x32_bf16 v[112:115], a[160:163], a[0:3], 0
  ds_read_b64_tr_b16 a[152:153], v198 offset:40960
  v_mul_f32 v35, v215, v35
  v_mul_f32 v0, v0, v32
  v_mfma_f32_16x16x32_bf16 v[116:119], a[160:163], a[4:7], 0
  ds_read_b64_tr_b16 a[154:155], v198 offset:41472
  buffer_load_dwordx4 v206, s[8:11], s44 offen offset:3072 lds
  v_mfma_f32_16x16x32_bf16 v[120:123], a[164:167], a[0:3], 0
  ds_read_b64_tr_b16 a[156:157], v199 offset:40960
  s_add_u32 m0, s46, 53248
  v_mul_f32 v1, v1, v33
  v_mfma_f32_16x16x32_bf16 v[124:127], a[164:167], a[4:7], 0
  ds_read_b64_tr_b16 a[158:159], v199 offset:41472
  v_mul_f32 v2, v2, v34
  v_mfma_f32_16x16x32_bf16 v[64:67], a[168:171], a[8:11], v[64:67]
  ds_read_b64_tr_b16 a[160:161], v200 offset:40960
  v_mul_f32 v3, v3, v35
  v_max_f32 v8, 0, v8
  v_mfma_f32_16x16x32_bf16 v[68:71], a[168:171], a[12:15], v[68:71]
  ds_read_b64_tr_b16 a[162:163], v200 offset:41472
  s_waitcnt lgkmcnt(4)
  v_mfma_f32_16x16x32_bf16 v[72:75], a[172:175], a[8:11], v[72:75]
  ds_read_b64_tr_b16 a[164:165], v201 offset:40960
  v_mul_f32 v40, v215, v40
  v_max_f32 v9, 0, v9
  v_mfma_f32_16x16x32_bf16 v[76:79], a[172:175], a[12:15], v[76:79]
  ds_read_b64_tr_b16 a[166:167], v201 offset:41472
  v_mul_f32 v41, v215, v41
  v_mfma_f32_16x16x32_bf16 v[80:83], a[144:147], a[8:11], v[80:83]
  ds_read_b64_tr_b16 a[168:169], v198 offset:32768
  buffer_load_dwordx4 v207, s[8:11], s44 offen lds
  v_max_f32 v10, 0, v10
  v_mfma_f32_16x16x32_bf16 v[84:87], a[144:147], a[12:15], v[84:87]
  ds_read_b64_tr_b16 a[170:171], v198 offset:33280
  s_waitcnt vmcnt(21)
  v_fmac_f32 v234, v221, v232
  v_mfma_f32_16x16x32_bf16 v[88:91], a[148:151], a[8:11], v[88:91]
  ds_read_b64_tr_b16 a[172:173], v199 offset:32768
  v_fmac_f32 v235, v221, v233
  v_fma_f32 v234, -v222, v233, v234
  v_mfma_f32_16x16x32_bf16 v[92:95], a[148:151], a[12:15], v[92:95]
  ds_read_b64_tr_b16 a[174:175], v199 offset:33280
  v_fmac_f32 v235, v222, v232
  v_mfma_f32_16x16x32_bf16 v[96:99], a[152:155], a[8:11], v[96:99]
  ds_read_b64_tr_b16 a[144:145], v200 offset:32768
  v_mul_f32 v42, v215, v42
  v_max_f32 v11, 0, v11
  v_mfma_f32_16x16x32_bf16 v[100:103], a[152:155], a[12:15], v[100:103]
  ds_read_b64_tr_b16 a[146:147], v200 offset:33280
  s_waitcnt lgkmcnt(4)
  v_mfma_f32_16x16x32_bf16 v[104:107], a[156:159], a[8:11], v[104:107]
  ds_read_b64_tr_b16 a[148:149], v201 offset:32768
  v_mul_f32 v43, v215, v43
  v_mul_f32 v8, v8, v40
  v_mfma_f32_16x16x32_bf16 v[108:111], a[156:159], a[12:15], v[108:111]
  ds_read_b64_tr_b16 a[150:151], v201 offset:33280
  buffer_load_dwordx4 v208, s[8:11], s44 offen offset:1024 lds
  v_mfma_f32_16x16x32_bf16 v[112:115], a[160:163], a[8:11], v[112:115]
  ds_read_b64_tr_b16 a[152:153], v198 offset:45056
  v_mul_f32 v9, v9, v41
  v_mfma_f32_16x16x32_bf16 v[116:119], a[160:163], a[12:15], v[116:119]
  ds_read_b64_tr_b16 a[154:155], v198 offset:45568
  v_mul_f32 v10, v10, v42
  v_mul_f32 v11, v11, v43
  v_mfma_f32_16x16x32_bf16 v[120:123], a[164:167], a[8:11], v[120:123]
  ds_read_b64_tr_b16 a[156:157], v199 offset:45056
  v_cvt_pk_bf16_f32 v32, v0, v1
  v_mfma_f32_16x16x32_bf16 v[124:127], a[164:167], a[12:15], v[124:127]
  ds_read_b64_tr_b16 a[158:159], v199 offset:45568
  v_cvt_pk_bf16_f32 v33, v2, v3
  v_cvt_pk_bf16_f32 v34, v8, v9
  v_mfma_f32_16x16x32_bf16 v[64:67], a[168:171], a[16:19], v[64:67]
  ds_read_b64_tr_b16 a[160:161], v200 offset:45056
  v_cvt_pk_bf16_f32 v35, v10, v11
  v_mfma_f32_16x16x32_bf16 v[68:71], a[168:171], a[20:23], v[68:71]
  ds_read_b64_tr_b16 a[162:163], v200 offset:45568
  v_accvgpr_write_b32 a192, v32
  s_waitcnt lgkmcnt(4)
  v_mfma_f32_16x16x32_bf16 v[72:75], a[172:175], a[16:19], v[72:75]
  ds_read_b64_tr_b16 a[164:165], v201 offset:45056
  v_mfma_f32_16x16x32_bf16 v[76:79], a[172:175], a[20:23], v[76:79]
  ds_read_b64_tr_b16 a[166:167], v201 offset:45568
  s_waitcnt vmcnt(15)
  v_fmac_f32 v236, v221, v234
  s_barrier
  v_mfma_f32_16x16x32_bf16 v[80:83], a[144:147], a[16:19], v[80:83]
  ds_read_b64_tr_b16 a[168:169], v194 offset:24576
  v_fmac_f32 v237, v221, v235
  v_mfma_f32_16x16x32_bf16 v[84:87], a[144:147], a[20:23], v[84:87]
  ds_read_b64_tr_b16 a[170:171], v194 offset:25088
  v_fma_f32 v236, -v222, v235, v236
  v_fmac_f32 v237, v222, v234
  v_mfma_f32_16x16x32_bf16 v[88:91], a[148:151], a[16:19], v[88:91]
  ds_read_b64_tr_b16 a[172:173], v195 offset:24576
  s_add_u32 s44, s44, 884736
  v_mfma_f32_16x16x32_bf16 v[92:95], a[148:151], a[20:23], v[92:95]
  ds_read_b64_tr_b16 a[174:175], v195 offset:25088
  s_add_u32 m0, s46, 98304
  s_nop 0
  buffer_load_dwordx4 v203, s[8:11], s44 offen lds
  v_mfma_f32_16x16x32_bf16 v[96:99], a[152:155], a[16:19], v[96:99]
  ds_read_b64_tr_b16 a[144:145], v196 offset:24576
  s_waitcnt vmcnt(15)
  v_fmac_f32 v238, v221, v236
  v_mfma_f32_16x16x32_bf16 v[100:103], a[152:155], a[20:23], v[100:103]
  ds_read_b64_tr_b16 a[146:147], v196 offset:25088
  v_fmac_f32 v239, v221, v237
  s_waitcnt lgkmcnt(4)
  v_mfma_f32_16x16x32_bf16 v[104:107], a[156:159], a[16:19], v[104:107]
  ds_read_b64_tr_b16 a[148:149], v197 offset:24576
  v_fma_f32 v238, -v222, v237, v238
  v_mfma_f32_16x16x32_bf16 v[108:111], a[156:159], a[20:23], v[108:111]
  ds_read_b64_tr_b16 a[150:151], v197 offset:25088
  v_fmac_f32 v239, v222, v236
  v_accvgpr_write_b32 a193, v33
  v_mfma_f32_16x16x32_bf16 v[112:115], a[160:163], a[16:19], v[112:115]
  ds_read_b64_tr_b16 a[152:153], v194 offset:36864
  s_waitcnt vmcnt(14)
  v_fmac_f32 v240, v221, v238
  v_mfma_f32_16x16x32_bf16 v[116:119], a[160:163], a[20:23], v[116:119]
  ds_read_b64_tr_b16 a[154:155], v194 offset:37376
  v_fmac_f32 v241, v221, v239
  v_fma_f32 v240, -v222, v239, v240
  v_mfma_f32_16x16x32_bf16 v[120:123], a[164:167], a[16:19], v[120:123]
  ds_read_b64_tr_b16 a[156:157], v195 offset:36864
  v_fmac_f32 v241, v222, v238
  v_mfma_f32_16x16x32_bf16 v[124:127], a[164:167], a[20:23], v[124:127]
  ds_read_b64_tr_b16 a[158:159], v195 offset:37376
  s_waitcnt vmcnt(13)
  v_fmac_f32 v242, v221, v240
  v_fmac_f32 v243, v221, v241
  v_mfma_f32_16x16x32_bf16 v[64:67], a[168:171], a[24:27], v[64:67]
  ds_read_b64_tr_b16 a[160:161], v196 offset:36864
  v_fma_f32 v242, -v222, v241, v242
  v_mfma_f32_16x16x32_bf16 v[68:71], a[168:171], a[28:31], v[68:71]
  ds_read_b64_tr_b16 a[162:163], v196 offset:37376
  v_fmac_f32 v243, v222, v240
  s_waitcnt lgkmcnt(4)
  v_mfma_f32_16x16x32_bf16 v[72:75], a[172:175], a[24:27], v[72:75]
  ds_read_b64_tr_b16 a[164:165], v197 offset:36864
  v_mov_b32 v250, v242
  v_mfma_f32_16x16x32_bf16 v[76:79], a[172:175], a[28:31], v[76:79]
  ds_read_b64_tr_b16 a[166:167], v197 offset:37376
  v_mov_b32 v251, v243
  v_subrev_u32 v249, 2688, v248
  v_mfma_f32_16x16x32_bf16 v[80:83], a[144:147], a[24:27], v[80:83]
  ds_read_b64_tr_b16 a[168:169], v194 offset:28672
  buffer_load_dwordx2 v[228:229], v249, s[28:31], 0 offen sc1
  v_mfma_f32_16x16x32_bf16 v[84:87], a[144:147], a[28:31], v[84:87]
  ds_read_b64_tr_b16 a[170:171], v194 offset:29184
  v_subrev_u32 v249, 2304, v248
  v_mfma_f32_16x16x32_bf16 v[88:91], a[148:151], a[24:27], v[88:91]
  ds_read_b64_tr_b16 a[172:173], v195 offset:28672
  v_accvgpr_write_b32 a194, v34
  v_accvgpr_write_b32 a195, v35
  v_mfma_f32_16x16x32_bf16 v[92:95], a[148:151], a[28:31], v[92:95]
  ds_read_b64_tr_b16 a[174:175], v195 offset:29184
  v_mfma_f32_16x16x32_bf16 v[96:99], a[152:155], a[24:27], v[96:99]
  ds_read_b64_tr_b16 a[144:145], v196 offset:28672
  v_mfma_f32_16x16x32_bf16 v[100:103], a[152:155], a[28:31], v[100:103]
  ds_read_b64_tr_b16 a[146:147], v196 offset:29184
  s_waitcnt lgkmcnt(4)
  v_mfma_f32_16x16x32_bf16 v[104:107], a[156:159], a[24:27], v[104:107]
  ds_read_b64_tr_b16 a[148:149], v197 offset:28672
  buffer_load_dwordx4 v204, s[8:11], s44 offen offset:1024 lds
  v_mfma_f32_16x16x32_bf16 v[108:111], a[156:159], a[28:31], v[108:111]
  ds_read_b64_tr_b16 a[150:151], v197 offset:29184
  v_mfma_f32_16x16x32_bf16 v[112:115], a[160:163], a[24:27], v[112:115]
  ds_read_b64_tr_b16 a[152:153], v194 offset:40960
  v_mfma_f32_16x16x32_bf16 v[116:119], a[160:163], a[28:31], v[116:119]
  ds_read_b64_tr_b16 a[154:155], v194 offset:41472
  v_mfma_f32_16x16x32_bf16 v[120:123], a[164:167], a[24:27], v[120:123]
  ds_read_b64_tr_b16 a[156:157], v195 offset:40960
  v_mfma_f32_16x16x32_bf16 v[124:127], a[164:167], a[28:31], v[124:127]
  ds_read_b64_tr_b16 a[158:159], v195 offset:41472
  buffer_load_dwordx2 v[230:231], v249, s[28:31], 0 offen sc1
  v_mfma_f32_16x16x32_bf16 v[64:67], a[168:171], a[32:35], v[64:67]
  ds_read_b64_tr_b16 a[160:161], v196 offset:40960
  v_subrev_u32 v249, 1920, v248
  v_mfma_f32_16x16x32_bf16 v[68:71], a[168:171], a[36:39], v[68:71]
  ds_read_b64_tr_b16 a[162:163], v196 offset:41472
  s_waitcnt lgkmcnt(4)
  v_mfma_f32_16x16x32_bf16 v[72:75], a[172:175], a[32:35], v[72:75]
  ds_read_b64_tr_b16 a[164:165], v197 offset:40960
  v_mfma_f32_16x16x32_bf16 v[76:79], a[172:175], a[36:39], v[76:79]
  ds_read_b64_tr_b16 a[166:167], v197 offset:41472
  v_mfma_f32_16x16x32_bf16 v[80:83], a[144:147], a[32:35], v[80:83]
  ds_read_b64_tr_b16 a[168:169], v194 offset:32768
  buffer_load_dwordx4 v205, s[8:11], s44 offen offset:2048 lds
  v_mfma_f32_16x16x32_bf16 v[84:87], a[144:147], a[36:39], v[84:87]
  ds_read_b64_tr_b16 a[170:171], v194 offset:33280
  v_mfma_f32_16x16x32_bf16 v[88:91], a[148:151], a[32:35], v[88:91]
  ds_read_b64_tr_b16 a[172:173], v195 offset:32768
  v_mfma_f32_16x16x32_bf16 v[92:95], a[148:151], a[36:39], v[92:95]
  ds_read_b64_tr_b16 a[174:175], v195 offset:33280
  v_mfma_f32_16x16x32_bf16 v[96:99], a[152:155], a[32:35], v[96:99]
  ds_read_b64_tr_b16 a[144:145], v196 offset:32768
  v_mfma_f32_16x16x32_bf16 v[100:103], a[152:155], a[36:39], v[100:103]
  ds_read_b64_tr_b16 a[146:147], v196 offset:33280
  s_waitcnt lgkmcnt(4)
  v_mfma_f32_16x16x32_bf16 v[104:107], a[156:159], a[32:35], v[104:107]
  ds_read_b64_tr_b16 a[148:149], v197 offset:32768
  buffer_load_dwordx2 v[232:233], v249, s[28:31], 0 offen sc1
  v_subrev_u32 v249, 1536, v248
  v_mfma_f32_16x16x32_bf16 v[108:111], a[156:159], a[36:39], v[108:111]
  ds_read_b64_tr_b16 a[150:151], v197 offset:33280
  v_mfma_f32_16x16x32_bf16 v[112:115], a[160:163], a[32:35], v[112:115]
  ds_read_b64_tr_b16 a[152:153], v194 offset:45056
  v_mfma_f32_16x16x32_bf16 v[116:119], a[160:163], a[36:39], v[116:119]
  ds_read_b64_tr_b16 a[154:155], v194 offset:45568
  v_mfma_f32_16x16x32_bf16 v[120:123], a[164:167], a[32:35], v[120:123]
  ds_read_b64_tr_b16 a[156:157], v195 offset:45056
  v_mfma_f32_16x16x32_bf16 v[124:127], a[164:167], a[36:39], v[124:127]
  ds_read_b64_tr_b16 a[158:159], v195 offset:45568
  buffer_load_dwordx4 v206, s[8:11], s44 offen offset:3072 lds
  s_add_u32 m0, s46, 102400
  s_nop 0
  buffer_load_dwordx4 v207, s[8:11], s44 offen lds
  buffer_load_dwordx4 v208, s[8:11], s44 offen offset:1024 lds
  v_mfma_f32_16x16x32_bf16 v[64:67], a[168:171], a[40:43], v[64:67]
  ds_read_b64_tr_b16 a[160:161], v196 offset:45056
  v_mfma_f32_16x16x32_bf16 v[68:71], a[168:171], a[44:47], v[68:71]
  ds_read_b64_tr_b16 a[162:163], v196 offset:45568
  s_waitcnt lgkmcnt(4)
  v_mfma_f32_16x16x32_bf16 v[72:75], a[172:175], a[40:43], v[72:75]
  ds_read_b64_tr_b16 a[164:165], v197 offset:45056
  v_mfma_f32_16x16x32_bf16 v[76:79], a[172:175], a[44:47], v[76:79]
  ds_read_b64_tr_b16 a[166:167], v197 offset:45568
  s_barrier
  v_mfma_f32_16x16x32_bf16 v[80:83], a[144:147], a[40:43], v[80:83]
  ds_read_b64_tr_b16 a[168:169], v190
  s_add_u32 s44, s64, 384
  s_add_u32 m0, s46, 122880
  v_mfma_f32_16x16x32_bf16 v[84:87], a[144:147], a[44:47], v[84:87]
  ds_read_b64_tr_b16 a[170:171], v190 offset:512
  buffer_load_dwordx2 v[234:235], v249, s[28:31], 0 offen sc1
  v_mfma_f32_16x16x32_bf16 v[88:91], a[148:151], a[40:43], v[88:91]
  ds_read_b64_tr_b16 a[172:173], v191
  v_subrev_u32 v249, 1152, v248
  v_mfma_f32_16x16x32_bf16 v[92:95], a[148:151], a[44:47], v[92:95]
  ds_read_b64_tr_b16 a[174:175], v191 offset:512
  v_mfma_f32_16x16x32_bf16 v[96:99], a[152:155], a[40:43], v[96:99]
  ds_read_b64_tr_b16 a[144:145], v192
  v_mfma_f32_16x16x32_bf16 v[100:103], a[152:155], a[44:47], v[100:103]
  ds_read_b64_tr_b16 a[146:147], v192 offset:512
  s_waitcnt lgkmcnt(4)
  v_mfma_f32_16x16x32_bf16 v[104:107], a[156:159], a[40:43], v[104:107]
  ds_read_b64_tr_b16 a[148:149], v193
  buffer_load_dwordx2 v[236:237], v249, s[28:31], 0 offen sc1
  v_mfma_f32_16x16x32_bf16 v[108:111], a[156:159], a[44:47], v[108:111]
  ds_read_b64_tr_b16 a[150:151], v193 offset:512
  v_subrev_u32 v249, 768, v248
  v_mfma_f32_16x16x32_bf16 v[112:115], a[160:163], a[40:43], v[112:115]
  ds_read_b64_tr_b16 a[152:153], v190 offset:12288
  v_mfma_f32_16x16x32_bf16 v[116:119], a[160:163], a[44:47], v[116:119]
  ds_read_b64_tr_b16 a[154:155], v190 offset:12800
  v_mfma_f32_16x16x32_bf16 v[120:123], a[164:167], a[40:43], v[120:123]
  ds_read_b64_tr_b16 a[156:157], v191 offset:12288
  buffer_load_dwordx2 v[238:239], v249, s[28:31], 0 offen sc1
  v_mfma_f32_16x16x32_bf16 v[124:127], a[164:167], a[44:47], v[124:127]
  ds_read_b64_tr_b16 a[158:159], v191 offset:12800
  v_subrev_u32 v249, 384, v248
  v_mfma_f32_16x16x32_bf16 v[64:67], a[168:171], a[48:51], v[64:67]
  ds_read_b64_tr_b16 a[160:161], v192 offset:12288
  v_mfma_f32_16x16x32_bf16 v[68:71], a[168:171], a[52:55], v[68:71]
  ds_read_b64_tr_b16 a[162:163], v192 offset:12800
  s_waitcnt lgkmcnt(4)
  v_mfma_f32_16x16x32_bf16 v[72:75], a[172:175], a[48:51], v[72:75]
  ds_read_b64_tr_b16 a[164:165], v193 offset:12288
  buffer_load_dwordx2 v[240:241], v249, s[28:31], 0 offen sc1
  v_mfma_f32_16x16x32_bf16 v[76:79], a[172:175], a[52:55], v[76:79]
  ds_read_b64_tr_b16 a[166:167], v193 offset:12800
  v_mfma_f32_16x16x32_bf16 v[80:83], a[144:147], a[48:51], v[80:83]
  ds_read_b64_tr_b16 a[168:169], v190 offset:4096
  v_mfma_f32_16x16x32_bf16 v[84:87], a[144:147], a[52:55], v[84:87]
  ds_read_b64_tr_b16 a[170:171], v190 offset:4608
  v_mfma_f32_16x16x32_bf16 v[88:91], a[148:151], a[48:51], v[88:91]
  ds_read_b64_tr_b16 a[172:173], v191 offset:4096
  v_mfma_f32_16x16x32_bf16 v[92:95], a[148:151], a[52:55], v[92:95]
  ds_read_b64_tr_b16 a[174:175], v191 offset:4608
  v_mfma_f32_16x16x32_bf16 v[96:99], a[152:155], a[48:51], v[96:99]
  ds_read_b64_tr_b16 a[144:145], v192 offset:4096
  buffer_load_dwordx4 v203, s[8:11], s44 offen lds
  v_mfma_f32_16x16x32_bf16 v[100:103], a[152:155], a[52:55], v[100:103]
  ds_read_b64_tr_b16 a[146:147], v192 offset:4608
  s_waitcnt lgkmcnt(4)
  v_mfma_f32_16x16x32_bf16 v[104:107], a[156:159], a[48:51], v[104:107]
  ds_read_b64_tr_b16 a[148:149], v193 offset:4096
  v_mfma_f32_16x16x32_bf16 v[108:111], a[156:159], a[52:55], v[108:111]
  ds_read_b64_tr_b16 a[150:151], v193 offset:4608
  v_mfma_f32_16x16x32_bf16 v[112:115], a[160:163], a[48:51], v[112:115]
  ds_read_b64_tr_b16 a[152:153], v190 offset:16384
  v_mfma_f32_16x16x32_bf16 v[116:119], a[160:163], a[52:55], v[116:119]
  ds_read_b64_tr_b16 a[154:155], v190 offset:16896
  s_add_u32 s63, s61, 4096
  buffer_store_dwordx4 v[32:35], v226, s[24:27], s63 offen sc1
  v_mfma_f32_16x16x32_bf16 v[120:123], a[164:167], a[48:51], v[120:123]
  ds_read_b64_tr_b16 a[156:157], v191 offset:16384
  v_max_f32 v4, 0, v4
  v_mul_f32 v36, v216, v36
  v_mfma_f32_16x16x32_bf16 v[124:127], a[164:167], a[52:55], v[124:127]
  ds_read_b64_tr_b16 a[158:159], v191 offset:16896
  v_max_f32 v5, 0, v5
  v_mul_f32 v37, v216, v37
  v_mfma_f32_16x16x32_bf16 v[64:67], a[168:171], a[56:59], v[64:67]
  ds_read_b64_tr_b16 a[160:161], v192 offset:16384
  v_max_f32 v6, 0, v6
  v_mfma_f32_16x16x32_bf16 v[68:71], a[168:171], a[60:63], v[68:71]
  ds_read_b64_tr_b16 a[162:163], v192 offset:16896
  v_mul_f32 v38, v216, v38
  s_waitcnt lgkmcnt(4)
  v_mfma_f32_16x16x32_bf16 v[72:75], a[172:175], a[56:59], v[72:75]
  ds_read_b64_tr_b16 a[164:165], v193 offset:16384
  buffer_load_dwordx4 v204, s[8:11], s44 offen offset:1024 lds
  v_mfma_f32_16x16x32_bf16 v[76:79], a[172:175], a[60:63], v[76:79]
  ds_read_b64_tr_b16 a[166:167], v193 offset:16896
  v_max_f32 v7, 0, v7
  v_mul_f32 v39, v216, v39
  v_mfma_f32_16x16x32_bf16 v[80:83], a[144:147], a[56:59], v[80:83]
  ds_read_b64_tr_b16 a[168:169], v190 offset:8192
  v_mul_f32 v4, v4, v36
  v_mfma_f32_16x16x32_bf16 v[84:87], a[144:147], a[60:63], v[84:87]
  ds_read_b64_tr_b16 a[170:171], v190 offset:8704
  v_mul_f32 v5, v5, v37
  v_mul_f32 v6, v6, v38
  v_mfma_f32_16x16x32_bf16 v[88:91], a[148:151], a[56:59], v[88:91]
  ds_read_b64_tr_b16 a[172:173], v191 offset:8192
  v_mul_f32 v7, v7, v39
  v_max_f32 v12, 0, v12
  v_mfma_f32_16x16x32_bf16 v[92:95], a[148:151], a[60:63], v[92:95]
  ds_read_b64_tr_b16 a[174:175], v191 offset:8704
  v_mul_f32 v44, v216, v44
  v_mfma_f32_16x16x32_bf16 v[96:99], a[152:155], a[56:59], v[96:99]
  ds_read_b64_tr_b16 a[144:145], v192 offset:8192
  v_max_f32 v13, 0, v13
  v_mul_f32 v45, v216, v45
  v_mfma_f32_16x16x32_bf16 v[100:103], a[152:155], a[60:63], v[100:103]
  ds_read_b64_tr_b16 a[146:147], v192 offset:8704
  s_waitcnt lgkmcnt(4)
  v_mfma_f32_16x16x32_bf16 v[104:107], a[156:159], a[56:59], v[104:107]
  ds_read_b64_tr_b16 a[148:149], v193 offset:8192
  buffer_load_dwordx4 v205, s[8:11], s44 offen offset:2048 lds
  v_max_f32 v14, 0, v14
  v_mfma_f32_16x16x32_bf16 v[108:111], a[156:159], a[60:63], v[108:111]
  ds_read_b64_tr_b16 a[150:151], v193 offset:8704
  v_mul_f32 v46, v216, v46
  v_mfma_f32_16x16x32_bf16 v[112:115], a[160:163], a[56:59], v[112:115]
  ds_read_b64_tr_b16 a[152:153], v190 offset:20480
  v_max_f32 v15, 0, v15
  v_mul_f32 v47, v216, v47
  v_mfma_f32_16x16x32_bf16 v[116:119], a[160:163], a[60:63], v[116:119]
  ds_read_b64_tr_b16 a[154:155], v190 offset:20992
  v_mul_f32 v12, v12, v44
  v_mfma_f32_16x16x32_bf16 v[120:123], a[164:167], a[56:59], v[120:123]
  ds_read_b64_tr_b16 a[156:157], v191 offset:20480
  v_mul_f32 v13, v13, v45
  v_mul_f32 v14, v14, v46
  v_mfma_f32_16x16x32_bf16 v[124:127], a[164:167], a[60:63], v[124:127]
  ds_read_b64_tr_b16 a[158:159], v191 offset:20992
  v_mul_f32 v15, v15, v47
  v_cvt_pk_bf16_f32 v36, v4, v5
  v_cvt_pk_bf16_f32 v37, v6, v7
  v_cvt_pk_bf16_f32 v38, v12, v13
  buffer_load_dwordx4 v206, s[8:11], s44 offen offset:3072 lds
  s_add_u32 m0, s46, 126976
  s_nop 0
  buffer_load_dwordx4 v207, s[8:11], s44 offen lds
  buffer_load_dwordx4 v208, s[8:11], s44 offen offset:1024 lds
  v_mfma_f32_16x16x32_bf16 v[64:67], a[168:171], a[64:67], v[64:67]
  ds_read_b64_tr_b16 a[160:161], v192 offset:20480
  v_cvt_pk_bf16_f32 v39, v14, v15
  v_accvgpr_write_b32 a196, v36
  v_mfma_f32_16x16x32_bf16 v[68:71], a[168:171], a[68:71], v[68:71]
  ds_read_b64_tr_b16 a[162:163], v192 offset:20992
  v_accvgpr_write_b32 a197, v37
  s_waitcnt lgkmcnt(4)
  v_mfma_f32_16x16x32_bf16 v[72:75], a[172:175], a[64:67], v[72:75]
  ds_read_b64_tr_b16 a[164:165], v193 offset:20480
  s_waitcnt vmcnt(26)
  v_mfma_f32_16x16x32_bf16 v[76:79], a[172:175], a[68:71], v[76:79]
  ds_read_b64_tr_b16 a[166:167], v193 offset:20992
  v_accvgpr_write_b32 a198, v38
  s_barrier
  v_mfma_f32_16x16x32_bf16 v[80:83], a[144:147], a[64:67], v[80:83]
  ds_read_b64_tr_b16 a[168:169], v190 offset:24576
  s_add_u32 s44, s44, 884736
  v_mfma_f32_16x16x32_bf16 v[84:87], a[144:147], a[68:71], v[84:87]
  ds_read_b64_tr_b16 a[170:171], v190 offset:25088
  s_add_u32 m0, s46, 73728
  v_accvgpr_write_b32 a199, v39
  v_mfma_f32_16x16x32_bf16 v[88:91], a[148:151], a[64:67], v[88:91]
  ds_read_b64_tr_b16 a[172:173], v191 offset:24576
  s_add_u32 s63, s61, 4096
  buffer_store_dwordx4 v[36:39], v226, s[24:27], s63 offen offset:1024 sc1
  v_mfma_f32_16x16x32_bf16 v[92:95], a[148:151], a[68:71], v[92:95]
  ds_read_b64_tr_b16 a[174:175], v191 offset:25088
  v_max_f32 v16, 0, v16
  v_mul_f32 v48, v215, v48
  v_mfma_f32_16x16x32_bf16 v[96:99], a[152:155], a[64:67], v[96:99]
  ds_read_b64_tr_b16 a[144:145], v192 offset:24576
  v_max_f32 v17, 0, v17
  v_mfma_f32_16x16x32_bf16 v[100:103], a[152:155], a[68:71], v[100:103]
  ds_read_b64_tr_b16 a[146:147], v192 offset:25088
  v_mul_f32 v49, v215, v49
  s_waitcnt lgkmcnt(4)
  v_mfma_f32_16x16x32_bf16 v[104:107], a[156:159], a[64:67], v[104:107]
  ds_read_b64_tr_b16 a[148:149], v193 offset:24576
  v_max_f32 v18, 0, v18
  v_mfma_f32_16x16x32_bf16 v[108:111], a[156:159], a[68:71], v[108:111]
  ds_read_b64_tr_b16 a[150:151], v193 offset:25088
  buffer_load_dwordx4 v203, s[8:11], s44 offen lds
  v_mul_f32 v50, v215, v50
  v_mfma_f32_16x16x32_bf16 v[112:115], a[160:163], a[64:67], v[112:115]
  ds_read_b64_tr_b16 a[152:153], v190 offset:36864
  v_max_f32 v19, 0, v19
  v_mul_f32 v51, v215, v51
  v_mfma_f32_16x16x32_bf16 v[116:119], a[160:163], a[68:71], v[116:119]
  ds_read_b64_tr_b16 a[154:155], v190 offset:37376
  v_mul_f32 v16, v16, v48
  v_mfma_f32_16x16x32_bf16 v[120:123], a[164:167], a[64:67], v[120:123]
  ds_read_b64_tr_b16 a[156:157], v191 offset:36864
  s_waitcnt vmcnt(20)
  v_fmac_f32 v228, v221, v250
  v_fmac_f32 v229, v221, v251
  v_mfma_f32_16x16x32_bf16 v[124:127], a[164:167], a[68:71], v[124:127]
  ds_read_b64_tr_b16 a[158:159], v191 offset:37376
  v_fma_f32 v228, -v222, v251, v228
  v_mfma_f32_16x16x32_bf16 v[64:67], a[168:171], a[72:75], v[64:67]
  ds_read_b64_tr_b16 a[160:161], v192 offset:36864
  v_fmac_f32 v229, v222, v250
  v_mul_f32 v17, v17, v49
  v_mfma_f32_16x16x32_bf16 v[68:71], a[168:171], a[76:79], v[68:71]
  ds_read_b64_tr_b16 a[162:163], v192 offset:37376
  s_waitcnt lgkmcnt(4)
  v_mfma_f32_16x16x32_bf16 v[72:75], a[172:175], a[72:75], v[72:75]
  ds_read_b64_tr_b16 a[164:165], v193 offset:36864
  buffer_load_dwordx4 v204, s[8:11], s44 offen offset:1024 lds
  v_mul_f32 v18, v18, v50
  v_mfma_f32_16x16x32_bf16 v[76:79], a[172:175], a[76:79], v[76:79]
  ds_read_b64_tr_b16 a[166:167], v193 offset:37376
  v_mul_f32 v19, v19, v51
  v_mfma_f32_16x16x32_bf16 v[80:83], a[144:147], a[72:75], v[80:83]
  ds_read_b64_tr_b16 a[168:169], v190 offset:28672
  v_max_f32 v24, 0, v24
  v_mul_f32 v56, v215, v56
  v_mfma_f32_16x16x32_bf16 v[84:87], a[144:147], a[76:79], v[84:87]
  ds_read_b64_tr_b16 a[170:171], v190 offset:29184
  v_max_f32 v25, 0, v25
  v_mfma_f32_16x16x32_bf16 v[88:91], a[148:151], a[72:75], v[88:91]
  ds_read_b64_tr_b16 a[172:173], v191 offset:28672
  v_mul_f32 v57, v215, v57
  v_max_f32 v26, 0, v26
  v_mfma_f32_16x16x32_bf16 v[92:95], a[148:151], a[76:79], v[92:95]
  ds_read_b64_tr_b16 a[174:175], v191 offset:29184
  v_mul_f32 v58, v215, v58
  v_max_f32 v27, 0, v27
  v_mfma_f32_16x16x32_bf16 v[96:99], a[152:155], a[72:75], v[96:99]
  ds_read_b64_tr_b16 a[144:145], v192 offset:28672
  v_mul_f32 v59, v215, v59
  v_mfma_f32_16x16x32_bf16 v[100:103], a[152:155], a[76:79], v[100:103]
  ds_read_b64_tr_b16 a[146:147], v192 offset:29184
  buffer_load_dwordx4 v205, s[8:11], s44 offen offset:2048 lds
  s_waitcnt lgkmcnt(4)
  v_mfma_f32_16x16x32_bf16 v[104:107], a[156:159], a[72:75], v[104:107]
  ds_read_b64_tr_b16 a[148:149], v193 offset:28672
  s_waitcnt vmcnt(20)
  v_fmac_f32 v230, v221, v228
  v_mfma_f32_16x16x32_bf16 v[108:111], a[156:159], a[76:79], v[108:111]
  ds_read_b64_tr_b16 a[150:151], v193 offset:29184
  v_fmac_f32 v231, v221, v229
  v_fma_f32 v230, -v222, v229, v230
  v_mfma_f32_16x16x32_bf16 v[112:115], a[160:163], a[72:75], v[112:115]
  ds_read_b64_tr_b16 a[152:153], v190 offset:40960
  v_fmac_f32 v231, v222, v228
  v_mfma_f32_16x16x32_bf16 v[116:119], a[160:163], a[76:79], v[116:119]
  ds_read_b64_tr_b16 a[154:155], v190 offset:41472
  v_mul_f32 v24, v24, v56
  v_mul_f32 v25, v25, v57
  v_mfma_f32_16x16x32_bf16 v[120:123], a[164:167], a[72:75], v[120:123]
  ds_read_b64_tr_b16 a[156:157], v191 offset:40960
  v_mul_f32 v26, v26, v58
  v_mfma_f32_16x16x32_bf16 v[124:127], a[164:167], a[76:79], v[124:127]
  ds_read_b64_tr_b16 a[158:159], v191 offset:41472
  v_mul_f32 v27, v27, v59
  v_cvt_pk_bf16_f32 v48, v16, v17
  v_mfma_f32_16x16x32_bf16 v[64:67], a[168:171], a[80:83], v[64:67]
  ds_read_b64_tr_b16 a[160:161], v192 offset:40960
  buffer_load_dwordx4 v206, s[8:11], s44 offen offset:3072 lds
  v_mfma_f32_16x16x32_bf16 v[68:71], a[168:171], a[84:87], v[68:71]
  ds_read_b64_tr_b16 a[162:163], v192 offset:41472
  s_add_u32 m0, s46, 77824
  s_waitcnt lgkmcnt(4)
  v_mfma_f32_16x16x32_bf16 v[72:75], a[172:175], a[80:83], v[72:75]
  ds_read_b64_tr_b16 a[164:165], v193 offset:40960
  v_cvt_pk_bf16_f32 v49, v18, v19
  v_cvt_pk_bf16_f32 v50, v24, v25
  v_mfma_f32_16x16x32_bf16 v[76:79], a[172:175], a[84:87], v[76:79]
  ds_read_b64_tr_b16 a[166:167], v193 offset:41472
  v_cvt_pk_bf16_f32 v51, v26, v27
  v_mfma_f32_16x16x32_bf16 v[80:83], a[144:147], a[80:83], v[80:83]
  ds_read_b64_tr_b16 a[168:169], v190 offset:32768
  s_waitcnt vmcnt(19)
  v_fmac_f32 v232, v221, v230
  v_fmac_f32 v233, v221, v231
  v_mfma_f32_16x16x32_bf16 v[84:87], a[144:147], a[84:87], v[84:87]
  ds_read_b64_tr_b16 a[170:171], v190 offset:33280
  v_fma_f32 v232, -v222, v231, v232
  v_mfma_f32_16x16x32_bf16 v[88:91], a[148:151], a[80:83], v[88:91]
  ds_read_b64_tr_b16 a[172:173], v191 offset:32768
  v_fmac_f32 v233, v222, v230
  v_accvgpr_write_b32 a200, v48
  v_mfma_f32_16x16x32_bf16 v[92:95], a[148:151], a[84:87], v[92:95]
  ds_read_b64_tr_b16 a[174:175], v191 offset:33280
  buffer_load_dwordx4 v207, s[8:11], s44 offen lds
  v_mfma_f32_16x16x32_bf16 v[96:99], a[152:155], a[80:83], v[96:99]
  ds_read_b64_tr_b16 a[144:145], v192 offset:32768
  v_accvgpr_write_b32 a201, v49
  v_accvgpr_write_b32 a202, v50
  v_mfma_f32_16x16x32_bf16 v[100:103], a[152:155], a[84:87], v[100:103]
  ds_read_b64_tr_b16 a[146:147], v192 offset:33280
  s_waitcnt lgkmcnt(4)
  v_mfma_f32_16x16x32_bf16 v[104:107], a[156:159], a[80:83], v[104:107]
  ds_read_b64_tr_b16 a[148:149], v193 offset:32768
  v_accvgpr_write_b32 a203, v51
  v_mfma_f32_16x16x32_bf16 v[108:111], a[156:159], a[84:87], v[108:111]
  ds_read_b64_tr_b16 a[150:151], v193 offset:33280
  v_mfma_f32_16x16x32_bf16 v[112:115], a[160:163], a[80:83], v[112:115]
  ds_read_b64_tr_b16 a[152:153], v190 offset:45056
  s_add_u32 s63, s61, 4096
  buffer_store_dwordx4 v[48:51], v226, s[24:27], s63 offen offset:2048 sc1
  v_mfma_f32_16x16x32_bf16 v[116:119], a[160:163], a[84:87], v[116:119]
  ds_read_b64_tr_b16 a[154:155], v190 offset:45568
  v_max_f32 v20, 0, v20
  v_mul_f32 v52, v216, v52
  v_mfma_f32_16x16x32_bf16 v[120:123], a[164:167], a[80:83], v[120:123]
  ds_read_b64_tr_b16 a[156:157], v191 offset:45056
  v_max_f32 v21, 0, v21
  v_mfma_f32_16x16x32_bf16 v[124:127], a[164:167], a[84:87], v[124:127]
  ds_read_b64_tr_b16 a[158:159], v191 offset:45568
  s_waitcnt vmcnt(17)
  v_fmac_f32 v234, v221, v232
  v_fmac_f32 v235, v221, v233
  buffer_load_dwordx4 v208, s[8:11], s44 offen offset:1024 lds
  v_mfma_f32_16x16x32_bf16 v[64:67], a[168:171], a[88:91], v[64:67]
  ds_read_b64_tr_b16 a[160:161], v192 offset:45056
  v_fma_f32 v234, -v222, v233, v234
  v_mfma_f32_16x16x32_bf16 v[68:71], a[168:171], a[92:95], v[68:71]
  ds_read_b64_tr_b16 a[162:163], v192 offset:45568
  v_fmac_f32 v235, v222, v232
  s_waitcnt lgkmcnt(4)
  v_mfma_f32_16x16x32_bf16 v[72:75], a[172:175], a[88:91], v[72:75]
  ds_read_b64_tr_b16 a[164:165], v193 offset:45056
  v_mfma_f32_16x16x32_bf16 v[76:79], a[172:175], a[92:95], v[76:79]
  ds_read_b64_tr_b16 a[166:167], v193 offset:45568
  v_mul_f32 v53, v216, v53
  s_barrier
  v_mfma_f32_16x16x32_bf16 v[80:83], a[144:147], a[88:91], v[80:83]
  ds_read_b64_tr_b16 a[168:169], v194
  s_waitcnt vmcnt(17)
  v_fmac_f32 v236, v221, v234
  v_mfma_f32_16x16x32_bf16 v[84:87], a[144:147], a[92:95], v[84:87]
  ds_read_b64_tr_b16 a[170:171], v194 offset:512
  v_fmac_f32 v237, v221, v235
  v_fma_f32 v236, -v222, v235, v236
  v_mfma_f32_16x16x32_bf16 v[88:91], a[148:151], a[88:91], v[88:91]
  ds_read_b64_tr_b16 a[172:173], v195
  v_fmac_f32 v237, v222, v234
  v_mfma_f32_16x16x32_bf16 v[92:95], a[148:151], a[92:95], v[92:95]
  ds_read_b64_tr_b16 a[174:175], v195 offset:512
  s_add_u32 s44, s44, 884736
  s_add_u32 m0, s46, 0
  v_mfma_f32_16x16x32_bf16 v[96:99], a[152:155], a[88:91], v[96:99]
  ds_read_b64_tr_b16 a[144:145], v196
  buffer_load_dwordx4 v203, s[8:11], s44 offen lds
  v_max_f32 v22, 0, v22
  v_mfma_f32_16x16x32_bf16 v[100:103], a[152:155], a[92:95], v[100:103]
  ds_read_b64_tr_b16 a[146:147], v196 offset:512
  s_waitcnt lgkmcnt(4)
  v_mfma_f32_16x16x32_bf16 v[104:107], a[156:159], a[88:91], v[104:107]
  ds_read_b64_tr_b16 a[148:149], v197
  s_waitcnt vmcnt(17)
  v_fmac_f32 v238, v221, v236
  v_fmac_f32 v239, v221, v237
  v_mfma_f32_16x16x32_bf16 v[108:111], a[156:159], a[92:95], v[108:111]
  ds_read_b64_tr_b16 a[150:151], v197 offset:512
  v_fma_f32 v238, -v222, v237, v238
  v_mfma_f32_16x16x32_bf16 v[112:115], a[160:163], a[88:91], v[112:115]
  ds_read_b64_tr_b16 a[152:153], v194 offset:12288
  v_fmac_f32 v239, v222, v236
  v_mul_f32 v54, v216, v54
  v_mfma_f32_16x16x32_bf16 v[116:119], a[160:163], a[92:95], v[116:119]
  ds_read_b64_tr_b16 a[154:155], v194 offset:12800
  s_waitcnt vmcnt(16)
  v_fmac_f32 v240, v221, v238
  v_mfma_f32_16x16x32_bf16 v[120:123], a[164:167], a[88:91], v[120:123]
  ds_read_b64_tr_b16 a[156:157], v195 offset:12288
  v_fmac_f32 v241, v221, v239
  v_fma_f32 v240, -v222, v239, v240
  v_mfma_f32_16x16x32_bf16 v[124:127], a[164:167], a[92:95], v[124:127]
  ds_read_b64_tr_b16 a[158:159], v195 offset:12800
  v_fmac_f32 v241, v222, v238
  v_mfma_f32_16x16x32_bf16 v[64:67], a[168:171], a[96:99], v[64:67]
  ds_read_b64_tr_b16 a[160:161], v196 offset:12288
  v_mov_b32 v250, v240
  v_mov_b32 v251, v241
  v_mfma_f32_16x16x32_bf16 v[68:71], a[168:171], a[100:103], v[68:71]
  ds_read_b64_tr_b16 a[162:163], v196 offset:12800
  s_waitcnt lgkmcnt(4)
  v_mfma_f32_16x16x32_bf16 v[72:75], a[172:175], a[96:99], v[72:75]
  ds_read_b64_tr_b16 a[164:165], v197 offset:12288
  s_sub_u32 s49, s40, 3
  s_max_i32 s49, s49, 0
  s_mul_i32 s49, s49, 384
  s_add_u32 s49, s49, 159744
  v_mfma_f32_16x16x32_bf16 v[76:79], a[172:175], a[100:103], v[76:79]
  ds_read_b64_tr_b16 a[166:167], v197 offset:12800
  buffer_load_dwordx4 v204, s[8:11], s44 offen offset:1024 lds
  v_add_u32 v248, s49, v227
  v_mfma_f32_16x16x32_bf16 v[80:83], a[144:147], a[96:99], v[80:83]
  ds_read_b64_tr_b16 a[168:169], v194 offset:4096
  ds_read_b64 v[228:229], v248
  v_mfma_f32_16x16x32_bf16 v[84:87], a[144:147], a[100:103], v[84:87]
  ds_read_b64_tr_b16 a[170:171], v194 offset:4608
  v_max_f32 v23, 0, v23
  v_mul_f32 v55, v216, v55
  v_mfma_f32_16x16x32_bf16 v[88:91], a[148:151], a[96:99], v[88:91]
  ds_read_b64_tr_b16 a[172:173], v195 offset:4096
  v_mul_f32 v20, v20, v52
  v_mfma_f32_16x16x32_bf16 v[92:95], a[148:151], a[100:103], v[92:95]
  ds_read_b64_tr_b16 a[174:175], v195 offset:4608
  v_mul_f32 v21, v21, v53
  v_mul_f32 v22, v22, v54
  v_mfma_f32_16x16x32_bf16 v[96:99], a[152:155], a[96:99], v[96:99]
  ds_read_b64_tr_b16 a[144:145], v196 offset:4096
  v_mul_f32 v23, v23, v55
  v_mfma_f32_16x16x32_bf16 v[100:103], a[152:155], a[100:103], v[100:103]
  ds_read_b64_tr_b16 a[146:147], v196 offset:4608
  v_max_f32 v28, 0, v28
  s_waitcnt lgkmcnt(4)
  v_mfma_f32_16x16x32_bf16 v[104:107], a[156:159], a[96:99], v[104:107]
  ds_read_b64_tr_b16 a[148:149], v197 offset:4096
  buffer_load_dwordx4 v205, s[8:11], s44 offen offset:2048 lds
  v_mfma_f32_16x16x32_bf16 v[108:111], a[156:159], a[100:103], v[108:111]
  ds_read_b64_tr_b16 a[150:151], v197 offset:4608
  v_mul_f32 v60, v216, v60
  v_max_f32 v29, 0, v29
  v_mfma_f32_16x16x32_bf16 v[112:115], a[160:163], a[96:99], v[112:115]
  ds_read_b64_tr_b16 a[152:153], v194 offset:16384
  v_mul_f32 v61, v216, v61
  v_mfma_f32_16x16x32_bf16 v[116:119], a[160:163], a[100:103], v[116:119]
  ds_read_b64_tr_b16 a[154:155], v194 offset:16896
  v_max_f32 v30, 0, v30
  v_mul_f32 v62, v216, v62
  v_mfma_f32_16x16x32_bf16 v[120:123], a[164:167], a[96:99], v[120:123]
  ds_read_b64_tr_b16 a[156:157], v195 offset:16384
  v_max_f32 v31, 0, v31
  v_mfma_f32_16x16x32_bf16 v[124:127], a[164:167], a[100:103], v[124:127]
  ds_read_b64_tr_b16 a[158:159], v195 offset:16896
  v_mul_f32 v63, v216, v63
  v_mul_f32 v28, v28, v60
  v_mfma_f32_16x16x32_bf16 v[64:67], a[168:171], a[104:107], v[64:67]
  ds_read_b64_tr_b16 a[160:161], v196 offset:16384
  v_mul_f32 v29, v29, v61
  v_mul_f32 v30, v30, v62
  v_mfma_f32_16x16x32_bf16 v[68:71], a[168:171], a[108:111], v[68:71]
  ds_read_b64_tr_b16 a[162:163], v196 offset:16896
  s_waitcnt lgkmcnt(4)
  v_mfma_f32_16x16x32_bf16 v[72:75], a[172:175], a[104:107], v[72:75]
  ds_read_b64_tr_b16 a[164:165], v197 offset:16384
  buffer_load_dwordx4 v206, s[8:11], s44 offen offset:3072 lds
  s_add_u32 m0, s46, 4096
  v_mfma_f32_16x16x32_bf16 v[76:79], a[172:175], a[108:111], v[76:79]
  ds_read_b64_tr_b16 a[166:167], v197 offset:16896
  v_mul_f32 v31, v31, v63
  v_mfma_f32_16x16x32_bf16 v[80:83], a[144:147], a[104:107], v[80:83]
  ds_read_b64_tr_b16 a[168:169], v194 offset:8192
  v_cvt_pk_bf16_f32 v52, v20, v21
  v_cvt_pk_bf16_f32 v53, v22, v23
  v_mfma_f32_16x16x32_bf16 v[84:87], a[144:147], a[108:111], v[84:87]
  ds_read_b64_tr_b16 a[170:171], v194 offset:8704
  v_cvt_pk_bf16_f32 v54, v28, v29
  v_mfma_f32_16x16x32_bf16 v[88:91], a[148:151], a[104:107], v[88:91]
  ds_read_b64_tr_b16 a[172:173], v195 offset:8192
  v_cvt_pk_bf16_f32 v55, v30, v31
  v_accvgpr_write_b32 a204, v52
  v_mfma_f32_16x16x32_bf16 v[92:95], a[148:151], a[108:111], v[92:95]
  ds_read_b64_tr_b16 a[174:175], v195 offset:8704
  v_accvgpr_write_b32 a205, v53
  v_mfma_f32_16x16x32_bf16 v[96:99], a[152:155], a[104:107], v[96:99]
  ds_read_b64_tr_b16 a[144:145], v196 offset:8192
  v_accvgpr_write_b32 a206, v54
  v_accvgpr_write_b32 a207, v55
  v_mfma_f32_16x16x32_bf16 v[100:103], a[152:155], a[108:111], v[100:103]
  ds_read_b64_tr_b16 a[146:147], v196 offset:8704
  s_waitcnt lgkmcnt(4)
  v_mfma_f32_16x16x32_bf16 v[104:107], a[156:159], a[104:107], v[104:107]
  ds_read_b64_tr_b16 a[148:149], v197 offset:8192
  buffer_load_dwordx4 v207, s[8:11], s44 offen lds
  s_sub_u32 s49, s40, 2
  s_max_i32 s49, s49, 0
  s_mul_i32 s49, s49, 384
  s_add_u32 s49, s49, 159744
  v_mfma_f32_16x16x32_bf16 v[108:111], a[156:159], a[108:111], v[108:111]
  ds_read_b64_tr_b16 a[150:151], v197 offset:8704
  v_add_u32 v248, s49, v227
  ds_read_b64 v[230:231], v248
  v_mfma_f32_16x16x32_bf16 v[112:115], a[160:163], a[104:107], v[112:115]
  ds_read_b64_tr_b16 a[152:153], v194 offset:20480
  s_sub_u32 s49, s40, 1
  s_max_i32 s49, s49, 0
  s_mul_i32 s49, s49, 384
  s_add_u32 s49, s49, 159744
  v_mfma_f32_16x16x32_bf16 v[116:119], a[160:163], a[108:111], v[116:119]
  ds_read_b64_tr_b16 a[154:155], v194 offset:20992
  v_add_u32 v248, s49, v227
  ds_read_b64 v[232:233], v248
  v_mfma_f32_16x16x32_bf16 v[120:123], a[164:167], a[104:107], v[120:123]
  ds_read_b64_tr_b16 a[156:157], v195 offset:20480
  v_mul_f32 v228, s60, v228
  v_mfma_f32_16x16x32_bf16 v[124:127], a[164:167], a[108:111], v[124:127]
  ds_read_b64_tr_b16 a[158:159], v195 offset:20992
  s_add_u32 s63, s61, 4096
  buffer_store_dwordx4 v[52:55], v226, s[24:27], s63 offen offset:3072 sc1
  buffer_load_dwordx4 v208, s[8:11], s44 offen offset:1024 lds
  v_mfma_f32_16x16x32_bf16 v[64:67], a[168:171], a[112:115], v[64:67]
  ds_read_b64_tr_b16 a[160:161], v196 offset:20480
  v_mul_f32 v229, s60, v229
  v_mfma_f32_16x16x32_bf16 v[68:71], a[168:171], a[116:119], v[68:71]
  ds_read_b64_tr_b16 a[162:163], v196 offset:20992
  s_waitcnt lgkmcnt(5)
  v_mfma_f32_16x16x32_bf16 v[72:75], a[172:175], a[112:115], v[72:75]
  ds_read_b64_tr_b16 a[164:165], v197 offset:20480
  v_mfma_f32_16x16x32_bf16 v[76:79], a[172:175], a[116:119], v[76:79]
  ds_read_b64_tr_b16 a[166:167], v197 offset:20992
  v_mul_f32 v230, s59, v230
  s_barrier
  v_mfma_f32_16x16x32_bf16 v[80:83], a[144:147], a[112:115], v[80:83]
  ds_read_b64_tr_b16 a[168:169], v198
  v_mul_f32 v231, s59, v231
  v_mfma_f32_16x16x32_bf16 v[84:87], a[144:147], a[116:119], v[84:87]
  ds_read_b64_tr_b16 a[170:171], v198 offset:512
  s_waitcnt lgkmcnt(8)
  v_mul_f32 v232, s58, v232
  v_mul_f32 v233, s58, v233
  v_mfma_f32_16x16x32_bf16 v[88:91], a[148:151], a[112:115], v[88:91]
  ds_read_b64_tr_b16 a[172:173], v199
  v_fmac_f32 v230, v219, v228
  v_mfma_f32_16x16x32_bf16 v[92:95], a[148:151], a[116:119], v[92:95]
  ds_read_b64_tr_b16 a[174:175], v199 offset:512
  v_fmac_f32 v231, v219, v229
  v_fma_f32 v230, -v220, v229, v230
  v_mfma_f32_16x16x32_bf16 v[96:99], a[152:155], a[112:115], v[96:99]
  ds_read_b64_tr_b16 a[144:145], v200
  v_fmac_f32 v231, v220, v228
  v_mfma_f32_16x16x32_bf16 v[100:103], a[152:155], a[116:119], v[100:103]
  ds_read_b64_tr_b16 a[146:147], v200 offset:512
  v_fmac_f32 v232, v219, v230
  s_waitcnt lgkmcnt(4)
  v_mfma_f32_16x16x32_bf16 v[104:107], a[156:159], a[112:115], v[104:107]
  ds_read_b64_tr_b16 a[148:149], v201
  v_fmac_f32 v233, v219, v231
  v_mfma_f32_16x16x32_bf16 v[108:111], a[156:159], a[116:119], v[108:111]
  ds_read_b64_tr_b16 a[150:151], v201 offset:512
  v_fma_f32 v232, -v220, v231, v232
  v_fmac_f32 v233, v220, v230
  v_mfma_f32_16x16x32_bf16 v[112:115], a[160:163], a[112:115], v[112:115]
  ds_read_b64_tr_b16 a[152:153], v198 offset:12288
  s_add_u32 s44, s44, 884736
  s_add_u32 m0, s46, 24576
  v_mfma_f32_16x16x32_bf16 v[116:119], a[160:163], a[116:119], v[116:119]
  ds_read_b64_tr_b16 a[154:155], v198 offset:12800
  buffer_load_dwordx4 v203, s[8:11], s44 offen lds
  v_mfma_f32_16x16x32_bf16 v[120:123], a[164:167], a[112:115], v[120:123]
  ds_read_b64_tr_b16 a[156:157], v199 offset:12288
  v_fmac_f32 v232, v223, v250
  v_fmac_f32 v233, v223, v251
  v_mfma_f32_16x16x32_bf16 v[124:127], a[164:167], a[116:119], v[124:127]
  ds_read_b64_tr_b16 a[158:159], v199 offset:12800
  v_fma_f32 v232, -v224, v251, v232
  v_mfma_f32_16x16x32_bf16 v[64:67], a[168:171], a[120:123], v[64:67]
  ds_read_b64_tr_b16 a[160:161], v200 offset:12288
  v_fmac_f32 v233, v224, v250
  v_mov_b32 v250, v232
  v_mfma_f32_16x16x32_bf16 v[68:71], a[168:171], a[124:127], v[68:71]
  ds_read_b64_tr_b16 a[162:163], v200 offset:12800
  s_waitcnt lgkmcnt(4)
  v_mfma_f32_16x16x32_bf16 v[72:75], a[172:175], a[120:123], v[72:75]
  ds_read_b64_tr_b16 a[164:165], v201 offset:12288
  v_mov_b32 v251, v233
  ds_read_b64 v[228:229], v246 offset:0
  v_mfma_f32_16x16x32_bf16 v[76:79], a[172:175], a[124:127], v[76:79]
  ds_read_b64_tr_b16 a[166:167], v201 offset:12800
  ds_read_b64 v[230:231], v246 offset:384
  v_mfma_f32_16x16x32_bf16 v[80:83], a[144:147], a[120:123], v[80:83]
  ds_read_b64_tr_b16 a[168:169], v198 offset:4096
  buffer_load_dwordx4 v204, s[8:11], s44 offen offset:1024 lds
  ds_read_b64 v[232:233], v246 offset:768
  v_mfma_f32_16x16x32_bf16 v[84:87], a[144:147], a[124:127], v[84:87]
  ds_read_b64_tr_b16 a[170:171], v198 offset:4608
  ds_read_b64 v[234:235], v246 offset:1152
  v_mfma_f32_16x16x32_bf16 v[88:91], a[148:151], a[120:123], v[88:91]
  ds_read_b64_tr_b16 a[172:173], v199 offset:4096
  ds_read_b64 v[236:237], v246 offset:1536
  ds_read_b64 v[238:239], v246 offset:1920
  v_mfma_f32_16x16x32_bf16 v[92:95], a[148:151], a[124:127], v[92:95]
  s_waitcnt lgkmcnt(14)
  ds_read_b64_tr_b16 a[174:175], v199 offset:4608
  s_waitcnt lgkmcnt(14)
  ds_read_b64 v[240:241], v246 offset:2304
  v_mfma_f32_16x16x32_bf16 v[96:99], a[152:155], a[120:123], v[96:99]
  s_waitcnt lgkmcnt(14)
  ds_read_b64_tr_b16 a[144:145], v200 offset:4096
  s_waitcnt lgkmcnt(14)
  ds_write_b64 v246, v[250:251]
  v_mfma_f32_16x16x32_bf16 v[100:103], a[152:155], a[124:127], v[100:103]
  s_waitcnt lgkmcnt(14)
  ds_read_b64_tr_b16 a[146:147], v200 offset:4608
  s_waitcnt lgkmcnt(9)
  v_mfma_f32_16x16x32_bf16 v[104:107], a[156:159], a[120:123], v[104:107]
  ds_read_b64_tr_b16 a[148:149], v201 offset:4096
  v_fmac_f32 v228, v217, v250
  v_fmac_f32 v229, v217, v251
  v_mfma_f32_16x16x32_bf16 v[108:111], a[156:159], a[124:127], v[108:111]
  ds_read_b64_tr_b16 a[150:151], v201 offset:4608
  buffer_load_dwordx4 v205, s[8:11], s44 offen offset:2048 lds
  v_fma_f32 v228, -v218, v251, v228
  v_mfma_f32_16x16x32_bf16 v[112:115], a[160:163], a[120:123], v[112:115]
  ds_read_b64_tr_b16 a[152:153], v198 offset:16384
  v_fmac_f32 v229, v218, v250
  v_mfma_f32_16x16x32_bf16 v[116:119], a[160:163], a[124:127], v[116:119]
  ds_read_b64_tr_b16 a[154:155], v198 offset:16896
  ds_write_b64 v246, v[228:229] offset:384
  v_fmac_f32 v230, v217, v228
  v_mfma_f32_16x16x32_bf16 v[120:123], a[164:167], a[120:123], v[120:123]
  ds_read_b64_tr_b16 a[156:157], v199 offset:16384
  v_fmac_f32 v231, v217, v229
  v_mfma_f32_16x16x32_bf16 v[124:127], a[164:167], a[124:127], v[124:127]
  s_waitcnt lgkmcnt(14)
  ds_read_b64_tr_b16 a[158:159], v199 offset:16896
  v_fma_f32 v230, -v218, v229, v230
  v_fmac_f32 v231, v218, v228
  v_mfma_f32_16x16x32_bf16 v[64:67], a[168:171], a[128:131], v[64:67]
  s_waitcnt lgkmcnt(14)
  ds_read_b64_tr_b16 a[160:161], v200 offset:16384
  s_waitcnt lgkmcnt(14)
  ds_write_b64 v246, v[230:231] offset:768
  v_mfma_f32_16x16x32_bf16 v[68:71], a[168:171], a[132:135], v[68:71]
  s_waitcnt lgkmcnt(14)
  ds_read_b64_tr_b16 a[162:163], v200 offset:16896
  v_fmac_f32 v232, v217, v230
  s_waitcnt lgkmcnt(6)
  v_mfma_f32_16x16x32_bf16 v[72:75], a[172:175], a[128:131], v[72:75]
  ds_read_b64_tr_b16 a[164:165], v201 offset:16384
  buffer_load_dwordx4 v206, s[8:11], s44 offen offset:3072 lds
  v_mfma_f32_16x16x32_bf16 v[76:79], a[172:175], a[132:135], v[76:79]
  ds_read_b64_tr_b16 a[166:167], v201 offset:16896
  s_add_u32 m0, s46, 28672
  v_fmac_f32 v233, v217, v231
  v_mfma_f32_16x16x32_bf16 v[80:83], a[144:147], a[128:131], v[80:83]
  ds_read_b64_tr_b16 a[168:169], v198 offset:8192
  v_fma_f32 v232, -v218, v231, v232
  v_mfma_f32_16x16x32_bf16 v[84:87], a[144:147], a[132:135], v[84:87]
  ds_read_b64_tr_b16 a[170:171], v198 offset:8704
  v_fmac_f32 v233, v218, v230
  ds_write_b64 v246, v[232:233] offset:1152
  v_mfma_f32_16x16x32_bf16 v[88:91], a[148:151], a[128:131], v[88:91]
  ds_read_b64_tr_b16 a[172:173], v199 offset:8192
  v_fmac_f32 v234, v217, v232
  v_mfma_f32_16x16x32_bf16 v[92:95], a[148:151], a[132:135], v[92:95]
  ds_read_b64_tr_b16 a[174:175], v199 offset:8704
  v_fmac_f32 v235, v217, v233
  v_fma_f32 v234, -v218, v233, v234
  v_mfma_f32_16x16x32_bf16 v[96:99], a[152:155], a[128:131], v[96:99]
  ds_read_b64_tr_b16 a[144:145], v200 offset:8192
  v_fmac_f32 v235, v218, v232
  v_mfma_f32_16x16x32_bf16 v[100:103], a[152:155], a[132:135], v[100:103]
  ds_read_b64_tr_b16 a[146:147], v200 offset:8704
  buffer_load_dwordx4 v207, s[8:11], s44 offen lds
  s_waitcnt lgkmcnt(5)
  v_mfma_f32_16x16x32_bf16 v[104:107], a[156:159], a[128:131], v[104:107]
  ds_read_b64_tr_b16 a[148:149], v201 offset:8192
  ds_write_b64 v246, v[234:235] offset:1536
  v_fmac_f32 v236, v217, v234
  v_mfma_f32_16x16x32_bf16 v[108:111], a[156:159], a[132:135], v[108:111]
  ds_read_b64_tr_b16 a[150:151], v201 offset:8704
  v_fmac_f32 v237, v217, v235
  v_mfma_f32_16x16x32_bf16 v[112:115], a[160:163], a[128:131], v[112:115]
  ds_read_b64_tr_b16 a[152:153], v198 offset:20480
  v_fma_f32 v236, -v218, v235, v236
  v_fmac_f32 v237, v218, v234
  v_mfma_f32_16x16x32_bf16 v[116:119], a[160:163], a[132:135], v[116:119]
  ds_read_b64_tr_b16 a[154:155], v198 offset:20992
  ds_write_b64 v246, v[236:237] offset:1920
  v_mfma_f32_16x16x32_bf16 v[120:123], a[164:167], a[128:131], v[120:123]
  ds_read_b64_tr_b16 a[156:157], v199 offset:20480
  v_fmac_f32 v238, v217, v236
  v_fmac_f32 v239, v217, v237
  v_mfma_f32_16x16x32_bf16 v[124:127], a[164:167], a[132:135], v[124:127]
  ds_read_b64_tr_b16 a[158:159], v199 offset:20992
  v_fma_f32 v238, -v218, v237, v238
  buffer_load_dwordx4 v208, s[8:11], s44 offen offset:1024 lds
  v_mfma_f32_16x16x32_bf16 v[64:67], a[168:171], a[136:139], v[64:67]
  ds_read_b64_tr_b16 a[160:161], v200 offset:20480
  v_fmac_f32 v239, v218, v236
  ds_write_b64 v246, v[238:239] offset:2304
  v_mfma_f32_16x16x32_bf16 v[68:71], a[168:171], a[140:143], v[68:71]
  s_waitcnt lgkmcnt(14)
  ds_read_b64_tr_b16 a[162:163], v200 offset:20992
  s_waitcnt lgkmcnt(6)
  v_mfma_f32_16x16x32_bf16 v[72:75], a[172:175], a[136:139], v[72:75]
  ds_read_b64_tr_b16 a[164:165], v201 offset:20480
  v_fmac_f32 v240, v217, v238
  s_waitcnt vmcnt(21)
  v_mfma_f32_16x16x32_bf16 v[76:79], a[172:175], a[140:143], v[76:79]
  ds_read_b64_tr_b16 a[166:167], v201 offset:20992
  s_barrier
  v_mfma_f32_16x16x32_bf16 v[80:83], a[144:147], a[136:139], v[80:83]
  ds_read_b64_tr_b16 a[168:169], v198 offset:24576
  s_add_u32 s44, s44, 884736
  s_add_u32 m0, s46, 49152
  v_mfma_f32_16x16x32_bf16 v[84:87], a[144:147], a[140:143], v[84:87]
  ds_read_b64_tr_b16 a[170:171], v198 offset:25088
  v_fmac_f32 v241, v217, v239
  v_mfma_f32_16x16x32_bf16 v[88:91], a[148:151], a[136:139], v[88:91]
  ds_read_b64_tr_b16 a[172:173], v199 offset:24576
  v_fma_f32 v240, -v218, v239, v240
  v_fmac_f32 v241, v218, v238
  v_mfma_f32_16x16x32_bf16 v[92:95], a[148:151], a[140:143], v[92:95]
  ds_read_b64_tr_b16 a[174:175], v199 offset:25088
  buffer_load_dwordx4 v203, s[8:11], s44 offen lds
  v_mfma_f32_16x16x32_bf16 v[96:99], a[152:155], a[136:139], v[96:99]
  ds_read_b64_tr_b16 a[144:145], v200 offset:24576
  ds_write_b64 v246, v[240:241] offset:2688
  v_and_b32 v248, 15, v225
  v_mfma_f32_16x16x32_bf16 v[100:103], a[152:155], a[140:143], v[100:103]
  ds_read_b64_tr_b16 a[146:147], v200 offset:25088
  s_waitcnt lgkmcnt(5)
  v_mfma_f32_16x16x32_bf16 v[104:107], a[156:159], a[136:139], v[104:107]
  ds_read_b64_tr_b16 a[148:149], v201 offset:24576
  v_lshlrev_b32 v248, 5, v248
  v_lshrrev_b32 v249, 4, v225
  v_mfma_f32_16x16x32_bf16 v[108:111], a[156:159], a[140:143], v[108:111]
  ds_read_b64_tr_b16 a[150:151], v201 offset:25088
  v_lshlrev_b32 v249, 3, v249
  v_mfma_f32_16x16x32_bf16 v[112:115], a[160:163], a[136:139], v[112:115]
  ds_read_b64_tr_b16 a[152:153], v198 offset:36864
  v_add_u32 v248, v248, v249
  v_mfma_f32_16x16x32_bf16 v[116:119], a[160:163], a[140:143], v[116:119]
  ds_read_b64_tr_b16 a[154:155], v198 offset:37376
  v_add_u32 v248, s47, v248
  v_mfma_f32_16x16x32_bf16 v[120:123], a[164:167], a[136:139], v[120:123]
  ds_read_b64_tr_b16 a[156:157], v199 offset:36864
  buffer_load_dwordx4 v204, s[8:11], s44 offen offset:1024 lds
  v_mfma_f32_16x16x32_bf16 v[124:127], a[164:167], a[140:143], v[124:127]
  ds_read_b64_tr_b16 a[158:159], v199 offset:37376
  v_add_u32 v248, 147456, v248
  v_lshlrev_b32 v249, 3, v225
  v_mfma_f32_16x16x32_bf16 v[0:3], a[168:171], a[0:3], 0
  ds_read_b64_tr_b16 a[160:161], v200 offset:36864
  v_add_u32 v249, s47, v249
  v_mfma_f32_16x16x32_bf16 v[4:7], a[168:171], a[4:7], 0
  ds_read_b64_tr_b16 a[162:163], v200 offset:37376
  v_add_u32 v249, 147456, v249
  s_waitcnt lgkmcnt(4)
  v_mfma_f32_16x16x32_bf16 v[8:11], a[172:175], a[0:3], 0
  ds_read_b64_tr_b16 a[164:165], v201 offset:36864
  ds_read_b64 v[228:229], v244 offset:0
  v_mfma_f32_16x16x32_bf16 v[12:15], a[172:175], a[4:7], 0
  ds_read_b64_tr_b16 a[166:167], v201 offset:37376
  ds_read_b64 v[230:231], v244 offset:128
  ds_read_b64 v[232:233], v244 offset:256
  v_mfma_f32_16x16x32_bf16 v[16:19], a[144:147], a[0:3], 0
  ds_read_b64_tr_b16 a[168:169], v198 offset:28672
  ds_read_b128 v[234:237], v247 offset:0
  v_mfma_f32_16x16x32_bf16 v[20:23], a[144:147], a[4:7], 0
  ds_read_b64_tr_b16 a[170:171], v198 offset:29184
  buffer_load_dwordx4 v205, s[8:11], s44 offen offset:2048 lds
  ds_read_b128 v[238:241], v247 offset:16
  v_mfma_f32_16x16x32_bf16 v[24:27], a[148:151], a[0:3], 0
  ds_read_b64_tr_b16 a[172:173], v199 offset:28672
  ds_read_b64 v[242:243], v247 offset:32
  v_mfma_f32_16x16x32_bf16 v[28:31], a[148:151], a[4:7], 0
  s_waitcnt lgkmcnt(14)
  ds_read_b64_tr_b16 a[174:175], v199 offset:29184
  v_max_f32 v64, 0, v64
  v_mul_f32 v96, v215, v96
  v_mfma_f32_16x16x32_bf16 v[32:35], a[152:155], a[0:3], 0
  s_waitcnt lgkmcnt(14)
  ds_read_b64_tr_b16 a[144:145], v200 offset:28672
  v_max_f32 v65, 0, v65
  v_mfma_f32_16x16x32_bf16 v[36:39], a[152:155], a[4:7], 0
  s_waitcnt lgkmcnt(14)
  ds_read_b64_tr_b16 a[146:147], v200 offset:29184
  v_mul_f32 v97, v215, v97
  s_waitcnt lgkmcnt(6)
  v_mfma_f32_16x16x32_bf16 v[40:43], a[156:159], a[0:3], 0
  ds_read_b64_tr_b16 a[148:149], v201 offset:28672
  v_max_f32 v66, 0, v66
  v_mul_f32 v98, v215, v98
  v_mfma_f32_16x16x32_bf16 v[44:47], a[156:159], a[4:7], 0
  ds_read_b64_tr_b16 a[150:151], v201 offset:29184
  v_max_f32 v67, 0, v67
  v_mfma_f32_16x16x32_bf16 v[48:51], a[160:163], a[0:3], 0
  ds_read_b64_tr_b16 a[152:153], v198 offset:40960
  buffer_load_dwordx4 v206, s[8:11], s44 offen offset:3072 lds
  s_add_u32 m0, s46, 53248
  v_mfma_f32_16x16x32_bf16 v[52:55], a[160:163], a[4:7], 0
  ds_read_b64_tr_b16 a[154:155], v198 offset:41472
  v_fmac_f32 v128, v234, v228
  v_mfma_f32_16x16x32_bf16 v[56:59], a[164:167], a[0:3], 0
  ds_read_b64_tr_b16 a[156:157], v199 offset:40960
  v_fmac_f32 v136, v234, v229
  v_fma_f32 v128, -v235, v229, v128
  v_mfma_f32_16x16x32_bf16 v[60:63], a[164:167], a[4:7], 0
  ds_read_b64_tr_b16 a[158:159], v199 offset:41472
  v_fmac_f32 v136, v235, v228
  v_mfma_f32_16x16x32_bf16 v[0:3], a[168:171], a[8:11], v[0:3]
  ds_read_b64_tr_b16 a[160:161], v200 offset:40960
  v_fmac_f32 v129, v236, v228
  v_fmac_f32 v137, v236, v229
  v_mfma_f32_16x16x32_bf16 v[4:7], a[168:171], a[12:15], v[4:7]
  ds_read_b64_tr_b16 a[162:163], v200 offset:41472
  s_waitcnt lgkmcnt(4)
  v_mfma_f32_16x16x32_bf16 v[8:11], a[172:175], a[8:11], v[8:11]
  ds_read_b64_tr_b16 a[164:165], v201 offset:40960
  v_fma_f32 v129, -v237, v229, v129
  v_fmac_f32 v137, v237, v228
  v_mfma_f32_16x16x32_bf16 v[12:15], a[172:175], a[12:15], v[12:15]
  ds_read_b64_tr_b16 a[166:167], v201 offset:41472
  buffer_load_dwordx4 v207, s[8:11], s44 offen lds
  v_mfma_f32_16x16x32_bf16 v[16:19], a[144:147], a[8:11], v[16:19]
  ds_read_b64_tr_b16 a[168:169], v198 offset:32768
  v_fmac_f32 v130, v238, v228
  v_fmac_f32 v138, v238, v229
  v_mfma_f32_16x16x32_bf16 v[20:23], a[144:147], a[12:15], v[20:23]
  ds_read_b64_tr_b16 a[170:171], v198 offset:33280
  v_fma_f32 v130, -v239, v229, v130
  v_mfma_f32_16x16x32_bf16 v[24:27], a[148:151], a[8:11], v[24:27]
  ds_read_b64_tr_b16 a[172:173], v199 offset:32768
  v_fmac_f32 v138, v239, v228
  v_fmac_f32 v131, v240, v228
  v_mfma_f32_16x16x32_bf16 v[28:31], a[148:151], a[12:15], v[28:31]
  ds_read_b64_tr_b16 a[174:175], v199 offset:33280
  v_fmac_f32 v139, v240, v229
  v_fma_f32 v131, -v241, v229, v131
  v_mfma_f32_16x16x32_bf16 v[32:35], a[152:155], a[8:11], v[32:35]
  ds_read_b64_tr_b16 a[144:145], v200 offset:32768
  v_fmac_f32 v139, v241, v228
  v_mfma_f32_16x16x32_bf16 v[36:39], a[152:155], a[12:15], v[36:39]
  ds_read_b64_tr_b16 a[146:147], v200 offset:33280
  v_mul_f32 v250, v242, v128
  s_waitcnt lgkmcnt(4)
  v_mfma_f32_16x16x32_bf16 v[40:43], a[156:159], a[8:11], v[40:43]
  ds_read_b64_tr_b16 a[148:149], v201 offset:32768
  buffer_load_dwordx4 v208, s[8:11], s44 offen offset:1024 lds
  v_mfma_f32_16x16x32_bf16 v[44:47], a[156:159], a[12:15], v[44:47]
  ds_read_b64_tr_b16 a[150:151], v201 offset:33280
  v_fma_f32 v250, -v243, v136, v250
  v_mul_f32 v136, v242, v136
  v_mfma_f32_16x16x32_bf16 v[48:51], a[160:163], a[8:11], v[48:51]
  ds_read_b64_tr_b16 a[152:153], v198 offset:45056
  v_fmac_f32 v136, v243, v128
  v_mfma_f32_16x16x32_bf16 v[52:55], a[160:163], a[12:15], v[52:55]
  ds_read_b64_tr_b16 a[154:155], v198 offset:45568
  v_mul_f32 v128, v176, v250
  v_mul_f32_e64 v136, -v176, v136
  v_mfma_f32_16x16x32_bf16 v[56:59], a[164:167], a[8:11], v[56:59]
  ds_read_b64_tr_b16 a[156:157], v199 offset:45056
  v_mul_f32 v251, v242, v129
  v_mfma_f32_16x16x32_bf16 v[60:63], a[164:167], a[12:15], v[60:63]
  ds_read_b64_tr_b16 a[158:159], v199 offset:45568
  v_fma_f32 v251, -v243, v137, v251
  v_mul_f32 v137, v242, v137
  v_mfma_f32_16x16x32_bf16 v[0:3], a[168:171], a[16:19], v[0:3]
  ds_read_b64_tr_b16 a[160:161], v200 offset:45056
  v_fmac_f32 v137, v243, v129
  v_mfma_f32_16x16x32_bf16 v[4:7], a[168:171], a[20:23], v[4:7]
  ds_read_b64_tr_b16 a[162:163], v200 offset:45568
  v_mul_f32 v129, v177, v251
  s_waitcnt lgkmcnt(4)
  v_mfma_f32_16x16x32_bf16 v[8:11], a[172:175], a[16:19], v[8:11]
  ds_read_b64_tr_b16 a[164:165], v201 offset:45056
  s_waitcnt vmcnt(19)
  v_mfma_f32_16x16x32_bf16 v[12:15], a[172:175], a[20:23], v[12:15]
  ds_read_b64_tr_b16 a[166:167], v201 offset:45568
  v_mul_f32_e64 v137, -v177, v137
  s_barrier
  v_mfma_f32_16x16x32_bf16 v[16:19], a[144:147], a[16:19], v[16:19]
  ds_read_b64_tr_b16 a[168:169], v194 offset:24576
  s_add_u32 s44, s44, 884736
  v_mfma_f32_16x16x32_bf16 v[20:23], a[144:147], a[20:23], v[20:23]
  ds_read_b64_tr_b16 a[170:171], v194 offset:25088
  s_add_u32 m0, s46, 98304
  s_nop 0
  buffer_load_dwordx4 v203, s[8:11], s44 offen lds
  v_mfma_f32_16x16x32_bf16 v[24:27], a[148:151], a[16:19], v[24:27]
  ds_read_b64_tr_b16 a[172:173], v195 offset:24576
  v_mul_f32 v250, v242, v130
  v_mul_f32 v99, v215, v99
  v_mfma_f32_16x16x32_bf16 v[28:31], a[148:151], a[20:23], v[28:31]
  ds_read_b64_tr_b16 a[174:175], v195 offset:25088
  v_fma_f32 v250, -v243, v138, v250
  v_mfma_f32_16x16x32_bf16 v[32:35], a[152:155], a[16:19], v[32:35]
  ds_read_b64_tr_b16 a[144:145], v196 offset:24576
  v_mul_f32 v138, v242, v138
  v_mul_f32 v64, v64, v96
  v_mfma_f32_16x16x32_bf16 v[36:39], a[152:155], a[20:23], v[36:39]
  ds_read_b64_tr_b16 a[146:147], v196 offset:25088
  s_waitcnt lgkmcnt(4)
  v_mfma_f32_16x16x32_bf16 v[40:43], a[156:159], a[16:19], v[40:43]
  ds_read_b64_tr_b16 a[148:149], v197 offset:24576
  v_fmac_f32 v138, v243, v130
  v_mul_f32 v130, v178, v250
  v_mfma_f32_16x16x32_bf16 v[44:47], a[156:159], a[20:23], v[44:47]
  ds_read_b64_tr_b16 a[150:151], v197 offset:25088
  v_mul_f32_e64 v138, -v178, v138
  v_mfma_f32_16x16x32_bf16 v[48:51], a[160:163], a[16:19], v[48:51]
  ds_read_b64_tr_b16 a[152:153], v194 offset:36864
  buffer_load_dwordx4 v204, s[8:11], s44 offen offset:1024 lds
  v_mul_f32 v251, v242, v131
  v_mfma_f32_16x16x32_bf16 v[52:55], a[160:163], a[20:23], v[52:55]
  ds_read_b64_tr_b16 a[154:155], v194 offset:37376
  v_fma_f32 v251, -v243, v139, v251
  v_mfma_f32_16x16x32_bf16 v[56:59], a[164:167], a[16:19], v[56:59]
  ds_read_b64_tr_b16 a[156:157], v195 offset:36864
  v_mul_f32 v139, v242, v139
  v_mul_f32 v65, v65, v97
  v_mfma_f32_16x16x32_bf16 v[60:63], a[164:167], a[20:23], v[60:63]
  ds_read_b64_tr_b16 a[158:159], v195 offset:37376
  v_fmac_f32 v139, v243, v131
  v_mfma_f32_16x16x32_bf16 v[0:3], a[168:171], a[24:27], v[0:3]
  ds_read_b64_tr_b16 a[160:161], v196 offset:36864
  v_mul_f32 v131, v179, v251
  v_mul_f32_e64 v139, -v179, v139
  v_mfma_f32_16x16x32_bf16 v[4:7], a[168:171], a[28:31], v[4:7]
  ds_read_b64_tr_b16 a[162:163], v196 offset:37376
  s_waitcnt lgkmcnt(4)
  v_mfma_f32_16x16x32_bf16 v[8:11], a[172:175], a[24:27], v[8:11]
  ds_read_b64_tr_b16 a[164:165], v197 offset:36864
  v_cvt_pk_bf16_f32 v128, v128, v129
  v_cvt_pk_bf16_f32 v129, v130, v131
  v_mfma_f32_16x16x32_bf16 v[12:15], a[172:175], a[28:31], v[12:15]
  ds_read_b64_tr_b16 a[166:167], v197 offset:37376
  buffer_load_dwordx4 v205, s[8:11], s44 offen offset:2048 lds
  v_mfma_f32_16x16x32_bf16 v[16:19], a[144:147], a[24:27], v[16:19]
  ds_read_b64_tr_b16 a[168:169], v194 offset:28672
  v_cvt_pk_bf16_f32 v136, v136, v137
  v_cvt_pk_bf16_f32 v137, v138, v139
  v_mfma_f32_16x16x32_bf16 v[20:23], a[144:147], a[28:31], v[20:23]
  ds_read_b64_tr_b16 a[170:171], v194 offset:29184
  ds_write_b64 v248, v[128:129] offset:0
  ds_write_b64 v248, v[136:137] offset:512
  v_mfma_f32_16x16x32_bf16 v[24:27], a[148:151], a[24:27], v[24:27]
  ds_read_b64_tr_b16 a[172:173], v195 offset:28672
  ds_read_b64_tr_b16 v[128:129], v249 offset:0
  v_mfma_f32_16x16x32_bf16 v[28:31], a[148:151], a[28:31], v[28:31]
  ds_read_b64_tr_b16 a[174:175], v195 offset:29184
  ds_read_b64_tr_b16 v[130:131], v249 offset:512
  ds_read_b128 v[234:237], v247 offset:768
  v_mfma_f32_16x16x32_bf16 v[32:35], a[152:155], a[24:27], v[32:35]
  s_waitcnt lgkmcnt(14)
  ds_read_b64_tr_b16 a[144:145], v196 offset:28672
  s_waitcnt lgkmcnt(14)
  ds_read_b128 v[238:241], v247 offset:784
  v_mfma_f32_16x16x32_bf16 v[36:39], a[152:155], a[28:31], v[36:39]
  s_waitcnt lgkmcnt(14)
  ds_read_b64_tr_b16 a[146:147], v196 offset:29184
  s_waitcnt lgkmcnt(14)
  ds_read_b64 v[242:243], v247 offset:800
  s_waitcnt lgkmcnt(11)
  v_mfma_f32_16x16x32_bf16 v[40:43], a[156:159], a[24:27], v[40:43]
  ds_read_b64_tr_b16 a[148:149], v197 offset:28672
  buffer_load_dwordx4 v206, s[8:11], s44 offen offset:3072 lds
  v_mfma_f32_16x16x32_bf16 v[44:47], a[156:159], a[28:31], v[44:47]
  ds_read_b64_tr_b16 a[150:151], v197 offset:29184
  s_add_u32 m0, s46, 102400
  v_mul_f32 v66, v66, v98
  v_mfma_f32_16x16x32_bf16 v[48:51], a[160:163], a[24:27], v[48:51]
  ds_read_b64_tr_b16 a[152:153], v194 offset:40960
  v_mul_f32 v67, v67, v99
  v_mfma_f32_16x16x32_bf16 v[52:55], a[160:163], a[28:31], v[52:55]
  ds_read_b64_tr_b16 a[154:155], v194 offset:41472
  v_max_f32 v72, 0, v72
  v_mul_f32 v104, v215, v104
  v_mfma_f32_16x16x32_bf16 v[56:59], a[164:167], a[24:27], v[56:59]
  s_waitcnt lgkmcnt(14)
  ds_read_b64_tr_b16 a[156:157], v195 offset:40960
  v_max_f32 v73, 0, v73
  v_mfma_f32_16x16x32_bf16 v[60:63], a[164:167], a[28:31], v[60:63]
  s_waitcnt lgkmcnt(14)
  ds_read_b64_tr_b16 a[158:159], v195 offset:41472
  s_waitcnt lgkmcnt(10)
  v_fmac_f32 v144, v234, v230
  v_fmac_f32 v152, v234, v231
  v_mfma_f32_16x16x32_bf16 v[0:3], a[168:171], a[32:35], v[0:3]
  ds_read_b64_tr_b16 a[160:161], v196 offset:40960
  v_fma_f32 v144, -v235, v231, v144
  v_mfma_f32_16x16x32_bf16 v[4:7], a[168:171], a[36:39], v[4:7]
  ds_read_b64_tr_b16 a[162:163], v196 offset:41472
  buffer_load_dwordx4 v207, s[8:11], s44 offen lds
  s_waitcnt lgkmcnt(4)
  v_mfma_f32_16x16x32_bf16 v[8:11], a[172:175], a[32:35], v[8:11]
  ds_read_b64_tr_b16 a[164:165], v197 offset:40960
  v_fmac_f32 v152, v235, v230
  v_fmac_f32 v145, v236, v230
  v_mfma_f32_16x16x32_bf16 v[12:15], a[172:175], a[36:39], v[12:15]
  ds_read_b64_tr_b16 a[166:167], v197 offset:41472
  v_fmac_f32 v153, v236, v231
  v_mfma_f32_16x16x32_bf16 v[16:19], a[144:147], a[32:35], v[16:19]
  ds_read_b64_tr_b16 a[168:169], v194 offset:32768
  v_fma_f32 v145, -v237, v231, v145
  v_fmac_f32 v153, v237, v230
  v_mfma_f32_16x16x32_bf16 v[20:23], a[144:147], a[36:39], v[20:23]
  ds_read_b64_tr_b16 a[170:171], v194 offset:33280
  v_fmac_f32 v146, v238, v230
  v_mfma_f32_16x16x32_bf16 v[24:27], a[148:151], a[32:35], v[24:27]
  ds_read_b64_tr_b16 a[172:173], v195 offset:32768
  v_fmac_f32 v154, v238, v231
  v_fma_f32 v146, -v239, v231, v146
  v_mfma_f32_16x16x32_bf16 v[28:31], a[148:151], a[36:39], v[28:31]
  ds_read_b64_tr_b16 a[174:175], v195 offset:33280
  v_fmac_f32 v154, v239, v230
  v_mfma_f32_16x16x32_bf16 v[32:35], a[152:155], a[32:35], v[32:35]
  ds_read_b64_tr_b16 a[144:145], v196 offset:32768
  buffer_load_dwordx4 v208, s[8:11], s44 offen offset:1024 lds
  v_fmac_f32 v147, v240, v230
  v_mfma_f32_16x16x32_bf16 v[36:39], a[152:155], a[36:39], v[36:39]
  ds_read_b64_tr_b16 a[146:147], v196 offset:33280
  s_waitcnt lgkmcnt(4)
  v_mfma_f32_16x16x32_bf16 v[40:43], a[156:159], a[32:35], v[40:43]
  ds_read_b64_tr_b16 a[148:149], v197 offset:32768
  v_fmac_f32 v155, v240, v231
  v_fma_f32 v147, -v241, v231, v147
  v_mfma_f32_16x16x32_bf16 v[44:47], a[156:159], a[36:39], v[44:47]
  ds_read_b64_tr_b16 a[150:151], v197 offset:33280
  v_fmac_f32 v155, v241, v230
  v_mfma_f32_16x16x32_bf16 v[48:51], a[160:163], a[32:35], v[48:51]
  ds_read_b64_tr_b16 a[152:153], v194 offset:45056
  v_mul_f32 v250, v242, v144
  v_mul_f32 v105, v215, v105
  v_mfma_f32_16x16x32_bf16 v[52:55], a[160:163], a[36:39], v[52:55]
  ds_read_b64_tr_b16 a[154:155], v194 offset:45568
  v_fma_f32 v250, -v243, v152, v250
  v_mfma_f32_16x16x32_bf16 v[56:59], a[164:167], a[32:35], v[56:59]
  ds_read_b64_tr_b16 a[156:157], v195 offset:45056
  v_mul_f32 v152, v242, v152
  v_max_f32 v74, 0, v74
  v_mfma_f32_16x16x32_bf16 v[60:63], a[164:167], a[36:39], v[60:63]
  ds_read_b64_tr_b16 a[158:159], v195 offset:45568
  v_fmac_f32 v152, v243, v144
  v_mfma_f32_16x16x32_bf16 v[0:3], a[168:171], a[40:43], v[0:3]
  ds_read_b64_tr_b16 a[160:161], v196 offset:45056
  v_mul_f32 v144, v176, v250
  v_mul_f32_e64 v152, -v176, v152
  v_mfma_f32_16x16x32_bf16 v[4:7], a[168:171], a[44:47], v[4:7]
  ds_read_b64_tr_b16 a[162:163], v196 offset:45568
  v_mul_f32 v251, v242, v145
  s_waitcnt lgkmcnt(4)
  v_mfma_f32_16x16x32_bf16 v[8:11], a[172:175], a[40:43], v[8:11]
  ds_read_b64_tr_b16 a[164:165], v197 offset:45056
  s_waitcnt vmcnt(18)
  v_mfma_f32_16x16x32_bf16 v[12:15], a[172:175], a[44:47], v[12:15]
  ds_read_b64_tr_b16 a[166:167], v197 offset:45568
  v_fma_f32 v251, -v243, v153, v251
  s_barrier
  v_mfma_f32_16x16x32_bf16 v[16:19], a[144:147], a[40:43], v[16:19]
  ds_read_b64_tr_b16 a[168:169], v190
  v_mov_b32 v189, 2
  v_mfma_f32_16x16x32_bf16 v[20:23], a[144:147], a[44:47], v[20:23]
  ds_read_b64_tr_b16 a[170:171], v190 offset:512
  buffer_store_dword v189, v187, s[24:27], 0 offen sc1
  s_add_u32 s44, s66, 332416
  v_mfma_f32_16x16x32_bf16 v[24:27], a[148:151], a[40:43], v[24:27]
  ds_read_b64_tr_b16 a[172:173], v191
  s_add_u32 m0, s46, 122880
  v_mfma_f32_16x16x32_bf16 v[28:31], a[148:151], a[44:47], v[28:31]
  ds_read_b64_tr_b16 a[174:175], v191 offset:512
  v_mul_f32 v153, v242, v153
  v_mul_f32 v106, v215, v106
  v_mfma_f32_16x16x32_bf16 v[32:35], a[152:155], a[40:43], v[32:35]
  ds_read_b64_tr_b16 a[144:145], v192
  v_fmac_f32 v153, v243, v145
  v_mfma_f32_16x16x32_bf16 v[36:39], a[152:155], a[44:47], v[36:39]
  ds_read_b64_tr_b16 a[146:147], v192 offset:512
  v_mul_f32 v145, v177, v251
  s_waitcnt lgkmcnt(4)
  v_mfma_f32_16x16x32_bf16 v[40:43], a[156:159], a[40:43], v[40:43]
  ds_read_b64_tr_b16 a[148:149], v193
  buffer_load_dwordx4 v209, s[12:15], s44 offen lds
  v_mfma_f32_16x16x32_bf16 v[44:47], a[156:159], a[44:47], v[44:47]
  ds_read_b64_tr_b16 a[150:151], v193 offset:512
  v_mul_f32_e64 v153, -v177, v153
  v_mul_f32 v250, v242, v146
  v_mfma_f32_16x16x32_bf16 v[48:51], a[160:163], a[40:43], v[48:51]
  ds_read_b64_tr_b16 a[152:153], v190 offset:12288
  v_fma_f32 v250, -v243, v154, v250
  v_mfma_f32_16x16x32_bf16 v[52:55], a[160:163], a[44:47], v[52:55]
  ds_read_b64_tr_b16 a[154:155], v190 offset:12800
  v_mul_f32 v154, v242, v154
  v_max_f32 v75, 0, v75
  v_mfma_f32_16x16x32_bf16 v[56:59], a[164:167], a[40:43], v[56:59]
  ds_read_b64_tr_b16 a[156:157], v191 offset:12288
  v_fmac_f32 v154, v243, v146
  v_mfma_f32_16x16x32_bf16 v[60:63], a[164:167], a[44:47], v[60:63]
  ds_read_b64_tr_b16 a[158:159], v191 offset:12800
  v_mul_f32 v146, v178, v250
  v_mul_f32_e64 v154, -v178, v154
  v_mfma_f32_16x16x32_bf16 v[0:3], a[168:171], a[48:51], v[0:3]
  ds_read_b64_tr_b16 a[160:161], v192 offset:12288
  v_mul_f32 v251, v242, v147
  v_mul_f32 v107, v215, v107
  v_mfma_f32_16x16x32_bf16 v[4:7], a[168:171], a[52:55], v[4:7]
  ds_read_b64_tr_b16 a[162:163], v192 offset:12800
  s_waitcnt lgkmcnt(4)
  v_mfma_f32_16x16x32_bf16 v[8:11], a[172:175], a[48:51], v[8:11]
  ds_read_b64_tr_b16 a[164:165], v193 offset:12288
  buffer_load_dwordx4 v210, s[12:15], s44 offen offset:1024 lds
  v_fma_f32 v251, -v243, v155, v251
  v_mfma_f32_16x16x32_bf16 v[12:15], a[172:175], a[52:55], v[12:15]
  ds_read_b64_tr_b16 a[166:167], v193 offset:12800
  v_mul_f32 v155, v242, v155
  v_mfma_f32_16x16x32_bf16 v[16:19], a[144:147], a[48:51], v[16:19]
  ds_read_b64_tr_b16 a[168:169], v190 offset:4096
  v_fmac_f32 v155, v243, v147
  v_mul_f32 v147, v179, v251
  v_mfma_f32_16x16x32_bf16 v[20:23], a[144:147], a[52:55], v[20:23]
  ds_read_b64_tr_b16 a[170:171], v190 offset:4608
  v_mul_f32_e64 v155, -v179, v155
  v_mfma_f32_16x16x32_bf16 v[24:27], a[148:151], a[48:51], v[24:27]
  ds_read_b64_tr_b16 a[172:173], v191 offset:4096
  v_cvt_pk_bf16_f32 v144, v144, v145
  v_cvt_pk_bf16_f32 v145, v146, v147
  v_mfma_f32_16x16x32_bf16 v[28:31], a[148:151], a[52:55], v[28:31]
  ds_read_b64_tr_b16 a[174:175], v191 offset:4608
  v_cvt_pk_bf16_f32 v152, v152, v153
  v_mfma_f32_16x16x32_bf16 v[32:35], a[152:155], a[48:51], v[32:35]
  ds_read_b64_tr_b16 a[144:145], v192 offset:4096
  v_cvt_pk_bf16_f32 v153, v154, v155
  ds_write_b64 v248, v[144:145] offset:0
  v_mfma_f32_16x16x32_bf16 v[36:39], a[152:155], a[52:55], v[36:39]
  ds_read_b64_tr_b16 a[146:147], v192 offset:4608
  s_waitcnt lgkmcnt(5)
  v_mfma_f32_16x16x32_bf16 v[40:43], a[156:159], a[48:51], v[40:43]
  ds_read_b64_tr_b16 a[148:149], v193 offset:4096
  buffer_load_dwordx4 v211, s[12:15], s44 offen offset:2048 lds
  ds_write_b64 v248, v[152:153] offset:512
  v_mfma_f32_16x16x32_bf16 v[44:47], a[156:159], a[52:55], v[44:47]
  ds_read_b64_tr_b16 a[150:151], v193 offset:4608
  ds_read_b64_tr_b16 v[144:145], v249 offset:0
  v_mfma_f32_16x16x32_bf16 v[48:51], a[160:163], a[48:51], v[48:51]
  ds_read_b64_tr_b16 a[152:153], v190 offset:16384
  ds_read_b64_tr_b16 v[146:147], v249 offset:512
  ds_read_b128 v[234:237], v247 offset:1536
  v_mfma_f32_16x16x32_bf16 v[52:55], a[160:163], a[52:55], v[52:55]
  ds_read_b64_tr_b16 a[154:155], v190 offset:16896
  ds_read_b128 v[238:241], v247 offset:1552
  ds_read_b64 v[242:243], v247 offset:1568
  v_mfma_f32_16x16x32_bf16 v[56:59], a[164:167], a[48:51], v[56:59]
  s_waitcnt lgkmcnt(14)
  ds_read_b64_tr_b16 a[156:157], v191 offset:16384
  v_mul_f32 v72, v72, v104
  v_mfma_f32_16x16x32_bf16 v[60:63], a[164:167], a[52:55], v[60:63]
  s_waitcnt lgkmcnt(14)
  ds_read_b64_tr_b16 a[158:159], v191 offset:16896
  v_mul_f32 v73, v73, v105
  v_mul_f32 v74, v74, v106
  v_mfma_f32_16x16x32_bf16 v[0:3], a[168:171], a[56:59], v[0:3]
  s_waitcnt lgkmcnt(14)
  ds_read_b64_tr_b16 a[160:161], v192 offset:16384
  v_mul_f32 v75, v75, v107
  v_mfma_f32_16x16x32_bf16 v[4:7], a[168:171], a[60:63], v[4:7]
  s_waitcnt lgkmcnt(14)
  ds_read_b64_tr_b16 a[162:163], v192 offset:16896
  buffer_load_dwordx4 v212, s[12:15], s44 offen offset:3072 lds
  s_waitcnt lgkmcnt(6)
  v_mfma_f32_16x16x32_bf16 v[8:11], a[172:175], a[56:59], v[8:11]
  ds_read_b64_tr_b16 a[164:165], v193 offset:16384
  s_add_u32 m0, s46, 126976
  v_mfma_f32_16x16x32_bf16 v[12:15], a[172:175], a[60:63], v[12:15]
  ds_read_b64_tr_b16 a[166:167], v193 offset:16896
  v_cvt_pk_bf16_f32 v96, v64, v65
  v_cvt_pk_bf16_f32 v97, v66, v67
  v_mfma_f32_16x16x32_bf16 v[16:19], a[144:147], a[56:59], v[16:19]
  ds_read_b64_tr_b16 a[168:169], v190 offset:8192
  v_fmac_f32 v160, v234, v232
  v_mfma_f32_16x16x32_bf16 v[20:23], a[144:147], a[60:63], v[20:23]
  ds_read_b64_tr_b16 a[170:171], v190 offset:8704
  v_fmac_f32 v168, v234, v233
  v_fma_f32 v160, -v235, v233, v160
  v_mfma_f32_16x16x32_bf16 v[24:27], a[148:151], a[56:59], v[24:27]
  ds_read_b64_tr_b16 a[172:173], v191 offset:8192
  v_fmac_f32 v168, v235, v232
  v_mfma_f32_16x16x32_bf16 v[28:31], a[148:151], a[60:63], v[28:31]
  ds_read_b64_tr_b16 a[174:175], v191 offset:8704
  v_fmac_f32 v161, v236, v232
  v_fmac_f32 v169, v236, v233
  v_mfma_f32_16x16x32_bf16 v[32:35], a[152:155], a[56:59], v[32:35]
  ds_read_b64_tr_b16 a[144:145], v192 offset:8192
  buffer_load_dwordx4 v213, s[12:15], s44 offen lds
  v_mfma_f32_16x16x32_bf16 v[36:39], a[152:155], a[60:63], v[36:39]
  ds_read_b64_tr_b16 a[146:147], v192 offset:8704
  v_fma_f32 v161, -v237, v233, v161
  s_waitcnt lgkmcnt(4)
  v_mfma_f32_16x16x32_bf16 v[40:43], a[156:159], a[56:59], v[40:43]
  ds_read_b64_tr_b16 a[148:149], v193 offset:8192
  v_fmac_f32 v169, v237, v232
  v_mfma_f32_16x16x32_bf16 v[44:47], a[156:159], a[60:63], v[44:47]
  ds_read_b64_tr_b16 a[150:151], v193 offset:8704
  v_fmac_f32 v162, v238, v232
  v_fmac_f32 v170, v238, v233
  v_mfma_f32_16x16x32_bf16 v[48:51], a[160:163], a[56:59], v[48:51]
  ds_read_b64_tr_b16 a[152:153], v190 offset:20480
  v_fma_f32 v162, -v239, v233, v162
  v_fmac_f32 v170, v239, v232
  v_mfma_f32_16x16x32_bf16 v[52:55], a[160:163], a[60:63], v[52:55]
  ds_read_b64_tr_b16 a[154:155], v190 offset:20992
  v_fmac_f32 v163, v240, v232
  v_mfma_f32_16x16x32_bf16 v[56:59], a[164:167], a[56:59], v[56:59]
  ds_read_b64_tr_b16 a[156:157], v191 offset:20480
  v_fmac_f32 v171, v240, v233
  v_fma_f32 v163, -v241, v233, v163
  v_mfma_f32_16x16x32_bf16 v[60:63], a[164:167], a[60:63], v[60:63]
  ds_read_b64_tr_b16 a[158:159], v191 offset:20992
  buffer_load_dwordx4 v214, s[12:15], s44 offen offset:1024 lds
  v_mfma_f32_16x16x32_bf16 v[0:3], a[168:171], a[64:67], v[0:3]
  ds_read_b64_tr_b16 a[160:161], v192 offset:20480
  v_fmac_f32 v171, v241, v232
  v_cvt_pk_bf16_f32 v98, v72, v73
  v_mfma_f32_16x16x32_bf16 v[4:7], a[168:171], a[68:71], v[4:7]
  ds_read_b64_tr_b16 a[162:163], v192 offset:20992
  s_waitcnt lgkmcnt(4)
  v_mfma_f32_16x16x32_bf16 v[8:11], a[172:175], a[64:67], v[8:11]
  ds_read_b64_tr_b16 a[164:165], v193 offset:20480
  v_cvt_pk_bf16_f32 v99, v74, v75
  s_waitcnt vmcnt(19)
  v_mfma_f32_16x16x32_bf16 v[12:15], a[172:175], a[68:71], v[12:15]
  ds_read_b64_tr_b16 a[166:167], v193 offset:20992
  s_barrier
  v_mfma_f32_16x16x32_bf16 v[16:19], a[144:147], a[64:67], v[16:19]
  ds_read_b64_tr_b16 a[168:169], v190 offset:24576
  s_add_u32 s44, s66, 443008
  s_add_u32 m0, s46, 73728
  v_mfma_f32_16x16x32_bf16 v[20:23], a[144:147], a[68:71], v[20:23]
  ds_read_b64_tr_b16 a[170:171], v190 offset:25088
  v_accvgpr_write_b32 a208, v96
  v_mfma_f32_16x16x32_bf16 v[24:27], a[148:151], a[64:67], v[24:27]
  ds_read_b64_tr_b16 a[172:173], v191 offset:24576
  buffer_load_dwordx4 v209, s[12:15], s44 offen lds
  v_accvgpr_write_b32 a209, v97
  v_mfma_f32_16x16x32_bf16 v[28:31], a[148:151], a[68:71], v[28:31]
  ds_read_b64_tr_b16 a[174:175], v191 offset:25088
  v_accvgpr_write_b32 a210, v98
  v_mfma_f32_16x16x32_bf16 v[32:35], a[152:155], a[64:67], v[32:35]
  ds_read_b64_tr_b16 a[144:145], v192 offset:24576
  v_accvgpr_write_b32 a211, v99
  v_mul_f32 v250, v242, v160
  v_mfma_f32_16x16x32_bf16 v[36:39], a[152:155], a[68:71], v[36:39]
  ds_read_b64_tr_b16 a[146:147], v192 offset:25088
  s_waitcnt lgkmcnt(4)
  v_mfma_f32_16x16x32_bf16 v[40:43], a[156:159], a[64:67], v[40:43]
  ds_read_b64_tr_b16 a[148:149], v193 offset:24576
  v_fma_f32 v250, -v243, v168, v250
  v_mul_f32 v168, v242, v168
  v_mfma_f32_16x16x32_bf16 v[44:47], a[156:159], a[68:71], v[44:47]
  ds_read_b64_tr_b16 a[150:151], v193 offset:25088
  s_add_u32 s63, s61, 8192
  buffer_store_dwordx4 v[96:99], v226, s[24:27], s63 offen sc1
  v_mfma_f32_16x16x32_bf16 v[48:51], a[160:163], a[64:67], v[48:51]
  ds_read_b64_tr_b16 a[152:153], v190 offset:36864
  v_max_f32 v68, 0, v68
  v_mfma_f32_16x16x32_bf16 v[52:55], a[160:163], a[68:71], v[52:55]
  ds_read_b64_tr_b16 a[154:155], v190 offset:37376
  v_mul_f32 v100, v216, v100
  v_max_f32 v69, 0, v69
  v_mfma_f32_16x16x32_bf16 v[56:59], a[164:167], a[64:67], v[56:59]
  ds_read_b64_tr_b16 a[156:157], v191 offset:36864
  v_mul_f32 v101, v216, v101
  v_mfma_f32_16x16x32_bf16 v[60:63], a[164:167], a[68:71], v[60:63]
  ds_read_b64_tr_b16 a[158:159], v191 offset:37376
  v_max_f32 v70, 0, v70
  v_mul_f32 v102, v216, v102
  v_mfma_f32_16x16x32_bf16 v[0:3], a[168:171], a[72:75], v[0:3]
  ds_read_b64_tr_b16 a[160:161], v192 offset:36864
  buffer_load_dwordx4 v210, s[12:15], s44 offen offset:1024 lds
  v_mfma_f32_16x16x32_bf16 v[4:7], a[168:171], a[76:79], v[4:7]
  ds_read_b64_tr_b16 a[162:163], v192 offset:37376
  v_max_f32 v71, 0, v71
  s_waitcnt lgkmcnt(4)
  v_mfma_f32_16x16x32_bf16 v[8:11], a[172:175], a[72:75], v[8:11]
  ds_read_b64_tr_b16 a[164:165], v193 offset:36864
  v_mul_f32 v103, v216, v103
  v_mfma_f32_16x16x32_bf16 v[12:15], a[172:175], a[76:79], v[12:15]
  ds_read_b64_tr_b16 a[166:167], v193 offset:37376
  v_mul_f32 v68, v68, v100
  v_mul_f32 v69, v69, v101
  v_mfma_f32_16x16x32_bf16 v[16:19], a[144:147], a[72:75], v[16:19]
  ds_read_b64_tr_b16 a[168:169], v190 offset:28672
  v_mul_f32 v70, v70, v102
  v_mfma_f32_16x16x32_bf16 v[20:23], a[144:147], a[76:79], v[20:23]
  ds_read_b64_tr_b16 a[170:171], v190 offset:29184
  v_mul_f32 v71, v71, v103
  v_max_f32 v76, 0, v76
  v_mfma_f32_16x16x32_bf16 v[24:27], a[148:151], a[72:75], v[24:27]
  ds_read_b64_tr_b16 a[172:173], v191 offset:28672
  v_mul_f32 v108, v216, v108
  v_mfma_f32_16x16x32_bf16 v[28:31], a[148:151], a[76:79], v[28:31]
  ds_read_b64_tr_b16 a[174:175], v191 offset:29184
  buffer_load_dwordx4 v211, s[12:15], s44 offen offset:2048 lds
  v_max_f32 v77, 0, v77
  v_mfma_f32_16x16x32_bf16 v[32:35], a[152:155], a[72:75], v[32:35]
  ds_read_b64_tr_b16 a[144:145], v192 offset:28672
  v_mul_f32 v109, v216, v109
  v_max_f32 v78, 0, v78
  v_mfma_f32_16x16x32_bf16 v[36:39], a[152:155], a[76:79], v[36:39]
  ds_read_b64_tr_b16 a[146:147], v192 offset:29184
  s_waitcnt lgkmcnt(4)
  v_mfma_f32_16x16x32_bf16 v[40:43], a[156:159], a[72:75], v[40:43]
  ds_read_b64_tr_b16 a[148:149], v193 offset:28672
  v_mul_f32 v110, v216, v110
  v_max_f32 v79, 0, v79
  v_mfma_f32_16x16x32_bf16 v[44:47], a[156:159], a[76:79], v[44:47]
  ds_read_b64_tr_b16 a[150:151], v193 offset:29184
  v_mul_f32 v111, v216, v111
  v_mfma_f32_16x16x32_bf16 v[48:51], a[160:163], a[72:75], v[48:51]
  ds_read_b64_tr_b16 a[152:153], v190 offset:40960
  v_mul_f32 v76, v76, v108
  v_mul_f32 v77, v77, v109
  v_mfma_f32_16x16x32_bf16 v[52:55], a[160:163], a[76:79], v[52:55]
  ds_read_b64_tr_b16 a[154:155], v190 offset:41472
  v_mul_f32 v78, v78, v110
  v_mfma_f32_16x16x32_bf16 v[56:59], a[164:167], a[72:75], v[56:59]
  ds_read_b64_tr_b16 a[156:157], v191 offset:40960
  buffer_load_dwordx4 v212, s[12:15], s44 offen offset:3072 lds
  s_add_u32 m0, s46, 77824
  v_mfma_f32_16x16x32_bf16 v[60:63], a[164:167], a[76:79], v[60:63]
  ds_read_b64_tr_b16 a[158:159], v191 offset:41472
  v_mul_f32 v79, v79, v111
  v_mfma_f32_16x16x32_bf16 v[0:3], a[168:171], a[80:83], v[0:3]
  ds_read_b64_tr_b16 a[160:161], v192 offset:40960
  v_cvt_pk_bf16_f32 v100, v68, v69
  v_cvt_pk_bf16_f32 v101, v70, v71
  v_mfma_f32_16x16x32_bf16 v[4:7], a[168:171], a[84:87], v[4:7]
  ds_read_b64_tr_b16 a[162:163], v192 offset:41472
  s_waitcnt lgkmcnt(4)
  v_mfma_f32_16x16x32_bf16 v[8:11], a[172:175], a[80:83], v[8:11]
  ds_read_b64_tr_b16 a[164:165], v193 offset:40960
  v_cvt_pk_bf16_f32 v102, v76, v77
  v_cvt_pk_bf16_f32 v103, v78, v79
  v_mfma_f32_16x16x32_bf16 v[12:15], a[172:175], a[84:87], v[12:15]
  ds_read_b64_tr_b16 a[166:167], v193 offset:41472
  v_accvgpr_write_b32 a212, v100
  v_mfma_f32_16x16x32_bf16 v[16:19], a[144:147], a[80:83], v[16:19]
  ds_read_b64_tr_b16 a[168:169], v190 offset:32768
  v_accvgpr_write_b32 a213, v101
  v_accvgpr_write_b32 a214, v102
  v_mfma_f32_16x16x32_bf16 v[20:23], a[144:147], a[84:87], v[20:23]
  ds_read_b64_tr_b16 a[170:171], v190 offset:33280
  buffer_load_dwordx4 v213, s[12:15], s44 offen lds
  v_mfma_f32_16x16x32_bf16 v[24:27], a[148:151], a[80:83], v[24:27]
  ds_read_b64_tr_b16 a[172:173], v191 offset:32768
  v_accvgpr_write_b32 a215, v103
  v_fmac_f32 v168, v243, v160
  v_mfma_f32_16x16x32_bf16 v[28:31], a[148:151], a[84:87], v[28:31]
  ds_read_b64_tr_b16 a[174:175], v191 offset:33280
  v_mul_f32 v160, v176, v250
  v_mul_f32_e64 v168, -v176, v168
  v_mfma_f32_16x16x32_bf16 v[32:35], a[152:155], a[80:83], v[32:35]
  ds_read_b64_tr_b16 a[144:145], v192 offset:32768
  v_mul_f32 v251, v242, v161
  v_mfma_f32_16x16x32_bf16 v[36:39], a[152:155], a[84:87], v[36:39]
  ds_read_b64_tr_b16 a[146:147], v192 offset:33280
  v_fma_f32 v251, -v243, v169, v251
  s_waitcnt lgkmcnt(4)
  v_mfma_f32_16x16x32_bf16 v[40:43], a[156:159], a[80:83], v[40:43]
  ds_read_b64_tr_b16 a[148:149], v193 offset:32768
  s_add_u32 s63, s61, 8192
  buffer_store_dwordx4 v[100:103], v226, s[24:27], s63 offen offset:1024 sc1
  v_mfma_f32_16x16x32_bf16 v[44:47], a[156:159], a[84:87], v[44:47]
  ds_read_b64_tr_b16 a[150:151], v193 offset:33280
  v_max_f32 v80, 0, v80
  v_mul_f32 v112, v215, v112
  v_mfma_f32_16x16x32_bf16 v[48:51], a[160:163], a[80:83], v[48:51]
  ds_read_b64_tr_b16 a[152:153], v190 offset:45056
  v_max_f32 v81, 0, v81
  v_mfma_f32_16x16x32_bf16 v[52:55], a[160:163], a[84:87], v[52:55]
  ds_read_b64_tr_b16 a[154:155], v190 offset:45568
  v_mul_f32 v113, v215, v113
  v_max_f32 v82, 0, v82
  v_mfma_f32_16x16x32_bf16 v[56:59], a[164:167], a[80:83], v[56:59]
  ds_read_b64_tr_b16 a[156:157], v191 offset:45056
  v_mul_f32 v114, v215, v114
  v_mfma_f32_16x16x32_bf16 v[60:63], a[164:167], a[84:87], v[60:63]
  ds_read_b64_tr_b16 a[158:159], v191 offset:45568
  buffer_load_dwordx4 v214, s[12:15], s44 offen offset:1024 lds
  v_max_f32 v83, 0, v83
  v_mfma_f32_16x16x32_bf16 v[0:3], a[168:171], a[88:91], v[0:3]
  ds_read_b64_tr_b16 a[160:161], v192 offset:45056
  v_mul_f32 v115, v215, v115
  v_mfma_f32_16x16x32_bf16 v[4:7], a[168:171], a[92:95], v[4:7]
  ds_read_b64_tr_b16 a[162:163], v192 offset:45568
  v_mul_f32 v80, v80, v112
  s_waitcnt lgkmcnt(4)
  v_mfma_f32_16x16x32_bf16 v[8:11], a[172:175], a[88:91], v[8:11]
  ds_read_b64_tr_b16 a[164:165], v193 offset:45056
  s_waitcnt vmcnt(21)
  v_mfma_f32_16x16x32_bf16 v[12:15], a[172:175], a[92:95], v[12:15]
  ds_read_b64_tr_b16 a[166:167], v193 offset:45568
  v_mul_f32 v81, v81, v113
  s_barrier
  v_mfma_f32_16x16x32_bf16 v[16:19], a[144:147], a[88:91], v[16:19]
  ds_read_b64_tr_b16 a[168:169], v194
  s_add_u32 s44, s67, 512
  v_mfma_f32_16x16x32_bf16 v[20:23], a[144:147], a[92:95], v[20:23]
  ds_read_b64_tr_b16 a[170:171], v194 offset:512
  s_add_u32 m0, s46, 0
  v_lshrrev_b32 v254, 4, v225
  v_mfma_f32_16x16x32_bf16 v[24:27], a[148:151], a[88:91], v[24:27]
  ds_read_b64_tr_b16 a[172:173], v195
  buffer_load_dwordx4 v209, s[12:15], s44 offen lds
  v_lshlrev_b32 v254, 9, v254
  v_mfma_f32_16x16x32_bf16 v[28:31], a[148:151], a[92:95], v[28:31]
  ds_read_b64_tr_b16 a[174:175], v195 offset:512
  v_sub_u32 v190, v190, v254
  v_mfma_f32_16x16x32_bf16 v[32:35], a[152:155], a[88:91], v[32:35]
  ds_read_b64_tr_b16 a[144:145], v196
  v_sub_u32 v191, v191, v254
  v_sub_u32 v192, v192, v254
  v_mfma_f32_16x16x32_bf16 v[36:39], a[152:155], a[92:95], v[36:39]
  ds_read_b64_tr_b16 a[146:147], v196 offset:512
  s_waitcnt lgkmcnt(4)
  v_mfma_f32_16x16x32_bf16 v[40:43], a[156:159], a[88:91], v[40:43]
  ds_read_b64_tr_b16 a[148:149], v197
  v_sub_u32 v193, v193, v254
  v_mul_f32 v82, v82, v114
  v_mfma_f32_16x16x32_bf16 v[44:47], a[156:159], a[92:95], v[44:47]
  ds_read_b64_tr_b16 a[150:151], v197 offset:512
  v_mul_f32 v83, v83, v115
  v_mfma_f32_16x16x32_bf16 v[48:51], a[160:163], a[88:91], v[48:51]
  ds_read_b64_tr_b16 a[152:153], v194 offset:12288
  v_max_f32 v88, 0, v88
  v_mul_f32 v120, v215, v120
  v_mfma_f32_16x16x32_bf16 v[52:55], a[160:163], a[92:95], v[52:55]
  ds_read_b64_tr_b16 a[154:155], v194 offset:12800
  buffer_load_dwordx4 v210, s[12:15], s44 offen offset:1024 lds
  v_mfma_f32_16x16x32_bf16 v[56:59], a[164:167], a[88:91], v[56:59]
  ds_read_b64_tr_b16 a[156:157], v195 offset:12288
  v_max_f32 v89, 0, v89
  v_mul_f32 v121, v215, v121
  v_mfma_f32_16x16x32_bf16 v[60:63], a[164:167], a[92:95], v[60:63]
  ds_read_b64_tr_b16 a[158:159], v195 offset:12800
  v_max_f32 v90, 0, v90
  v_mfma_f32_16x16x32_bf16 v[0:3], a[168:171], a[96:99], v[0:3]
  ds_read_b64_tr_b16 a[160:161], v196 offset:12288
  v_mul_f32 v122, v215, v122
  v_max_f32 v91, 0, v91
  v_mfma_f32_16x16x32_bf16 v[4:7], a[168:171], a[100:103], v[4:7]
  ds_read_b64_tr_b16 a[162:163], v196 offset:12800
  s_waitcnt lgkmcnt(4)
  v_mfma_f32_16x16x32_bf16 v[8:11], a[172:175], a[96:99], v[8:11]
  ds_read_b64_tr_b16 a[164:165], v197 offset:12288
  v_mul_f32 v123, v215, v123
  v_mul_f32 v88, v88, v120
  v_mfma_f32_16x16x32_bf16 v[12:15], a[172:175], a[100:103], v[12:15]
  ds_read_b64_tr_b16 a[166:167], v197 offset:12800
  v_mul_f32 v89, v89, v121
  v_mfma_f32_16x16x32_bf16 v[16:19], a[144:147], a[96:99], v[16:19]
  ds_read_b64_tr_b16 a[168:169], v194 offset:4096
  buffer_load_dwordx4 v211, s[12:15], s44 offen offset:2048 lds
  v_mul_f32 v90, v90, v122
  v_mfma_f32_16x16x32_bf16 v[20:23], a[144:147], a[100:103], v[20:23]
  ds_read_b64_tr_b16 a[170:171], v194 offset:4608
  v_mul_f32 v91, v91, v123
  v_mfma_f32_16x16x32_bf16 v[24:27], a[148:151], a[96:99], v[24:27]
  ds_read_b64_tr_b16 a[172:173], v195 offset:4096
  v_cvt_pk_bf16_f32 v112, v80, v81
  v_cvt_pk_bf16_f32 v113, v82, v83
  v_mfma_f32_16x16x32_bf16 v[28:31], a[148:151], a[100:103], v[28:31]
  ds_read_b64_tr_b16 a[174:175], v195 offset:4608
  v_cvt_pk_bf16_f32 v114, v88, v89
  v_cvt_pk_bf16_f32 v115, v90, v91
  v_mfma_f32_16x16x32_bf16 v[32:35], a[152:155], a[96:99], v[32:35]
  ds_read_b64_tr_b16 a[144:145], v196 offset:4096
  v_accvgpr_write_b32 a216, v112
  v_mfma_f32_16x16x32_bf16 v[36:39], a[152:155], a[100:103], v[36:39]
  ds_read_b64_tr_b16 a[146:147], v196 offset:4608
  v_accvgpr_write_b32 a217, v113
  s_waitcnt lgkmcnt(4)
  v_mfma_f32_16x16x32_bf16 v[40:43], a[156:159], a[96:99], v[40:43]
  ds_read_b64_tr_b16 a[148:149], v197 offset:4096
  v_accvgpr_write_b32 a218, v114
  v_mfma_f32_16x16x32_bf16 v[44:47], a[156:159], a[100:103], v[44:47]
  ds_read_b64_tr_b16 a[150:151], v197 offset:4608
  buffer_load_dwordx4 v212, s[12:15], s44 offen offset:3072 lds
  s_add_u32 m0, s46, 4096
  v_mfma_f32_16x16x32_bf16 v[48:51], a[160:163], a[96:99], v[48:51]
  ds_read_b64_tr_b16 a[152:153], v194 offset:16384
  v_accvgpr_write_b32 a219, v115
  v_mfma_f32_16x16x32_bf16 v[52:55], a[160:163], a[100:103], v[52:55]
  ds_read_b64_tr_b16 a[154:155], v194 offset:16896
  v_mul_f32 v169, v242, v169
  v_add_u32 v252, 0, v225
  v_mfma_f32_16x16x32_bf16 v[56:59], a[164:167], a[96:99], v[56:59]
  ds_read_b64_tr_b16 a[156:157], v195 offset:16384
  v_fmac_f32 v169, v243, v161
  v_mfma_f32_16x16x32_bf16 v[60:63], a[164:167], a[100:103], v[60:63]
  ds_read_b64_tr_b16 a[158:159], v195 offset:16896
  v_mul_f32 v161, v177, v251
  v_mul_f32_e64 v169, -v177, v169
  v_mfma_f32_16x16x32_bf16 v[0:3], a[168:171], a[104:107], v[0:3]
  ds_read_b64_tr_b16 a[160:161], v196 offset:16384
  s_add_u32 s63, s61, 8192
  buffer_store_dwordx4 v[112:115], v226, s[24:27], s63 offen offset:2048 sc1
  v_mfma_f32_16x16x32_bf16 v[4:7], a[168:171], a[108:111], v[4:7]
  ds_read_b64_tr_b16 a[162:163], v196 offset:16896
  v_max_f32 v84, 0, v84
  s_waitcnt lgkmcnt(4)
  v_mfma_f32_16x16x32_bf16 v[8:11], a[172:175], a[104:107], v[8:11]
  ds_read_b64_tr_b16 a[164:165], v197 offset:16384
  v_mul_f32 v116, v216, v116
  v_mfma_f32_16x16x32_bf16 v[12:15], a[172:175], a[108:111], v[12:15]
  ds_read_b64_tr_b16 a[166:167], v197 offset:16896
  v_max_f32 v85, 0, v85
  v_mul_f32 v117, v216, v117
  v_mfma_f32_16x16x32_bf16 v[16:19], a[144:147], a[104:107], v[16:19]
  ds_read_b64_tr_b16 a[168:169], v194 offset:8192
  v_max_f32 v86, 0, v86
  v_mfma_f32_16x16x32_bf16 v[20:23], a[144:147], a[108:111], v[20:23]
  ds_read_b64_tr_b16 a[170:171], v194 offset:8704
  buffer_load_dwordx4 v213, s[12:15], s44 offen lds
  v_mul_f32 v118, v216, v118
  v_mfma_f32_16x16x32_bf16 v[24:27], a[148:151], a[104:107], v[24:27]
  ds_read_b64_tr_b16 a[172:173], v195 offset:8192
  v_max_f32 v87, 0, v87
  v_mul_f32 v119, v216, v119
  v_mfma_f32_16x16x32_bf16 v[28:31], a[148:151], a[108:111], v[28:31]
  ds_read_b64_tr_b16 a[174:175], v195 offset:8704
  v_mul_f32 v84, v84, v116
  v_mfma_f32_16x16x32_bf16 v[32:35], a[152:155], a[104:107], v[32:35]
  ds_read_b64_tr_b16 a[144:145], v196 offset:8192
  v_mul_f32 v85, v85, v117
  v_mul_f32 v86, v86, v118
  v_mfma_f32_16x16x32_bf16 v[36:39], a[152:155], a[108:111], v[36:39]
  ds_read_b64_tr_b16 a[146:147], v196 offset:8704
  s_waitcnt lgkmcnt(4)
  v_mfma_f32_16x16x32_bf16 v[40:43], a[156:159], a[104:107], v[40:43]
  ds_read_b64_tr_b16 a[148:149], v197 offset:8192
  v_mul_f32 v87, v87, v119
  v_max_f32 v92, 0, v92
  v_mfma_f32_16x16x32_bf16 v[44:47], a[156:159], a[108:111], v[44:47]
  ds_read_b64_tr_b16 a[150:151], v197 offset:8704
  v_mul_f32 v124, v216, v124
  v_mfma_f32_16x16x32_bf16 v[48:51], a[160:163], a[104:107], v[48:51]
  ds_read_b64_tr_b16 a[152:153], v194 offset:20480
  buffer_load_dwordx4 v214, s[12:15], s44 offen offset:1024 lds
  v_max_f32 v93, 0, v93
  v_mfma_f32_16x16x32_bf16 v[52:55], a[160:163], a[108:111], v[52:55]
  ds_read_b64_tr_b16 a[154:155], v194 offset:20992
  v_mul_f32 v125, v216, v125
  v_mfma_f32_16x16x32_bf16 v[56:59], a[164:167], a[104:107], v[56:59]
  ds_read_b64_tr_b16 a[156:157], v195 offset:20480
  v_max_f32 v94, 0, v94
  v_mul_f32 v126, v216, v126
  v_mfma_f32_16x16x32_bf16 v[60:63], a[164:167], a[108:111], v[60:63]
  ds_read_b64_tr_b16 a[158:159], v195 offset:20992
  v_max_f32 v95, 0, v95
  v_mfma_f32_16x16x32_bf16 v[0:3], a[168:171], a[112:115], v[0:3]
  ds_read_b64_tr_b16 a[160:161], v196 offset:20480
  v_mul_f32 v127, v216, v127
  v_mul_f32 v92, v92, v124
  v_mfma_f32_16x16x32_bf16 v[4:7], a[168:171], a[116:119], v[4:7]
  ds_read_b64_tr_b16 a[162:163], v196 offset:20992
  s_waitcnt lgkmcnt(4)
  v_mfma_f32_16x16x32_bf16 v[8:11], a[172:175], a[112:115], v[8:11]
  ds_read_b64_tr_b16 a[164:165], v197 offset:20480
  v_mul_f32 v93, v93, v125
  s_waitcnt vmcnt(22)
  v_mfma_f32_16x16x32_bf16 v[12:15], a[172:175], a[116:119], v[12:15]
  ds_read_b64_tr_b16 a[166:167], v197 offset:20992
  s_barrier
  v_mfma_f32_16x16x32_bf16 v[16:19], a[144:147], a[112:115], v[16:19]
  ds_read_b64_tr_b16 a[168:169], v198
  s_add_u32 s44, s66, 332672
  s_add_u32 m0, s46, 24576
  v_mfma_f32_16x16x32_bf16 v[20:23], a[144:147], a[116:119], v[20:23]
  ds_read_b64_tr_b16 a[170:171], v198 offset:512
  buffer_load_dwordx4 v209, s[12:15], s44 offen lds
  v_mfma_f32_16x16x32_bf16 v[24:27], a[148:151], a[112:115], v[24:27]
  ds_read_b64_tr_b16 a[172:173], v199
  v_sub_u32 v194, v194, v254
  v_sub_u32 v195, v195, v254
  v_mfma_f32_16x16x32_bf16 v[28:31], a[148:151], a[116:119], v[28:31]
  ds_read_b64_tr_b16 a[174:175], v199 offset:512
  v_sub_u32 v196, v196, v254
  v_mfma_f32_16x16x32_bf16 v[32:35], a[152:155], a[112:115], v[32:35]
  ds_read_b64_tr_b16 a[144:145], v200
  v_sub_u32 v197, v197, v254
  v_mul_f32 v94, v94, v126
  v_mfma_f32_16x16x32_bf16 v[36:39], a[152:155], a[116:119], v[36:39]
  ds_read_b64_tr_b16 a[146:147], v200 offset:512
  v_mul_f32 v95, v95, v127
  s_waitcnt lgkmcnt(4)
  v_mfma_f32_16x16x32_bf16 v[40:43], a[156:159], a[112:115], v[40:43]
  ds_read_b64_tr_b16 a[148:149], v201
  v_cvt_pk_bf16_f32 v116, v84, v85
  v_mfma_f32_16x16x32_bf16 v[44:47], a[156:159], a[116:119], v[44:47]
  ds_read_b64_tr_b16 a[150:151], v201 offset:512
  v_cvt_pk_bf16_f32 v117, v86, v87
  v_cvt_pk_bf16_f32 v118, v92, v93
  v_mfma_f32_16x16x32_bf16 v[48:51], a[160:163], a[112:115], v[48:51]
  ds_read_b64_tr_b16 a[152:153], v198 offset:12288
  buffer_load_dwordx4 v210, s[12:15], s44 offen offset:1024 lds
  v_mfma_f32_16x16x32_bf16 v[52:55], a[160:163], a[116:119], v[52:55]
  ds_read_b64_tr_b16 a[154:155], v198 offset:12800
  v_cvt_pk_bf16_f32 v119, v94, v95
  v_accvgpr_write_b32 a220, v116
  v_mfma_f32_16x16x32_bf16 v[56:59], a[164:167], a[112:115], v[56:59]
  ds_read_b64_tr_b16 a[156:157], v199 offset:12288
  v_accvgpr_write_b32 a221, v117
  v_mfma_f32_16x16x32_bf16 v[60:63], a[164:167], a[116:119], v[60:63]
  ds_read_b64_tr_b16 a[158:159], v199 offset:12800
  v_accvgpr_write_b32 a222, v118
  v_accvgpr_write_b32 a223, v119
  v_mfma_f32_16x16x32_bf16 v[0:3], a[168:171], a[120:123], v[0:3]
  ds_read_b64_tr_b16 a[160:161], v200 offset:12288
  v_mul_f32 v250, v242, v162
  v_mfma_f32_16x16x32_bf16 v[4:7], a[168:171], a[124:127], v[4:7]
  ds_read_b64_tr_b16 a[162:163], v200 offset:12800
  s_add_u32 s63, s61, 8192
  buffer_store_dwordx4 v[116:119], v226, s[24:27], s63 offen offset:3072 sc1
  s_waitcnt lgkmcnt(4)
  v_mfma_f32_16x16x32_bf16 v[8:11], a[172:175], a[120:123], v[8:11]
  ds_read_b64_tr_b16 a[164:165], v201 offset:12288
  v_fma_f32 v250, -v243, v170, v250
  v_mfma_f32_16x16x32_bf16 v[12:15], a[172:175], a[124:127], v[12:15]
  ds_read_b64_tr_b16 a[166:167], v201 offset:12800
  v_mul_f32 v170, v242, v170
  v_mul_u32_u24 v253, 10923, v252
  v_mfma_f32_16x16x32_bf16 v[16:19], a[144:147], a[120:123], v[16:19]
  ds_read_b64_tr_b16 a[168:169], v198 offset:4096
  v_fmac_f32 v170, v243, v162
  v_mfma_f32_16x16x32_bf16 v[20:23], a[144:147], a[124:127], v[20:23]
  ds_read_b64_tr_b16 a[170:171], v198 offset:4608
  v_mul_f32 v162, v178, v250
  v_mul_f32_e64 v170, -v178, v170
  v_mfma_f32_16x16x32_bf16 v[24:27], a[148:151], a[120:123], v[24:27]
  ds_read_b64_tr_b16 a[172:173], v199 offset:4096
  buffer_load_dwordx4 v211, s[12:15], s44 offen offset:2048 lds
  v_mfma_f32_16x16x32_bf16 v[28:31], a[148:151], a[124:127], v[28:31]
  ds_read_b64_tr_b16 a[174:175], v199 offset:4608
  v_mul_f32 v251, v242, v163
  v_lshrrev_b32 v253, 16, v253
  v_mfma_f32_16x16x32_bf16 v[32:35], a[152:155], a[120:123], v[32:35]
  ds_read_b64_tr_b16 a[144:145], v200 offset:4096
  v_fma_f32 v251, -v243, v171, v251
  v_mfma_f32_16x16x32_bf16 v[36:39], a[152:155], a[124:127], v[36:39]
  ds_read_b64_tr_b16 a[146:147], v200 offset:4608
  v_mul_f32 v171, v242, v171
  s_waitcnt lgkmcnt(4)
  v_mfma_f32_16x16x32_bf16 v[40:43], a[156:159], a[120:123], v[40:43]
  ds_read_b64_tr_b16 a[148:149], v201 offset:4096
  v_fmac_f32 v171, v243, v163
  v_mfma_f32_16x16x32_bf16 v[44:47], a[156:159], a[124:127], v[44:47]
  ds_read_b64_tr_b16 a[150:151], v201 offset:4608
  v_mul_f32 v163, v179, v251
  v_mul_f32_e64 v171, -v179, v171
  v_mfma_f32_16x16x32_bf16 v[48:51], a[160:163], a[120:123], v[48:51]
  ds_read_b64_tr_b16 a[152:153], v198 offset:16384
  v_cvt_pk_bf16_f32 v160, v160, v161
  v_cvt_pk_bf16_f32 v161, v162, v163
  v_mfma_f32_16x16x32_bf16 v[52:55], a[160:163], a[124:127], v[52:55]
  ds_read_b64_tr_b16 a[154:155], v198 offset:16896
  buffer_load_dwordx4 v212, s[12:15], s44 offen offset:3072 lds
  v_mfma_f32_16x16x32_bf16 v[56:59], a[164:167], a[120:123], v[56:59]
  ds_read_b64_tr_b16 a[156:157], v199 offset:16384
  s_add_u32 m0, s46, 28672
  v_cvt_pk_bf16_f32 v168, v168, v169
  v_mfma_f32_16x16x32_bf16 v[60:63], a[164:167], a[124:127], v[60:63]
  ds_read_b64_tr_b16 a[158:159], v199 offset:16896
  v_cvt_pk_bf16_f32 v169, v170, v171
  v_mfma_f32_16x16x32_bf16 v[0:3], a[168:171], a[128:131], v[0:3]
  ds_read_b64_tr_b16 a[160:161], v200 offset:16384
  ds_write_b64 v248, v[160:161] offset:0
  ds_write_b64 v248, v[168:169] offset:512
  v_mfma_f32_16x16x32_bf16 v[4:7], a[168:171], a[132:135], v[4:7]
  ds_read_b64_tr_b16 a[162:163], v200 offset:16896
  s_waitcnt lgkmcnt(6)
  v_mfma_f32_16x16x32_bf16 v[8:11], a[172:175], a[128:131], v[8:11]
  ds_read_b64_tr_b16 a[164:165], v201 offset:16384
  ds_read_b64_tr_b16 v[160:161], v249 offset:0
  ds_read_b64_tr_b16 v[162:163], v249 offset:512
  v_mfma_f32_16x16x32_bf16 v[12:15], a[172:175], a[132:135], v[12:15]
  ds_read_b64_tr_b16 a[166:167], v201 offset:16896
  ds_read_b64 v[228:229], v245 offset:0
  v_mfma_f32_16x16x32_bf16 v[16:19], a[144:147], a[128:131], v[16:19]
  ds_read_b64_tr_b16 a[168:169], v198 offset:8192
  buffer_load_dwordx4 v213, s[12:15], s44 offen lds
  ds_read_b64 v[230:231], v245 offset:128
  v_mfma_f32_16x16x32_bf16 v[20:23], a[144:147], a[132:135], v[20:23]
  ds_read_b64_tr_b16 a[170:171], v198 offset:8704
  ds_read_b64 v[232:233], v245 offset:256
  v_mfma_f32_16x16x32_bf16 v[24:27], a[148:151], a[128:131], v[24:27]
  s_waitcnt lgkmcnt(14)
  ds_read_b64_tr_b16 a[172:173], v199 offset:8192
  s_waitcnt lgkmcnt(14)
  ds_read_b128 v[234:237], v247 offset:0
  s_waitcnt lgkmcnt(14)
  ds_read_b128 v[238:241], v247 offset:16
  v_mfma_f32_16x16x32_bf16 v[28:31], a[148:151], a[132:135], v[28:31]
  s_waitcnt lgkmcnt(14)
  ds_read_b64_tr_b16 a[174:175], v199 offset:8704
  s_waitcnt lgkmcnt(14)
  ds_read_b64 v[242:243], v247 offset:32
  v_mfma_f32_16x16x32_bf16 v[32:35], a[152:155], a[128:131], v[32:35]
  s_waitcnt lgkmcnt(14)
  ds_read_b64_tr_b16 a[144:145], v200 offset:8192
  v_mul_u32_u24 v203, 6, v253
  v_mfma_f32_16x16x32_bf16 v[36:39], a[152:155], a[132:135], v[36:39]
  s_waitcnt lgkmcnt(14)
  ds_read_b64_tr_b16 a[146:147], v200 offset:8704
  s_waitcnt lgkmcnt(8)
  v_mfma_f32_16x16x32_bf16 v[40:43], a[156:159], a[128:131], v[40:43]
  ds_read_b64_tr_b16 a[148:149], v201 offset:8192
  v_sub_u32 v203, v252, v203
  v_bfe_u32 v252, v253, 3, 1
  v_mfma_f32_16x16x32_bf16 v[44:47], a[156:159], a[132:135], v[44:47]
  ds_read_b64_tr_b16 a[150:151], v201 offset:8704
  buffer_load_dwordx4 v214, s[12:15], s44 offen offset:1024 lds
  v_mfma_f32_16x16x32_bf16 v[48:51], a[160:163], a[128:131], v[48:51]
  ds_read_b64_tr_b16 a[152:153], v198 offset:20480
  v_xor_b32 v203, v203, v252
  v_mfma_f32_16x16x32_bf16 v[52:55], a[160:163], a[132:135], v[52:55]
  ds_read_b64_tr_b16 a[154:155], v198 offset:20992
  v_lshlrev_b32 v203, 4, v203
  v_mfma_f32_16x16x32_bf16 v[56:59], a[164:167], a[128:131], v[56:59]
  ds_read_b64_tr_b16 a[156:157], v199 offset:20480
  s_waitcnt lgkmcnt(10)
  v_fmac_f32 v132, v234, v228
  v_fmac_f32 v140, v234, v229
  v_mfma_f32_16x16x32_bf16 v[60:63], a[164:167], a[132:135], v[60:63]
  ds_read_b64_tr_b16 a[158:159], v199 offset:20992
  v_fma_f32 v132, -v235, v229, v132
  v_fmac_f32 v140, v235, v228
  v_mfma_f32_16x16x32_bf16 v[0:3], a[168:171], a[136:139], v[0:3]
  ds_read_b64_tr_b16 a[160:161], v200 offset:20480
  v_fmac_f32 v133, v236, v228
  v_mfma_f32_16x16x32_bf16 v[4:7], a[168:171], a[140:143], v[4:7]
  ds_read_b64_tr_b16 a[162:163], v200 offset:20992
  v_fmac_f32 v141, v236, v229
  v_fma_f32 v133, -v237, v229, v133
  s_waitcnt lgkmcnt(4)
  v_mfma_f32_16x16x32_bf16 v[8:11], a[172:175], a[136:139], v[8:11]
  ds_read_b64_tr_b16 a[164:165], v201 offset:20480
  v_fmac_f32 v141, v237, v228
  v_fmac_f32 v134, v238, v228
  s_waitcnt vmcnt(22)
  v_mfma_f32_16x16x32_bf16 v[12:15], a[172:175], a[140:143], v[12:15]
  ds_read_b64_tr_b16 a[166:167], v201 offset:20992
  v_fmac_f32 v142, v238, v229
  v_fma_f32 v134, -v239, v229, v134
  v_fmac_f32 v142, v239, v228
  v_fmac_f32 v135, v240, v228
  v_sub_u32 v198, v198, v254
  v_sub_u32 v199, v199, v254
  v_sub_u32 v200, v200, v254
  v_sub_u32 v201, v201, v254
  s_barrier
  v_mfma_f32_16x16x32_bf16 v[16:19], a[144:147], a[136:139], v[16:19]
  ds_read_b64_tr_b16 a[168:169], v198 offset:24576
  s_add_u32 s44, s66, 443264
  v_mfma_f32_16x16x32_bf16 v[20:23], a[144:147], a[140:143], v[20:23]
  ds_read_b64_tr_b16 a[170:171], v198 offset:26624
  s_add_u32 m0, s46, 49152
  s_nop 0
  buffer_load_dwordx4 v209, s[12:15], s44 offen lds
  v_mfma_f32_16x16x32_bf16 v[24:27], a[148:151], a[136:139], v[24:27]
  ds_read_b64_tr_b16 a[172:173], v199 offset:24576
  v_fmac_f32 v143, v240, v229
  v_mfma_f32_16x16x32_bf16 v[28:31], a[148:151], a[140:143], v[28:31]
  ds_read_b64_tr_b16 a[174:175], v199 offset:26624
  v_fma_f32 v135, -v241, v229, v135
  v_fmac_f32 v143, v241, v228
  v_mfma_f32_16x16x32_bf16 v[32:35], a[152:155], a[136:139], v[32:35]
  ds_read_b64_tr_b16 a[144:145], v200 offset:24576
  v_mul_f32 v250, v242, v132
  v_mfma_f32_16x16x32_bf16 v[36:39], a[152:155], a[140:143], v[36:39]
  ds_read_b64_tr_b16 a[146:147], v200 offset:26624
  s_waitcnt lgkmcnt(4)
  v_mfma_f32_16x16x32_bf16 v[40:43], a[156:159], a[136:139], v[40:43]
  ds_read_b64_tr_b16 a[148:149], v201 offset:24576
  v_fma_f32 v250, -v243, v140, v250
  v_mul_f32 v140, v242, v140
  v_mfma_f32_16x16x32_bf16 v[44:47], a[156:159], a[140:143], v[44:47]
  ds_read_b64_tr_b16 a[150:151], v201 offset:26624
  v_fmac_f32 v140, v243, v132
  v_mfma_f32_16x16x32_bf16 v[48:51], a[160:163], a[136:139], v[48:51]
  ds_read_b64_tr_b16 a[152:153], v198 offset:36864
  buffer_load_dwordx4 v210, s[12:15], s44 offen offset:1024 lds
  v_mul_f32 v132, v180, v250
  v_mfma_f32_16x16x32_bf16 v[52:55], a[160:163], a[140:143], v[52:55]
  ds_read_b64_tr_b16 a[154:155], v198 offset:38912
  v_mul_f32_e64 v140, -v180, v140
  v_mfma_f32_16x16x32_bf16 v[56:59], a[164:167], a[136:139], v[56:59]
  ds_read_b64_tr_b16 a[156:157], v199 offset:36864
  v_mul_f32 v251, v242, v133
  v_mul_u32_u24 v253, 1152, v253
  v_mfma_f32_16x16x32_bf16 v[60:63], a[164:167], a[140:143], v[60:63]
  ds_read_b64_tr_b16 a[158:159], v199 offset:38912
  v_fma_f32 v251, -v243, v141, v251
  v_mfma_f32_16x16x32_bf16 v[64:67], a[168:171], a[240:243], 0
  ds_read_b64_tr_b16 a[160:161], v200 offset:36864
  v_mul_f32 v141, v242, v141
  v_add_u32 v203, v203, v253
  v_mfma_f32_16x16x32_bf16 v[68:71], a[168:171], a[244:247], 0
  ds_read_b64_tr_b16 a[162:163], v200 offset:38912
  s_waitcnt lgkmcnt(4)
  v_mfma_f32_16x16x32_bf16 v[72:75], a[172:175], a[240:243], 0
  ds_read_b64_tr_b16 a[164:165], v201 offset:36864
  v_fmac_f32 v141, v243, v133
  v_mul_f32 v133, v181, v251
  v_mfma_f32_16x16x32_bf16 v[76:79], a[172:175], a[244:247], 0
  ds_read_b64_tr_b16 a[166:167], v201 offset:38912
  buffer_load_dwordx4 v211, s[12:15], s44 offen offset:2048 lds
  v_mfma_f32_16x16x32_bf16 v[80:83], a[144:147], a[240:243], 0
  ds_read_b64_tr_b16 a[168:169], v198 offset:28672
  v_mul_f32_e64 v141, -v181, v141
  v_mul_f32 v250, v242, v134
  v_mfma_f32_16x16x32_bf16 v[84:87], a[144:147], a[244:247], 0
  ds_read_b64_tr_b16 a[170:171], v198 offset:30720
  v_fma_f32 v250, -v243, v142, v250
  v_mfma_f32_16x16x32_bf16 v[88:91], a[148:151], a[240:243], 0
  ds_read_b64_tr_b16 a[172:173], v199 offset:28672
  v_mul_f32 v142, v242, v142
  v_max_f32 v0, 0, v0
  v_mfma_f32_16x16x32_bf16 v[92:95], a[148:151], a[244:247], 0
  ds_read_b64_tr_b16 a[174:175], v199 offset:30720
  v_fmac_f32 v142, v243, v134
  v_mfma_f32_16x16x32_bf16 v[96:99], a[152:155], a[240:243], 0
  ds_read_b64_tr_b16 a[144:145], v200 offset:28672
  v_mul_f32 v134, v182, v250
  v_mul_f32_e64 v142, -v182, v142
  v_mfma_f32_16x16x32_bf16 v[100:103], a[152:155], a[244:247], 0
  ds_read_b64_tr_b16 a[146:147], v200 offset:30720
  s_waitcnt lgkmcnt(4)
  v_mfma_f32_16x16x32_bf16 v[104:107], a[156:159], a[240:243], 0
  ds_read_b64_tr_b16 a[148:149], v201 offset:28672
  buffer_load_dwordx4 v212, s[12:15], s44 offen offset:3072 lds
  s_add_u32 m0, s46, 53248
  v_mfma_f32_16x16x32_bf16 v[108:111], a[156:159], a[244:247], 0
  ds_read_b64_tr_b16 a[150:151], v201 offset:30720
  v_mul_f32 v251, v242, v135
  v_mfma_f32_16x16x32_bf16 v[112:115], a[160:163], a[240:243], 0
  ds_read_b64_tr_b16 a[152:153], v198 offset:40960
  v_fma_f32 v251, -v243, v143, v251
  v_mul_f32 v143, v242, v143
  v_mfma_f32_16x16x32_bf16 v[116:119], a[160:163], a[244:247], 0
  ds_read_b64_tr_b16 a[154:155], v198 offset:43008
  v_fmac_f32 v143, v243, v135
  v_mfma_f32_16x16x32_bf16 v[120:123], a[164:167], a[240:243], 0
  ds_read_b64_tr_b16 a[156:157], v199 offset:40960
  v_mul_f32 v135, v183, v251
  v_mul_f32_e64 v143, -v183, v143
  v_mfma_f32_16x16x32_bf16 v[124:127], a[164:167], a[244:247], 0
  ds_read_b64_tr_b16 a[158:159], v199 offset:43008
  v_cvt_pk_bf16_f32 v132, v132, v133
  v_mfma_f32_16x16x32_bf16 v[64:67], a[168:171], a[176:179], v[64:67]
  ds_read_b64_tr_b16 a[160:161], v200 offset:40960
  v_cvt_pk_bf16_f32 v133, v134, v135
  v_cvt_pk_bf16_f32 v140, v140, v141
  v_mfma_f32_16x16x32_bf16 v[68:71], a[168:171], a[180:183], v[68:71]
  ds_read_b64_tr_b16 a[162:163], v200 offset:43008
  s_waitcnt lgkmcnt(4)
  v_mfma_f32_16x16x32_bf16 v[72:75], a[172:175], a[176:179], v[72:75]
  ds_read_b64_tr_b16 a[164:165], v201 offset:40960
  buffer_load_dwordx4 v213, s[12:15], s44 offen lds
  v_cvt_pk_bf16_f32 v141, v142, v143
  v_mfma_f32_16x16x32_bf16 v[76:79], a[172:175], a[180:183], v[76:79]
  ds_read_b64_tr_b16 a[166:167], v201 offset:43008
  ds_write_b64 v248, v[132:133] offset:1536
  v_mfma_f32_16x16x32_bf16 v[80:83], a[144:147], a[176:179], v[80:83]
  ds_read_b64_tr_b16 a[168:169], v198 offset:32768
  ds_write_b64 v248, v[140:141] offset:2048
  v_mfma_f32_16x16x32_bf16 v[84:87], a[144:147], a[180:183], v[84:87]
  ds_read_b64_tr_b16 a[170:171], v198 offset:34816
  v_mul_f32 v32, v215, v32
  v_max_f32 v1, 0, v1
  v_mfma_f32_16x16x32_bf16 v[88:91], a[148:151], a[176:179], v[88:91]
  ds_read_b64_tr_b16 a[172:173], v199 offset:32768
  v_mul_f32 v33, v215, v33
  v_mfma_f32_16x16x32_bf16 v[92:95], a[148:151], a[180:183], v[92:95]
  ds_read_b64_tr_b16 a[174:175], v199 offset:34816
  v_max_f32 v2, 0, v2
  v_mul_f32 v34, v215, v34
  v_mfma_f32_16x16x32_bf16 v[96:99], a[152:155], a[176:179], v[96:99]
  ds_read_b64_tr_b16 a[144:145], v200 offset:32768
  v_max_f32 v3, 0, v3
  v_mfma_f32_16x16x32_bf16 v[100:103], a[152:155], a[180:183], v[100:103]
  ds_read_b64_tr_b16 a[146:147], v200 offset:34816
  buffer_load_dwordx4 v214, s[12:15], s44 offen offset:1024 lds
  s_waitcnt lgkmcnt(4)
  v_mfma_f32_16x16x32_bf16 v[104:107], a[156:159], a[176:179], v[104:107]
  ds_read_b64_tr_b16 a[148:149], v201 offset:32768
  v_mul_f32 v35, v215, v35
  v_mfma_f32_16x16x32_bf16 v[108:111], a[156:159], a[180:183], v[108:111]
  ds_read_b64_tr_b16 a[150:151], v201 offset:34816
  v_mul_f32 v0, v0, v32
  v_mul_f32 v1, v1, v33
  v_mfma_f32_16x16x32_bf16 v[112:115], a[160:163], a[176:179], v[112:115]
  ds_read_b64_tr_b16 a[152:153], v198 offset:45056
  v_mul_f32 v2, v2, v34
  v_mfma_f32_16x16x32_bf16 v[116:119], a[160:163], a[180:183], v[116:119]
  ds_read_b64_tr_b16 a[154:155], v198 offset:47104
  v_mul_f32 v3, v3, v35
  v_max_f32 v8, 0, v8
  v_mfma_f32_16x16x32_bf16 v[120:123], a[164:167], a[176:179], v[120:123]
  ds_read_b64_tr_b16 a[156:157], v199 offset:45056
  v_mul_f32 v40, v215, v40
  v_mfma_f32_16x16x32_bf16 v[124:127], a[164:167], a[180:183], v[124:127]
  ds_read_b64_tr_b16 a[158:159], v199 offset:47104
  v_max_f32 v9, 0, v9
  v_mul_f32 v41, v215, v41
  v_mfma_f32_16x16x32_bf16 v[64:67], a[168:171], a[184:187], v[64:67]
  ds_read_b64_tr_b16 a[160:161], v200 offset:45056
  v_max_f32 v10, 0, v10
  v_mfma_f32_16x16x32_bf16 v[68:71], a[168:171], a[188:191], v[68:71]
  ds_read_b64_tr_b16 a[162:163], v200 offset:47104
  v_mul_f32 v42, v215, v42
  s_waitcnt lgkmcnt(4)
  v_mfma_f32_16x16x32_bf16 v[72:75], a[172:175], a[184:187], v[72:75]
  ds_read_b64_tr_b16 a[164:165], v201 offset:45056
  s_waitcnt vmcnt(20)
  v_mfma_f32_16x16x32_bf16 v[76:79], a[172:175], a[188:191], v[76:79]
  ds_read_b64_tr_b16 a[166:167], v201 offset:47104
  v_max_f32 v11, 0, v11
  s_barrier
  v_mfma_f32_16x16x32_bf16 v[80:83], a[144:147], a[184:187], v[80:83]
  ds_read_b64_tr_b16 a[168:169], v194 offset:24576
  s_add_u32 s44, s66, 553600
  v_mfma_f32_16x16x32_bf16 v[84:87], a[144:147], a[188:191], v[84:87]
  ds_read_b64_tr_b16 a[170:171], v194 offset:26624
  s_add_u32 m0, s46, 98304
  s_nop 0
  buffer_load_dwordx4 v209, s[12:15], s44 offen lds
  v_mfma_f32_16x16x32_bf16 v[88:91], a[148:151], a[184:187], v[88:91]
  ds_read_b64_tr_b16 a[172:173], v195 offset:24576
  v_mul_f32 v43, v215, v43
  v_mfma_f32_16x16x32_bf16 v[92:95], a[148:151], a[188:191], v[92:95]
  ds_read_b64_tr_b16 a[174:175], v195 offset:26624
  v_mul_f32 v8, v8, v40
  v_mul_f32 v9, v9, v41
  v_mfma_f32_16x16x32_bf16 v[96:99], a[152:155], a[184:187], v[96:99]
  ds_read_b64_tr_b16 a[144:145], v196 offset:24576
  v_mul_f32 v10, v10, v42
  v_mfma_f32_16x16x32_bf16 v[100:103], a[152:155], a[188:191], v[100:103]
  ds_read_b64_tr_b16 a[146:147], v196 offset:26624
  v_mul_f32 v11, v11, v43
  s_waitcnt lgkmcnt(4)
  v_mfma_f32_16x16x32_bf16 v[104:107], a[156:159], a[184:187], v[104:107]
  ds_read_b64_tr_b16 a[148:149], v197 offset:24576
  v_cvt_pk_bf16_f32 v32, v0, v1
  v_mfma_f32_16x16x32_bf16 v[108:111], a[156:159], a[188:191], v[108:111]
  ds_read_b64_tr_b16 a[150:151], v197 offset:26624
  v_cvt_pk_bf16_f32 v33, v2, v3
  v_cvt_pk_bf16_f32 v34, v8, v9
  v_mfma_f32_16x16x32_bf16 v[112:115], a[160:163], a[184:187], v[112:115]
  ds_read_b64_tr_b16 a[152:153], v194 offset:36864
  buffer_load_dwordx4 v210, s[12:15], s44 offen offset:1024 lds
  v_mfma_f32_16x16x32_bf16 v[116:119], a[160:163], a[188:191], v[116:119]
  ds_read_b64_tr_b16 a[154:155], v194 offset:38912
  v_cvt_pk_bf16_f32 v35, v10, v11
  v_accvgpr_write_b32 a224, v32
  v_mfma_f32_16x16x32_bf16 v[120:123], a[164:167], a[184:187], v[120:123]
  ds_read_b64_tr_b16 a[156:157], v195 offset:36864
  v_accvgpr_write_b32 a225, v33
  v_mfma_f32_16x16x32_bf16 v[124:127], a[164:167], a[188:191], v[124:127]
  ds_read_b64_tr_b16 a[158:159], v195 offset:38912
  v_accvgpr_write_b32 a226, v34
  v_accvgpr_write_b32 a227, v35
  v_mfma_f32_16x16x32_bf16 v[64:67], a[168:171], a[192:195], v[64:67]
  ds_read_b64_tr_b16 a[160:161], v196 offset:36864
  ds_read_b64_tr_b16 v[132:133], v249 offset:1536
  v_mfma_f32_16x16x32_bf16 v[68:71], a[168:171], a[196:199], v[68:71]
  ds_read_b64_tr_b16 a[162:163], v196 offset:38912
  s_add_u32 s63, s61, 12288
  buffer_store_dwordx4 v[32:35], v226, s[24:27], s63 offen sc1
  s_waitcnt lgkmcnt(5)
  v_mfma_f32_16x16x32_bf16 v[72:75], a[172:175], a[192:195], v[72:75]
  ds_read_b64_tr_b16 a[164:165], v197 offset:36864
  v_max_f32 v4, 0, v4
  v_mfma_f32_16x16x32_bf16 v[76:79], a[172:175], a[196:199], v[76:79]
  ds_read_b64_tr_b16 a[166:167], v197 offset:38912
  v_mul_f32 v36, v216, v36
  v_mfma_f32_16x16x32_bf16 v[80:83], a[144:147], a[192:195], v[80:83]
  ds_read_b64_tr_b16 a[168:169], v194 offset:28672
  v_max_f32 v5, 0, v5
  v_mul_f32 v37, v216, v37
  v_mfma_f32_16x16x32_bf16 v[84:87], a[144:147], a[196:199], v[84:87]
  ds_read_b64_tr_b16 a[170:171], v194 offset:30720
  v_max_f32 v6, 0, v6
  v_mfma_f32_16x16x32_bf16 v[88:91], a[148:151], a[192:195], v[88:91]
  ds_read_b64_tr_b16 a[172:173], v195 offset:28672
  buffer_load_dwordx4 v211, s[12:15], s44 offen offset:2048 lds
  v_mul_f32 v38, v216, v38
  v_mfma_f32_16x16x32_bf16 v[92:95], a[148:151], a[196:199], v[92:95]
  ds_read_b64_tr_b16 a[174:175], v195 offset:30720
  v_max_f32 v7, 0, v7
  v_mfma_f32_16x16x32_bf16 v[96:99], a[152:155], a[192:195], v[96:99]
  ds_read_b64_tr_b16 a[144:145], v196 offset:28672
  v_mul_f32 v39, v216, v39
  v_mul_f32 v4, v4, v36
  v_mfma_f32_16x16x32_bf16 v[100:103], a[152:155], a[196:199], v[100:103]
  ds_read_b64_tr_b16 a[146:147], v196 offset:30720
  s_waitcnt lgkmcnt(4)
  v_mfma_f32_16x16x32_bf16 v[104:107], a[156:159], a[192:195], v[104:107]
  ds_read_b64_tr_b16 a[148:149], v197 offset:28672
  v_mul_f32 v5, v5, v37
  v_mul_f32 v6, v6, v38
  v_mfma_f32_16x16x32_bf16 v[108:111], a[156:159], a[196:199], v[108:111]
  ds_read_b64_tr_b16 a[150:151], v197 offset:30720
  v_mul_f32 v7, v7, v39
  v_mfma_f32_16x16x32_bf16 v[112:115], a[160:163], a[192:195], v[112:115]
  ds_read_b64_tr_b16 a[152:153], v194 offset:40960
  v_max_f32 v12, 0, v12
  v_mul_f32 v44, v216, v44
  v_mfma_f32_16x16x32_bf16 v[116:119], a[160:163], a[196:199], v[116:119]
  ds_read_b64_tr_b16 a[154:155], v194 offset:43008
  buffer_load_dwordx4 v212, s[12:15], s44 offen offset:3072 lds
  v_mfma_f32_16x16x32_bf16 v[120:123], a[164:167], a[192:195], v[120:123]
  ds_read_b64_tr_b16 a[156:157], v195 offset:40960
  s_add_u32 m0, s46, 102400
  v_max_f32 v13, 0, v13
  v_mfma_f32_16x16x32_bf16 v[124:127], a[164:167], a[196:199], v[124:127]
  ds_read_b64_tr_b16 a[158:159], v195 offset:43008
  v_mul_f32 v45, v216, v45
  v_mfma_f32_16x16x32_bf16 v[64:67], a[168:171], a[200:203], v[64:67]
  ds_read_b64_tr_b16 a[160:161], v196 offset:40960
  v_max_f32 v14, 0, v14
  v_mul_f32 v46, v216, v46
  v_mfma_f32_16x16x32_bf16 v[68:71], a[168:171], a[204:207], v[68:71]
  ds_read_b64_tr_b16 a[162:163], v196 offset:43008
  s_waitcnt lgkmcnt(4)
  v_mfma_f32_16x16x32_bf16 v[72:75], a[172:175], a[200:203], v[72:75]
  ds_read_b64_tr_b16 a[164:165], v197 offset:40960
  v_max_f32 v15, 0, v15
  v_mul_f32 v47, v216, v47
  v_mfma_f32_16x16x32_bf16 v[76:79], a[172:175], a[204:207], v[76:79]
  ds_read_b64_tr_b16 a[166:167], v197 offset:43008
  v_mul_f32 v12, v12, v44
  v_mfma_f32_16x16x32_bf16 v[80:83], a[144:147], a[200:203], v[80:83]
  ds_read_b64_tr_b16 a[168:169], v194 offset:32768
  buffer_load_dwordx4 v213, s[12:15], s44 offen lds
  v_mfma_f32_16x16x32_bf16 v[84:87], a[144:147], a[204:207], v[84:87]
  ds_read_b64_tr_b16 a[170:171], v194 offset:34816
  v_mul_f32 v13, v13, v45
  v_mul_f32 v14, v14, v46
  v_mfma_f32_16x16x32_bf16 v[88:91], a[148:151], a[200:203], v[88:91]
  ds_read_b64_tr_b16 a[172:173], v195 offset:32768
  v_mul_f32 v15, v15, v47
  v_mfma_f32_16x16x32_bf16 v[92:95], a[148:151], a[204:207], v[92:95]
  ds_read_b64_tr_b16 a[174:175], v195 offset:34816
  v_cvt_pk_bf16_f32 v36, v4, v5
  v_cvt_pk_bf16_f32 v37, v6, v7
  v_mfma_f32_16x16x32_bf16 v[96:99], a[152:155], a[200:203], v[96:99]
  ds_read_b64_tr_b16 a[144:145], v196 offset:32768
  v_cvt_pk_bf16_f32 v38, v12, v13
  v_mfma_f32_16x16x32_bf16 v[100:103], a[152:155], a[204:207], v[100:103]
  ds_read_b64_tr_b16 a[146:147], v196 offset:34816
  v_cvt_pk_bf16_f32 v39, v14, v15
  s_waitcnt lgkmcnt(4)
  v_mfma_f32_16x16x32_bf16 v[104:107], a[156:159], a[200:203], v[104:107]
  ds_read_b64_tr_b16 a[148:149], v197 offset:32768
  v_accvgpr_write_b32 a228, v36
  v_mfma_f32_16x16x32_bf16 v[108:111], a[156:159], a[204:207], v[108:111]
  ds_read_b64_tr_b16 a[150:151], v197 offset:34816
  buffer_load_dwordx4 v214, s[12:15], s44 offen offset:1024 lds
  v_accvgpr_write_b32 a229, v37
  v_mfma_f32_16x16x32_bf16 v[112:115], a[160:163], a[200:203], v[112:115]
  ds_read_b64_tr_b16 a[152:153], v194 offset:45056
  v_accvgpr_write_b32 a230, v38
  v_mfma_f32_16x16x32_bf16 v[116:119], a[160:163], a[204:207], v[116:119]
  ds_read_b64_tr_b16 a[154:155], v194 offset:47104
  v_accvgpr_write_b32 a231, v39
  ds_read_b64_tr_b16 v[134:135], v249 offset:2048
  v_mfma_f32_16x16x32_bf16 v[120:123], a[164:167], a[200:203], v[120:123]
  ds_read_b64_tr_b16 a[156:157], v195 offset:45056
  ds_read_b128 v[234:237], v247 offset:768
  v_mfma_f32_16x16x32_bf16 v[124:127], a[164:167], a[204:207], v[124:127]
  ds_read_b64_tr_b16 a[158:159], v195 offset:47104
  ds_read_b128 v[238:241], v247 offset:784
  ds_read_b64 v[242:243], v247 offset:800
  v_mfma_f32_16x16x32_bf16 v[64:67], a[168:171], a[208:211], v[64:67]
  ds_read_b64_tr_b16 a[160:161], v196 offset:45056
  s_add_u32 s63, s61, 12288
  buffer_store_dwordx4 v[36:39], v226, s[24:27], s63 offen offset:1024 sc1
  v_mfma_f32_16x16x32_bf16 v[68:71], a[168:171], a[212:215], v[68:71]
  s_waitcnt lgkmcnt(14)
  ds_read_b64_tr_b16 a[162:163], v196 offset:47104
  v_max_f32 v16, 0, v16
  s_waitcnt lgkmcnt(8)
  v_mfma_f32_16x16x32_bf16 v[72:75], a[172:175], a[208:211], v[72:75]
  ds_read_b64_tr_b16 a[164:165], v197 offset:45056
  s_waitcnt vmcnt(21)
  v_mfma_f32_16x16x32_bf16 v[76:79], a[172:175], a[212:215], v[76:79]
  ds_read_b64_tr_b16 a[166:167], v197 offset:47104
  v_mul_f32 v48, v215, v48
  s_barrier
  v_mfma_f32_16x16x32_bf16 v[80:83], a[144:147], a[208:211], v[80:83]
  ds_read_b64_tr_b16 a[168:169], v190
  s_add_u32 s44, s66, 553856
  v_mfma_f32_16x16x32_bf16 v[84:87], a[144:147], a[212:215], v[84:87]
  ds_read_b64_tr_b16 a[170:171], v190 offset:2048
  s_add_u32 m0, s46, 122880
  s_nop 0
  buffer_load_dwordx4 v209, s[12:15], s44 offen lds
  v_mfma_f32_16x16x32_bf16 v[88:91], a[148:151], a[208:211], v[88:91]
  ds_read_b64_tr_b16 a[172:173], v191
  v_max_f32 v17, 0, v17
  v_mfma_f32_16x16x32_bf16 v[92:95], a[148:151], a[212:215], v[92:95]
  ds_read_b64_tr_b16 a[174:175], v191 offset:2048
  v_mul_f32 v49, v215, v49
  v_max_f32 v18, 0, v18
  v_mfma_f32_16x16x32_bf16 v[96:99], a[152:155], a[208:211], v[96:99]
  ds_read_b64_tr_b16 a[144:145], v192
  v_mul_f32 v50, v215, v50
  v_mfma_f32_16x16x32_bf16 v[100:103], a[152:155], a[212:215], v[100:103]
  s_waitcnt lgkmcnt(14)
  ds_read_b64_tr_b16 a[146:147], v192 offset:2048
  v_max_f32 v19, 0, v19
  s_waitcnt lgkmcnt(4)
  v_mfma_f32_16x16x32_bf16 v[104:107], a[156:159], a[208:211], v[104:107]
  ds_read_b64_tr_b16 a[148:149], v193
  v_mul_f32 v51, v215, v51
  v_mul_f32 v16, v16, v48
  v_mfma_f32_16x16x32_bf16 v[108:111], a[156:159], a[212:215], v[108:111]
  ds_read_b64_tr_b16 a[150:151], v193 offset:2048
  v_mul_f32 v17, v17, v49
  v_mfma_f32_16x16x32_bf16 v[112:115], a[160:163], a[208:211], v[112:115]
  ds_read_b64_tr_b16 a[152:153], v190 offset:4096
  buffer_load_dwordx4 v210, s[12:15], s44 offen offset:1024 lds
  v_mul_f32 v18, v18, v50
  v_mfma_f32_16x16x32_bf16 v[116:119], a[160:163], a[212:215], v[116:119]
  ds_read_b64_tr_b16 a[154:155], v190 offset:6144
  v_mul_f32 v19, v19, v51
  v_mfma_f32_16x16x32_bf16 v[120:123], a[164:167], a[208:211], v[120:123]
  ds_read_b64_tr_b16 a[156:157], v191 offset:4096
  v_max_f32 v24, 0, v24
  v_mul_f32 v56, v215, v56
  v_mfma_f32_16x16x32_bf16 v[124:127], a[164:167], a[212:215], v[124:127]
  ds_read_b64_tr_b16 a[158:159], v191 offset:6144
  v_max_f32 v25, 0, v25
  v_mfma_f32_16x16x32_bf16 a[96:99], a[168:171], a[240:243], 0
  ds_read_b64_tr_b16 a[160:161], v192 offset:4096
  v_mul_f32 v57, v215, v57
  v_max_f32 v26, 0, v26
  v_mfma_f32_16x16x32_bf16 a[100:103], a[168:171], a[244:247], 0
  ds_read_b64_tr_b16 a[162:163], v192 offset:6144
  s_waitcnt lgkmcnt(4)
  v_mfma_f32_16x16x32_bf16 a[104:107], a[172:175], a[240:243], 0
  ds_read_b64_tr_b16 a[164:165], v193 offset:4096
  buffer_load_dword v202, v188, s[24:27], 0 offen sc1
  v_mul_f32 v58, v215, v58
  v_mfma_f32_16x16x32_bf16 a[108:111], a[172:175], a[244:247], 0
  ds_read_b64_tr_b16 a[166:167], v193 offset:6144
  v_max_f32 v27, 0, v27
  v_mfma_f32_16x16x32_bf16 a[112:115], a[144:147], a[240:243], 0
  ds_read_b64_tr_b16 a[168:169], v190 offset:8192
  v_mul_f32 v59, v215, v59
  v_mul_f32 v24, v24, v56
  v_mfma_f32_16x16x32_bf16 a[116:119], a[144:147], a[244:247], 0
  ds_read_b64_tr_b16 a[170:171], v190 offset:10240
  v_mul_f32 v25, v25, v57
  v_mfma_f32_16x16x32_bf16 a[120:123], a[148:151], a[240:243], 0
  ds_read_b64_tr_b16 a[172:173], v191 offset:8192
  v_mul_f32 v26, v26, v58
  v_mul_f32 v27, v27, v59
  v_mfma_f32_16x16x32_bf16 a[124:127], a[148:151], a[244:247], 0
  ds_read_b64_tr_b16 a[174:175], v191 offset:10240
  buffer_load_dwordx4 v211, s[12:15], s44 offen offset:2048 lds
  v_mfma_f32_16x16x32_bf16 a[96:99], a[152:155], a[176:179], a[96:99]
  ds_read_b64_tr_b16 a[144:145], v192 offset:8192
  v_cvt_pk_bf16_f32 v48, v16, v17
  v_cvt_pk_bf16_f32 v49, v18, v19
  v_mfma_f32_16x16x32_bf16 a[100:103], a[152:155], a[180:183], a[100:103]
  ds_read_b64_tr_b16 a[146:147], v192 offset:10240
  s_waitcnt lgkmcnt(4)
  v_mfma_f32_16x16x32_bf16 a[104:107], a[156:159], a[176:179], a[104:107]
  ds_read_b64_tr_b16 a[148:149], v193 offset:8192
  v_cvt_pk_bf16_f32 v50, v24, v25
  v_cvt_pk_bf16_f32 v51, v26, v27
  v_mfma_f32_16x16x32_bf16 a[108:111], a[156:159], a[180:183], a[108:111]
  ds_read_b64_tr_b16 a[150:151], v193 offset:10240
  v_accvgpr_write_b32 a232, v48
  v_mfma_f32_16x16x32_bf16 a[112:115], a[160:163], a[176:179], a[112:115]
  ds_read_b64_tr_b16 a[152:153], v190 offset:12288
  v_accvgpr_write_b32 a233, v49
  v_accvgpr_write_b32 a234, v50
  v_mfma_f32_16x16x32_bf16 a[116:119], a[160:163], a[180:183], a[116:119]
  ds_read_b64_tr_b16 a[154:155], v190 offset:14336
  v_accvgpr_write_b32 a235, v51
  v_mfma_f32_16x16x32_bf16 a[120:123], a[164:167], a[176:179], a[120:123]
  ds_read_b64_tr_b16 a[156:157], v191 offset:12288
  buffer_load_dwordx4 v212, s[12:15], s44 offen offset:3072 lds
  s_add_u32 m0, s46, 126976
  v_mfma_f32_16x16x32_bf16 a[124:127], a[164:167], a[180:183], a[124:127]
  ds_read_b64_tr_b16 a[158:159], v191 offset:14336
  v_fmac_f32 v148, v234, v230
  v_mfma_f32_16x16x32_bf16 a[96:99], a[168:171], a[184:187], a[96:99]
  ds_read_b64_tr_b16 a[160:161], v192 offset:12288
  v_fmac_f32 v156, v234, v231
  v_fma_f32 v148, -v235, v231, v148
  v_mfma_f32_16x16x32_bf16 a[100:103], a[168:171], a[188:191], a[100:103]
  ds_read_b64_tr_b16 a[162:163], v192 offset:14336
  v_fmac_f32 v156, v235, v230
  s_waitcnt lgkmcnt(4)
  v_mfma_f32_16x16x32_bf16 a[104:107], a[172:175], a[184:187], a[104:107]
  ds_read_b64_tr_b16 a[164:165], v193 offset:12288
  v_fmac_f32 v149, v236, v230
  v_mfma_f32_16x16x32_bf16 a[108:111], a[172:175], a[188:191], a[108:111]
  ds_read_b64_tr_b16 a[166:167], v193 offset:14336
  s_add_u32 s63, s61, 12288
  buffer_store_dwordx4 v[48:51], v226, s[24:27], s63 offen offset:2048 sc1
  v_mfma_f32_16x16x32_bf16 a[112:115], a[144:147], a[184:187], a[112:115]
  ds_read_b64_tr_b16 a[168:169], v190 offset:16384
  v_max_f32 v20, 0, v20
  v_mul_f32 v52, v216, v52
  v_mfma_f32_16x16x32_bf16 a[116:119], a[144:147], a[188:191], a[116:119]
  ds_read_b64_tr_b16 a[170:171], v190 offset:18432
  v_max_f32 v21, 0, v21
  v_mfma_f32_16x16x32_bf16 a[120:123], a[148:151], a[184:187], a[120:123]
  ds_read_b64_tr_b16 a[172:173], v191 offset:16384
  v_mul_f32 v53, v216, v53
  v_max_f32 v22, 0, v22
  v_mfma_f32_16x16x32_bf16 a[124:127], a[148:151], a[188:191], a[124:127]
  ds_read_b64_tr_b16 a[174:175], v191 offset:18432
  v_mul_f32 v54, v216, v54
  v_max_f32 v23, 0, v23
  v_mfma_f32_16x16x32_bf16 a[96:99], a[152:155], a[192:195], a[96:99]
  ds_read_b64_tr_b16 a[144:145], v192 offset:16384
  buffer_load_dwordx4 v213, s[12:15], s44 offen lds
  v_mul_f32 v55, v216, v55
  v_mfma_f32_16x16x32_bf16 a[100:103], a[152:155], a[196:199], a[100:103]
  ds_read_b64_tr_b16 a[146:147], v192 offset:18432
  s_waitcnt lgkmcnt(4)
  v_mfma_f32_16x16x32_bf16 a[104:107], a[156:159], a[192:195], a[104:107]
  ds_read_b64_tr_b16 a[148:149], v193 offset:16384
  v_mul_f32 v20, v20, v52
  v_mul_f32 v21, v21, v53
  v_mfma_f32_16x16x32_bf16 a[108:111], a[156:159], a[196:199], a[108:111]
  ds_read_b64_tr_b16 a[150:151], v193 offset:18432
  v_mul_f32 v22, v22, v54
  v_mul_f32 v23, v23, v55
  v_mfma_f32_16x16x32_bf16 a[112:115], a[160:163], a[192:195], a[112:115]
  ds_read_b64_tr_b16 a[152:153], v190 offset:20480
  v_max_f32 v28, 0, v28
  v_mfma_f32_16x16x32_bf16 a[116:119], a[160:163], a[196:199], a[116:119]
  ds_read_b64_tr_b16 a[154:155], v190 offset:22528
  v_mul_f32 v60, v216, v60
  v_max_f32 v29, 0, v29
  v_mfma_f32_16x16x32_bf16 a[120:123], a[164:167], a[192:195], a[120:123]
  ds_read_b64_tr_b16 a[156:157], v191 offset:20480
  v_mul_f32 v61, v216, v61
  v_max_f32 v30, 0, v30
  v_mfma_f32_16x16x32_bf16 a[124:127], a[164:167], a[196:199], a[124:127]
  ds_read_b64_tr_b16 a[158:159], v191 offset:22528
  buffer_load_dwordx4 v214, s[12:15], s44 offen offset:1024 lds
  v_mfma_f32_16x16x32_bf16 a[96:99], a[168:171], a[200:203], a[96:99]
  ds_read_b64_tr_b16 a[160:161], v192 offset:20480
  v_mul_f32 v62, v216, v62
  v_max_f32 v31, 0, v31
  v_mfma_f32_16x16x32_bf16 a[100:103], a[168:171], a[204:207], a[100:103]
  ds_read_b64_tr_b16 a[162:163], v192 offset:22528
  v_mul_f32 v63, v216, v63
  s_waitcnt lgkmcnt(4)
  v_mfma_f32_16x16x32_bf16 a[104:107], a[172:175], a[200:203], a[104:107]
  ds_read_b64_tr_b16 a[164:165], v193 offset:20480
  v_mul_f32 v28, v28, v60
  s_waitcnt vmcnt(22)
  v_mfma_f32_16x16x32_bf16 a[108:111], a[172:175], a[204:207], a[108:111]
  ds_read_b64_tr_b16 a[166:167], v193 offset:22528
  s_barrier
  v_mfma_f32_16x16x32_bf16 a[112:115], a[144:147], a[200:203], a[112:115]
  ds_read_b64_tr_b16 a[168:169], v190 offset:24576
  v_mul_f32 v29, v29, v61
  v_mul_f32 v30, v30, v62
  v_mfma_f32_16x16x32_bf16 a[116:119], a[144:147], a[204:207], a[116:119]
  ds_read_b64_tr_b16 a[170:171], v190 offset:26624
  v_mul_f32 v31, v31, v63
  v_cvt_pk_bf16_f32 v52, v20, v21
  v_mfma_f32_16x16x32_bf16 a[120:123], a[148:151], a[200:203], a[120:123]
  ds_read_b64_tr_b16 a[172:173], v191 offset:24576
  v_cvt_pk_bf16_f32 v53, v22, v23
  v_mfma_f32_16x16x32_bf16 a[124:127], a[148:151], a[204:207], a[124:127]
  ds_read_b64_tr_b16 a[174:175], v191 offset:26624
  v_cvt_pk_bf16_f32 v54, v28, v29
  v_cvt_pk_bf16_f32 v55, v30, v31
  v_mfma_f32_16x16x32_bf16 a[96:99], a[152:155], a[208:211], a[96:99]
  ds_read_b64_tr_b16 a[144:145], v192 offset:24576
  v_accvgpr_write_b32 a236, v52
  v_accvgpr_write_b32 a237, v53
  v_mfma_f32_16x16x32_bf16 a[100:103], a[152:155], a[212:215], a[100:103]
  ds_read_b64_tr_b16 a[146:147], v192 offset:26624
  v_accvgpr_write_b32 a238, v54
  s_waitcnt lgkmcnt(4)
  v_mfma_f32_16x16x32_bf16 a[104:107], a[156:159], a[208:211], a[104:107]
  ds_read_b64_tr_b16 a[148:149], v193 offset:24576
  v_accvgpr_write_b32 a239, v55
  v_mfma_f32_16x16x32_bf16 a[108:111], a[156:159], a[212:215], a[108:111]
  ds_read_b64_tr_b16 a[150:151], v193 offset:26624
  s_add_u32 s63, s61, 12288
  buffer_store_dwordx4 v[52:55], v226, s[24:27], s63 offen offset:3072 sc1
  v_mfma_f32_16x16x32_bf16 a[112:115], a[160:163], a[208:211], a[112:115]
  ds_read_b64_tr_b16 a[152:153], v190 offset:36864
  v_fmac_f32 v157, v236, v231
  v_mfma_f32_16x16x32_bf16 a[116:119], a[160:163], a[212:215], a[116:119]
  ds_read_b64_tr_b16 a[154:155], v190 offset:38912
  v_fma_f32 v149, -v237, v231, v149
  v_fmac_f32 v157, v237, v230
  v_mfma_f32_16x16x32_bf16 a[120:123], a[164:167], a[208:211], a[120:123]
  ds_read_b64_tr_b16 a[156:157], v191 offset:36864
  v_fmac_f32 v150, v238, v230
  v_mfma_f32_16x16x32_bf16 a[124:127], a[164:167], a[212:215], a[124:127]
  ds_read_b64_tr_b16 a[158:159], v191 offset:38912
  v_fmac_f32 v158, v238, v231
  v_mfma_f32_16x16x32_bf16 v[0:3], a[168:171], a[240:243], 0
  ds_read_b64_tr_b16 a[160:161], v192 offset:36864
  v_fma_f32 v150, -v239, v231, v150
  v_mfma_f32_16x16x32_bf16 v[4:7], a[168:171], a[244:247], 0
  ds_read_b64_tr_b16 a[162:163], v192 offset:38912
  v_fmac_f32 v158, v239, v230
  s_waitcnt lgkmcnt(4)
  v_mfma_f32_16x16x32_bf16 v[8:11], a[172:175], a[240:243], 0
  ds_read_b64_tr_b16 a[164:165], v193 offset:36864
  v_fmac_f32 v151, v240, v230
  v_mfma_f32_16x16x32_bf16 v[12:15], a[172:175], a[244:247], 0
  ds_read_b64_tr_b16 a[166:167], v193 offset:38912
  v_fmac_f32 v159, v240, v231
  v_mfma_f32_16x16x32_bf16 v[16:19], a[144:147], a[240:243], 0
  ds_read_b64_tr_b16 a[168:169], v190 offset:28672
  v_fma_f32 v151, -v241, v231, v151
  v_mfma_f32_16x16x32_bf16 v[20:23], a[144:147], a[244:247], 0
  ds_read_b64_tr_b16 a[170:171], v190 offset:30720
  s_add_u32 s44, s68, 512
  s_add_u32 m0, s47, 73728
  v_mfma_f32_16x16x32_bf16 v[24:27], a[148:151], a[240:243], 0
  ds_read_b64_tr_b16 a[172:173], v191 offset:28672
  buffer_load_dwordx4 v209, s[12:15], s44 offen lds
  v_mfma_f32_16x16x32_bf16 v[28:31], a[148:151], a[244:247], 0
  ds_read_b64_tr_b16 a[174:175], v191 offset:30720
  v_fmac_f32 v159, v241, v230
  v_mfma_f32_16x16x32_bf16 v[32:35], a[152:155], a[240:243], 0
  ds_read_b64_tr_b16 a[144:145], v192 offset:28672
  v_mul_f32 v250, v242, v148
  v_mfma_f32_16x16x32_bf16 v[36:39], a[152:155], a[244:247], 0
  ds_read_b64_tr_b16 a[146:147], v192 offset:30720
  v_fma_f32 v250, -v243, v156, v250
  s_waitcnt lgkmcnt(4)
  v_mfma_f32_16x16x32_bf16 v[40:43], a[156:159], a[240:243], 0
  ds_read_b64_tr_b16 a[148:149], v193 offset:28672
  v_add_u32 v252, 64, v225
  v_mfma_f32_16x16x32_bf16 v[44:47], a[156:159], a[244:247], 0
  ds_read_b64_tr_b16 a[150:151], v193 offset:30720
  v_mul_u32_u24 v253, 10923, v252
  v_mfma_f32_16x16x32_bf16 v[48:51], a[160:163], a[240:243], 0
  ds_read_b64_tr_b16 a[152:153], v190 offset:40960
  v_lshrrev_b32 v253, 16, v253
  v_mfma_f32_16x16x32_bf16 v[52:55], a[160:163], a[244:247], 0
  ds_read_b64_tr_b16 a[154:155], v190 offset:43008
  buffer_load_dwordx4 v210, s[12:15], s44 offen offset:1024 lds
  v_mul_u32_u24 v204, 6, v253
  v_mfma_f32_16x16x32_bf16 v[56:59], a[164:167], a[240:243], 0
  ds_read_b64_tr_b16 a[156:157], v191 offset:40960
  v_sub_u32 v204, v252, v204
  v_mfma_f32_16x16x32_bf16 v[60:63], a[164:167], a[244:247], 0
  ds_read_b64_tr_b16 a[158:159], v191 offset:43008
  v_bfe_u32 v252, v253, 3, 1
  v_mfma_f32_16x16x32_bf16 v[0:3], a[168:171], a[176:179], v[0:3]
  ds_read_b64_tr_b16 a[160:161], v192 offset:40960
  v_xor_b32 v204, v204, v252
  v_mfma_f32_16x16x32_bf16 v[4:7], a[168:171], a[180:183], v[4:7]
  ds_read_b64_tr_b16 a[162:163], v192 offset:43008
  v_lshlrev_b32 v204, 4, v204
  s_waitcnt lgkmcnt(4)
  v_mfma_f32_16x16x32_bf16 v[8:11], a[172:175], a[176:179], v[8:11]
  ds_read_b64_tr_b16 a[164:165], v193 offset:40960
  v_mul_u32_u24 v253, 1152, v253
  v_mfma_f32_16x16x32_bf16 v[12:15], a[172:175], a[180:183], v[12:15]
  ds_read_b64_tr_b16 a[166:167], v193 offset:43008
  v_add_u32 v204, v204, v253
  v_mfma_f32_16x16x32_bf16 v[16:19], a[144:147], a[176:179], v[16:19]
  ds_read_b64_tr_b16 a[168:169], v190 offset:32768
  buffer_load_dwordx4 v211, s[12:15], s44 offen offset:2048 lds
  v_mfma_f32_16x16x32_bf16 v[20:23], a[144:147], a[180:183], v[20:23]
  ds_read_b64_tr_b16 a[170:171], v190 offset:34816
  v_subrev_u32 v204, 1024, v204
  v_add_u32 v252, 128, v225
  v_mfma_f32_16x16x32_bf16 v[24:27], a[148:151], a[176:179], v[24:27]
  ds_read_b64_tr_b16 a[172:173], v191 offset:32768
  v_mul_u32_u24 v253, 10923, v252
  v_mfma_f32_16x16x32_bf16 v[28:31], a[148:151], a[180:183], v[28:31]
  ds_read_b64_tr_b16 a[174:175], v191 offset:34816
  v_lshrrev_b32 v253, 16, v253
  v_mfma_f32_16x16x32_bf16 v[32:35], a[152:155], a[176:179], v[32:35]
  ds_read_b64_tr_b16 a[144:145], v192 offset:32768
  v_mul_u32_u24 v205, 6, v253
  v_mfma_f32_16x16x32_bf16 v[36:39], a[152:155], a[180:183], v[36:39]
  ds_read_b64_tr_b16 a[146:147], v192 offset:34816
  v_sub_u32 v205, v252, v205
  s_waitcnt lgkmcnt(4)
  v_mfma_f32_16x16x32_bf16 v[40:43], a[156:159], a[176:179], v[40:43]
  ds_read_b64_tr_b16 a[148:149], v193 offset:32768
  v_bfe_u32 v252, v253, 3, 1
  v_mfma_f32_16x16x32_bf16 v[44:47], a[156:159], a[180:183], v[44:47]
  ds_read_b64_tr_b16 a[150:151], v193 offset:34816
  v_xor_b32 v205, v205, v252
  v_mfma_f32_16x16x32_bf16 v[48:51], a[160:163], a[176:179], v[48:51]
  ds_read_b64_tr_b16 a[152:153], v190 offset:45056
  v_lshlrev_b32 v205, 4, v205
  v_mfma_f32_16x16x32_bf16 v[52:55], a[160:163], a[180:183], v[52:55]
  ds_read_b64_tr_b16 a[154:155], v190 offset:47104
  v_mul_u32_u24 v253, 1152, v253
  v_mul_f32 v156, v242, v156
  v_mfma_f32_16x16x32_bf16 v[56:59], a[164:167], a[176:179], v[56:59]
  ds_read_b64_tr_b16 a[156:157], v191 offset:45056
  v_add_u32 v205, v205, v253
  v_mfma_f32_16x16x32_bf16 v[60:63], a[164:167], a[180:183], v[60:63]
  ds_read_b64_tr_b16 a[158:159], v191 offset:47104
  v_subrev_u32 v205, 2048, v205
  v_mfma_f32_16x16x32_bf16 v[0:3], a[168:171], a[184:187], v[0:3]
  ds_read_b64_tr_b16 a[160:161], v192 offset:45056
  v_add_u32 v206, 33792, v203
  v_add_u32 v207, 37888, v204
  v_mfma_f32_16x16x32_bf16 v[4:7], a[168:171], a[188:191], v[4:7]
  ds_read_b64_tr_b16 a[162:163], v192 offset:47104
  s_waitcnt lgkmcnt(4)
  v_mfma_f32_16x16x32_bf16 v[8:11], a[172:175], a[184:187], v[8:11]
  ds_read_b64_tr_b16 a[164:165], v193 offset:45056
  v_add_u32 v208, 37888, v205
  s_waitcnt vmcnt(20)
  v_mfma_f32_16x16x32_bf16 v[12:15], a[172:175], a[188:191], v[12:15]
  ds_read_b64_tr_b16 a[166:167], v193 offset:47104
  s_barrier
  v_mfma_f32_16x16x32_bf16 v[16:19], a[144:147], a[184:187], v[16:19]
  ds_read_b64_tr_b16 a[168:169], v194
  v_fmac_f32 v156, v243, v148
  v_mfma_f32_16x16x32_bf16 v[20:23], a[144:147], a[188:191], v[20:23]
  ds_read_b64_tr_b16 a[170:171], v194 offset:2048
  v_mul_f32 v148, v180, v250
  v_mfma_f32_16x16x32_bf16 v[24:27], a[148:151], a[184:187], v[24:27]
  ds_read_b64_tr_b16 a[172:173], v195
  v_mul_f32_e64 v156, -v180, v156
  v_mfma_f32_16x16x32_bf16 v[28:31], a[148:151], a[188:191], v[28:31]
  ds_read_b64_tr_b16 a[174:175], v195 offset:2048
  v_mul_f32 v251, v242, v149
  v_mfma_f32_16x16x32_bf16 v[32:35], a[152:155], a[184:187], v[32:35]
  ds_read_b64_tr_b16 a[144:145], v196
  v_fma_f32 v251, -v243, v157, v251
  v_mul_f32 v157, v242, v157
  v_mfma_f32_16x16x32_bf16 v[36:39], a[152:155], a[188:191], v[36:39]
  ds_read_b64_tr_b16 a[146:147], v196 offset:2048
  s_waitcnt lgkmcnt(4)
  v_mfma_f32_16x16x32_bf16 v[40:43], a[156:159], a[184:187], v[40:43]
  ds_read_b64_tr_b16 a[148:149], v197
  v_fmac_f32 v157, v243, v149
  v_mfma_f32_16x16x32_bf16 v[44:47], a[156:159], a[188:191], v[44:47]
  ds_read_b64_tr_b16 a[150:151], v197 offset:2048
  v_mul_f32 v149, v181, v251
  v_mfma_f32_16x16x32_bf16 v[48:51], a[160:163], a[184:187], v[48:51]
  ds_read_b64_tr_b16 a[152:153], v194 offset:12288
  v_mul_f32_e64 v157, -v181, v157
  v_mfma_f32_16x16x32_bf16 v[52:55], a[160:163], a[188:191], v[52:55]
  ds_read_b64_tr_b16 a[154:155], v194 offset:14336
  s_waitcnt vmcnt(9)
  v_cmp_le_u32 vcc, 2, v202
  s_nop 3
  s_cmp_eq_u64 vcc, -1
  s_cbranch_scc0 L_slow_A1
L_back_A1:
  v_mfma_f32_16x16x32_bf16 v[56:59], a[164:167], a[184:187], v[56:59]
  ds_read_b64_tr_b16 a[156:157], v195 offset:12288
  v_mul_f32 v250, v242, v150
  s_add_u32 s44, s52, 368640
  v_mfma_f32_16x16x32_bf16 v[60:63], a[164:167], a[188:191], v[60:63]
  ds_read_b64_tr_b16 a[158:159], v195 offset:14336
  v_fma_f32 v250, -v243, v158, v250
  v_mfma_f32_16x16x32_bf16 v[0:3], a[168:171], a[192:195], v[0:3]
  ds_read_b64_tr_b16 a[160:161], v196 offset:12288
  v_mul_f32 v158, v242, v158
  v_mfma_f32_16x16x32_bf16 v[4:7], a[168:171], a[196:199], v[4:7]
  ds_read_b64_tr_b16 a[162:163], v196 offset:14336
  s_waitcnt lgkmcnt(4)
  v_mfma_f32_16x16x32_bf16 v[8:11], a[172:175], a[192:195], v[8:11]
  ds_read_b64_tr_b16 a[164:165], v197 offset:12288
  v_fmac_f32 v158, v243, v150
  v_mfma_f32_16x16x32_bf16 v[12:15], a[172:175], a[196:199], v[12:15]
  ds_read_b64_tr_b16 a[166:167], v197 offset:14336
  v_mul_f32 v150, v182, v250
  v_mfma_f32_16x16x32_bf16 v[16:19], a[144:147], a[192:195], v[16:19]
  ds_read_b64_tr_b16 a[168:169], v194 offset:4096
  v_mul_f32_e64 v158, -v182, v158
  v_mfma_f32_16x16x32_bf16 v[20:23], a[144:147], a[196:199], v[20:23]
  ds_read_b64_tr_b16 a[170:171], v194 offset:6144
  v_mul_f32 v251, v242, v151
  v_mfma_f32_16x16x32_bf16 v[24:27], a[148:151], a[192:195], v[24:27]
  ds_read_b64_tr_b16 a[172:173], v195 offset:4096
  v_fma_f32 v251, -v243, v159, v251
  v_mul_f32 v159, v242, v159
  v_mfma_f32_16x16x32_bf16 v[28:31], a[148:151], a[196:199], v[28:31]
  ds_read_b64_tr_b16 a[174:175], v195 offset:6144
  v_fmac_f32 v159, v243, v151
  v_mfma_f32_16x16x32_bf16 v[32:35], a[152:155], a[192:195], v[32:35]
  ds_read_b64_tr_b16 a[144:145], v196 offset:4096
  v_mul_f32 v151, v183, v251
  v_mfma_f32_16x16x32_bf16 v[36:39], a[152:155], a[196:199], v[36:39]
  ds_read_b64_tr_b16 a[146:147], v196 offset:6144
  s_waitcnt lgkmcnt(4)
  v_mfma_f32_16x16x32_bf16 v[40:43], a[156:159], a[192:195], v[40:43]
  ds_read_b64_tr_b16 a[148:149], v197 offset:4096
  v_mul_f32_e64 v159, -v183, v159
  v_mfma_f32_16x16x32_bf16 v[44:47], a[156:159], a[196:199], v[44:47]
  ds_read_b64_tr_b16 a[150:151], v197 offset:6144
  v_cvt_pk_bf16_f32 v148, v148, v149
  v_mfma_f32_16x16x32_bf16 v[48:51], a[160:163], a[192:195], v[48:51]
  ds_read_b64_tr_b16 a[152:153], v194 offset:16384
  v_cvt_pk_bf16_f32 v149, v150, v151
  v_mfma_f32_16x16x32_bf16 v[52:55], a[160:163], a[196:199], v[52:55]
  ds_read_b64_tr_b16 a[154:155], v194 offset:18432
  v_cvt_pk_bf16_f32 v156, v156, v157
  v_cvt_pk_bf16_f32 v157, v158, v159
  v_mfma_f32_16x16x32_bf16 v[56:59], a[164:167], a[192:195], v[56:59]
  ds_read_b64_tr_b16 a[156:157], v195 offset:16384
  ds_write_b64 v248, v[148:149] offset:1536
  v_mfma_f32_16x16x32_bf16 v[60:63], a[164:167], a[196:199], v[60:63]
  ds_read_b64_tr_b16 a[158:159], v195 offset:18432
  s_add_u32 m0, s46, 0
  v_mfma_f32_16x16x32_bf16 v[0:3], a[168:171], a[200:203], v[0:3]
  ds_read_b64_tr_b16 a[160:161], v196 offset:16384
  buffer_load_dwordx4 v203, s[20:23], s44 offen lds
  v_mfma_f32_16x16x32_bf16 v[4:7], a[168:171], a[204:207], v[4:7]
  ds_read_b64_tr_b16 a[162:163], v196 offset:18432
  s_waitcnt lgkmcnt(5)
  v_mfma_f32_16x16x32_bf16 v[8:11], a[172:175], a[200:203], v[8:11]
  ds_read_b64_tr_b16 a[164:165], v197 offset:16384
  ds_write_b64 v248, v[156:157] offset:2048
  v_mfma_f32_16x16x32_bf16 v[12:15], a[172:175], a[204:207], v[12:15]
  ds_read_b64_tr_b16 a[166:167], v197 offset:18432
  ds_read_b64_tr_b16 v[148:149], v249 offset:1536
  v_mfma_f32_16x16x32_bf16 v[16:19], a[144:147], a[200:203], v[16:19]
  ds_read_b64_tr_b16 a[168:169], v194 offset:8192
  ds_read_b64_tr_b16 v[150:151], v249 offset:2048
  ds_read_b128 v[234:237], v247 offset:1536
  v_mfma_f32_16x16x32_bf16 v[20:23], a[144:147], a[204:207], v[20:23]
  ds_read_b64_tr_b16 a[170:171], v194 offset:10240
  ds_read_b128 v[238:241], v247 offset:1552
  v_mfma_f32_16x16x32_bf16 v[24:27], a[148:151], a[200:203], v[24:27]
  ds_read_b64_tr_b16 a[172:173], v195 offset:8192
  s_waitcnt lgkmcnt(14)
  ds_read_b64 v[242:243], v247 offset:1568
  v_mfma_f32_16x16x32_bf16 v[28:31], a[148:151], a[204:207], v[28:31]
  s_waitcnt lgkmcnt(14)
  ds_read_b64_tr_b16 a[174:175], v195 offset:10240
  buffer_load_dwordx4 v204, s[20:23], s44 offen offset:1024 lds
  v_mfma_f32_16x16x32_bf16 v[32:35], a[152:155], a[200:203], v[32:35]
  s_waitcnt lgkmcnt(14)
  ds_read_b64_tr_b16 a[144:145], v196 offset:8192
  v_mfma_f32_16x16x32_bf16 v[36:39], a[152:155], a[204:207], v[36:39]
  s_waitcnt lgkmcnt(14)
  ds_read_b64_tr_b16 a[146:147], v196 offset:10240
  s_waitcnt lgkmcnt(6)
  v_mfma_f32_16x16x32_bf16 v[40:43], a[156:159], a[200:203], v[40:43]
  ds_read_b64_tr_b16 a[148:149], v197 offset:8192
  v_mfma_f32_16x16x32_bf16 v[44:47], a[156:159], a[204:207], v[44:47]
  ds_read_b64_tr_b16 a[150:151], v197 offset:10240
  v_mfma_f32_16x16x32_bf16 v[48:51], a[160:163], a[200:203], v[48:51]
  ds_read_b64_tr_b16 a[152:153], v194 offset:20480
  v_fmac_f32 v164, v234, v232
  v_mfma_f32_16x16x32_bf16 v[52:55], a[160:163], a[204:207], v[52:55]
  ds_read_b64_tr_b16 a[154:155], v194 offset:22528
  v_fmac_f32 v172, v234, v233
  v_mfma_f32_16x16x32_bf16 v[56:59], a[164:167], a[200:203], v[56:59]
  ds_read_b64_tr_b16 a[156:157], v195 offset:20480
  buffer_load_dwordx4 v205, s[20:23], s44 offen offset:2048 lds
  v_fma_f32 v164, -v235, v233, v164
  v_fmac_f32 v172, v235, v232
  v_mfma_f32_16x16x32_bf16 v[60:63], a[164:167], a[204:207], v[60:63]
  ds_read_b64_tr_b16 a[158:159], v195 offset:22528
  v_fmac_f32 v165, v236, v232
  v_fmac_f32 v173, v236, v233
  v_fma_f32 v165, -v237, v233, v165
  v_fmac_f32 v173, v237, v232
  buffer_load_dwordx4 v206, s[20:23], s44 offen offset:3072 lds
  s_add_u32 m0, s46, 4096
  s_nop 0
  buffer_load_dwordx4 v207, s[20:23], s44 offen lds
  buffer_load_dwordx4 v208, s[20:23], s44 offen offset:1024 lds
  v_mfma_f32_16x16x32_bf16 v[0:3], a[168:171], a[208:211], v[0:3]
  ds_read_b64_tr_b16 a[160:161], v196 offset:20480
  s_waitcnt lgkmcnt(12)
  v_fmac_f32 v166, v238, v232
  v_mfma_f32_16x16x32_bf16 v[4:7], a[168:171], a[212:215], v[4:7]
  ds_read_b64_tr_b16 a[162:163], v196 offset:22528
  s_waitcnt lgkmcnt(4)
  v_mfma_f32_16x16x32_bf16 v[8:11], a[172:175], a[208:211], v[8:11]
  ds_read_b64_tr_b16 a[164:165], v197 offset:20480
  v_mfma_f32_16x16x32_bf16 v[12:15], a[172:175], a[212:215], v[12:15]
  ds_read_b64_tr_b16 a[166:167], v197 offset:22528
  s_barrier
  v_mfma_f32_16x16x32_bf16 v[16:19], a[144:147], a[208:211], v[16:19]
  ds_read_b64_tr_b16 a[168:169], v198
  v_fmac_f32 v174, v238, v233
  v_mfma_f32_16x16x32_bf16 v[20:23], a[144:147], a[212:215], v[20:23]
  ds_read_b64_tr_b16 a[170:171], v198 offset:2048
  v_fma_f32 v166, -v239, v233, v166
  v_mfma_f32_16x16x32_bf16 v[24:27], a[148:151], a[208:211], v[24:27]
  ds_read_b64_tr_b16 a[172:173], v199
  v_fmac_f32 v174, v239, v232
  v_mfma_f32_16x16x32_bf16 v[28:31], a[148:151], a[212:215], v[28:31]
  ds_read_b64_tr_b16 a[174:175], v199 offset:2048
  v_fmac_f32 v167, v240, v232
  v_mfma_f32_16x16x32_bf16 v[32:35], a[152:155], a[208:211], v[32:35]
  ds_read_b64_tr_b16 a[144:145], v200
  v_fmac_f32 v175, v240, v233
  v_fma_f32 v167, -v241, v233, v167
  v_mfma_f32_16x16x32_bf16 v[36:39], a[152:155], a[212:215], v[36:39]
  ds_read_b64_tr_b16 a[146:147], v200 offset:2048
  s_waitcnt lgkmcnt(4)
  v_mfma_f32_16x16x32_bf16 v[40:43], a[156:159], a[208:211], v[40:43]
  ds_read_b64_tr_b16 a[148:149], v201
  v_fmac_f32 v175, v241, v232
  v_mfma_f32_16x16x32_bf16 v[44:47], a[156:159], a[212:215], v[44:47]
  ds_read_b64_tr_b16 a[150:151], v201 offset:2048
  v_mul_f32 v250, v242, v164
  v_mfma_f32_16x16x32_bf16 v[48:51], a[160:163], a[208:211], v[48:51]
  ds_read_b64_tr_b16 a[152:153], v198 offset:12288
  v_fma_f32 v250, -v243, v172, v250
  v_mfma_f32_16x16x32_bf16 v[52:55], a[160:163], a[212:215], v[52:55]
  ds_read_b64_tr_b16 a[154:155], v198 offset:14336
  v_mul_f32 v172, v242, v172
  v_mfma_f32_16x16x32_bf16 v[56:59], a[164:167], a[208:211], v[56:59]
  ds_read_b64_tr_b16 a[156:157], v199 offset:12288
  v_fmac_f32 v172, v243, v164
  v_mfma_f32_16x16x32_bf16 v[60:63], a[164:167], a[212:215], v[60:63]
  ds_read_b64_tr_b16 a[158:159], v199 offset:14336
  v_mul_f32 v164, v180, v250
  v_mfma_f32_16x16x32_bf16 v[64:67], a[168:171], a[216:219], v[64:67]
  ds_read_b64_tr_b16 a[160:161], v200 offset:12288
  v_mul_f32_e64 v172, -v180, v172
  v_mfma_f32_16x16x32_bf16 v[68:71], a[168:171], a[220:223], v[68:71]
  ds_read_b64_tr_b16 a[162:163], v200 offset:14336
  s_waitcnt lgkmcnt(4)
  v_mfma_f32_16x16x32_bf16 v[72:75], a[172:175], a[216:219], v[72:75]
  ds_read_b64_tr_b16 a[164:165], v201 offset:12288
  s_add_u32 s44, s52, 516096
  v_mfma_f32_16x16x32_bf16 v[76:79], a[172:175], a[220:223], v[76:79]
  ds_read_b64_tr_b16 a[166:167], v201 offset:14336
  s_add_u32 m0, s46, 24576
  v_mfma_f32_16x16x32_bf16 v[80:83], a[144:147], a[216:219], v[80:83]
  ds_read_b64_tr_b16 a[168:169], v198 offset:4096
  buffer_load_dwordx4 v203, s[20:23], s44 offen lds
  v_mfma_f32_16x16x32_bf16 v[84:87], a[144:147], a[220:223], v[84:87]
  ds_read_b64_tr_b16 a[170:171], v198 offset:6144
  v_mul_f32 v251, v242, v165
  v_mfma_f32_16x16x32_bf16 v[88:91], a[148:151], a[216:219], v[88:91]
  ds_read_b64_tr_b16 a[172:173], v199 offset:4096
  v_fma_f32 v251, -v243, v173, v251
  v_mfma_f32_16x16x32_bf16 v[92:95], a[148:151], a[220:223], v[92:95]
  ds_read_b64_tr_b16 a[174:175], v199 offset:6144
  v_mul_f32 v173, v242, v173
  v_mfma_f32_16x16x32_bf16 v[96:99], a[152:155], a[216:219], v[96:99]
  ds_read_b64_tr_b16 a[144:145], v200 offset:4096
  v_fmac_f32 v173, v243, v165
  v_mul_f32 v165, v181, v251
  v_mfma_f32_16x16x32_bf16 v[100:103], a[152:155], a[220:223], v[100:103]
  ds_read_b64_tr_b16 a[146:147], v200 offset:6144
  s_waitcnt lgkmcnt(4)
  v_mfma_f32_16x16x32_bf16 v[104:107], a[156:159], a[216:219], v[104:107]
  ds_read_b64_tr_b16 a[148:149], v201 offset:4096
  v_mul_f32_e64 v173, -v181, v173
  v_mfma_f32_16x16x32_bf16 v[108:111], a[156:159], a[220:223], v[108:111]
  ds_read_b64_tr_b16 a[150:151], v201 offset:6144
  buffer_load_dwordx4 v204, s[20:23], s44 offen offset:1024 lds
  v_mfma_f32_16x16x32_bf16 v[112:115], a[160:163], a[216:219], v[112:115]
  ds_read_b64_tr_b16 a[152:153], v198 offset:16384
  v_mul_f32 v250, v242, v166
  v_mfma_f32_16x16x32_bf16 v[116:119], a[160:163], a[220:223], v[116:119]
  ds_read_b64_tr_b16 a[154:155], v198 offset:18432
  v_fma_f32 v250, -v243, v174, v250
  v_mfma_f32_16x16x32_bf16 v[120:123], a[164:167], a[216:219], v[120:123]
  ds_read_b64_tr_b16 a[156:157], v199 offset:16384
  v_mul_f32 v174, v242, v174
  v_mfma_f32_16x16x32_bf16 v[124:127], a[164:167], a[220:223], v[124:127]
  ds_read_b64_tr_b16 a[158:159], v199 offset:18432
  v_fmac_f32 v174, v243, v166
  v_mfma_f32_16x16x32_bf16 v[64:67], a[168:171], a[224:227], v[64:67]
  ds_read_b64_tr_b16 a[160:161], v200 offset:16384
  s_add_u32 s74, s62, 0
  buffer_load_dwordx4 a[8:11], v226, s[24:27], s74 offen sc1
  v_mfma_f32_16x16x32_bf16 v[68:71], a[168:171], a[228:231], v[68:71]
  ds_read_b64_tr_b16 a[162:163], v200 offset:18432
  s_waitcnt lgkmcnt(4)
  v_mfma_f32_16x16x32_bf16 v[72:75], a[172:175], a[224:227], v[72:75]
  ds_read_b64_tr_b16 a[164:165], v201 offset:16384
  v_mul_f32 v166, v182, v250
  v_mfma_f32_16x16x32_bf16 v[76:79], a[172:175], a[228:231], v[76:79]
  ds_read_b64_tr_b16 a[166:167], v201 offset:18432
  v_mul_f32_e64 v174, -v182, v174
  v_mfma_f32_16x16x32_bf16 v[80:83], a[144:147], a[224:227], v[80:83]
  ds_read_b64_tr_b16 a[168:169], v198 offset:8192
  v_mul_f32 v251, v242, v167
  v_mfma_f32_16x16x32_bf16 v[84:87], a[144:147], a[228:231], v[84:87]
  ds_read_b64_tr_b16 a[170:171], v198 offset:10240
  buffer_load_dwordx4 v205, s[20:23], s44 offen offset:2048 lds
  v_mfma_f32_16x16x32_bf16 v[88:91], a[148:151], a[224:227], v[88:91]
  ds_read_b64_tr_b16 a[172:173], v199 offset:8192
  v_fma_f32 v251, -v243, v175, v251
  v_mfma_f32_16x16x32_bf16 v[92:95], a[148:151], a[228:231], v[92:95]
  ds_read_b64_tr_b16 a[174:175], v199 offset:10240
  v_mul_f32 v175, v242, v175
  v_mfma_f32_16x16x32_bf16 v[96:99], a[152:155], a[224:227], v[96:99]
  ds_read_b64_tr_b16 a[144:145], v200 offset:8192
  v_fmac_f32 v175, v243, v167
  v_mul_f32 v167, v183, v251
  v_mfma_f32_16x16x32_bf16 v[100:103], a[152:155], a[228:231], v[100:103]
  ds_read_b64_tr_b16 a[146:147], v200 offset:10240
  s_waitcnt lgkmcnt(4)
  v_mfma_f32_16x16x32_bf16 v[104:107], a[156:159], a[224:227], v[104:107]
  ds_read_b64_tr_b16 a[148:149], v201 offset:8192
  s_add_u32 s74, s62, 0
  buffer_load_dwordx4 a[12:15], v226, s[24:27], s74 offen offset:1024 sc1
  v_mfma_f32_16x16x32_bf16 v[108:111], a[156:159], a[228:231], v[108:111]
  ds_read_b64_tr_b16 a[150:151], v201 offset:10240
  v_mul_f32_e64 v175, -v183, v175
  v_mfma_f32_16x16x32_bf16 v[112:115], a[160:163], a[224:227], v[112:115]
  ds_read_b64_tr_b16 a[152:153], v198 offset:20480
  v_cvt_pk_bf16_f32 v164, v164, v165
  v_cvt_pk_bf16_f32 v165, v166, v167
  v_mfma_f32_16x16x32_bf16 v[116:119], a[160:163], a[228:231], v[116:119]
  ds_read_b64_tr_b16 a[154:155], v198 offset:22528
  v_cvt_pk_bf16_f32 v172, v172, v173
  v_mfma_f32_16x16x32_bf16 v[120:123], a[164:167], a[224:227], v[120:123]
  ds_read_b64_tr_b16 a[156:157], v199 offset:20480
  v_cvt_pk_bf16_f32 v173, v174, v175
  ds_write_b64 v248, v[164:165] offset:1536
  v_mfma_f32_16x16x32_bf16 v[124:127], a[164:167], a[228:231], v[124:127]
  ds_read_b64_tr_b16 a[158:159], v199 offset:22528
  buffer_load_dwordx4 v206, s[20:23], s44 offen offset:3072 lds
  s_add_u32 m0, s46, 28672
  ds_write_b64 v248, v[172:173] offset:2048
  ds_read_b64_tr_b16 v[164:165], v249 offset:1536
  buffer_load_dwordx4 v207, s[20:23], s44 offen lds
  buffer_load_dwordx4 v208, s[20:23], s44 offen offset:1024 lds
  v_mfma_f32_16x16x32_bf16 v[64:67], a[168:171], a[232:235], v[64:67]
  ds_read_b64_tr_b16 a[160:161], v200 offset:20480
  ds_read_b64_tr_b16 v[166:167], v249 offset:2048
  v_mfma_f32_16x16x32_bf16 v[68:71], a[168:171], a[236:239], v[68:71]
  s_waitcnt lgkmcnt(14)
  ds_read_b64_tr_b16 a[162:163], v200 offset:22528
  s_waitcnt lgkmcnt(8)
  v_mfma_f32_16x16x32_bf16 v[72:75], a[172:175], a[232:235], v[72:75]
  ds_read_b64_tr_b16 a[164:165], v201 offset:20480
  s_waitcnt vmcnt(17)
  v_mfma_f32_16x16x32_bf16 v[76:79], a[172:175], a[236:239], v[76:79]
  ds_read_b64_tr_b16 a[166:167], v201 offset:22528
  s_barrier
  v_mfma_f32_16x16x32_bf16 v[80:83], a[144:147], a[232:235], v[80:83]
  ds_read_b64_tr_b16 a[168:169], v198 offset:24576
  v_mov_b32 v189, 3
  s_add_u32 s44, s69, 294912
  v_mfma_f32_16x16x32_bf16 v[84:87], a[144:147], a[236:239], v[84:87]
  ds_read_b64_tr_b16 a[170:171], v198 offset:26624
  buffer_store_dword v189, v187, s[24:27], 0 offen sc1
  v_mfma_f32_16x16x32_bf16 v[88:91], a[148:151], a[232:235], v[88:91]
  ds_read_b64_tr_b16 a[172:173], v199 offset:24576
  s_add_u32 m0, s47, 49152
  v_mfma_f32_16x16x32_bf16 v[92:95], a[148:151], a[236:239], v[92:95]
  ds_read_b64_tr_b16 a[174:175], v199 offset:26624
  v_mfma_f32_16x16x32_bf16 v[96:99], a[152:155], a[232:235], v[96:99]
  ds_read_b64_tr_b16 a[144:145], v200 offset:24576
  v_mfma_f32_16x16x32_bf16 v[100:103], a[152:155], a[236:239], v[100:103]
  s_waitcnt lgkmcnt(14)
  ds_read_b64_tr_b16 a[146:147], v200 offset:26624
  s_waitcnt lgkmcnt(4)
  v_mfma_f32_16x16x32_bf16 v[104:107], a[156:159], a[232:235], v[104:107]
  ds_read_b64_tr_b16 a[148:149], v201 offset:24576
  s_add_u32 s74, s62, 0
  buffer_load_dwordx4 a[16:19], v226, s[24:27], s74 offen offset:2048 sc1
  v_mfma_f32_16x16x32_bf16 v[108:111], a[156:159], a[236:239], v[108:111]
  ds_read_b64_tr_b16 a[150:151], v201 offset:26624
  v_mfma_f32_16x16x32_bf16 v[112:115], a[160:163], a[232:235], v[112:115]
  ds_read_b64_tr_b16 a[152:153], v198 offset:36864
  v_mfma_f32_16x16x32_bf16 v[116:119], a[160:163], a[236:239], v[116:119]
  ds_read_b64_tr_b16 a[154:155], v198 offset:38912
  v_mfma_f32_16x16x32_bf16 v[120:123], a[164:167], a[232:235], v[120:123]
  ds_read_b64_tr_b16 a[156:157], v199 offset:36864
  v_mfma_f32_16x16x32_bf16 v[124:127], a[164:167], a[236:239], v[124:127]
  ds_read_b64_tr_b16 a[158:159], v199 offset:38912
  s_add_u32 s74, s62, 0
  buffer_load_dwordx4 a[20:23], v226, s[24:27], s74 offen offset:3072 sc1
  s_add_u32 s74, s62, 4096
  buffer_load_dwordx4 a[24:27], v226, s[24:27], s74 offen sc1
  s_add_u32 s74, s62, 4096
  buffer_load_dwordx4 a[28:31], v226, s[24:27], s74 offen offset:1024 sc1
  s_add_u32 s74, s62, 4096
  buffer_load_dwordx4 a[32:35], v226, s[24:27], s74 offen offset:2048 sc1
  s_add_u32 s74, s62, 4096
  buffer_load_dwordx4 a[36:39], v226, s[24:27], s74 offen offset:3072 sc1
  s_add_u32 s74, s62, 16384
  buffer_load_dwordx4 a[0:3], v226, s[24:27], s74 offen sc1
  s_add_u32 s74, s62, 16384
  buffer_load_dwordx4 a[4:7], v226, s[24:27], s74 offen offset:1024 sc1
  v_mfma_f32_16x16x32_bf16 v[0:3], a[168:171], a[216:219], v[0:3]
  ds_read_b64_tr_b16 a[160:161], v200 offset:36864
  v_mfma_f32_16x16x32_bf16 v[4:7], a[168:171], a[220:223], v[4:7]
  ds_read_b64_tr_b16 a[162:163], v200 offset:38912
  s_waitcnt lgkmcnt(4)
  v_mfma_f32_16x16x32_bf16 v[8:11], a[172:175], a[216:219], v[8:11]
  ds_read_b64_tr_b16 a[164:165], v201 offset:36864
  v_mfma_f32_16x16x32_bf16 v[12:15], a[172:175], a[220:223], v[12:15]
  ds_read_b64_tr_b16 a[166:167], v201 offset:38912
  v_mfma_f32_16x16x32_bf16 v[16:19], a[144:147], a[216:219], v[16:19]
  ds_read_b64_tr_b16 a[168:169], v198 offset:28672
  v_mfma_f32_16x16x32_bf16 v[20:23], a[144:147], a[220:223], v[20:23]
  ds_read_b64_tr_b16 a[170:171], v198 offset:30720
  s_add_u32 s49, s61, 16384
  buffer_store_dwordx4 v[128:131], v226, s[24:27], s49 offen offset:2048 sc1
  v_mfma_f32_16x16x32_bf16 v[24:27], a[148:151], a[216:219], v[24:27]
  ds_read_b64_tr_b16 a[172:173], v199 offset:28672
  v_mfma_f32_16x16x32_bf16 v[28:31], a[148:151], a[220:223], v[28:31]
  ds_read_b64_tr_b16 a[174:175], v199 offset:30720
  v_mfma_f32_16x16x32_bf16 v[32:35], a[152:155], a[216:219], v[32:35]
  ds_read_b64_tr_b16 a[144:145], v200 offset:28672
  v_mfma_f32_16x16x32_bf16 v[36:39], a[152:155], a[220:223], v[36:39]
  ds_read_b64_tr_b16 a[146:147], v200 offset:30720
  s_waitcnt lgkmcnt(4)
  v_mfma_f32_16x16x32_bf16 v[40:43], a[156:159], a[216:219], v[40:43]
  ds_read_b64_tr_b16 a[148:149], v201 offset:28672
  s_add_u32 s49, s61, 20480
  buffer_store_dwordx4 v[144:147], v226, s[24:27], s49 offen sc1
  v_mfma_f32_16x16x32_bf16 v[44:47], a[156:159], a[220:223], v[44:47]
  ds_read_b64_tr_b16 a[150:151], v201 offset:30720
  v_mfma_f32_16x16x32_bf16 v[48:51], a[160:163], a[216:219], v[48:51]
  ds_read_b64_tr_b16 a[152:153], v198 offset:40960
  v_mfma_f32_16x16x32_bf16 v[52:55], a[160:163], a[220:223], v[52:55]
  ds_read_b64_tr_b16 a[154:155], v198 offset:43008
  v_mfma_f32_16x16x32_bf16 v[56:59], a[164:167], a[216:219], v[56:59]
  ds_read_b64_tr_b16 a[156:157], v199 offset:40960
  v_mfma_f32_16x16x32_bf16 v[60:63], a[164:167], a[220:223], v[60:63]
  ds_read_b64_tr_b16 a[158:159], v199 offset:43008
  buffer_load_dwordx4 v203, s[20:23], s44 offen lds
  v_mfma_f32_16x16x32_bf16 v[0:3], a[168:171], a[224:227], v[0:3]
  ds_read_b64_tr_b16 a[160:161], v200 offset:40960
  v_mfma_f32_16x16x32_bf16 v[4:7], a[168:171], a[228:231], v[4:7]
  ds_read_b64_tr_b16 a[162:163], v200 offset:43008
  s_waitcnt lgkmcnt(4)
  v_mfma_f32_16x16x32_bf16 v[8:11], a[172:175], a[224:227], v[8:11]
  ds_read_b64_tr_b16 a[164:165], v201 offset:40960
  v_mfma_f32_16x16x32_bf16 v[12:15], a[172:175], a[228:231], v[12:15]
  ds_read_b64_tr_b16 a[166:167], v201 offset:43008
  v_mfma_f32_16x16x32_bf16 v[16:19], a[144:147], a[224:227], v[16:19]
  ds_read_b64_tr_b16 a[168:169], v198 offset:32768
  s_add_u32 s49, s61, 20480
  buffer_store_dwordx4 v[160:163], v226, s[24:27], s49 offen offset:2048 sc1
  v_mfma_f32_16x16x32_bf16 v[20:23], a[144:147], a[228:231], v[20:23]
  ds_read_b64_tr_b16 a[170:171], v198 offset:34816
  v_mfma_f32_16x16x32_bf16 v[24:27], a[148:151], a[224:227], v[24:27]
  ds_read_b64_tr_b16 a[172:173], v199 offset:32768
  v_mfma_f32_16x16x32_bf16 v[28:31], a[148:151], a[228:231], v[28:31]
  ds_read_b64_tr_b16 a[174:175], v199 offset:34816
  v_mfma_f32_16x16x32_bf16 v[32:35], a[152:155], a[224:227], v[32:35]
  ds_read_b64_tr_b16 a[144:145], v200 offset:32768
  v_mfma_f32_16x16x32_bf16 v[36:39], a[152:155], a[228:231], v[36:39]
  ds_read_b64_tr_b16 a[146:147], v200 offset:34816
  s_waitcnt lgkmcnt(4)
  v_mfma_f32_16x16x32_bf16 v[40:43], a[156:159], a[224:227], v[40:43]
  ds_read_b64_tr_b16 a[148:149], v201 offset:32768
  buffer_load_dwordx4 v204, s[20:23], s44 offen offset:1024 lds
  v_mfma_f32_16x16x32_bf16 v[44:47], a[156:159], a[228:231], v[44:47]
  ds_read_b64_tr_b16 a[150:151], v201 offset:34816
  v_mfma_f32_16x16x32_bf16 v[48:51], a[160:163], a[224:227], v[48:51]
  ds_read_b64_tr_b16 a[152:153], v198 offset:45056
  v_mfma_f32_16x16x32_bf16 v[52:55], a[160:163], a[228:231], v[52:55]
  ds_read_b64_tr_b16 a[154:155], v198 offset:47104
  v_mfma_f32_16x16x32_bf16 v[56:59], a[164:167], a[224:227], v[56:59]
  ds_read_b64_tr_b16 a[156:157], v199 offset:45056
  v_mfma_f32_16x16x32_bf16 v[60:63], a[164:167], a[228:231], v[60:63]
  ds_read_b64_tr_b16 a[158:159], v199 offset:47104
  s_add_u32 s49, s61, 16384
  buffer_store_dwordx4 v[132:135], v226, s[24:27], s49 offen offset:3072 sc1
  buffer_load_dwordx4 v205, s[20:23], s44 offen offset:2048 lds
  v_mfma_f32_16x16x32_bf16 v[0:3], a[168:171], a[232:235], v[0:3]
  ds_read_b64_tr_b16 a[160:161], v200 offset:45056
  v_mfma_f32_16x16x32_bf16 v[4:7], a[168:171], a[236:239], v[4:7]
  ds_read_b64_tr_b16 a[162:163], v200 offset:47104
  s_waitcnt lgkmcnt(4)
  v_mfma_f32_16x16x32_bf16 v[8:11], a[172:175], a[232:235], v[8:11]
  ds_read_b64_tr_b16 a[164:165], v201 offset:45056
  s_waitcnt vmcnt(30)
  v_mfma_f32_16x16x32_bf16 v[12:15], a[172:175], a[236:239], v[12:15]
  ds_read_b64_tr_b16 a[166:167], v201 offset:47104
  s_barrier
  v_mfma_f32_16x16x32_bf16 v[16:19], a[144:147], a[232:235], v[16:19]
  ds_read_b64_tr_b16 a[168:169], v194 offset:24576
  s_add_u32 s44, s66, 640
  v_mfma_f32_16x16x32_bf16 v[20:23], a[144:147], a[236:239], v[20:23]
  ds_read_b64_tr_b16 a[170:171], v194 offset:26624
  s_add_u32 s49, s61, 20480
  buffer_store_dwordx4 v[148:151], v226, s[24:27], s49 offen offset:1024 sc1
  v_mfma_f32_16x16x32_bf16 v[24:27], a[148:151], a[232:235], v[24:27]
  ds_read_b64_tr_b16 a[172:173], v195 offset:24576
  s_add_u32 m0, s46, 98304
  v_mfma_f32_16x16x32_bf16 v[28:31], a[148:151], a[236:239], v[28:31]
  ds_read_b64_tr_b16 a[174:175], v195 offset:26624
  v_mfma_f32_16x16x32_bf16 v[32:35], a[152:155], a[232:235], v[32:35]
  ds_read_b64_tr_b16 a[144:145], v196 offset:24576
  v_mfma_f32_16x16x32_bf16 v[36:39], a[152:155], a[236:239], v[36:39]
  ds_read_b64_tr_b16 a[146:147], v196 offset:26624
  s_add_u32 s49, s61, 20480
  buffer_store_dwordx4 v[164:167], v226, s[24:27], s49 offen offset:3072 sc1
  s_waitcnt lgkmcnt(4)
  v_mfma_f32_16x16x32_bf16 v[40:43], a[156:159], a[232:235], v[40:43]
  ds_read_b64_tr_b16 a[148:149], v197 offset:24576
  v_mfma_f32_16x16x32_bf16 v[44:47], a[156:159], a[236:239], v[44:47]
  ds_read_b64_tr_b16 a[150:151], v197 offset:26624
  v_mfma_f32_16x16x32_bf16 v[48:51], a[160:163], a[232:235], v[48:51]
  ds_read_b64_tr_b16 a[152:153], v194 offset:28672
  v_mfma_f32_16x16x32_bf16 v[52:55], a[160:163], a[236:239], v[52:55]
  ds_read_b64_tr_b16 a[154:155], v194 offset:30720
  v_mfma_f32_16x16x32_bf16 v[56:59], a[164:167], a[232:235], v[56:59]
  ds_read_b64_tr_b16 a[156:157], v195 offset:28672
  v_mfma_f32_16x16x32_bf16 v[60:63], a[164:167], a[236:239], v[60:63]
  ds_read_b64_tr_b16 a[158:159], v195 offset:30720
  buffer_load_dwordx4 v209, s[12:15], s44 offen lds
  v_mfma_f32_16x16x32_bf16 a[96:99], a[168:171], a[216:219], a[96:99]
  ds_read_b64_tr_b16 a[160:161], v196 offset:28672
  v_mfma_f32_16x16x32_bf16 a[100:103], a[168:171], a[220:223], a[100:103]
  ds_read_b64_tr_b16 a[162:163], v196 offset:30720
  s_waitcnt lgkmcnt(4)
  v_mfma_f32_16x16x32_bf16 a[104:107], a[172:175], a[216:219], a[104:107]
  ds_read_b64_tr_b16 a[164:165], v197 offset:28672
  v_mfma_f32_16x16x32_bf16 a[108:111], a[172:175], a[220:223], a[108:111]
  ds_read_b64_tr_b16 a[166:167], v197 offset:30720
  v_mfma_f32_16x16x32_bf16 a[112:115], a[144:147], a[216:219], a[112:115]
  ds_read_b64_tr_b16 a[168:169], v194 offset:32768
  v_mfma_f32_16x16x32_bf16 a[116:119], a[144:147], a[220:223], a[116:119]
  ds_read_b64_tr_b16 a[170:171], v194 offset:34816
  v_mfma_f32_16x16x32_bf16 a[120:123], a[148:151], a[216:219], a[120:123]
  ds_read_b64_tr_b16 a[172:173], v195 offset:32768
  buffer_load_dwordx4 v210, s[12:15], s44 offen offset:1024 lds
  v_mfma_f32_16x16x32_bf16 a[124:127], a[148:151], a[220:223], a[124:127]
  ds_read_b64_tr_b16 a[174:175], v195 offset:34816
  v_mfma_f32_16x16x32_bf16 a[96:99], a[152:155], a[224:227], a[96:99]
  ds_read_b64_tr_b16 a[144:145], v196 offset:32768
  v_mfma_f32_16x16x32_bf16 a[100:103], a[152:155], a[228:231], a[100:103]
  ds_read_b64_tr_b16 a[146:147], v196 offset:34816
  s_waitcnt lgkmcnt(4)
  v_mfma_f32_16x16x32_bf16 a[104:107], a[156:159], a[224:227], a[104:107]
  ds_read_b64_tr_b16 a[148:149], v197 offset:32768
  s_waitcnt vmcnt(28)
  v_mfma_f32_16x16x32_bf16 a[108:111], a[156:159], a[228:231], a[108:111]
  ds_read_b64_tr_b16 a[150:151], v197 offset:34816
  s_barrier
  v_mfma_f32_16x16x32_bf16 a[112:115], a[160:163], a[224:227], a[112:115]
  ds_read_b64 a[152:153], v184
  buffer_load_dword v202, v188, s[24:27], 0 offen sc1
  v_mfma_f32_16x16x32_bf16 a[116:119], a[160:163], a[228:231], a[116:119]
  ds_read_b64 a[154:155], v184 offset:12288
  v_mfma_f32_16x16x32_bf16 a[120:123], a[164:167], a[224:227], a[120:123]
  ds_read_b64 a[156:157], v184 offset:1536
  v_mfma_f32_16x16x32_bf16 a[124:127], a[164:167], a[228:231], a[124:127]
  ds_read_b64 a[158:159], v184 offset:13824
  v_mfma_f32_16x16x32_bf16 a[96:99], a[168:171], a[232:235], a[96:99]
  ds_read_b64 a[160:161], v184 offset:3072
  v_mfma_f32_16x16x32_bf16 a[100:103], a[168:171], a[236:239], a[100:103]
  ds_read_b64 a[162:163], v184 offset:15360
  s_waitcnt lgkmcnt(4)
  v_mfma_f32_16x16x32_bf16 a[104:107], a[172:175], a[232:235], a[104:107]
  ds_read_b64 a[164:165], v184 offset:4608
  buffer_load_dwordx4 v211, s[12:15], s44 offen offset:2048 lds
  v_mfma_f32_16x16x32_bf16 a[108:111], a[172:175], a[236:239], a[108:111]
  ds_read_b64 a[166:167], v184 offset:16896
  v_mfma_f32_16x16x32_bf16 a[112:115], a[144:147], a[232:235], a[112:115]
  ds_read_b64 a[168:169], v184 offset:6144
  v_mfma_f32_16x16x32_bf16 a[116:119], a[144:147], a[236:239], a[116:119]
  ds_read_b64 a[170:171], v184 offset:18432
  v_mfma_f32_16x16x32_bf16 a[120:123], a[148:151], a[232:235], a[120:123]
  ds_read_b64 a[172:173], v184 offset:7680
  v_mfma_f32_16x16x32_bf16 a[124:127], a[148:151], a[236:239], a[124:127]
  ds_read_b64 a[174:175], v184 offset:19968
  v_mfma_f32_16x16x32_bf16 v[64:67], a[152:155], v[128:131], v[64:67]
  ds_read_b64 a[144:145], v184 offset:9216
  v_mfma_f32_16x16x32_bf16 v[68:71], a[152:155], v[132:135], v[68:71]
  ds_read_b64 a[146:147], v184 offset:21504
  s_waitcnt lgkmcnt(4)
  v_mfma_f32_16x16x32_bf16 v[72:75], a[156:159], v[128:131], v[72:75]
  ds_read_b64 a[148:149], v184 offset:10752
  buffer_load_dwordx4 v212, s[12:15], s44 offen offset:3072 lds
  v_mfma_f32_16x16x32_bf16 v[76:79], a[156:159], v[132:135], v[76:79]
  ds_read_b64 a[150:151], v184 offset:23040
  s_add_u32 m0, s46, 102400
  v_mfma_f32_16x16x32_bf16 v[80:83], a[160:163], v[128:131], v[80:83]
  ds_read_b64 a[152:153], v184 offset:32
  v_mfma_f32_16x16x32_bf16 v[84:87], a[160:163], v[132:135], v[84:87]
  ds_read_b64 a[154:155], v184 offset:12320
  v_mfma_f32_16x16x32_bf16 v[88:91], a[164:167], v[128:131], v[88:91]
  ds_read_b64 a[156:157], v184 offset:1568
  v_mfma_f32_16x16x32_bf16 v[92:95], a[164:167], v[132:135], v[92:95]
  ds_read_b64 a[158:159], v184 offset:13856
  buffer_load_dwordx4 v213, s[12:15], s44 offen lds
  buffer_load_dwordx4 v214, s[12:15], s44 offen offset:1024 lds
  v_mfma_f32_16x16x32_bf16 v[96:99], a[168:171], v[128:131], v[96:99]
  ds_read_b64 a[160:161], v184 offset:3104
  s_add_u32 s44, s66, 896
  v_mfma_f32_16x16x32_bf16 v[100:103], a[168:171], v[132:135], v[100:103]
  ds_read_b64 a[162:163], v184 offset:15392
  s_waitcnt lgkmcnt(4)
  v_mfma_f32_16x16x32_bf16 v[104:107], a[172:175], v[128:131], v[104:107]
  ds_read_b64 a[164:165], v184 offset:4640
  s_add_u32 m0, s46, 122880
  v_mfma_f32_16x16x32_bf16 v[108:111], a[172:175], v[132:135], v[108:111]
  ds_read_b64 a[166:167], v184 offset:16928
  v_mfma_f32_16x16x32_bf16 v[112:115], a[144:147], v[128:131], v[112:115]
  ds_read_b64 a[168:169], v184 offset:6176
  v_mfma_f32_16x16x32_bf16 v[116:119], a[144:147], v[132:135], v[116:119]
  ds_read_b64 a[170:171], v184 offset:18464
  v_mfma_f32_16x16x32_bf16 v[120:123], a[148:151], v[128:131], v[120:123]
  ds_read_b64 a[172:173], v184 offset:7712
  v_mfma_f32_16x16x32_bf16 v[124:127], a[148:151], v[132:135], v[124:127]
  ds_read_b64 a[174:175], v184 offset:20000
  buffer_load_dwordx4 v209, s[12:15], s44 offen lds
  v_mfma_f32_16x16x32_bf16 v[64:67], a[152:155], v[144:147], v[64:67]
  ds_read_b64 a[144:145], v184 offset:9248
  v_mfma_f32_16x16x32_bf16 v[68:71], a[152:155], v[148:151], v[68:71]
  ds_read_b64 a[146:147], v184 offset:21536
  s_waitcnt lgkmcnt(4)
  v_mfma_f32_16x16x32_bf16 v[72:75], a[156:159], v[144:147], v[72:75]
  ds_read_b64 a[148:149], v184 offset:10784
  v_mfma_f32_16x16x32_bf16 v[76:79], a[156:159], v[148:151], v[76:79]
  ds_read_b64 a[150:151], v184 offset:23072
  v_mfma_f32_16x16x32_bf16 v[80:83], a[160:163], v[144:147], v[80:83]
  ds_read_b64 a[152:153], v184 offset:64
  v_mfma_f32_16x16x32_bf16 v[84:87], a[160:163], v[148:151], v[84:87]
  ds_read_b64 a[154:155], v184 offset:12352
  v_mfma_f32_16x16x32_bf16 v[88:91], a[164:167], v[144:147], v[88:91]
  ds_read_b64 a[156:157], v184 offset:1600
  buffer_load_dwordx4 v210, s[12:15], s44 offen offset:1024 lds
  v_mfma_f32_16x16x32_bf16 v[92:95], a[164:167], v[148:151], v[92:95]
  ds_read_b64 a[158:159], v184 offset:13888
  v_mfma_f32_16x16x32_bf16 v[96:99], a[168:171], v[144:147], v[96:99]
  ds_read_b64 a[160:161], v184 offset:3136
  v_mfma_f32_16x16x32_bf16 v[100:103], a[168:171], v[148:151], v[100:103]
  ds_read_b64 a[162:163], v184 offset:15424
  s_waitcnt lgkmcnt(4)
  v_mfma_f32_16x16x32_bf16 v[104:107], a[172:175], v[144:147], v[104:107]
  ds_read_b64 a[164:165], v184 offset:4672
  v_mfma_f32_16x16x32_bf16 v[108:111], a[172:175], v[148:151], v[108:111]
  ds_read_b64 a[166:167], v184 offset:16960
  v_mfma_f32_16x16x32_bf16 v[112:115], a[144:147], v[144:147], v[112:115]
  ds_read_b64 a[168:169], v184 offset:6208
  v_mfma_f32_16x16x32_bf16 v[116:119], a[144:147], v[148:151], v[116:119]
  ds_read_b64 a[170:171], v184 offset:18496
  buffer_load_dwordx4 v211, s[12:15], s44 offen offset:2048 lds
  v_mfma_f32_16x16x32_bf16 v[120:123], a[148:151], v[144:147], v[120:123]
  ds_read_b64 a[172:173], v184 offset:7744
  v_mfma_f32_16x16x32_bf16 v[124:127], a[148:151], v[148:151], v[124:127]
  ds_read_b64 a[174:175], v184 offset:20032
  buffer_load_dwordx4 v212, s[12:15], s44 offen offset:3072 lds
  s_add_u32 m0, s46, 126976
  s_nop 0
  buffer_load_dwordx4 v213, s[12:15], s44 offen lds
  buffer_load_dwordx4 v214, s[12:15], s44 offen offset:1024 lds
  v_mfma_f32_16x16x32_bf16 v[64:67], a[152:155], v[160:163], v[64:67]
  ds_read_b64 a[144:145], v184 offset:9280
  v_mfma_f32_16x16x32_bf16 v[68:71], a[152:155], v[164:167], v[68:71]
  ds_read_b64 a[146:147], v184 offset:21568
  s_waitcnt lgkmcnt(4)
  v_mfma_f32_16x16x32_bf16 v[72:75], a[156:159], v[160:163], v[72:75]
  ds_read_b64 a[148:149], v184 offset:10816
  s_waitcnt vmcnt(31)
  v_mfma_f32_16x16x32_bf16 v[76:79], a[156:159], v[164:167], v[76:79]
  ds_read_b64 a[150:151], v184 offset:23104
  s_barrier
  v_mfma_f32_16x16x32_bf16 v[80:83], a[160:163], v[160:163], v[80:83]
  ds_read_b64 a[152:153], v184 offset:24576
  s_add_u32 s44, s66, 111232
  v_mfma_f32_16x16x32_bf16 v[84:87], a[160:163], v[164:167], v[84:87]
  ds_read_b64 a[154:155], v184 offset:36864
  s_add_u32 m0, s46, 73728
  v_mfma_f32_16x16x32_bf16 v[88:91], a[164:167], v[160:163], v[88:91]
  ds_read_b64 a[156:157], v184 offset:26112
  v_mfma_f32_16x16x32_bf16 v[92:95], a[164:167], v[164:167], v[92:95]
  ds_read_b64 a[158:159], v184 offset:38400
  buffer_load_dwordx4 v209, s[12:15], s44 offen lds
  v_mfma_f32_16x16x32_bf16 v[96:99], a[168:171], v[160:163], v[96:99]
  ds_read_b64 a[160:161], v184 offset:27648
  v_mfma_f32_16x16x32_bf16 v[100:103], a[168:171], v[164:167], v[100:103]
  ds_read_b64 a[162:163], v184 offset:39936
  s_waitcnt lgkmcnt(4)
  v_mfma_f32_16x16x32_bf16 v[104:107], a[172:175], v[160:163], v[104:107]
  ds_read_b64 a[164:165], v184 offset:29184
  v_mfma_f32_16x16x32_bf16 v[108:111], a[172:175], v[164:167], v[108:111]
  ds_read_b64 a[166:167], v184 offset:41472
  v_mfma_f32_16x16x32_bf16 v[112:115], a[144:147], v[160:163], v[112:115]
  ds_read_b64 a[168:169], v184 offset:30720
  v_mfma_f32_16x16x32_bf16 v[116:119], a[144:147], v[164:167], v[116:119]
  ds_read_b64 a[170:171], v184 offset:43008
  v_mfma_f32_16x16x32_bf16 v[120:123], a[148:151], v[160:163], v[120:123]
  ds_read_b64 a[172:173], v184 offset:32256
  buffer_load_dwordx4 v210, s[12:15], s44 offen offset:1024 lds
  v_mfma_f32_16x16x32_bf16 v[124:127], a[148:151], v[164:167], v[124:127]
  ds_read_b64 a[174:175], v184 offset:44544
  v_mfma_f32_16x16x32_bf16 v[0:3], a[152:155], v[128:131], v[0:3]
  ds_read_b64 a[144:145], v184 offset:33792
  v_mfma_f32_16x16x32_bf16 v[4:7], a[152:155], v[132:135], v[4:7]
  ds_read_b64 a[146:147], v184 offset:46080
  s_waitcnt lgkmcnt(4)
  v_mfma_f32_16x16x32_bf16 v[8:11], a[156:159], v[128:131], v[8:11]
  ds_read_b64 a[148:149], v184 offset:35328
  v_mfma_f32_16x16x32_bf16 v[12:15], a[156:159], v[132:135], v[12:15]
  ds_read_b64 a[150:151], v184 offset:47616
  v_mfma_f32_16x16x32_bf16 v[16:19], a[160:163], v[128:131], v[16:19]
  ds_read_b64 a[152:153], v184 offset:24608
  v_mfma_f32_16x16x32_bf16 v[20:23], a[160:163], v[132:135], v[20:23]
  ds_read_b64 a[154:155], v184 offset:36896
  buffer_load_dwordx4 v211, s[12:15], s44 offen offset:2048 lds
  v_mfma_f32_16x16x32_bf16 v[24:27], a[164:167], v[128:131], v[24:27]
  ds_read_b64 a[156:157], v184 offset:26144
  v_mfma_f32_16x16x32_bf16 v[28:31], a[164:167], v[132:135], v[28:31]
  ds_read_b64 a[158:159], v184 offset:38432
  v_mfma_f32_16x16x32_bf16 v[32:35], a[168:171], v[128:131], v[32:35]
  ds_read_b64 a[160:161], v184 offset:27680
  v_mfma_f32_16x16x32_bf16 v[36:39], a[168:171], v[132:135], v[36:39]
  ds_read_b64 a[162:163], v184 offset:39968
  s_waitcnt lgkmcnt(4)
  v_mfma_f32_16x16x32_bf16 v[40:43], a[172:175], v[128:131], v[40:43]
  ds_read_b64 a[164:165], v184 offset:29216
  v_mfma_f32_16x16x32_bf16 v[44:47], a[172:175], v[132:135], v[44:47]
  ds_read_b64 a[166:167], v184 offset:41504
  v_mfma_f32_16x16x32_bf16 v[48:51], a[144:147], v[128:131], v[48:51]
  ds_read_b64 a[168:169], v184 offset:30752
  buffer_load_dwordx4 v212, s[12:15], s44 offen offset:3072 lds
  v_mfma_f32_16x16x32_bf16 v[52:55], a[144:147], v[132:135], v[52:55]
  ds_read_b64 a[170:171], v184 offset:43040
  s_add_u32 m0, s46, 77824
  v_mfma_f32_16x16x32_bf16 v[56:59], a[148:151], v[128:131], v[56:59]
  ds_read_b64 a[172:173], v184 offset:32288
  v_mfma_f32_16x16x32_bf16 v[60:63], a[148:151], v[132:135], v[60:63]
  ds_read_b64 a[174:175], v184 offset:44576
  v_mfma_f32_16x16x32_bf16 v[0:3], a[152:155], v[144:147], v[0:3]
  ds_read_b64 a[144:145], v184 offset:33824
  v_mfma_f32_16x16x32_bf16 v[4:7], a[152:155], v[148:151], v[4:7]
  ds_read_b64 a[146:147], v184 offset:46112
  s_waitcnt lgkmcnt(4)
  v_mfma_f32_16x16x32_bf16 v[8:11], a[156:159], v[144:147], v[8:11]
  ds_read_b64 a[148:149], v184 offset:35360
  v_mfma_f32_16x16x32_bf16 v[12:15], a[156:159], v[148:151], v[12:15]
  ds_read_b64 a[150:151], v184 offset:47648
  buffer_load_dwordx4 v213, s[12:15], s44 offen lds
  v_mfma_f32_16x16x32_bf16 v[16:19], a[160:163], v[144:147], v[16:19]
  ds_read_b64 a[152:153], v184 offset:24640
  v_mfma_f32_16x16x32_bf16 v[20:23], a[160:163], v[148:151], v[20:23]
  ds_read_b64 a[154:155], v184 offset:36928
  v_mfma_f32_16x16x32_bf16 v[24:27], a[164:167], v[144:147], v[24:27]
  ds_read_b64 a[156:157], v184 offset:26176
  v_mfma_f32_16x16x32_bf16 v[28:31], a[164:167], v[148:151], v[28:31]
  ds_read_b64 a[158:159], v184 offset:38464
  v_mfma_f32_16x16x32_bf16 v[32:35], a[168:171], v[144:147], v[32:35]
  ds_read_b64 a[160:161], v184 offset:27712
  v_mfma_f32_16x16x32_bf16 v[36:39], a[168:171], v[148:151], v[36:39]
  ds_read_b64 a[162:163], v184 offset:40000
  s_waitcnt lgkmcnt(4)
  v_mfma_f32_16x16x32_bf16 v[40:43], a[172:175], v[144:147], v[40:43]
  ds_read_b64 a[164:165], v184 offset:29248
  buffer_load_dwordx4 v214, s[12:15], s44 offen offset:1024 lds
  v_mfma_f32_16x16x32_bf16 v[44:47], a[172:175], v[148:151], v[44:47]
  ds_read_b64 a[166:167], v184 offset:41536
  s_waitcnt vmcnt(16)
  v_cmp_le_u32 vcc, 3, v202
  s_nop 3
  s_cmp_eq_u64 vcc, -1
  s_cbranch_scc0 L_slow_B1
L_back_B1:
  v_mfma_f32_16x16x32_bf16 v[48:51], a[144:147], v[144:147], v[48:51]
  ds_read_b64 a[168:169], v184 offset:30784
  v_mfma_f32_16x16x32_bf16 v[52:55], a[144:147], v[148:151], v[52:55]
  ds_read_b64 a[170:171], v184 offset:43072
  v_mfma_f32_16x16x32_bf16 v[56:59], a[148:151], v[144:147], v[56:59]
  ds_read_b64 a[172:173], v184 offset:32320
  v_mfma_f32_16x16x32_bf16 v[60:63], a[148:151], v[148:151], v[60:63]
  ds_read_b64 a[174:175], v184 offset:44608
  s_add_u32 s74, s62, 8192
  buffer_load_dwordx4 a[40:43], v226, s[24:27], s74 offen sc1
  v_mfma_f32_16x16x32_bf16 v[0:3], a[152:155], v[160:163], v[0:3]
  ds_read_b64 a[144:145], v184 offset:33856
  v_mfma_f32_16x16x32_bf16 v[4:7], a[152:155], v[164:167], v[4:7]
  ds_read_b64 a[146:147], v184 offset:46144
  s_waitcnt lgkmcnt(4)
  v_mfma_f32_16x16x32_bf16 v[8:11], a[156:159], v[160:163], v[8:11]
  ds_read_b64 a[148:149], v184 offset:35392
  v_mfma_f32_16x16x32_bf16 v[12:15], a[156:159], v[164:167], v[12:15]
  ds_read_b64 a[150:151], v184 offset:47680
  s_barrier
  v_mfma_f32_16x16x32_bf16 v[16:19], a[160:163], v[160:163], v[16:19]
  ds_read_b64 a[152:153], v185
  s_add_u32 s44, s66, 111488
  v_mfma_f32_16x16x32_bf16 v[20:23], a[160:163], v[164:167], v[20:23]
  ds_read_b64 a[154:155], v185 offset:6144
  s_add_u32 m0, s46, 0
  v_mfma_f32_16x16x32_bf16 v[24:27], a[164:167], v[160:163], v[24:27]
  ds_read_b64 a[156:157], v185 offset:1536
  buffer_load_dwordx4 v209, s[12:15], s44 offen lds
  v_mfma_f32_16x16x32_bf16 v[28:31], a[164:167], v[164:167], v[28:31]
  ds_read_b64 a[158:159], v185 offset:7680
  v_mfma_f32_16x16x32_bf16 v[32:35], a[168:171], v[160:163], v[32:35]
  ds_read_b64 a[160:161], v185 offset:3072
  v_mfma_f32_16x16x32_bf16 v[36:39], a[168:171], v[164:167], v[36:39]
  ds_read_b64 a[162:163], v185 offset:9216
  s_waitcnt lgkmcnt(4)
  v_mfma_f32_16x16x32_bf16 v[40:43], a[172:175], v[160:163], v[40:43]
  ds_read_b64 a[164:165], v185 offset:4608
  v_mfma_f32_16x16x32_bf16 v[44:47], a[172:175], v[164:167], v[44:47]
  ds_read_b64 a[166:167], v185 offset:10752
  s_add_u32 s74, s62, 8192
  buffer_load_dwordx4 a[44:47], v226, s[24:27], s74 offen offset:1024 sc1
  v_mfma_f32_16x16x32_bf16 v[48:51], a[144:147], v[160:163], v[48:51]
  ds_read_b64 a[168:169], v185 offset:32
  v_mfma_f32_16x16x32_bf16 v[52:55], a[144:147], v[164:167], v[52:55]
  ds_read_b64 a[170:171], v185 offset:6176
  v_mfma_f32_16x16x32_bf16 v[56:59], a[148:151], v[160:163], v[56:59]
  ds_read_b64 a[172:173], v185 offset:1568
  v_mfma_f32_16x16x32_bf16 v[60:63], a[148:151], v[164:167], v[60:63]
  ds_read_b64 a[174:175], v185 offset:7712
  v_mfma_f32_16x16x32_bf16 a[96:99], a[152:155], v[128:131], a[96:99]
  ds_read_b64 a[144:145], v185 offset:3104
  buffer_load_dwordx4 v210, s[12:15], s44 offen offset:1024 lds
  v_mfma_f32_16x16x32_bf16 a[100:103], a[152:155], v[132:135], a[100:103]
  ds_read_b64 a[146:147], v185 offset:9248
  s_waitcnt lgkmcnt(4)
  v_mfma_f32_16x16x32_bf16 a[104:107], a[156:159], v[128:131], a[104:107]
  ds_read_b64 a[148:149], v185 offset:4640
  v_mfma_f32_16x16x32_bf16 a[108:111], a[156:159], v[132:135], a[108:111]
  ds_read_b64 a[150:151], v185 offset:10784
  v_mfma_f32_16x16x32_bf16 a[112:115], a[160:163], v[128:131], a[112:115]
  ds_read_b64 a[152:153], v185 offset:64
  v_mfma_f32_16x16x32_bf16 a[116:119], a[160:163], v[132:135], a[116:119]
  ds_read_b64 a[154:155], v185 offset:6208
  s_add_u32 s74, s62, 8192
  buffer_load_dwordx4 a[48:51], v226, s[24:27], s74 offen offset:2048 sc1
  v_mfma_f32_16x16x32_bf16 a[120:123], a[164:167], v[128:131], a[120:123]
  ds_read_b64 a[156:157], v185 offset:1600
  v_mfma_f32_16x16x32_bf16 a[124:127], a[164:167], v[132:135], a[124:127]
  ds_read_b64 a[158:159], v185 offset:7744
  v_mfma_f32_16x16x32_bf16 a[96:99], a[168:171], v[144:147], a[96:99]
  ds_read_b64 a[160:161], v185 offset:3136
  v_mfma_f32_16x16x32_bf16 a[100:103], a[168:171], v[148:151], a[100:103]
  ds_read_b64 a[162:163], v185 offset:9280
  s_waitcnt lgkmcnt(4)
  v_mfma_f32_16x16x32_bf16 a[104:107], a[172:175], v[144:147], a[104:107]
  ds_read_b64 a[164:165], v185 offset:4672
  buffer_load_dwordx4 v211, s[12:15], s44 offen offset:2048 lds
  s_waitcnt vmcnt(18)
  v_mfma_f32_16x16x32_bf16 a[108:111], a[172:175], v[148:151], a[108:111]
  ds_read_b64 a[166:167], v185 offset:10816
  s_barrier
  v_mfma_f32_16x16x32_bf16 a[112:115], a[144:147], v[144:147], a[112:115]
  ds_read_b64_tr_b16 a[168:169], v198
  v_mov_b32 v189, 4
  v_mfma_f32_16x16x32_bf16 a[116:119], a[144:147], v[148:151], a[116:119]
  ds_read_b64_tr_b16 a[170:171], v198 offset:2048
  v_mfma_f32_16x16x32_bf16 a[120:123], a[148:151], v[144:147], a[120:123]
  ds_read_b64_tr_b16 a[172:173], v199
  v_mfma_f32_16x16x32_bf16 a[124:127], a[148:151], v[148:151], a[124:127]
  ds_read_b64_tr_b16 a[174:175], v199 offset:2048
  buffer_store_dword v189, v187, s[24:27], 0 offen sc1
  v_mfma_f32_16x16x32_bf16 a[96:99], a[152:155], v[160:163], a[96:99]
  ds_read_b64_tr_b16 a[144:145], v200
  v_mfma_f32_16x16x32_bf16 a[100:103], a[152:155], v[164:167], a[100:103]
  ds_read_b64_tr_b16 a[146:147], v200 offset:2048
  s_waitcnt lgkmcnt(4)
  v_mfma_f32_16x16x32_bf16 a[104:107], a[156:159], v[160:163], a[104:107]
  ds_read_b64_tr_b16 a[148:149], v201
  v_mfma_f32_16x16x32_bf16 a[108:111], a[156:159], v[164:167], a[108:111]
  ds_read_b64_tr_b16 a[150:151], v201 offset:2048
  v_mfma_f32_16x16x32_bf16 a[112:115], a[160:163], v[160:163], a[112:115]
  ds_read_b64_tr_b16 a[152:153], v198 offset:12288
  buffer_load_dwordx4 v212, s[12:15], s44 offen offset:3072 lds
  s_add_u32 m0, s46, 4096
  v_mfma_f32_16x16x32_bf16 a[116:119], a[160:163], v[164:167], a[116:119]
  ds_read_b64_tr_b16 a[154:155], v198 offset:14336
  v_mfma_f32_16x16x32_bf16 a[120:123], a[164:167], v[160:163], a[120:123]
  ds_read_b64_tr_b16 a[156:157], v199 offset:12288
  v_mfma_f32_16x16x32_bf16 a[124:127], a[164:167], v[164:167], a[124:127]
  ds_read_b64_tr_b16 a[158:159], v199 offset:14336
  v_mfma_f32_16x16x32_bf16 v[64:67], a[168:171], a[8:11], v[64:67]
  ds_read_b64_tr_b16 a[160:161], v200 offset:12288
  v_mfma_f32_16x16x32_bf16 v[68:71], a[168:171], a[12:15], v[68:71]
  ds_read_b64_tr_b16 a[162:163], v200 offset:14336
  s_add_u32 s74, s62, 8192
  buffer_load_dwordx4 a[52:55], v226, s[24:27], s74 offen offset:3072 sc1
  s_waitcnt lgkmcnt(4)
  v_mfma_f32_16x16x32_bf16 v[72:75], a[172:175], a[8:11], v[72:75]
  ds_read_b64_tr_b16 a[164:165], v201 offset:12288
  v_mfma_f32_16x16x32_bf16 v[76:79], a[172:175], a[12:15], v[76:79]
  ds_read_b64_tr_b16 a[166:167], v201 offset:14336
  v_accvgpr_read_b32 v228, a96
  v_accvgpr_read_b32 v229, a97
  v_mfma_f32_16x16x32_bf16 v[80:83], a[144:147], a[8:11], v[80:83]
  ds_read_b64_tr_b16 a[168:169], v198 offset:4096
  v_accvgpr_read_b32 v230, a98
  v_accvgpr_read_b32 v231, a99
  v_mfma_f32_16x16x32_bf16 v[84:87], a[144:147], a[12:15], v[84:87]
  ds_read_b64_tr_b16 a[170:171], v198 offset:6144
  v_accvgpr_read_b32 v232, a100
  v_accvgpr_read_b32 v233, a101
  v_accvgpr_read_b32 v234, a102
  v_mfma_f32_16x16x32_bf16 v[88:91], a[148:151], a[8:11], v[88:91]
  ds_read_b64_tr_b16 a[172:173], v199 offset:4096
  buffer_load_dwordx4 v213, s[12:15], s44 offen lds
  v_accvgpr_read_b32 v235, a103
  v_mfma_f32_16x16x32_bf16 v[92:95], a[148:151], a[12:15], v[92:95]
  ds_read_b64_tr_b16 a[174:175], v199 offset:6144
  v_cvt_pk_bf16_f32 v228, v228, v229
  v_cvt_pk_bf16_f32 v229, v230, v231
  buffer_load_dwordx4 v214, s[12:15], s44 offen offset:1024 lds
  v_mfma_f32_16x16x32_bf16 v[96:99], a[152:155], a[8:11], v[96:99]
  ds_read_b64_tr_b16 a[144:145], v200 offset:4096
  s_add_u32 s44, s66, 221824
  s_add_u32 m0, s46, 24576
  v_cvt_pk_bf16_f32 v230, v232, v233
  v_mfma_f32_16x16x32_bf16 v[100:103], a[152:155], a[12:15], v[100:103]
  ds_read_b64_tr_b16 a[146:147], v200 offset:6144
  v_cvt_pk_bf16_f32 v231, v234, v235
  s_waitcnt lgkmcnt(4)
  v_mfma_f32_16x16x32_bf16 v[104:107], a[156:159], a[8:11], v[104:107]
  ds_read_b64_tr_b16 a[148:149], v201 offset:4096
  v_mfma_f32_16x16x32_bf16 v[108:111], a[156:159], a[12:15], v[108:111]
  ds_read_b64_tr_b16 a[150:151], v201 offset:6144
  v_mfma_f32_16x16x32_bf16 v[112:115], a[160:163], a[8:11], v[112:115]
  ds_read_b64_tr_b16 a[152:153], v198 offset:16384
  v_mfma_f32_16x16x32_bf16 v[116:119], a[160:163], a[12:15], v[116:119]
  ds_read_b64_tr_b16 a[154:155], v198 offset:18432
  s_add_u32 s74, s62, 12288
  buffer_load_dwordx4 a[56:59], v226, s[24:27], s74 offen sc1
  v_mfma_f32_16x16x32_bf16 v[120:123], a[164:167], a[8:11], v[120:123]
  ds_read_b64_tr_b16 a[156:157], v199 offset:16384
  v_mfma_f32_16x16x32_bf16 v[124:127], a[164:167], a[12:15], v[124:127]
  ds_read_b64_tr_b16 a[158:159], v199 offset:18432
  v_mfma_f32_16x16x32_bf16 v[64:67], a[168:171], a[16:19], v[64:67]
  ds_read_b64_tr_b16 a[160:161], v200 offset:16384
  v_mfma_f32_16x16x32_bf16 v[68:71], a[168:171], a[20:23], v[68:71]
  ds_read_b64_tr_b16 a[162:163], v200 offset:18432
  s_waitcnt lgkmcnt(4)
  v_mfma_f32_16x16x32_bf16 v[72:75], a[172:175], a[16:19], v[72:75]
  ds_read_b64_tr_b16 a[164:165], v201 offset:16384
  s_add_u32 s74, s62, 12288
  buffer_load_dwordx4 a[60:63], v226, s[24:27], s74 offen offset:1024 sc1
  v_mfma_f32_16x16x32_bf16 v[76:79], a[172:175], a[20:23], v[76:79]
  ds_read_b64_tr_b16 a[166:167], v201 offset:18432
  v_mfma_f32_16x16x32_bf16 v[80:83], a[144:147], a[16:19], v[80:83]
  ds_read_b64_tr_b16 a[168:169], v198 offset:8192
  v_mfma_f32_16x16x32_bf16 v[84:87], a[144:147], a[20:23], v[84:87]
  ds_read_b64_tr_b16 a[170:171], v198 offset:10240
  v_mfma_f32_16x16x32_bf16 v[88:91], a[148:151], a[16:19], v[88:91]
  ds_read_b64_tr_b16 a[172:173], v199 offset:8192
  v_mfma_f32_16x16x32_bf16 v[92:95], a[148:151], a[20:23], v[92:95]
  ds_read_b64_tr_b16 a[174:175], v199 offset:10240
  s_add_u32 s74, s62, 12288
  buffer_load_dwordx4 a[64:67], v226, s[24:27], s74 offen offset:2048 sc1
  v_mfma_f32_16x16x32_bf16 v[96:99], a[152:155], a[16:19], v[96:99]
  ds_read_b64_tr_b16 a[144:145], v200 offset:8192
  v_mfma_f32_16x16x32_bf16 v[100:103], a[152:155], a[20:23], v[100:103]
  ds_read_b64_tr_b16 a[146:147], v200 offset:10240
  s_add_u32 s74, s62, 12288
  buffer_load_dwordx4 a[68:71], v226, s[24:27], s74 offen offset:3072 sc1
  s_waitcnt lgkmcnt(4)
  v_mfma_f32_16x16x32_bf16 v[104:107], a[156:159], a[16:19], v[104:107]
  ds_read_b64_tr_b16 a[148:149], v201 offset:8192
  v_mfma_f32_16x16x32_bf16 v[108:111], a[156:159], a[20:23], v[108:111]
  ds_read_b64_tr_b16 a[150:151], v201 offset:10240
  v_mfma_f32_16x16x32_bf16 v[112:115], a[160:163], a[16:19], v[112:115]
  ds_read_b64_tr_b16 a[152:153], v198 offset:20480
  v_mfma_f32_16x16x32_bf16 v[116:119], a[160:163], a[20:23], v[116:119]
  ds_read_b64_tr_b16 a[154:155], v198 offset:22528
  v_mfma_f32_16x16x32_bf16 v[120:123], a[164:167], a[16:19], v[120:123]
  ds_read_b64_tr_b16 a[156:157], v199 offset:20480
  v_mfma_f32_16x16x32_bf16 v[124:127], a[164:167], a[20:23], v[124:127]
  ds_read_b64_tr_b16 a[158:159], v199 offset:22528
  buffer_load_dwordx4 v209, s[12:15], s44 offen lds
  buffer_load_dwordx4 v210, s[12:15], s44 offen offset:1024 lds
  buffer_load_dwordx4 v211, s[12:15], s44 offen offset:2048 lds
  buffer_load_dwordx4 v212, s[12:15], s44 offen offset:3072 lds
  s_add_u32 m0, s46, 28672
  s_nop 0
  buffer_load_dwordx4 v213, s[12:15], s44 offen lds
  buffer_load_dwordx4 v214, s[12:15], s44 offen offset:1024 lds
  v_mfma_f32_16x16x32_bf16 v[64:67], a[168:171], a[24:27], v[64:67]
  ds_read_b64_tr_b16 a[160:161], v200 offset:20480
  v_mfma_f32_16x16x32_bf16 v[68:71], a[168:171], a[28:31], v[68:71]
  ds_read_b64_tr_b16 a[162:163], v200 offset:22528
  s_waitcnt lgkmcnt(4)
  v_mfma_f32_16x16x32_bf16 v[72:75], a[172:175], a[24:27], v[72:75]
  ds_read_b64_tr_b16 a[164:165], v201 offset:20480
  s_waitcnt vmcnt(27)
  v_mfma_f32_16x16x32_bf16 v[76:79], a[172:175], a[28:31], v[76:79]
  ds_read_b64_tr_b16 a[166:167], v201 offset:22528
  buffer_store_dwordx4 v[228:231], v226, s[24:27], s54 offen sc1
  v_accvgpr_read_b32 v236, a104
  v_accvgpr_read_b32 v237, a105
  v_accvgpr_read_b32 v238, a106
  v_accvgpr_read_b32 v239, a107
  v_accvgpr_read_b32 v240, a108
  v_accvgpr_read_b32 v241, a109
  v_accvgpr_read_b32 v242, a110
  v_accvgpr_read_b32 v243, a111
  v_cvt_pk_bf16_f32 v236, v236, v237
  v_cvt_pk_bf16_f32 v237, v238, v239
  v_cvt_pk_bf16_f32 v238, v240, v241
  v_cvt_pk_bf16_f32 v239, v242, v243
  buffer_store_dwordx4 v[236:239], v226, s[24:27], s54 offen offset:1024 sc1
  v_accvgpr_read_b32 v228, a112
  v_accvgpr_read_b32 v229, a113
  v_accvgpr_read_b32 v230, a114
  v_accvgpr_read_b32 v231, a115
  v_accvgpr_read_b32 v232, a116
  v_accvgpr_read_b32 v233, a117
  v_accvgpr_read_b32 v234, a118
  v_accvgpr_read_b32 v235, a119
  v_cvt_pk_bf16_f32 v228, v228, v229
  v_cvt_pk_bf16_f32 v229, v230, v231
  v_cvt_pk_bf16_f32 v230, v232, v233
  v_cvt_pk_bf16_f32 v231, v234, v235
  buffer_store_dwordx4 v[228:231], v226, s[24:27], s54 offen offset:2048 sc1
  v_accvgpr_read_b32 v236, a120
  v_accvgpr_read_b32 v237, a121
  v_accvgpr_read_b32 v238, a122
  v_accvgpr_read_b32 v239, a123
  v_accvgpr_read_b32 v240, a124
  v_accvgpr_read_b32 v241, a125
  v_accvgpr_read_b32 v242, a126
  v_accvgpr_read_b32 v243, a127
  v_cvt_pk_bf16_f32 v236, v236, v237
  v_cvt_pk_bf16_f32 v237, v238, v239
  v_cvt_pk_bf16_f32 v238, v240, v241
  v_cvt_pk_bf16_f32 v239, v242, v243
  buffer_store_dwordx4 v[236:239], v226, s[24:27], s54 offen offset:3072 sc1
  s_add_u32 s54, s54, 4096
  s_barrier
  v_mfma_f32_16x16x32_bf16 v[80:83], a[144:147], a[24:27], v[80:83]
  ds_read_b64_tr_b16 a[168:169], v198 offset:24576
  s_add_u32 s44, s72, 368640
  v_mfma_f32_16x16x32_bf16 v[84:87], a[144:147], a[28:31], v[84:87]
  ds_read_b64_tr_b16 a[170:171], v198 offset:26624
  s_add_u32 m0, s46, 49152
  v_mfma_f32_16x16x32_bf16 v[88:91], a[148:151], a[24:27], v[88:91]
  ds_read_b64_tr_b16 a[172:173], v199 offset:24576
  v_mfma_f32_16x16x32_bf16 v[92:95], a[148:151], a[28:31], v[92:95]
  ds_read_b64_tr_b16 a[174:175], v199 offset:26624
  v_mfma_f32_16x16x32_bf16 v[96:99], a[152:155], a[24:27], v[96:99]
  ds_read_b64_tr_b16 a[144:145], v200 offset:24576
  v_mfma_f32_16x16x32_bf16 v[100:103], a[152:155], a[28:31], v[100:103]
  ds_read_b64_tr_b16 a[146:147], v200 offset:26624
  s_waitcnt lgkmcnt(4)
  v_mfma_f32_16x16x32_bf16 v[104:107], a[156:159], a[24:27], v[104:107]
  ds_read_b64_tr_b16 a[148:149], v201 offset:24576
  buffer_load_dwordx4 v203, s[20:23], s44 offen lds
  v_mfma_f32_16x16x32_bf16 v[108:111], a[156:159], a[28:31], v[108:111]
  ds_read_b64_tr_b16 a[150:151], v201 offset:26624
  v_mfma_f32_16x16x32_bf16 v[112:115], a[160:163], a[24:27], v[112:115]
  ds_read_b64_tr_b16 a[152:153], v198 offset:36864
  v_mfma_f32_16x16x32_bf16 v[116:119], a[160:163], a[28:31], v[116:119]
  ds_read_b64_tr_b16 a[154:155], v198 offset:38912
  v_mfma_f32_16x16x32_bf16 v[120:123], a[164:167], a[24:27], v[120:123]
  ds_read_b64_tr_b16 a[156:157], v199 offset:36864
  v_mfma_f32_16x16x32_bf16 v[124:127], a[164:167], a[28:31], v[124:127]
  ds_read_b64_tr_b16 a[158:159], v199 offset:38912
  v_mfma_f32_16x16x32_bf16 v[0:3], a[168:171], a[8:11], v[0:3]
  ds_read_b64_tr_b16 a[160:161], v200 offset:36864
  v_mfma_f32_16x16x32_bf16 v[4:7], a[168:171], a[12:15], v[4:7]
  ds_read_b64_tr_b16 a[162:163], v200 offset:38912
  s_waitcnt lgkmcnt(4)
  v_mfma_f32_16x16x32_bf16 v[8:11], a[172:175], a[8:11], v[8:11]
  ds_read_b64_tr_b16 a[164:165], v201 offset:36864
  buffer_load_dword v202, v188, s[24:27], 0 offen sc1
  v_mfma_f32_16x16x32_bf16 v[12:15], a[172:175], a[12:15], v[12:15]
  ds_read_b64_tr_b16 a[166:167], v201 offset:38912
  v_mfma_f32_16x16x32_bf16 v[16:19], a[144:147], a[8:11], v[16:19]
  ds_read_b64_tr_b16 a[168:169], v198 offset:28672
  v_mfma_f32_16x16x32_bf16 v[20:23], a[144:147], a[12:15], v[20:23]
  ds_read_b64_tr_b16 a[170:171], v198 offset:30720
  v_mfma_f32_16x16x32_bf16 v[24:27], a[148:151], a[8:11], v[24:27]
  ds_read_b64_tr_b16 a[172:173], v199 offset:28672
  v_mfma_f32_16x16x32_bf16 v[28:31], a[148:151], a[12:15], v[28:31]
  ds_read_b64_tr_b16 a[174:175], v199 offset:30720
  buffer_load_dwordx4 v204, s[20:23], s44 offen offset:1024 lds
  v_mfma_f32_16x16x32_bf16 v[32:35], a[152:155], a[8:11], v[32:35]
  ds_read_b64_tr_b16 a[144:145], v200 offset:28672
  v_mfma_f32_16x16x32_bf16 v[36:39], a[152:155], a[12:15], v[36:39]
  ds_read_b64_tr_b16 a[146:147], v200 offset:30720
  s_waitcnt lgkmcnt(4)
  v_mfma_f32_16x16x32_bf16 v[40:43], a[156:159], a[8:11], v[40:43]
  ds_read_b64_tr_b16 a[148:149], v201 offset:28672
  v_mfma_f32_16x16x32_bf16 v[44:47], a[156:159], a[12:15], v[44:47]
  ds_read_b64_tr_b16 a[150:151], v201 offset:30720
  v_mfma_f32_16x16x32_bf16 v[48:51], a[160:163], a[8:11], v[48:51]
  ds_read_b64_tr_b16 a[152:153], v198 offset:40960
  v_mfma_f32_16x16x32_bf16 v[52:55], a[160:163], a[12:15], v[52:55]
  ds_read_b64_tr_b16 a[154:155], v198 offset:43008
  v_mfma_f32_16x16x32_bf16 v[56:59], a[164:167], a[8:11], v[56:59]
  ds_read_b64_tr_b16 a[156:157], v199 offset:40960
  buffer_load_dwordx4 v205, s[20:23], s44 offen offset:2048 lds
  v_mfma_f32_16x16x32_bf16 v[60:63], a[164:167], a[12:15], v[60:63]
  ds_read_b64_tr_b16 a[158:159], v199 offset:43008
  v_mfma_f32_16x16x32_bf16 v[0:3], a[168:171], a[16:19], v[0:3]
  ds_read_b64_tr_b16 a[160:161], v200 offset:40960
  v_mfma_f32_16x16x32_bf16 v[4:7], a[168:171], a[20:23], v[4:7]
  ds_read_b64_tr_b16 a[162:163], v200 offset:43008
  s_waitcnt lgkmcnt(4)
  v_mfma_f32_16x16x32_bf16 v[8:11], a[172:175], a[16:19], v[8:11]
  ds_read_b64_tr_b16 a[164:165], v201 offset:40960
  v_mfma_f32_16x16x32_bf16 v[12:15], a[172:175], a[20:23], v[12:15]
  ds_read_b64_tr_b16 a[166:167], v201 offset:43008
  v_mfma_f32_16x16x32_bf16 v[16:19], a[144:147], a[16:19], v[16:19]
  ds_read_b64_tr_b16 a[168:169], v198 offset:32768
  v_mfma_f32_16x16x32_bf16 v[20:23], a[144:147], a[20:23], v[20:23]
  ds_read_b64_tr_b16 a[170:171], v198 offset:34816
  buffer_load_dwordx4 v206, s[20:23], s44 offen offset:3072 lds
  v_mfma_f32_16x16x32_bf16 v[24:27], a[148:151], a[16:19], v[24:27]
  ds_read_b64_tr_b16 a[172:173], v199 offset:32768
  s_add_u32 m0, s46, 53248
  v_mfma_f32_16x16x32_bf16 v[28:31], a[148:151], a[20:23], v[28:31]
  ds_read_b64_tr_b16 a[174:175], v199 offset:34816
  v_mfma_f32_16x16x32_bf16 v[32:35], a[152:155], a[16:19], v[32:35]
  ds_read_b64_tr_b16 a[144:145], v200 offset:32768
  v_mfma_f32_16x16x32_bf16 v[36:39], a[152:155], a[20:23], v[36:39]
  ds_read_b64_tr_b16 a[146:147], v200 offset:34816
  s_waitcnt lgkmcnt(4)
  v_mfma_f32_16x16x32_bf16 v[40:43], a[156:159], a[16:19], v[40:43]
  ds_read_b64_tr_b16 a[148:149], v201 offset:32768
  v_mfma_f32_16x16x32_bf16 v[44:47], a[156:159], a[20:23], v[44:47]
  ds_read_b64_tr_b16 a[150:151], v201 offset:34816
  v_mfma_f32_16x16x32_bf16 v[48:51], a[160:163], a[16:19], v[48:51]
  ds_read_b64_tr_b16 a[152:153], v198 offset:45056
  buffer_load_dwordx4 v207, s[20:23], s44 offen lds
  v_mfma_f32_16x16x32_bf16 v[52:55], a[160:163], a[20:23], v[52:55]
  ds_read_b64_tr_b16 a[154:155], v198 offset:47104
  v_mfma_f32_16x16x32_bf16 v[56:59], a[164:167], a[16:19], v[56:59]
  ds_read_b64_tr_b16 a[156:157], v199 offset:45056
  v_mfma_f32_16x16x32_bf16 v[60:63], a[164:167], a[20:23], v[60:63]
  ds_read_b64_tr_b16 a[158:159], v199 offset:47104
  buffer_load_dwordx4 v208, s[20:23], s44 offen offset:1024 lds
  v_mfma_f32_16x16x32_bf16 v[0:3], a[168:171], a[24:27], v[0:3]
  ds_read_b64_tr_b16 a[160:161], v200 offset:45056
  v_mfma_f32_16x16x32_bf16 v[4:7], a[168:171], a[28:31], v[4:7]
  ds_read_b64_tr_b16 a[162:163], v200 offset:47104
  s_waitcnt lgkmcnt(4)
  v_mfma_f32_16x16x32_bf16 v[8:11], a[172:175], a[24:27], v[8:11]
  ds_read_b64_tr_b16 a[164:165], v201 offset:45056
  s_waitcnt vmcnt(32)
  v_mfma_f32_16x16x32_bf16 v[12:15], a[172:175], a[28:31], v[12:15]
  ds_read_b64_tr_b16 a[166:167], v201 offset:47104
  s_barrier
  v_mfma_f32_16x16x32_bf16 v[16:19], a[144:147], a[24:27], v[16:19]
  ds_read_b64_tr_b16 a[168:169], v194 offset:24576
  s_add_u32 s44, s66, 222080
  v_mfma_f32_16x16x32_bf16 v[20:23], a[144:147], a[28:31], v[20:23]
  ds_read_b64_tr_b16 a[170:171], v194 offset:26624
  s_add_u32 m0, s46, 98304
  v_mfma_f32_16x16x32_bf16 v[24:27], a[148:151], a[24:27], v[24:27]
  ds_read_b64_tr_b16 a[172:173], v195 offset:24576
  v_mfma_f32_16x16x32_bf16 v[28:31], a[148:151], a[28:31], v[28:31]
  ds_read_b64_tr_b16 a[174:175], v195 offset:26624
  buffer_load_dwordx4 v209, s[12:15], s44 offen lds
  v_mfma_f32_16x16x32_bf16 v[32:35], a[152:155], a[24:27], v[32:35]
  ds_read_b64_tr_b16 a[144:145], v196 offset:24576
  v_mfma_f32_16x16x32_bf16 v[36:39], a[152:155], a[28:31], v[36:39]
  ds_read_b64_tr_b16 a[146:147], v196 offset:26624
  s_waitcnt lgkmcnt(4)
  v_mfma_f32_16x16x32_bf16 v[40:43], a[156:159], a[24:27], v[40:43]
  ds_read_b64_tr_b16 a[148:149], v197 offset:24576
  v_mfma_f32_16x16x32_bf16 v[44:47], a[156:159], a[28:31], v[44:47]
  ds_read_b64_tr_b16 a[150:151], v197 offset:26624
  v_mfma_f32_16x16x32_bf16 v[48:51], a[160:163], a[24:27], v[48:51]
  ds_read_b64_tr_b16 a[152:153], v194 offset:36864
  v_mfma_f32_16x16x32_bf16 v[52:55], a[160:163], a[28:31], v[52:55]
  ds_read_b64_tr_b16 a[154:155], v194 offset:38912
  v_mfma_f32_16x16x32_bf16 v[56:59], a[164:167], a[24:27], v[56:59]
  ds_read_b64_tr_b16 a[156:157], v195 offset:36864
  buffer_load_dwordx4 v210, s[12:15], s44 offen offset:1024 lds
  v_mfma_f32_16x16x32_bf16 v[60:63], a[164:167], a[28:31], v[60:63]
  ds_read_b64_tr_b16 a[158:159], v195 offset:38912
  v_mfma_f32_16x16x32_bf16 v[64:67], a[168:171], a[32:35], v[64:67]
  ds_read_b64_tr_b16 a[160:161], v196 offset:36864
  v_mfma_f32_16x16x32_bf16 v[68:71], a[168:171], a[36:39], v[68:71]
  ds_read_b64_tr_b16 a[162:163], v196 offset:38912
  s_waitcnt lgkmcnt(4)
  v_mfma_f32_16x16x32_bf16 v[72:75], a[172:175], a[32:35], v[72:75]
  ds_read_b64_tr_b16 a[164:165], v197 offset:36864
  v_mfma_f32_16x16x32_bf16 v[76:79], a[172:175], a[36:39], v[76:79]
  ds_read_b64_tr_b16 a[166:167], v197 offset:38912
  v_mfma_f32_16x16x32_bf16 v[80:83], a[144:147], a[32:35], v[80:83]
  ds_read_b64_tr_b16 a[168:169], v194 offset:28672
  v_mfma_f32_16x16x32_bf16 v[84:87], a[144:147], a[36:39], v[84:87]
  ds_read_b64_tr_b16 a[170:171], v194 offset:30720
  buffer_load_dwordx4 v211, s[12:15], s44 offen offset:2048 lds
  v_mfma_f32_16x16x32_bf16 v[88:91], a[148:151], a[32:35], v[88:91]
  ds_read_b64_tr_b16 a[172:173], v195 offset:28672
  v_mfma_f32_16x16x32_bf16 v[92:95], a[148:151], a[36:39], v[92:95]
  ds_read_b64_tr_b16 a[174:175], v195 offset:30720
  v_mfma_f32_16x16x32_bf16 v[96:99], a[152:155], a[32:35], v[96:99]
  ds_read_b64_tr_b16 a[144:145], v196 offset:28672
  v_mfma_f32_16x16x32_bf16 v[100:103], a[152:155], a[36:39], v[100:103]
  ds_read_b64_tr_b16 a[146:147], v196 offset:30720
  s_waitcnt lgkmcnt(4)
  v_mfma_f32_16x16x32_bf16 v[104:107], a[156:159], a[32:35], v[104:107]
  ds_read_b64_tr_b16 a[148:149], v197 offset:28672
  v_mfma_f32_16x16x32_bf16 v[108:111], a[156:159], a[36:39], v[108:111]
  ds_read_b64_tr_b16 a[150:151], v197 offset:30720
  v_mfma_f32_16x16x32_bf16 v[112:115], a[160:163], a[32:35], v[112:115]
  ds_read_b64_tr_b16 a[152:153], v194 offset:40960
  buffer_load_dwordx4 v212, s[12:15], s44 offen offset:3072 lds
  v_mfma_f32_16x16x32_bf16 v[116:119], a[160:163], a[36:39], v[116:119]
  ds_read_b64_tr_b16 a[154:155], v194 offset:43008
  s_add_u32 m0, s46, 102400
  v_mfma_f32_16x16x32_bf16 v[120:123], a[164:167], a[32:35], v[120:123]
  ds_read_b64_tr_b16 a[156:157], v195 offset:40960
  v_mfma_f32_16x16x32_bf16 v[124:127], a[164:167], a[36:39], v[124:127]
  ds_read_b64_tr_b16 a[158:159], v195 offset:43008
  s_waitcnt vmcnt(35)
  v_mfma_f32_16x16x32_bf16 v[64:67], a[168:171], a[40:43], v[64:67]
  ds_read_b64_tr_b16 a[160:161], v196 offset:40960
  s_waitcnt vmcnt(33)
  v_mfma_f32_16x16x32_bf16 v[68:71], a[168:171], a[44:47], v[68:71]
  ds_read_b64_tr_b16 a[162:163], v196 offset:43008
  s_waitcnt lgkmcnt(4)
  v_mfma_f32_16x16x32_bf16 v[72:75], a[172:175], a[40:43], v[72:75]
  ds_read_b64_tr_b16 a[164:165], v197 offset:40960
  v_mfma_f32_16x16x32_bf16 v[76:79], a[172:175], a[44:47], v[76:79]
  ds_read_b64_tr_b16 a[166:167], v197 offset:43008
  buffer_load_dwordx4 v213, s[12:15], s44 offen lds
  v_mfma_f32_16x16x32_bf16 v[80:83], a[144:147], a[40:43], v[80:83]
  ds_read_b64_tr_b16 a[168:169], v194 offset:32768
  v_mfma_f32_16x16x32_bf16 v[84:87], a[144:147], a[44:47], v[84:87]
  ds_read_b64_tr_b16 a[170:171], v194 offset:34816
  v_mfma_f32_16x16x32_bf16 v[88:91], a[148:151], a[40:43], v[88:91]
  ds_read_b64_tr_b16 a[172:173], v195 offset:32768
  v_mfma_f32_16x16x32_bf16 v[92:95], a[148:151], a[44:47], v[92:95]
  ds_read_b64_tr_b16 a[174:175], v195 offset:34816
  v_mfma_f32_16x16x32_bf16 v[96:99], a[152:155], a[40:43], v[96:99]
  ds_read_b64_tr_b16 a[144:145], v196 offset:32768
  v_mfma_f32_16x16x32_bf16 v[100:103], a[152:155], a[44:47], v[100:103]
  ds_read_b64_tr_b16 a[146:147], v196 offset:34816
  s_waitcnt lgkmcnt(4)
  v_mfma_f32_16x16x32_bf16 v[104:107], a[156:159], a[40:43], v[104:107]
  ds_read_b64_tr_b16 a[148:149], v197 offset:32768
  buffer_load_dwordx4 v214, s[12:15], s44 offen offset:1024 lds
  v_mfma_f32_16x16x32_bf16 v[108:111], a[156:159], a[44:47], v[108:111]
  ds_read_b64_tr_b16 a[150:151], v197 offset:34816
  v_mfma_f32_16x16x32_bf16 v[112:115], a[160:163], a[40:43], v[112:115]
  ds_read_b64_tr_b16 a[152:153], v194 offset:45056
  v_mfma_f32_16x16x32_bf16 v[116:119], a[160:163], a[44:47], v[116:119]
  ds_read_b64_tr_b16 a[154:155], v194 offset:47104
  v_mfma_f32_16x16x32_bf16 v[120:123], a[164:167], a[40:43], v[120:123]
  ds_read_b64_tr_b16 a[156:157], v195 offset:45056
  v_mfma_f32_16x16x32_bf16 v[124:127], a[164:167], a[44:47], v[124:127]
  ds_read_b64_tr_b16 a[158:159], v195 offset:47104
  s_waitcnt vmcnt(33)
  v_mfma_f32_16x16x32_bf16 v[64:67], a[168:171], a[48:51], v[64:67]
  ds_read_b64_tr_b16 a[160:161], v196 offset:45056
  s_waitcnt vmcnt(29)
  v_mfma_f32_16x16x32_bf16 v[68:71], a[168:171], a[52:55], v[68:71]
  ds_read_b64_tr_b16 a[162:163], v196 offset:47104
  s_waitcnt vmcnt(11)
  v_cmp_le_u32 vcc, 4, v202
  s_nop 3
  s_cmp_eq_u64 vcc, -1
  s_cbranch_scc0 L_slow_D1
L_back_D1:
  s_waitcnt lgkmcnt(4)
  v_mfma_f32_16x16x32_bf16 v[72:75], a[172:175], a[48:51], v[72:75]
  ds_read_b64_tr_b16 a[164:165], v197 offset:45056
  v_mfma_f32_16x16x32_bf16 v[76:79], a[172:175], a[52:55], v[76:79]
  ds_read_b64_tr_b16 a[166:167], v197 offset:47104
  s_barrier
  v_mfma_f32_16x16x32_bf16 v[80:83], a[144:147], a[48:51], v[80:83]
  ds_read_b64_tr_b16 a[168:169], v190
  v_mov_b32 v189, 5
  v_mfma_f32_16x16x32_bf16 v[84:87], a[144:147], a[52:55], v[84:87]
  ds_read_b64_tr_b16 a[170:171], v190 offset:2048
  buffer_store_dword v189, v187, s[24:27], 0 offen sc1
  v_mfma_f32_16x16x32_bf16 v[88:91], a[148:151], a[48:51], v[88:91]
  ds_read_b64_tr_b16 a[172:173], v191
  s_add_u32 s44, s72, 516096
  v_mfma_f32_16x16x32_bf16 v[92:95], a[148:151], a[52:55], v[92:95]
  ds_read_b64_tr_b16 a[174:175], v191 offset:2048
  s_add_u32 m0, s46, 122880
  v_mfma_f32_16x16x32_bf16 v[96:99], a[152:155], a[48:51], v[96:99]
  ds_read_b64_tr_b16 a[144:145], v192
  v_mfma_f32_16x16x32_bf16 v[100:103], a[152:155], a[52:55], v[100:103]
  ds_read_b64_tr_b16 a[146:147], v192 offset:2048
  s_waitcnt lgkmcnt(4)
  v_mfma_f32_16x16x32_bf16 v[104:107], a[156:159], a[48:51], v[104:107]
  ds_read_b64_tr_b16 a[148:149], v193
  s_add_u32 s74, s62, 16384
  buffer_load_dwordx4 a[72:75], v226, s[24:27], s74 offen offset:2048 sc1
  v_mfma_f32_16x16x32_bf16 v[108:111], a[156:159], a[52:55], v[108:111]
  ds_read_b64_tr_b16 a[150:151], v193 offset:2048
  s_mov_b32 s36, s92
  v_mfma_f32_16x16x32_bf16 v[112:115], a[160:163], a[48:51], v[112:115]
  ds_read_b64_tr_b16 a[152:153], v190 offset:12288
  s_mov_b32 s37, s93
  v_mfma_f32_16x16x32_bf16 v[116:119], a[160:163], a[52:55], v[116:119]
  ds_read_b64_tr_b16 a[154:155], v190 offset:14336
  s_mov_b32 s38, 4718592
  v_mfma_f32_16x16x32_bf16 v[120:123], a[164:167], a[48:51], v[120:123]
  ds_read_b64_tr_b16 a[156:157], v191 offset:12288
  s_mov_b32 s39, 0x20000
  v_mfma_f32_16x16x32_bf16 v[124:127], a[164:167], a[52:55], v[124:127]
  ds_read_b64_tr_b16 a[158:159], v191 offset:14336
  s_add_u32 s74, s62, 16384
  buffer_load_dwordx4 a[76:79], v226, s[24:27], s74 offen offset:3072 sc1
  v_mfma_f32_16x16x32_bf16 v[0:3], a[168:171], a[32:35], v[0:3]
  ds_read_b64_tr_b16 a[160:161], v192 offset:12288
  s_mov_b32 s16, s80
  v_mfma_f32_16x16x32_bf16 v[4:7], a[168:171], a[36:39], v[4:7]
  ds_read_b64_tr_b16 a[162:163], v192 offset:14336
  s_waitcnt lgkmcnt(4)
  v_mfma_f32_16x16x32_bf16 v[8:11], a[172:175], a[32:35], v[8:11]
  ds_read_b64_tr_b16 a[164:165], v193 offset:12288
  s_mov_b32 s17, s81
  v_mfma_f32_16x16x32_bf16 v[12:15], a[172:175], a[36:39], v[12:15]
  ds_read_b64_tr_b16 a[166:167], v193 offset:14336
  s_mov_b32 s18, 1152
  v_mfma_f32_16x16x32_bf16 v[16:19], a[144:147], a[32:35], v[16:19]
  ds_read_b64_tr_b16 a[168:169], v190 offset:4096
  s_add_u32 s74, s62, 20480
  buffer_load_dwordx4 a[80:83], v226, s[24:27], s74 offen sc1
  v_mfma_f32_16x16x32_bf16 v[20:23], a[144:147], a[36:39], v[20:23]
  ds_read_b64_tr_b16 a[170:171], v190 offset:6144
  s_mov_b32 s19, 0x20000
  v_mfma_f32_16x16x32_bf16 v[24:27], a[148:151], a[32:35], v[24:27]
  ds_read_b64_tr_b16 a[172:173], v191 offset:4096
  s_mov_b32 s56, 0xffff0000
  v_mfma_f32_16x16x32_bf16 v[28:31], a[148:151], a[36:39], v[28:31]
  ds_read_b64_tr_b16 a[174:175], v191 offset:6144
  s_mov_b32 s57, -1
  v_mfma_f32_16x16x32_bf16 v[32:35], a[152:155], a[32:35], v[32:35]
  ds_read_b64_tr_b16 a[144:145], v192 offset:4096
  s_mov_b32 s58, 0xffff5555
  v_mfma_f32_16x16x32_bf16 v[36:39], a[152:155], a[36:39], v[36:39]
  ds_read_b64_tr_b16 a[146:147], v192 offset:6144
  s_waitcnt lgkmcnt(4)
  v_mfma_f32_16x16x32_bf16 v[40:43], a[156:159], a[32:35], v[40:43]
  ds_read_b64_tr_b16 a[148:149], v193 offset:4096
  s_add_u32 s74, s62, 20480
  buffer_load_dwordx4 a[84:87], v226, s[24:27], s74 offen offset:1024 sc1
  v_mfma_f32_16x16x32_bf16 v[44:47], a[156:159], a[36:39], v[44:47]
  ds_read_b64_tr_b16 a[150:151], v193 offset:6144
  s_mov_b32 s59, -1
  v_mfma_f32_16x16x32_bf16 v[48:51], a[160:163], a[32:35], v[48:51]
  ds_read_b64_tr_b16 a[152:153], v190 offset:16384
  s_lshl_b32 s49, s41, 7
  s_add_u32 s49, s49, 46243840
  v_mfma_f32_16x16x32_bf16 v[52:55], a[160:163], a[36:39], v[52:55]
  ds_read_b64_tr_b16 a[154:155], v190 offset:18432
  v_lshlrev_b32 v217, 11, v225
  v_mfma_f32_16x16x32_bf16 v[56:59], a[164:167], a[32:35], v[56:59]
  ds_read_b64_tr_b16 a[156:157], v191 offset:16384
  v_add_u32 v217, s49, v217
  v_mfma_f32_16x16x32_bf16 v[60:63], a[164:167], a[36:39], v[60:63]
  ds_read_b64_tr_b16 a[158:159], v191 offset:18432
  buffer_load_dwordx4 v203, s[20:23], s44 offen lds
  v_mfma_f32_16x16x32_bf16 v[0:3], a[168:171], a[40:43], v[0:3]
  ds_read_b64_tr_b16 a[160:161], v192 offset:16384
  v_cmp_gt_u32 vcc, 16, v225
  v_mov_b32 v218, 0x7ffffff0
  s_nop 0
  v_cndmask_b32 v217, v218, v217, vcc
  v_mfma_f32_16x16x32_bf16 v[4:7], a[168:171], a[44:47], v[4:7]
  ds_read_b64_tr_b16 a[162:163], v192 offset:18432
  s_waitcnt lgkmcnt(4)
  v_mfma_f32_16x16x32_bf16 v[8:11], a[172:175], a[40:43], v[8:11]
  ds_read_b64_tr_b16 a[164:165], v193 offset:16384
  v_and_b32 v219, 15, v225
  v_mfma_f32_16x16x32_bf16 v[12:15], a[172:175], a[44:47], v[12:15]
  ds_read_b64_tr_b16 a[166:167], v193 offset:18432
  v_lshrrev_b32 v220, 4, v225
  v_mfma_f32_16x16x32_bf16 v[16:19], a[144:147], a[40:43], v[16:19]
  ds_read_b64_tr_b16 a[168:169], v190 offset:8192
  s_lshr_b32 s82, s42, 1
  v_mfma_f32_16x16x32_bf16 v[20:23], a[144:147], a[44:47], v[20:23]
  ds_read_b64_tr_b16 a[170:171], v190 offset:10240
  s_lshr_b32 s49, s42, 2
  s_and_b32 s85, s42, 3
  s_and_b32 s55, s40, 1
  s_lshr_b32 s50, s40, 1
  s_lshl_b32 s89, s41, 2
  s_add_u32 s89, s89, s49
  s_lshl_b32 s89, s89, 2
  s_add_u32 s89, s89, s85
  v_mfma_f32_16x16x32_bf16 v[24:27], a[148:151], a[40:43], v[24:27]
  ds_read_b64_tr_b16 a[172:173], v191 offset:8192
  buffer_load_dwordx4 v204, s[20:23], s44 offen offset:1024 lds
  v_mfma_f32_16x16x32_bf16 v[28:31], a[148:151], a[44:47], v[28:31]
  ds_read_b64_tr_b16 a[174:175], v191 offset:10240
  s_lshl_b32 s89, s89, 10
  v_mfma_f32_16x16x32_bf16 v[32:35], a[152:155], a[40:43], v[32:35]
  ds_read_b64_tr_b16 a[144:145], v192 offset:8192
  s_mul_i32 s50, s50, 2097152
  v_mfma_f32_16x16x32_bf16 v[36:39], a[152:155], a[44:47], v[36:39]
  ds_read_b64_tr_b16 a[146:147], v192 offset:10240
  s_waitcnt lgkmcnt(4)
  v_mfma_f32_16x16x32_bf16 v[40:43], a[156:159], a[40:43], v[40:43]
  ds_read_b64_tr_b16 a[148:149], v193 offset:8192
  s_add_u32 s89, s89, s50
  v_mfma_f32_16x16x32_bf16 v[44:47], a[156:159], a[44:47], v[44:47]
  ds_read_b64_tr_b16 a[150:151], v193 offset:10240
  s_lshl_b32 s51, s55, 3
  v_mfma_f32_16x16x32_bf16 v[48:51], a[160:163], a[40:43], v[48:51]
  ds_read_b64_tr_b16 a[152:153], v190 offset:20480
  s_add_u32 s89, s89, s51
  v_mfma_f32_16x16x32_bf16 v[52:55], a[160:163], a[44:47], v[52:55]
  ds_read_b64_tr_b16 a[154:155], v190 offset:22528
  buffer_load_dwordx4 v205, s[20:23], s44 offen offset:2048 lds
  v_mfma_f32_16x16x32_bf16 v[56:59], a[164:167], a[40:43], v[56:59]
  ds_read_b64_tr_b16 a[156:157], v191 offset:20480
  s_add_u32 s89, s89, 16777216
  s_lshl_b32 s86, s41, 2
  s_add_u32 s86, s86, s40
  v_mfma_f32_16x16x32_bf16 v[60:63], a[164:167], a[44:47], v[60:63]
  ds_read_b64_tr_b16 a[158:159], v191 offset:22528
  s_lshl_b32 s86, s86, 15
  s_lshl_b32 s49, s82, 10
  s_add_u32 s86, s86, s49
  s_add_u32 s86, s86, 16384
  buffer_load_dwordx4 v206, s[20:23], s44 offen offset:3072 lds
  s_add_u32 m0, s46, 126976
  s_nop 0
  buffer_load_dwordx4 v207, s[20:23], s44 offen lds
  buffer_load_dwordx4 v208, s[20:23], s44 offen offset:1024 lds
  v_mfma_f32_16x16x32_bf16 v[0:3], a[168:171], a[48:51], v[0:3]
  ds_read_b64_tr_b16 a[160:161], v192 offset:20480
  s_lshl_b32 s87, s82, 4
  v_mfma_f32_16x16x32_bf16 v[4:7], a[168:171], a[52:55], v[4:7]
  ds_read_b64_tr_b16 a[162:163], v192 offset:22528
  s_waitcnt lgkmcnt(4)
  v_mfma_f32_16x16x32_bf16 v[8:11], a[172:175], a[48:51], v[8:11]
  ds_read_b64_tr_b16 a[164:165], v193 offset:20480
  v_mfma_f32_16x16x32_bf16 v[12:15], a[172:175], a[52:55], v[12:15]
  ds_read_b64_tr_b16 a[166:167], v193 offset:22528
  s_barrier
  v_mfma_f32_16x16x32_bf16 v[16:19], a[144:147], a[48:51], v[16:19]
  ds_read_b64_tr_b16 a[168:169], v190 offset:24576
  s_add_u32 s87, s87, 320
  v_mfma_f32_16x16x32_bf16 v[20:23], a[144:147], a[52:55], v[20:23]
  ds_read_b64_tr_b16 a[170:171], v190 offset:26624
  s_lshl_b32 s83, s41, 7
  v_mfma_f32_16x16x32_bf16 v[24:27], a[148:151], a[48:51], v[24:27]
  ds_read_b64_tr_b16 a[172:173], v191 offset:24576
  s_lshl_b32 s49, s40, 5
  v_mfma_f32_16x16x32_bf16 v[28:31], a[148:151], a[52:55], v[28:31]
  ds_read_b64_tr_b16 a[174:175], v191 offset:26624
  s_add_u32 s83, s83, s49
  v_mfma_f32_16x16x32_bf16 v[32:35], a[152:155], a[48:51], v[32:35]
  ds_read_b64_tr_b16 a[144:145], v192 offset:24576
  v_add_u32 v136, s83, v219
  v_mfma_f32_16x16x32_bf16 v[36:39], a[152:155], a[52:55], v[36:39]
  ds_read_b64_tr_b16 a[146:147], v192 offset:26624
  s_waitcnt lgkmcnt(4)
  v_mfma_f32_16x16x32_bf16 v[40:43], a[156:159], a[48:51], v[40:43]
  ds_read_b64_tr_b16 a[148:149], v193 offset:24576
  v_lshlrev_b32 v138, 2, v220
  v_mfma_f32_16x16x32_bf16 v[44:47], a[156:159], a[52:55], v[44:47]
  ds_read_b64_tr_b16 a[150:151], v193 offset:26624
  v_add_u32 v138, s87, v138
  v_mfma_f32_16x16x32_bf16 v[48:51], a[160:163], a[48:51], v[48:51]
  ds_read_b64_tr_b16 a[152:153], v190 offset:36864
  v_mul_u32_u24 v136, 576, v136
  v_mfma_f32_16x16x32_bf16 v[52:55], a[160:163], a[52:55], v[52:55]
  ds_read_b64_tr_b16 a[154:155], v190 offset:38912
  v_add_u32 v136, v136, v138
  v_mfma_f32_16x16x32_bf16 v[56:59], a[164:167], a[48:51], v[56:59]
  ds_read_b64_tr_b16 a[156:157], v191 offset:36864
  v_lshlrev_b32 v137, 1, v136
  v_mfma_f32_16x16x32_bf16 v[60:63], a[164:167], a[52:55], v[60:63]
  ds_read_b64_tr_b16 a[158:159], v191 offset:38912
  v_lshlrev_b32 v138, 1, v138
  v_mfma_f32_16x16x32_bf16 v[64:67], a[168:171], a[56:59], v[64:67]
  ds_read_b64_tr_b16 a[160:161], v192 offset:36864
  v_lshlrev_b32 v136, 2, v136
  v_mfma_f32_16x16x32_bf16 v[68:71], a[168:171], a[60:63], v[68:71]
  ds_read_b64_tr_b16 a[162:163], v192 offset:38912
  s_waitcnt lgkmcnt(4)
  v_mfma_f32_16x16x32_bf16 v[72:75], a[172:175], a[56:59], v[72:75]
  ds_read_b64_tr_b16 a[164:165], v193 offset:36864
  v_accvgpr_read_b32 v222, a249
  v_mfma_f32_16x16x32_bf16 v[76:79], a[172:175], a[60:63], v[76:79]
  ds_read_b64_tr_b16 a[166:167], v193 offset:38912
  v_accvgpr_read_b32 v223, a250
  v_mfma_f32_16x16x32_bf16 v[80:83], a[144:147], a[56:59], v[80:83]
  ds_read_b64_tr_b16 a[168:169], v190 offset:28672
  s_mov_b32 s49, 0
  buffer_load_dwordx2 v[228:229], v137, s[4:7], s49 offen
  v_mfma_f32_16x16x32_bf16 v[84:87], a[144:147], a[60:63], v[84:87]
  ds_read_b64_tr_b16 a[170:171], v190 offset:30720
  v_mfma_f32_16x16x32_bf16 v[88:91], a[148:151], a[56:59], v[88:91]
  ds_read_b64_tr_b16 a[172:173], v191 offset:28672
  v_mfma_f32_16x16x32_bf16 v[92:95], a[148:151], a[60:63], v[92:95]
  ds_read_b64_tr_b16 a[174:175], v191 offset:30720
  v_mfma_f32_16x16x32_bf16 v[96:99], a[152:155], a[56:59], v[96:99]
  ds_read_b64_tr_b16 a[144:145], v192 offset:28672
  v_mfma_f32_16x16x32_bf16 v[100:103], a[152:155], a[60:63], v[100:103]
  ds_read_b64_tr_b16 a[146:147], v192 offset:30720
  s_waitcnt lgkmcnt(4)
  v_mfma_f32_16x16x32_bf16 v[104:107], a[156:159], a[56:59], v[104:107]
  ds_read_b64_tr_b16 a[148:149], v193 offset:28672
  s_mov_b32 s50, 18432
  buffer_load_dwordx2 v[230:231], v137, s[4:7], s50 offen
  v_mfma_f32_16x16x32_bf16 v[108:111], a[156:159], a[60:63], v[108:111]
  ds_read_b64_tr_b16 a[150:151], v193 offset:30720
  v_mfma_f32_16x16x32_bf16 v[112:115], a[160:163], a[56:59], v[112:115]
  ds_read_b64_tr_b16 a[152:153], v190 offset:40960
  v_mfma_f32_16x16x32_bf16 v[116:119], a[160:163], a[60:63], v[116:119]
  ds_read_b64_tr_b16 a[154:155], v190 offset:43008
  v_mfma_f32_16x16x32_bf16 v[120:123], a[164:167], a[56:59], v[120:123]
  ds_read_b64_tr_b16 a[156:157], v191 offset:40960
  v_mfma_f32_16x16x32_bf16 v[124:127], a[164:167], a[60:63], v[124:127]
  ds_read_b64_tr_b16 a[158:159], v191 offset:43008
  s_mov_b32 s49, 0
  buffer_load_dwordx2 v[232:233], v138, s[16:19], s49 offen
  v_mfma_f32_16x16x32_bf16 v[64:67], a[168:171], a[64:67], v[64:67]
  ds_read_b64_tr_b16 a[160:161], v192 offset:40960
  v_mfma_f32_16x16x32_bf16 v[68:71], a[168:171], a[68:71], v[68:71]
  ds_read_b64_tr_b16 a[162:163], v192 offset:43008
  s_waitcnt lgkmcnt(4)
  v_mfma_f32_16x16x32_bf16 v[72:75], a[172:175], a[64:67], v[72:75]
  ds_read_b64_tr_b16 a[164:165], v193 offset:40960
  v_mfma_f32_16x16x32_bf16 v[76:79], a[172:175], a[68:71], v[76:79]
  ds_read_b64_tr_b16 a[166:167], v193 offset:43008
  v_mfma_f32_16x16x32_bf16 v[80:83], a[144:147], a[64:67], v[80:83]
  ds_read_b64_tr_b16 a[168:169], v190 offset:32768
  s_mov_b32 s49, 256
  buffer_load_dwordx2 v[234:235], v137, s[4:7], s49 offen
  v_mfma_f32_16x16x32_bf16 v[84:87], a[144:147], a[68:71], v[84:87]
  ds_read_b64_tr_b16 a[170:171], v190 offset:34816
  v_mfma_f32_16x16x32_bf16 v[88:91], a[148:151], a[64:67], v[88:91]
  ds_read_b64_tr_b16 a[172:173], v191 offset:32768
  v_mfma_f32_16x16x32_bf16 v[92:95], a[148:151], a[68:71], v[92:95]
  ds_read_b64_tr_b16 a[174:175], v191 offset:34816
  v_mfma_f32_16x16x32_bf16 v[96:99], a[152:155], a[64:67], v[96:99]
  ds_read_b64_tr_b16 a[144:145], v192 offset:32768
  v_mfma_f32_16x16x32_bf16 v[100:103], a[152:155], a[68:71], v[100:103]
  ds_read_b64_tr_b16 a[146:147], v192 offset:34816
  s_waitcnt lgkmcnt(4)
  v_mfma_f32_16x16x32_bf16 v[104:107], a[156:159], a[64:67], v[104:107]
  ds_read_b64_tr_b16 a[148:149], v193 offset:32768
  s_mov_b32 s50, 18688
  buffer_load_dwordx2 v[236:237], v137, s[4:7], s50 offen
  v_mfma_f32_16x16x32_bf16 v[108:111], a[156:159], a[68:71], v[108:111]
  ds_read_b64_tr_b16 a[150:151], v193 offset:34816
  v_mfma_f32_16x16x32_bf16 v[112:115], a[160:163], a[64:67], v[112:115]
  ds_read_b64_tr_b16 a[152:153], v190 offset:45056
  v_mfma_f32_16x16x32_bf16 v[116:119], a[160:163], a[68:71], v[116:119]
  ds_read_b64_tr_b16 a[154:155], v190 offset:47104
  v_mfma_f32_16x16x32_bf16 v[120:123], a[164:167], a[64:67], v[120:123]
  ds_read_b64_tr_b16 a[156:157], v191 offset:45056
  v_mfma_f32_16x16x32_bf16 v[124:127], a[164:167], a[68:71], v[124:127]
  ds_read_b64_tr_b16 a[158:159], v191 offset:47104
  buffer_load_dword v218, v217, s[24:27], 0 offen sc1
  v_mfma_f32_16x16x32_bf16 v[64:67], a[168:171], a[0:3], v[64:67]
  ds_read_b64_tr_b16 a[160:161], v192 offset:45056
  v_mfma_f32_16x16x32_bf16 v[68:71], a[168:171], a[4:7], v[68:71]
  ds_read_b64_tr_b16 a[162:163], v192 offset:47104
  s_waitcnt lgkmcnt(4)
  v_mfma_f32_16x16x32_bf16 v[72:75], a[172:175], a[0:3], v[72:75]
  ds_read_b64_tr_b16 a[164:165], v193 offset:45056
  s_waitcnt vmcnt(23)
  v_mfma_f32_16x16x32_bf16 v[76:79], a[172:175], a[4:7], v[76:79]
  ds_read_b64_tr_b16 a[166:167], v193 offset:47104
  s_barrier
  v_mfma_f32_16x16x32_bf16 v[80:83], a[144:147], a[0:3], v[80:83]
  ds_read_b64 a[168:169], v185
  s_mov_b32 s49, 256
  buffer_load_dwordx2 v[238:239], v138, s[16:19], s49 offen
  v_mfma_f32_16x16x32_bf16 v[84:87], a[144:147], a[4:7], v[84:87]
  ds_read_b64 a[170:171], v185 offset:12288
  s_lshr_b32 s49, s42, 2
  s_lshl_b32 s83, s41, 7
  s_lshl_b32 s49, s49, 5
  s_add_u32 s83, s83, s49
  s_lshl_b32 s51, s55, 4
  v_mfma_f32_16x16x32_bf16 v[88:91], a[148:151], a[0:3], v[88:91]
  ds_read_b64 a[172:173], v185 offset:1536
  s_add_u32 s83, s83, s51
  v_mfma_f32_16x16x32_bf16 v[92:95], a[148:151], a[4:7], v[92:95]
  ds_read_b64 a[174:175], v185 offset:13824
  s_lshl_b32 s85, s85, 4
  v_mfma_f32_16x16x32_bf16 v[96:99], a[152:155], a[0:3], v[96:99]
  ds_read_b64 a[144:145], v185 offset:3072
  s_add_u32 s85, s85, 256
  v_mfma_f32_16x16x32_bf16 v[100:103], a[152:155], a[4:7], v[100:103]
  ds_read_b64 a[146:147], v185 offset:15360
  s_waitcnt lgkmcnt(4)
  v_mfma_f32_16x16x32_bf16 v[104:107], a[156:159], a[0:3], v[104:107]
  ds_read_b64 a[148:149], v185 offset:4608
  v_add_u32 v180, s83, v219
  v_mfma_f32_16x16x32_bf16 v[108:111], a[156:159], a[4:7], v[108:111]
  ds_read_b64 a[150:151], v185 offset:16896
  v_lshlrev_b32 v242, 2, v220
  v_mfma_f32_16x16x32_bf16 v[112:115], a[160:163], a[0:3], v[112:115]
  ds_read_b64 a[152:153], v185 offset:6144
  v_add_u32 v242, s85, v242
  v_mfma_f32_16x16x32_bf16 v[116:119], a[160:163], a[4:7], v[116:119]
  ds_read_b64 a[154:155], v185 offset:18432
  v_mul_u32_u24 v139, 576, v180
  v_mfma_f32_16x16x32_bf16 v[120:123], a[164:167], a[0:3], v[120:123]
  ds_read_b64 a[156:157], v185 offset:7680
  v_add_u32 v139, v139, v242
  v_mfma_f32_16x16x32_bf16 v[124:127], a[164:167], a[4:7], v[124:127]
  ds_read_b64 a[158:159], v185 offset:19968
  v_lshlrev_b32 v240, 1, v139
  s_waitcnt vmcnt(16)
  v_mfma_f32_16x16x32_bf16 v[64:67], a[168:171], a[72:75], v[64:67]
  ds_read_b64 a[160:161], v185 offset:9216
  v_lshlrev_b32 v242, 1, v242
  s_waitcnt vmcnt(15)
  v_mfma_f32_16x16x32_bf16 v[68:71], a[168:171], a[76:79], v[68:71]
  ds_read_b64 a[162:163], v185 offset:21504
  s_waitcnt lgkmcnt(4)
  v_mfma_f32_16x16x32_bf16 v[72:75], a[172:175], a[72:75], v[72:75]
  ds_read_b64 a[164:165], v185 offset:10752
  v_lshlrev_b32 v180, 2, v180
  v_mfma_f32_16x16x32_bf16 v[76:79], a[172:175], a[76:79], v[76:79]
  ds_read_b64 a[166:167], v185 offset:23040
  v_lshlrev_b32 v139, 2, v139
  v_mfma_f32_16x16x32_bf16 v[80:83], a[144:147], a[72:75], v[80:83]
  ds_read_b64 a[168:169], v185 offset:32
  buffer_load_dwordx2 v[240:241], v240, s[4:7], 0 offen
  v_mfma_f32_16x16x32_bf16 v[84:87], a[144:147], a[76:79], v[84:87]
  ds_read_b64 a[170:171], v185 offset:12320
  v_mfma_f32_16x16x32_bf16 v[88:91], a[148:151], a[72:75], v[88:91]
  ds_read_b64 a[172:173], v185 offset:1568
  v_mfma_f32_16x16x32_bf16 v[92:95], a[148:151], a[76:79], v[92:95]
  ds_read_b64 a[174:175], v185 offset:13856
  v_mfma_f32_16x16x32_bf16 v[96:99], a[152:155], a[72:75], v[96:99]
  ds_read_b64 a[144:145], v185 offset:3104
  v_mfma_f32_16x16x32_bf16 v[100:103], a[152:155], a[76:79], v[100:103]
  ds_read_b64 a[146:147], v185 offset:15392
  s_waitcnt lgkmcnt(4)
  v_mfma_f32_16x16x32_bf16 v[104:107], a[156:159], a[72:75], v[104:107]
  ds_read_b64 a[148:149], v185 offset:4640
  buffer_load_dwordx2 v[242:243], v242, s[16:19], 0 offen
  v_mfma_f32_16x16x32_bf16 v[108:111], a[156:159], a[76:79], v[108:111]
  ds_read_b64 a[150:151], v185 offset:16928
  s_mov_b32 s50, 46235648
  v_mfma_f32_16x16x32_bf16 v[112:115], a[160:163], a[72:75], v[112:115]
  ds_read_b64 a[152:153], v185 offset:6176
  v_mfma_f32_16x16x32_bf16 v[116:119], a[160:163], a[76:79], v[116:119]
  ds_read_b64 a[154:155], v185 offset:18464
  v_mfma_f32_16x16x32_bf16 v[120:123], a[164:167], a[72:75], v[120:123]
  ds_read_b64 a[156:157], v185 offset:7712
  v_mfma_f32_16x16x32_bf16 v[124:127], a[164:167], a[76:79], v[124:127]
  ds_read_b64 a[158:159], v185 offset:20000
  s_waitcnt vmcnt(16)
  v_mfma_f32_16x16x32_bf16 v[64:67], a[168:171], a[80:83], v[64:67]
  ds_read_b64 a[160:161], v185 offset:9248
  s_waitcnt vmcnt(15)
  v_mfma_f32_16x16x32_bf16 v[68:71], a[168:171], a[84:87], v[68:71]
  ds_read_b64 a[162:163], v185 offset:21536
  s_waitcnt lgkmcnt(4)
  v_mfma_f32_16x16x32_bf16 v[72:75], a[172:175], a[80:83], v[72:75]
  ds_read_b64 a[164:165], v185 offset:10784
  v_mfma_f32_16x16x32_bf16 v[76:79], a[172:175], a[84:87], v[76:79]
  ds_read_b64 a[166:167], v185 offset:23072
  s_barrier
  v_mfma_f32_16x16x32_bf16 v[80:83], a[144:147], a[80:83], v[80:83]
  ds_read_b64_tr_b16 a[168:169], v198
  v_mfma_f32_16x16x32_bf16 v[84:87], a[144:147], a[84:87], v[84:87]
  ds_read_b64_tr_b16 a[170:171], v198 offset:2048
  v_mfma_f32_16x16x32_bf16 v[88:91], a[148:151], a[80:83], v[88:91]
  ds_read_b64_tr_b16 a[172:173], v199
  v_mfma_f32_16x16x32_bf16 v[92:95], a[148:151], a[84:87], v[92:95]
  ds_read_b64_tr_b16 a[174:175], v199 offset:2048
  v_mfma_f32_16x16x32_bf16 v[96:99], a[152:155], a[80:83], v[96:99]
  ds_read_b64_tr_b16 a[144:145], v200
  v_mfma_f32_16x16x32_bf16 v[100:103], a[152:155], a[84:87], v[100:103]
  ds_read_b64_tr_b16 a[146:147], v200 offset:2048
  s_waitcnt lgkmcnt(4)
  v_mfma_f32_16x16x32_bf16 v[104:107], a[156:159], a[80:83], v[104:107]
  ds_read_b64_tr_b16 a[148:149], v201
  v_mfma_f32_16x16x32_bf16 v[108:111], a[156:159], a[84:87], v[108:111]
  ds_read_b64_tr_b16 a[150:151], v201 offset:2048
  v_mfma_f32_16x16x32_bf16 v[112:115], a[160:163], a[80:83], v[112:115]
  ds_read_b64_tr_b16 a[152:153], v198 offset:12288
  v_mfma_f32_16x16x32_bf16 v[116:119], a[160:163], a[84:87], v[116:119]
  ds_read_b64_tr_b16 a[154:155], v198 offset:14336
  v_mfma_f32_16x16x32_bf16 v[120:123], a[164:167], a[80:83], v[120:123]
  ds_read_b64_tr_b16 a[156:157], v199 offset:12288
  v_mfma_f32_16x16x32_bf16 v[124:127], a[164:167], a[84:87], v[124:127]
  ds_read_b64_tr_b16 a[158:159], v199 offset:14336
  v_mfma_f32_16x16x32_bf16 v[0:3], a[168:171], a[56:59], v[0:3]
  ds_read_b64_tr_b16 a[160:161], v200 offset:12288
  v_mfma_f32_16x16x32_bf16 v[4:7], a[168:171], a[60:63], v[4:7]
  ds_read_b64_tr_b16 a[162:163], v200 offset:14336
  s_waitcnt lgkmcnt(4)
  v_mfma_f32_16x16x32_bf16 v[8:11], a[172:175], a[56:59], v[8:11]
  ds_read_b64_tr_b16 a[164:165], v201 offset:12288
  v_mfma_f32_16x16x32_bf16 v[12:15], a[172:175], a[60:63], v[12:15]
  ds_read_b64_tr_b16 a[166:167], v201 offset:14336
  v_cvt_pk_bf16_f32 v64, v64, v65
  v_mfma_f32_16x16x32_bf16 v[16:19], a[144:147], a[56:59], v[16:19]
  ds_read_b64_tr_b16 a[168:169], v198 offset:4096
  v_cvt_pk_bf16_f32 v65, v66, v67
  v_mfma_f32_16x16x32_bf16 v[20:23], a[144:147], a[60:63], v[20:23]
  ds_read_b64_tr_b16 a[170:171], v198 offset:6144
  v_cvt_pk_bf16_f32 v66, v68, v69
  v_mfma_f32_16x16x32_bf16 v[24:27], a[148:151], a[56:59], v[24:27]
  ds_read_b64_tr_b16 a[172:173], v199 offset:4096
  v_cvt_pk_bf16_f32 v67, v70, v71
  v_mfma_f32_16x16x32_bf16 v[28:31], a[148:151], a[60:63], v[28:31]
  ds_read_b64_tr_b16 a[174:175], v199 offset:6144
  buffer_store_dwordx4 v[64:67], v226, s[24:27], s48 offen sc1
  v_mfma_f32_16x16x32_bf16 v[32:35], a[152:155], a[56:59], v[32:35]
  ds_read_b64_tr_b16 a[144:145], v200 offset:4096
  v_cvt_pk_bf16_f32 v72, v72, v73
  v_mfma_f32_16x16x32_bf16 v[36:39], a[152:155], a[60:63], v[36:39]
  ds_read_b64_tr_b16 a[146:147], v200 offset:6144
  s_waitcnt lgkmcnt(4)
  v_mfma_f32_16x16x32_bf16 v[40:43], a[156:159], a[56:59], v[40:43]
  ds_read_b64_tr_b16 a[148:149], v201 offset:4096
  v_cvt_pk_bf16_f32 v73, v74, v75
  v_mfma_f32_16x16x32_bf16 v[44:47], a[156:159], a[60:63], v[44:47]
  ds_read_b64_tr_b16 a[150:151], v201 offset:6144
  v_cvt_pk_bf16_f32 v74, v76, v77
  v_mfma_f32_16x16x32_bf16 v[48:51], a[160:163], a[56:59], v[48:51]
  ds_read_b64_tr_b16 a[152:153], v198 offset:16384
  v_cvt_pk_bf16_f32 v75, v78, v79
  v_mfma_f32_16x16x32_bf16 v[52:55], a[160:163], a[60:63], v[52:55]
  ds_read_b64_tr_b16 a[154:155], v198 offset:18432
  buffer_store_dwordx4 v[72:75], v226, s[24:27], s48 offen offset:1024 sc1
  v_mfma_f32_16x16x32_bf16 v[56:59], a[164:167], a[56:59], v[56:59]
  ds_read_b64_tr_b16 a[156:157], v199 offset:16384
  v_cvt_pk_bf16_f32 v80, v80, v81
  v_mfma_f32_16x16x32_bf16 v[60:63], a[164:167], a[60:63], v[60:63]
  ds_read_b64_tr_b16 a[158:159], v199 offset:18432
  v_cvt_pk_bf16_f32 v81, v82, v83
  v_mfma_f32_16x16x32_bf16 v[0:3], a[168:171], a[64:67], v[0:3]
  ds_read_b64_tr_b16 a[160:161], v200 offset:16384
  v_cvt_pk_bf16_f32 v82, v84, v85
  v_mfma_f32_16x16x32_bf16 v[4:7], a[168:171], a[68:71], v[4:7]
  ds_read_b64_tr_b16 a[162:163], v200 offset:18432
  s_waitcnt lgkmcnt(4)
  v_mfma_f32_16x16x32_bf16 v[8:11], a[172:175], a[64:67], v[8:11]
  ds_read_b64_tr_b16 a[164:165], v201 offset:16384
  v_cvt_pk_bf16_f32 v83, v86, v87
  v_mfma_f32_16x16x32_bf16 v[12:15], a[172:175], a[68:71], v[12:15]
  ds_read_b64_tr_b16 a[166:167], v201 offset:18432
  buffer_store_dwordx4 v[80:83], v226, s[24:27], s48 offen offset:2048 sc1
  v_mfma_f32_16x16x32_bf16 v[16:19], a[144:147], a[64:67], v[16:19]
  ds_read_b64_tr_b16 a[168:169], v198 offset:8192
  v_cvt_pk_bf16_f32 v88, v88, v89
  v_mfma_f32_16x16x32_bf16 v[20:23], a[144:147], a[68:71], v[20:23]
  ds_read_b64_tr_b16 a[170:171], v198 offset:10240
  v_cvt_pk_bf16_f32 v89, v90, v91
  v_mfma_f32_16x16x32_bf16 v[24:27], a[148:151], a[64:67], v[24:27]
  ds_read_b64_tr_b16 a[172:173], v199 offset:8192
  v_cvt_pk_bf16_f32 v90, v92, v93
  v_mfma_f32_16x16x32_bf16 v[28:31], a[148:151], a[68:71], v[28:31]
  ds_read_b64_tr_b16 a[174:175], v199 offset:10240
  v_cvt_pk_bf16_f32 v91, v94, v95
  v_mfma_f32_16x16x32_bf16 v[32:35], a[152:155], a[64:67], v[32:35]
  ds_read_b64_tr_b16 a[144:145], v200 offset:8192
  buffer_store_dwordx4 v[88:91], v226, s[24:27], s48 offen offset:3072 sc1
  v_mfma_f32_16x16x32_bf16 v[36:39], a[152:155], a[68:71], v[36:39]
  ds_read_b64_tr_b16 a[146:147], v200 offset:10240
  s_waitcnt lgkmcnt(4)
  v_mfma_f32_16x16x32_bf16 v[40:43], a[156:159], a[64:67], v[40:43]
  ds_read_b64_tr_b16 a[148:149], v201 offset:8192
  s_add_u32 s48, s48, 4096
  v_mfma_f32_16x16x32_bf16 v[44:47], a[156:159], a[68:71], v[44:47]
  ds_read_b64_tr_b16 a[150:151], v201 offset:10240
  v_cvt_pk_bf16_f32 v96, v96, v97
  v_mfma_f32_16x16x32_bf16 v[48:51], a[160:163], a[64:67], v[48:51]
  ds_read_b64_tr_b16 a[152:153], v198 offset:20480
  v_cvt_pk_bf16_f32 v97, v98, v99
  v_mfma_f32_16x16x32_bf16 v[52:55], a[160:163], a[68:71], v[52:55]
  ds_read_b64_tr_b16 a[154:155], v198 offset:22528
  v_cvt_pk_bf16_f32 v98, v100, v101
  v_mfma_f32_16x16x32_bf16 v[56:59], a[164:167], a[64:67], v[56:59]
  ds_read_b64_tr_b16 a[156:157], v199 offset:20480
  v_cvt_pk_bf16_f32 v99, v102, v103
  v_mfma_f32_16x16x32_bf16 v[60:63], a[164:167], a[68:71], v[60:63]
  ds_read_b64_tr_b16 a[158:159], v199 offset:22528
  buffer_store_dwordx4 v[96:99], v226, s[24:27], s48 offen sc1
  v_mfma_f32_16x16x32_bf16 v[0:3], a[168:171], a[0:3], v[0:3]
  ds_read_b64_tr_b16 a[160:161], v200 offset:20480
  v_cvt_pk_bf16_f32 v104, v104, v105
  v_mfma_f32_16x16x32_bf16 v[4:7], a[168:171], a[4:7], v[4:7]
  ds_read_b64_tr_b16 a[162:163], v200 offset:22528
  s_waitcnt lgkmcnt(4)
  v_mfma_f32_16x16x32_bf16 v[8:11], a[172:175], a[0:3], v[8:11]
  ds_read_b64_tr_b16 a[164:165], v201 offset:20480
  s_waitcnt vmcnt(14)
  v_mfma_f32_16x16x32_bf16 v[12:15], a[172:175], a[4:7], v[12:15]
  ds_read_b64_tr_b16 a[166:167], v201 offset:22528
  s_barrier
  v_mfma_f32_16x16x32_bf16 v[16:19], a[144:147], a[0:3], v[16:19]
  ds_read_b64 a[168:169], v186 offset:24576
  v_cvt_pk_bf16_f32 v105, v106, v107
  v_mfma_f32_16x16x32_bf16 v[20:23], a[144:147], a[4:7], v[20:23]
  ds_read_b64 a[170:171], v186 offset:36864
  v_cvt_pk_bf16_f32 v106, v108, v109
  v_mfma_f32_16x16x32_bf16 v[24:27], a[148:151], a[0:3], v[24:27]
  ds_read_b64 a[172:173], v186 offset:26112
  v_cvt_pk_bf16_f32 v107, v110, v111
  v_mfma_f32_16x16x32_bf16 v[28:31], a[148:151], a[4:7], v[28:31]
  ds_read_b64 a[174:175], v186 offset:38400
  buffer_store_dwordx4 v[104:107], v226, s[24:27], s48 offen offset:1024 sc1
  v_mfma_f32_16x16x32_bf16 v[32:35], a[152:155], a[0:3], v[32:35]
  ds_read_b64 a[144:145], v186 offset:27648
  v_cvt_pk_bf16_f32 v112, v112, v113
  v_cvt_pk_bf16_f32 v113, v114, v115
  v_mfma_f32_16x16x32_bf16 v[36:39], a[152:155], a[4:7], v[36:39]
  ds_read_b64 a[146:147], v186 offset:39936
  s_waitcnt vmcnt(9)
  v_cmp_le_u32 vcc, 5, v218
  s_nop 3
  s_or_b64 vcc, vcc, s[56:57]
  s_cmp_eq_u64 vcc, -1
  s_cselect_b32 s88, 1, 0
  s_cselect_b32 s84, s89, 0x7ff00000
  s_cselect_b32 s49, s50, 0x7ff00000
  s_waitcnt lgkmcnt(4)
  v_mfma_f32_16x16x32_bf16 v[40:43], a[156:159], a[0:3], v[40:43]
  ds_read_b64 a[148:149], v186 offset:29184
  v_cvt_pk_bf16_f32 v114, v116, v117
  v_mfma_f32_16x16x32_bf16 v[44:47], a[156:159], a[4:7], v[44:47]
  ds_read_b64 a[150:151], v186 offset:41472
  v_cvt_pk_bf16_f32 v115, v118, v119
  v_mfma_f32_16x16x32_bf16 v[48:51], a[160:163], a[0:3], v[48:51]
  ds_read_b64 a[152:153], v186 offset:30720
  buffer_store_dwordx4 v[112:115], v226, s[24:27], s48 offen offset:2048 sc1
  v_mfma_f32_16x16x32_bf16 v[52:55], a[160:163], a[4:7], v[52:55]
  ds_read_b64 a[154:155], v186 offset:43008
  v_cvt_pk_bf16_f32 v120, v120, v121
  v_mfma_f32_16x16x32_bf16 v[56:59], a[164:167], a[0:3], v[56:59]
  ds_read_b64 a[156:157], v186 offset:32256
  v_cvt_pk_bf16_f32 v121, v122, v123
  v_mfma_f32_16x16x32_bf16 v[60:63], a[164:167], a[4:7], v[60:63]
  ds_read_b64 a[158:159], v186 offset:44544
  v_cvt_pk_bf16_f32 v122, v124, v125
  v_mfma_f32_16x16x32_bf16 v[0:3], a[168:171], a[72:75], v[0:3]
  ds_read_b64 a[160:161], v186 offset:33792
  v_cvt_pk_bf16_f32 v123, v126, v127
  v_mfma_f32_16x16x32_bf16 v[4:7], a[168:171], a[76:79], v[4:7]
  ds_read_b64 a[162:163], v186 offset:46080
  s_waitcnt lgkmcnt(4)
  v_mfma_f32_16x16x32_bf16 v[8:11], a[172:175], a[72:75], v[8:11]
  ds_read_b64 a[164:165], v186 offset:35328
  buffer_store_dwordx4 v[120:123], v226, s[24:27], s48 offen offset:3072 sc1
  v_mfma_f32_16x16x32_bf16 v[12:15], a[172:175], a[76:79], v[12:15]
  ds_read_b64 a[166:167], v186 offset:47616
  s_add_u32 s48, s48, 4096
  v_mfma_f32_16x16x32_bf16 v[16:19], a[144:147], a[72:75], v[16:19]
  ds_read_b64 a[168:169], v186 offset:24608
  v_mfma_f32_16x16x32_bf16 v[20:23], a[144:147], a[76:79], v[20:23]
  ds_read_b64 a[170:171], v186 offset:36896
  v_mfma_f32_16x16x32_bf16 v[24:27], a[148:151], a[72:75], v[24:27]
  ds_read_b64 a[172:173], v186 offset:26144
  v_mfma_f32_16x16x32_bf16 v[28:31], a[148:151], a[76:79], v[28:31]
  ds_read_b64 a[174:175], v186 offset:38432
  buffer_load_dword v181, v180, s[24:27], s49 offen sc1
  v_mfma_f32_16x16x32_bf16 v[32:35], a[152:155], a[72:75], v[32:35]
  ds_read_b64 a[144:145], v186 offset:27680
  v_mfma_f32_16x16x32_bf16 v[36:39], a[152:155], a[76:79], v[36:39]
  ds_read_b64 a[146:147], v186 offset:39968
  s_waitcnt lgkmcnt(4)
  v_mfma_f32_16x16x32_bf16 v[40:43], a[156:159], a[72:75], v[40:43]
  ds_read_b64 a[148:149], v186 offset:29216
  v_mfma_f32_16x16x32_bf16 v[44:47], a[156:159], a[76:79], v[44:47]
  ds_read_b64 a[150:151], v186 offset:41504
  v_mfma_f32_16x16x32_bf16 v[48:51], a[160:163], a[72:75], v[48:51]
  ds_read_b64 a[152:153], v186 offset:30752
  buffer_load_dwordx2 a[96:97], v226, s[24:27], s84 offen sc1
  v_mfma_f32_16x16x32_bf16 v[52:55], a[160:163], a[76:79], v[52:55]
  ds_read_b64 a[154:155], v186 offset:43040
  s_add_u32 s84, s84, 262144
  v_mfma_f32_16x16x32_bf16 v[56:59], a[164:167], a[72:75], v[56:59]
  ds_read_b64 a[156:157], v186 offset:32288
  v_mfma_f32_16x16x32_bf16 v[60:63], a[164:167], a[76:79], v[60:63]
  ds_read_b64 a[158:159], v186 offset:44576
  v_mfma_f32_16x16x32_bf16 v[0:3], a[168:171], a[80:83], v[0:3]
  ds_read_b64 a[160:161], v186 offset:33824
  v_mfma_f32_16x16x32_bf16 v[4:7], a[168:171], a[84:87], v[4:7]
  ds_read_b64 a[162:163], v186 offset:46112
  s_waitcnt lgkmcnt(4)
  v_mfma_f32_16x16x32_bf16 v[8:11], a[172:175], a[80:83], v[8:11]
  ds_read_b64 a[164:165], v186 offset:35360
  buffer_load_dwordx2 a[98:99], v226, s[24:27], s84 offen sc1
  v_mfma_f32_16x16x32_bf16 v[12:15], a[172:175], a[84:87], v[12:15]
  ds_read_b64 a[166:167], v186 offset:47648
  s_add_u32 s84, s84, 262144
  v_mfma_f32_16x16x32_bf16 v[16:19], a[144:147], a[80:83], v[16:19]
  v_mfma_f32_16x16x32_bf16 v[20:23], a[144:147], a[84:87], v[20:23]
  v_mfma_f32_16x16x32_bf16 v[24:27], a[148:151], a[80:83], v[24:27]
  v_mfma_f32_16x16x32_bf16 v[28:31], a[148:151], a[84:87], v[28:31]
  buffer_load_dwordx2 a[100:101], v226, s[24:27], s84 offen sc1
  s_add_u32 s84, s84, 262144
  v_mfma_f32_16x16x32_bf16 v[32:35], a[152:155], a[80:83], v[32:35]
  v_mfma_f32_16x16x32_bf16 v[36:39], a[152:155], a[84:87], v[36:39]
  s_waitcnt lgkmcnt(0)
  v_mfma_f32_16x16x32_bf16 v[40:43], a[156:159], a[80:83], v[40:43]
  v_mfma_f32_16x16x32_bf16 v[44:47], a[156:159], a[84:87], v[44:47]
  v_mfma_f32_16x16x32_bf16 v[48:51], a[160:163], a[80:83], v[48:51]
  buffer_load_dwordx2 a[102:103], v226, s[24:27], s84 offen sc1
  s_add_u32 s84, s84, 262144
  v_mfma_f32_16x16x32_bf16 v[52:55], a[160:163], a[84:87], v[52:55]
  v_mfma_f32_16x16x32_bf16 v[56:59], a[164:167], a[80:83], v[56:59]
  v_mfma_f32_16x16x32_bf16 v[60:63], a[164:167], a[84:87], v[60:63]
  v_cvt_pk_bf16_f32 v0, v0, v1
  v_cvt_pk_bf16_f32 v1, v2, v3
  v_cvt_pk_bf16_f32 v2, v4, v5
  v_cvt_pk_bf16_f32 v3, v6, v7
  buffer_store_dwordx4 v[0:3], v226, s[24:27], s48 offen sc1
  v_cvt_pk_bf16_f32 v8, v8, v9
  v_cvt_pk_bf16_f32 v9, v10, v11
  v_cvt_pk_bf16_f32 v10, v12, v13
  v_cvt_pk_bf16_f32 v11, v14, v15
  buffer_store_dwordx4 v[8:11], v226, s[24:27], s48 offen offset:1024 sc1
  v_cvt_pk_bf16_f32 v16, v16, v17
  v_cvt_pk_bf16_f32 v17, v18, v19
  v_cvt_pk_bf16_f32 v18, v20, v21
  v_cvt_pk_bf16_f32 v19, v22, v23
  buffer_store_dwordx4 v[16:19], v226, s[24:27], s48 offen offset:2048 sc1
  v_cvt_pk_bf16_f32 v24, v24, v25
  v_cvt_pk_bf16_f32 v25, v26, v27
  v_cvt_pk_bf16_f32 v26, v28, v29
  v_cvt_pk_bf16_f32 v27, v30, v31
  buffer_store_dwordx4 v[24:27], v226, s[24:27], s48 offen offset:3072 sc1
  s_add_u32 s48, s48, 4096
  v_cvt_pk_bf16_f32 v32, v32, v33
  v_cvt_pk_bf16_f32 v33, v34, v35
  v_cvt_pk_bf16_f32 v34, v36, v37
  v_cvt_pk_bf16_f32 v35, v38, v39
  buffer_store_dwordx4 v[32:35], v226, s[24:27], s48 offen sc1
  v_cvt_pk_bf16_f32 v40, v40, v41
  v_cvt_pk_bf16_f32 v41, v42, v43
  v_cvt_pk_bf16_f32 v42, v44, v45
  v_cvt_pk_bf16_f32 v43, v46, v47
  buffer_store_dwordx4 v[40:43], v226, s[24:27], s48 offen offset:1024 sc1
  v_cvt_pk_bf16_f32 v48, v48, v49
  v_cvt_pk_bf16_f32 v49, v50, v51
  v_cvt_pk_bf16_f32 v50, v52, v53
  v_cvt_pk_bf16_f32 v51, v54, v55
  buffer_store_dwordx4 v[48:51], v226, s[24:27], s48 offen offset:2048 sc1
  v_cvt_pk_bf16_f32 v56, v56, v57
  v_cvt_pk_bf16_f32 v57, v58, v59
  v_cvt_pk_bf16_f32 v58, v60, v61
  v_cvt_pk_bf16_f32 v59, v62, v63
  buffer_store_dwordx4 v[56:59], v226, s[24:27], s48 offen offset:3072 sc1
  s_add_u32 s48, s48, 4096
  buffer_load_dwordx2 a[104:105], v226, s[24:27], s84 offen sc1
  s_add_u32 s84, s84, 262144
  buffer_load_dwordx2 a[106:107], v226, s[24:27], s84 offen sc1
  s_add_u32 s84, s84, 262144
  buffer_load_dwordx2 a[108:109], v226, s[24:27], s84 offen sc1
  s_add_u32 s84, s84, 262144
  buffer_load_dwordx2 a[110:111], v226, s[24:27], s84 offen sc1
  v_lshlrev_b32 v176, 16, v228
  v_and_b32 v177, 0xffff0000, v228
  v_lshlrev_b32 v178, 16, v232
  v_and_b32 v179, 0xffff0000, v232
  v_mul_f32 v176, v176, v178
  v_mul_f32 v177, v177, v179
  v_cvt_pk_bf16_f32 v176, v176, v177
  v_and_b32 v177, 0xffff0000, v176
  v_lshlrev_b32 v176, 16, v176
  v_mul_f32 v152, v222, v176
  v_mul_f32 v153, v222, v177
  v_lshlrev_b32 v176, 16, v229
  v_and_b32 v177, 0xffff0000, v229
  v_lshlrev_b32 v178, 16, v233
  v_and_b32 v179, 0xffff0000, v233
  v_mul_f32 v176, v176, v178
  v_mul_f32 v177, v177, v179
  v_cvt_pk_bf16_f32 v176, v176, v177
  v_and_b32 v177, 0xffff0000, v176
  v_lshlrev_b32 v176, 16, v176
  v_mul_f32 v154, v222, v176
  v_mul_f32 v155, v222, v177
  v_lshlrev_b32 v176, 16, v230
  v_and_b32 v177, 0xffff0000, v230
  v_lshlrev_b32 v178, 16, v232
  v_and_b32 v179, 0xffff0000, v232
  v_mul_f32 v176, v176, v178
  v_mul_f32 v177, v177, v179
  v_cvt_pk_bf16_f32 v176, v176, v177
  v_and_b32 v177, 0xffff0000, v176
  v_lshlrev_b32 v176, 16, v176
  v_mul_f32 v156, v223, v176
  v_mul_f32 v157, v223, v177
  v_lshlrev_b32 v176, 16, v231
  v_and_b32 v177, 0xffff0000, v231
  v_lshlrev_b32 v178, 16, v233
  v_and_b32 v179, 0xffff0000, v233
  v_mul_f32 v176, v176, v178
  v_mul_f32 v177, v177, v179
  v_cvt_pk_bf16_f32 v176, v176, v177
  v_and_b32 v177, 0xffff0000, v176
  v_lshlrev_b32 v176, 16, v176
  v_mul_f32 v158, v223, v176
  v_mul_f32 v159, v223, v177
  v_lshlrev_b32 v176, 16, v234
  v_and_b32 v177, 0xffff0000, v234
  s_waitcnt vmcnt(27)
  v_lshlrev_b32 v178, 16, v238
  v_and_b32 v179, 0xffff0000, v238
  v_mul_f32 v176, v176, v178
  v_mul_f32 v177, v177, v179
  v_cvt_pk_bf16_f32 v176, v176, v177
  v_and_b32 v177, 0xffff0000, v176
  v_lshlrev_b32 v176, 16, v176
  v_mul_f32 v168, v222, v176
  v_mul_f32 v169, v222, v177
  v_lshlrev_b32 v176, 16, v235
  v_and_b32 v177, 0xffff0000, v235
  v_lshlrev_b32 v178, 16, v239
  v_and_b32 v179, 0xffff0000, v239
  v_mul_f32 v176, v176, v178
  v_mul_f32 v177, v177, v179
  v_cvt_pk_bf16_f32 v176, v176, v177
  v_and_b32 v177, 0xffff0000, v176
  v_lshlrev_b32 v176, 16, v176
  v_mul_f32 v170, v222, v176
  v_mul_f32 v171, v222, v177
  v_lshlrev_b32 v176, 16, v236
  v_and_b32 v177, 0xffff0000, v236
  v_lshlrev_b32 v178, 16, v238
  v_and_b32 v179, 0xffff0000, v238
  v_mul_f32 v176, v176, v178
  v_mul_f32 v177, v177, v179
  v_cvt_pk_bf16_f32 v176, v176, v177
  v_and_b32 v177, 0xffff0000, v176
  v_lshlrev_b32 v176, 16, v176
  v_mul_f32 v172, v223, v176
  v_mul_f32 v173, v223, v177
  v_lshlrev_b32 v176, 16, v237
  v_and_b32 v177, 0xffff0000, v237
  v_lshlrev_b32 v178, 16, v239
  v_and_b32 v179, 0xffff0000, v239
  v_mul_f32 v176, v176, v178
  v_mul_f32 v177, v177, v179
  v_cvt_pk_bf16_f32 v176, v176, v177
  v_and_b32 v177, 0xffff0000, v176
  v_lshlrev_b32 v176, 16, v176
  v_mul_f32 v174, v223, v176
  v_mul_f32 v175, v223, v177
  v_lshrrev_b32 v229, 2, v219
  v_xor_b32 v231, v229, v220
  v_and_b32 v229, 1, v219
  v_lshlrev_b32 v229, 4, v229
  v_mov_b32 v230, 0x3f80
  v_lshlrev_b32 v229, v229, v230
  v_cmp_eq_u32 vcc, 0, v231
  s_nop 1
  v_cndmask_b32 v229, 0, v229, vcc
  v_and_b32 v228, 2, v219
  v_cmp_eq_u32 vcc, 0, v228
  s_nop 1
  v_cndmask_b32 v228, 0, v229, vcc
  v_cndmask_b32 v229, v229, 0, vcc
  v_mov_b32 v230, 0
  v_accvgpr_write_b32 a112, v228
  v_accvgpr_write_b32 a114, v228
  v_accvgpr_write_b32 a116, v228
  v_accvgpr_write_b32 a122, v228
  v_accvgpr_write_b32 a113, v229
  v_accvgpr_write_b32 a115, v229
  v_accvgpr_write_b32 a117, v229
  v_accvgpr_write_b32 a123, v229
  v_accvgpr_write_b32 a118, v230
  v_accvgpr_write_b32 a119, v230
  v_accvgpr_write_b32 a120, v230
  v_accvgpr_write_b32 a121, v230
  s_waitcnt vmcnt(17)
  s_barrier
  v_mov_b32 v189, 6
  buffer_store_dword v189, v187, s[24:27], 0 offen sc1
  s_waitcnt vmcnt(1)
  s_cmp_eq_u32 s88, 1
  s_cbranch_scc0 L_slow_M1
L_back_M1:
  s_cmp_lt_u32 s40, 2
  s_cselect_b32 s49, 1.0, 0
  v_mul_f32 v181, s49, v181
  v_lshlrev_b32 v176, 16, v240
  v_and_b32 v177, 0xffff0000, v240
  v_lshlrev_b32 v178, 16, v242
  v_and_b32 v179, 0xffff0000, v242
  v_mul_f32 v176, v176, v178
  v_mul_f32 v177, v177, v179
  v_cvt_pk_bf16_f32 v176, v176, v177
  v_and_b32 v177, 0xffff0000, v176
  v_lshlrev_b32 v176, 16, v176
  v_mul_f32 v140, v181, v176
  v_mul_f32 v141, v181, v177
  v_lshlrev_b32 v176, 16, v241
  v_and_b32 v177, 0xffff0000, v241
  v_lshlrev_b32 v178, 16, v243
  v_and_b32 v179, 0xffff0000, v243
  v_mul_f32 v176, v176, v178
  v_mul_f32 v177, v177, v179
  v_cvt_pk_bf16_f32 v176, v176, v177
  v_and_b32 v177, 0xffff0000, v176
  v_lshlrev_b32 v176, 16, v176
  v_mul_f32 v142, v181, v176
  v_mul_f32 v143, v181, v177
  s_nop 1
  v_mfma_f32_16x16x32_bf16 v[140:143], a[112:115], a[96:99], v[140:143]
  v_mfma_f32_16x16x32_bf16 v[140:143], a[112:115], a[100:103], v[140:143]
  v_mfma_f32_16x16x32_bf16 v[140:143], a[112:115], a[104:107], v[140:143]
  v_mfma_f32_16x16x32_bf16 v[140:143], a[112:115], a[108:111], v[140:143]
  s_and_b32 s49, s40, 1
  s_lshl_b32 s49, s49, 10
  v_add_u32 v240, s49, v226
  s_cmp_ge_u32 s40, 2
  s_cselect_b32 s50, 0, 2048
  v_add_u32 v241, s50, v240
  s_nop 1
  ds_write_b128 v241, v[140:143]
  buffer_load_dword v218, v217, s[24:27], 0 offen sc1
  s_waitcnt lgkmcnt(0)
  s_barrier
  v_mov_b32 v189, 7
  buffer_store_dword v189, v187, s[24:27], 0 offen sc1
  ds_read_b128 v[180:183], v240
  s_waitcnt vmcnt(1)
  v_cmp_le_u32 vcc, 6, v218
  s_nop 3
  s_or_b64 vcc, vcc, s[58:59]
  s_cmp_eq_u64 vcc, -1
  s_cbranch_scc0 L_slow_PA1
L_back_PA1:
  s_add_u32 s84, s86, 0
  buffer_load_dwordx4 v[32:35], v226, s[24:27], s84 offen sc1
  s_add_u32 s84, s84, 2097152
  buffer_load_dwordx4 v[36:39], v226, s[24:27], s84 offen sc1
  s_add_u32 s84, s84, 2097152
  buffer_load_dwordx4 v[40:43], v226, s[24:27], s84 offen sc1
  s_add_u32 s84, s84, 2097152
  buffer_load_dwordx4 v[44:47], v226, s[24:27], s84 offen sc1
  s_add_u32 s84, s84, 2097152
  buffer_load_dwordx4 v[48:51], v226, s[24:27], s84 offen sc1
  s_add_u32 s84, s84, 2097152
  buffer_load_dwordx4 v[52:55], v226, s[24:27], s84 offen sc1
  s_add_u32 s84, s84, 2097152
  buffer_load_dwordx4 v[56:59], v226, s[24:27], s84 offen sc1
  s_add_u32 s84, s84, 2097152
  buffer_load_dwordx4 v[60:63], v226, s[24:27], s84 offen sc1
  buffer_load_dword v218, v217, s[24:27], 0 offen sc1
  s_waitcnt lgkmcnt(0)
  v_add_f32 v140, v140, v180
  v_add_f32 v141, v141, v181
  v_add_f32 v142, v142, v182
  v_add_f32 v143, v143, v183
  s_cmp_lt_u32 s40, 2
  s_cselect_b32 s49, 0, 0x7ff00000
  buffer_store_dwordx4 v[140:143], v139, s[36:39], s49 offen nt
  s_waitcnt vmcnt(9)
  v_mfma_f32_16x16x32_bf16 v[152:155], a[116:119], v[32:35], v[152:155]
  v_mfma_f32_16x16x32_bf16 v[156:159], a[120:123], v[32:35], v[156:159]
  s_waitcnt vmcnt(8)
  v_mfma_f32_16x16x32_bf16 v[152:155], a[116:119], v[36:39], v[152:155]
  v_mfma_f32_16x16x32_bf16 v[156:159], a[120:123], v[36:39], v[156:159]
  s_waitcnt vmcnt(7)
  v_mfma_f32_16x16x32_bf16 v[152:155], a[116:119], v[40:43], v[152:155]
  v_mfma_f32_16x16x32_bf16 v[156:159], a[120:123], v[40:43], v[156:159]
  s_waitcnt vmcnt(6)
  v_mfma_f32_16x16x32_bf16 v[152:155], a[116:119], v[44:47], v[152:155]
  v_mfma_f32_16x16x32_bf16 v[156:159], a[120:123], v[44:47], v[156:159]
  s_waitcnt vmcnt(5)
  v_mfma_f32_16x16x32_bf16 v[152:155], a[116:119], v[48:51], v[152:155]
  v_mfma_f32_16x16x32_bf16 v[156:159], a[120:123], v[48:51], v[156:159]
  s_waitcnt vmcnt(4)
  v_mfma_f32_16x16x32_bf16 v[152:155], a[116:119], v[52:55], v[152:155]
  v_mfma_f32_16x16x32_bf16 v[156:159], a[120:123], v[52:55], v[156:159]
  s_waitcnt vmcnt(3)
  v_mfma_f32_16x16x32_bf16 v[152:155], a[116:119], v[56:59], v[152:155]
  v_mfma_f32_16x16x32_bf16 v[156:159], a[120:123], v[56:59], v[156:159]
  s_waitcnt vmcnt(2)
  v_mfma_f32_16x16x32_bf16 v[152:155], a[116:119], v[60:63], v[152:155]
  v_mfma_f32_16x16x32_bf16 v[156:159], a[120:123], v[60:63], v[156:159]
  s_mov_b32 s49, 0
  s_mov_b32 s50, 36864
  s_nop 4
  buffer_store_dwordx4 v[152:155], v136, s[36:39], s49 offen nt
  buffer_store_dwordx4 v[156:159], v136, s[36:39], s50 offen nt
  s_waitcnt vmcnt(3)
  v_cmp_le_u32 vcc, 7, v218
  s_nop 3
  s_or_b64 vcc, vcc, s[58:59]
  s_cmp_eq_u64 vcc, -1
  s_cbranch_scc0 L_slow_PB1
L_back_PB1:
  s_add_u32 s84, s86, 8192
  buffer_load_dwordx4 v[64:67], v226, s[24:27], s84 offen sc1
  s_add_u32 s84, s84, 2097152
  buffer_load_dwordx4 v[68:71], v226, s[24:27], s84 offen sc1
  s_add_u32 s84, s84, 2097152
  buffer_load_dwordx4 v[72:75], v226, s[24:27], s84 offen sc1
  s_add_u32 s84, s84, 2097152
  buffer_load_dwordx4 v[76:79], v226, s[24:27], s84 offen sc1
  s_add_u32 s84, s84, 2097152
  buffer_load_dwordx4 v[80:83], v226, s[24:27], s84 offen sc1
  s_add_u32 s84, s84, 2097152
  buffer_load_dwordx4 v[84:87], v226, s[24:27], s84 offen sc1
  s_add_u32 s84, s84, 2097152
  buffer_load_dwordx4 v[88:91], v226, s[24:27], s84 offen sc1
  s_add_u32 s84, s84, 2097152
  buffer_load_dwordx4 v[92:95], v226, s[24:27], s84 offen sc1
  s_waitcnt vmcnt(7)
  v_mfma_f32_16x16x32_bf16 v[168:171], a[116:119], v[64:67], v[168:171]
  v_mfma_f32_16x16x32_bf16 v[172:175], a[120:123], v[64:67], v[172:175]
  s_waitcnt vmcnt(6)
  v_mfma_f32_16x16x32_bf16 v[168:171], a[116:119], v[68:71], v[168:171]
  v_mfma_f32_16x16x32_bf16 v[172:175], a[120:123], v[68:71], v[172:175]
  s_waitcnt vmcnt(5)
  v_mfma_f32_16x16x32_bf16 v[168:171], a[116:119], v[72:75], v[168:171]
  v_mfma_f32_16x16x32_bf16 v[172:175], a[120:123], v[72:75], v[172:175]
  s_waitcnt vmcnt(4)
  v_mfma_f32_16x16x32_bf16 v[168:171], a[116:119], v[76:79], v[168:171]
  v_mfma_f32_16x16x32_bf16 v[172:175], a[120:123], v[76:79], v[172:175]
  s_waitcnt vmcnt(3)
  v_mfma_f32_16x16x32_bf16 v[168:171], a[116:119], v[80:83], v[168:171]
  v_mfma_f32_16x16x32_bf16 v[172:175], a[120:123], v[80:83], v[172:175]
  s_waitcnt vmcnt(2)
  v_mfma_f32_16x16x32_bf16 v[168:171], a[116:119], v[84:87], v[168:171]
  v_mfma_f32_16x16x32_bf16 v[172:175], a[120:123], v[84:87], v[172:175]
  s_waitcnt vmcnt(1)
  v_mfma_f32_16x16x32_bf16 v[168:171], a[116:119], v[88:91], v[168:171]
  v_mfma_f32_16x16x32_bf16 v[172:175], a[120:123], v[88:91], v[172:175]
  s_waitcnt vmcnt(0)
  v_mfma_f32_16x16x32_bf16 v[168:171], a[116:119], v[92:95], v[168:171]
  v_mfma_f32_16x16x32_bf16 v[172:175], a[120:123], v[92:95], v[172:175]
  s_mov_b32 s49, 512
  s_mov_b32 s50, 37376
  s_nop 4
  buffer_store_dwordx4 v[168:171], v136, s[36:39], s49 offen nt
  buffer_store_dwordx4 v[172:175], v136, s[36:39], s50 offen nt
  s_endpgm
L_slow_C1:
  s_mov_b32 s51, 0
L_slowl_C1:
  s_sleep 1
  buffer_load_ubyte v249, v248, s[32:35], 0 offen sc1
  s_waitcnt vmcnt(0)
  v_cmp_ne_u32 vcc, 0, v249
  s_nop 4
  s_or_b32 vcc_hi, vcc_hi, -1
  s_cmp_eq_u64 vcc, -1
  s_cbranch_scc1 L_back_C1
  s_add_u32 s51, s51, 1
  s_cmp_lt_u32 s51, 0x40000
  s_cbranch_scc1 L_slowl_C1
  s_branch L_back_C1
L_slow_S1:
  s_mov_b32 s51, 0
L_slowl_S1:
  s_sleep 1
  buffer_load_dword v249, v248, s[24:27], 0 offen sc1
  s_waitcnt vmcnt(0)
  v_cmp_ne_u32 vcc, 0, v249
  s_nop 4
  s_or_b64 vcc, vcc, s[56:57]
  s_cmp_eq_u64 vcc, -1
  s_cbranch_scc1 L_back_S1
  s_add_u32 s51, s51, 1
  s_cmp_lt_u32 s51, 0x40000
  s_cbranch_scc1 L_slowl_S1
  s_branch L_back_S1
L_slow_A1:
  s_mov_b32 s75, 0
L_slowl_A1:
  s_sleep 1
  buffer_load_dword v202, v188, s[24:27], 0 offen sc1
  s_waitcnt vmcnt(0)
  v_cmp_le_u32 vcc, 2, v202
  s_nop 4
  s_cmp_eq_u64 vcc, -1
  s_cbranch_scc1 L_back_A1
  s_add_u32 s75, s75, 1
  s_cmp_lt_u32 s75, 0x40000
  s_cbranch_scc1 L_slowl_A1
  s_branch L_back_A1
L_slow_B1:
  s_mov_b32 s75, 0
L_slowl_B1:
  s_sleep 1
  buffer_load_dword v202, v188, s[24:27], 0 offen sc1
  s_waitcnt vmcnt(0)
  v_cmp_le_u32 vcc, 3, v202
  s_nop 4
  s_cmp_eq_u64 vcc, -1
  s_cbranch_scc1 L_back_B1
  s_add_u32 s75, s75, 1
  s_cmp_lt_u32 s75, 0x40000
  s_cbranch_scc1 L_slowl_B1
  s_branch L_back_B1
L_slow_D1:
  s_mov_b32 s75, 0
L_slowl_D1:
  s_sleep 1
  buffer_load_dword v202, v188, s[24:27], 0 offen sc1
  s_waitcnt vmcnt(0)
  v_cmp_le_u32 vcc, 4, v202
  s_nop 4
  s_cmp_eq_u64 vcc, -1
  s_cbranch_scc1 L_back_D1
  s_add_u32 s75, s75, 1
  s_cmp_lt_u32 s75, 0x40000
  s_cbranch_scc1 L_slowl_D1
  s_branch L_back_D1
L_slow_M1:
  s_mov_b32 s51, 0
L_slowl_M1:
  buffer_load_dword v218, v217, s[24:27], 0 offen sc1
  s_waitcnt vmcnt(0)
  v_cmp_le_u32 vcc, 5, v218
  s_nop 4
  s_or_b64 vcc, vcc, s[56:57]
  s_cmp_eq_u64 vcc, -1
  s_cbranch_scc1 L_slowd_M1
  s_add_u32 s51, s51, 1
  s_cmp_lt_u32 s51, 0x40000
  s_cbranch_scc1 L_slowl_M1
L_slowd_M1:
  s_mov_b32 s84, s89
  s_mov_b32 s49, 46235648
  buffer_load_dword v181, v180, s[24:27], s49 offen sc1
  buffer_load_dwordx2 a[96:97], v226, s[24:27], s84 offen sc1
  s_add_u32 s84, s84, 262144
  buffer_load_dwordx2 a[98:99], v226, s[24:27], s84 offen sc1
  s_add_u32 s84, s84, 262144
  buffer_load_dwordx2 a[100:101], v226, s[24:27], s84 offen sc1
  s_add_u32 s84, s84, 262144
  buffer_load_dwordx2 a[102:103], v226, s[24:27], s84 offen sc1
  s_add_u32 s84, s84, 262144
  buffer_load_dwordx2 a[104:105], v226, s[24:27], s84 offen sc1
  s_add_u32 s84, s84, 262144
  buffer_load_dwordx2 a[106:107], v226, s[24:27], s84 offen sc1
  s_add_u32 s84, s84, 262144
  buffer_load_dwordx2 a[108:109], v226, s[24:27], s84 offen sc1
  s_add_u32 s84, s84, 262144
  buffer_load_dwordx2 a[110:111], v226, s[24:27], s84 offen sc1
  buffer_load_dword v218, v217, s[24:27], 0 offen sc1
  s_waitcnt vmcnt(0)
  s_branch L_back_M1
L_slow_PA1:
  s_mov_b32 s51, 0
L_slowl_PA1:
  buffer_load_dword v218, v217, s[24:27], 0 offen sc1
  s_waitcnt vmcnt(0)
  v_cmp_le_u32 vcc, 6, v218
  s_nop 4
  s_or_b64 vcc, vcc, s[58:59]
  s_cmp_eq_u64 vcc, -1
  s_cbranch_scc1 L_slowd_PA1
  s_add_u32 s51, s51, 1
  s_cmp_lt_u32 s51, 0x40000
  s_cbranch_scc1 L_slowl_PA1
L_slowd_PA1:
  s_waitcnt vmcnt(0)
  s_branch L_back_PA1
L_slow_PB1:
  s_mov_b32 s51, 0
L_slowl_PB1:
  buffer_load_dword v218, v217, s[24:27], 0 offen sc1
  s_waitcnt vmcnt(0)
  v_cmp_le_u32 vcc, 7, v218
  s_nop 4
  s_or_b64 vcc, vcc, s[58:59]
  s_cmp_eq_u64 vcc, -1
  s_cbranch_scc1 L_slowd_PB1
  s_add_u32 s51, s51, 1
  s_cmp_lt_u32 s51, 0x40000
  s_cbranch_scc1 L_slowl_PB1
L_slowd_PB1:
  s_waitcnt vmcnt(0)
  s_branch L_back_PB1
L_end1:
.set CODE_SPAN0, L_end0 - L_pc0 - 4
.set CODE_SPAN1, L_end1 - L_pc1 - 4
.section .rodata,"a"
.p2align 6
.amdhsa_kernel gated_mix__ssm_conv_s5__glu_gated_reglu__prompt_kernel
  .amdhsa_next_free_vgpr 512
  .amdhsa_next_free_sgpr 102
  .amdhsa_accum_offset 256
  .amdhsa_group_segment_fixed_size 0
  .amdhsa_kernarg_size 136
  .amdhsa_user_sgpr_count 2
  .amdhsa_user_sgpr_kernarg_segment_ptr 1
  .amdhsa_system_sgpr_workgroup_id_x 1
.end_amdhsa_kernel
```
